```python
import torch

def _softmax(x, axis=-1):
    return torch.softmax(x, dim=axis)
def _gelu(x):
    return torch.nn.functional.gelu(x, approximate="tanh")
def _silu(x):
    return torch.nn.functional.silu(x)
def _sigmoid(x):
    return torch.sigmoid(x)
def _layernorm(x, axis=-1, eps=1e-5):
    m = x.mean(dim=axis, keepdim=True)
    v = x.var(dim=axis, keepdim=True, unbiased=False)
    return (x - m) / torch.sqrt(v + eps)
def _scatter_add(tgt, idx, src, axis=0):
    return tgt.clone().index_add_(axis, idx, src)
def _segment_sum(src, seg, n):
    out = torch.zeros((n,) + src.shape[1:], dtype=src.dtype)
    return out.index_add_(0, seg, src)
def _pad(x, pw):
    flat = tuple(v for pair in reversed(pw) for v in pair)
    return torch.nn.functional.pad(x, flat)

kernel_name = 'interleave_layers__mha_block__mixer_channel_mlp__prompt'

def setup_inputs():

    _w = (lambda a: (lambda t: t.to(torch.bfloat16) if t.is_floating_point() else t)(torch.as_tensor(a)))
    def _A_setup():
        B, S, D, H = 1, 2048, 640, 32
        return {
            "x": _w((lambda *s: torch.randn(*s, dtype=torch.bfloat16) * 0.05)(B, S, D)),
            "wqkv": _w((lambda *s: torch.randn(*s, dtype=torch.bfloat16) * 0.05)(D, 3 * D)),
            "wo": _w((lambda *s: torch.randn(*s, dtype=torch.bfloat16) * 0.05)(D, D)),
        }
    _A_in = _A_setup()

    def _B_setup():
        B, S, D, F = 1, 2048, 640, 1536
        return {
            "x": _w((lambda *s: torch.randn(*s, dtype=torch.bfloat16) * 0.05)(B, S, D)),
            "w1": _w((lambda *s: torch.randn(*s, dtype=torch.bfloat16) * 3.2)(D, F) * (D ** -0.5)),
            "b1": _w((lambda *s: torch.randn(*s, dtype=torch.bfloat16) * 0.8)(F)),
            "w2": _w((lambda *s: torch.randn(*s, dtype=torch.bfloat16) * 0.4)(F, D) * (F ** -0.5)),
            "b2": _w((lambda *s: torch.randn(*s, dtype=torch.bfloat16) * 0.4)(D)),
        }
    _B_in = _B_setup()

    return {
        "A_x": _A_in["x"],
        "A_wqkv": _A_in["wqkv"],
        "A_wo": _A_in["wo"],
        "B_x": _B_in["x"],
        "B_w1": _B_in["w1"],
        "B_b1": _B_in["b1"],
        "B_w2": _B_in["w2"],
        "B_b2": _B_in["b2"],
    }

def reference(A_x, A_wqkv, A_wo, B_x, B_w1, B_b1, B_w2, B_b2):
    def _A_ref(x, wqkv, wo):
        B, S, D = x.shape
        H = 32
        Dh = D // H
        qkv = (lambda x, *d: x.permute(*d))((x @ wqkv).reshape(B, S, 3, H, Dh), 2, 0, 3, 1, 4)
        q, k, v = qkv[0], qkv[1], qkv[2]
        scores = torch.einsum("bhqd,bhkd->bhqk", q, k) * (Dh ** -0.5)
        p = _softmax(scores, axis=-1)
        o = torch.einsum("bhqk,bhkd->bhqd", p, v)
        return (lambda x, *d: x.permute(*d))(o, 0, 2, 1, 3).reshape(B, S, D) @ wo

    def _B_ref(x, w1, b1, w2, b2):
        y = _layernorm(x, axis=-1)
        h = _gelu(torch.einsum("bsd,df->bsf", y, w1) + b1)
        return torch.einsum("bsf,fd->bsd", h, w2) + b2

    x = A_x
    x = x + _A_ref(_layernorm(x, axis=-1), A_wqkv, A_wo)
    x = x + _B_ref(_layernorm(x, axis=-1), B_w1, B_b1, B_w2, B_b2)
    x = x + _A_ref(_layernorm(x, axis=-1), A_wqkv, A_wo)
    x = x + _B_ref(_layernorm(x, axis=-1), B_w1, B_b1, B_w2, B_b2)
    return x
```

```asm
; @launch kernel=interleave_layers__mha_block__mixer_channel_mlp__prompt_kernel grid=(256,1,1) block=(512,1,1) lds=163840
; @launch kernel=c1_kernel grid=(256,1,1) block=(512,1,1) lds=163840
; @launch kernel=c2_kernel grid=(256,1,1) block=(512,1,1) lds=163840
.amdgcn_target "amdgcn-amd-amdhsa--gfx950"
.text
.globl interleave_layers__mha_block__mixer_channel_mlp__prompt_kernel
.p2align 8
.type interleave_layers__mha_block__mixer_channel_mlp__prompt_kernel,@function
interleave_layers__mha_block__mixer_channel_mlp__prompt_kernel:
 s_cmp_ge_u32 s2, 256
 s_cbranch_scc1 C0_end
 s_load_dwordx4 s[12:15], s[0:1], 0
 s_load_dwordx2 s[4:5], s[0:1], 80
 v_lshrrev_b32 v1, 6, v0
 s_nop 0
 v_readfirstlane_b32 s20, v1
 v_and_b32 v1, 63, v0
 s_mov_b32 s6, 0x10000000
 s_mov_b32 s7, 0x00020000
 s_lshr_b32 s23, s2, 3
 s_and_b32 s24, s2, 1
 s_lshl_b32 s24, s24, 2
 s_and_b32 s22, s23, 3
 s_add_u32 s22, s22, s24
 s_and_b32 s24, s2, 6
 s_lshl_b32 s24, s24, 2
 s_lshr_b32 s21, s23, 2
 s_add_u32 s21, s21, s24
 s_cmp_ge_u32 s20, 6
 s_cbranch_scc1 C0_al
 s_cmp_eq_u32 s20, 4
 s_cbranch_scc1 C0_bl0
 s_cmp_eq_u32 s20, 5
 s_cbranch_scc1 C0_bl1
 s_load_dwordx2 s[16:17], s[0:1], 16
 s_load_dwordx2 s[38:39], s[0:1], 32
 s_load_dwordx2 s[40:41], s[0:1], 48
 s_waitcnt lgkmcnt(0)
 s_mov_b32 s8, s14
 s_mov_b32 s9, s15
 s_mov_b32 s10, 0x258000
 s_mov_b32 s11, 0x00020000
 s_mov_b32 s44, s12
 s_mov_b32 s45, s13
 s_mov_b32 s46, 2621440
 s_mov_b32 s47, 0x00020000
 s_and_b32 s23, s21, 7
 s_lshl_b32 s23, s23, 2
 s_and_b32 s24, s22, 3
 s_add_u32 s23, s23, s24
 s_mul_i32 s43, s23, 3840
 s_lshr_b32 s24, s22, 2
 s_mul_i32 s25, s24, 1280
 s_mul_i32 s26, s24, 640
 s_add_u32 s26, s26, 1280
 v_and_b32 v8, 15, v1
 v_min_u32 v8, 14, v8
 v_mov_b32 v9, s25
 v_mov_b32 v10, s26
 v_cmp_gt_u32 vcc, 10, v8
 s_nop 1
 v_cndmask_b32 v9, v10, v9, vcc
 v_lshl_add_u32 v19, v8, 7, v9
 v_lshrrev_b32 v9, 4, v1
 s_mov_b32 s24, 122880
 v_mad_u32_u24 v9, v9, s24, v19
 s_mul_i32 s25, s20, 491520
 s_add_u32 s25, s25, s43
 s_cmp_lt_u32 s20, 2
 s_cbranch_scc0 C0_tw
 buffer_load_dword v17, v9, s[8:11], s25 offen
C0_tw:
 v_and_b32 v8, 15, v1
 v_mul_u32_u24 v212, 1280, v8
 v_lshrrev_b32 v9, 4, v1
 v_lshl_add_u32 v9, v9, 7, v212
 s_lshl_b32 s23, s21, 2
 s_and_b32 s24, s22, 3
 s_add_u32 s23, s23, s24
 s_mul_i32 s48, s23, 20480
 s_cmp_eq_u32 s20, 3
 s_cbranch_scc0 C0_tx
 buffer_load_dword v17, v9, s[44:47], s48 offen
C0_tx:
 s_cmp_lt_u32 s2, 136
 s_cbranch_scc0 C0_u2c
 s_cmp_lt_u32 s2, 96
 s_cselect_b32 s32, 0, 1
 s_cselect_b32 s30, 0, 96
 s_sub_u32 s28, s2, s30
 s_lshr_b32 s33, s28, 2
 s_and_b32 s34, s28, 3
 s_mul_i32 s35, s34, 160
 s_branch C0_ujc
C0_u2c:
 s_mov_b32 s32, 2
 s_sub_u32 s28, s2, 136
 s_mul_i32 s33, s28, 171
 s_lshr_b32 s33, s33, 11
 s_mul_i32 s30, s33, 12
 s_sub_u32 s34, s28, s30
 s_lshl_b32 s35, s34, 7
C0_ujc:
 s_cmp_eq_u32 s32, 0
 s_mov_b32 s36, 1280
 s_cselect_b32 s36, 3072, s36
 s_cmp_eq_u32 s32, 0
 s_cselect_b32 s16, s38, s16
 s_cselect_b32 s17, s39, s17
 s_mov_b32 s18, 819200
 s_cselect_b32 s18, 1966080, s18
 s_cmp_eq_u32 s32, 2
 s_cselect_b32 s16, s40, s16
 s_cselect_b32 s17, s41, s17
 s_cselect_b32 s18, 1966080, s18
 s_mov_b32 s19, 0x00020000
 v_min_u32 v18, 39, v1
 v_mul_lo_u32 v18, v18, s36
 s_mul_i32 s42, s20, 40
 s_add_u32 s42, s42, s35
 s_mul_i32 s42, s42, s36
 s_lshl_b32 s30, s33, 7
 s_add_u32 s42, s42, s30
 v_and_b32 v8, 15, v1
 v_lshrrev_b32 v9, 4, v1
 v_lshrrev_b32 v7, 1, v8
 v_xor_b32 v7, v7, v9
 v_lshlrev_b32 v7, 4, v7
 v_lshlrev_b32 v2, 7, v8
 v_add_u32 v2, v2, v7
 v_xor_b32 v3, 64, v2
 v_lshlrev_b32 v16, 4, v1
 v_mov_b32 v12, 0x3f803f80
 v_mov_b32 v13, 0x3f803f80
 v_mov_b32 v14, 0x3f803f80
 v_mov_b32 v15, 0x3f803f80
 v_and_b32 v7, 15, v1
 v_lshrrev_b32 v7, 2, v7
 v_bfe_u32 v6, v1, 4, 1
 v_lshl_add_u32 v7, v6, 2, v7
 v_lshrrev_b32 v6, 5, v1
 v_lshl_add_u32 v7, v6, 4, v7
 v_lshlrev_b32 v5, 9, v7
 v_add_u32 v5, 32768, v5
 v_and_b32 v4, 7, v7
 v_lshlrev_b32 v4, 5, v4
 v_and_b32 v6, 3, v1
 s_mul_i32 s31, s22, 15
 s_lshl_b32 s23, s20, 2
 s_add_u32 s31, s31, s23
 s_lshl_b32 s31, s31, 6
 s_add_u32 s31, s31, 0x6e0000
 s_mul_i32 s30, s21, 245760
 s_mul_i32 s23, s22, 10
 s_lshl_b32 s24, s20, 2
 s_add_u32 s23, s23, s24
 s_lshl_b32 s23, s23, 9
 s_add_u32 s30, s30, s23
 s_add_u32 s30, s30, 0x1172000
 s_add_u32 s29, s30, 122880
 s_mul_i32 s28, s21, 2688
 s_add_u32 s28, s28, 0x192e000
 s_cmp_lt_u32 s22, 4
 s_cselect_b32 s27, 0x3ea52b5c, 1.0
 s_mul_i32 s26, s22, 901120
 s_mul_i32 s23, s21, 15360
 s_add_u32 s26, s26, s23
 s_lshl_b32 s23, s20, 12
 s_add_u32 s26, s26, s23
 s_add_u32 s26, s26, 0x91000
 s_cmp_eq_u32 s20, 2
 s_cbranch_scc1 C0_q_mx
 s_cmp_eq_u32 s20, 3
 s_cbranch_scc1 C0_q_vv
 v_lshrrev_b32 v9, 4, v1
 v_and_b32 v203, 1, v9
 s_mov_b32 s23, 61440
 v_mul_lo_u32 v203, v203, s23
 v_lshrrev_b32 v9, 1, v9
 v_lshlrev_b32 v9, 8, v9
 v_add_u32 v203, v203, v9
 v_and_b32 v9, 15, v1
 v_lshlrev_b32 v9, 4, v9
 v_add_u32 v203, v203, v9
 s_lshl_b32 s23, s20, 4
 s_add_u32 s23, s23, 0
 v_add_u32 v8, s23, v6
 v_mul_u32_u24 v9, 6554, v8
 v_lshrrev_b32 v9, 16, v9
 v_mul_u32_u24 v10, 10, v9
 v_sub_u32 v10, v8, v10
 v_add_u32 v11, 2, v10
 v_lshrrev_b32 v11, 3, v11
 v_sub_u32 v11, v10, v11
 v_cmp_eq_u32 vcc, 5, v10
 v_mov_b32 v10, 9
 s_nop 0
 v_cndmask_b32 v11, v11, v10, vcc
 v_mul_u32_u24 v9, 80, v9
 v_lshl_add_u32 v9, v11, 3, v9
 v_xor_b32 v9, v4, v9
 v_add_u32 v204, v5, v9
 v_add_u32 v208, 65536, v204
 s_lshl_b32 s23, s20, 4
 s_add_u32 s23, s23, 4
 v_add_u32 v8, s23, v6
 v_mul_u32_u24 v9, 6554, v8
 v_lshrrev_b32 v9, 16, v9
 v_mul_u32_u24 v10, 10, v9
 v_sub_u32 v10, v8, v10
 v_add_u32 v11, 2, v10
 v_lshrrev_b32 v11, 3, v11
 v_sub_u32 v11, v10, v11
 v_cmp_eq_u32 vcc, 5, v10
 v_mov_b32 v10, 9
 s_nop 0
 v_cndmask_b32 v11, v11, v10, vcc
 v_mul_u32_u24 v9, 80, v9
 v_lshl_add_u32 v9, v11, 3, v9
 v_xor_b32 v9, v4, v9
 v_add_u32 v205, v5, v9
 v_add_u32 v209, 65536, v205
 s_lshl_b32 s23, s20, 4
 s_add_u32 s23, s23, 8
 v_add_u32 v8, s23, v6
 v_mul_u32_u24 v9, 6554, v8
 v_lshrrev_b32 v9, 16, v9
 v_mul_u32_u24 v10, 10, v9
 v_sub_u32 v10, v8, v10
 v_add_u32 v11, 2, v10
 v_lshrrev_b32 v11, 3, v11
 v_sub_u32 v11, v10, v11
 v_cmp_eq_u32 vcc, 5, v10
 v_mov_b32 v10, 9
 s_nop 0
 v_cndmask_b32 v11, v11, v10, vcc
 v_mul_u32_u24 v9, 80, v9
 v_lshl_add_u32 v9, v11, 3, v9
 v_xor_b32 v9, v4, v9
 v_add_u32 v206, v5, v9
 v_add_u32 v210, 65536, v206
 s_lshl_b32 s23, s20, 4
 s_add_u32 s23, s23, 12
 v_add_u32 v8, s23, v6
 v_mul_u32_u24 v9, 6554, v8
 v_lshrrev_b32 v9, 16, v9
 v_mul_u32_u24 v10, 10, v9
 v_sub_u32 v10, v8, v10
 v_add_u32 v11, 2, v10
 v_lshrrev_b32 v11, 3, v11
 v_sub_u32 v11, v10, v11
 v_cmp_eq_u32 vcc, 5, v10
 v_mov_b32 v10, 9
 s_nop 0
 v_cndmask_b32 v11, v11, v10, vcc
 v_mul_u32_u24 v9, 80, v9
 v_lshl_add_u32 v9, v11, 3, v9
 v_xor_b32 v9, v4, v9
 v_add_u32 v207, v5, v9
 v_add_u32 v211, 65536, v207
 s_waitcnt lgkmcnt(0)
 s_barrier
 ds_read_b64_tr_b16 v[84:85], v204 offset:0
 ds_read_b64_tr_b16 v[86:87], v204 offset:4096
 ds_read_b128 v[100:103], v2 offset:0
 ds_read_b64_tr_b16 v[88:89], v205 offset:0
 ds_read_b64_tr_b16 v[90:91], v205 offset:4096
 ds_read_b64_tr_b16 v[92:93], v206 offset:0
 ds_read_b64_tr_b16 v[94:95], v206 offset:4096
 ds_read_b64_tr_b16 v[96:97], v207 offset:0
 ds_read_b64_tr_b16 v[98:99], v207 offset:4096
 ds_read_b128 v[104:107], v2 offset:2048
 ds_read_b128 v[108:111], v2 offset:4096
 ds_read_b128 v[112:115], v2 offset:6144
 s_waitcnt lgkmcnt(0)
 s_cmp_lg_u32 s20, 0
 s_cbranch_scc1 C0_qk_nt0
 s_mov_b64 exec, 0xffff
 s_add_u32 s23, s43, 0xf0000
 buffer_load_dword v17, v19, s[8:11], s23 offen
 s_add_u32 s23, s48, 512
 buffer_load_dword v17, v212, s[44:47], s23 offen
 s_mov_b64 exec, -1
C0_qk_nt0:
 s_cmp_lg_u32 s21, 0
 s_cbranch_scc1 C0_qk_ns0
 buffer_store_dwordx4 v[84:87], v16, s[4:7], s26 offen offset:0 sc1
 buffer_store_dwordx4 v[88:91], v16, s[4:7], s26 offen offset:1024 sc1
 buffer_store_dwordx4 v[92:95], v16, s[4:7], s26 offen offset:2048 sc1
 buffer_store_dwordx4 v[96:99], v16, s[4:7], s26 offen offset:3072 sc1
C0_qk_ns0:
 v_mfma_f32_16x16x32_bf16 v[20:23], v[84:87], v[100:103], 0
 ds_read_b64_tr_b16 v[116:117], v204 offset:16384
 v_mfma_f32_16x16x32_bf16 v[24:27], v[88:91], v[100:103], 0
 ds_read_b64_tr_b16 v[118:119], v204 offset:20480
 v_mfma_f32_16x16x32_bf16 v[28:31], v[92:95], v[100:103], 0
 ds_read_b128 v[132:135], v3 offset:0
 v_mfma_f32_16x16x32_bf16 v[32:35], v[96:99], v[100:103], 0
 ds_read_b64_tr_b16 v[120:121], v205 offset:16384
 v_mfma_f32_16x16x32_bf16 v[180:183], v[84:87], v[12:15], 0
 ds_read_b64_tr_b16 v[122:123], v205 offset:20480
 v_mfma_f32_16x16x32_bf16 v[36:39], v[84:87], v[104:107], 0
 ds_read_b64_tr_b16 v[124:125], v206 offset:16384
 v_mfma_f32_16x16x32_bf16 v[40:43], v[88:91], v[104:107], 0
 ds_read_b64_tr_b16 v[126:127], v206 offset:20480
 v_mfma_f32_16x16x32_bf16 v[44:47], v[92:95], v[104:107], 0
 ds_read_b64_tr_b16 v[128:129], v207 offset:16384
 v_mfma_f32_16x16x32_bf16 v[48:51], v[96:99], v[104:107], 0
 ds_read_b64_tr_b16 v[130:131], v207 offset:20480
 v_mfma_f32_16x16x32_bf16 v[184:187], v[88:91], v[12:15], 0
 ds_read_b128 v[136:139], v3 offset:2048
 v_mfma_f32_16x16x32_bf16 v[52:55], v[84:87], v[108:111], 0
 ds_read_b128 v[140:143], v3 offset:4096
 v_mfma_f32_16x16x32_bf16 v[56:59], v[88:91], v[108:111], 0
 ds_read_b128 v[144:147], v3 offset:6144
 v_mfma_f32_16x16x32_bf16 v[60:63], v[92:95], v[108:111], 0
 v_mfma_f32_16x16x32_bf16 v[64:67], v[96:99], v[108:111], 0
 v_mfma_f32_16x16x32_bf16 v[188:191], v[92:95], v[12:15], 0
 v_mfma_f32_16x16x32_bf16 v[68:71], v[84:87], v[112:115], 0
 v_mfma_f32_16x16x32_bf16 v[72:75], v[88:91], v[112:115], 0
 v_mfma_f32_16x16x32_bf16 v[76:79], v[92:95], v[112:115], 0
 v_mfma_f32_16x16x32_bf16 v[80:83], v[96:99], v[112:115], 0
 v_mfma_f32_16x16x32_bf16 v[192:195], v[96:99], v[12:15], 0
 s_waitcnt lgkmcnt(0)
 s_cmp_lg_u32 s20, 1
 s_cbranch_scc1 C0_qk_nt1
 s_mov_b64 exec, 0xffff
 s_add_u32 s23, s43, 0x10e000
 buffer_load_dword v17, v19, s[8:11], s23 offen
 s_add_u32 s23, s48, 640
 buffer_load_dword v17, v212, s[44:47], s23 offen
 s_mov_b64 exec, -1
C0_qk_nt1:
 s_cmp_lg_u32 s21, 1
 s_cbranch_scc1 C0_qk_ns1
 buffer_store_dwordx4 v[116:119], v16, s[4:7], s26 offen offset:0 sc1
 buffer_store_dwordx4 v[120:123], v16, s[4:7], s26 offen offset:1024 sc1
 buffer_store_dwordx4 v[124:127], v16, s[4:7], s26 offen offset:2048 sc1
 buffer_store_dwordx4 v[128:131], v16, s[4:7], s26 offen offset:3072 sc1
C0_qk_ns1:
 v_mfma_f32_16x16x32_bf16 v[20:23], v[116:119], v[132:135], v[20:23]
 s_barrier
 ds_read_b64_tr_b16 v[84:85], v204 offset:32768
 v_mfma_f32_16x16x32_bf16 v[24:27], v[120:123], v[132:135], v[24:27]
 ds_read_b64_tr_b16 v[86:87], v204 offset:36864
 v_mfma_f32_16x16x32_bf16 v[28:31], v[124:127], v[132:135], v[28:31]
 ds_read_b128 v[100:103], v2 offset:8192
 v_mfma_f32_16x16x32_bf16 v[32:35], v[128:131], v[132:135], v[32:35]
 ds_read_b64_tr_b16 v[88:89], v205 offset:32768
 v_mfma_f32_16x16x32_bf16 v[180:183], v[116:119], v[12:15], v[180:183]
 ds_read_b64_tr_b16 v[90:91], v205 offset:36864
 v_mfma_f32_16x16x32_bf16 v[36:39], v[116:119], v[136:139], v[36:39]
 ds_read_b64_tr_b16 v[92:93], v206 offset:32768
 v_mfma_f32_16x16x32_bf16 v[40:43], v[120:123], v[136:139], v[40:43]
 ds_read_b64_tr_b16 v[94:95], v206 offset:36864
 v_mfma_f32_16x16x32_bf16 v[44:47], v[124:127], v[136:139], v[44:47]
 ds_read_b64_tr_b16 v[96:97], v207 offset:32768
 v_mfma_f32_16x16x32_bf16 v[48:51], v[128:131], v[136:139], v[48:51]
 ds_read_b64_tr_b16 v[98:99], v207 offset:36864
 v_mfma_f32_16x16x32_bf16 v[184:187], v[120:123], v[12:15], v[184:187]
 ds_read_b128 v[104:107], v2 offset:10240
 v_mfma_f32_16x16x32_bf16 v[52:55], v[116:119], v[140:143], v[52:55]
 ds_read_b128 v[108:111], v2 offset:12288
 v_mfma_f32_16x16x32_bf16 v[56:59], v[120:123], v[140:143], v[56:59]
 ds_read_b128 v[112:115], v2 offset:14336
 v_mfma_f32_16x16x32_bf16 v[60:63], v[124:127], v[140:143], v[60:63]
 v_mfma_f32_16x16x32_bf16 v[64:67], v[128:131], v[140:143], v[64:67]
 v_mfma_f32_16x16x32_bf16 v[188:191], v[124:127], v[12:15], v[188:191]
 v_mfma_f32_16x16x32_bf16 v[68:71], v[116:119], v[144:147], v[68:71]
 v_mfma_f32_16x16x32_bf16 v[72:75], v[120:123], v[144:147], v[72:75]
 v_mfma_f32_16x16x32_bf16 v[76:79], v[124:127], v[144:147], v[76:79]
 v_mfma_f32_16x16x32_bf16 v[80:83], v[128:131], v[144:147], v[80:83]
 v_mfma_f32_16x16x32_bf16 v[192:195], v[128:131], v[12:15], v[192:195]
 s_waitcnt lgkmcnt(0)
 buffer_load_dword v17, v18, s[16:19], s42 offen
 s_cmp_lg_u32 s21, 2
 s_cbranch_scc1 C0_qk_ns2
 buffer_store_dwordx4 v[84:87], v16, s[4:7], s26 offen offset:0 sc1
 buffer_store_dwordx4 v[88:91], v16, s[4:7], s26 offen offset:1024 sc1
 buffer_store_dwordx4 v[92:95], v16, s[4:7], s26 offen offset:2048 sc1
 buffer_store_dwordx4 v[96:99], v16, s[4:7], s26 offen offset:3072 sc1
C0_qk_ns2:
 v_mfma_f32_16x16x32_bf16 v[20:23], v[84:87], v[100:103], v[20:23]
 ds_read_b64_tr_b16 v[116:117], v204 offset:49152
 v_mfma_f32_16x16x32_bf16 v[24:27], v[88:91], v[100:103], v[24:27]
 ds_read_b64_tr_b16 v[118:119], v204 offset:53248
 v_mfma_f32_16x16x32_bf16 v[28:31], v[92:95], v[100:103], v[28:31]
 ds_read_b128 v[132:135], v3 offset:8192
 v_mfma_f32_16x16x32_bf16 v[32:35], v[96:99], v[100:103], v[32:35]
 ds_read_b64_tr_b16 v[120:121], v205 offset:49152
 v_mfma_f32_16x16x32_bf16 v[180:183], v[84:87], v[12:15], v[180:183]
 ds_read_b64_tr_b16 v[122:123], v205 offset:53248
 v_mfma_f32_16x16x32_bf16 v[36:39], v[84:87], v[104:107], v[36:39]
 ds_read_b64_tr_b16 v[124:125], v206 offset:49152
 v_mfma_f32_16x16x32_bf16 v[40:43], v[88:91], v[104:107], v[40:43]
 ds_read_b64_tr_b16 v[126:127], v206 offset:53248
 v_mfma_f32_16x16x32_bf16 v[44:47], v[92:95], v[104:107], v[44:47]
 ds_read_b64_tr_b16 v[128:129], v207 offset:49152
 v_mfma_f32_16x16x32_bf16 v[48:51], v[96:99], v[104:107], v[48:51]
 ds_read_b64_tr_b16 v[130:131], v207 offset:53248
 v_mfma_f32_16x16x32_bf16 v[184:187], v[88:91], v[12:15], v[184:187]
 ds_read_b128 v[136:139], v3 offset:10240
 v_mfma_f32_16x16x32_bf16 v[52:55], v[84:87], v[108:111], v[52:55]
 ds_read_b128 v[140:143], v3 offset:12288
 v_mfma_f32_16x16x32_bf16 v[56:59], v[88:91], v[108:111], v[56:59]
 ds_read_b128 v[144:147], v3 offset:14336
 v_mfma_f32_16x16x32_bf16 v[60:63], v[92:95], v[108:111], v[60:63]
 v_mfma_f32_16x16x32_bf16 v[64:67], v[96:99], v[108:111], v[64:67]
 v_mfma_f32_16x16x32_bf16 v[188:191], v[92:95], v[12:15], v[188:191]
 v_mfma_f32_16x16x32_bf16 v[68:71], v[84:87], v[112:115], v[68:71]
 v_mfma_f32_16x16x32_bf16 v[72:75], v[88:91], v[112:115], v[72:75]
 v_mfma_f32_16x16x32_bf16 v[76:79], v[92:95], v[112:115], v[76:79]
 v_mfma_f32_16x16x32_bf16 v[80:83], v[96:99], v[112:115], v[80:83]
 v_mfma_f32_16x16x32_bf16 v[192:195], v[96:99], v[12:15], v[192:195]
 s_waitcnt lgkmcnt(0)
 s_cmp_lg_u32 s21, 3
 s_cbranch_scc1 C0_qk_ns3
 buffer_store_dwordx4 v[116:119], v16, s[4:7], s26 offen offset:0 sc1
 buffer_store_dwordx4 v[120:123], v16, s[4:7], s26 offen offset:1024 sc1
 buffer_store_dwordx4 v[124:127], v16, s[4:7], s26 offen offset:2048 sc1
 buffer_store_dwordx4 v[128:131], v16, s[4:7], s26 offen offset:3072 sc1
C0_qk_ns3:
 v_mfma_f32_16x16x32_bf16 v[20:23], v[116:119], v[132:135], v[20:23]
 s_barrier
 ds_read_b64_tr_b16 v[84:85], v208 offset:0
 v_mfma_f32_16x16x32_bf16 v[24:27], v[120:123], v[132:135], v[24:27]
 ds_read_b64_tr_b16 v[86:87], v208 offset:4096
 v_mfma_f32_16x16x32_bf16 v[28:31], v[124:127], v[132:135], v[28:31]
 ds_read_b128 v[100:103], v2 offset:16384
 v_mfma_f32_16x16x32_bf16 v[32:35], v[128:131], v[132:135], v[32:35]
 ds_read_b64_tr_b16 v[88:89], v209 offset:0
 v_mfma_f32_16x16x32_bf16 v[180:183], v[116:119], v[12:15], v[180:183]
 ds_read_b64_tr_b16 v[90:91], v209 offset:4096
 v_mfma_f32_16x16x32_bf16 v[36:39], v[116:119], v[136:139], v[36:39]
 ds_read_b64_tr_b16 v[92:93], v210 offset:0
 v_mfma_f32_16x16x32_bf16 v[40:43], v[120:123], v[136:139], v[40:43]
 ds_read_b64_tr_b16 v[94:95], v210 offset:4096
 v_mfma_f32_16x16x32_bf16 v[44:47], v[124:127], v[136:139], v[44:47]
 ds_read_b64_tr_b16 v[96:97], v211 offset:0
 v_mfma_f32_16x16x32_bf16 v[48:51], v[128:131], v[136:139], v[48:51]
 ds_read_b64_tr_b16 v[98:99], v211 offset:4096
 v_mfma_f32_16x16x32_bf16 v[184:187], v[120:123], v[12:15], v[184:187]
 ds_read_b128 v[104:107], v2 offset:18432
 v_mfma_f32_16x16x32_bf16 v[52:55], v[116:119], v[140:143], v[52:55]
 ds_read_b128 v[108:111], v2 offset:20480
 v_mfma_f32_16x16x32_bf16 v[56:59], v[120:123], v[140:143], v[56:59]
 ds_read_b128 v[112:115], v2 offset:22528
 v_mfma_f32_16x16x32_bf16 v[60:63], v[124:127], v[140:143], v[60:63]
 v_mfma_f32_16x16x32_bf16 v[64:67], v[128:131], v[140:143], v[64:67]
 v_mfma_f32_16x16x32_bf16 v[188:191], v[124:127], v[12:15], v[188:191]
 v_mfma_f32_16x16x32_bf16 v[68:71], v[116:119], v[144:147], v[68:71]
 v_mfma_f32_16x16x32_bf16 v[72:75], v[120:123], v[144:147], v[72:75]
 v_mfma_f32_16x16x32_bf16 v[76:79], v[124:127], v[144:147], v[76:79]
 v_mfma_f32_16x16x32_bf16 v[80:83], v[128:131], v[144:147], v[80:83]
 v_mfma_f32_16x16x32_bf16 v[192:195], v[128:131], v[12:15], v[192:195]
 s_waitcnt lgkmcnt(0)
 s_cmp_lg_u32 s20, 0
 s_cbranch_scc1 C0_qk_nt4
 s_mov_b64 exec, 0xffff
 s_add_u32 s23, s43, 0x168000
 buffer_load_dword v17, v19, s[8:11], s23 offen
 s_add_u32 s23, s48, 1024
 buffer_load_dword v17, v212, s[44:47], s23 offen
 s_mov_b64 exec, -1
C0_qk_nt4:
 s_cmp_lg_u32 s21, 4
 s_cbranch_scc1 C0_qk_ns4
 buffer_store_dwordx4 v[84:87], v16, s[4:7], s26 offen offset:0 sc1
 buffer_store_dwordx4 v[88:91], v16, s[4:7], s26 offen offset:1024 sc1
 buffer_store_dwordx4 v[92:95], v16, s[4:7], s26 offen offset:2048 sc1
 buffer_store_dwordx4 v[96:99], v16, s[4:7], s26 offen offset:3072 sc1
C0_qk_ns4:
 v_mfma_f32_16x16x32_bf16 v[20:23], v[84:87], v[100:103], v[20:23]
 ds_read_b64_tr_b16 v[116:117], v208 offset:16384
 v_mfma_f32_16x16x32_bf16 v[24:27], v[88:91], v[100:103], v[24:27]
 ds_read_b64_tr_b16 v[118:119], v208 offset:20480
 v_mfma_f32_16x16x32_bf16 v[28:31], v[92:95], v[100:103], v[28:31]
 ds_read_b128 v[132:135], v3 offset:16384
 v_mfma_f32_16x16x32_bf16 v[32:35], v[96:99], v[100:103], v[32:35]
 ds_read_b64_tr_b16 v[120:121], v209 offset:16384
 v_mfma_f32_16x16x32_bf16 v[180:183], v[84:87], v[12:15], v[180:183]
 ds_read_b64_tr_b16 v[122:123], v209 offset:20480
 v_mfma_f32_16x16x32_bf16 v[36:39], v[84:87], v[104:107], v[36:39]
 ds_read_b64_tr_b16 v[124:125], v210 offset:16384
 v_mfma_f32_16x16x32_bf16 v[40:43], v[88:91], v[104:107], v[40:43]
 ds_read_b64_tr_b16 v[126:127], v210 offset:20480
 v_mfma_f32_16x16x32_bf16 v[44:47], v[92:95], v[104:107], v[44:47]
 ds_read_b64_tr_b16 v[128:129], v211 offset:16384
 v_mfma_f32_16x16x32_bf16 v[48:51], v[96:99], v[104:107], v[48:51]
 ds_read_b64_tr_b16 v[130:131], v211 offset:20480
 v_mfma_f32_16x16x32_bf16 v[184:187], v[88:91], v[12:15], v[184:187]
 ds_read_b128 v[136:139], v3 offset:18432
 v_mfma_f32_16x16x32_bf16 v[52:55], v[84:87], v[108:111], v[52:55]
 ds_read_b128 v[140:143], v3 offset:20480
 v_mfma_f32_16x16x32_bf16 v[56:59], v[88:91], v[108:111], v[56:59]
 ds_read_b128 v[144:147], v3 offset:22528
 v_mfma_f32_16x16x32_bf16 v[60:63], v[92:95], v[108:111], v[60:63]
 v_mfma_f32_16x16x32_bf16 v[64:67], v[96:99], v[108:111], v[64:67]
 v_mfma_f32_16x16x32_bf16 v[188:191], v[92:95], v[12:15], v[188:191]
 v_mfma_f32_16x16x32_bf16 v[68:71], v[84:87], v[112:115], v[68:71]
 v_mfma_f32_16x16x32_bf16 v[72:75], v[88:91], v[112:115], v[72:75]
 v_mfma_f32_16x16x32_bf16 v[76:79], v[92:95], v[112:115], v[76:79]
 v_mfma_f32_16x16x32_bf16 v[80:83], v[96:99], v[112:115], v[80:83]
 v_mfma_f32_16x16x32_bf16 v[192:195], v[96:99], v[12:15], v[192:195]
 s_waitcnt lgkmcnt(0)
 s_cmp_lg_u32 s20, 1
 s_cbranch_scc1 C0_qk_nt5
 s_mov_b64 exec, 0xffff
 s_add_u32 s23, s43, 0x186000
 buffer_load_dword v17, v19, s[8:11], s23 offen
 s_add_u32 s23, s48, 1152
 buffer_load_dword v17, v212, s[44:47], s23 offen
 s_mov_b64 exec, -1
C0_qk_nt5:
 s_cmp_lg_u32 s21, 5
 s_cbranch_scc1 C0_qk_ns5
 buffer_store_dwordx4 v[116:119], v16, s[4:7], s26 offen offset:0 sc1
 buffer_store_dwordx4 v[120:123], v16, s[4:7], s26 offen offset:1024 sc1
 buffer_store_dwordx4 v[124:127], v16, s[4:7], s26 offen offset:2048 sc1
 buffer_store_dwordx4 v[128:131], v16, s[4:7], s26 offen offset:3072 sc1
C0_qk_ns5:
 v_mfma_f32_16x16x32_bf16 v[20:23], v[116:119], v[132:135], v[20:23]
 s_barrier
 ds_read_b64_tr_b16 v[84:85], v204 offset:0
 v_mfma_f32_16x16x32_bf16 v[24:27], v[120:123], v[132:135], v[24:27]
 ds_read_b64_tr_b16 v[86:87], v204 offset:4096
 v_mfma_f32_16x16x32_bf16 v[28:31], v[124:127], v[132:135], v[28:31]
 ds_read_b128 v[100:103], v2 offset:24576
 v_mfma_f32_16x16x32_bf16 v[32:35], v[128:131], v[132:135], v[32:35]
 ds_read_b64_tr_b16 v[88:89], v205 offset:0
 v_mfma_f32_16x16x32_bf16 v[180:183], v[116:119], v[12:15], v[180:183]
 ds_read_b64_tr_b16 v[90:91], v205 offset:4096
 v_mfma_f32_16x16x32_bf16 v[36:39], v[116:119], v[136:139], v[36:39]
 ds_read_b64_tr_b16 v[92:93], v206 offset:0
 v_mfma_f32_16x16x32_bf16 v[40:43], v[120:123], v[136:139], v[40:43]
 ds_read_b64_tr_b16 v[94:95], v206 offset:4096
 v_mfma_f32_16x16x32_bf16 v[44:47], v[124:127], v[136:139], v[44:47]
 ds_read_b64_tr_b16 v[96:97], v207 offset:0
 v_mfma_f32_16x16x32_bf16 v[48:51], v[128:131], v[136:139], v[48:51]
 ds_read_b64_tr_b16 v[98:99], v207 offset:4096
 v_mfma_f32_16x16x32_bf16 v[184:187], v[120:123], v[12:15], v[184:187]
 ds_read_b128 v[104:107], v2 offset:26624
 v_mfma_f32_16x16x32_bf16 v[52:55], v[116:119], v[140:143], v[52:55]
 ds_read_b128 v[108:111], v2 offset:28672
 v_mfma_f32_16x16x32_bf16 v[56:59], v[120:123], v[140:143], v[56:59]
 ds_read_b128 v[112:115], v2 offset:30720
 v_mfma_f32_16x16x32_bf16 v[60:63], v[124:127], v[140:143], v[60:63]
 v_mfma_f32_16x16x32_bf16 v[64:67], v[128:131], v[140:143], v[64:67]
 v_mfma_f32_16x16x32_bf16 v[188:191], v[124:127], v[12:15], v[188:191]
 v_mfma_f32_16x16x32_bf16 v[68:71], v[116:119], v[144:147], v[68:71]
 v_mfma_f32_16x16x32_bf16 v[72:75], v[120:123], v[144:147], v[72:75]
 v_mfma_f32_16x16x32_bf16 v[76:79], v[124:127], v[144:147], v[76:79]
 v_mfma_f32_16x16x32_bf16 v[80:83], v[128:131], v[144:147], v[80:83]
 v_mfma_f32_16x16x32_bf16 v[192:195], v[128:131], v[12:15], v[192:195]
 s_waitcnt lgkmcnt(0)
 s_cmp_lg_u32 s21, 6
 s_cbranch_scc1 C0_qk_ns6
 buffer_store_dwordx4 v[84:87], v16, s[4:7], s26 offen offset:0 sc1
 buffer_store_dwordx4 v[88:91], v16, s[4:7], s26 offen offset:1024 sc1
 buffer_store_dwordx4 v[92:95], v16, s[4:7], s26 offen offset:2048 sc1
 buffer_store_dwordx4 v[96:99], v16, s[4:7], s26 offen offset:3072 sc1
C0_qk_ns6:
 v_mfma_f32_16x16x32_bf16 v[20:23], v[84:87], v[100:103], v[20:23]
 ds_read_b64_tr_b16 v[116:117], v204 offset:16384
 v_mfma_f32_16x16x32_bf16 v[24:27], v[88:91], v[100:103], v[24:27]
 ds_read_b64_tr_b16 v[118:119], v204 offset:20480
 v_mfma_f32_16x16x32_bf16 v[28:31], v[92:95], v[100:103], v[28:31]
 ds_read_b128 v[132:135], v3 offset:24576
 v_mfma_f32_16x16x32_bf16 v[32:35], v[96:99], v[100:103], v[32:35]
 ds_read_b64_tr_b16 v[120:121], v205 offset:16384
 v_mfma_f32_16x16x32_bf16 v[180:183], v[84:87], v[12:15], v[180:183]
 ds_read_b64_tr_b16 v[122:123], v205 offset:20480
 v_mfma_f32_16x16x32_bf16 v[36:39], v[84:87], v[104:107], v[36:39]
 ds_read_b64_tr_b16 v[124:125], v206 offset:16384
 v_mfma_f32_16x16x32_bf16 v[40:43], v[88:91], v[104:107], v[40:43]
 ds_read_b64_tr_b16 v[126:127], v206 offset:20480
 v_mfma_f32_16x16x32_bf16 v[44:47], v[92:95], v[104:107], v[44:47]
 ds_read_b64_tr_b16 v[128:129], v207 offset:16384
 v_mfma_f32_16x16x32_bf16 v[48:51], v[96:99], v[104:107], v[48:51]
 ds_read_b64_tr_b16 v[130:131], v207 offset:20480
 v_mfma_f32_16x16x32_bf16 v[184:187], v[88:91], v[12:15], v[184:187]
 ds_read_b128 v[136:139], v3 offset:26624
 v_mfma_f32_16x16x32_bf16 v[52:55], v[84:87], v[108:111], v[52:55]
 ds_read_b128 v[140:143], v3 offset:28672
 v_mfma_f32_16x16x32_bf16 v[56:59], v[88:91], v[108:111], v[56:59]
 ds_read_b128 v[144:147], v3 offset:30720
 v_mfma_f32_16x16x32_bf16 v[60:63], v[92:95], v[108:111], v[60:63]
 v_mfma_f32_16x16x32_bf16 v[64:67], v[96:99], v[108:111], v[64:67]
 v_mfma_f32_16x16x32_bf16 v[188:191], v[92:95], v[12:15], v[188:191]
 v_mfma_f32_16x16x32_bf16 v[68:71], v[84:87], v[112:115], v[68:71]
 v_mfma_f32_16x16x32_bf16 v[72:75], v[88:91], v[112:115], v[72:75]
 v_mfma_f32_16x16x32_bf16 v[76:79], v[92:95], v[112:115], v[76:79]
 v_mfma_f32_16x16x32_bf16 v[80:83], v[96:99], v[112:115], v[80:83]
 v_mfma_f32_16x16x32_bf16 v[192:195], v[96:99], v[12:15], v[192:195]
 s_waitcnt lgkmcnt(0)
 s_cmp_lg_u32 s21, 7
 s_cbranch_scc1 C0_qk_ns7
 buffer_store_dwordx4 v[116:119], v16, s[4:7], s26 offen offset:0 sc1
 buffer_store_dwordx4 v[120:123], v16, s[4:7], s26 offen offset:1024 sc1
 buffer_store_dwordx4 v[124:127], v16, s[4:7], s26 offen offset:2048 sc1
 buffer_store_dwordx4 v[128:131], v16, s[4:7], s26 offen offset:3072 sc1
C0_qk_ns7:
 v_mfma_f32_16x16x32_bf16 v[20:23], v[116:119], v[132:135], v[20:23]
 s_barrier
 ds_read_b64_tr_b16 v[84:85], v204 offset:32768
 v_mfma_f32_16x16x32_bf16 v[24:27], v[120:123], v[132:135], v[24:27]
 ds_read_b64_tr_b16 v[86:87], v204 offset:36864
 v_mfma_f32_16x16x32_bf16 v[28:31], v[124:127], v[132:135], v[28:31]
 ds_read_b128 v[100:103], v2 offset:0
 v_mfma_f32_16x16x32_bf16 v[32:35], v[128:131], v[132:135], v[32:35]
 ds_read_b64_tr_b16 v[88:89], v205 offset:32768
 v_mfma_f32_16x16x32_bf16 v[180:183], v[116:119], v[12:15], v[180:183]
 ds_read_b64_tr_b16 v[90:91], v205 offset:36864
 v_mfma_f32_16x16x32_bf16 v[36:39], v[116:119], v[136:139], v[36:39]
 ds_read_b64_tr_b16 v[92:93], v206 offset:32768
 v_mfma_f32_16x16x32_bf16 v[40:43], v[120:123], v[136:139], v[40:43]
 ds_read_b64_tr_b16 v[94:95], v206 offset:36864
 v_mfma_f32_16x16x32_bf16 v[44:47], v[124:127], v[136:139], v[44:47]
 ds_read_b64_tr_b16 v[96:97], v207 offset:32768
 v_mfma_f32_16x16x32_bf16 v[48:51], v[128:131], v[136:139], v[48:51]
 ds_read_b64_tr_b16 v[98:99], v207 offset:36864
 v_mfma_f32_16x16x32_bf16 v[184:187], v[120:123], v[12:15], v[184:187]
 ds_read_b128 v[104:107], v2 offset:2048
 v_mfma_f32_16x16x32_bf16 v[52:55], v[116:119], v[140:143], v[52:55]
 ds_read_b128 v[108:111], v2 offset:4096
 v_mfma_f32_16x16x32_bf16 v[56:59], v[120:123], v[140:143], v[56:59]
 ds_read_b128 v[112:115], v2 offset:6144
 v_mfma_f32_16x16x32_bf16 v[60:63], v[124:127], v[140:143], v[60:63]
 v_mfma_f32_16x16x32_bf16 v[64:67], v[128:131], v[140:143], v[64:67]
 v_mfma_f32_16x16x32_bf16 v[188:191], v[124:127], v[12:15], v[188:191]
 v_mfma_f32_16x16x32_bf16 v[68:71], v[116:119], v[144:147], v[68:71]
 v_mfma_f32_16x16x32_bf16 v[72:75], v[120:123], v[144:147], v[72:75]
 v_mfma_f32_16x16x32_bf16 v[76:79], v[124:127], v[144:147], v[76:79]
 v_mfma_f32_16x16x32_bf16 v[80:83], v[128:131], v[144:147], v[80:83]
 v_mfma_f32_16x16x32_bf16 v[192:195], v[128:131], v[12:15], v[192:195]
 s_waitcnt lgkmcnt(0)
 s_cmp_lg_u32 s20, 0
 s_cbranch_scc1 C0_qk_nt8
 s_mov_b64 exec, 0xffff
 s_add_u32 s23, s43, 0x1e0000
 buffer_load_dword v17, v19, s[8:11], s23 offen
 s_mov_b64 exec, -1
C0_qk_nt8:
 s_cmp_lg_u32 s21, 8
 s_cbranch_scc1 C0_qk_ns8
 buffer_store_dwordx4 v[84:87], v16, s[4:7], s26 offen offset:0 sc1
 buffer_store_dwordx4 v[88:91], v16, s[4:7], s26 offen offset:1024 sc1
 buffer_store_dwordx4 v[92:95], v16, s[4:7], s26 offen offset:2048 sc1
 buffer_store_dwordx4 v[96:99], v16, s[4:7], s26 offen offset:3072 sc1
C0_qk_ns8:
 v_mfma_f32_16x16x32_bf16 v[20:23], v[84:87], v[100:103], v[20:23]
 ds_read_b64_tr_b16 v[116:117], v204 offset:49152
 v_mfma_f32_16x16x32_bf16 v[24:27], v[88:91], v[100:103], v[24:27]
 ds_read_b64_tr_b16 v[118:119], v204 offset:53248
 v_mfma_f32_16x16x32_bf16 v[28:31], v[92:95], v[100:103], v[28:31]
 ds_read_b128 v[132:135], v3 offset:0
 v_mfma_f32_16x16x32_bf16 v[32:35], v[96:99], v[100:103], v[32:35]
 ds_read_b64_tr_b16 v[120:121], v205 offset:49152
 v_mfma_f32_16x16x32_bf16 v[180:183], v[84:87], v[12:15], v[180:183]
 ds_read_b64_tr_b16 v[122:123], v205 offset:53248
 v_mfma_f32_16x16x32_bf16 v[36:39], v[84:87], v[104:107], v[36:39]
 ds_read_b64_tr_b16 v[124:125], v206 offset:49152
 v_mfma_f32_16x16x32_bf16 v[40:43], v[88:91], v[104:107], v[40:43]
 ds_read_b64_tr_b16 v[126:127], v206 offset:53248
 v_mfma_f32_16x16x32_bf16 v[44:47], v[92:95], v[104:107], v[44:47]
 ds_read_b64_tr_b16 v[128:129], v207 offset:49152
 v_mfma_f32_16x16x32_bf16 v[48:51], v[96:99], v[104:107], v[48:51]
 ds_read_b64_tr_b16 v[130:131], v207 offset:53248
 v_mfma_f32_16x16x32_bf16 v[184:187], v[88:91], v[12:15], v[184:187]
 ds_read_b128 v[136:139], v3 offset:2048
 v_mfma_f32_16x16x32_bf16 v[52:55], v[84:87], v[108:111], v[52:55]
 ds_read_b128 v[140:143], v3 offset:4096
 v_mfma_f32_16x16x32_bf16 v[56:59], v[88:91], v[108:111], v[56:59]
 ds_read_b128 v[144:147], v3 offset:6144
 v_mfma_f32_16x16x32_bf16 v[60:63], v[92:95], v[108:111], v[60:63]
 v_mfma_f32_16x16x32_bf16 v[64:67], v[96:99], v[108:111], v[64:67]
 v_mfma_f32_16x16x32_bf16 v[188:191], v[92:95], v[12:15], v[188:191]
 v_mfma_f32_16x16x32_bf16 v[68:71], v[84:87], v[112:115], v[68:71]
 v_mfma_f32_16x16x32_bf16 v[72:75], v[88:91], v[112:115], v[72:75]
 v_mfma_f32_16x16x32_bf16 v[76:79], v[92:95], v[112:115], v[76:79]
 v_mfma_f32_16x16x32_bf16 v[80:83], v[96:99], v[112:115], v[80:83]
 v_mfma_f32_16x16x32_bf16 v[192:195], v[96:99], v[12:15], v[192:195]
 s_waitcnt lgkmcnt(0)
 s_cmp_lg_u32 s20, 1
 s_cbranch_scc1 C0_qk_nt9
 s_mov_b64 exec, 0xffff
 s_add_u32 s23, s43, 0x1fe000
 buffer_load_dword v17, v19, s[8:11], s23 offen
 s_mov_b64 exec, -1
C0_qk_nt9:
 s_cmp_lg_u32 s21, 9
 s_cbranch_scc1 C0_qk_ns9
 buffer_store_dwordx4 v[116:119], v16, s[4:7], s26 offen offset:0 sc1
 buffer_store_dwordx4 v[120:123], v16, s[4:7], s26 offen offset:1024 sc1
 buffer_store_dwordx4 v[124:127], v16, s[4:7], s26 offen offset:2048 sc1
 buffer_store_dwordx4 v[128:131], v16, s[4:7], s26 offen offset:3072 sc1
C0_qk_ns9:
 v_mfma_f32_16x16x32_bf16 v[20:23], v[116:119], v[132:135], v[20:23]
 s_barrier
 ds_read_b64_tr_b16 v[84:85], v208 offset:0
 v_mfma_f32_16x16x32_bf16 v[24:27], v[120:123], v[132:135], v[24:27]
 ds_read_b64_tr_b16 v[86:87], v208 offset:4096
 v_mfma_f32_16x16x32_bf16 v[28:31], v[124:127], v[132:135], v[28:31]
 ds_read_b128 v[100:103], v2 offset:8192
 v_mfma_f32_16x16x32_bf16 v[32:35], v[128:131], v[132:135], v[32:35]
 ds_read_b64_tr_b16 v[88:89], v209 offset:0
 v_mfma_f32_16x16x32_bf16 v[180:183], v[116:119], v[12:15], v[180:183]
 ds_read_b64_tr_b16 v[90:91], v209 offset:4096
 v_mfma_f32_16x16x32_bf16 v[36:39], v[116:119], v[136:139], v[36:39]
 ds_read_b64_tr_b16 v[92:93], v210 offset:0
 v_mfma_f32_16x16x32_bf16 v[40:43], v[120:123], v[136:139], v[40:43]
 ds_read_b64_tr_b16 v[94:95], v210 offset:4096
 v_mfma_f32_16x16x32_bf16 v[44:47], v[124:127], v[136:139], v[44:47]
 ds_read_b64_tr_b16 v[96:97], v211 offset:0
 v_mfma_f32_16x16x32_bf16 v[48:51], v[128:131], v[136:139], v[48:51]
 ds_read_b64_tr_b16 v[98:99], v211 offset:4096
 v_mfma_f32_16x16x32_bf16 v[184:187], v[120:123], v[12:15], v[184:187]
 ds_read_b128 v[104:107], v2 offset:10240
 v_mfma_f32_16x16x32_bf16 v[52:55], v[116:119], v[140:143], v[52:55]
 ds_read_b128 v[108:111], v2 offset:12288
 v_mfma_f32_16x16x32_bf16 v[56:59], v[120:123], v[140:143], v[56:59]
 ds_read_b128 v[112:115], v2 offset:14336
 v_mfma_f32_16x16x32_bf16 v[60:63], v[124:127], v[140:143], v[60:63]
 v_mfma_f32_16x16x32_bf16 v[64:67], v[128:131], v[140:143], v[64:67]
 v_mfma_f32_16x16x32_bf16 v[188:191], v[124:127], v[12:15], v[188:191]
 v_mfma_f32_16x16x32_bf16 v[68:71], v[116:119], v[144:147], v[68:71]
 v_mfma_f32_16x16x32_bf16 v[72:75], v[120:123], v[144:147], v[72:75]
 v_mfma_f32_16x16x32_bf16 v[76:79], v[124:127], v[144:147], v[76:79]
 v_mfma_f32_16x16x32_bf16 v[80:83], v[128:131], v[144:147], v[80:83]
 v_mfma_f32_16x16x32_bf16 v[192:195], v[128:131], v[12:15], v[192:195]
 s_waitcnt lgkmcnt(0)
 s_cmp_lg_u32 s21, 10
 s_cbranch_scc1 C0_qk_ns10
 buffer_store_dwordx4 v[84:87], v16, s[4:7], s26 offen offset:0 sc1
 buffer_store_dwordx4 v[88:91], v16, s[4:7], s26 offen offset:1024 sc1
 buffer_store_dwordx4 v[92:95], v16, s[4:7], s26 offen offset:2048 sc1
 buffer_store_dwordx4 v[96:99], v16, s[4:7], s26 offen offset:3072 sc1
C0_qk_ns10:
 v_mfma_f32_16x16x32_bf16 v[20:23], v[84:87], v[100:103], v[20:23]
 ds_read_b64_tr_b16 v[116:117], v208 offset:16384
 v_mfma_f32_16x16x32_bf16 v[24:27], v[88:91], v[100:103], v[24:27]
 ds_read_b64_tr_b16 v[118:119], v208 offset:20480
 v_mfma_f32_16x16x32_bf16 v[28:31], v[92:95], v[100:103], v[28:31]
 ds_read_b128 v[132:135], v3 offset:8192
 v_mfma_f32_16x16x32_bf16 v[32:35], v[96:99], v[100:103], v[32:35]
 ds_read_b64_tr_b16 v[120:121], v209 offset:16384
 v_mfma_f32_16x16x32_bf16 v[180:183], v[84:87], v[12:15], v[180:183]
 ds_read_b64_tr_b16 v[122:123], v209 offset:20480
 v_mfma_f32_16x16x32_bf16 v[36:39], v[84:87], v[104:107], v[36:39]
 ds_read_b64_tr_b16 v[124:125], v210 offset:16384
 v_mfma_f32_16x16x32_bf16 v[40:43], v[88:91], v[104:107], v[40:43]
 ds_read_b64_tr_b16 v[126:127], v210 offset:20480
 v_mfma_f32_16x16x32_bf16 v[44:47], v[92:95], v[104:107], v[44:47]
 ds_read_b64_tr_b16 v[128:129], v211 offset:16384
 v_mfma_f32_16x16x32_bf16 v[48:51], v[96:99], v[104:107], v[48:51]
 ds_read_b64_tr_b16 v[130:131], v211 offset:20480
 v_mfma_f32_16x16x32_bf16 v[184:187], v[88:91], v[12:15], v[184:187]
 ds_read_b128 v[136:139], v3 offset:10240
 v_mfma_f32_16x16x32_bf16 v[52:55], v[84:87], v[108:111], v[52:55]
 ds_read_b128 v[140:143], v3 offset:12288
 v_mfma_f32_16x16x32_bf16 v[56:59], v[88:91], v[108:111], v[56:59]
 ds_read_b128 v[144:147], v3 offset:14336
 v_mfma_f32_16x16x32_bf16 v[60:63], v[92:95], v[108:111], v[60:63]
 v_mfma_f32_16x16x32_bf16 v[64:67], v[96:99], v[108:111], v[64:67]
 v_mfma_f32_16x16x32_bf16 v[188:191], v[92:95], v[12:15], v[188:191]
 v_mfma_f32_16x16x32_bf16 v[68:71], v[84:87], v[112:115], v[68:71]
 v_mfma_f32_16x16x32_bf16 v[72:75], v[88:91], v[112:115], v[72:75]
 v_mfma_f32_16x16x32_bf16 v[76:79], v[92:95], v[112:115], v[76:79]
 v_mfma_f32_16x16x32_bf16 v[80:83], v[96:99], v[112:115], v[80:83]
 v_mfma_f32_16x16x32_bf16 v[192:195], v[96:99], v[12:15], v[192:195]
 s_waitcnt lgkmcnt(0)
 s_cmp_lg_u32 s21, 11
 s_cbranch_scc1 C0_qk_ns11
 buffer_store_dwordx4 v[116:119], v16, s[4:7], s26 offen offset:0 sc1
 buffer_store_dwordx4 v[120:123], v16, s[4:7], s26 offen offset:1024 sc1
 buffer_store_dwordx4 v[124:127], v16, s[4:7], s26 offen offset:2048 sc1
 buffer_store_dwordx4 v[128:131], v16, s[4:7], s26 offen offset:3072 sc1
C0_qk_ns11:
 v_mfma_f32_16x16x32_bf16 v[20:23], v[116:119], v[132:135], v[20:23]
 s_barrier
 ds_read_b64_tr_b16 v[84:85], v204 offset:0
 v_mfma_f32_16x16x32_bf16 v[24:27], v[120:123], v[132:135], v[24:27]
 ds_read_b64_tr_b16 v[86:87], v204 offset:4096
 v_mfma_f32_16x16x32_bf16 v[28:31], v[124:127], v[132:135], v[28:31]
 ds_read_b128 v[100:103], v2 offset:16384
 v_mfma_f32_16x16x32_bf16 v[32:35], v[128:131], v[132:135], v[32:35]
 ds_read_b64_tr_b16 v[88:89], v205 offset:0
 v_mfma_f32_16x16x32_bf16 v[180:183], v[116:119], v[12:15], v[180:183]
 ds_read_b64_tr_b16 v[90:91], v205 offset:4096
 v_mfma_f32_16x16x32_bf16 v[36:39], v[116:119], v[136:139], v[36:39]
 ds_read_b64_tr_b16 v[92:93], v206 offset:0
 v_mfma_f32_16x16x32_bf16 v[40:43], v[120:123], v[136:139], v[40:43]
 ds_read_b64_tr_b16 v[94:95], v206 offset:4096
 v_mfma_f32_16x16x32_bf16 v[44:47], v[124:127], v[136:139], v[44:47]
 ds_read_b64_tr_b16 v[96:97], v207 offset:0
 v_mfma_f32_16x16x32_bf16 v[48:51], v[128:131], v[136:139], v[48:51]
 ds_read_b64_tr_b16 v[98:99], v207 offset:4096
 v_mfma_f32_16x16x32_bf16 v[184:187], v[120:123], v[12:15], v[184:187]
 ds_read_b128 v[104:107], v2 offset:18432
 v_mfma_f32_16x16x32_bf16 v[52:55], v[116:119], v[140:143], v[52:55]
 ds_read_b128 v[108:111], v2 offset:20480
 v_mfma_f32_16x16x32_bf16 v[56:59], v[120:123], v[140:143], v[56:59]
 ds_read_b128 v[112:115], v2 offset:22528
 v_mfma_f32_16x16x32_bf16 v[60:63], v[124:127], v[140:143], v[60:63]
 v_mfma_f32_16x16x32_bf16 v[64:67], v[128:131], v[140:143], v[64:67]
 v_mfma_f32_16x16x32_bf16 v[188:191], v[124:127], v[12:15], v[188:191]
 v_mfma_f32_16x16x32_bf16 v[68:71], v[116:119], v[144:147], v[68:71]
 v_mfma_f32_16x16x32_bf16 v[72:75], v[120:123], v[144:147], v[72:75]
 v_mfma_f32_16x16x32_bf16 v[76:79], v[124:127], v[144:147], v[76:79]
 v_mfma_f32_16x16x32_bf16 v[80:83], v[128:131], v[144:147], v[80:83]
 v_mfma_f32_16x16x32_bf16 v[192:195], v[128:131], v[12:15], v[192:195]
 s_waitcnt lgkmcnt(0)
 s_cmp_lg_u32 s21, 12
 s_cbranch_scc1 C0_qk_ns12
 buffer_store_dwordx4 v[84:87], v16, s[4:7], s26 offen offset:0 sc1
 buffer_store_dwordx4 v[88:91], v16, s[4:7], s26 offen offset:1024 sc1
 buffer_store_dwordx4 v[92:95], v16, s[4:7], s26 offen offset:2048 sc1
 buffer_store_dwordx4 v[96:99], v16, s[4:7], s26 offen offset:3072 sc1
C0_qk_ns12:
 v_mfma_f32_16x16x32_bf16 v[20:23], v[84:87], v[100:103], v[20:23]
 ds_read_b64_tr_b16 v[116:117], v204 offset:16384
 v_mfma_f32_16x16x32_bf16 v[24:27], v[88:91], v[100:103], v[24:27]
 ds_read_b64_tr_b16 v[118:119], v204 offset:20480
 v_mfma_f32_16x16x32_bf16 v[28:31], v[92:95], v[100:103], v[28:31]
 ds_read_b128 v[132:135], v3 offset:16384
 v_mfma_f32_16x16x32_bf16 v[32:35], v[96:99], v[100:103], v[32:35]
 ds_read_b64_tr_b16 v[120:121], v205 offset:16384
 v_mfma_f32_16x16x32_bf16 v[180:183], v[84:87], v[12:15], v[180:183]
 ds_read_b64_tr_b16 v[122:123], v205 offset:20480
 v_mfma_f32_16x16x32_bf16 v[36:39], v[84:87], v[104:107], v[36:39]
 ds_read_b64_tr_b16 v[124:125], v206 offset:16384
 v_mfma_f32_16x16x32_bf16 v[40:43], v[88:91], v[104:107], v[40:43]
 ds_read_b64_tr_b16 v[126:127], v206 offset:20480
 v_mfma_f32_16x16x32_bf16 v[44:47], v[92:95], v[104:107], v[44:47]
 ds_read_b64_tr_b16 v[128:129], v207 offset:16384
 v_mfma_f32_16x16x32_bf16 v[48:51], v[96:99], v[104:107], v[48:51]
 ds_read_b64_tr_b16 v[130:131], v207 offset:20480
 v_mfma_f32_16x16x32_bf16 v[184:187], v[88:91], v[12:15], v[184:187]
 ds_read_b128 v[136:139], v3 offset:18432
 v_mfma_f32_16x16x32_bf16 v[52:55], v[84:87], v[108:111], v[52:55]
 ds_read_b128 v[140:143], v3 offset:20480
 v_mfma_f32_16x16x32_bf16 v[56:59], v[88:91], v[108:111], v[56:59]
 ds_read_b128 v[144:147], v3 offset:22528
 v_mfma_f32_16x16x32_bf16 v[60:63], v[92:95], v[108:111], v[60:63]
 v_mfma_f32_16x16x32_bf16 v[64:67], v[96:99], v[108:111], v[64:67]
 v_mfma_f32_16x16x32_bf16 v[188:191], v[92:95], v[12:15], v[188:191]
 v_mfma_f32_16x16x32_bf16 v[68:71], v[84:87], v[112:115], v[68:71]
 v_mfma_f32_16x16x32_bf16 v[72:75], v[88:91], v[112:115], v[72:75]
 v_mfma_f32_16x16x32_bf16 v[76:79], v[92:95], v[112:115], v[76:79]
 v_mfma_f32_16x16x32_bf16 v[80:83], v[96:99], v[112:115], v[80:83]
 v_mfma_f32_16x16x32_bf16 v[192:195], v[96:99], v[12:15], v[192:195]
 s_waitcnt lgkmcnt(0)
 s_cmp_lg_u32 s21, 13
 s_cbranch_scc1 C0_qk_ns13
 buffer_store_dwordx4 v[116:119], v16, s[4:7], s26 offen offset:0 sc1
 buffer_store_dwordx4 v[120:123], v16, s[4:7], s26 offen offset:1024 sc1
 buffer_store_dwordx4 v[124:127], v16, s[4:7], s26 offen offset:2048 sc1
 buffer_store_dwordx4 v[128:131], v16, s[4:7], s26 offen offset:3072 sc1
C0_qk_ns13:
 v_mfma_f32_16x16x32_bf16 v[20:23], v[116:119], v[132:135], v[20:23]
 s_barrier
 ds_read_b64_tr_b16 v[84:85], v204 offset:32768
 v_mfma_f32_16x16x32_bf16 v[24:27], v[120:123], v[132:135], v[24:27]
 ds_read_b64_tr_b16 v[86:87], v204 offset:36864
 v_mfma_f32_16x16x32_bf16 v[28:31], v[124:127], v[132:135], v[28:31]
 ds_read_b128 v[100:103], v2 offset:24576
 v_mfma_f32_16x16x32_bf16 v[32:35], v[128:131], v[132:135], v[32:35]
 ds_read_b64_tr_b16 v[88:89], v205 offset:32768
 v_mfma_f32_16x16x32_bf16 v[180:183], v[116:119], v[12:15], v[180:183]
 ds_read_b64_tr_b16 v[90:91], v205 offset:36864
 v_mfma_f32_16x16x32_bf16 v[36:39], v[116:119], v[136:139], v[36:39]
 ds_read_b64_tr_b16 v[92:93], v206 offset:32768
 v_mfma_f32_16x16x32_bf16 v[40:43], v[120:123], v[136:139], v[40:43]
 ds_read_b64_tr_b16 v[94:95], v206 offset:36864
 v_mfma_f32_16x16x32_bf16 v[44:47], v[124:127], v[136:139], v[44:47]
 ds_read_b64_tr_b16 v[96:97], v207 offset:32768
 v_mfma_f32_16x16x32_bf16 v[48:51], v[128:131], v[136:139], v[48:51]
 ds_read_b64_tr_b16 v[98:99], v207 offset:36864
 v_mfma_f32_16x16x32_bf16 v[184:187], v[120:123], v[12:15], v[184:187]
 ds_read_b128 v[104:107], v2 offset:26624
 v_mfma_f32_16x16x32_bf16 v[52:55], v[116:119], v[140:143], v[52:55]
 ds_read_b128 v[108:111], v2 offset:28672
 v_mfma_f32_16x16x32_bf16 v[56:59], v[120:123], v[140:143], v[56:59]
 ds_read_b128 v[112:115], v2 offset:30720
 v_mfma_f32_16x16x32_bf16 v[60:63], v[124:127], v[140:143], v[60:63]
 v_mfma_f32_16x16x32_bf16 v[64:67], v[128:131], v[140:143], v[64:67]
 v_mfma_f32_16x16x32_bf16 v[188:191], v[124:127], v[12:15], v[188:191]
 v_mfma_f32_16x16x32_bf16 v[68:71], v[116:119], v[144:147], v[68:71]
 v_mfma_f32_16x16x32_bf16 v[72:75], v[120:123], v[144:147], v[72:75]
 v_mfma_f32_16x16x32_bf16 v[76:79], v[124:127], v[144:147], v[76:79]
 v_mfma_f32_16x16x32_bf16 v[80:83], v[128:131], v[144:147], v[80:83]
 v_mfma_f32_16x16x32_bf16 v[192:195], v[128:131], v[12:15], v[192:195]
 s_waitcnt lgkmcnt(0)
 s_cmp_lg_u32 s21, 14
 s_cbranch_scc1 C0_qk_ns14
 buffer_store_dwordx4 v[84:87], v16, s[4:7], s26 offen offset:0 sc1
 buffer_store_dwordx4 v[88:91], v16, s[4:7], s26 offen offset:1024 sc1
 buffer_store_dwordx4 v[92:95], v16, s[4:7], s26 offen offset:2048 sc1
 buffer_store_dwordx4 v[96:99], v16, s[4:7], s26 offen offset:3072 sc1
C0_qk_ns14:
 v_mfma_f32_16x16x32_bf16 v[20:23], v[84:87], v[100:103], v[20:23]
 ds_read_b64_tr_b16 v[116:117], v204 offset:49152
 v_mfma_f32_16x16x32_bf16 v[24:27], v[88:91], v[100:103], v[24:27]
 ds_read_b64_tr_b16 v[118:119], v204 offset:53248
 v_mfma_f32_16x16x32_bf16 v[28:31], v[92:95], v[100:103], v[28:31]
 ds_read_b128 v[132:135], v3 offset:24576
 v_mfma_f32_16x16x32_bf16 v[32:35], v[96:99], v[100:103], v[32:35]
 ds_read_b64_tr_b16 v[120:121], v205 offset:49152
 v_mfma_f32_16x16x32_bf16 v[180:183], v[84:87], v[12:15], v[180:183]
 ds_read_b64_tr_b16 v[122:123], v205 offset:53248
 v_mfma_f32_16x16x32_bf16 v[36:39], v[84:87], v[104:107], v[36:39]
 ds_read_b64_tr_b16 v[124:125], v206 offset:49152
 v_mfma_f32_16x16x32_bf16 v[40:43], v[88:91], v[104:107], v[40:43]
 ds_read_b64_tr_b16 v[126:127], v206 offset:53248
 v_mfma_f32_16x16x32_bf16 v[44:47], v[92:95], v[104:107], v[44:47]
 ds_read_b64_tr_b16 v[128:129], v207 offset:49152
 v_mfma_f32_16x16x32_bf16 v[48:51], v[96:99], v[104:107], v[48:51]
 ds_read_b64_tr_b16 v[130:131], v207 offset:53248
 v_mfma_f32_16x16x32_bf16 v[184:187], v[88:91], v[12:15], v[184:187]
 ds_read_b128 v[136:139], v3 offset:26624
 v_mfma_f32_16x16x32_bf16 v[52:55], v[84:87], v[108:111], v[52:55]
 ds_read_b128 v[140:143], v3 offset:28672
 v_mfma_f32_16x16x32_bf16 v[56:59], v[88:91], v[108:111], v[56:59]
 ds_read_b128 v[144:147], v3 offset:30720
 v_mfma_f32_16x16x32_bf16 v[60:63], v[92:95], v[108:111], v[60:63]
 v_mfma_f32_16x16x32_bf16 v[64:67], v[96:99], v[108:111], v[64:67]
 v_mfma_f32_16x16x32_bf16 v[188:191], v[92:95], v[12:15], v[188:191]
 v_mfma_f32_16x16x32_bf16 v[68:71], v[84:87], v[112:115], v[68:71]
 v_mfma_f32_16x16x32_bf16 v[72:75], v[88:91], v[112:115], v[72:75]
 v_mfma_f32_16x16x32_bf16 v[76:79], v[92:95], v[112:115], v[76:79]
 v_mfma_f32_16x16x32_bf16 v[80:83], v[96:99], v[112:115], v[80:83]
 v_mfma_f32_16x16x32_bf16 v[192:195], v[96:99], v[12:15], v[192:195]
 s_waitcnt lgkmcnt(0)
 s_cmp_lg_u32 s21, 15
 s_cbranch_scc1 C0_qk_ns15
 buffer_store_dwordx4 v[116:119], v16, s[4:7], s26 offen offset:0 sc1
 buffer_store_dwordx4 v[120:123], v16, s[4:7], s26 offen offset:1024 sc1
 buffer_store_dwordx4 v[124:127], v16, s[4:7], s26 offen offset:2048 sc1
 buffer_store_dwordx4 v[128:131], v16, s[4:7], s26 offen offset:3072 sc1
C0_qk_ns15:
 v_mfma_f32_16x16x32_bf16 v[20:23], v[116:119], v[132:135], v[20:23]
 s_barrier
 ds_read_b64_tr_b16 v[84:85], v208 offset:0
 v_mfma_f32_16x16x32_bf16 v[24:27], v[120:123], v[132:135], v[24:27]
 ds_read_b64_tr_b16 v[86:87], v208 offset:4096
 v_mfma_f32_16x16x32_bf16 v[28:31], v[124:127], v[132:135], v[28:31]
 ds_read_b128 v[100:103], v2 offset:0
 v_mfma_f32_16x16x32_bf16 v[32:35], v[128:131], v[132:135], v[32:35]
 ds_read_b64_tr_b16 v[88:89], v209 offset:0
 v_mfma_f32_16x16x32_bf16 v[180:183], v[116:119], v[12:15], v[180:183]
 ds_read_b64_tr_b16 v[90:91], v209 offset:4096
 v_mfma_f32_16x16x32_bf16 v[36:39], v[116:119], v[136:139], v[36:39]
 ds_read_b64_tr_b16 v[92:93], v210 offset:0
 v_mfma_f32_16x16x32_bf16 v[40:43], v[120:123], v[136:139], v[40:43]
 ds_read_b64_tr_b16 v[94:95], v210 offset:4096
 v_mfma_f32_16x16x32_bf16 v[44:47], v[124:127], v[136:139], v[44:47]
 ds_read_b64_tr_b16 v[96:97], v211 offset:0
 v_mfma_f32_16x16x32_bf16 v[48:51], v[128:131], v[136:139], v[48:51]
 ds_read_b64_tr_b16 v[98:99], v211 offset:4096
 v_mfma_f32_16x16x32_bf16 v[184:187], v[120:123], v[12:15], v[184:187]
 ds_read_b128 v[104:107], v2 offset:2048
 v_mfma_f32_16x16x32_bf16 v[52:55], v[116:119], v[140:143], v[52:55]
 ds_read_b128 v[108:111], v2 offset:4096
 v_mfma_f32_16x16x32_bf16 v[56:59], v[120:123], v[140:143], v[56:59]
 ds_read_b128 v[112:115], v2 offset:6144
 v_mfma_f32_16x16x32_bf16 v[60:63], v[124:127], v[140:143], v[60:63]
 v_mfma_f32_16x16x32_bf16 v[64:67], v[128:131], v[140:143], v[64:67]
 v_mfma_f32_16x16x32_bf16 v[188:191], v[124:127], v[12:15], v[188:191]
 v_mfma_f32_16x16x32_bf16 v[68:71], v[116:119], v[144:147], v[68:71]
 v_mfma_f32_16x16x32_bf16 v[72:75], v[120:123], v[144:147], v[72:75]
 v_mfma_f32_16x16x32_bf16 v[76:79], v[124:127], v[144:147], v[76:79]
 v_mfma_f32_16x16x32_bf16 v[80:83], v[128:131], v[144:147], v[80:83]
 v_mfma_f32_16x16x32_bf16 v[192:195], v[128:131], v[12:15], v[192:195]
 s_waitcnt lgkmcnt(0)
 s_cmp_lg_u32 s21, 16
 s_cbranch_scc1 C0_qk_ns16
 buffer_store_dwordx4 v[84:87], v16, s[4:7], s26 offen offset:0 sc1
 buffer_store_dwordx4 v[88:91], v16, s[4:7], s26 offen offset:1024 sc1
 buffer_store_dwordx4 v[92:95], v16, s[4:7], s26 offen offset:2048 sc1
 buffer_store_dwordx4 v[96:99], v16, s[4:7], s26 offen offset:3072 sc1
C0_qk_ns16:
 v_mfma_f32_16x16x32_bf16 v[20:23], v[84:87], v[100:103], v[20:23]
 ds_read_b64_tr_b16 v[116:117], v208 offset:16384
 v_mfma_f32_16x16x32_bf16 v[24:27], v[88:91], v[100:103], v[24:27]
 ds_read_b64_tr_b16 v[118:119], v208 offset:20480
 v_mfma_f32_16x16x32_bf16 v[28:31], v[92:95], v[100:103], v[28:31]
 ds_read_b128 v[132:135], v3 offset:0
 v_mfma_f32_16x16x32_bf16 v[32:35], v[96:99], v[100:103], v[32:35]
 ds_read_b64_tr_b16 v[120:121], v209 offset:16384
 v_mfma_f32_16x16x32_bf16 v[180:183], v[84:87], v[12:15], v[180:183]
 ds_read_b64_tr_b16 v[122:123], v209 offset:20480
 v_mfma_f32_16x16x32_bf16 v[36:39], v[84:87], v[104:107], v[36:39]
 ds_read_b64_tr_b16 v[124:125], v210 offset:16384
 v_mfma_f32_16x16x32_bf16 v[40:43], v[88:91], v[104:107], v[40:43]
 ds_read_b64_tr_b16 v[126:127], v210 offset:20480
 v_mfma_f32_16x16x32_bf16 v[44:47], v[92:95], v[104:107], v[44:47]
 ds_read_b64_tr_b16 v[128:129], v211 offset:16384
 v_mfma_f32_16x16x32_bf16 v[48:51], v[96:99], v[104:107], v[48:51]
 ds_read_b64_tr_b16 v[130:131], v211 offset:20480
 v_mfma_f32_16x16x32_bf16 v[184:187], v[88:91], v[12:15], v[184:187]
 ds_read_b128 v[136:139], v3 offset:2048
 v_mfma_f32_16x16x32_bf16 v[52:55], v[84:87], v[108:111], v[52:55]
 ds_read_b128 v[140:143], v3 offset:4096
 v_mfma_f32_16x16x32_bf16 v[56:59], v[88:91], v[108:111], v[56:59]
 ds_read_b128 v[144:147], v3 offset:6144
 v_mfma_f32_16x16x32_bf16 v[60:63], v[92:95], v[108:111], v[60:63]
 v_mfma_f32_16x16x32_bf16 v[64:67], v[96:99], v[108:111], v[64:67]
 v_mfma_f32_16x16x32_bf16 v[188:191], v[92:95], v[12:15], v[188:191]
 v_mfma_f32_16x16x32_bf16 v[68:71], v[84:87], v[112:115], v[68:71]
 v_mfma_f32_16x16x32_bf16 v[72:75], v[88:91], v[112:115], v[72:75]
 v_mfma_f32_16x16x32_bf16 v[76:79], v[92:95], v[112:115], v[76:79]
 v_mfma_f32_16x16x32_bf16 v[80:83], v[96:99], v[112:115], v[80:83]
 v_mfma_f32_16x16x32_bf16 v[192:195], v[96:99], v[12:15], v[192:195]
 s_waitcnt lgkmcnt(0)
 s_cmp_lg_u32 s21, 17
 s_cbranch_scc1 C0_qk_ns17
 buffer_store_dwordx4 v[116:119], v16, s[4:7], s26 offen offset:0 sc1
 buffer_store_dwordx4 v[120:123], v16, s[4:7], s26 offen offset:1024 sc1
 buffer_store_dwordx4 v[124:127], v16, s[4:7], s26 offen offset:2048 sc1
 buffer_store_dwordx4 v[128:131], v16, s[4:7], s26 offen offset:3072 sc1
C0_qk_ns17:
 v_mfma_f32_16x16x32_bf16 v[20:23], v[116:119], v[132:135], v[20:23]
 s_barrier
 ds_read_b64_tr_b16 v[84:85], v204 offset:0
 v_mfma_f32_16x16x32_bf16 v[24:27], v[120:123], v[132:135], v[24:27]
 ds_read_b64_tr_b16 v[86:87], v204 offset:4096
 v_mfma_f32_16x16x32_bf16 v[28:31], v[124:127], v[132:135], v[28:31]
 ds_read_b128 v[100:103], v2 offset:8192
 v_mfma_f32_16x16x32_bf16 v[32:35], v[128:131], v[132:135], v[32:35]
 ds_read_b64_tr_b16 v[88:89], v205 offset:0
 v_mfma_f32_16x16x32_bf16 v[180:183], v[116:119], v[12:15], v[180:183]
 ds_read_b64_tr_b16 v[90:91], v205 offset:4096
 v_mfma_f32_16x16x32_bf16 v[36:39], v[116:119], v[136:139], v[36:39]
 ds_read_b64_tr_b16 v[92:93], v206 offset:0
 v_mfma_f32_16x16x32_bf16 v[40:43], v[120:123], v[136:139], v[40:43]
 ds_read_b64_tr_b16 v[94:95], v206 offset:4096
 v_mfma_f32_16x16x32_bf16 v[44:47], v[124:127], v[136:139], v[44:47]
 ds_read_b64_tr_b16 v[96:97], v207 offset:0
 v_mfma_f32_16x16x32_bf16 v[48:51], v[128:131], v[136:139], v[48:51]
 ds_read_b64_tr_b16 v[98:99], v207 offset:4096
 v_mfma_f32_16x16x32_bf16 v[184:187], v[120:123], v[12:15], v[184:187]
 ds_read_b128 v[104:107], v2 offset:10240
 v_mfma_f32_16x16x32_bf16 v[52:55], v[116:119], v[140:143], v[52:55]
 ds_read_b128 v[108:111], v2 offset:12288
 v_mfma_f32_16x16x32_bf16 v[56:59], v[120:123], v[140:143], v[56:59]
 ds_read_b128 v[112:115], v2 offset:14336
 v_mfma_f32_16x16x32_bf16 v[60:63], v[124:127], v[140:143], v[60:63]
 v_mfma_f32_16x16x32_bf16 v[64:67], v[128:131], v[140:143], v[64:67]
 v_mfma_f32_16x16x32_bf16 v[188:191], v[124:127], v[12:15], v[188:191]
 v_mfma_f32_16x16x32_bf16 v[68:71], v[116:119], v[144:147], v[68:71]
 v_mfma_f32_16x16x32_bf16 v[72:75], v[120:123], v[144:147], v[72:75]
 v_mfma_f32_16x16x32_bf16 v[76:79], v[124:127], v[144:147], v[76:79]
 v_mfma_f32_16x16x32_bf16 v[80:83], v[128:131], v[144:147], v[80:83]
 v_mfma_f32_16x16x32_bf16 v[192:195], v[128:131], v[12:15], v[192:195]
 s_waitcnt lgkmcnt(0)
 s_cmp_lg_u32 s21, 18
 s_cbranch_scc1 C0_qk_ns18
 buffer_store_dwordx4 v[84:87], v16, s[4:7], s26 offen offset:0 sc1
 buffer_store_dwordx4 v[88:91], v16, s[4:7], s26 offen offset:1024 sc1
 buffer_store_dwordx4 v[92:95], v16, s[4:7], s26 offen offset:2048 sc1
 buffer_store_dwordx4 v[96:99], v16, s[4:7], s26 offen offset:3072 sc1
C0_qk_ns18:
 v_mfma_f32_16x16x32_bf16 v[20:23], v[84:87], v[100:103], v[20:23]
 ds_read_b64_tr_b16 v[116:117], v204 offset:16384
 v_mfma_f32_16x16x32_bf16 v[24:27], v[88:91], v[100:103], v[24:27]
 ds_read_b64_tr_b16 v[118:119], v204 offset:20480
 v_mfma_f32_16x16x32_bf16 v[28:31], v[92:95], v[100:103], v[28:31]
 ds_read_b128 v[132:135], v3 offset:8192
 v_mfma_f32_16x16x32_bf16 v[32:35], v[96:99], v[100:103], v[32:35]
 ds_read_b64_tr_b16 v[120:121], v205 offset:16384
 v_mfma_f32_16x16x32_bf16 v[180:183], v[84:87], v[12:15], v[180:183]
 ds_read_b64_tr_b16 v[122:123], v205 offset:20480
 v_mfma_f32_16x16x32_bf16 v[36:39], v[84:87], v[104:107], v[36:39]
 ds_read_b64_tr_b16 v[124:125], v206 offset:16384
 v_mfma_f32_16x16x32_bf16 v[40:43], v[88:91], v[104:107], v[40:43]
 ds_read_b64_tr_b16 v[126:127], v206 offset:20480
 v_mfma_f32_16x16x32_bf16 v[44:47], v[92:95], v[104:107], v[44:47]
 ds_read_b64_tr_b16 v[128:129], v207 offset:16384
 v_mfma_f32_16x16x32_bf16 v[48:51], v[96:99], v[104:107], v[48:51]
 ds_read_b64_tr_b16 v[130:131], v207 offset:20480
 v_mfma_f32_16x16x32_bf16 v[184:187], v[88:91], v[12:15], v[184:187]
 ds_read_b128 v[136:139], v3 offset:10240
 v_mfma_f32_16x16x32_bf16 v[52:55], v[84:87], v[108:111], v[52:55]
 ds_read_b128 v[140:143], v3 offset:12288
 v_mfma_f32_16x16x32_bf16 v[56:59], v[88:91], v[108:111], v[56:59]
 ds_read_b128 v[144:147], v3 offset:14336
 v_mfma_f32_16x16x32_bf16 v[60:63], v[92:95], v[108:111], v[60:63]
 v_mfma_f32_16x16x32_bf16 v[64:67], v[96:99], v[108:111], v[64:67]
 v_mfma_f32_16x16x32_bf16 v[188:191], v[92:95], v[12:15], v[188:191]
 v_mfma_f32_16x16x32_bf16 v[68:71], v[84:87], v[112:115], v[68:71]
 v_mfma_f32_16x16x32_bf16 v[72:75], v[88:91], v[112:115], v[72:75]
 v_mfma_f32_16x16x32_bf16 v[76:79], v[92:95], v[112:115], v[76:79]
 v_mfma_f32_16x16x32_bf16 v[80:83], v[96:99], v[112:115], v[80:83]
 v_mfma_f32_16x16x32_bf16 v[192:195], v[96:99], v[12:15], v[192:195]
 s_waitcnt lgkmcnt(0)
 s_cmp_lg_u32 s21, 19
 s_cbranch_scc1 C0_qk_ns19
 buffer_store_dwordx4 v[116:119], v16, s[4:7], s26 offen offset:0 sc1
 buffer_store_dwordx4 v[120:123], v16, s[4:7], s26 offen offset:1024 sc1
 buffer_store_dwordx4 v[124:127], v16, s[4:7], s26 offen offset:2048 sc1
 buffer_store_dwordx4 v[128:131], v16, s[4:7], s26 offen offset:3072 sc1
C0_qk_ns19:
 v_mfma_f32_16x16x32_bf16 v[20:23], v[116:119], v[132:135], v[20:23]
 s_barrier
 v_mfma_f32_16x16x32_bf16 v[24:27], v[120:123], v[132:135], v[24:27]
 v_mfma_f32_16x16x32_bf16 v[28:31], v[124:127], v[132:135], v[28:31]
 v_mfma_f32_16x16x32_bf16 v[32:35], v[128:131], v[132:135], v[32:35]
 v_mfma_f32_16x16x32_bf16 v[180:183], v[116:119], v[12:15], v[180:183]
 v_mfma_f32_16x16x32_bf16 v[36:39], v[116:119], v[136:139], v[36:39]
 v_mfma_f32_16x16x32_bf16 v[40:43], v[120:123], v[136:139], v[40:43]
 v_mfma_f32_16x16x32_bf16 v[44:47], v[124:127], v[136:139], v[44:47]
 v_mfma_f32_16x16x32_bf16 v[48:51], v[128:131], v[136:139], v[48:51]
 v_mfma_f32_16x16x32_bf16 v[184:187], v[120:123], v[12:15], v[184:187]
 v_mfma_f32_16x16x32_bf16 v[52:55], v[116:119], v[140:143], v[52:55]
 v_mfma_f32_16x16x32_bf16 v[56:59], v[120:123], v[140:143], v[56:59]
 v_mfma_f32_16x16x32_bf16 v[60:63], v[124:127], v[140:143], v[60:63]
 v_mfma_f32_16x16x32_bf16 v[64:67], v[128:131], v[140:143], v[64:67]
 v_mfma_f32_16x16x32_bf16 v[188:191], v[124:127], v[12:15], v[188:191]
 v_mfma_f32_16x16x32_bf16 v[68:71], v[116:119], v[144:147], v[68:71]
 v_mfma_f32_16x16x32_bf16 v[72:75], v[120:123], v[144:147], v[72:75]
 v_mfma_f32_16x16x32_bf16 v[76:79], v[124:127], v[144:147], v[76:79]
 v_mfma_f32_16x16x32_bf16 v[80:83], v[128:131], v[144:147], v[80:83]
 v_mfma_f32_16x16x32_bf16 v[192:195], v[128:131], v[12:15], v[192:195]
 v_and_b32 v8, 15, v1
 v_lshlrev_b32 v8, 2, v8
 v_add_u32 v8, 161792, v8
 ds_read_b32 v84, v8 offset:0
 ds_read_b32 v85, v8 offset:64
 ds_read_b32 v86, v8 offset:128
 ds_read_b32 v87, v8 offset:192
 ds_read_b32 v88, v8 offset:256
 ds_read_b32 v89, v8 offset:320
 ds_read_b32 v90, v8 offset:384
 ds_read_b32 v91, v8 offset:448
 s_cmp_lg_u32 s21, 20
 s_cbranch_scc1 C0_qk_nocs
 v_lshrrev_b32 v8, 4, v1
 v_lshlrev_b32 v8, 4, v8
 s_mov_b32 exec_lo, 0x00010001
 s_mov_b32 exec_hi, 0x00010001
 buffer_store_dwordx4 v[180:183], v8, s[4:7], s31 offen offset:0
 buffer_store_dwordx4 v[184:187], v8, s[4:7], s31 offen offset:64
 buffer_store_dwordx4 v[188:191], v8, s[4:7], s31 offen offset:128
 buffer_store_dwordx4 v[192:195], v8, s[4:7], s31 offen offset:192
 s_mov_b64 exec, -1
C0_qk_nocs:
 s_waitcnt lgkmcnt(0)
 v_mul_f32 v84, s27, v84
 v_mul_f32 v85, s27, v85
 v_mul_f32 v86, s27, v86
 v_mul_f32 v87, s27, v87
 v_mul_f32 v88, s27, v88
 v_mul_f32 v89, s27, v89
 v_mul_f32 v90, s27, v90
 v_mul_f32 v91, s27, v91
 v_pk_mul_f32 v[204:205], v[180:181], v[88:89] op_sel:[0,0] op_sel_hi:[1,0]
 v_pk_mul_f32 v[206:207], v[182:183], v[88:89] op_sel:[0,0] op_sel_hi:[1,0]
 v_pk_mul_f32 v[208:209], v[180:181], v[88:89] op_sel:[0,1] op_sel_hi:[1,1]
 v_pk_mul_f32 v[210:211], v[182:183], v[88:89] op_sel:[0,1] op_sel_hi:[1,1]
 v_pk_fma_f32 v[204:205], v[20:21], v[84:85], v[204:205] op_sel:[0,0,0] op_sel_hi:[1,0,1] neg_lo:[0,0,1] neg_hi:[0,0,1]
 v_pk_fma_f32 v[206:207], v[22:23], v[84:85], v[206:207] op_sel:[0,0,0] op_sel_hi:[1,0,1] neg_lo:[0,0,1] neg_hi:[0,0,1]
 v_pk_fma_f32 v[208:209], v[36:37], v[84:85], v[208:209] op_sel:[0,1,0] op_sel_hi:[1,1,1] neg_lo:[0,0,1] neg_hi:[0,0,1]
 v_pk_fma_f32 v[210:211], v[38:39], v[84:85], v[210:211] op_sel:[0,1,0] op_sel_hi:[1,1,1] neg_lo:[0,0,1] neg_hi:[0,0,1]
 v_cvt_pk_bf16_f32 v212, v204, v205
 v_cvt_pk_bf16_f32 v213, v206, v207
 v_cvt_pk_bf16_f32 v214, v208, v209
 v_cvt_pk_bf16_f32 v215, v210, v211
 s_nop 0
 v_permlane16_swap_b32 v212, v214
 v_permlane16_swap_b32 v213, v215
 buffer_store_dwordx4 v[212:215], v203, s[4:7], s30 offen offset:0
 v_pk_mul_f32 v[220:221], v[180:181], v[90:91] op_sel:[0,0] op_sel_hi:[1,0]
 v_pk_mul_f32 v[222:223], v[182:183], v[90:91] op_sel:[0,0] op_sel_hi:[1,0]
 v_pk_mul_f32 v[224:225], v[180:181], v[90:91] op_sel:[0,1] op_sel_hi:[1,1]
 v_pk_mul_f32 v[226:227], v[182:183], v[90:91] op_sel:[0,1] op_sel_hi:[1,1]
 v_pk_fma_f32 v[220:221], v[52:53], v[86:87], v[220:221] op_sel:[0,0,0] op_sel_hi:[1,0,1] neg_lo:[0,0,1] neg_hi:[0,0,1]
 v_pk_fma_f32 v[222:223], v[54:55], v[86:87], v[222:223] op_sel:[0,0,0] op_sel_hi:[1,0,1] neg_lo:[0,0,1] neg_hi:[0,0,1]
 v_pk_fma_f32 v[224:225], v[68:69], v[86:87], v[224:225] op_sel:[0,1,0] op_sel_hi:[1,1,1] neg_lo:[0,0,1] neg_hi:[0,0,1]
 v_pk_fma_f32 v[226:227], v[70:71], v[86:87], v[226:227] op_sel:[0,1,0] op_sel_hi:[1,1,1] neg_lo:[0,0,1] neg_hi:[0,0,1]
 v_cvt_pk_bf16_f32 v228, v220, v221
 v_cvt_pk_bf16_f32 v229, v222, v223
 v_cvt_pk_bf16_f32 v230, v224, v225
 v_cvt_pk_bf16_f32 v231, v226, v227
 s_nop 0
 v_permlane16_swap_b32 v228, v230
 v_permlane16_swap_b32 v229, v231
 buffer_store_dwordx4 v[228:231], v203, s[4:7], s29 offen offset:0
 v_pk_mul_f32 v[204:205], v[184:185], v[88:89] op_sel:[0,0] op_sel_hi:[1,0]
 v_pk_mul_f32 v[206:207], v[186:187], v[88:89] op_sel:[0,0] op_sel_hi:[1,0]
 v_pk_mul_f32 v[208:209], v[184:185], v[88:89] op_sel:[0,1] op_sel_hi:[1,1]
 v_pk_mul_f32 v[210:211], v[186:187], v[88:89] op_sel:[0,1] op_sel_hi:[1,1]
 v_pk_fma_f32 v[204:205], v[24:25], v[84:85], v[204:205] op_sel:[0,0,0] op_sel_hi:[1,0,1] neg_lo:[0,0,1] neg_hi:[0,0,1]
 v_pk_fma_f32 v[206:207], v[26:27], v[84:85], v[206:207] op_sel:[0,0,0] op_sel_hi:[1,0,1] neg_lo:[0,0,1] neg_hi:[0,0,1]
 v_pk_fma_f32 v[208:209], v[40:41], v[84:85], v[208:209] op_sel:[0,1,0] op_sel_hi:[1,1,1] neg_lo:[0,0,1] neg_hi:[0,0,1]
 v_pk_fma_f32 v[210:211], v[42:43], v[84:85], v[210:211] op_sel:[0,1,0] op_sel_hi:[1,1,1] neg_lo:[0,0,1] neg_hi:[0,0,1]
 v_cvt_pk_bf16_f32 v212, v204, v205
 v_cvt_pk_bf16_f32 v213, v206, v207
 v_cvt_pk_bf16_f32 v214, v208, v209
 v_cvt_pk_bf16_f32 v215, v210, v211
 s_nop 0
 v_permlane16_swap_b32 v212, v214
 v_permlane16_swap_b32 v213, v215
 buffer_store_dwordx4 v[212:215], v203, s[4:7], s30 offen offset:512
 v_pk_mul_f32 v[220:221], v[184:185], v[90:91] op_sel:[0,0] op_sel_hi:[1,0]
 v_pk_mul_f32 v[222:223], v[186:187], v[90:91] op_sel:[0,0] op_sel_hi:[1,0]
 v_pk_mul_f32 v[224:225], v[184:185], v[90:91] op_sel:[0,1] op_sel_hi:[1,1]
 v_pk_mul_f32 v[226:227], v[186:187], v[90:91] op_sel:[0,1] op_sel_hi:[1,1]
 v_pk_fma_f32 v[220:221], v[56:57], v[86:87], v[220:221] op_sel:[0,0,0] op_sel_hi:[1,0,1] neg_lo:[0,0,1] neg_hi:[0,0,1]
 v_pk_fma_f32 v[222:223], v[58:59], v[86:87], v[222:223] op_sel:[0,0,0] op_sel_hi:[1,0,1] neg_lo:[0,0,1] neg_hi:[0,0,1]
 v_pk_fma_f32 v[224:225], v[72:73], v[86:87], v[224:225] op_sel:[0,1,0] op_sel_hi:[1,1,1] neg_lo:[0,0,1] neg_hi:[0,0,1]
 v_pk_fma_f32 v[226:227], v[74:75], v[86:87], v[226:227] op_sel:[0,1,0] op_sel_hi:[1,1,1] neg_lo:[0,0,1] neg_hi:[0,0,1]
 v_cvt_pk_bf16_f32 v228, v220, v221
 v_cvt_pk_bf16_f32 v229, v222, v223
 v_cvt_pk_bf16_f32 v230, v224, v225
 v_cvt_pk_bf16_f32 v231, v226, v227
 s_nop 0
 v_permlane16_swap_b32 v228, v230
 v_permlane16_swap_b32 v229, v231
 buffer_store_dwordx4 v[228:231], v203, s[4:7], s29 offen offset:512
 v_pk_mul_f32 v[204:205], v[188:189], v[88:89] op_sel:[0,0] op_sel_hi:[1,0]
 v_pk_mul_f32 v[206:207], v[190:191], v[88:89] op_sel:[0,0] op_sel_hi:[1,0]
 v_pk_mul_f32 v[208:209], v[188:189], v[88:89] op_sel:[0,1] op_sel_hi:[1,1]
 v_pk_mul_f32 v[210:211], v[190:191], v[88:89] op_sel:[0,1] op_sel_hi:[1,1]
 v_pk_fma_f32 v[204:205], v[28:29], v[84:85], v[204:205] op_sel:[0,0,0] op_sel_hi:[1,0,1] neg_lo:[0,0,1] neg_hi:[0,0,1]
 v_pk_fma_f32 v[206:207], v[30:31], v[84:85], v[206:207] op_sel:[0,0,0] op_sel_hi:[1,0,1] neg_lo:[0,0,1] neg_hi:[0,0,1]
 v_pk_fma_f32 v[208:209], v[44:45], v[84:85], v[208:209] op_sel:[0,1,0] op_sel_hi:[1,1,1] neg_lo:[0,0,1] neg_hi:[0,0,1]
 v_pk_fma_f32 v[210:211], v[46:47], v[84:85], v[210:211] op_sel:[0,1,0] op_sel_hi:[1,1,1] neg_lo:[0,0,1] neg_hi:[0,0,1]
 v_cvt_pk_bf16_f32 v212, v204, v205
 v_cvt_pk_bf16_f32 v213, v206, v207
 v_cvt_pk_bf16_f32 v214, v208, v209
 v_cvt_pk_bf16_f32 v215, v210, v211
 s_nop 0
 v_permlane16_swap_b32 v212, v214
 v_permlane16_swap_b32 v213, v215
 buffer_store_dwordx4 v[212:215], v203, s[4:7], s30 offen offset:1024
 v_pk_mul_f32 v[220:221], v[188:189], v[90:91] op_sel:[0,0] op_sel_hi:[1,0]
 v_pk_mul_f32 v[222:223], v[190:191], v[90:91] op_sel:[0,0] op_sel_hi:[1,0]
 v_pk_mul_f32 v[224:225], v[188:189], v[90:91] op_sel:[0,1] op_sel_hi:[1,1]
 v_pk_mul_f32 v[226:227], v[190:191], v[90:91] op_sel:[0,1] op_sel_hi:[1,1]
 v_pk_fma_f32 v[220:221], v[60:61], v[86:87], v[220:221] op_sel:[0,0,0] op_sel_hi:[1,0,1] neg_lo:[0,0,1] neg_hi:[0,0,1]
 v_pk_fma_f32 v[222:223], v[62:63], v[86:87], v[222:223] op_sel:[0,0,0] op_sel_hi:[1,0,1] neg_lo:[0,0,1] neg_hi:[0,0,1]
 v_pk_fma_f32 v[224:225], v[76:77], v[86:87], v[224:225] op_sel:[0,1,0] op_sel_hi:[1,1,1] neg_lo:[0,0,1] neg_hi:[0,0,1]
 v_pk_fma_f32 v[226:227], v[78:79], v[86:87], v[226:227] op_sel:[0,1,0] op_sel_hi:[1,1,1] neg_lo:[0,0,1] neg_hi:[0,0,1]
 v_cvt_pk_bf16_f32 v228, v220, v221
 v_cvt_pk_bf16_f32 v229, v222, v223
 v_cvt_pk_bf16_f32 v230, v224, v225
 v_cvt_pk_bf16_f32 v231, v226, v227
 s_nop 0
 v_permlane16_swap_b32 v228, v230
 v_permlane16_swap_b32 v229, v231
 buffer_store_dwordx4 v[228:231], v203, s[4:7], s29 offen offset:1024
 v_pk_mul_f32 v[204:205], v[192:193], v[88:89] op_sel:[0,0] op_sel_hi:[1,0]
 v_pk_mul_f32 v[206:207], v[194:195], v[88:89] op_sel:[0,0] op_sel_hi:[1,0]
 v_pk_mul_f32 v[208:209], v[192:193], v[88:89] op_sel:[0,1] op_sel_hi:[1,1]
 v_pk_mul_f32 v[210:211], v[194:195], v[88:89] op_sel:[0,1] op_sel_hi:[1,1]
 v_pk_fma_f32 v[204:205], v[32:33], v[84:85], v[204:205] op_sel:[0,0,0] op_sel_hi:[1,0,1] neg_lo:[0,0,1] neg_hi:[0,0,1]
 v_pk_fma_f32 v[206:207], v[34:35], v[84:85], v[206:207] op_sel:[0,0,0] op_sel_hi:[1,0,1] neg_lo:[0,0,1] neg_hi:[0,0,1]
 v_pk_fma_f32 v[208:209], v[48:49], v[84:85], v[208:209] op_sel:[0,1,0] op_sel_hi:[1,1,1] neg_lo:[0,0,1] neg_hi:[0,0,1]
 v_pk_fma_f32 v[210:211], v[50:51], v[84:85], v[210:211] op_sel:[0,1,0] op_sel_hi:[1,1,1] neg_lo:[0,0,1] neg_hi:[0,0,1]
 v_cvt_pk_bf16_f32 v212, v204, v205
 v_cvt_pk_bf16_f32 v213, v206, v207
 v_cvt_pk_bf16_f32 v214, v208, v209
 v_cvt_pk_bf16_f32 v215, v210, v211
 s_nop 0
 v_permlane16_swap_b32 v212, v214
 v_permlane16_swap_b32 v213, v215
 buffer_store_dwordx4 v[212:215], v203, s[4:7], s30 offen offset:1536
 v_pk_mul_f32 v[220:221], v[192:193], v[90:91] op_sel:[0,0] op_sel_hi:[1,0]
 v_pk_mul_f32 v[222:223], v[194:195], v[90:91] op_sel:[0,0] op_sel_hi:[1,0]
 v_pk_mul_f32 v[224:225], v[192:193], v[90:91] op_sel:[0,1] op_sel_hi:[1,1]
 v_pk_mul_f32 v[226:227], v[194:195], v[90:91] op_sel:[0,1] op_sel_hi:[1,1]
 v_pk_fma_f32 v[220:221], v[64:65], v[86:87], v[220:221] op_sel:[0,0,0] op_sel_hi:[1,0,1] neg_lo:[0,0,1] neg_hi:[0,0,1]
 v_pk_fma_f32 v[222:223], v[66:67], v[86:87], v[222:223] op_sel:[0,0,0] op_sel_hi:[1,0,1] neg_lo:[0,0,1] neg_hi:[0,0,1]
 v_pk_fma_f32 v[224:225], v[80:81], v[86:87], v[224:225] op_sel:[0,1,0] op_sel_hi:[1,1,1] neg_lo:[0,0,1] neg_hi:[0,0,1]
 v_pk_fma_f32 v[226:227], v[82:83], v[86:87], v[226:227] op_sel:[0,1,0] op_sel_hi:[1,1,1] neg_lo:[0,0,1] neg_hi:[0,0,1]
 v_cvt_pk_bf16_f32 v228, v220, v221
 v_cvt_pk_bf16_f32 v229, v222, v223
 v_cvt_pk_bf16_f32 v230, v224, v225
 v_cvt_pk_bf16_f32 v231, v226, v227
 s_nop 0
 v_permlane16_swap_b32 v228, v230
 v_permlane16_swap_b32 v229, v231
 buffer_store_dwordx4 v[228:231], v203, s[4:7], s29 offen offset:1536
 s_endpgm
C0_q_mx:
 v_lshrrev_b32 v9, 4, v1
 v_and_b32 v203, 1, v9
 s_mov_b32 s23, 61440
 v_mul_lo_u32 v203, v203, s23
 v_lshrrev_b32 v9, 1, v9
 v_lshlrev_b32 v9, 8, v9
 v_add_u32 v203, v203, v9
 v_and_b32 v9, 15, v1
 v_lshlrev_b32 v9, 4, v9
 v_add_u32 v203, v203, v9
 v_and_b32 v8, 15, v1
 v_lshrrev_b32 v9, 5, v1
 v_mul_u32_u24 v9, 672, v9
 v_bfe_u32 v204, v1, 4, 1
 v_mul_u32_u24 v204, 336, v204
 v_add_u32 v9, v9, v204
 s_mul_i32 s23, s22, 80
 s_lshl_b32 s24, s20, 6
 s_add_u32 s23, s23, s24
 s_sub_u32 s23, s23, 160
 v_add_u32 v8, s23, v8
 s_mov_b32 s24, 86016
 v_add_u32 v204, 32, v8
 v_mul_u32_u24 v205, 3277, v204
 v_lshrrev_b32 v205, 16, v205
 v_mul_u32_u24 v206, 20, v205
 v_sub_u32 v206, v204, v206
 v_lshlrev_b32 v206, 4, v206
 v_mul_lo_u32 v205, v205, s24
 v_add_u32 v205, v205, v206
 v_add_u32 v200, v205, v9
 v_add_u32 v204, 48, v8
 v_mul_u32_u24 v205, 3277, v204
 v_lshrrev_b32 v205, 16, v205
 v_mul_u32_u24 v206, 20, v205
 v_sub_u32 v206, v204, v206
 v_lshlrev_b32 v206, 4, v206
 v_mul_lo_u32 v205, v205, s24
 v_add_u32 v205, v205, v206
 v_add_u32 v201, v205, v9
 v_add_u32 v8, 32, v6
 v_mul_u32_u24 v9, 6554, v8
 v_lshrrev_b32 v9, 16, v9
 v_mul_u32_u24 v10, 10, v9
 v_sub_u32 v10, v8, v10
 v_add_u32 v11, 2, v10
 v_lshrrev_b32 v11, 3, v11
 v_sub_u32 v11, v10, v11
 v_cmp_eq_u32 vcc, 5, v10
 v_mov_b32 v10, 9
 s_nop 0
 v_cndmask_b32 v11, v11, v10, vcc
 v_mul_u32_u24 v9, 80, v9
 v_lshl_add_u32 v9, v11, 3, v9
 v_xor_b32 v9, v4, v9
 v_add_u32 v204, v5, v9
 v_add_u32 v208, 65536, v204
 v_add_u32 v8, 36, v6
 v_mul_u32_u24 v9, 6554, v8
 v_lshrrev_b32 v9, 16, v9
 v_mul_u32_u24 v10, 10, v9
 v_sub_u32 v10, v8, v10
 v_add_u32 v11, 2, v10
 v_lshrrev_b32 v11, 3, v11
 v_sub_u32 v11, v10, v11
 v_cmp_eq_u32 vcc, 5, v10
 v_mov_b32 v10, 9
 s_nop 0
 v_cndmask_b32 v11, v11, v10, vcc
 v_mul_u32_u24 v9, 80, v9
 v_lshl_add_u32 v9, v11, 3, v9
 v_xor_b32 v9, v4, v9
 v_add_u32 v205, v5, v9
 v_add_u32 v209, 65536, v205
 v_lshlrev_b32 v9, 3, v6
 v_add_u32 v9, 320, v9
 v_xor_b32 v9, v4, v9
 v_add_u32 v206, v5, v9
 v_add_u32 v210, 65536, v206
 v_lshlrev_b32 v9, 3, v6
 v_add_u32 v9, 352, v9
 v_xor_b32 v9, v4, v9
 v_add_u32 v207, v5, v9
 v_add_u32 v211, 65536, v207
 s_waitcnt lgkmcnt(0)
 s_barrier
 ds_read_b64_tr_b16 v[84:85], v204 offset:0
 ds_read_b64_tr_b16 v[86:87], v204 offset:4096
 ds_read_b128 v[100:103], v2 offset:0
 ds_read_b64_tr_b16 v[88:89], v205 offset:0
 ds_read_b64_tr_b16 v[90:91], v205 offset:4096
 ds_read_b64_tr_b16 v[92:93], v206 offset:0
 ds_read_b64_tr_b16 v[94:95], v206 offset:4096
 ds_read_b64_tr_b16 v[96:97], v207 offset:0
 ds_read_b64_tr_b16 v[98:99], v207 offset:4096
 ds_read_b128 v[104:107], v2 offset:2048
 ds_read_b128 v[108:111], v2 offset:4096
 ds_read_b128 v[112:115], v2 offset:6144
 s_waitcnt lgkmcnt(0)
 s_cmp_lg_u32 s21, 0
 s_cbranch_scc1 C0_mx_ns0
 buffer_store_dwordx4 v[84:87], v16, s[4:7], s26 offen offset:0 sc1
 buffer_store_dwordx4 v[88:91], v16, s[4:7], s26 offen offset:1024 sc1
 buffer_store_dwordx4 v[92:95], v16, s[4:7], s26 offen offset:2048 sc1
 buffer_store_dwordx4 v[96:99], v16, s[4:7], s26 offen offset:3072 sc1
C0_mx_ns0:
 v_mfma_f32_16x16x32_bf16 v[20:23], v[84:87], v[100:103], 0
 ds_read_b64_tr_b16 v[116:117], v204 offset:16384
 v_mfma_f32_16x16x32_bf16 v[24:27], v[88:91], v[100:103], 0
 ds_read_b64_tr_b16 v[118:119], v204 offset:20480
 v_mfma_f32_16x16x32_bf16 v[28:31], v[100:103], v[92:95], 0
 ds_read_b128 v[132:135], v3 offset:0
 v_mfma_f32_16x16x32_bf16 v[32:35], v[100:103], v[96:99], 0
 ds_read_b64_tr_b16 v[120:121], v205 offset:16384
 v_mfma_f32_16x16x32_bf16 v[180:183], v[84:87], v[12:15], 0
 ds_read_b64_tr_b16 v[122:123], v205 offset:20480
 v_mfma_f32_16x16x32_bf16 v[36:39], v[84:87], v[104:107], 0
 ds_read_b64_tr_b16 v[124:125], v206 offset:16384
 v_mfma_f32_16x16x32_bf16 v[40:43], v[88:91], v[104:107], 0
 ds_read_b64_tr_b16 v[126:127], v206 offset:20480
 v_mfma_f32_16x16x32_bf16 v[44:47], v[104:107], v[92:95], 0
 ds_read_b64_tr_b16 v[128:129], v207 offset:16384
 v_mfma_f32_16x16x32_bf16 v[48:51], v[104:107], v[96:99], 0
 ds_read_b64_tr_b16 v[130:131], v207 offset:20480
 v_mfma_f32_16x16x32_bf16 v[184:187], v[88:91], v[12:15], 0
 ds_read_b128 v[136:139], v3 offset:2048
 v_mfma_f32_16x16x32_bf16 v[52:55], v[84:87], v[108:111], 0
 ds_read_b128 v[140:143], v3 offset:4096
 v_mfma_f32_16x16x32_bf16 v[56:59], v[88:91], v[108:111], 0
 ds_read_b128 v[144:147], v3 offset:6144
 v_mfma_f32_16x16x32_bf16 v[60:63], v[108:111], v[92:95], 0
 v_mfma_f32_16x16x32_bf16 v[64:67], v[108:111], v[96:99], 0
 v_mfma_f32_16x16x32_bf16 v[188:191], v[12:15], v[92:95], 0
 v_mfma_f32_16x16x32_bf16 v[68:71], v[84:87], v[112:115], 0
 v_mfma_f32_16x16x32_bf16 v[72:75], v[88:91], v[112:115], 0
 v_mfma_f32_16x16x32_bf16 v[76:79], v[112:115], v[92:95], 0
 v_mfma_f32_16x16x32_bf16 v[80:83], v[112:115], v[96:99], 0
 v_mfma_f32_16x16x32_bf16 v[192:195], v[12:15], v[96:99], 0
 s_waitcnt lgkmcnt(0)
 s_cmp_lg_u32 s21, 1
 s_cbranch_scc1 C0_mx_ns1
 buffer_store_dwordx4 v[116:119], v16, s[4:7], s26 offen offset:0 sc1
 buffer_store_dwordx4 v[120:123], v16, s[4:7], s26 offen offset:1024 sc1
 buffer_store_dwordx4 v[124:127], v16, s[4:7], s26 offen offset:2048 sc1
 buffer_store_dwordx4 v[128:131], v16, s[4:7], s26 offen offset:3072 sc1
C0_mx_ns1:
 v_mfma_f32_16x16x32_bf16 v[20:23], v[116:119], v[132:135], v[20:23]
 s_barrier
 ds_read_b64_tr_b16 v[84:85], v204 offset:32768
 v_mfma_f32_16x16x32_bf16 v[24:27], v[120:123], v[132:135], v[24:27]
 ds_read_b64_tr_b16 v[86:87], v204 offset:36864
 v_mfma_f32_16x16x32_bf16 v[28:31], v[132:135], v[124:127], v[28:31]
 ds_read_b128 v[100:103], v2 offset:8192
 v_mfma_f32_16x16x32_bf16 v[32:35], v[132:135], v[128:131], v[32:35]
 ds_read_b64_tr_b16 v[88:89], v205 offset:32768
 v_mfma_f32_16x16x32_bf16 v[180:183], v[116:119], v[12:15], v[180:183]
 ds_read_b64_tr_b16 v[90:91], v205 offset:36864
 v_mfma_f32_16x16x32_bf16 v[36:39], v[116:119], v[136:139], v[36:39]
 ds_read_b64_tr_b16 v[92:93], v206 offset:32768
 v_mfma_f32_16x16x32_bf16 v[40:43], v[120:123], v[136:139], v[40:43]
 ds_read_b64_tr_b16 v[94:95], v206 offset:36864
 v_mfma_f32_16x16x32_bf16 v[44:47], v[136:139], v[124:127], v[44:47]
 ds_read_b64_tr_b16 v[96:97], v207 offset:32768
 v_mfma_f32_16x16x32_bf16 v[48:51], v[136:139], v[128:131], v[48:51]
 ds_read_b64_tr_b16 v[98:99], v207 offset:36864
 v_mfma_f32_16x16x32_bf16 v[184:187], v[120:123], v[12:15], v[184:187]
 ds_read_b128 v[104:107], v2 offset:10240
 v_mfma_f32_16x16x32_bf16 v[52:55], v[116:119], v[140:143], v[52:55]
 ds_read_b128 v[108:111], v2 offset:12288
 v_mfma_f32_16x16x32_bf16 v[56:59], v[120:123], v[140:143], v[56:59]
 ds_read_b128 v[112:115], v2 offset:14336
 v_mfma_f32_16x16x32_bf16 v[60:63], v[140:143], v[124:127], v[60:63]
 v_mfma_f32_16x16x32_bf16 v[64:67], v[140:143], v[128:131], v[64:67]
 v_mfma_f32_16x16x32_bf16 v[188:191], v[12:15], v[124:127], v[188:191]
 v_mfma_f32_16x16x32_bf16 v[68:71], v[116:119], v[144:147], v[68:71]
 v_mfma_f32_16x16x32_bf16 v[72:75], v[120:123], v[144:147], v[72:75]
 v_mfma_f32_16x16x32_bf16 v[76:79], v[144:147], v[124:127], v[76:79]
 v_mfma_f32_16x16x32_bf16 v[80:83], v[144:147], v[128:131], v[80:83]
 v_mfma_f32_16x16x32_bf16 v[192:195], v[12:15], v[128:131], v[192:195]
 s_waitcnt lgkmcnt(0)
 buffer_load_dword v17, v18, s[16:19], s42 offen
 s_mov_b64 exec, 0xffff
 s_add_u32 s23, s43, 0x12c000
 buffer_load_dword v17, v19, s[8:11], s23 offen
 s_add_u32 s23, s48, 768
 buffer_load_dword v17, v212, s[44:47], s23 offen
 s_mov_b64 exec, -1
 s_cmp_lg_u32 s21, 2
 s_cbranch_scc1 C0_mx_ns2
 buffer_store_dwordx4 v[84:87], v16, s[4:7], s26 offen offset:0 sc1
 buffer_store_dwordx4 v[88:91], v16, s[4:7], s26 offen offset:1024 sc1
 buffer_store_dwordx4 v[92:95], v16, s[4:7], s26 offen offset:2048 sc1
 buffer_store_dwordx4 v[96:99], v16, s[4:7], s26 offen offset:3072 sc1
C0_mx_ns2:
 v_mfma_f32_16x16x32_bf16 v[20:23], v[84:87], v[100:103], v[20:23]
 ds_read_b64_tr_b16 v[116:117], v204 offset:49152
 v_mfma_f32_16x16x32_bf16 v[24:27], v[88:91], v[100:103], v[24:27]
 ds_read_b64_tr_b16 v[118:119], v204 offset:53248
 v_mfma_f32_16x16x32_bf16 v[28:31], v[100:103], v[92:95], v[28:31]
 ds_read_b128 v[132:135], v3 offset:8192
 v_mfma_f32_16x16x32_bf16 v[32:35], v[100:103], v[96:99], v[32:35]
 ds_read_b64_tr_b16 v[120:121], v205 offset:49152
 v_mfma_f32_16x16x32_bf16 v[180:183], v[84:87], v[12:15], v[180:183]
 ds_read_b64_tr_b16 v[122:123], v205 offset:53248
 v_mfma_f32_16x16x32_bf16 v[36:39], v[84:87], v[104:107], v[36:39]
 ds_read_b64_tr_b16 v[124:125], v206 offset:49152
 v_mfma_f32_16x16x32_bf16 v[40:43], v[88:91], v[104:107], v[40:43]
 ds_read_b64_tr_b16 v[126:127], v206 offset:53248
 v_mfma_f32_16x16x32_bf16 v[44:47], v[104:107], v[92:95], v[44:47]
 ds_read_b64_tr_b16 v[128:129], v207 offset:49152
 v_mfma_f32_16x16x32_bf16 v[48:51], v[104:107], v[96:99], v[48:51]
 ds_read_b64_tr_b16 v[130:131], v207 offset:53248
 v_mfma_f32_16x16x32_bf16 v[184:187], v[88:91], v[12:15], v[184:187]
 ds_read_b128 v[136:139], v3 offset:10240
 v_mfma_f32_16x16x32_bf16 v[52:55], v[84:87], v[108:111], v[52:55]
 ds_read_b128 v[140:143], v3 offset:12288
 v_mfma_f32_16x16x32_bf16 v[56:59], v[88:91], v[108:111], v[56:59]
 ds_read_b128 v[144:147], v3 offset:14336
 v_mfma_f32_16x16x32_bf16 v[60:63], v[108:111], v[92:95], v[60:63]
 v_mfma_f32_16x16x32_bf16 v[64:67], v[108:111], v[96:99], v[64:67]
 v_mfma_f32_16x16x32_bf16 v[188:191], v[12:15], v[92:95], v[188:191]
 v_mfma_f32_16x16x32_bf16 v[68:71], v[84:87], v[112:115], v[68:71]
 v_mfma_f32_16x16x32_bf16 v[72:75], v[88:91], v[112:115], v[72:75]
 v_mfma_f32_16x16x32_bf16 v[76:79], v[112:115], v[92:95], v[76:79]
 v_mfma_f32_16x16x32_bf16 v[80:83], v[112:115], v[96:99], v[80:83]
 v_mfma_f32_16x16x32_bf16 v[192:195], v[12:15], v[96:99], v[192:195]
 s_waitcnt lgkmcnt(0)
 s_cmp_lg_u32 s21, 3
 s_cbranch_scc1 C0_mx_ns3
 buffer_store_dwordx4 v[116:119], v16, s[4:7], s26 offen offset:0 sc1
 buffer_store_dwordx4 v[120:123], v16, s[4:7], s26 offen offset:1024 sc1
 buffer_store_dwordx4 v[124:127], v16, s[4:7], s26 offen offset:2048 sc1
 buffer_store_dwordx4 v[128:131], v16, s[4:7], s26 offen offset:3072 sc1
C0_mx_ns3:
 v_mfma_f32_16x16x32_bf16 v[20:23], v[116:119], v[132:135], v[20:23]
 s_barrier
 ds_read_b64_tr_b16 v[84:85], v208 offset:0
 v_mfma_f32_16x16x32_bf16 v[24:27], v[120:123], v[132:135], v[24:27]
 ds_read_b64_tr_b16 v[86:87], v208 offset:4096
 v_mfma_f32_16x16x32_bf16 v[28:31], v[132:135], v[124:127], v[28:31]
 ds_read_b128 v[100:103], v2 offset:16384
 v_mfma_f32_16x16x32_bf16 v[32:35], v[132:135], v[128:131], v[32:35]
 ds_read_b64_tr_b16 v[88:89], v209 offset:0
 v_mfma_f32_16x16x32_bf16 v[180:183], v[116:119], v[12:15], v[180:183]
 ds_read_b64_tr_b16 v[90:91], v209 offset:4096
 v_mfma_f32_16x16x32_bf16 v[36:39], v[116:119], v[136:139], v[36:39]
 ds_read_b64_tr_b16 v[92:93], v210 offset:0
 v_mfma_f32_16x16x32_bf16 v[40:43], v[120:123], v[136:139], v[40:43]
 ds_read_b64_tr_b16 v[94:95], v210 offset:4096
 v_mfma_f32_16x16x32_bf16 v[44:47], v[136:139], v[124:127], v[44:47]
 ds_read_b64_tr_b16 v[96:97], v211 offset:0
 v_mfma_f32_16x16x32_bf16 v[48:51], v[136:139], v[128:131], v[48:51]
 ds_read_b64_tr_b16 v[98:99], v211 offset:4096
 v_mfma_f32_16x16x32_bf16 v[184:187], v[120:123], v[12:15], v[184:187]
 ds_read_b128 v[104:107], v2 offset:18432
 v_mfma_f32_16x16x32_bf16 v[52:55], v[116:119], v[140:143], v[52:55]
 ds_read_b128 v[108:111], v2 offset:20480
 v_mfma_f32_16x16x32_bf16 v[56:59], v[120:123], v[140:143], v[56:59]
 ds_read_b128 v[112:115], v2 offset:22528
 v_mfma_f32_16x16x32_bf16 v[60:63], v[140:143], v[124:127], v[60:63]
 v_mfma_f32_16x16x32_bf16 v[64:67], v[140:143], v[128:131], v[64:67]
 v_mfma_f32_16x16x32_bf16 v[188:191], v[12:15], v[124:127], v[188:191]
 v_mfma_f32_16x16x32_bf16 v[68:71], v[116:119], v[144:147], v[68:71]
 v_mfma_f32_16x16x32_bf16 v[72:75], v[120:123], v[144:147], v[72:75]
 v_mfma_f32_16x16x32_bf16 v[76:79], v[144:147], v[124:127], v[76:79]
 v_mfma_f32_16x16x32_bf16 v[80:83], v[144:147], v[128:131], v[80:83]
 v_mfma_f32_16x16x32_bf16 v[192:195], v[12:15], v[128:131], v[192:195]
 s_waitcnt lgkmcnt(0)
 s_cmp_lg_u32 s21, 4
 s_cbranch_scc1 C0_mx_ns4
 buffer_store_dwordx4 v[84:87], v16, s[4:7], s26 offen offset:0 sc1
 buffer_store_dwordx4 v[88:91], v16, s[4:7], s26 offen offset:1024 sc1
 buffer_store_dwordx4 v[92:95], v16, s[4:7], s26 offen offset:2048 sc1
 buffer_store_dwordx4 v[96:99], v16, s[4:7], s26 offen offset:3072 sc1
C0_mx_ns4:
 v_mfma_f32_16x16x32_bf16 v[20:23], v[84:87], v[100:103], v[20:23]
 ds_read_b64_tr_b16 v[116:117], v208 offset:16384
 v_mfma_f32_16x16x32_bf16 v[24:27], v[88:91], v[100:103], v[24:27]
 ds_read_b64_tr_b16 v[118:119], v208 offset:20480
 v_mfma_f32_16x16x32_bf16 v[28:31], v[100:103], v[92:95], v[28:31]
 ds_read_b128 v[132:135], v3 offset:16384
 v_mfma_f32_16x16x32_bf16 v[32:35], v[100:103], v[96:99], v[32:35]
 ds_read_b64_tr_b16 v[120:121], v209 offset:16384
 v_mfma_f32_16x16x32_bf16 v[180:183], v[84:87], v[12:15], v[180:183]
 ds_read_b64_tr_b16 v[122:123], v209 offset:20480
 v_mfma_f32_16x16x32_bf16 v[36:39], v[84:87], v[104:107], v[36:39]
 ds_read_b64_tr_b16 v[124:125], v210 offset:16384
 v_mfma_f32_16x16x32_bf16 v[40:43], v[88:91], v[104:107], v[40:43]
 ds_read_b64_tr_b16 v[126:127], v210 offset:20480
 v_mfma_f32_16x16x32_bf16 v[44:47], v[104:107], v[92:95], v[44:47]
 ds_read_b64_tr_b16 v[128:129], v211 offset:16384
 v_mfma_f32_16x16x32_bf16 v[48:51], v[104:107], v[96:99], v[48:51]
 ds_read_b64_tr_b16 v[130:131], v211 offset:20480
 v_mfma_f32_16x16x32_bf16 v[184:187], v[88:91], v[12:15], v[184:187]
 ds_read_b128 v[136:139], v3 offset:18432
 v_mfma_f32_16x16x32_bf16 v[52:55], v[84:87], v[108:111], v[52:55]
 ds_read_b128 v[140:143], v3 offset:20480
 v_mfma_f32_16x16x32_bf16 v[56:59], v[88:91], v[108:111], v[56:59]
 ds_read_b128 v[144:147], v3 offset:22528
 v_mfma_f32_16x16x32_bf16 v[60:63], v[108:111], v[92:95], v[60:63]
 v_mfma_f32_16x16x32_bf16 v[64:67], v[108:111], v[96:99], v[64:67]
 v_mfma_f32_16x16x32_bf16 v[188:191], v[12:15], v[92:95], v[188:191]
 v_mfma_f32_16x16x32_bf16 v[68:71], v[84:87], v[112:115], v[68:71]
 v_mfma_f32_16x16x32_bf16 v[72:75], v[88:91], v[112:115], v[72:75]
 v_mfma_f32_16x16x32_bf16 v[76:79], v[112:115], v[92:95], v[76:79]
 v_mfma_f32_16x16x32_bf16 v[80:83], v[112:115], v[96:99], v[80:83]
 v_mfma_f32_16x16x32_bf16 v[192:195], v[12:15], v[96:99], v[192:195]
 s_waitcnt lgkmcnt(0)
 s_cmp_lg_u32 s21, 5
 s_cbranch_scc1 C0_mx_ns5
 buffer_store_dwordx4 v[116:119], v16, s[4:7], s26 offen offset:0 sc1
 buffer_store_dwordx4 v[120:123], v16, s[4:7], s26 offen offset:1024 sc1
 buffer_store_dwordx4 v[124:127], v16, s[4:7], s26 offen offset:2048 sc1
 buffer_store_dwordx4 v[128:131], v16, s[4:7], s26 offen offset:3072 sc1
C0_mx_ns5:
 v_mfma_f32_16x16x32_bf16 v[20:23], v[116:119], v[132:135], v[20:23]
 s_barrier
 ds_read_b64_tr_b16 v[84:85], v204 offset:0
 v_mfma_f32_16x16x32_bf16 v[24:27], v[120:123], v[132:135], v[24:27]
 ds_read_b64_tr_b16 v[86:87], v204 offset:4096
 v_mfma_f32_16x16x32_bf16 v[28:31], v[132:135], v[124:127], v[28:31]
 ds_read_b128 v[100:103], v2 offset:24576
 v_mfma_f32_16x16x32_bf16 v[32:35], v[132:135], v[128:131], v[32:35]
 ds_read_b64_tr_b16 v[88:89], v205 offset:0
 v_mfma_f32_16x16x32_bf16 v[180:183], v[116:119], v[12:15], v[180:183]
 ds_read_b64_tr_b16 v[90:91], v205 offset:4096
 v_mfma_f32_16x16x32_bf16 v[36:39], v[116:119], v[136:139], v[36:39]
 ds_read_b64_tr_b16 v[92:93], v206 offset:0
 v_mfma_f32_16x16x32_bf16 v[40:43], v[120:123], v[136:139], v[40:43]
 ds_read_b64_tr_b16 v[94:95], v206 offset:4096
 v_mfma_f32_16x16x32_bf16 v[44:47], v[136:139], v[124:127], v[44:47]
 ds_read_b64_tr_b16 v[96:97], v207 offset:0
 v_mfma_f32_16x16x32_bf16 v[48:51], v[136:139], v[128:131], v[48:51]
 ds_read_b64_tr_b16 v[98:99], v207 offset:4096
 v_mfma_f32_16x16x32_bf16 v[184:187], v[120:123], v[12:15], v[184:187]
 ds_read_b128 v[104:107], v2 offset:26624
 v_mfma_f32_16x16x32_bf16 v[52:55], v[116:119], v[140:143], v[52:55]
 ds_read_b128 v[108:111], v2 offset:28672
 v_mfma_f32_16x16x32_bf16 v[56:59], v[120:123], v[140:143], v[56:59]
 ds_read_b128 v[112:115], v2 offset:30720
 v_mfma_f32_16x16x32_bf16 v[60:63], v[140:143], v[124:127], v[60:63]
 v_mfma_f32_16x16x32_bf16 v[64:67], v[140:143], v[128:131], v[64:67]
 v_mfma_f32_16x16x32_bf16 v[188:191], v[12:15], v[124:127], v[188:191]
 v_mfma_f32_16x16x32_bf16 v[68:71], v[116:119], v[144:147], v[68:71]
 v_mfma_f32_16x16x32_bf16 v[72:75], v[120:123], v[144:147], v[72:75]
 v_mfma_f32_16x16x32_bf16 v[76:79], v[144:147], v[124:127], v[76:79]
 v_mfma_f32_16x16x32_bf16 v[80:83], v[144:147], v[128:131], v[80:83]
 v_mfma_f32_16x16x32_bf16 v[192:195], v[12:15], v[128:131], v[192:195]
 s_waitcnt lgkmcnt(0)
 s_mov_b64 exec, 0xffff
 s_add_u32 s23, s43, 0x1a4000
 buffer_load_dword v17, v19, s[8:11], s23 offen
 s_mov_b64 exec, -1
 s_cmp_lg_u32 s21, 6
 s_cbranch_scc1 C0_mx_ns6
 buffer_store_dwordx4 v[84:87], v16, s[4:7], s26 offen offset:0 sc1
 buffer_store_dwordx4 v[88:91], v16, s[4:7], s26 offen offset:1024 sc1
 buffer_store_dwordx4 v[92:95], v16, s[4:7], s26 offen offset:2048 sc1
 buffer_store_dwordx4 v[96:99], v16, s[4:7], s26 offen offset:3072 sc1
C0_mx_ns6:
 v_mfma_f32_16x16x32_bf16 v[20:23], v[84:87], v[100:103], v[20:23]
 ds_read_b64_tr_b16 v[116:117], v204 offset:16384
 v_mfma_f32_16x16x32_bf16 v[24:27], v[88:91], v[100:103], v[24:27]
 ds_read_b64_tr_b16 v[118:119], v204 offset:20480
 v_mfma_f32_16x16x32_bf16 v[28:31], v[100:103], v[92:95], v[28:31]
 ds_read_b128 v[132:135], v3 offset:24576
 v_mfma_f32_16x16x32_bf16 v[32:35], v[100:103], v[96:99], v[32:35]
 ds_read_b64_tr_b16 v[120:121], v205 offset:16384
 v_mfma_f32_16x16x32_bf16 v[180:183], v[84:87], v[12:15], v[180:183]
 ds_read_b64_tr_b16 v[122:123], v205 offset:20480
 v_mfma_f32_16x16x32_bf16 v[36:39], v[84:87], v[104:107], v[36:39]
 ds_read_b64_tr_b16 v[124:125], v206 offset:16384
 v_mfma_f32_16x16x32_bf16 v[40:43], v[88:91], v[104:107], v[40:43]
 ds_read_b64_tr_b16 v[126:127], v206 offset:20480
 v_mfma_f32_16x16x32_bf16 v[44:47], v[104:107], v[92:95], v[44:47]
 ds_read_b64_tr_b16 v[128:129], v207 offset:16384
 v_mfma_f32_16x16x32_bf16 v[48:51], v[104:107], v[96:99], v[48:51]
 ds_read_b64_tr_b16 v[130:131], v207 offset:20480
 v_mfma_f32_16x16x32_bf16 v[184:187], v[88:91], v[12:15], v[184:187]
 ds_read_b128 v[136:139], v3 offset:26624
 v_mfma_f32_16x16x32_bf16 v[52:55], v[84:87], v[108:111], v[52:55]
 ds_read_b128 v[140:143], v3 offset:28672
 v_mfma_f32_16x16x32_bf16 v[56:59], v[88:91], v[108:111], v[56:59]
 ds_read_b128 v[144:147], v3 offset:30720
 v_mfma_f32_16x16x32_bf16 v[60:63], v[108:111], v[92:95], v[60:63]
 v_mfma_f32_16x16x32_bf16 v[64:67], v[108:111], v[96:99], v[64:67]
 v_mfma_f32_16x16x32_bf16 v[188:191], v[12:15], v[92:95], v[188:191]
 v_mfma_f32_16x16x32_bf16 v[68:71], v[84:87], v[112:115], v[68:71]
 v_mfma_f32_16x16x32_bf16 v[72:75], v[88:91], v[112:115], v[72:75]
 v_mfma_f32_16x16x32_bf16 v[76:79], v[112:115], v[92:95], v[76:79]
 v_mfma_f32_16x16x32_bf16 v[80:83], v[112:115], v[96:99], v[80:83]
 v_mfma_f32_16x16x32_bf16 v[192:195], v[12:15], v[96:99], v[192:195]
 s_waitcnt lgkmcnt(0)
 s_cmp_lg_u32 s21, 7
 s_cbranch_scc1 C0_mx_ns7
 buffer_store_dwordx4 v[116:119], v16, s[4:7], s26 offen offset:0 sc1
 buffer_store_dwordx4 v[120:123], v16, s[4:7], s26 offen offset:1024 sc1
 buffer_store_dwordx4 v[124:127], v16, s[4:7], s26 offen offset:2048 sc1
 buffer_store_dwordx4 v[128:131], v16, s[4:7], s26 offen offset:3072 sc1
C0_mx_ns7:
 v_mfma_f32_16x16x32_bf16 v[20:23], v[116:119], v[132:135], v[20:23]
 s_barrier
 ds_read_b64_tr_b16 v[84:85], v204 offset:32768
 v_mfma_f32_16x16x32_bf16 v[24:27], v[120:123], v[132:135], v[24:27]
 ds_read_b64_tr_b16 v[86:87], v204 offset:36864
 v_mfma_f32_16x16x32_bf16 v[28:31], v[132:135], v[124:127], v[28:31]
 ds_read_b128 v[100:103], v2 offset:0
 v_mfma_f32_16x16x32_bf16 v[32:35], v[132:135], v[128:131], v[32:35]
 ds_read_b64_tr_b16 v[88:89], v205 offset:32768
 v_mfma_f32_16x16x32_bf16 v[180:183], v[116:119], v[12:15], v[180:183]
 ds_read_b64_tr_b16 v[90:91], v205 offset:36864
 v_mfma_f32_16x16x32_bf16 v[36:39], v[116:119], v[136:139], v[36:39]
 ds_read_b64_tr_b16 v[92:93], v206 offset:32768
 v_mfma_f32_16x16x32_bf16 v[40:43], v[120:123], v[136:139], v[40:43]
 ds_read_b64_tr_b16 v[94:95], v206 offset:36864
 v_mfma_f32_16x16x32_bf16 v[44:47], v[136:139], v[124:127], v[44:47]
 ds_read_b64_tr_b16 v[96:97], v207 offset:32768
 v_mfma_f32_16x16x32_bf16 v[48:51], v[136:139], v[128:131], v[48:51]
 ds_read_b64_tr_b16 v[98:99], v207 offset:36864
 v_mfma_f32_16x16x32_bf16 v[184:187], v[120:123], v[12:15], v[184:187]
 ds_read_b128 v[104:107], v2 offset:2048
 v_mfma_f32_16x16x32_bf16 v[52:55], v[116:119], v[140:143], v[52:55]
 ds_read_b128 v[108:111], v2 offset:4096
 v_mfma_f32_16x16x32_bf16 v[56:59], v[120:123], v[140:143], v[56:59]
 ds_read_b128 v[112:115], v2 offset:6144
 v_mfma_f32_16x16x32_bf16 v[60:63], v[140:143], v[124:127], v[60:63]
 v_mfma_f32_16x16x32_bf16 v[64:67], v[140:143], v[128:131], v[64:67]
 v_mfma_f32_16x16x32_bf16 v[188:191], v[12:15], v[124:127], v[188:191]
 v_mfma_f32_16x16x32_bf16 v[68:71], v[116:119], v[144:147], v[68:71]
 v_mfma_f32_16x16x32_bf16 v[72:75], v[120:123], v[144:147], v[72:75]
 v_mfma_f32_16x16x32_bf16 v[76:79], v[144:147], v[124:127], v[76:79]
 v_mfma_f32_16x16x32_bf16 v[80:83], v[144:147], v[128:131], v[80:83]
 v_mfma_f32_16x16x32_bf16 v[192:195], v[12:15], v[128:131], v[192:195]
 s_waitcnt lgkmcnt(0)
 s_cmp_lg_u32 s21, 8
 s_cbranch_scc1 C0_mx_ns8
 buffer_store_dwordx4 v[84:87], v16, s[4:7], s26 offen offset:0 sc1
 buffer_store_dwordx4 v[88:91], v16, s[4:7], s26 offen offset:1024 sc1
 buffer_store_dwordx4 v[92:95], v16, s[4:7], s26 offen offset:2048 sc1
 buffer_store_dwordx4 v[96:99], v16, s[4:7], s26 offen offset:3072 sc1
C0_mx_ns8:
 v_mfma_f32_16x16x32_bf16 v[20:23], v[84:87], v[100:103], v[20:23]
 ds_read_b64_tr_b16 v[116:117], v204 offset:49152
 v_mfma_f32_16x16x32_bf16 v[24:27], v[88:91], v[100:103], v[24:27]
 ds_read_b64_tr_b16 v[118:119], v204 offset:53248
 v_mfma_f32_16x16x32_bf16 v[28:31], v[100:103], v[92:95], v[28:31]
 ds_read_b128 v[132:135], v3 offset:0
 v_mfma_f32_16x16x32_bf16 v[32:35], v[100:103], v[96:99], v[32:35]
 ds_read_b64_tr_b16 v[120:121], v205 offset:49152
 v_mfma_f32_16x16x32_bf16 v[180:183], v[84:87], v[12:15], v[180:183]
 ds_read_b64_tr_b16 v[122:123], v205 offset:53248
 v_mfma_f32_16x16x32_bf16 v[36:39], v[84:87], v[104:107], v[36:39]
 ds_read_b64_tr_b16 v[124:125], v206 offset:49152
 v_mfma_f32_16x16x32_bf16 v[40:43], v[88:91], v[104:107], v[40:43]
 ds_read_b64_tr_b16 v[126:127], v206 offset:53248
 v_mfma_f32_16x16x32_bf16 v[44:47], v[104:107], v[92:95], v[44:47]
 ds_read_b64_tr_b16 v[128:129], v207 offset:49152
 v_mfma_f32_16x16x32_bf16 v[48:51], v[104:107], v[96:99], v[48:51]
 ds_read_b64_tr_b16 v[130:131], v207 offset:53248
 v_mfma_f32_16x16x32_bf16 v[184:187], v[88:91], v[12:15], v[184:187]
 ds_read_b128 v[136:139], v3 offset:2048
 v_mfma_f32_16x16x32_bf16 v[52:55], v[84:87], v[108:111], v[52:55]
 ds_read_b128 v[140:143], v3 offset:4096
 v_mfma_f32_16x16x32_bf16 v[56:59], v[88:91], v[108:111], v[56:59]
 ds_read_b128 v[144:147], v3 offset:6144
 v_mfma_f32_16x16x32_bf16 v[60:63], v[108:111], v[92:95], v[60:63]
 v_mfma_f32_16x16x32_bf16 v[64:67], v[108:111], v[96:99], v[64:67]
 v_mfma_f32_16x16x32_bf16 v[188:191], v[12:15], v[92:95], v[188:191]
 v_mfma_f32_16x16x32_bf16 v[68:71], v[84:87], v[112:115], v[68:71]
 v_mfma_f32_16x16x32_bf16 v[72:75], v[88:91], v[112:115], v[72:75]
 v_mfma_f32_16x16x32_bf16 v[76:79], v[112:115], v[92:95], v[76:79]
 v_mfma_f32_16x16x32_bf16 v[80:83], v[112:115], v[96:99], v[80:83]
 v_mfma_f32_16x16x32_bf16 v[192:195], v[12:15], v[96:99], v[192:195]
 s_waitcnt lgkmcnt(0)
 s_cmp_lg_u32 s21, 9
 s_cbranch_scc1 C0_mx_ns9
 buffer_store_dwordx4 v[116:119], v16, s[4:7], s26 offen offset:0 sc1
 buffer_store_dwordx4 v[120:123], v16, s[4:7], s26 offen offset:1024 sc1
 buffer_store_dwordx4 v[124:127], v16, s[4:7], s26 offen offset:2048 sc1
 buffer_store_dwordx4 v[128:131], v16, s[4:7], s26 offen offset:3072 sc1
C0_mx_ns9:
 v_mfma_f32_16x16x32_bf16 v[20:23], v[116:119], v[132:135], v[20:23]
 s_barrier
 ds_read_b64_tr_b16 v[84:85], v208 offset:0
 v_mfma_f32_16x16x32_bf16 v[24:27], v[120:123], v[132:135], v[24:27]
 ds_read_b64_tr_b16 v[86:87], v208 offset:4096
 v_mfma_f32_16x16x32_bf16 v[28:31], v[132:135], v[124:127], v[28:31]
 ds_read_b128 v[100:103], v2 offset:8192
 v_mfma_f32_16x16x32_bf16 v[32:35], v[132:135], v[128:131], v[32:35]
 ds_read_b64_tr_b16 v[88:89], v209 offset:0
 v_mfma_f32_16x16x32_bf16 v[180:183], v[116:119], v[12:15], v[180:183]
 ds_read_b64_tr_b16 v[90:91], v209 offset:4096
 v_mfma_f32_16x16x32_bf16 v[36:39], v[116:119], v[136:139], v[36:39]
 ds_read_b64_tr_b16 v[92:93], v210 offset:0
 v_mfma_f32_16x16x32_bf16 v[40:43], v[120:123], v[136:139], v[40:43]
 ds_read_b64_tr_b16 v[94:95], v210 offset:4096
 v_mfma_f32_16x16x32_bf16 v[44:47], v[136:139], v[124:127], v[44:47]
 ds_read_b64_tr_b16 v[96:97], v211 offset:0
 v_mfma_f32_16x16x32_bf16 v[48:51], v[136:139], v[128:131], v[48:51]
 ds_read_b64_tr_b16 v[98:99], v211 offset:4096
 v_mfma_f32_16x16x32_bf16 v[184:187], v[120:123], v[12:15], v[184:187]
 ds_read_b128 v[104:107], v2 offset:10240
 v_mfma_f32_16x16x32_bf16 v[52:55], v[116:119], v[140:143], v[52:55]
 ds_read_b128 v[108:111], v2 offset:12288
 v_mfma_f32_16x16x32_bf16 v[56:59], v[120:123], v[140:143], v[56:59]
 ds_read_b128 v[112:115], v2 offset:14336
 v_mfma_f32_16x16x32_bf16 v[60:63], v[140:143], v[124:127], v[60:63]
 v_mfma_f32_16x16x32_bf16 v[64:67], v[140:143], v[128:131], v[64:67]
 v_mfma_f32_16x16x32_bf16 v[188:191], v[12:15], v[124:127], v[188:191]
 v_mfma_f32_16x16x32_bf16 v[68:71], v[116:119], v[144:147], v[68:71]
 v_mfma_f32_16x16x32_bf16 v[72:75], v[120:123], v[144:147], v[72:75]
 v_mfma_f32_16x16x32_bf16 v[76:79], v[144:147], v[124:127], v[76:79]
 v_mfma_f32_16x16x32_bf16 v[80:83], v[144:147], v[128:131], v[80:83]
 v_mfma_f32_16x16x32_bf16 v[192:195], v[12:15], v[128:131], v[192:195]
 s_waitcnt lgkmcnt(0)
 s_mov_b64 exec, 0xffff
 s_add_u32 s23, s43, 0x21c000
 buffer_load_dword v17, v19, s[8:11], s23 offen
 s_mov_b64 exec, -1
 s_cmp_lg_u32 s21, 10
 s_cbranch_scc1 C0_mx_ns10
 buffer_store_dwordx4 v[84:87], v16, s[4:7], s26 offen offset:0 sc1
 buffer_store_dwordx4 v[88:91], v16, s[4:7], s26 offen offset:1024 sc1
 buffer_store_dwordx4 v[92:95], v16, s[4:7], s26 offen offset:2048 sc1
 buffer_store_dwordx4 v[96:99], v16, s[4:7], s26 offen offset:3072 sc1
C0_mx_ns10:
 v_mfma_f32_16x16x32_bf16 v[20:23], v[84:87], v[100:103], v[20:23]
 ds_read_b64_tr_b16 v[116:117], v208 offset:16384
 v_mfma_f32_16x16x32_bf16 v[24:27], v[88:91], v[100:103], v[24:27]
 ds_read_b64_tr_b16 v[118:119], v208 offset:20480
 v_mfma_f32_16x16x32_bf16 v[28:31], v[100:103], v[92:95], v[28:31]
 ds_read_b128 v[132:135], v3 offset:8192
 v_mfma_f32_16x16x32_bf16 v[32:35], v[100:103], v[96:99], v[32:35]
 ds_read_b64_tr_b16 v[120:121], v209 offset:16384
 v_mfma_f32_16x16x32_bf16 v[180:183], v[84:87], v[12:15], v[180:183]
 ds_read_b64_tr_b16 v[122:123], v209 offset:20480
 v_mfma_f32_16x16x32_bf16 v[36:39], v[84:87], v[104:107], v[36:39]
 ds_read_b64_tr_b16 v[124:125], v210 offset:16384
 v_mfma_f32_16x16x32_bf16 v[40:43], v[88:91], v[104:107], v[40:43]
 ds_read_b64_tr_b16 v[126:127], v210 offset:20480
 v_mfma_f32_16x16x32_bf16 v[44:47], v[104:107], v[92:95], v[44:47]
 ds_read_b64_tr_b16 v[128:129], v211 offset:16384
 v_mfma_f32_16x16x32_bf16 v[48:51], v[104:107], v[96:99], v[48:51]
 ds_read_b64_tr_b16 v[130:131], v211 offset:20480
 v_mfma_f32_16x16x32_bf16 v[184:187], v[88:91], v[12:15], v[184:187]
 ds_read_b128 v[136:139], v3 offset:10240
 v_mfma_f32_16x16x32_bf16 v[52:55], v[84:87], v[108:111], v[52:55]
 ds_read_b128 v[140:143], v3 offset:12288
 v_mfma_f32_16x16x32_bf16 v[56:59], v[88:91], v[108:111], v[56:59]
 ds_read_b128 v[144:147], v3 offset:14336
 v_mfma_f32_16x16x32_bf16 v[60:63], v[108:111], v[92:95], v[60:63]
 v_mfma_f32_16x16x32_bf16 v[64:67], v[108:111], v[96:99], v[64:67]
 v_mfma_f32_16x16x32_bf16 v[188:191], v[12:15], v[92:95], v[188:191]
 v_mfma_f32_16x16x32_bf16 v[68:71], v[84:87], v[112:115], v[68:71]
 v_mfma_f32_16x16x32_bf16 v[72:75], v[88:91], v[112:115], v[72:75]
 v_mfma_f32_16x16x32_bf16 v[76:79], v[112:115], v[92:95], v[76:79]
 v_mfma_f32_16x16x32_bf16 v[80:83], v[112:115], v[96:99], v[80:83]
 v_mfma_f32_16x16x32_bf16 v[192:195], v[12:15], v[96:99], v[192:195]
 s_waitcnt lgkmcnt(0)
 s_cmp_lg_u32 s21, 11
 s_cbranch_scc1 C0_mx_ns11
 buffer_store_dwordx4 v[116:119], v16, s[4:7], s26 offen offset:0 sc1
 buffer_store_dwordx4 v[120:123], v16, s[4:7], s26 offen offset:1024 sc1
 buffer_store_dwordx4 v[124:127], v16, s[4:7], s26 offen offset:2048 sc1
 buffer_store_dwordx4 v[128:131], v16, s[4:7], s26 offen offset:3072 sc1
C0_mx_ns11:
 v_mfma_f32_16x16x32_bf16 v[20:23], v[116:119], v[132:135], v[20:23]
 s_barrier
 ds_read_b64_tr_b16 v[84:85], v204 offset:0
 v_mfma_f32_16x16x32_bf16 v[24:27], v[120:123], v[132:135], v[24:27]
 ds_read_b64_tr_b16 v[86:87], v204 offset:4096
 v_mfma_f32_16x16x32_bf16 v[28:31], v[132:135], v[124:127], v[28:31]
 ds_read_b128 v[100:103], v2 offset:16384
 v_mfma_f32_16x16x32_bf16 v[32:35], v[132:135], v[128:131], v[32:35]
 ds_read_b64_tr_b16 v[88:89], v205 offset:0
 v_mfma_f32_16x16x32_bf16 v[180:183], v[116:119], v[12:15], v[180:183]
 ds_read_b64_tr_b16 v[90:91], v205 offset:4096
 v_mfma_f32_16x16x32_bf16 v[36:39], v[116:119], v[136:139], v[36:39]
 ds_read_b64_tr_b16 v[92:93], v206 offset:0
 v_mfma_f32_16x16x32_bf16 v[40:43], v[120:123], v[136:139], v[40:43]
 ds_read_b64_tr_b16 v[94:95], v206 offset:4096
 v_mfma_f32_16x16x32_bf16 v[44:47], v[136:139], v[124:127], v[44:47]
 ds_read_b64_tr_b16 v[96:97], v207 offset:0
 v_mfma_f32_16x16x32_bf16 v[48:51], v[136:139], v[128:131], v[48:51]
 ds_read_b64_tr_b16 v[98:99], v207 offset:4096
 v_mfma_f32_16x16x32_bf16 v[184:187], v[120:123], v[12:15], v[184:187]
 ds_read_b128 v[104:107], v2 offset:18432
 v_mfma_f32_16x16x32_bf16 v[52:55], v[116:119], v[140:143], v[52:55]
 ds_read_b128 v[108:111], v2 offset:20480
 v_mfma_f32_16x16x32_bf16 v[56:59], v[120:123], v[140:143], v[56:59]
 ds_read_b128 v[112:115], v2 offset:22528
 v_mfma_f32_16x16x32_bf16 v[60:63], v[140:143], v[124:127], v[60:63]
 v_mfma_f32_16x16x32_bf16 v[64:67], v[140:143], v[128:131], v[64:67]
 v_mfma_f32_16x16x32_bf16 v[188:191], v[12:15], v[124:127], v[188:191]
 v_mfma_f32_16x16x32_bf16 v[68:71], v[116:119], v[144:147], v[68:71]
 v_mfma_f32_16x16x32_bf16 v[72:75], v[120:123], v[144:147], v[72:75]
 v_mfma_f32_16x16x32_bf16 v[76:79], v[144:147], v[124:127], v[76:79]
 v_mfma_f32_16x16x32_bf16 v[80:83], v[144:147], v[128:131], v[80:83]
 v_mfma_f32_16x16x32_bf16 v[192:195], v[12:15], v[128:131], v[192:195]
 s_waitcnt lgkmcnt(0)
 s_cmp_lg_u32 s21, 12
 s_cbranch_scc1 C0_mx_ns12
 buffer_store_dwordx4 v[84:87], v16, s[4:7], s26 offen offset:0 sc1
 buffer_store_dwordx4 v[88:91], v16, s[4:7], s26 offen offset:1024 sc1
 buffer_store_dwordx4 v[92:95], v16, s[4:7], s26 offen offset:2048 sc1
 buffer_store_dwordx4 v[96:99], v16, s[4:7], s26 offen offset:3072 sc1
C0_mx_ns12:
 v_mfma_f32_16x16x32_bf16 v[20:23], v[84:87], v[100:103], v[20:23]
 ds_read_b64_tr_b16 v[116:117], v204 offset:16384
 v_mfma_f32_16x16x32_bf16 v[24:27], v[88:91], v[100:103], v[24:27]
 ds_read_b64_tr_b16 v[118:119], v204 offset:20480
 v_mfma_f32_16x16x32_bf16 v[28:31], v[100:103], v[92:95], v[28:31]
 ds_read_b128 v[132:135], v3 offset:16384
 v_mfma_f32_16x16x32_bf16 v[32:35], v[100:103], v[96:99], v[32:35]
 ds_read_b64_tr_b16 v[120:121], v205 offset:16384
 v_mfma_f32_16x16x32_bf16 v[180:183], v[84:87], v[12:15], v[180:183]
 ds_read_b64_tr_b16 v[122:123], v205 offset:20480
 v_mfma_f32_16x16x32_bf16 v[36:39], v[84:87], v[104:107], v[36:39]
 ds_read_b64_tr_b16 v[124:125], v206 offset:16384
 v_mfma_f32_16x16x32_bf16 v[40:43], v[88:91], v[104:107], v[40:43]
 ds_read_b64_tr_b16 v[126:127], v206 offset:20480
 v_mfma_f32_16x16x32_bf16 v[44:47], v[104:107], v[92:95], v[44:47]
 ds_read_b64_tr_b16 v[128:129], v207 offset:16384
 v_mfma_f32_16x16x32_bf16 v[48:51], v[104:107], v[96:99], v[48:51]
 ds_read_b64_tr_b16 v[130:131], v207 offset:20480
 v_mfma_f32_16x16x32_bf16 v[184:187], v[88:91], v[12:15], v[184:187]
 ds_read_b128 v[136:139], v3 offset:18432
 v_mfma_f32_16x16x32_bf16 v[52:55], v[84:87], v[108:111], v[52:55]
 ds_read_b128 v[140:143], v3 offset:20480
 v_mfma_f32_16x16x32_bf16 v[56:59], v[88:91], v[108:111], v[56:59]
 ds_read_b128 v[144:147], v3 offset:22528
 v_mfma_f32_16x16x32_bf16 v[60:63], v[108:111], v[92:95], v[60:63]
 v_mfma_f32_16x16x32_bf16 v[64:67], v[108:111], v[96:99], v[64:67]
 v_mfma_f32_16x16x32_bf16 v[188:191], v[12:15], v[92:95], v[188:191]
 v_mfma_f32_16x16x32_bf16 v[68:71], v[84:87], v[112:115], v[68:71]
 v_mfma_f32_16x16x32_bf16 v[72:75], v[88:91], v[112:115], v[72:75]
 v_mfma_f32_16x16x32_bf16 v[76:79], v[112:115], v[92:95], v[76:79]
 v_mfma_f32_16x16x32_bf16 v[80:83], v[112:115], v[96:99], v[80:83]
 v_mfma_f32_16x16x32_bf16 v[192:195], v[12:15], v[96:99], v[192:195]
 s_waitcnt lgkmcnt(0)
 s_cmp_lg_u32 s21, 13
 s_cbranch_scc1 C0_mx_ns13
 buffer_store_dwordx4 v[116:119], v16, s[4:7], s26 offen offset:0 sc1
 buffer_store_dwordx4 v[120:123], v16, s[4:7], s26 offen offset:1024 sc1
 buffer_store_dwordx4 v[124:127], v16, s[4:7], s26 offen offset:2048 sc1
 buffer_store_dwordx4 v[128:131], v16, s[4:7], s26 offen offset:3072 sc1
C0_mx_ns13:
 v_mfma_f32_16x16x32_bf16 v[20:23], v[116:119], v[132:135], v[20:23]
 s_barrier
 ds_read_b64_tr_b16 v[84:85], v204 offset:32768
 v_mfma_f32_16x16x32_bf16 v[24:27], v[120:123], v[132:135], v[24:27]
 ds_read_b64_tr_b16 v[86:87], v204 offset:36864
 v_mfma_f32_16x16x32_bf16 v[28:31], v[132:135], v[124:127], v[28:31]
 ds_read_b128 v[100:103], v2 offset:24576
 v_mfma_f32_16x16x32_bf16 v[32:35], v[132:135], v[128:131], v[32:35]
 ds_read_b64_tr_b16 v[88:89], v205 offset:32768
 v_mfma_f32_16x16x32_bf16 v[180:183], v[116:119], v[12:15], v[180:183]
 ds_read_b64_tr_b16 v[90:91], v205 offset:36864
 v_mfma_f32_16x16x32_bf16 v[36:39], v[116:119], v[136:139], v[36:39]
 ds_read_b64_tr_b16 v[92:93], v206 offset:32768
 v_mfma_f32_16x16x32_bf16 v[40:43], v[120:123], v[136:139], v[40:43]
 ds_read_b64_tr_b16 v[94:95], v206 offset:36864
 v_mfma_f32_16x16x32_bf16 v[44:47], v[136:139], v[124:127], v[44:47]
 ds_read_b64_tr_b16 v[96:97], v207 offset:32768
 v_mfma_f32_16x16x32_bf16 v[48:51], v[136:139], v[128:131], v[48:51]
 ds_read_b64_tr_b16 v[98:99], v207 offset:36864
 v_mfma_f32_16x16x32_bf16 v[184:187], v[120:123], v[12:15], v[184:187]
 ds_read_b128 v[104:107], v2 offset:26624
 v_mfma_f32_16x16x32_bf16 v[52:55], v[116:119], v[140:143], v[52:55]
 ds_read_b128 v[108:111], v2 offset:28672
 v_mfma_f32_16x16x32_bf16 v[56:59], v[120:123], v[140:143], v[56:59]
 ds_read_b128 v[112:115], v2 offset:30720
 v_mfma_f32_16x16x32_bf16 v[60:63], v[140:143], v[124:127], v[60:63]
 v_mfma_f32_16x16x32_bf16 v[64:67], v[140:143], v[128:131], v[64:67]
 v_mfma_f32_16x16x32_bf16 v[188:191], v[12:15], v[124:127], v[188:191]
 v_mfma_f32_16x16x32_bf16 v[68:71], v[116:119], v[144:147], v[68:71]
 v_mfma_f32_16x16x32_bf16 v[72:75], v[120:123], v[144:147], v[72:75]
 v_mfma_f32_16x16x32_bf16 v[76:79], v[144:147], v[124:127], v[76:79]
 v_mfma_f32_16x16x32_bf16 v[80:83], v[144:147], v[128:131], v[80:83]
 v_mfma_f32_16x16x32_bf16 v[192:195], v[12:15], v[128:131], v[192:195]
 s_waitcnt lgkmcnt(0)
 s_cmp_lg_u32 s21, 14
 s_cbranch_scc1 C0_mx_ns14
 buffer_store_dwordx4 v[84:87], v16, s[4:7], s26 offen offset:0 sc1
 buffer_store_dwordx4 v[88:91], v16, s[4:7], s26 offen offset:1024 sc1
 buffer_store_dwordx4 v[92:95], v16, s[4:7], s26 offen offset:2048 sc1
 buffer_store_dwordx4 v[96:99], v16, s[4:7], s26 offen offset:3072 sc1
C0_mx_ns14:
 v_mfma_f32_16x16x32_bf16 v[20:23], v[84:87], v[100:103], v[20:23]
 ds_read_b64_tr_b16 v[116:117], v204 offset:49152
 v_mfma_f32_16x16x32_bf16 v[24:27], v[88:91], v[100:103], v[24:27]
 ds_read_b64_tr_b16 v[118:119], v204 offset:53248
 v_mfma_f32_16x16x32_bf16 v[28:31], v[100:103], v[92:95], v[28:31]
 ds_read_b128 v[132:135], v3 offset:24576
 v_mfma_f32_16x16x32_bf16 v[32:35], v[100:103], v[96:99], v[32:35]
 ds_read_b64_tr_b16 v[120:121], v205 offset:49152
 v_mfma_f32_16x16x32_bf16 v[180:183], v[84:87], v[12:15], v[180:183]
 ds_read_b64_tr_b16 v[122:123], v205 offset:53248
 v_mfma_f32_16x16x32_bf16 v[36:39], v[84:87], v[104:107], v[36:39]
 ds_read_b64_tr_b16 v[124:125], v206 offset:49152
 v_mfma_f32_16x16x32_bf16 v[40:43], v[88:91], v[104:107], v[40:43]
 ds_read_b64_tr_b16 v[126:127], v206 offset:53248
 v_mfma_f32_16x16x32_bf16 v[44:47], v[104:107], v[92:95], v[44:47]
 ds_read_b64_tr_b16 v[128:129], v207 offset:49152
 v_mfma_f32_16x16x32_bf16 v[48:51], v[104:107], v[96:99], v[48:51]
 ds_read_b64_tr_b16 v[130:131], v207 offset:53248
 v_mfma_f32_16x16x32_bf16 v[184:187], v[88:91], v[12:15], v[184:187]
 ds_read_b128 v[136:139], v3 offset:26624
 v_mfma_f32_16x16x32_bf16 v[52:55], v[84:87], v[108:111], v[52:55]
 ds_read_b128 v[140:143], v3 offset:28672
 v_mfma_f32_16x16x32_bf16 v[56:59], v[88:91], v[108:111], v[56:59]
 ds_read_b128 v[144:147], v3 offset:30720
 v_mfma_f32_16x16x32_bf16 v[60:63], v[108:111], v[92:95], v[60:63]
 v_mfma_f32_16x16x32_bf16 v[64:67], v[108:111], v[96:99], v[64:67]
 v_mfma_f32_16x16x32_bf16 v[188:191], v[12:15], v[92:95], v[188:191]
 v_mfma_f32_16x16x32_bf16 v[68:71], v[84:87], v[112:115], v[68:71]
 v_mfma_f32_16x16x32_bf16 v[72:75], v[88:91], v[112:115], v[72:75]
 v_mfma_f32_16x16x32_bf16 v[76:79], v[112:115], v[92:95], v[76:79]
 v_mfma_f32_16x16x32_bf16 v[80:83], v[112:115], v[96:99], v[80:83]
 v_mfma_f32_16x16x32_bf16 v[192:195], v[12:15], v[96:99], v[192:195]
 s_waitcnt lgkmcnt(0)
 s_cmp_lg_u32 s21, 15
 s_cbranch_scc1 C0_mx_ns15
 buffer_store_dwordx4 v[116:119], v16, s[4:7], s26 offen offset:0 sc1
 buffer_store_dwordx4 v[120:123], v16, s[4:7], s26 offen offset:1024 sc1
 buffer_store_dwordx4 v[124:127], v16, s[4:7], s26 offen offset:2048 sc1
 buffer_store_dwordx4 v[128:131], v16, s[4:7], s26 offen offset:3072 sc1
C0_mx_ns15:
 v_mfma_f32_16x16x32_bf16 v[20:23], v[116:119], v[132:135], v[20:23]
 s_barrier
 ds_read_b64_tr_b16 v[84:85], v208 offset:0
 v_mfma_f32_16x16x32_bf16 v[24:27], v[120:123], v[132:135], v[24:27]
 ds_read_b64_tr_b16 v[86:87], v208 offset:4096
 v_mfma_f32_16x16x32_bf16 v[28:31], v[132:135], v[124:127], v[28:31]
 ds_read_b128 v[100:103], v2 offset:0
 v_mfma_f32_16x16x32_bf16 v[32:35], v[132:135], v[128:131], v[32:35]
 ds_read_b64_tr_b16 v[88:89], v209 offset:0
 v_mfma_f32_16x16x32_bf16 v[180:183], v[116:119], v[12:15], v[180:183]
 ds_read_b64_tr_b16 v[90:91], v209 offset:4096
 v_mfma_f32_16x16x32_bf16 v[36:39], v[116:119], v[136:139], v[36:39]
 ds_read_b64_tr_b16 v[92:93], v210 offset:0
 v_mfma_f32_16x16x32_bf16 v[40:43], v[120:123], v[136:139], v[40:43]
 ds_read_b64_tr_b16 v[94:95], v210 offset:4096
 v_mfma_f32_16x16x32_bf16 v[44:47], v[136:139], v[124:127], v[44:47]
 ds_read_b64_tr_b16 v[96:97], v211 offset:0
 v_mfma_f32_16x16x32_bf16 v[48:51], v[136:139], v[128:131], v[48:51]
 ds_read_b64_tr_b16 v[98:99], v211 offset:4096
 v_mfma_f32_16x16x32_bf16 v[184:187], v[120:123], v[12:15], v[184:187]
 ds_read_b128 v[104:107], v2 offset:2048
 v_mfma_f32_16x16x32_bf16 v[52:55], v[116:119], v[140:143], v[52:55]
 ds_read_b128 v[108:111], v2 offset:4096
 v_mfma_f32_16x16x32_bf16 v[56:59], v[120:123], v[140:143], v[56:59]
 ds_read_b128 v[112:115], v2 offset:6144
 v_mfma_f32_16x16x32_bf16 v[60:63], v[140:143], v[124:127], v[60:63]
 v_mfma_f32_16x16x32_bf16 v[64:67], v[140:143], v[128:131], v[64:67]
 v_mfma_f32_16x16x32_bf16 v[188:191], v[12:15], v[124:127], v[188:191]
 v_mfma_f32_16x16x32_bf16 v[68:71], v[116:119], v[144:147], v[68:71]
 v_mfma_f32_16x16x32_bf16 v[72:75], v[120:123], v[144:147], v[72:75]
 v_mfma_f32_16x16x32_bf16 v[76:79], v[144:147], v[124:127], v[76:79]
 v_mfma_f32_16x16x32_bf16 v[80:83], v[144:147], v[128:131], v[80:83]
 v_mfma_f32_16x16x32_bf16 v[192:195], v[12:15], v[128:131], v[192:195]
 s_waitcnt lgkmcnt(0)
 s_cmp_lg_u32 s21, 16
 s_cbranch_scc1 C0_mx_ns16
 buffer_store_dwordx4 v[84:87], v16, s[4:7], s26 offen offset:0 sc1
 buffer_store_dwordx4 v[88:91], v16, s[4:7], s26 offen offset:1024 sc1
 buffer_store_dwordx4 v[92:95], v16, s[4:7], s26 offen offset:2048 sc1
 buffer_store_dwordx4 v[96:99], v16, s[4:7], s26 offen offset:3072 sc1
C0_mx_ns16:
 v_mfma_f32_16x16x32_bf16 v[20:23], v[84:87], v[100:103], v[20:23]
 ds_read_b64_tr_b16 v[116:117], v208 offset:16384
 v_mfma_f32_16x16x32_bf16 v[24:27], v[88:91], v[100:103], v[24:27]
 ds_read_b64_tr_b16 v[118:119], v208 offset:20480
 v_mfma_f32_16x16x32_bf16 v[28:31], v[100:103], v[92:95], v[28:31]
 ds_read_b128 v[132:135], v3 offset:0
 v_mfma_f32_16x16x32_bf16 v[32:35], v[100:103], v[96:99], v[32:35]
 ds_read_b64_tr_b16 v[120:121], v209 offset:16384
 v_mfma_f32_16x16x32_bf16 v[180:183], v[84:87], v[12:15], v[180:183]
 ds_read_b64_tr_b16 v[122:123], v209 offset:20480
 v_mfma_f32_16x16x32_bf16 v[36:39], v[84:87], v[104:107], v[36:39]
 ds_read_b64_tr_b16 v[124:125], v210 offset:16384
 v_mfma_f32_16x16x32_bf16 v[40:43], v[88:91], v[104:107], v[40:43]
 ds_read_b64_tr_b16 v[126:127], v210 offset:20480
 v_mfma_f32_16x16x32_bf16 v[44:47], v[104:107], v[92:95], v[44:47]
 ds_read_b64_tr_b16 v[128:129], v211 offset:16384
 v_mfma_f32_16x16x32_bf16 v[48:51], v[104:107], v[96:99], v[48:51]
 ds_read_b64_tr_b16 v[130:131], v211 offset:20480
 v_mfma_f32_16x16x32_bf16 v[184:187], v[88:91], v[12:15], v[184:187]
 ds_read_b128 v[136:139], v3 offset:2048
 v_mfma_f32_16x16x32_bf16 v[52:55], v[84:87], v[108:111], v[52:55]
 ds_read_b128 v[140:143], v3 offset:4096
 v_mfma_f32_16x16x32_bf16 v[56:59], v[88:91], v[108:111], v[56:59]
 ds_read_b128 v[144:147], v3 offset:6144
 v_mfma_f32_16x16x32_bf16 v[60:63], v[108:111], v[92:95], v[60:63]
 v_mfma_f32_16x16x32_bf16 v[64:67], v[108:111], v[96:99], v[64:67]
 v_mfma_f32_16x16x32_bf16 v[188:191], v[12:15], v[92:95], v[188:191]
 v_mfma_f32_16x16x32_bf16 v[68:71], v[84:87], v[112:115], v[68:71]
 v_mfma_f32_16x16x32_bf16 v[72:75], v[88:91], v[112:115], v[72:75]
 v_mfma_f32_16x16x32_bf16 v[76:79], v[112:115], v[92:95], v[76:79]
 v_mfma_f32_16x16x32_bf16 v[80:83], v[112:115], v[96:99], v[80:83]
 v_mfma_f32_16x16x32_bf16 v[192:195], v[12:15], v[96:99], v[192:195]
 s_waitcnt lgkmcnt(0)
 s_cmp_lg_u32 s21, 17
 s_cbranch_scc1 C0_mx_ns17
 buffer_store_dwordx4 v[116:119], v16, s[4:7], s26 offen offset:0 sc1
 buffer_store_dwordx4 v[120:123], v16, s[4:7], s26 offen offset:1024 sc1
 buffer_store_dwordx4 v[124:127], v16, s[4:7], s26 offen offset:2048 sc1
 buffer_store_dwordx4 v[128:131], v16, s[4:7], s26 offen offset:3072 sc1
C0_mx_ns17:
 v_mfma_f32_16x16x32_bf16 v[20:23], v[116:119], v[132:135], v[20:23]
 s_barrier
 ds_read_b64_tr_b16 v[84:85], v204 offset:0
 v_mfma_f32_16x16x32_bf16 v[24:27], v[120:123], v[132:135], v[24:27]
 ds_read_b64_tr_b16 v[86:87], v204 offset:4096
 v_mfma_f32_16x16x32_bf16 v[28:31], v[132:135], v[124:127], v[28:31]
 ds_read_b128 v[100:103], v2 offset:8192
 v_mfma_f32_16x16x32_bf16 v[32:35], v[132:135], v[128:131], v[32:35]
 ds_read_b64_tr_b16 v[88:89], v205 offset:0
 v_mfma_f32_16x16x32_bf16 v[180:183], v[116:119], v[12:15], v[180:183]
 ds_read_b64_tr_b16 v[90:91], v205 offset:4096
 v_mfma_f32_16x16x32_bf16 v[36:39], v[116:119], v[136:139], v[36:39]
 ds_read_b64_tr_b16 v[92:93], v206 offset:0
 v_mfma_f32_16x16x32_bf16 v[40:43], v[120:123], v[136:139], v[40:43]
 ds_read_b64_tr_b16 v[94:95], v206 offset:4096
 v_mfma_f32_16x16x32_bf16 v[44:47], v[136:139], v[124:127], v[44:47]
 ds_read_b64_tr_b16 v[96:97], v207 offset:0
 v_mfma_f32_16x16x32_bf16 v[48:51], v[136:139], v[128:131], v[48:51]
 ds_read_b64_tr_b16 v[98:99], v207 offset:4096
 v_mfma_f32_16x16x32_bf16 v[184:187], v[120:123], v[12:15], v[184:187]
 ds_read_b128 v[104:107], v2 offset:10240
 v_mfma_f32_16x16x32_bf16 v[52:55], v[116:119], v[140:143], v[52:55]
 ds_read_b128 v[108:111], v2 offset:12288
 v_mfma_f32_16x16x32_bf16 v[56:59], v[120:123], v[140:143], v[56:59]
 ds_read_b128 v[112:115], v2 offset:14336
 v_mfma_f32_16x16x32_bf16 v[60:63], v[140:143], v[124:127], v[60:63]
 v_mfma_f32_16x16x32_bf16 v[64:67], v[140:143], v[128:131], v[64:67]
 v_mfma_f32_16x16x32_bf16 v[188:191], v[12:15], v[124:127], v[188:191]
 v_mfma_f32_16x16x32_bf16 v[68:71], v[116:119], v[144:147], v[68:71]
 v_mfma_f32_16x16x32_bf16 v[72:75], v[120:123], v[144:147], v[72:75]
 v_mfma_f32_16x16x32_bf16 v[76:79], v[144:147], v[124:127], v[76:79]
 v_mfma_f32_16x16x32_bf16 v[80:83], v[144:147], v[128:131], v[80:83]
 v_mfma_f32_16x16x32_bf16 v[192:195], v[12:15], v[128:131], v[192:195]
 s_waitcnt lgkmcnt(0)
 s_cmp_lg_u32 s21, 18
 s_cbranch_scc1 C0_mx_ns18
 buffer_store_dwordx4 v[84:87], v16, s[4:7], s26 offen offset:0 sc1
 buffer_store_dwordx4 v[88:91], v16, s[4:7], s26 offen offset:1024 sc1
 buffer_store_dwordx4 v[92:95], v16, s[4:7], s26 offen offset:2048 sc1
 buffer_store_dwordx4 v[96:99], v16, s[4:7], s26 offen offset:3072 sc1
C0_mx_ns18:
 v_mfma_f32_16x16x32_bf16 v[20:23], v[84:87], v[100:103], v[20:23]
 ds_read_b64_tr_b16 v[116:117], v204 offset:16384
 v_mfma_f32_16x16x32_bf16 v[24:27], v[88:91], v[100:103], v[24:27]
 ds_read_b64_tr_b16 v[118:119], v204 offset:20480
 v_mfma_f32_16x16x32_bf16 v[28:31], v[100:103], v[92:95], v[28:31]
 ds_read_b128 v[132:135], v3 offset:8192
 v_mfma_f32_16x16x32_bf16 v[32:35], v[100:103], v[96:99], v[32:35]
 ds_read_b64_tr_b16 v[120:121], v205 offset:16384
 v_mfma_f32_16x16x32_bf16 v[180:183], v[84:87], v[12:15], v[180:183]
 ds_read_b64_tr_b16 v[122:123], v205 offset:20480
 v_mfma_f32_16x16x32_bf16 v[36:39], v[84:87], v[104:107], v[36:39]
 ds_read_b64_tr_b16 v[124:125], v206 offset:16384
 v_mfma_f32_16x16x32_bf16 v[40:43], v[88:91], v[104:107], v[40:43]
 ds_read_b64_tr_b16 v[126:127], v206 offset:20480
 v_mfma_f32_16x16x32_bf16 v[44:47], v[104:107], v[92:95], v[44:47]
 ds_read_b64_tr_b16 v[128:129], v207 offset:16384
 v_mfma_f32_16x16x32_bf16 v[48:51], v[104:107], v[96:99], v[48:51]
 ds_read_b64_tr_b16 v[130:131], v207 offset:20480
 v_mfma_f32_16x16x32_bf16 v[184:187], v[88:91], v[12:15], v[184:187]
 ds_read_b128 v[136:139], v3 offset:10240
 v_mfma_f32_16x16x32_bf16 v[52:55], v[84:87], v[108:111], v[52:55]
 ds_read_b128 v[140:143], v3 offset:12288
 v_mfma_f32_16x16x32_bf16 v[56:59], v[88:91], v[108:111], v[56:59]
 ds_read_b128 v[144:147], v3 offset:14336
 v_mfma_f32_16x16x32_bf16 v[60:63], v[108:111], v[92:95], v[60:63]
 v_mfma_f32_16x16x32_bf16 v[64:67], v[108:111], v[96:99], v[64:67]
 v_mfma_f32_16x16x32_bf16 v[188:191], v[12:15], v[92:95], v[188:191]
 v_mfma_f32_16x16x32_bf16 v[68:71], v[84:87], v[112:115], v[68:71]
 v_mfma_f32_16x16x32_bf16 v[72:75], v[88:91], v[112:115], v[72:75]
 v_mfma_f32_16x16x32_bf16 v[76:79], v[112:115], v[92:95], v[76:79]
 v_mfma_f32_16x16x32_bf16 v[80:83], v[112:115], v[96:99], v[80:83]
 v_mfma_f32_16x16x32_bf16 v[192:195], v[12:15], v[96:99], v[192:195]
 s_waitcnt lgkmcnt(0)
 s_cmp_lg_u32 s21, 19
 s_cbranch_scc1 C0_mx_ns19
 buffer_store_dwordx4 v[116:119], v16, s[4:7], s26 offen offset:0 sc1
 buffer_store_dwordx4 v[120:123], v16, s[4:7], s26 offen offset:1024 sc1
 buffer_store_dwordx4 v[124:127], v16, s[4:7], s26 offen offset:2048 sc1
 buffer_store_dwordx4 v[128:131], v16, s[4:7], s26 offen offset:3072 sc1
C0_mx_ns19:
 v_mfma_f32_16x16x32_bf16 v[20:23], v[116:119], v[132:135], v[20:23]
 s_barrier
 v_mfma_f32_16x16x32_bf16 v[24:27], v[120:123], v[132:135], v[24:27]
 v_mfma_f32_16x16x32_bf16 v[28:31], v[132:135], v[124:127], v[28:31]
 v_mfma_f32_16x16x32_bf16 v[32:35], v[132:135], v[128:131], v[32:35]
 v_mfma_f32_16x16x32_bf16 v[180:183], v[116:119], v[12:15], v[180:183]
 v_mfma_f32_16x16x32_bf16 v[36:39], v[116:119], v[136:139], v[36:39]
 v_mfma_f32_16x16x32_bf16 v[40:43], v[120:123], v[136:139], v[40:43]
 v_mfma_f32_16x16x32_bf16 v[44:47], v[136:139], v[124:127], v[44:47]
 v_mfma_f32_16x16x32_bf16 v[48:51], v[136:139], v[128:131], v[48:51]
 v_mfma_f32_16x16x32_bf16 v[184:187], v[120:123], v[12:15], v[184:187]
 v_mfma_f32_16x16x32_bf16 v[52:55], v[116:119], v[140:143], v[52:55]
 v_mfma_f32_16x16x32_bf16 v[56:59], v[120:123], v[140:143], v[56:59]
 v_mfma_f32_16x16x32_bf16 v[60:63], v[140:143], v[124:127], v[60:63]
 v_mfma_f32_16x16x32_bf16 v[64:67], v[140:143], v[128:131], v[64:67]
 v_mfma_f32_16x16x32_bf16 v[188:191], v[12:15], v[124:127], v[188:191]
 v_mfma_f32_16x16x32_bf16 v[68:71], v[116:119], v[144:147], v[68:71]
 v_mfma_f32_16x16x32_bf16 v[72:75], v[120:123], v[144:147], v[72:75]
 v_mfma_f32_16x16x32_bf16 v[76:79], v[144:147], v[124:127], v[76:79]
 v_mfma_f32_16x16x32_bf16 v[80:83], v[144:147], v[128:131], v[80:83]
 v_mfma_f32_16x16x32_bf16 v[192:195], v[12:15], v[128:131], v[192:195]
 v_and_b32 v8, 15, v1
 v_lshlrev_b32 v8, 2, v8
 v_add_u32 v8, 161792, v8
 ds_read_b32 v84, v8 offset:0
 ds_read_b32 v85, v8 offset:64
 ds_read_b32 v86, v8 offset:128
 ds_read_b32 v87, v8 offset:192
 ds_read_b32 v88, v8 offset:256
 ds_read_b32 v89, v8 offset:320
 ds_read_b32 v90, v8 offset:384
 ds_read_b32 v91, v8 offset:448
 v_lshrrev_b32 v9, 4, v1
 v_lshlrev_b32 v9, 4, v9
 v_add_u32 v9, 161792, v9
 ds_read_b128 v[92:95], v9 offset:0
 ds_read_b128 v[108:111], v9 offset:256
 ds_read_b128 v[96:99], v9 offset:64
 ds_read_b128 v[112:115], v9 offset:320
 ds_read_b128 v[100:103], v9 offset:128
 ds_read_b128 v[116:119], v9 offset:384
 ds_read_b128 v[104:107], v9 offset:192
 ds_read_b128 v[120:123], v9 offset:448
 v_mov_b32 v196, v188
 v_mov_b32 v197, v192
 s_cmp_lg_u32 s21, 20
 s_cbranch_scc1 C0_mx_nocs
 v_lshrrev_b32 v8, 4, v1
 v_lshlrev_b32 v8, 4, v8
 s_mov_b32 exec_lo, 0x00010001
 s_mov_b32 exec_hi, 0x00010001
 buffer_store_dwordx4 v[180:183], v8, s[4:7], s31 offen offset:0
 buffer_store_dwordx4 v[184:187], v8, s[4:7], s31 offen offset:64
 s_mov_b64 exec, -1
 v_lshlrev_b32 v8, 2, v1
 s_mov_b64 exec, 0xffff
 buffer_store_dword v188, v8, s[4:7], s31 offen offset:128
 buffer_store_dword v192, v8, s[4:7], s31 offen offset:192
 s_mov_b64 exec, -1
C0_mx_nocs:
 s_waitcnt lgkmcnt(0)
 v_mul_f32 v84, s27, v84
 v_mul_f32 v85, s27, v85
 v_mul_f32 v86, s27, v86
 v_mul_f32 v87, s27, v87
 v_mul_f32 v88, s27, v88
 v_mul_f32 v89, s27, v89
 v_mul_f32 v90, s27, v90
 v_mul_f32 v91, s27, v91
 v_pk_mul_f32 v[204:205], v[180:181], v[88:89] op_sel:[0,0] op_sel_hi:[1,0]
 v_pk_mul_f32 v[206:207], v[182:183], v[88:89] op_sel:[0,0] op_sel_hi:[1,0]
 v_pk_mul_f32 v[208:209], v[180:181], v[88:89] op_sel:[0,1] op_sel_hi:[1,1]
 v_pk_mul_f32 v[210:211], v[182:183], v[88:89] op_sel:[0,1] op_sel_hi:[1,1]
 v_pk_fma_f32 v[204:205], v[20:21], v[84:85], v[204:205] op_sel:[0,0,0] op_sel_hi:[1,0,1] neg_lo:[0,0,1] neg_hi:[0,0,1]
 v_pk_fma_f32 v[206:207], v[22:23], v[84:85], v[206:207] op_sel:[0,0,0] op_sel_hi:[1,0,1] neg_lo:[0,0,1] neg_hi:[0,0,1]
 v_pk_fma_f32 v[208:209], v[36:37], v[84:85], v[208:209] op_sel:[0,1,0] op_sel_hi:[1,1,1] neg_lo:[0,0,1] neg_hi:[0,0,1]
 v_pk_fma_f32 v[210:211], v[38:39], v[84:85], v[210:211] op_sel:[0,1,0] op_sel_hi:[1,1,1] neg_lo:[0,0,1] neg_hi:[0,0,1]
 v_cvt_pk_bf16_f32 v212, v204, v205
 v_cvt_pk_bf16_f32 v213, v206, v207
 v_cvt_pk_bf16_f32 v214, v208, v209
 v_cvt_pk_bf16_f32 v215, v210, v211
 s_nop 0
 v_permlane16_swap_b32 v212, v214
 v_permlane16_swap_b32 v213, v215
 buffer_store_dwordx4 v[212:215], v203, s[4:7], s30 offen offset:0
 v_pk_mul_f32 v[220:221], v[180:181], v[90:91] op_sel:[0,0] op_sel_hi:[1,0]
 v_pk_mul_f32 v[222:223], v[182:183], v[90:91] op_sel:[0,0] op_sel_hi:[1,0]
 v_pk_mul_f32 v[224:225], v[180:181], v[90:91] op_sel:[0,1] op_sel_hi:[1,1]
 v_pk_mul_f32 v[226:227], v[182:183], v[90:91] op_sel:[0,1] op_sel_hi:[1,1]
 v_pk_fma_f32 v[220:221], v[52:53], v[86:87], v[220:221] op_sel:[0,0,0] op_sel_hi:[1,0,1] neg_lo:[0,0,1] neg_hi:[0,0,1]
 v_pk_fma_f32 v[222:223], v[54:55], v[86:87], v[222:223] op_sel:[0,0,0] op_sel_hi:[1,0,1] neg_lo:[0,0,1] neg_hi:[0,0,1]
 v_pk_fma_f32 v[224:225], v[68:69], v[86:87], v[224:225] op_sel:[0,1,0] op_sel_hi:[1,1,1] neg_lo:[0,0,1] neg_hi:[0,0,1]
 v_pk_fma_f32 v[226:227], v[70:71], v[86:87], v[226:227] op_sel:[0,1,0] op_sel_hi:[1,1,1] neg_lo:[0,0,1] neg_hi:[0,0,1]
 v_cvt_pk_bf16_f32 v228, v220, v221
 v_cvt_pk_bf16_f32 v229, v222, v223
 v_cvt_pk_bf16_f32 v230, v224, v225
 v_cvt_pk_bf16_f32 v231, v226, v227
 s_nop 0
 v_permlane16_swap_b32 v228, v230
 v_permlane16_swap_b32 v229, v231
 buffer_store_dwordx4 v[228:231], v203, s[4:7], s29 offen offset:0
 v_pk_mul_f32 v[204:205], v[184:185], v[88:89] op_sel:[0,0] op_sel_hi:[1,0]
 v_pk_mul_f32 v[206:207], v[186:187], v[88:89] op_sel:[0,0] op_sel_hi:[1,0]
 v_pk_mul_f32 v[208:209], v[184:185], v[88:89] op_sel:[0,1] op_sel_hi:[1,1]
 v_pk_mul_f32 v[210:211], v[186:187], v[88:89] op_sel:[0,1] op_sel_hi:[1,1]
 v_pk_fma_f32 v[204:205], v[24:25], v[84:85], v[204:205] op_sel:[0,0,0] op_sel_hi:[1,0,1] neg_lo:[0,0,1] neg_hi:[0,0,1]
 v_pk_fma_f32 v[206:207], v[26:27], v[84:85], v[206:207] op_sel:[0,0,0] op_sel_hi:[1,0,1] neg_lo:[0,0,1] neg_hi:[0,0,1]
 v_pk_fma_f32 v[208:209], v[40:41], v[84:85], v[208:209] op_sel:[0,1,0] op_sel_hi:[1,1,1] neg_lo:[0,0,1] neg_hi:[0,0,1]
 v_pk_fma_f32 v[210:211], v[42:43], v[84:85], v[210:211] op_sel:[0,1,0] op_sel_hi:[1,1,1] neg_lo:[0,0,1] neg_hi:[0,0,1]
 v_cvt_pk_bf16_f32 v212, v204, v205
 v_cvt_pk_bf16_f32 v213, v206, v207
 v_cvt_pk_bf16_f32 v214, v208, v209
 v_cvt_pk_bf16_f32 v215, v210, v211
 s_nop 0
 v_permlane16_swap_b32 v212, v214
 v_permlane16_swap_b32 v213, v215
 buffer_store_dwordx4 v[212:215], v203, s[4:7], s30 offen offset:512
 v_pk_mul_f32 v[220:221], v[184:185], v[90:91] op_sel:[0,0] op_sel_hi:[1,0]
 v_pk_mul_f32 v[222:223], v[186:187], v[90:91] op_sel:[0,0] op_sel_hi:[1,0]
 v_pk_mul_f32 v[224:225], v[184:185], v[90:91] op_sel:[0,1] op_sel_hi:[1,1]
 v_pk_mul_f32 v[226:227], v[186:187], v[90:91] op_sel:[0,1] op_sel_hi:[1,1]
 v_pk_fma_f32 v[220:221], v[56:57], v[86:87], v[220:221] op_sel:[0,0,0] op_sel_hi:[1,0,1] neg_lo:[0,0,1] neg_hi:[0,0,1]
 v_pk_fma_f32 v[222:223], v[58:59], v[86:87], v[222:223] op_sel:[0,0,0] op_sel_hi:[1,0,1] neg_lo:[0,0,1] neg_hi:[0,0,1]
 v_pk_fma_f32 v[224:225], v[72:73], v[86:87], v[224:225] op_sel:[0,1,0] op_sel_hi:[1,1,1] neg_lo:[0,0,1] neg_hi:[0,0,1]
 v_pk_fma_f32 v[226:227], v[74:75], v[86:87], v[226:227] op_sel:[0,1,0] op_sel_hi:[1,1,1] neg_lo:[0,0,1] neg_hi:[0,0,1]
 v_cvt_pk_bf16_f32 v228, v220, v221
 v_cvt_pk_bf16_f32 v229, v222, v223
 v_cvt_pk_bf16_f32 v230, v224, v225
 v_cvt_pk_bf16_f32 v231, v226, v227
 s_nop 0
 v_permlane16_swap_b32 v228, v230
 v_permlane16_swap_b32 v229, v231
 buffer_store_dwordx4 v[228:231], v203, s[4:7], s29 offen offset:512
 v_pk_mul_f32 v[204:205], v[108:109], v[196:197] op_sel:[0,0] op_sel_hi:[1,0]
 v_pk_mul_f32 v[206:207], v[110:111], v[196:197] op_sel:[0,0] op_sel_hi:[1,0]
 v_pk_mul_f32 v[208:209], v[112:113], v[196:197] op_sel:[0,0] op_sel_hi:[1,0]
 v_pk_mul_f32 v[210:211], v[114:115], v[196:197] op_sel:[0,0] op_sel_hi:[1,0]
 v_pk_fma_f32 v[204:205], v[28:29], v[92:93], v[204:205] neg_lo:[0,0,1] neg_hi:[0,0,1]
 v_pk_fma_f32 v[206:207], v[30:31], v[94:95], v[206:207] neg_lo:[0,0,1] neg_hi:[0,0,1]
 v_pk_fma_f32 v[208:209], v[44:45], v[96:97], v[208:209] neg_lo:[0,0,1] neg_hi:[0,0,1]
 v_pk_fma_f32 v[210:211], v[46:47], v[98:99], v[210:211] neg_lo:[0,0,1] neg_hi:[0,0,1]
 v_cvt_pk_bf16_f32 v212, v204, v205
 v_cvt_pk_bf16_f32 v213, v206, v207
 v_cvt_pk_bf16_f32 v214, v208, v209
 v_cvt_pk_bf16_f32 v215, v210, v211
 s_nop 0
 v_permlane32_swap_b32 v212, v214
 v_permlane32_swap_b32 v213, v215
 buffer_store_dwordx4 v[212:215], v200, s[4:7], s28 offen offset:0
 v_pk_mul_f32 v[220:221], v[116:117], v[196:197] op_sel:[0,0] op_sel_hi:[1,0]
 v_pk_mul_f32 v[222:223], v[118:119], v[196:197] op_sel:[0,0] op_sel_hi:[1,0]
 v_pk_mul_f32 v[224:225], v[120:121], v[196:197] op_sel:[0,0] op_sel_hi:[1,0]
 v_pk_mul_f32 v[226:227], v[122:123], v[196:197] op_sel:[0,0] op_sel_hi:[1,0]
 v_pk_fma_f32 v[220:221], v[60:61], v[100:101], v[220:221] neg_lo:[0,0,1] neg_hi:[0,0,1]
 v_pk_fma_f32 v[222:223], v[62:63], v[102:103], v[222:223] neg_lo:[0,0,1] neg_hi:[0,0,1]
 v_pk_fma_f32 v[224:225], v[76:77], v[104:105], v[224:225] neg_lo:[0,0,1] neg_hi:[0,0,1]
 v_pk_fma_f32 v[226:227], v[78:79], v[106:107], v[226:227] neg_lo:[0,0,1] neg_hi:[0,0,1]
 v_cvt_pk_bf16_f32 v228, v220, v221
 v_cvt_pk_bf16_f32 v229, v222, v223
 v_cvt_pk_bf16_f32 v230, v224, v225
 v_cvt_pk_bf16_f32 v231, v226, v227
 s_nop 0
 v_permlane32_swap_b32 v228, v230
 v_permlane32_swap_b32 v229, v231
 buffer_store_dwordx4 v[228:231], v200, s[4:7], s28 offen offset:1344
 v_pk_mul_f32 v[204:205], v[108:109], v[196:197] op_sel:[0,1] op_sel_hi:[1,1]
 v_pk_mul_f32 v[206:207], v[110:111], v[196:197] op_sel:[0,1] op_sel_hi:[1,1]
 v_pk_mul_f32 v[208:209], v[112:113], v[196:197] op_sel:[0,1] op_sel_hi:[1,1]
 v_pk_mul_f32 v[210:211], v[114:115], v[196:197] op_sel:[0,1] op_sel_hi:[1,1]
 v_pk_fma_f32 v[204:205], v[32:33], v[92:93], v[204:205] neg_lo:[0,0,1] neg_hi:[0,0,1]
 v_pk_fma_f32 v[206:207], v[34:35], v[94:95], v[206:207] neg_lo:[0,0,1] neg_hi:[0,0,1]
 v_pk_fma_f32 v[208:209], v[48:49], v[96:97], v[208:209] neg_lo:[0,0,1] neg_hi:[0,0,1]
 v_pk_fma_f32 v[210:211], v[50:51], v[98:99], v[210:211] neg_lo:[0,0,1] neg_hi:[0,0,1]
 v_cvt_pk_bf16_f32 v212, v204, v205
 v_cvt_pk_bf16_f32 v213, v206, v207
 v_cvt_pk_bf16_f32 v214, v208, v209
 v_cvt_pk_bf16_f32 v215, v210, v211
 s_nop 0
 v_permlane32_swap_b32 v212, v214
 v_permlane32_swap_b32 v213, v215
 buffer_store_dwordx4 v[212:215], v201, s[4:7], s28 offen offset:0
 v_pk_mul_f32 v[220:221], v[116:117], v[196:197] op_sel:[0,1] op_sel_hi:[1,1]
 v_pk_mul_f32 v[222:223], v[118:119], v[196:197] op_sel:[0,1] op_sel_hi:[1,1]
 v_pk_mul_f32 v[224:225], v[120:121], v[196:197] op_sel:[0,1] op_sel_hi:[1,1]
 v_pk_mul_f32 v[226:227], v[122:123], v[196:197] op_sel:[0,1] op_sel_hi:[1,1]
 v_pk_fma_f32 v[220:221], v[64:65], v[100:101], v[220:221] neg_lo:[0,0,1] neg_hi:[0,0,1]
 v_pk_fma_f32 v[222:223], v[66:67], v[102:103], v[222:223] neg_lo:[0,0,1] neg_hi:[0,0,1]
 v_pk_fma_f32 v[224:225], v[80:81], v[104:105], v[224:225] neg_lo:[0,0,1] neg_hi:[0,0,1]
 v_pk_fma_f32 v[226:227], v[82:83], v[106:107], v[226:227] neg_lo:[0,0,1] neg_hi:[0,0,1]
 v_cvt_pk_bf16_f32 v228, v220, v221
 v_cvt_pk_bf16_f32 v229, v222, v223
 v_cvt_pk_bf16_f32 v230, v224, v225
 v_cvt_pk_bf16_f32 v231, v226, v227
 s_nop 0
 v_permlane32_swap_b32 v228, v230
 v_permlane32_swap_b32 v229, v231
 buffer_store_dwordx4 v[228:231], v201, s[4:7], s28 offen offset:1344
 s_endpgm
C0_q_vv:
 v_and_b32 v8, 15, v1
 v_lshrrev_b32 v9, 5, v1
 v_mul_u32_u24 v9, 672, v9
 v_bfe_u32 v204, v1, 4, 1
 v_mul_u32_u24 v204, 336, v204
 v_add_u32 v9, v9, v204
 s_mul_i32 s23, s22, 80
 s_lshl_b32 s24, s20, 6
 s_add_u32 s23, s23, s24
 s_sub_u32 s23, s23, 160
 v_add_u32 v8, s23, v8
 s_mov_b32 s24, 86016
 v_add_u32 v204, 0, v8
 v_mul_u32_u24 v205, 3277, v204
 v_lshrrev_b32 v205, 16, v205
 v_mul_u32_u24 v206, 20, v205
 v_sub_u32 v206, v204, v206
 v_lshlrev_b32 v206, 4, v206
 v_mul_lo_u32 v205, v205, s24
 v_add_u32 v205, v205, v206
 v_add_u32 v200, v205, v9
 v_add_u32 v204, 16, v8
 v_mul_u32_u24 v205, 3277, v204
 v_lshrrev_b32 v205, 16, v205
 v_mul_u32_u24 v206, 20, v205
 v_sub_u32 v206, v204, v206
 v_lshlrev_b32 v206, 4, v206
 v_mul_lo_u32 v205, v205, s24
 v_add_u32 v205, v205, v206
 v_add_u32 v201, v205, v9
 v_add_u32 v204, 32, v8
 v_mul_u32_u24 v205, 3277, v204
 v_lshrrev_b32 v205, 16, v205
 v_mul_u32_u24 v206, 20, v205
 v_sub_u32 v206, v204, v206
 v_lshlrev_b32 v206, 4, v206
 v_mul_lo_u32 v205, v205, s24
 v_add_u32 v205, v205, v206
 v_add_u32 v202, v205, v9
 v_lshlrev_b32 v9, 3, v6
 v_add_u32 v9, 384, v9
 v_xor_b32 v9, v4, v9
 v_add_u32 v204, v5, v9
 v_add_u32 v208, 65536, v204
 v_lshlrev_b32 v9, 3, v6
 v_add_u32 v9, 416, v9
 v_xor_b32 v9, v4, v9
 v_add_u32 v205, v5, v9
 v_add_u32 v209, 65536, v205
 v_lshlrev_b32 v9, 3, v6
 v_add_u32 v9, 448, v9
 v_xor_b32 v9, v4, v9
 v_add_u32 v206, v5, v9
 v_add_u32 v210, 65536, v206
 s_waitcnt lgkmcnt(0)
 s_barrier
 ds_read_b64_tr_b16 v[84:85], v204 offset:0
 ds_read_b64_tr_b16 v[86:87], v204 offset:4096
 ds_read_b128 v[100:103], v2 offset:0
 ds_read_b64_tr_b16 v[88:89], v205 offset:0
 ds_read_b64_tr_b16 v[90:91], v205 offset:4096
 ds_read_b64_tr_b16 v[92:93], v206 offset:0
 ds_read_b64_tr_b16 v[94:95], v206 offset:4096
 ds_read_b128 v[104:107], v2 offset:2048
 ds_read_b128 v[108:111], v2 offset:4096
 ds_read_b128 v[112:115], v2 offset:6144
 s_waitcnt lgkmcnt(0)
 s_cmp_lg_u32 s21, 0
 s_cbranch_scc1 C0_vv_ns0
 buffer_store_dwordx4 v[84:87], v16, s[4:7], s26 offen offset:0 sc1
 buffer_store_dwordx4 v[88:91], v16, s[4:7], s26 offen offset:1024 sc1
 buffer_store_dwordx4 v[92:95], v16, s[4:7], s26 offen offset:2048 sc1
C0_vv_ns0:
 v_mfma_f32_16x16x32_bf16 v[20:23], v[100:103], v[84:87], 0
 ds_read_b64_tr_b16 v[116:117], v204 offset:16384
 v_mfma_f32_16x16x32_bf16 v[24:27], v[100:103], v[88:91], 0
 ds_read_b64_tr_b16 v[118:119], v204 offset:20480
 v_mfma_f32_16x16x32_bf16 v[28:31], v[100:103], v[92:95], 0
 ds_read_b128 v[132:135], v3 offset:0
 v_mfma_f32_16x16x32_bf16 v[180:183], v[12:15], v[84:87], 0
 ds_read_b64_tr_b16 v[120:121], v205 offset:16384
 v_mfma_f32_16x16x32_bf16 v[32:35], v[104:107], v[84:87], 0
 ds_read_b64_tr_b16 v[122:123], v205 offset:20480
 v_mfma_f32_16x16x32_bf16 v[36:39], v[104:107], v[88:91], 0
 ds_read_b64_tr_b16 v[124:125], v206 offset:16384
 v_mfma_f32_16x16x32_bf16 v[40:43], v[104:107], v[92:95], 0
 ds_read_b64_tr_b16 v[126:127], v206 offset:20480
 v_mfma_f32_16x16x32_bf16 v[184:187], v[12:15], v[88:91], 0
 ds_read_b128 v[136:139], v3 offset:2048
 v_mfma_f32_16x16x32_bf16 v[44:47], v[108:111], v[84:87], 0
 ds_read_b128 v[140:143], v3 offset:4096
 v_mfma_f32_16x16x32_bf16 v[48:51], v[108:111], v[88:91], 0
 ds_read_b128 v[144:147], v3 offset:6144
 v_mfma_f32_16x16x32_bf16 v[52:55], v[108:111], v[92:95], 0
 v_mfma_f32_16x16x32_bf16 v[188:191], v[12:15], v[92:95], 0
 v_mfma_f32_16x16x32_bf16 v[56:59], v[112:115], v[84:87], 0
 v_mfma_f32_16x16x32_bf16 v[60:63], v[112:115], v[88:91], 0
 v_mfma_f32_16x16x32_bf16 v[64:67], v[112:115], v[92:95], 0
 s_waitcnt lgkmcnt(0)
 s_cmp_lg_u32 s21, 1
 s_cbranch_scc1 C0_vv_ns1
 buffer_store_dwordx4 v[116:119], v16, s[4:7], s26 offen offset:0 sc1
 buffer_store_dwordx4 v[120:123], v16, s[4:7], s26 offen offset:1024 sc1
 buffer_store_dwordx4 v[124:127], v16, s[4:7], s26 offen offset:2048 sc1
C0_vv_ns1:
 v_mfma_f32_16x16x32_bf16 v[20:23], v[132:135], v[116:119], v[20:23]
 s_barrier
 ds_read_b64_tr_b16 v[84:85], v204 offset:32768
 v_mfma_f32_16x16x32_bf16 v[24:27], v[132:135], v[120:123], v[24:27]
 ds_read_b64_tr_b16 v[86:87], v204 offset:36864
 v_mfma_f32_16x16x32_bf16 v[28:31], v[132:135], v[124:127], v[28:31]
 ds_read_b128 v[100:103], v2 offset:8192
 v_mfma_f32_16x16x32_bf16 v[180:183], v[12:15], v[116:119], v[180:183]
 ds_read_b64_tr_b16 v[88:89], v205 offset:32768
 v_mfma_f32_16x16x32_bf16 v[32:35], v[136:139], v[116:119], v[32:35]
 ds_read_b64_tr_b16 v[90:91], v205 offset:36864
 v_mfma_f32_16x16x32_bf16 v[36:39], v[136:139], v[120:123], v[36:39]
 ds_read_b64_tr_b16 v[92:93], v206 offset:32768
 v_mfma_f32_16x16x32_bf16 v[40:43], v[136:139], v[124:127], v[40:43]
 ds_read_b64_tr_b16 v[94:95], v206 offset:36864
 v_mfma_f32_16x16x32_bf16 v[184:187], v[12:15], v[120:123], v[184:187]
 ds_read_b128 v[104:107], v2 offset:10240
 v_mfma_f32_16x16x32_bf16 v[44:47], v[140:143], v[116:119], v[44:47]
 ds_read_b128 v[108:111], v2 offset:12288
 v_mfma_f32_16x16x32_bf16 v[48:51], v[140:143], v[120:123], v[48:51]
 ds_read_b128 v[112:115], v2 offset:14336
 v_mfma_f32_16x16x32_bf16 v[52:55], v[140:143], v[124:127], v[52:55]
 v_mfma_f32_16x16x32_bf16 v[188:191], v[12:15], v[124:127], v[188:191]
 v_mfma_f32_16x16x32_bf16 v[56:59], v[144:147], v[116:119], v[56:59]
 v_mfma_f32_16x16x32_bf16 v[60:63], v[144:147], v[120:123], v[60:63]
 v_mfma_f32_16x16x32_bf16 v[64:67], v[144:147], v[124:127], v[64:67]
 s_waitcnt lgkmcnt(0)
 buffer_load_dword v17, v18, s[16:19], s42 offen
 s_cmp_lg_u32 s21, 2
 s_cbranch_scc1 C0_vv_ns2
 buffer_store_dwordx4 v[84:87], v16, s[4:7], s26 offen offset:0 sc1
 buffer_store_dwordx4 v[88:91], v16, s[4:7], s26 offen offset:1024 sc1
 buffer_store_dwordx4 v[92:95], v16, s[4:7], s26 offen offset:2048 sc1
C0_vv_ns2:
 v_mfma_f32_16x16x32_bf16 v[20:23], v[100:103], v[84:87], v[20:23]
 ds_read_b64_tr_b16 v[116:117], v204 offset:49152
 v_mfma_f32_16x16x32_bf16 v[24:27], v[100:103], v[88:91], v[24:27]
 ds_read_b64_tr_b16 v[118:119], v204 offset:53248
 v_mfma_f32_16x16x32_bf16 v[28:31], v[100:103], v[92:95], v[28:31]
 ds_read_b128 v[132:135], v3 offset:8192
 v_mfma_f32_16x16x32_bf16 v[180:183], v[12:15], v[84:87], v[180:183]
 ds_read_b64_tr_b16 v[120:121], v205 offset:49152
 v_mfma_f32_16x16x32_bf16 v[32:35], v[104:107], v[84:87], v[32:35]
 ds_read_b64_tr_b16 v[122:123], v205 offset:53248
 v_mfma_f32_16x16x32_bf16 v[36:39], v[104:107], v[88:91], v[36:39]
 ds_read_b64_tr_b16 v[124:125], v206 offset:49152
 v_mfma_f32_16x16x32_bf16 v[40:43], v[104:107], v[92:95], v[40:43]
 ds_read_b64_tr_b16 v[126:127], v206 offset:53248
 v_mfma_f32_16x16x32_bf16 v[184:187], v[12:15], v[88:91], v[184:187]
 ds_read_b128 v[136:139], v3 offset:10240
 v_mfma_f32_16x16x32_bf16 v[44:47], v[108:111], v[84:87], v[44:47]
 ds_read_b128 v[140:143], v3 offset:12288
 v_mfma_f32_16x16x32_bf16 v[48:51], v[108:111], v[88:91], v[48:51]
 ds_read_b128 v[144:147], v3 offset:14336
 v_mfma_f32_16x16x32_bf16 v[52:55], v[108:111], v[92:95], v[52:55]
 v_mfma_f32_16x16x32_bf16 v[188:191], v[12:15], v[92:95], v[188:191]
 v_mfma_f32_16x16x32_bf16 v[56:59], v[112:115], v[84:87], v[56:59]
 v_mfma_f32_16x16x32_bf16 v[60:63], v[112:115], v[88:91], v[60:63]
 v_mfma_f32_16x16x32_bf16 v[64:67], v[112:115], v[92:95], v[64:67]
 s_waitcnt lgkmcnt(0)
 s_mov_b64 exec, 0xffff
 s_add_u32 s23, s43, 0x14a000
 buffer_load_dword v17, v19, s[8:11], s23 offen
 s_add_u32 s23, s48, 896
 buffer_load_dword v17, v212, s[44:47], s23 offen
 s_mov_b64 exec, -1
 s_cmp_lg_u32 s21, 3
 s_cbranch_scc1 C0_vv_ns3
 buffer_store_dwordx4 v[116:119], v16, s[4:7], s26 offen offset:0 sc1
 buffer_store_dwordx4 v[120:123], v16, s[4:7], s26 offen offset:1024 sc1
 buffer_store_dwordx4 v[124:127], v16, s[4:7], s26 offen offset:2048 sc1
C0_vv_ns3:
 v_mfma_f32_16x16x32_bf16 v[20:23], v[132:135], v[116:119], v[20:23]
 s_barrier
 ds_read_b64_tr_b16 v[84:85], v208 offset:0
 v_mfma_f32_16x16x32_bf16 v[24:27], v[132:135], v[120:123], v[24:27]
 ds_read_b64_tr_b16 v[86:87], v208 offset:4096
 v_mfma_f32_16x16x32_bf16 v[28:31], v[132:135], v[124:127], v[28:31]
 ds_read_b128 v[100:103], v2 offset:16384
 v_mfma_f32_16x16x32_bf16 v[180:183], v[12:15], v[116:119], v[180:183]
 ds_read_b64_tr_b16 v[88:89], v209 offset:0
 v_mfma_f32_16x16x32_bf16 v[32:35], v[136:139], v[116:119], v[32:35]
 ds_read_b64_tr_b16 v[90:91], v209 offset:4096
 v_mfma_f32_16x16x32_bf16 v[36:39], v[136:139], v[120:123], v[36:39]
 ds_read_b64_tr_b16 v[92:93], v210 offset:0
 v_mfma_f32_16x16x32_bf16 v[40:43], v[136:139], v[124:127], v[40:43]
 ds_read_b64_tr_b16 v[94:95], v210 offset:4096
 v_mfma_f32_16x16x32_bf16 v[184:187], v[12:15], v[120:123], v[184:187]
 ds_read_b128 v[104:107], v2 offset:18432
 v_mfma_f32_16x16x32_bf16 v[44:47], v[140:143], v[116:119], v[44:47]
 ds_read_b128 v[108:111], v2 offset:20480
 v_mfma_f32_16x16x32_bf16 v[48:51], v[140:143], v[120:123], v[48:51]
 ds_read_b128 v[112:115], v2 offset:22528
 v_mfma_f32_16x16x32_bf16 v[52:55], v[140:143], v[124:127], v[52:55]
 v_mfma_f32_16x16x32_bf16 v[188:191], v[12:15], v[124:127], v[188:191]
 v_mfma_f32_16x16x32_bf16 v[56:59], v[144:147], v[116:119], v[56:59]
 v_mfma_f32_16x16x32_bf16 v[60:63], v[144:147], v[120:123], v[60:63]
 v_mfma_f32_16x16x32_bf16 v[64:67], v[144:147], v[124:127], v[64:67]
 s_waitcnt lgkmcnt(0)
 s_cmp_lg_u32 s21, 4
 s_cbranch_scc1 C0_vv_ns4
 buffer_store_dwordx4 v[84:87], v16, s[4:7], s26 offen offset:0 sc1
 buffer_store_dwordx4 v[88:91], v16, s[4:7], s26 offen offset:1024 sc1
 buffer_store_dwordx4 v[92:95], v16, s[4:7], s26 offen offset:2048 sc1
C0_vv_ns4:
 v_mfma_f32_16x16x32_bf16 v[20:23], v[100:103], v[84:87], v[20:23]
 ds_read_b64_tr_b16 v[116:117], v208 offset:16384
 v_mfma_f32_16x16x32_bf16 v[24:27], v[100:103], v[88:91], v[24:27]
 ds_read_b64_tr_b16 v[118:119], v208 offset:20480
 v_mfma_f32_16x16x32_bf16 v[28:31], v[100:103], v[92:95], v[28:31]
 ds_read_b128 v[132:135], v3 offset:16384
 v_mfma_f32_16x16x32_bf16 v[180:183], v[12:15], v[84:87], v[180:183]
 ds_read_b64_tr_b16 v[120:121], v209 offset:16384
 v_mfma_f32_16x16x32_bf16 v[32:35], v[104:107], v[84:87], v[32:35]
 ds_read_b64_tr_b16 v[122:123], v209 offset:20480
 v_mfma_f32_16x16x32_bf16 v[36:39], v[104:107], v[88:91], v[36:39]
 ds_read_b64_tr_b16 v[124:125], v210 offset:16384
 v_mfma_f32_16x16x32_bf16 v[40:43], v[104:107], v[92:95], v[40:43]
 ds_read_b64_tr_b16 v[126:127], v210 offset:20480
 v_mfma_f32_16x16x32_bf16 v[184:187], v[12:15], v[88:91], v[184:187]
 ds_read_b128 v[136:139], v3 offset:18432
 v_mfma_f32_16x16x32_bf16 v[44:47], v[108:111], v[84:87], v[44:47]
 ds_read_b128 v[140:143], v3 offset:20480
 v_mfma_f32_16x16x32_bf16 v[48:51], v[108:111], v[88:91], v[48:51]
 ds_read_b128 v[144:147], v3 offset:22528
 v_mfma_f32_16x16x32_bf16 v[52:55], v[108:111], v[92:95], v[52:55]
 v_mfma_f32_16x16x32_bf16 v[188:191], v[12:15], v[92:95], v[188:191]
 v_mfma_f32_16x16x32_bf16 v[56:59], v[112:115], v[84:87], v[56:59]
 v_mfma_f32_16x16x32_bf16 v[60:63], v[112:115], v[88:91], v[60:63]
 v_mfma_f32_16x16x32_bf16 v[64:67], v[112:115], v[92:95], v[64:67]
 s_waitcnt lgkmcnt(0)
 s_cmp_lg_u32 s21, 5
 s_cbranch_scc1 C0_vv_ns5
 buffer_store_dwordx4 v[116:119], v16, s[4:7], s26 offen offset:0 sc1
 buffer_store_dwordx4 v[120:123], v16, s[4:7], s26 offen offset:1024 sc1
 buffer_store_dwordx4 v[124:127], v16, s[4:7], s26 offen offset:2048 sc1
C0_vv_ns5:
 v_mfma_f32_16x16x32_bf16 v[20:23], v[132:135], v[116:119], v[20:23]
 s_barrier
 ds_read_b64_tr_b16 v[84:85], v204 offset:0
 v_mfma_f32_16x16x32_bf16 v[24:27], v[132:135], v[120:123], v[24:27]
 ds_read_b64_tr_b16 v[86:87], v204 offset:4096
 v_mfma_f32_16x16x32_bf16 v[28:31], v[132:135], v[124:127], v[28:31]
 ds_read_b128 v[100:103], v2 offset:24576
 v_mfma_f32_16x16x32_bf16 v[180:183], v[12:15], v[116:119], v[180:183]
 ds_read_b64_tr_b16 v[88:89], v205 offset:0
 v_mfma_f32_16x16x32_bf16 v[32:35], v[136:139], v[116:119], v[32:35]
 ds_read_b64_tr_b16 v[90:91], v205 offset:4096
 v_mfma_f32_16x16x32_bf16 v[36:39], v[136:139], v[120:123], v[36:39]
 ds_read_b64_tr_b16 v[92:93], v206 offset:0
 v_mfma_f32_16x16x32_bf16 v[40:43], v[136:139], v[124:127], v[40:43]
 ds_read_b64_tr_b16 v[94:95], v206 offset:4096
 v_mfma_f32_16x16x32_bf16 v[184:187], v[12:15], v[120:123], v[184:187]
 ds_read_b128 v[104:107], v2 offset:26624
 v_mfma_f32_16x16x32_bf16 v[44:47], v[140:143], v[116:119], v[44:47]
 ds_read_b128 v[108:111], v2 offset:28672
 v_mfma_f32_16x16x32_bf16 v[48:51], v[140:143], v[120:123], v[48:51]
 ds_read_b128 v[112:115], v2 offset:30720
 v_mfma_f32_16x16x32_bf16 v[52:55], v[140:143], v[124:127], v[52:55]
 v_mfma_f32_16x16x32_bf16 v[188:191], v[12:15], v[124:127], v[188:191]
 v_mfma_f32_16x16x32_bf16 v[56:59], v[144:147], v[116:119], v[56:59]
 v_mfma_f32_16x16x32_bf16 v[60:63], v[144:147], v[120:123], v[60:63]
 v_mfma_f32_16x16x32_bf16 v[64:67], v[144:147], v[124:127], v[64:67]
 s_waitcnt lgkmcnt(0)
 s_cmp_lg_u32 s21, 6
 s_cbranch_scc1 C0_vv_ns6
 buffer_store_dwordx4 v[84:87], v16, s[4:7], s26 offen offset:0 sc1
 buffer_store_dwordx4 v[88:91], v16, s[4:7], s26 offen offset:1024 sc1
 buffer_store_dwordx4 v[92:95], v16, s[4:7], s26 offen offset:2048 sc1
C0_vv_ns6:
 v_mfma_f32_16x16x32_bf16 v[20:23], v[100:103], v[84:87], v[20:23]
 ds_read_b64_tr_b16 v[116:117], v204 offset:16384
 v_mfma_f32_16x16x32_bf16 v[24:27], v[100:103], v[88:91], v[24:27]
 ds_read_b64_tr_b16 v[118:119], v204 offset:20480
 v_mfma_f32_16x16x32_bf16 v[28:31], v[100:103], v[92:95], v[28:31]
 ds_read_b128 v[132:135], v3 offset:24576
 v_mfma_f32_16x16x32_bf16 v[180:183], v[12:15], v[84:87], v[180:183]
 ds_read_b64_tr_b16 v[120:121], v205 offset:16384
 v_mfma_f32_16x16x32_bf16 v[32:35], v[104:107], v[84:87], v[32:35]
 ds_read_b64_tr_b16 v[122:123], v205 offset:20480
 v_mfma_f32_16x16x32_bf16 v[36:39], v[104:107], v[88:91], v[36:39]
 ds_read_b64_tr_b16 v[124:125], v206 offset:16384
 v_mfma_f32_16x16x32_bf16 v[40:43], v[104:107], v[92:95], v[40:43]
 ds_read_b64_tr_b16 v[126:127], v206 offset:20480
 v_mfma_f32_16x16x32_bf16 v[184:187], v[12:15], v[88:91], v[184:187]
 ds_read_b128 v[136:139], v3 offset:26624
 v_mfma_f32_16x16x32_bf16 v[44:47], v[108:111], v[84:87], v[44:47]
 ds_read_b128 v[140:143], v3 offset:28672
 v_mfma_f32_16x16x32_bf16 v[48:51], v[108:111], v[88:91], v[48:51]
 ds_read_b128 v[144:147], v3 offset:30720
 v_mfma_f32_16x16x32_bf16 v[52:55], v[108:111], v[92:95], v[52:55]
 v_mfma_f32_16x16x32_bf16 v[188:191], v[12:15], v[92:95], v[188:191]
 v_mfma_f32_16x16x32_bf16 v[56:59], v[112:115], v[84:87], v[56:59]
 v_mfma_f32_16x16x32_bf16 v[60:63], v[112:115], v[88:91], v[60:63]
 v_mfma_f32_16x16x32_bf16 v[64:67], v[112:115], v[92:95], v[64:67]
 s_waitcnt lgkmcnt(0)
 s_mov_b64 exec, 0xffff
 s_add_u32 s23, s43, 0x1c2000
 buffer_load_dword v17, v19, s[8:11], s23 offen
 s_mov_b64 exec, -1
 s_cmp_lg_u32 s21, 7
 s_cbranch_scc1 C0_vv_ns7
 buffer_store_dwordx4 v[116:119], v16, s[4:7], s26 offen offset:0 sc1
 buffer_store_dwordx4 v[120:123], v16, s[4:7], s26 offen offset:1024 sc1
 buffer_store_dwordx4 v[124:127], v16, s[4:7], s26 offen offset:2048 sc1
C0_vv_ns7:
 v_mfma_f32_16x16x32_bf16 v[20:23], v[132:135], v[116:119], v[20:23]
 s_barrier
 ds_read_b64_tr_b16 v[84:85], v204 offset:32768
 v_mfma_f32_16x16x32_bf16 v[24:27], v[132:135], v[120:123], v[24:27]
 ds_read_b64_tr_b16 v[86:87], v204 offset:36864
 v_mfma_f32_16x16x32_bf16 v[28:31], v[132:135], v[124:127], v[28:31]
 ds_read_b128 v[100:103], v2 offset:0
 v_mfma_f32_16x16x32_bf16 v[180:183], v[12:15], v[116:119], v[180:183]
 ds_read_b64_tr_b16 v[88:89], v205 offset:32768
 v_mfma_f32_16x16x32_bf16 v[32:35], v[136:139], v[116:119], v[32:35]
 ds_read_b64_tr_b16 v[90:91], v205 offset:36864
 v_mfma_f32_16x16x32_bf16 v[36:39], v[136:139], v[120:123], v[36:39]
 ds_read_b64_tr_b16 v[92:93], v206 offset:32768
 v_mfma_f32_16x16x32_bf16 v[40:43], v[136:139], v[124:127], v[40:43]
 ds_read_b64_tr_b16 v[94:95], v206 offset:36864
 v_mfma_f32_16x16x32_bf16 v[184:187], v[12:15], v[120:123], v[184:187]
 ds_read_b128 v[104:107], v2 offset:2048
 v_mfma_f32_16x16x32_bf16 v[44:47], v[140:143], v[116:119], v[44:47]
 ds_read_b128 v[108:111], v2 offset:4096
 v_mfma_f32_16x16x32_bf16 v[48:51], v[140:143], v[120:123], v[48:51]
 ds_read_b128 v[112:115], v2 offset:6144
 v_mfma_f32_16x16x32_bf16 v[52:55], v[140:143], v[124:127], v[52:55]
 v_mfma_f32_16x16x32_bf16 v[188:191], v[12:15], v[124:127], v[188:191]
 v_mfma_f32_16x16x32_bf16 v[56:59], v[144:147], v[116:119], v[56:59]
 v_mfma_f32_16x16x32_bf16 v[60:63], v[144:147], v[120:123], v[60:63]
 v_mfma_f32_16x16x32_bf16 v[64:67], v[144:147], v[124:127], v[64:67]
 s_waitcnt lgkmcnt(0)
 s_cmp_lg_u32 s21, 8
 s_cbranch_scc1 C0_vv_ns8
 buffer_store_dwordx4 v[84:87], v16, s[4:7], s26 offen offset:0 sc1
 buffer_store_dwordx4 v[88:91], v16, s[4:7], s26 offen offset:1024 sc1
 buffer_store_dwordx4 v[92:95], v16, s[4:7], s26 offen offset:2048 sc1
C0_vv_ns8:
 v_mfma_f32_16x16x32_bf16 v[20:23], v[100:103], v[84:87], v[20:23]
 ds_read_b64_tr_b16 v[116:117], v204 offset:49152
 v_mfma_f32_16x16x32_bf16 v[24:27], v[100:103], v[88:91], v[24:27]
 ds_read_b64_tr_b16 v[118:119], v204 offset:53248
 v_mfma_f32_16x16x32_bf16 v[28:31], v[100:103], v[92:95], v[28:31]
 ds_read_b128 v[132:135], v3 offset:0
 v_mfma_f32_16x16x32_bf16 v[180:183], v[12:15], v[84:87], v[180:183]
 ds_read_b64_tr_b16 v[120:121], v205 offset:49152
 v_mfma_f32_16x16x32_bf16 v[32:35], v[104:107], v[84:87], v[32:35]
 ds_read_b64_tr_b16 v[122:123], v205 offset:53248
 v_mfma_f32_16x16x32_bf16 v[36:39], v[104:107], v[88:91], v[36:39]
 ds_read_b64_tr_b16 v[124:125], v206 offset:49152
 v_mfma_f32_16x16x32_bf16 v[40:43], v[104:107], v[92:95], v[40:43]
 ds_read_b64_tr_b16 v[126:127], v206 offset:53248
 v_mfma_f32_16x16x32_bf16 v[184:187], v[12:15], v[88:91], v[184:187]
 ds_read_b128 v[136:139], v3 offset:2048
 v_mfma_f32_16x16x32_bf16 v[44:47], v[108:111], v[84:87], v[44:47]
 ds_read_b128 v[140:143], v3 offset:4096
 v_mfma_f32_16x16x32_bf16 v[48:51], v[108:111], v[88:91], v[48:51]
 ds_read_b128 v[144:147], v3 offset:6144
 v_mfma_f32_16x16x32_bf16 v[52:55], v[108:111], v[92:95], v[52:55]
 v_mfma_f32_16x16x32_bf16 v[188:191], v[12:15], v[92:95], v[188:191]
 v_mfma_f32_16x16x32_bf16 v[56:59], v[112:115], v[84:87], v[56:59]
 v_mfma_f32_16x16x32_bf16 v[60:63], v[112:115], v[88:91], v[60:63]
 v_mfma_f32_16x16x32_bf16 v[64:67], v[112:115], v[92:95], v[64:67]
 s_waitcnt lgkmcnt(0)
 s_cmp_lg_u32 s21, 9
 s_cbranch_scc1 C0_vv_ns9
 buffer_store_dwordx4 v[116:119], v16, s[4:7], s26 offen offset:0 sc1
 buffer_store_dwordx4 v[120:123], v16, s[4:7], s26 offen offset:1024 sc1
 buffer_store_dwordx4 v[124:127], v16, s[4:7], s26 offen offset:2048 sc1
C0_vv_ns9:
 v_mfma_f32_16x16x32_bf16 v[20:23], v[132:135], v[116:119], v[20:23]
 s_barrier
 ds_read_b64_tr_b16 v[84:85], v208 offset:0
 v_mfma_f32_16x16x32_bf16 v[24:27], v[132:135], v[120:123], v[24:27]
 ds_read_b64_tr_b16 v[86:87], v208 offset:4096
 v_mfma_f32_16x16x32_bf16 v[28:31], v[132:135], v[124:127], v[28:31]
 ds_read_b128 v[100:103], v2 offset:8192
 v_mfma_f32_16x16x32_bf16 v[180:183], v[12:15], v[116:119], v[180:183]
 ds_read_b64_tr_b16 v[88:89], v209 offset:0
 v_mfma_f32_16x16x32_bf16 v[32:35], v[136:139], v[116:119], v[32:35]
 ds_read_b64_tr_b16 v[90:91], v209 offset:4096
 v_mfma_f32_16x16x32_bf16 v[36:39], v[136:139], v[120:123], v[36:39]
 ds_read_b64_tr_b16 v[92:93], v210 offset:0
 v_mfma_f32_16x16x32_bf16 v[40:43], v[136:139], v[124:127], v[40:43]
 ds_read_b64_tr_b16 v[94:95], v210 offset:4096
 v_mfma_f32_16x16x32_bf16 v[184:187], v[12:15], v[120:123], v[184:187]
 ds_read_b128 v[104:107], v2 offset:10240
 v_mfma_f32_16x16x32_bf16 v[44:47], v[140:143], v[116:119], v[44:47]
 ds_read_b128 v[108:111], v2 offset:12288
 v_mfma_f32_16x16x32_bf16 v[48:51], v[140:143], v[120:123], v[48:51]
 ds_read_b128 v[112:115], v2 offset:14336
 v_mfma_f32_16x16x32_bf16 v[52:55], v[140:143], v[124:127], v[52:55]
 v_mfma_f32_16x16x32_bf16 v[188:191], v[12:15], v[124:127], v[188:191]
 v_mfma_f32_16x16x32_bf16 v[56:59], v[144:147], v[116:119], v[56:59]
 v_mfma_f32_16x16x32_bf16 v[60:63], v[144:147], v[120:123], v[60:63]
 v_mfma_f32_16x16x32_bf16 v[64:67], v[144:147], v[124:127], v[64:67]
 s_waitcnt lgkmcnt(0)
 s_cmp_lg_u32 s21, 10
 s_cbranch_scc1 C0_vv_ns10
 buffer_store_dwordx4 v[84:87], v16, s[4:7], s26 offen offset:0 sc1
 buffer_store_dwordx4 v[88:91], v16, s[4:7], s26 offen offset:1024 sc1
 buffer_store_dwordx4 v[92:95], v16, s[4:7], s26 offen offset:2048 sc1
C0_vv_ns10:
 v_mfma_f32_16x16x32_bf16 v[20:23], v[100:103], v[84:87], v[20:23]
 ds_read_b64_tr_b16 v[116:117], v208 offset:16384
 v_mfma_f32_16x16x32_bf16 v[24:27], v[100:103], v[88:91], v[24:27]
 ds_read_b64_tr_b16 v[118:119], v208 offset:20480
 v_mfma_f32_16x16x32_bf16 v[28:31], v[100:103], v[92:95], v[28:31]
 ds_read_b128 v[132:135], v3 offset:8192
 v_mfma_f32_16x16x32_bf16 v[180:183], v[12:15], v[84:87], v[180:183]
 ds_read_b64_tr_b16 v[120:121], v209 offset:16384
 v_mfma_f32_16x16x32_bf16 v[32:35], v[104:107], v[84:87], v[32:35]
 ds_read_b64_tr_b16 v[122:123], v209 offset:20480
 v_mfma_f32_16x16x32_bf16 v[36:39], v[104:107], v[88:91], v[36:39]
 ds_read_b64_tr_b16 v[124:125], v210 offset:16384
 v_mfma_f32_16x16x32_bf16 v[40:43], v[104:107], v[92:95], v[40:43]
 ds_read_b64_tr_b16 v[126:127], v210 offset:20480
 v_mfma_f32_16x16x32_bf16 v[184:187], v[12:15], v[88:91], v[184:187]
 ds_read_b128 v[136:139], v3 offset:10240
 v_mfma_f32_16x16x32_bf16 v[44:47], v[108:111], v[84:87], v[44:47]
 ds_read_b128 v[140:143], v3 offset:12288
 v_mfma_f32_16x16x32_bf16 v[48:51], v[108:111], v[88:91], v[48:51]
 ds_read_b128 v[144:147], v3 offset:14336
 v_mfma_f32_16x16x32_bf16 v[52:55], v[108:111], v[92:95], v[52:55]
 v_mfma_f32_16x16x32_bf16 v[188:191], v[12:15], v[92:95], v[188:191]
 v_mfma_f32_16x16x32_bf16 v[56:59], v[112:115], v[84:87], v[56:59]
 v_mfma_f32_16x16x32_bf16 v[60:63], v[112:115], v[88:91], v[60:63]
 v_mfma_f32_16x16x32_bf16 v[64:67], v[112:115], v[92:95], v[64:67]
 s_waitcnt lgkmcnt(0)
 s_mov_b64 exec, 0xffff
 s_add_u32 s23, s43, 0x23a000
 buffer_load_dword v17, v19, s[8:11], s23 offen
 s_mov_b64 exec, -1
 s_cmp_lg_u32 s21, 11
 s_cbranch_scc1 C0_vv_ns11
 buffer_store_dwordx4 v[116:119], v16, s[4:7], s26 offen offset:0 sc1
 buffer_store_dwordx4 v[120:123], v16, s[4:7], s26 offen offset:1024 sc1
 buffer_store_dwordx4 v[124:127], v16, s[4:7], s26 offen offset:2048 sc1
C0_vv_ns11:
 v_mfma_f32_16x16x32_bf16 v[20:23], v[132:135], v[116:119], v[20:23]
 s_barrier
 ds_read_b64_tr_b16 v[84:85], v204 offset:0
 v_mfma_f32_16x16x32_bf16 v[24:27], v[132:135], v[120:123], v[24:27]
 ds_read_b64_tr_b16 v[86:87], v204 offset:4096
 v_mfma_f32_16x16x32_bf16 v[28:31], v[132:135], v[124:127], v[28:31]
 ds_read_b128 v[100:103], v2 offset:16384
 v_mfma_f32_16x16x32_bf16 v[180:183], v[12:15], v[116:119], v[180:183]
 ds_read_b64_tr_b16 v[88:89], v205 offset:0
 v_mfma_f32_16x16x32_bf16 v[32:35], v[136:139], v[116:119], v[32:35]
 ds_read_b64_tr_b16 v[90:91], v205 offset:4096
 v_mfma_f32_16x16x32_bf16 v[36:39], v[136:139], v[120:123], v[36:39]
 ds_read_b64_tr_b16 v[92:93], v206 offset:0
 v_mfma_f32_16x16x32_bf16 v[40:43], v[136:139], v[124:127], v[40:43]
 ds_read_b64_tr_b16 v[94:95], v206 offset:4096
 v_mfma_f32_16x16x32_bf16 v[184:187], v[12:15], v[120:123], v[184:187]
 ds_read_b128 v[104:107], v2 offset:18432
 v_mfma_f32_16x16x32_bf16 v[44:47], v[140:143], v[116:119], v[44:47]
 ds_read_b128 v[108:111], v2 offset:20480
 v_mfma_f32_16x16x32_bf16 v[48:51], v[140:143], v[120:123], v[48:51]
 ds_read_b128 v[112:115], v2 offset:22528
 v_mfma_f32_16x16x32_bf16 v[52:55], v[140:143], v[124:127], v[52:55]
 v_mfma_f32_16x16x32_bf16 v[188:191], v[12:15], v[124:127], v[188:191]
 v_mfma_f32_16x16x32_bf16 v[56:59], v[144:147], v[116:119], v[56:59]
 v_mfma_f32_16x16x32_bf16 v[60:63], v[144:147], v[120:123], v[60:63]
 v_mfma_f32_16x16x32_bf16 v[64:67], v[144:147], v[124:127], v[64:67]
 s_waitcnt lgkmcnt(0)
 s_cmp_lg_u32 s21, 12
 s_cbranch_scc1 C0_vv_ns12
 buffer_store_dwordx4 v[84:87], v16, s[4:7], s26 offen offset:0 sc1
 buffer_store_dwordx4 v[88:91], v16, s[4:7], s26 offen offset:1024 sc1
 buffer_store_dwordx4 v[92:95], v16, s[4:7], s26 offen offset:2048 sc1
C0_vv_ns12:
 v_mfma_f32_16x16x32_bf16 v[20:23], v[100:103], v[84:87], v[20:23]
 ds_read_b64_tr_b16 v[116:117], v204 offset:16384
 v_mfma_f32_16x16x32_bf16 v[24:27], v[100:103], v[88:91], v[24:27]
 ds_read_b64_tr_b16 v[118:119], v204 offset:20480
 v_mfma_f32_16x16x32_bf16 v[28:31], v[100:103], v[92:95], v[28:31]
 ds_read_b128 v[132:135], v3 offset:16384
 v_mfma_f32_16x16x32_bf16 v[180:183], v[12:15], v[84:87], v[180:183]
 ds_read_b64_tr_b16 v[120:121], v205 offset:16384
 v_mfma_f32_16x16x32_bf16 v[32:35], v[104:107], v[84:87], v[32:35]
 ds_read_b64_tr_b16 v[122:123], v205 offset:20480
 v_mfma_f32_16x16x32_bf16 v[36:39], v[104:107], v[88:91], v[36:39]
 ds_read_b64_tr_b16 v[124:125], v206 offset:16384
 v_mfma_f32_16x16x32_bf16 v[40:43], v[104:107], v[92:95], v[40:43]
 ds_read_b64_tr_b16 v[126:127], v206 offset:20480
 v_mfma_f32_16x16x32_bf16 v[184:187], v[12:15], v[88:91], v[184:187]
 ds_read_b128 v[136:139], v3 offset:18432
 v_mfma_f32_16x16x32_bf16 v[44:47], v[108:111], v[84:87], v[44:47]
 ds_read_b128 v[140:143], v3 offset:20480
 v_mfma_f32_16x16x32_bf16 v[48:51], v[108:111], v[88:91], v[48:51]
 ds_read_b128 v[144:147], v3 offset:22528
 v_mfma_f32_16x16x32_bf16 v[52:55], v[108:111], v[92:95], v[52:55]
 v_mfma_f32_16x16x32_bf16 v[188:191], v[12:15], v[92:95], v[188:191]
 v_mfma_f32_16x16x32_bf16 v[56:59], v[112:115], v[84:87], v[56:59]
 v_mfma_f32_16x16x32_bf16 v[60:63], v[112:115], v[88:91], v[60:63]
 v_mfma_f32_16x16x32_bf16 v[64:67], v[112:115], v[92:95], v[64:67]
 s_waitcnt lgkmcnt(0)
 s_cmp_lg_u32 s21, 13
 s_cbranch_scc1 C0_vv_ns13
 buffer_store_dwordx4 v[116:119], v16, s[4:7], s26 offen offset:0 sc1
 buffer_store_dwordx4 v[120:123], v16, s[4:7], s26 offen offset:1024 sc1
 buffer_store_dwordx4 v[124:127], v16, s[4:7], s26 offen offset:2048 sc1
C0_vv_ns13:
 v_mfma_f32_16x16x32_bf16 v[20:23], v[132:135], v[116:119], v[20:23]
 s_barrier
 ds_read_b64_tr_b16 v[84:85], v204 offset:32768
 v_mfma_f32_16x16x32_bf16 v[24:27], v[132:135], v[120:123], v[24:27]
 ds_read_b64_tr_b16 v[86:87], v204 offset:36864
 v_mfma_f32_16x16x32_bf16 v[28:31], v[132:135], v[124:127], v[28:31]
 ds_read_b128 v[100:103], v2 offset:24576
 v_mfma_f32_16x16x32_bf16 v[180:183], v[12:15], v[116:119], v[180:183]
 ds_read_b64_tr_b16 v[88:89], v205 offset:32768
 v_mfma_f32_16x16x32_bf16 v[32:35], v[136:139], v[116:119], v[32:35]
 ds_read_b64_tr_b16 v[90:91], v205 offset:36864
 v_mfma_f32_16x16x32_bf16 v[36:39], v[136:139], v[120:123], v[36:39]
 ds_read_b64_tr_b16 v[92:93], v206 offset:32768
 v_mfma_f32_16x16x32_bf16 v[40:43], v[136:139], v[124:127], v[40:43]
 ds_read_b64_tr_b16 v[94:95], v206 offset:36864
 v_mfma_f32_16x16x32_bf16 v[184:187], v[12:15], v[120:123], v[184:187]
 ds_read_b128 v[104:107], v2 offset:26624
 v_mfma_f32_16x16x32_bf16 v[44:47], v[140:143], v[116:119], v[44:47]
 ds_read_b128 v[108:111], v2 offset:28672
 v_mfma_f32_16x16x32_bf16 v[48:51], v[140:143], v[120:123], v[48:51]
 ds_read_b128 v[112:115], v2 offset:30720
 v_mfma_f32_16x16x32_bf16 v[52:55], v[140:143], v[124:127], v[52:55]
 v_mfma_f32_16x16x32_bf16 v[188:191], v[12:15], v[124:127], v[188:191]
 v_mfma_f32_16x16x32_bf16 v[56:59], v[144:147], v[116:119], v[56:59]
 v_mfma_f32_16x16x32_bf16 v[60:63], v[144:147], v[120:123], v[60:63]
 v_mfma_f32_16x16x32_bf16 v[64:67], v[144:147], v[124:127], v[64:67]
 s_waitcnt lgkmcnt(0)
 s_cmp_lg_u32 s21, 14
 s_cbranch_scc1 C0_vv_ns14
 buffer_store_dwordx4 v[84:87], v16, s[4:7], s26 offen offset:0 sc1
 buffer_store_dwordx4 v[88:91], v16, s[4:7], s26 offen offset:1024 sc1
 buffer_store_dwordx4 v[92:95], v16, s[4:7], s26 offen offset:2048 sc1
C0_vv_ns14:
 v_mfma_f32_16x16x32_bf16 v[20:23], v[100:103], v[84:87], v[20:23]
 ds_read_b64_tr_b16 v[116:117], v204 offset:49152
 v_mfma_f32_16x16x32_bf16 v[24:27], v[100:103], v[88:91], v[24:27]
 ds_read_b64_tr_b16 v[118:119], v204 offset:53248
 v_mfma_f32_16x16x32_bf16 v[28:31], v[100:103], v[92:95], v[28:31]
 ds_read_b128 v[132:135], v3 offset:24576
 v_mfma_f32_16x16x32_bf16 v[180:183], v[12:15], v[84:87], v[180:183]
 ds_read_b64_tr_b16 v[120:121], v205 offset:49152
 v_mfma_f32_16x16x32_bf16 v[32:35], v[104:107], v[84:87], v[32:35]
 ds_read_b64_tr_b16 v[122:123], v205 offset:53248
 v_mfma_f32_16x16x32_bf16 v[36:39], v[104:107], v[88:91], v[36:39]
 ds_read_b64_tr_b16 v[124:125], v206 offset:49152
 v_mfma_f32_16x16x32_bf16 v[40:43], v[104:107], v[92:95], v[40:43]
 ds_read_b64_tr_b16 v[126:127], v206 offset:53248
 v_mfma_f32_16x16x32_bf16 v[184:187], v[12:15], v[88:91], v[184:187]
 ds_read_b128 v[136:139], v3 offset:26624
 v_mfma_f32_16x16x32_bf16 v[44:47], v[108:111], v[84:87], v[44:47]
 ds_read_b128 v[140:143], v3 offset:28672
 v_mfma_f32_16x16x32_bf16 v[48:51], v[108:111], v[88:91], v[48:51]
 ds_read_b128 v[144:147], v3 offset:30720
 v_mfma_f32_16x16x32_bf16 v[52:55], v[108:111], v[92:95], v[52:55]
 v_mfma_f32_16x16x32_bf16 v[188:191], v[12:15], v[92:95], v[188:191]
 v_mfma_f32_16x16x32_bf16 v[56:59], v[112:115], v[84:87], v[56:59]
 v_mfma_f32_16x16x32_bf16 v[60:63], v[112:115], v[88:91], v[60:63]
 v_mfma_f32_16x16x32_bf16 v[64:67], v[112:115], v[92:95], v[64:67]
 s_waitcnt lgkmcnt(0)
 s_cmp_lg_u32 s21, 15
 s_cbranch_scc1 C0_vv_ns15
 buffer_store_dwordx4 v[116:119], v16, s[4:7], s26 offen offset:0 sc1
 buffer_store_dwordx4 v[120:123], v16, s[4:7], s26 offen offset:1024 sc1
 buffer_store_dwordx4 v[124:127], v16, s[4:7], s26 offen offset:2048 sc1
C0_vv_ns15:
 v_mfma_f32_16x16x32_bf16 v[20:23], v[132:135], v[116:119], v[20:23]
 s_barrier
 ds_read_b64_tr_b16 v[84:85], v208 offset:0
 v_mfma_f32_16x16x32_bf16 v[24:27], v[132:135], v[120:123], v[24:27]
 ds_read_b64_tr_b16 v[86:87], v208 offset:4096
 v_mfma_f32_16x16x32_bf16 v[28:31], v[132:135], v[124:127], v[28:31]
 ds_read_b128 v[100:103], v2 offset:0
 v_mfma_f32_16x16x32_bf16 v[180:183], v[12:15], v[116:119], v[180:183]
 ds_read_b64_tr_b16 v[88:89], v209 offset:0
 v_mfma_f32_16x16x32_bf16 v[32:35], v[136:139], v[116:119], v[32:35]
 ds_read_b64_tr_b16 v[90:91], v209 offset:4096
 v_mfma_f32_16x16x32_bf16 v[36:39], v[136:139], v[120:123], v[36:39]
 ds_read_b64_tr_b16 v[92:93], v210 offset:0
 v_mfma_f32_16x16x32_bf16 v[40:43], v[136:139], v[124:127], v[40:43]
 ds_read_b64_tr_b16 v[94:95], v210 offset:4096
 v_mfma_f32_16x16x32_bf16 v[184:187], v[12:15], v[120:123], v[184:187]
 ds_read_b128 v[104:107], v2 offset:2048
 v_mfma_f32_16x16x32_bf16 v[44:47], v[140:143], v[116:119], v[44:47]
 ds_read_b128 v[108:111], v2 offset:4096
 v_mfma_f32_16x16x32_bf16 v[48:51], v[140:143], v[120:123], v[48:51]
 ds_read_b128 v[112:115], v2 offset:6144
 v_mfma_f32_16x16x32_bf16 v[52:55], v[140:143], v[124:127], v[52:55]
 v_mfma_f32_16x16x32_bf16 v[188:191], v[12:15], v[124:127], v[188:191]
 v_mfma_f32_16x16x32_bf16 v[56:59], v[144:147], v[116:119], v[56:59]
 v_mfma_f32_16x16x32_bf16 v[60:63], v[144:147], v[120:123], v[60:63]
 v_mfma_f32_16x16x32_bf16 v[64:67], v[144:147], v[124:127], v[64:67]
 s_waitcnt lgkmcnt(0)
 s_cmp_lg_u32 s21, 16
 s_cbranch_scc1 C0_vv_ns16
 buffer_store_dwordx4 v[84:87], v16, s[4:7], s26 offen offset:0 sc1
 buffer_store_dwordx4 v[88:91], v16, s[4:7], s26 offen offset:1024 sc1
 buffer_store_dwordx4 v[92:95], v16, s[4:7], s26 offen offset:2048 sc1
C0_vv_ns16:
 v_mfma_f32_16x16x32_bf16 v[20:23], v[100:103], v[84:87], v[20:23]
 ds_read_b64_tr_b16 v[116:117], v208 offset:16384
 v_mfma_f32_16x16x32_bf16 v[24:27], v[100:103], v[88:91], v[24:27]
 ds_read_b64_tr_b16 v[118:119], v208 offset:20480
 v_mfma_f32_16x16x32_bf16 v[28:31], v[100:103], v[92:95], v[28:31]
 ds_read_b128 v[132:135], v3 offset:0
 v_mfma_f32_16x16x32_bf16 v[180:183], v[12:15], v[84:87], v[180:183]
 ds_read_b64_tr_b16 v[120:121], v209 offset:16384
 v_mfma_f32_16x16x32_bf16 v[32:35], v[104:107], v[84:87], v[32:35]
 ds_read_b64_tr_b16 v[122:123], v209 offset:20480
 v_mfma_f32_16x16x32_bf16 v[36:39], v[104:107], v[88:91], v[36:39]
 ds_read_b64_tr_b16 v[124:125], v210 offset:16384
 v_mfma_f32_16x16x32_bf16 v[40:43], v[104:107], v[92:95], v[40:43]
 ds_read_b64_tr_b16 v[126:127], v210 offset:20480
 v_mfma_f32_16x16x32_bf16 v[184:187], v[12:15], v[88:91], v[184:187]
 ds_read_b128 v[136:139], v3 offset:2048
 v_mfma_f32_16x16x32_bf16 v[44:47], v[108:111], v[84:87], v[44:47]
 ds_read_b128 v[140:143], v3 offset:4096
 v_mfma_f32_16x16x32_bf16 v[48:51], v[108:111], v[88:91], v[48:51]
 ds_read_b128 v[144:147], v3 offset:6144
 v_mfma_f32_16x16x32_bf16 v[52:55], v[108:111], v[92:95], v[52:55]
 v_mfma_f32_16x16x32_bf16 v[188:191], v[12:15], v[92:95], v[188:191]
 v_mfma_f32_16x16x32_bf16 v[56:59], v[112:115], v[84:87], v[56:59]
 v_mfma_f32_16x16x32_bf16 v[60:63], v[112:115], v[88:91], v[60:63]
 v_mfma_f32_16x16x32_bf16 v[64:67], v[112:115], v[92:95], v[64:67]
 s_waitcnt lgkmcnt(0)
 s_cmp_lg_u32 s21, 17
 s_cbranch_scc1 C0_vv_ns17
 buffer_store_dwordx4 v[116:119], v16, s[4:7], s26 offen offset:0 sc1
 buffer_store_dwordx4 v[120:123], v16, s[4:7], s26 offen offset:1024 sc1
 buffer_store_dwordx4 v[124:127], v16, s[4:7], s26 offen offset:2048 sc1
C0_vv_ns17:
 v_mfma_f32_16x16x32_bf16 v[20:23], v[132:135], v[116:119], v[20:23]
 s_barrier
 ds_read_b64_tr_b16 v[84:85], v204 offset:0
 v_mfma_f32_16x16x32_bf16 v[24:27], v[132:135], v[120:123], v[24:27]
 ds_read_b64_tr_b16 v[86:87], v204 offset:4096
 v_mfma_f32_16x16x32_bf16 v[28:31], v[132:135], v[124:127], v[28:31]
 ds_read_b128 v[100:103], v2 offset:8192
 v_mfma_f32_16x16x32_bf16 v[180:183], v[12:15], v[116:119], v[180:183]
 ds_read_b64_tr_b16 v[88:89], v205 offset:0
 v_mfma_f32_16x16x32_bf16 v[32:35], v[136:139], v[116:119], v[32:35]
 ds_read_b64_tr_b16 v[90:91], v205 offset:4096
 v_mfma_f32_16x16x32_bf16 v[36:39], v[136:139], v[120:123], v[36:39]
 ds_read_b64_tr_b16 v[92:93], v206 offset:0
 v_mfma_f32_16x16x32_bf16 v[40:43], v[136:139], v[124:127], v[40:43]
 ds_read_b64_tr_b16 v[94:95], v206 offset:4096
 v_mfma_f32_16x16x32_bf16 v[184:187], v[12:15], v[120:123], v[184:187]
 ds_read_b128 v[104:107], v2 offset:10240
 v_mfma_f32_16x16x32_bf16 v[44:47], v[140:143], v[116:119], v[44:47]
 ds_read_b128 v[108:111], v2 offset:12288
 v_mfma_f32_16x16x32_bf16 v[48:51], v[140:143], v[120:123], v[48:51]
 ds_read_b128 v[112:115], v2 offset:14336
 v_mfma_f32_16x16x32_bf16 v[52:55], v[140:143], v[124:127], v[52:55]
 v_mfma_f32_16x16x32_bf16 v[188:191], v[12:15], v[124:127], v[188:191]
 v_mfma_f32_16x16x32_bf16 v[56:59], v[144:147], v[116:119], v[56:59]
 v_mfma_f32_16x16x32_bf16 v[60:63], v[144:147], v[120:123], v[60:63]
 v_mfma_f32_16x16x32_bf16 v[64:67], v[144:147], v[124:127], v[64:67]
 s_waitcnt lgkmcnt(0)
 s_cmp_lg_u32 s21, 18
 s_cbranch_scc1 C0_vv_ns18
 buffer_store_dwordx4 v[84:87], v16, s[4:7], s26 offen offset:0 sc1
 buffer_store_dwordx4 v[88:91], v16, s[4:7], s26 offen offset:1024 sc1
 buffer_store_dwordx4 v[92:95], v16, s[4:7], s26 offen offset:2048 sc1
C0_vv_ns18:
 v_mfma_f32_16x16x32_bf16 v[20:23], v[100:103], v[84:87], v[20:23]
 ds_read_b64_tr_b16 v[116:117], v204 offset:16384
 v_mfma_f32_16x16x32_bf16 v[24:27], v[100:103], v[88:91], v[24:27]
 ds_read_b64_tr_b16 v[118:119], v204 offset:20480
 v_mfma_f32_16x16x32_bf16 v[28:31], v[100:103], v[92:95], v[28:31]
 ds_read_b128 v[132:135], v3 offset:8192
 v_mfma_f32_16x16x32_bf16 v[180:183], v[12:15], v[84:87], v[180:183]
 ds_read_b64_tr_b16 v[120:121], v205 offset:16384
 v_mfma_f32_16x16x32_bf16 v[32:35], v[104:107], v[84:87], v[32:35]
 ds_read_b64_tr_b16 v[122:123], v205 offset:20480
 v_mfma_f32_16x16x32_bf16 v[36:39], v[104:107], v[88:91], v[36:39]
 ds_read_b64_tr_b16 v[124:125], v206 offset:16384
 v_mfma_f32_16x16x32_bf16 v[40:43], v[104:107], v[92:95], v[40:43]
 ds_read_b64_tr_b16 v[126:127], v206 offset:20480
 v_mfma_f32_16x16x32_bf16 v[184:187], v[12:15], v[88:91], v[184:187]
 ds_read_b128 v[136:139], v3 offset:10240
 v_mfma_f32_16x16x32_bf16 v[44:47], v[108:111], v[84:87], v[44:47]
 ds_read_b128 v[140:143], v3 offset:12288
 v_mfma_f32_16x16x32_bf16 v[48:51], v[108:111], v[88:91], v[48:51]
 ds_read_b128 v[144:147], v3 offset:14336
 v_mfma_f32_16x16x32_bf16 v[52:55], v[108:111], v[92:95], v[52:55]
 v_mfma_f32_16x16x32_bf16 v[188:191], v[12:15], v[92:95], v[188:191]
 v_mfma_f32_16x16x32_bf16 v[56:59], v[112:115], v[84:87], v[56:59]
 v_mfma_f32_16x16x32_bf16 v[60:63], v[112:115], v[88:91], v[60:63]
 v_mfma_f32_16x16x32_bf16 v[64:67], v[112:115], v[92:95], v[64:67]
 s_waitcnt lgkmcnt(0)
 s_cmp_lg_u32 s21, 19
 s_cbranch_scc1 C0_vv_ns19
 buffer_store_dwordx4 v[116:119], v16, s[4:7], s26 offen offset:0 sc1
 buffer_store_dwordx4 v[120:123], v16, s[4:7], s26 offen offset:1024 sc1
 buffer_store_dwordx4 v[124:127], v16, s[4:7], s26 offen offset:2048 sc1
C0_vv_ns19:
 v_mfma_f32_16x16x32_bf16 v[20:23], v[132:135], v[116:119], v[20:23]
 s_barrier
 v_mfma_f32_16x16x32_bf16 v[24:27], v[132:135], v[120:123], v[24:27]
 v_mfma_f32_16x16x32_bf16 v[28:31], v[132:135], v[124:127], v[28:31]
 v_mfma_f32_16x16x32_bf16 v[180:183], v[12:15], v[116:119], v[180:183]
 v_mfma_f32_16x16x32_bf16 v[32:35], v[136:139], v[116:119], v[32:35]
 v_mfma_f32_16x16x32_bf16 v[36:39], v[136:139], v[120:123], v[36:39]
 v_mfma_f32_16x16x32_bf16 v[40:43], v[136:139], v[124:127], v[40:43]
 v_mfma_f32_16x16x32_bf16 v[184:187], v[12:15], v[120:123], v[184:187]
 v_mfma_f32_16x16x32_bf16 v[44:47], v[140:143], v[116:119], v[44:47]
 v_mfma_f32_16x16x32_bf16 v[48:51], v[140:143], v[120:123], v[48:51]
 v_mfma_f32_16x16x32_bf16 v[52:55], v[140:143], v[124:127], v[52:55]
 v_mfma_f32_16x16x32_bf16 v[188:191], v[12:15], v[124:127], v[188:191]
 v_mfma_f32_16x16x32_bf16 v[56:59], v[144:147], v[116:119], v[56:59]
 v_mfma_f32_16x16x32_bf16 v[60:63], v[144:147], v[120:123], v[60:63]
 v_mfma_f32_16x16x32_bf16 v[64:67], v[144:147], v[124:127], v[64:67]
 v_lshrrev_b32 v9, 4, v1
 v_lshlrev_b32 v9, 4, v9
 v_add_u32 v9, 161792, v9
 ds_read_b128 v[92:95], v9 offset:0
 ds_read_b128 v[108:111], v9 offset:256
 ds_read_b128 v[96:99], v9 offset:64
 ds_read_b128 v[112:115], v9 offset:320
 ds_read_b128 v[100:103], v9 offset:128
 ds_read_b128 v[116:119], v9 offset:384
 ds_read_b128 v[104:107], v9 offset:192
 ds_read_b128 v[120:123], v9 offset:448
 v_mov_b32 v196, v180
 v_mov_b32 v197, v184
 v_mov_b32 v198, v188
 s_cmp_lg_u32 s21, 20
 s_cbranch_scc1 C0_vv_nocs
 v_lshlrev_b32 v8, 2, v1
 s_mov_b64 exec, 0xffff
 buffer_store_dword v180, v8, s[4:7], s31 offen offset:0
 buffer_store_dword v184, v8, s[4:7], s31 offen offset:64
 buffer_store_dword v188, v8, s[4:7], s31 offen offset:128
 s_mov_b64 exec, -1
C0_vv_nocs:
 s_waitcnt lgkmcnt(0)
 v_pk_mul_f32 v[204:205], v[108:109], v[196:197] op_sel:[0,0] op_sel_hi:[1,0]
 v_pk_mul_f32 v[206:207], v[110:111], v[196:197] op_sel:[0,0] op_sel_hi:[1,0]
 v_pk_mul_f32 v[208:209], v[112:113], v[196:197] op_sel:[0,0] op_sel_hi:[1,0]
 v_pk_mul_f32 v[210:211], v[114:115], v[196:197] op_sel:[0,0] op_sel_hi:[1,0]
 v_pk_fma_f32 v[204:205], v[20:21], v[92:93], v[204:205] neg_lo:[0,0,1] neg_hi:[0,0,1]
 v_pk_fma_f32 v[206:207], v[22:23], v[94:95], v[206:207] neg_lo:[0,0,1] neg_hi:[0,0,1]
 v_pk_fma_f32 v[208:209], v[32:33], v[96:97], v[208:209] neg_lo:[0,0,1] neg_hi:[0,0,1]
 v_pk_fma_f32 v[210:211], v[34:35], v[98:99], v[210:211] neg_lo:[0,0,1] neg_hi:[0,0,1]
 v_cvt_pk_bf16_f32 v212, v204, v205
 v_cvt_pk_bf16_f32 v213, v206, v207
 v_cvt_pk_bf16_f32 v214, v208, v209
 v_cvt_pk_bf16_f32 v215, v210, v211
 s_nop 0
 v_permlane32_swap_b32 v212, v214
 v_permlane32_swap_b32 v213, v215
 buffer_store_dwordx4 v[212:215], v200, s[4:7], s28 offen offset:0
 v_pk_mul_f32 v[220:221], v[116:117], v[196:197] op_sel:[0,0] op_sel_hi:[1,0]
 v_pk_mul_f32 v[222:223], v[118:119], v[196:197] op_sel:[0,0] op_sel_hi:[1,0]
 v_pk_mul_f32 v[224:225], v[120:121], v[196:197] op_sel:[0,0] op_sel_hi:[1,0]
 v_pk_mul_f32 v[226:227], v[122:123], v[196:197] op_sel:[0,0] op_sel_hi:[1,0]
 v_pk_fma_f32 v[220:221], v[44:45], v[100:101], v[220:221] neg_lo:[0,0,1] neg_hi:[0,0,1]
 v_pk_fma_f32 v[222:223], v[46:47], v[102:103], v[222:223] neg_lo:[0,0,1] neg_hi:[0,0,1]
 v_pk_fma_f32 v[224:225], v[56:57], v[104:105], v[224:225] neg_lo:[0,0,1] neg_hi:[0,0,1]
 v_pk_fma_f32 v[226:227], v[58:59], v[106:107], v[226:227] neg_lo:[0,0,1] neg_hi:[0,0,1]
 v_cvt_pk_bf16_f32 v228, v220, v221
 v_cvt_pk_bf16_f32 v229, v222, v223
 v_cvt_pk_bf16_f32 v230, v224, v225
 v_cvt_pk_bf16_f32 v231, v226, v227
 s_nop 0
 v_permlane32_swap_b32 v228, v230
 v_permlane32_swap_b32 v229, v231
 buffer_store_dwordx4 v[228:231], v200, s[4:7], s28 offen offset:1344
 v_pk_mul_f32 v[204:205], v[108:109], v[196:197] op_sel:[0,1] op_sel_hi:[1,1]
 v_pk_mul_f32 v[206:207], v[110:111], v[196:197] op_sel:[0,1] op_sel_hi:[1,1]
 v_pk_mul_f32 v[208:209], v[112:113], v[196:197] op_sel:[0,1] op_sel_hi:[1,1]
 v_pk_mul_f32 v[210:211], v[114:115], v[196:197] op_sel:[0,1] op_sel_hi:[1,1]
 v_pk_fma_f32 v[204:205], v[24:25], v[92:93], v[204:205] neg_lo:[0,0,1] neg_hi:[0,0,1]
 v_pk_fma_f32 v[206:207], v[26:27], v[94:95], v[206:207] neg_lo:[0,0,1] neg_hi:[0,0,1]
 v_pk_fma_f32 v[208:209], v[36:37], v[96:97], v[208:209] neg_lo:[0,0,1] neg_hi:[0,0,1]
 v_pk_fma_f32 v[210:211], v[38:39], v[98:99], v[210:211] neg_lo:[0,0,1] neg_hi:[0,0,1]
 v_cvt_pk_bf16_f32 v212, v204, v205
 v_cvt_pk_bf16_f32 v213, v206, v207
 v_cvt_pk_bf16_f32 v214, v208, v209
 v_cvt_pk_bf16_f32 v215, v210, v211
 s_nop 0
 v_permlane32_swap_b32 v212, v214
 v_permlane32_swap_b32 v213, v215
 buffer_store_dwordx4 v[212:215], v201, s[4:7], s28 offen offset:0
 v_pk_mul_f32 v[220:221], v[116:117], v[196:197] op_sel:[0,1] op_sel_hi:[1,1]
 v_pk_mul_f32 v[222:223], v[118:119], v[196:197] op_sel:[0,1] op_sel_hi:[1,1]
 v_pk_mul_f32 v[224:225], v[120:121], v[196:197] op_sel:[0,1] op_sel_hi:[1,1]
 v_pk_mul_f32 v[226:227], v[122:123], v[196:197] op_sel:[0,1] op_sel_hi:[1,1]
 v_pk_fma_f32 v[220:221], v[48:49], v[100:101], v[220:221] neg_lo:[0,0,1] neg_hi:[0,0,1]
 v_pk_fma_f32 v[222:223], v[50:51], v[102:103], v[222:223] neg_lo:[0,0,1] neg_hi:[0,0,1]
 v_pk_fma_f32 v[224:225], v[60:61], v[104:105], v[224:225] neg_lo:[0,0,1] neg_hi:[0,0,1]
 v_pk_fma_f32 v[226:227], v[62:63], v[106:107], v[226:227] neg_lo:[0,0,1] neg_hi:[0,0,1]
 v_cvt_pk_bf16_f32 v228, v220, v221
 v_cvt_pk_bf16_f32 v229, v222, v223
 v_cvt_pk_bf16_f32 v230, v224, v225
 v_cvt_pk_bf16_f32 v231, v226, v227
 s_nop 0
 v_permlane32_swap_b32 v228, v230
 v_permlane32_swap_b32 v229, v231
 buffer_store_dwordx4 v[228:231], v201, s[4:7], s28 offen offset:1344
 v_pk_mul_f32 v[204:205], v[108:109], v[198:199] op_sel:[0,0] op_sel_hi:[1,0]
 v_pk_mul_f32 v[206:207], v[110:111], v[198:199] op_sel:[0,0] op_sel_hi:[1,0]
 v_pk_mul_f32 v[208:209], v[112:113], v[198:199] op_sel:[0,0] op_sel_hi:[1,0]
 v_pk_mul_f32 v[210:211], v[114:115], v[198:199] op_sel:[0,0] op_sel_hi:[1,0]
 v_pk_fma_f32 v[204:205], v[28:29], v[92:93], v[204:205] neg_lo:[0,0,1] neg_hi:[0,0,1]
 v_pk_fma_f32 v[206:207], v[30:31], v[94:95], v[206:207] neg_lo:[0,0,1] neg_hi:[0,0,1]
 v_pk_fma_f32 v[208:209], v[40:41], v[96:97], v[208:209] neg_lo:[0,0,1] neg_hi:[0,0,1]
 v_pk_fma_f32 v[210:211], v[42:43], v[98:99], v[210:211] neg_lo:[0,0,1] neg_hi:[0,0,1]
 v_cvt_pk_bf16_f32 v212, v204, v205
 v_cvt_pk_bf16_f32 v213, v206, v207
 v_cvt_pk_bf16_f32 v214, v208, v209
 v_cvt_pk_bf16_f32 v215, v210, v211
 s_nop 0
 v_permlane32_swap_b32 v212, v214
 v_permlane32_swap_b32 v213, v215
 buffer_store_dwordx4 v[212:215], v202, s[4:7], s28 offen offset:0
 v_pk_mul_f32 v[220:221], v[116:117], v[198:199] op_sel:[0,0] op_sel_hi:[1,0]
 v_pk_mul_f32 v[222:223], v[118:119], v[198:199] op_sel:[0,0] op_sel_hi:[1,0]
 v_pk_mul_f32 v[224:225], v[120:121], v[198:199] op_sel:[0,0] op_sel_hi:[1,0]
 v_pk_mul_f32 v[226:227], v[122:123], v[198:199] op_sel:[0,0] op_sel_hi:[1,0]
 v_pk_fma_f32 v[220:221], v[52:53], v[100:101], v[220:221] neg_lo:[0,0,1] neg_hi:[0,0,1]
 v_pk_fma_f32 v[222:223], v[54:55], v[102:103], v[222:223] neg_lo:[0,0,1] neg_hi:[0,0,1]
 v_pk_fma_f32 v[224:225], v[64:65], v[104:105], v[224:225] neg_lo:[0,0,1] neg_hi:[0,0,1]
 v_pk_fma_f32 v[226:227], v[66:67], v[106:107], v[226:227] neg_lo:[0,0,1] neg_hi:[0,0,1]
 v_cvt_pk_bf16_f32 v228, v220, v221
 v_cvt_pk_bf16_f32 v229, v222, v223
 v_cvt_pk_bf16_f32 v230, v224, v225
 v_cvt_pk_bf16_f32 v231, v226, v227
 s_nop 0
 v_permlane32_swap_b32 v228, v230
 v_permlane32_swap_b32 v229, v231
 buffer_store_dwordx4 v[228:231], v202, s[4:7], s28 offen offset:1344
 s_endpgm
C0_bl0:
 s_mul_i32 s23, s22, 320
 v_mov_b32 v4, s23
 s_mul_i32 s23, s22, 160
 s_add_u32 s23, s23, 2240
 v_mov_b32 v5, s23
 s_movk_i32 s30, 3840
 v_and_b32 v6, 31, v1
 v_lshrrev_b32 v7, 5, v1
 v_lshlrev_b32 v8, 1, v7
 v_xor_b32 v6, v6, v8
 v_xor_b32 v9, 0, v6
 v_min_u32 v9, 29, v9
 v_cmp_gt_u32 vcc, 20, v9
 s_nop 1
 v_cndmask_b32 v10, v5, v4, vcc
 v_lshl_add_u32 v16, v9, 4, v10
 v_mad_u32_u24 v16, v7, s30, v16
 v_xor_b32 v9, 8, v6
 v_min_u32 v9, 29, v9
 v_cmp_gt_u32 vcc, 20, v9
 s_nop 1
 v_cndmask_b32 v10, v5, v4, vcc
 v_lshl_add_u32 v17, v9, 4, v10
 v_mad_u32_u24 v17, v7, s30, v17
 s_waitcnt lgkmcnt(0)
 s_mov_b32 s8, s14
 s_mov_b32 s9, s15
 s_mov_b32 s10, 0x258000
 s_mov_b32 s11, 0x00020000
 s_mov_b32 s24, 0x0
 s_mov_b32 m0, 0x8000
 s_nop 0
 buffer_load_dwordx4 v16, s[8:11], s24 offen lds
 s_mov_b32 s24, 0x7800
 s_mov_b32 m0, 0x8800
 s_nop 0
 buffer_load_dwordx4 v17, s[8:11], s24 offen lds
 s_mov_b32 s24, 0x3c00
 s_mov_b32 m0, 0x9000
 s_nop 0
 buffer_load_dwordx4 v16, s[8:11], s24 offen lds
 s_mov_b32 s24, 0xb400
 s_mov_b32 m0, 0x9800
 s_nop 0
 buffer_load_dwordx4 v17, s[8:11], s24 offen lds
 s_mov_b32 s24, 0xf000
 s_mov_b32 m0, 0xa000
 s_nop 0
 buffer_load_dwordx4 v16, s[8:11], s24 offen lds
 s_mov_b32 s24, 0x16800
 s_mov_b32 m0, 0xa800
 s_nop 0
 buffer_load_dwordx4 v17, s[8:11], s24 offen lds
 s_mov_b32 s24, 0x12c00
 s_mov_b32 m0, 0xb000
 s_nop 0
 buffer_load_dwordx4 v16, s[8:11], s24 offen lds
 s_mov_b32 s24, 0x1a400
 s_mov_b32 m0, 0xb800
 s_nop 0
 buffer_load_dwordx4 v17, s[8:11], s24 offen lds
 s_mov_b32 s24, 0x1e000
 s_mov_b32 m0, 0xc000
 s_nop 0
 buffer_load_dwordx4 v16, s[8:11], s24 offen lds
 s_mov_b32 s24, 0x25800
 s_mov_b32 m0, 0xc800
 s_nop 0
 buffer_load_dwordx4 v17, s[8:11], s24 offen lds
 s_mov_b32 s24, 0x21c00
 s_mov_b32 m0, 0xd000
 s_nop 0
 buffer_load_dwordx4 v16, s[8:11], s24 offen lds
 s_mov_b32 s24, 0x29400
 s_mov_b32 m0, 0xd800
 s_nop 0
 buffer_load_dwordx4 v17, s[8:11], s24 offen lds
 s_mov_b32 s24, 0x2d000
 s_mov_b32 m0, 0xe000
 s_nop 0
 buffer_load_dwordx4 v16, s[8:11], s24 offen lds
 s_mov_b32 s24, 0x34800
 s_mov_b32 m0, 0xe800
 s_nop 0
 buffer_load_dwordx4 v17, s[8:11], s24 offen lds
 s_mov_b32 s24, 0x30c00
 s_mov_b32 m0, 0xf000
 s_nop 0
 buffer_load_dwordx4 v16, s[8:11], s24 offen lds
 s_mov_b32 s24, 0x38400
 s_mov_b32 m0, 0xf800
 s_nop 0
 buffer_load_dwordx4 v17, s[8:11], s24 offen lds
 s_mov_b32 s24, 0x3c000
 s_mov_b32 m0, 0x10000
 s_nop 0
 buffer_load_dwordx4 v16, s[8:11], s24 offen lds
 s_mov_b32 s24, 0x43800
 s_mov_b32 m0, 0x10800
 s_nop 0
 buffer_load_dwordx4 v17, s[8:11], s24 offen lds
 s_mov_b32 s24, 0x3fc00
 s_mov_b32 m0, 0x11000
 s_nop 0
 buffer_load_dwordx4 v16, s[8:11], s24 offen lds
 s_mov_b32 s24, 0x47400
 s_mov_b32 m0, 0x11800
 s_nop 0
 buffer_load_dwordx4 v17, s[8:11], s24 offen lds
 s_mov_b32 s24, 0x4b000
 s_mov_b32 m0, 0x12000
 s_nop 0
 buffer_load_dwordx4 v16, s[8:11], s24 offen lds
 s_mov_b32 s24, 0x52800
 s_mov_b32 m0, 0x12800
 s_nop 0
 buffer_load_dwordx4 v17, s[8:11], s24 offen lds
 s_mov_b32 s24, 0x4ec00
 s_mov_b32 m0, 0x13000
 s_nop 0
 buffer_load_dwordx4 v16, s[8:11], s24 offen lds
 s_mov_b32 s24, 0x56400
 s_mov_b32 m0, 0x13800
 s_nop 0
 buffer_load_dwordx4 v17, s[8:11], s24 offen lds
 s_mov_b32 s24, 0x5a000
 s_mov_b32 m0, 0x14000
 s_nop 0
 buffer_load_dwordx4 v16, s[8:11], s24 offen lds
 s_mov_b32 s24, 0x61800
 s_mov_b32 m0, 0x14800
 s_nop 0
 buffer_load_dwordx4 v17, s[8:11], s24 offen lds
 s_mov_b32 s24, 0x5dc00
 s_mov_b32 m0, 0x15000
 s_nop 0
 buffer_load_dwordx4 v16, s[8:11], s24 offen lds
 s_mov_b32 s24, 0x65400
 s_mov_b32 m0, 0x15800
 s_nop 0
 buffer_load_dwordx4 v17, s[8:11], s24 offen lds
 s_mov_b32 s24, 0x69000
 s_mov_b32 m0, 0x16000
 s_nop 0
 buffer_load_dwordx4 v16, s[8:11], s24 offen lds
 s_mov_b32 s24, 0x70800
 s_mov_b32 m0, 0x16800
 s_nop 0
 buffer_load_dwordx4 v17, s[8:11], s24 offen lds
 s_mov_b32 s24, 0x6cc00
 s_mov_b32 m0, 0x17000
 s_nop 0
 buffer_load_dwordx4 v16, s[8:11], s24 offen lds
 s_mov_b32 s24, 0x74400
 s_mov_b32 m0, 0x17800
 s_nop 0
 buffer_load_dwordx4 v17, s[8:11], s24 offen lds
 v_and_b32 v8, 15, v1
 v_lshrrev_b32 v9, 4, v1
 v_lshrrev_b32 v7, 1, v8
 v_xor_b32 v7, v7, v9
 v_lshlrev_b32 v7, 4, v7
 v_lshlrev_b32 v2, 7, v8
 v_add_u32 v2, v2, v7
 v_xor_b32 v3, 64, v2
 s_sub_u32 s23, s20, 4
 s_lshl_b32 s23, s23, 11
 v_add_u32 v2, s23, v2
 v_add_u32 v3, s23, v3
 v_mov_b32 v48, 0x3f803f80
 v_mov_b32 v49, 0x3f803f80
 v_mov_b32 v50, 0x3f803f80
 v_mov_b32 v51, 0x3f803f80
 s_waitcnt vmcnt(16)
 s_barrier
 s_mov_b32 s24, 0x78000
 s_mov_b32 m0, 0x18000
 s_nop 0
 buffer_load_dwordx4 v16, s[8:11], s24 offen lds
 s_mov_b32 s24, 0x7f800
 s_mov_b32 m0, 0x18800
 s_nop 0
 buffer_load_dwordx4 v17, s[8:11], s24 offen lds
 s_mov_b32 s24, 0x7bc00
 s_mov_b32 m0, 0x19000
 s_nop 0
 buffer_load_dwordx4 v16, s[8:11], s24 offen lds
 s_mov_b32 s24, 0x83400
 s_mov_b32 m0, 0x19800
 s_nop 0
 buffer_load_dwordx4 v17, s[8:11], s24 offen lds
 s_mov_b32 s24, 0x87000
 s_mov_b32 m0, 0x1a000
 s_nop 0
 buffer_load_dwordx4 v16, s[8:11], s24 offen lds
 s_mov_b32 s24, 0x8e800
 s_mov_b32 m0, 0x1a800
 s_nop 0
 buffer_load_dwordx4 v17, s[8:11], s24 offen lds
 s_mov_b32 s24, 0x8ac00
 s_mov_b32 m0, 0x1b000
 s_nop 0
 buffer_load_dwordx4 v16, s[8:11], s24 offen lds
 s_mov_b32 s24, 0x92400
 s_mov_b32 m0, 0x1b800
 s_nop 0
 buffer_load_dwordx4 v17, s[8:11], s24 offen lds
 s_mov_b32 s24, 0x96000
 s_mov_b32 m0, 0x1c000
 s_nop 0
 buffer_load_dwordx4 v16, s[8:11], s24 offen lds
 s_mov_b32 s24, 0x9d800
 s_mov_b32 m0, 0x1c800
 s_nop 0
 buffer_load_dwordx4 v17, s[8:11], s24 offen lds
 s_mov_b32 s24, 0x99c00
 s_mov_b32 m0, 0x1d000
 s_nop 0
 buffer_load_dwordx4 v16, s[8:11], s24 offen lds
 s_mov_b32 s24, 0xa1400
 s_mov_b32 m0, 0x1d800
 s_nop 0
 buffer_load_dwordx4 v17, s[8:11], s24 offen lds
 s_mov_b32 s24, 0xa5000
 s_mov_b32 m0, 0x1e000
 s_nop 0
 buffer_load_dwordx4 v16, s[8:11], s24 offen lds
 s_mov_b32 s24, 0xac800
 s_mov_b32 m0, 0x1e800
 s_nop 0
 buffer_load_dwordx4 v17, s[8:11], s24 offen lds
 s_mov_b32 s24, 0xa8c00
 s_mov_b32 m0, 0x1f000
 s_nop 0
 buffer_load_dwordx4 v16, s[8:11], s24 offen lds
 s_mov_b32 s24, 0xb0400
 s_mov_b32 m0, 0x1f800
 s_nop 0
 buffer_load_dwordx4 v17, s[8:11], s24 offen lds
 ds_read_b128 v[52:55], v2 offset:0
 ds_read_b128 v[56:59], v3 offset:0
 s_waitcnt lgkmcnt(0)
 v_mfma_f32_16x16x32_bf16 v[40:43], v[52:55], v[52:55], 0
 v_mfma_f32_16x16x32_bf16 v[44:47], v[48:51], v[52:55], 0
 v_mfma_f32_16x16x32_bf16 v[40:43], v[56:59], v[56:59], v[40:43]
 v_mfma_f32_16x16x32_bf16 v[44:47], v[48:51], v[56:59], v[44:47]
 s_waitcnt vmcnt(16)
 s_barrier
 s_mov_b32 s24, 0xb4000
 s_mov_b32 m0, 0x8000
 s_nop 0
 buffer_load_dwordx4 v16, s[8:11], s24 offen lds
 s_mov_b32 s24, 0xbb800
 s_mov_b32 m0, 0x8800
 s_nop 0
 buffer_load_dwordx4 v17, s[8:11], s24 offen lds
 s_mov_b32 s24, 0xb7c00
 s_mov_b32 m0, 0x9000
 s_nop 0
 buffer_load_dwordx4 v16, s[8:11], s24 offen lds
 s_mov_b32 s24, 0xbf400
 s_mov_b32 m0, 0x9800
 s_nop 0
 buffer_load_dwordx4 v17, s[8:11], s24 offen lds
 s_mov_b32 s24, 0xc3000
 s_mov_b32 m0, 0xa000
 s_nop 0
 buffer_load_dwordx4 v16, s[8:11], s24 offen lds
 s_mov_b32 s24, 0xca800
 s_mov_b32 m0, 0xa800
 s_nop 0
 buffer_load_dwordx4 v17, s[8:11], s24 offen lds
 s_mov_b32 s24, 0xc6c00
 s_mov_b32 m0, 0xb000
 s_nop 0
 buffer_load_dwordx4 v16, s[8:11], s24 offen lds
 s_mov_b32 s24, 0xce400
 s_mov_b32 m0, 0xb800
 s_nop 0
 buffer_load_dwordx4 v17, s[8:11], s24 offen lds
 s_mov_b32 s24, 0xd2000
 s_mov_b32 m0, 0xc000
 s_nop 0
 buffer_load_dwordx4 v16, s[8:11], s24 offen lds
 s_mov_b32 s24, 0xd9800
 s_mov_b32 m0, 0xc800
 s_nop 0
 buffer_load_dwordx4 v17, s[8:11], s24 offen lds
 s_mov_b32 s24, 0xd5c00
 s_mov_b32 m0, 0xd000
 s_nop 0
 buffer_load_dwordx4 v16, s[8:11], s24 offen lds
 s_mov_b32 s24, 0xdd400
 s_mov_b32 m0, 0xd800
 s_nop 0
 buffer_load_dwordx4 v17, s[8:11], s24 offen lds
 s_mov_b32 s24, 0xe1000
 s_mov_b32 m0, 0xe000
 s_nop 0
 buffer_load_dwordx4 v16, s[8:11], s24 offen lds
 s_mov_b32 s24, 0xe8800
 s_mov_b32 m0, 0xe800
 s_nop 0
 buffer_load_dwordx4 v17, s[8:11], s24 offen lds
 s_mov_b32 s24, 0xe4c00
 s_mov_b32 m0, 0xf000
 s_nop 0
 buffer_load_dwordx4 v16, s[8:11], s24 offen lds
 s_mov_b32 s24, 0xec400
 s_mov_b32 m0, 0xf800
 s_nop 0
 buffer_load_dwordx4 v17, s[8:11], s24 offen lds
 ds_read_b128 v[52:55], v2 offset:8192
 ds_read_b128 v[56:59], v3 offset:8192
 s_waitcnt lgkmcnt(0)
 v_mfma_f32_16x16x32_bf16 v[40:43], v[52:55], v[52:55], v[40:43]
 v_mfma_f32_16x16x32_bf16 v[44:47], v[48:51], v[52:55], v[44:47]
 v_mfma_f32_16x16x32_bf16 v[40:43], v[56:59], v[56:59], v[40:43]
 v_mfma_f32_16x16x32_bf16 v[44:47], v[48:51], v[56:59], v[44:47]
 s_waitcnt vmcnt(16)
 s_barrier
 s_mov_b32 s24, 0xf0000
 s_mov_b32 m0, 0x10000
 s_nop 0
 buffer_load_dwordx4 v16, s[8:11], s24 offen lds
 s_mov_b32 s24, 0xf7800
 s_mov_b32 m0, 0x10800
 s_nop 0
 buffer_load_dwordx4 v17, s[8:11], s24 offen lds
 s_mov_b32 s24, 0xf3c00
 s_mov_b32 m0, 0x11000
 s_nop 0
 buffer_load_dwordx4 v16, s[8:11], s24 offen lds
 s_mov_b32 s24, 0xfb400
 s_mov_b32 m0, 0x11800
 s_nop 0
 buffer_load_dwordx4 v17, s[8:11], s24 offen lds
 s_mov_b32 s24, 0xff000
 s_mov_b32 m0, 0x12000
 s_nop 0
 buffer_load_dwordx4 v16, s[8:11], s24 offen lds
 s_mov_b32 s24, 0x106800
 s_mov_b32 m0, 0x12800
 s_nop 0
 buffer_load_dwordx4 v17, s[8:11], s24 offen lds
 s_mov_b32 s24, 0x102c00
 s_mov_b32 m0, 0x13000
 s_nop 0
 buffer_load_dwordx4 v16, s[8:11], s24 offen lds
 s_mov_b32 s24, 0x10a400
 s_mov_b32 m0, 0x13800
 s_nop 0
 buffer_load_dwordx4 v17, s[8:11], s24 offen lds
 s_mov_b32 s24, 0x10e000
 s_mov_b32 m0, 0x14000
 s_nop 0
 buffer_load_dwordx4 v16, s[8:11], s24 offen lds
 s_mov_b32 s24, 0x115800
 s_mov_b32 m0, 0x14800
 s_nop 0
 buffer_load_dwordx4 v17, s[8:11], s24 offen lds
 s_mov_b32 s24, 0x111c00
 s_mov_b32 m0, 0x15000
 s_nop 0
 buffer_load_dwordx4 v16, s[8:11], s24 offen lds
 s_mov_b32 s24, 0x119400
 s_mov_b32 m0, 0x15800
 s_nop 0
 buffer_load_dwordx4 v17, s[8:11], s24 offen lds
 s_mov_b32 s24, 0x11d000
 s_mov_b32 m0, 0x16000
 s_nop 0
 buffer_load_dwordx4 v16, s[8:11], s24 offen lds
 s_mov_b32 s24, 0x124800
 s_mov_b32 m0, 0x16800
 s_nop 0
 buffer_load_dwordx4 v17, s[8:11], s24 offen lds
 s_mov_b32 s24, 0x120c00
 s_mov_b32 m0, 0x17000
 s_nop 0
 buffer_load_dwordx4 v16, s[8:11], s24 offen lds
 s_mov_b32 s24, 0x128400
 s_mov_b32 m0, 0x17800
 s_nop 0
 buffer_load_dwordx4 v17, s[8:11], s24 offen lds
 ds_read_b128 v[52:55], v2 offset:16384
 ds_read_b128 v[56:59], v3 offset:16384
 s_waitcnt lgkmcnt(0)
 v_mfma_f32_16x16x32_bf16 v[40:43], v[52:55], v[52:55], v[40:43]
 v_mfma_f32_16x16x32_bf16 v[44:47], v[48:51], v[52:55], v[44:47]
 v_mfma_f32_16x16x32_bf16 v[40:43], v[56:59], v[56:59], v[40:43]
 v_mfma_f32_16x16x32_bf16 v[44:47], v[48:51], v[56:59], v[44:47]
 s_waitcnt vmcnt(16)
 s_barrier
 s_mov_b32 s24, 0x12c000
 s_mov_b32 m0, 0x18000
 s_nop 0
 buffer_load_dwordx4 v16, s[8:11], s24 offen lds
 s_mov_b32 s24, 0x133800
 s_mov_b32 m0, 0x18800
 s_nop 0
 buffer_load_dwordx4 v17, s[8:11], s24 offen lds
 s_mov_b32 s24, 0x12fc00
 s_mov_b32 m0, 0x19000
 s_nop 0
 buffer_load_dwordx4 v16, s[8:11], s24 offen lds
 s_mov_b32 s24, 0x137400
 s_mov_b32 m0, 0x19800
 s_nop 0
 buffer_load_dwordx4 v17, s[8:11], s24 offen lds
 s_mov_b32 s24, 0x13b000
 s_mov_b32 m0, 0x1a000
 s_nop 0
 buffer_load_dwordx4 v16, s[8:11], s24 offen lds
 s_mov_b32 s24, 0x142800
 s_mov_b32 m0, 0x1a800
 s_nop 0
 buffer_load_dwordx4 v17, s[8:11], s24 offen lds
 s_mov_b32 s24, 0x13ec00
 s_mov_b32 m0, 0x1b000
 s_nop 0
 buffer_load_dwordx4 v16, s[8:11], s24 offen lds
 s_mov_b32 s24, 0x146400
 s_mov_b32 m0, 0x1b800
 s_nop 0
 buffer_load_dwordx4 v17, s[8:11], s24 offen lds
 s_mov_b32 s24, 0x14a000
 s_mov_b32 m0, 0x1c000
 s_nop 0
 buffer_load_dwordx4 v16, s[8:11], s24 offen lds
 s_mov_b32 s24, 0x151800
 s_mov_b32 m0, 0x1c800
 s_nop 0
 buffer_load_dwordx4 v17, s[8:11], s24 offen lds
 s_mov_b32 s24, 0x14dc00
 s_mov_b32 m0, 0x1d000
 s_nop 0
 buffer_load_dwordx4 v16, s[8:11], s24 offen lds
 s_mov_b32 s24, 0x155400
 s_mov_b32 m0, 0x1d800
 s_nop 0
 buffer_load_dwordx4 v17, s[8:11], s24 offen lds
 s_mov_b32 s24, 0x159000
 s_mov_b32 m0, 0x1e000
 s_nop 0
 buffer_load_dwordx4 v16, s[8:11], s24 offen lds
 s_mov_b32 s24, 0x160800
 s_mov_b32 m0, 0x1e800
 s_nop 0
 buffer_load_dwordx4 v17, s[8:11], s24 offen lds
 s_mov_b32 s24, 0x15cc00
 s_mov_b32 m0, 0x1f000
 s_nop 0
 buffer_load_dwordx4 v16, s[8:11], s24 offen lds
 s_mov_b32 s24, 0x164400
 s_mov_b32 m0, 0x1f800
 s_nop 0
 buffer_load_dwordx4 v17, s[8:11], s24 offen lds
 ds_read_b128 v[52:55], v2 offset:24576
 ds_read_b128 v[56:59], v3 offset:24576
 s_waitcnt lgkmcnt(0)
 v_mfma_f32_16x16x32_bf16 v[40:43], v[52:55], v[52:55], v[40:43]
 v_mfma_f32_16x16x32_bf16 v[44:47], v[48:51], v[52:55], v[44:47]
 v_mfma_f32_16x16x32_bf16 v[40:43], v[56:59], v[56:59], v[40:43]
 v_mfma_f32_16x16x32_bf16 v[44:47], v[48:51], v[56:59], v[44:47]
 s_waitcnt vmcnt(16)
 s_barrier
 s_mov_b32 s24, 0x168000
 s_mov_b32 m0, 0x8000
 s_nop 0
 buffer_load_dwordx4 v16, s[8:11], s24 offen lds
 s_mov_b32 s24, 0x16f800
 s_mov_b32 m0, 0x8800
 s_nop 0
 buffer_load_dwordx4 v17, s[8:11], s24 offen lds
 s_mov_b32 s24, 0x16bc00
 s_mov_b32 m0, 0x9000
 s_nop 0
 buffer_load_dwordx4 v16, s[8:11], s24 offen lds
 s_mov_b32 s24, 0x173400
 s_mov_b32 m0, 0x9800
 s_nop 0
 buffer_load_dwordx4 v17, s[8:11], s24 offen lds
 s_mov_b32 s24, 0x177000
 s_mov_b32 m0, 0xa000
 s_nop 0
 buffer_load_dwordx4 v16, s[8:11], s24 offen lds
 s_mov_b32 s24, 0x17e800
 s_mov_b32 m0, 0xa800
 s_nop 0
 buffer_load_dwordx4 v17, s[8:11], s24 offen lds
 s_mov_b32 s24, 0x17ac00
 s_mov_b32 m0, 0xb000
 s_nop 0
 buffer_load_dwordx4 v16, s[8:11], s24 offen lds
 s_mov_b32 s24, 0x182400
 s_mov_b32 m0, 0xb800
 s_nop 0
 buffer_load_dwordx4 v17, s[8:11], s24 offen lds
 s_mov_b32 s24, 0x186000
 s_mov_b32 m0, 0xc000
 s_nop 0
 buffer_load_dwordx4 v16, s[8:11], s24 offen lds
 s_mov_b32 s24, 0x18d800
 s_mov_b32 m0, 0xc800
 s_nop 0
 buffer_load_dwordx4 v17, s[8:11], s24 offen lds
 s_mov_b32 s24, 0x189c00
 s_mov_b32 m0, 0xd000
 s_nop 0
 buffer_load_dwordx4 v16, s[8:11], s24 offen lds
 s_mov_b32 s24, 0x191400
 s_mov_b32 m0, 0xd800
 s_nop 0
 buffer_load_dwordx4 v17, s[8:11], s24 offen lds
 s_mov_b32 s24, 0x195000
 s_mov_b32 m0, 0xe000
 s_nop 0
 buffer_load_dwordx4 v16, s[8:11], s24 offen lds
 s_mov_b32 s24, 0x19c800
 s_mov_b32 m0, 0xe800
 s_nop 0
 buffer_load_dwordx4 v17, s[8:11], s24 offen lds
 s_mov_b32 s24, 0x198c00
 s_mov_b32 m0, 0xf000
 s_nop 0
 buffer_load_dwordx4 v16, s[8:11], s24 offen lds
 s_mov_b32 s24, 0x1a0400
 s_mov_b32 m0, 0xf800
 s_nop 0
 buffer_load_dwordx4 v17, s[8:11], s24 offen lds
 ds_read_b128 v[52:55], v2 offset:0
 ds_read_b128 v[56:59], v3 offset:0
 s_waitcnt lgkmcnt(0)
 v_mfma_f32_16x16x32_bf16 v[40:43], v[52:55], v[52:55], v[40:43]
 v_mfma_f32_16x16x32_bf16 v[44:47], v[48:51], v[52:55], v[44:47]
 v_mfma_f32_16x16x32_bf16 v[40:43], v[56:59], v[56:59], v[40:43]
 v_mfma_f32_16x16x32_bf16 v[44:47], v[48:51], v[56:59], v[44:47]
 s_waitcnt vmcnt(16)
 s_barrier
 s_mov_b32 s24, 0x1a4000
 s_mov_b32 m0, 0x10000
 s_nop 0
 buffer_load_dwordx4 v16, s[8:11], s24 offen lds
 s_mov_b32 s24, 0x1ab800
 s_mov_b32 m0, 0x10800
 s_nop 0
 buffer_load_dwordx4 v17, s[8:11], s24 offen lds
 s_mov_b32 s24, 0x1a7c00
 s_mov_b32 m0, 0x11000
 s_nop 0
 buffer_load_dwordx4 v16, s[8:11], s24 offen lds
 s_mov_b32 s24, 0x1af400
 s_mov_b32 m0, 0x11800
 s_nop 0
 buffer_load_dwordx4 v17, s[8:11], s24 offen lds
 s_mov_b32 s24, 0x1b3000
 s_mov_b32 m0, 0x12000
 s_nop 0
 buffer_load_dwordx4 v16, s[8:11], s24 offen lds
 s_mov_b32 s24, 0x1ba800
 s_mov_b32 m0, 0x12800
 s_nop 0
 buffer_load_dwordx4 v17, s[8:11], s24 offen lds
 s_mov_b32 s24, 0x1b6c00
 s_mov_b32 m0, 0x13000
 s_nop 0
 buffer_load_dwordx4 v16, s[8:11], s24 offen lds
 s_mov_b32 s24, 0x1be400
 s_mov_b32 m0, 0x13800
 s_nop 0
 buffer_load_dwordx4 v17, s[8:11], s24 offen lds
 s_mov_b32 s24, 0x1c2000
 s_mov_b32 m0, 0x14000
 s_nop 0
 buffer_load_dwordx4 v16, s[8:11], s24 offen lds
 s_mov_b32 s24, 0x1c9800
 s_mov_b32 m0, 0x14800
 s_nop 0
 buffer_load_dwordx4 v17, s[8:11], s24 offen lds
 s_mov_b32 s24, 0x1c5c00
 s_mov_b32 m0, 0x15000
 s_nop 0
 buffer_load_dwordx4 v16, s[8:11], s24 offen lds
 s_mov_b32 s24, 0x1cd400
 s_mov_b32 m0, 0x15800
 s_nop 0
 buffer_load_dwordx4 v17, s[8:11], s24 offen lds
 s_mov_b32 s24, 0x1d1000
 s_mov_b32 m0, 0x16000
 s_nop 0
 buffer_load_dwordx4 v16, s[8:11], s24 offen lds
 s_mov_b32 s24, 0x1d8800
 s_mov_b32 m0, 0x16800
 s_nop 0
 buffer_load_dwordx4 v17, s[8:11], s24 offen lds
 s_mov_b32 s24, 0x1d4c00
 s_mov_b32 m0, 0x17000
 s_nop 0
 buffer_load_dwordx4 v16, s[8:11], s24 offen lds
 s_mov_b32 s24, 0x1dc400
 s_mov_b32 m0, 0x17800
 s_nop 0
 buffer_load_dwordx4 v17, s[8:11], s24 offen lds
 ds_read_b128 v[52:55], v2 offset:8192
 ds_read_b128 v[56:59], v3 offset:8192
 s_waitcnt lgkmcnt(0)
 v_mfma_f32_16x16x32_bf16 v[40:43], v[52:55], v[52:55], v[40:43]
 v_mfma_f32_16x16x32_bf16 v[44:47], v[48:51], v[52:55], v[44:47]
 v_mfma_f32_16x16x32_bf16 v[40:43], v[56:59], v[56:59], v[40:43]
 v_mfma_f32_16x16x32_bf16 v[44:47], v[48:51], v[56:59], v[44:47]
 s_waitcnt vmcnt(16)
 s_barrier
 s_mov_b32 s24, 0x1e0000
 s_mov_b32 m0, 0x18000
 s_nop 0
 buffer_load_dwordx4 v16, s[8:11], s24 offen lds
 s_mov_b32 s24, 0x1e7800
 s_mov_b32 m0, 0x18800
 s_nop 0
 buffer_load_dwordx4 v17, s[8:11], s24 offen lds
 s_mov_b32 s24, 0x1e3c00
 s_mov_b32 m0, 0x19000
 s_nop 0
 buffer_load_dwordx4 v16, s[8:11], s24 offen lds
 s_mov_b32 s24, 0x1eb400
 s_mov_b32 m0, 0x19800
 s_nop 0
 buffer_load_dwordx4 v17, s[8:11], s24 offen lds
 s_mov_b32 s24, 0x1ef000
 s_mov_b32 m0, 0x1a000
 s_nop 0
 buffer_load_dwordx4 v16, s[8:11], s24 offen lds
 s_mov_b32 s24, 0x1f6800
 s_mov_b32 m0, 0x1a800
 s_nop 0
 buffer_load_dwordx4 v17, s[8:11], s24 offen lds
 s_mov_b32 s24, 0x1f2c00
 s_mov_b32 m0, 0x1b000
 s_nop 0
 buffer_load_dwordx4 v16, s[8:11], s24 offen lds
 s_mov_b32 s24, 0x1fa400
 s_mov_b32 m0, 0x1b800
 s_nop 0
 buffer_load_dwordx4 v17, s[8:11], s24 offen lds
 s_mov_b32 s24, 0x1fe000
 s_mov_b32 m0, 0x1c000
 s_nop 0
 buffer_load_dwordx4 v16, s[8:11], s24 offen lds
 s_mov_b32 s24, 0x205800
 s_mov_b32 m0, 0x1c800
 s_nop 0
 buffer_load_dwordx4 v17, s[8:11], s24 offen lds
 s_mov_b32 s24, 0x201c00
 s_mov_b32 m0, 0x1d000
 s_nop 0
 buffer_load_dwordx4 v16, s[8:11], s24 offen lds
 s_mov_b32 s24, 0x209400
 s_mov_b32 m0, 0x1d800
 s_nop 0
 buffer_load_dwordx4 v17, s[8:11], s24 offen lds
 s_mov_b32 s24, 0x20d000
 s_mov_b32 m0, 0x1e000
 s_nop 0
 buffer_load_dwordx4 v16, s[8:11], s24 offen lds
 s_mov_b32 s24, 0x214800
 s_mov_b32 m0, 0x1e800
 s_nop 0
 buffer_load_dwordx4 v17, s[8:11], s24 offen lds
 s_mov_b32 s24, 0x210c00
 s_mov_b32 m0, 0x1f000
 s_nop 0
 buffer_load_dwordx4 v16, s[8:11], s24 offen lds
 s_mov_b32 s24, 0x218400
 s_mov_b32 m0, 0x1f800
 s_nop 0
 buffer_load_dwordx4 v17, s[8:11], s24 offen lds
 ds_read_b128 v[52:55], v2 offset:16384
 ds_read_b128 v[56:59], v3 offset:16384
 s_waitcnt lgkmcnt(0)
 v_mfma_f32_16x16x32_bf16 v[40:43], v[52:55], v[52:55], v[40:43]
 v_mfma_f32_16x16x32_bf16 v[44:47], v[48:51], v[52:55], v[44:47]
 v_mfma_f32_16x16x32_bf16 v[40:43], v[56:59], v[56:59], v[40:43]
 v_mfma_f32_16x16x32_bf16 v[44:47], v[48:51], v[56:59], v[44:47]
 s_waitcnt vmcnt(16)
 s_barrier
 s_mov_b32 s24, 0x21c000
 s_mov_b32 m0, 0x8000
 s_nop 0
 buffer_load_dwordx4 v16, s[8:11], s24 offen lds
 s_mov_b32 s24, 0x223800
 s_mov_b32 m0, 0x8800
 s_nop 0
 buffer_load_dwordx4 v17, s[8:11], s24 offen lds
 s_mov_b32 s24, 0x21fc00
 s_mov_b32 m0, 0x9000
 s_nop 0
 buffer_load_dwordx4 v16, s[8:11], s24 offen lds
 s_mov_b32 s24, 0x227400
 s_mov_b32 m0, 0x9800
 s_nop 0
 buffer_load_dwordx4 v17, s[8:11], s24 offen lds
 s_mov_b32 s24, 0x22b000
 s_mov_b32 m0, 0xa000
 s_nop 0
 buffer_load_dwordx4 v16, s[8:11], s24 offen lds
 s_mov_b32 s24, 0x232800
 s_mov_b32 m0, 0xa800
 s_nop 0
 buffer_load_dwordx4 v17, s[8:11], s24 offen lds
 s_mov_b32 s24, 0x22ec00
 s_mov_b32 m0, 0xb000
 s_nop 0
 buffer_load_dwordx4 v16, s[8:11], s24 offen lds
 s_mov_b32 s24, 0x236400
 s_mov_b32 m0, 0xb800
 s_nop 0
 buffer_load_dwordx4 v17, s[8:11], s24 offen lds
 s_mov_b32 s24, 0x23a000
 s_mov_b32 m0, 0xc000
 s_nop 0
 buffer_load_dwordx4 v16, s[8:11], s24 offen lds
 s_mov_b32 s24, 0x241800
 s_mov_b32 m0, 0xc800
 s_nop 0
 buffer_load_dwordx4 v17, s[8:11], s24 offen lds
 s_mov_b32 s24, 0x23dc00
 s_mov_b32 m0, 0xd000
 s_nop 0
 buffer_load_dwordx4 v16, s[8:11], s24 offen lds
 s_mov_b32 s24, 0x245400
 s_mov_b32 m0, 0xd800
 s_nop 0
 buffer_load_dwordx4 v17, s[8:11], s24 offen lds
 s_mov_b32 s24, 0x249000
 s_mov_b32 m0, 0xe000
 s_nop 0
 buffer_load_dwordx4 v16, s[8:11], s24 offen lds
 s_mov_b32 s24, 0x250800
 s_mov_b32 m0, 0xe800
 s_nop 0
 buffer_load_dwordx4 v17, s[8:11], s24 offen lds
 s_mov_b32 s24, 0x24cc00
 s_mov_b32 m0, 0xf000
 s_nop 0
 buffer_load_dwordx4 v16, s[8:11], s24 offen lds
 s_mov_b32 s24, 0x254400
 s_mov_b32 m0, 0xf800
 s_nop 0
 buffer_load_dwordx4 v17, s[8:11], s24 offen lds
 ds_read_b128 v[52:55], v2 offset:24576
 ds_read_b128 v[56:59], v3 offset:24576
 s_waitcnt lgkmcnt(0)
 v_mfma_f32_16x16x32_bf16 v[40:43], v[52:55], v[52:55], v[40:43]
 v_mfma_f32_16x16x32_bf16 v[44:47], v[48:51], v[52:55], v[44:47]
 v_mfma_f32_16x16x32_bf16 v[40:43], v[56:59], v[56:59], v[40:43]
 v_mfma_f32_16x16x32_bf16 v[44:47], v[48:51], v[56:59], v[44:47]
 s_waitcnt vmcnt(16)
 s_barrier
 ds_read_b128 v[52:55], v2 offset:0
 ds_read_b128 v[56:59], v3 offset:0
 s_waitcnt lgkmcnt(0)
 v_mfma_f32_16x16x32_bf16 v[40:43], v[52:55], v[52:55], v[40:43]
 v_mfma_f32_16x16x32_bf16 v[44:47], v[48:51], v[52:55], v[44:47]
 v_mfma_f32_16x16x32_bf16 v[40:43], v[56:59], v[56:59], v[40:43]
 v_mfma_f32_16x16x32_bf16 v[44:47], v[48:51], v[56:59], v[44:47]
 s_waitcnt vmcnt(0)
 s_barrier
 ds_read_b128 v[52:55], v2 offset:8192
 ds_read_b128 v[56:59], v3 offset:8192
 s_waitcnt lgkmcnt(0)
 v_mfma_f32_16x16x32_bf16 v[40:43], v[52:55], v[52:55], v[40:43]
 v_mfma_f32_16x16x32_bf16 v[44:47], v[48:51], v[52:55], v[44:47]
 v_mfma_f32_16x16x32_bf16 v[40:43], v[56:59], v[56:59], v[40:43]
 v_mfma_f32_16x16x32_bf16 v[44:47], v[48:51], v[56:59], v[44:47]
 v_and_b32 v8, 3, v1
 v_and_b32 v9, 15, v1
 v_lshlrev_b32 v9, 2, v9
 s_sub_u32 s23, s20, 4
 s_lshl_b32 s23, s23, 6
 s_add_u32 s23, s23, 161792
 v_add_u32 v9, s23, v9
 v_cmp_eq_u32 vcc, 1, v8
 s_nop 1
 v_cndmask_b32 v10, v40, v41, vcc
 v_cmp_eq_u32 vcc, 2, v8
 s_nop 1
 v_cndmask_b32 v10, v10, v42, vcc
 v_cmp_eq_u32 vcc, 3, v8
 s_nop 1
 v_cndmask_b32 v10, v10, v43, vcc
 v_mul_f32 v11, 0x3acccccd, v44
 v_mul_f32 v10, 0x3acccccd, v10
 v_fma_f32 v10, -v11, v11, v10
 v_max_f32 v10, 0, v10
 v_add_f32 v10, 0x3727c5ac, v10
 v_rsq_f32 v10, v10
 s_nop 0
 v_mul_f32 v11, v11, v10
 s_mov_b32 exec_lo, 0x00f0000f
 s_mov_b32 exec_hi, 0xf0000f00
 ds_write_b32 v9, v10
 ds_write_b32 v9, v11 offset:256
 s_mov_b64 exec, -1
 s_waitcnt lgkmcnt(0)
 s_barrier
 s_endpgm
C0_bl1:
 s_mul_i32 s23, s22, 320
 v_mov_b32 v4, s23
 s_mul_i32 s23, s22, 160
 s_add_u32 s23, s23, 2240
 v_mov_b32 v5, s23
 s_movk_i32 s30, 3840
 v_and_b32 v6, 31, v1
 v_lshrrev_b32 v7, 5, v1
 v_lshlrev_b32 v8, 1, v7
 v_xor_b32 v6, v6, v8
 v_xor_b32 v9, 4, v6
 v_min_u32 v9, 29, v9
 v_cmp_gt_u32 vcc, 20, v9
 s_nop 1
 v_cndmask_b32 v10, v5, v4, vcc
 v_lshl_add_u32 v16, v9, 4, v10
 v_mad_u32_u24 v16, v7, s30, v16
 v_xor_b32 v9, 12, v6
 v_min_u32 v9, 29, v9
 v_cmp_gt_u32 vcc, 20, v9
 s_nop 1
 v_cndmask_b32 v10, v5, v4, vcc
 v_lshl_add_u32 v17, v9, 4, v10
 v_mad_u32_u24 v17, v7, s30, v17
 s_waitcnt lgkmcnt(0)
 s_mov_b32 s8, s14
 s_mov_b32 s9, s15
 s_mov_b32 s10, 0x258000
 s_mov_b32 s11, 0x00020000
 s_mov_b32 s24, 0x1e00
 s_mov_b32 m0, 0x8400
 s_nop 0
 buffer_load_dwordx4 v16, s[8:11], s24 offen lds
 s_mov_b32 s24, 0x9600
 s_mov_b32 m0, 0x8c00
 s_nop 0
 buffer_load_dwordx4 v17, s[8:11], s24 offen lds
 s_mov_b32 s24, 0x5a00
 s_mov_b32 m0, 0x9400
 s_nop 0
 buffer_load_dwordx4 v16, s[8:11], s24 offen lds
 s_mov_b32 s24, 0xd200
 s_mov_b32 m0, 0x9c00
 s_nop 0
 buffer_load_dwordx4 v17, s[8:11], s24 offen lds
 s_mov_b32 s24, 0x10e00
 s_mov_b32 m0, 0xa400
 s_nop 0
 buffer_load_dwordx4 v16, s[8:11], s24 offen lds
 s_mov_b32 s24, 0x18600
 s_mov_b32 m0, 0xac00
 s_nop 0
 buffer_load_dwordx4 v17, s[8:11], s24 offen lds
 s_mov_b32 s24, 0x14a00
 s_mov_b32 m0, 0xb400
 s_nop 0
 buffer_load_dwordx4 v16, s[8:11], s24 offen lds
 s_mov_b32 s24, 0x1c200
 s_mov_b32 m0, 0xbc00
 s_nop 0
 buffer_load_dwordx4 v17, s[8:11], s24 offen lds
 s_mov_b32 s24, 0x1fe00
 s_mov_b32 m0, 0xc400
 s_nop 0
 buffer_load_dwordx4 v16, s[8:11], s24 offen lds
 s_mov_b32 s24, 0x27600
 s_mov_b32 m0, 0xcc00
 s_nop 0
 buffer_load_dwordx4 v17, s[8:11], s24 offen lds
 s_mov_b32 s24, 0x23a00
 s_mov_b32 m0, 0xd400
 s_nop 0
 buffer_load_dwordx4 v16, s[8:11], s24 offen lds
 s_mov_b32 s24, 0x2b200
 s_mov_b32 m0, 0xdc00
 s_nop 0
 buffer_load_dwordx4 v17, s[8:11], s24 offen lds
 s_mov_b32 s24, 0x2ee00
 s_mov_b32 m0, 0xe400
 s_nop 0
 buffer_load_dwordx4 v16, s[8:11], s24 offen lds
 s_mov_b32 s24, 0x36600
 s_mov_b32 m0, 0xec00
 s_nop 0
 buffer_load_dwordx4 v17, s[8:11], s24 offen lds
 s_mov_b32 s24, 0x32a00
 s_mov_b32 m0, 0xf400
 s_nop 0
 buffer_load_dwordx4 v16, s[8:11], s24 offen lds
 s_mov_b32 s24, 0x3a200
 s_mov_b32 m0, 0xfc00
 s_nop 0
 buffer_load_dwordx4 v17, s[8:11], s24 offen lds
 s_mov_b32 s24, 0x3de00
 s_mov_b32 m0, 0x10400
 s_nop 0
 buffer_load_dwordx4 v16, s[8:11], s24 offen lds
 s_mov_b32 s24, 0x45600
 s_mov_b32 m0, 0x10c00
 s_nop 0
 buffer_load_dwordx4 v17, s[8:11], s24 offen lds
 s_mov_b32 s24, 0x41a00
 s_mov_b32 m0, 0x11400
 s_nop 0
 buffer_load_dwordx4 v16, s[8:11], s24 offen lds
 s_mov_b32 s24, 0x49200
 s_mov_b32 m0, 0x11c00
 s_nop 0
 buffer_load_dwordx4 v17, s[8:11], s24 offen lds
 s_mov_b32 s24, 0x4ce00
 s_mov_b32 m0, 0x12400
 s_nop 0
 buffer_load_dwordx4 v16, s[8:11], s24 offen lds
 s_mov_b32 s24, 0x54600
 s_mov_b32 m0, 0x12c00
 s_nop 0
 buffer_load_dwordx4 v17, s[8:11], s24 offen lds
 s_mov_b32 s24, 0x50a00
 s_mov_b32 m0, 0x13400
 s_nop 0
 buffer_load_dwordx4 v16, s[8:11], s24 offen lds
 s_mov_b32 s24, 0x58200
 s_mov_b32 m0, 0x13c00
 s_nop 0
 buffer_load_dwordx4 v17, s[8:11], s24 offen lds
 s_mov_b32 s24, 0x5be00
 s_mov_b32 m0, 0x14400
 s_nop 0
 buffer_load_dwordx4 v16, s[8:11], s24 offen lds
 s_mov_b32 s24, 0x63600
 s_mov_b32 m0, 0x14c00
 s_nop 0
 buffer_load_dwordx4 v17, s[8:11], s24 offen lds
 s_mov_b32 s24, 0x5fa00
 s_mov_b32 m0, 0x15400
 s_nop 0
 buffer_load_dwordx4 v16, s[8:11], s24 offen lds
 s_mov_b32 s24, 0x67200
 s_mov_b32 m0, 0x15c00
 s_nop 0
 buffer_load_dwordx4 v17, s[8:11], s24 offen lds
 s_mov_b32 s24, 0x6ae00
 s_mov_b32 m0, 0x16400
 s_nop 0
 buffer_load_dwordx4 v16, s[8:11], s24 offen lds
 s_mov_b32 s24, 0x72600
 s_mov_b32 m0, 0x16c00
 s_nop 0
 buffer_load_dwordx4 v17, s[8:11], s24 offen lds
 s_mov_b32 s24, 0x6ea00
 s_mov_b32 m0, 0x17400
 s_nop 0
 buffer_load_dwordx4 v16, s[8:11], s24 offen lds
 s_mov_b32 s24, 0x76200
 s_mov_b32 m0, 0x17c00
 s_nop 0
 buffer_load_dwordx4 v17, s[8:11], s24 offen lds
 v_and_b32 v8, 15, v1
 v_lshrrev_b32 v9, 4, v1
 v_lshrrev_b32 v7, 1, v8
 v_xor_b32 v7, v7, v9
 v_lshlrev_b32 v7, 4, v7
 v_lshlrev_b32 v2, 7, v8
 v_add_u32 v2, v2, v7
 v_xor_b32 v3, 64, v2
 s_sub_u32 s23, s20, 4
 s_lshl_b32 s23, s23, 11
 v_add_u32 v2, s23, v2
 v_add_u32 v3, s23, v3
 v_mov_b32 v48, 0x3f803f80
 v_mov_b32 v49, 0x3f803f80
 v_mov_b32 v50, 0x3f803f80
 v_mov_b32 v51, 0x3f803f80
 s_waitcnt vmcnt(16)
 s_barrier
 s_mov_b32 s24, 0x79e00
 s_mov_b32 m0, 0x18400
 s_nop 0
 buffer_load_dwordx4 v16, s[8:11], s24 offen lds
 s_mov_b32 s24, 0x81600
 s_mov_b32 m0, 0x18c00
 s_nop 0
 buffer_load_dwordx4 v17, s[8:11], s24 offen lds
 s_mov_b32 s24, 0x7da00
 s_mov_b32 m0, 0x19400
 s_nop 0
 buffer_load_dwordx4 v16, s[8:11], s24 offen lds
 s_mov_b32 s24, 0x85200
 s_mov_b32 m0, 0x19c00
 s_nop 0
 buffer_load_dwordx4 v17, s[8:11], s24 offen lds
 s_mov_b32 s24, 0x88e00
 s_mov_b32 m0, 0x1a400
 s_nop 0
 buffer_load_dwordx4 v16, s[8:11], s24 offen lds
 s_mov_b32 s24, 0x90600
 s_mov_b32 m0, 0x1ac00
 s_nop 0
 buffer_load_dwordx4 v17, s[8:11], s24 offen lds
 s_mov_b32 s24, 0x8ca00
 s_mov_b32 m0, 0x1b400
 s_nop 0
 buffer_load_dwordx4 v16, s[8:11], s24 offen lds
 s_mov_b32 s24, 0x94200
 s_mov_b32 m0, 0x1bc00
 s_nop 0
 buffer_load_dwordx4 v17, s[8:11], s24 offen lds
 s_mov_b32 s24, 0x97e00
 s_mov_b32 m0, 0x1c400
 s_nop 0
 buffer_load_dwordx4 v16, s[8:11], s24 offen lds
 s_mov_b32 s24, 0x9f600
 s_mov_b32 m0, 0x1cc00
 s_nop 0
 buffer_load_dwordx4 v17, s[8:11], s24 offen lds
 s_mov_b32 s24, 0x9ba00
 s_mov_b32 m0, 0x1d400
 s_nop 0
 buffer_load_dwordx4 v16, s[8:11], s24 offen lds
 s_mov_b32 s24, 0xa3200
 s_mov_b32 m0, 0x1dc00
 s_nop 0
 buffer_load_dwordx4 v17, s[8:11], s24 offen lds
 s_mov_b32 s24, 0xa6e00
 s_mov_b32 m0, 0x1e400
 s_nop 0
 buffer_load_dwordx4 v16, s[8:11], s24 offen lds
 s_mov_b32 s24, 0xae600
 s_mov_b32 m0, 0x1ec00
 s_nop 0
 buffer_load_dwordx4 v17, s[8:11], s24 offen lds
 s_mov_b32 s24, 0xaaa00
 s_mov_b32 m0, 0x1f400
 s_nop 0
 buffer_load_dwordx4 v16, s[8:11], s24 offen lds
 s_mov_b32 s24, 0xb2200
 s_mov_b32 m0, 0x1fc00
 s_nop 0
 buffer_load_dwordx4 v17, s[8:11], s24 offen lds
 ds_read_b128 v[52:55], v2 offset:0
 ds_read_b128 v[56:59], v3 offset:0
 s_waitcnt lgkmcnt(0)
 v_mfma_f32_16x16x32_bf16 v[40:43], v[52:55], v[52:55], 0
 v_mfma_f32_16x16x32_bf16 v[44:47], v[48:51], v[52:55], 0
 v_mfma_f32_16x16x32_bf16 v[40:43], v[56:59], v[56:59], v[40:43]
 v_mfma_f32_16x16x32_bf16 v[44:47], v[48:51], v[56:59], v[44:47]
 s_waitcnt vmcnt(16)
 s_barrier
 s_mov_b32 s24, 0xb5e00
 s_mov_b32 m0, 0x8400
 s_nop 0
 buffer_load_dwordx4 v16, s[8:11], s24 offen lds
 s_mov_b32 s24, 0xbd600
 s_mov_b32 m0, 0x8c00
 s_nop 0
 buffer_load_dwordx4 v17, s[8:11], s24 offen lds
 s_mov_b32 s24, 0xb9a00
 s_mov_b32 m0, 0x9400
 s_nop 0
 buffer_load_dwordx4 v16, s[8:11], s24 offen lds
 s_mov_b32 s24, 0xc1200
 s_mov_b32 m0, 0x9c00
 s_nop 0
 buffer_load_dwordx4 v17, s[8:11], s24 offen lds
 s_mov_b32 s24, 0xc4e00
 s_mov_b32 m0, 0xa400
 s_nop 0
 buffer_load_dwordx4 v16, s[8:11], s24 offen lds
 s_mov_b32 s24, 0xcc600
 s_mov_b32 m0, 0xac00
 s_nop 0
 buffer_load_dwordx4 v17, s[8:11], s24 offen lds
 s_mov_b32 s24, 0xc8a00
 s_mov_b32 m0, 0xb400
 s_nop 0
 buffer_load_dwordx4 v16, s[8:11], s24 offen lds
 s_mov_b32 s24, 0xd0200
 s_mov_b32 m0, 0xbc00
 s_nop 0
 buffer_load_dwordx4 v17, s[8:11], s24 offen lds
 s_mov_b32 s24, 0xd3e00
 s_mov_b32 m0, 0xc400
 s_nop 0
 buffer_load_dwordx4 v16, s[8:11], s24 offen lds
 s_mov_b32 s24, 0xdb600
 s_mov_b32 m0, 0xcc00
 s_nop 0
 buffer_load_dwordx4 v17, s[8:11], s24 offen lds
 s_mov_b32 s24, 0xd7a00
 s_mov_b32 m0, 0xd400
 s_nop 0
 buffer_load_dwordx4 v16, s[8:11], s24 offen lds
 s_mov_b32 s24, 0xdf200
 s_mov_b32 m0, 0xdc00
 s_nop 0
 buffer_load_dwordx4 v17, s[8:11], s24 offen lds
 s_mov_b32 s24, 0xe2e00
 s_mov_b32 m0, 0xe400
 s_nop 0
 buffer_load_dwordx4 v16, s[8:11], s24 offen lds
 s_mov_b32 s24, 0xea600
 s_mov_b32 m0, 0xec00
 s_nop 0
 buffer_load_dwordx4 v17, s[8:11], s24 offen lds
 s_mov_b32 s24, 0xe6a00
 s_mov_b32 m0, 0xf400
 s_nop 0
 buffer_load_dwordx4 v16, s[8:11], s24 offen lds
 s_mov_b32 s24, 0xee200
 s_mov_b32 m0, 0xfc00
 s_nop 0
 buffer_load_dwordx4 v17, s[8:11], s24 offen lds
 ds_read_b128 v[52:55], v2 offset:8192
 ds_read_b128 v[56:59], v3 offset:8192
 s_waitcnt lgkmcnt(0)
 v_mfma_f32_16x16x32_bf16 v[40:43], v[52:55], v[52:55], v[40:43]
 v_mfma_f32_16x16x32_bf16 v[44:47], v[48:51], v[52:55], v[44:47]
 v_mfma_f32_16x16x32_bf16 v[40:43], v[56:59], v[56:59], v[40:43]
 v_mfma_f32_16x16x32_bf16 v[44:47], v[48:51], v[56:59], v[44:47]
 s_waitcnt vmcnt(16)
 s_barrier
 s_mov_b32 s24, 0xf1e00
 s_mov_b32 m0, 0x10400
 s_nop 0
 buffer_load_dwordx4 v16, s[8:11], s24 offen lds
 s_mov_b32 s24, 0xf9600
 s_mov_b32 m0, 0x10c00
 s_nop 0
 buffer_load_dwordx4 v17, s[8:11], s24 offen lds
 s_mov_b32 s24, 0xf5a00
 s_mov_b32 m0, 0x11400
 s_nop 0
 buffer_load_dwordx4 v16, s[8:11], s24 offen lds
 s_mov_b32 s24, 0xfd200
 s_mov_b32 m0, 0x11c00
 s_nop 0
 buffer_load_dwordx4 v17, s[8:11], s24 offen lds
 s_mov_b32 s24, 0x100e00
 s_mov_b32 m0, 0x12400
 s_nop 0
 buffer_load_dwordx4 v16, s[8:11], s24 offen lds
 s_mov_b32 s24, 0x108600
 s_mov_b32 m0, 0x12c00
 s_nop 0
 buffer_load_dwordx4 v17, s[8:11], s24 offen lds
 s_mov_b32 s24, 0x104a00
 s_mov_b32 m0, 0x13400
 s_nop 0
 buffer_load_dwordx4 v16, s[8:11], s24 offen lds
 s_mov_b32 s24, 0x10c200
 s_mov_b32 m0, 0x13c00
 s_nop 0
 buffer_load_dwordx4 v17, s[8:11], s24 offen lds
 s_mov_b32 s24, 0x10fe00
 s_mov_b32 m0, 0x14400
 s_nop 0
 buffer_load_dwordx4 v16, s[8:11], s24 offen lds
 s_mov_b32 s24, 0x117600
 s_mov_b32 m0, 0x14c00
 s_nop 0
 buffer_load_dwordx4 v17, s[8:11], s24 offen lds
 s_mov_b32 s24, 0x113a00
 s_mov_b32 m0, 0x15400
 s_nop 0
 buffer_load_dwordx4 v16, s[8:11], s24 offen lds
 s_mov_b32 s24, 0x11b200
 s_mov_b32 m0, 0x15c00
 s_nop 0
 buffer_load_dwordx4 v17, s[8:11], s24 offen lds
 s_mov_b32 s24, 0x11ee00
 s_mov_b32 m0, 0x16400
 s_nop 0
 buffer_load_dwordx4 v16, s[8:11], s24 offen lds
 s_mov_b32 s24, 0x126600
 s_mov_b32 m0, 0x16c00
 s_nop 0
 buffer_load_dwordx4 v17, s[8:11], s24 offen lds
 s_mov_b32 s24, 0x122a00
 s_mov_b32 m0, 0x17400
 s_nop 0
 buffer_load_dwordx4 v16, s[8:11], s24 offen lds
 s_mov_b32 s24, 0x12a200
 s_mov_b32 m0, 0x17c00
 s_nop 0
 buffer_load_dwordx4 v17, s[8:11], s24 offen lds
 ds_read_b128 v[52:55], v2 offset:16384
 ds_read_b128 v[56:59], v3 offset:16384
 s_waitcnt lgkmcnt(0)
 v_mfma_f32_16x16x32_bf16 v[40:43], v[52:55], v[52:55], v[40:43]
 v_mfma_f32_16x16x32_bf16 v[44:47], v[48:51], v[52:55], v[44:47]
 v_mfma_f32_16x16x32_bf16 v[40:43], v[56:59], v[56:59], v[40:43]
 v_mfma_f32_16x16x32_bf16 v[44:47], v[48:51], v[56:59], v[44:47]
 s_waitcnt vmcnt(16)
 s_barrier
 s_mov_b32 s24, 0x12de00
 s_mov_b32 m0, 0x18400
 s_nop 0
 buffer_load_dwordx4 v16, s[8:11], s24 offen lds
 s_mov_b32 s24, 0x135600
 s_mov_b32 m0, 0x18c00
 s_nop 0
 buffer_load_dwordx4 v17, s[8:11], s24 offen lds
 s_mov_b32 s24, 0x131a00
 s_mov_b32 m0, 0x19400
 s_nop 0
 buffer_load_dwordx4 v16, s[8:11], s24 offen lds
 s_mov_b32 s24, 0x139200
 s_mov_b32 m0, 0x19c00
 s_nop 0
 buffer_load_dwordx4 v17, s[8:11], s24 offen lds
 s_mov_b32 s24, 0x13ce00
 s_mov_b32 m0, 0x1a400
 s_nop 0
 buffer_load_dwordx4 v16, s[8:11], s24 offen lds
 s_mov_b32 s24, 0x144600
 s_mov_b32 m0, 0x1ac00
 s_nop 0
 buffer_load_dwordx4 v17, s[8:11], s24 offen lds
 s_mov_b32 s24, 0x140a00
 s_mov_b32 m0, 0x1b400
 s_nop 0
 buffer_load_dwordx4 v16, s[8:11], s24 offen lds
 s_mov_b32 s24, 0x148200
 s_mov_b32 m0, 0x1bc00
 s_nop 0
 buffer_load_dwordx4 v17, s[8:11], s24 offen lds
 s_mov_b32 s24, 0x14be00
 s_mov_b32 m0, 0x1c400
 s_nop 0
 buffer_load_dwordx4 v16, s[8:11], s24 offen lds
 s_mov_b32 s24, 0x153600
 s_mov_b32 m0, 0x1cc00
 s_nop 0
 buffer_load_dwordx4 v17, s[8:11], s24 offen lds
 s_mov_b32 s24, 0x14fa00
 s_mov_b32 m0, 0x1d400
 s_nop 0
 buffer_load_dwordx4 v16, s[8:11], s24 offen lds
 s_mov_b32 s24, 0x157200
 s_mov_b32 m0, 0x1dc00
 s_nop 0
 buffer_load_dwordx4 v17, s[8:11], s24 offen lds
 s_mov_b32 s24, 0x15ae00
 s_mov_b32 m0, 0x1e400
 s_nop 0
 buffer_load_dwordx4 v16, s[8:11], s24 offen lds
 s_mov_b32 s24, 0x162600
 s_mov_b32 m0, 0x1ec00
 s_nop 0
 buffer_load_dwordx4 v17, s[8:11], s24 offen lds
 s_mov_b32 s24, 0x15ea00
 s_mov_b32 m0, 0x1f400
 s_nop 0
 buffer_load_dwordx4 v16, s[8:11], s24 offen lds
 s_mov_b32 s24, 0x166200
 s_mov_b32 m0, 0x1fc00
 s_nop 0
 buffer_load_dwordx4 v17, s[8:11], s24 offen lds
 ds_read_b128 v[52:55], v2 offset:24576
 ds_read_b128 v[56:59], v3 offset:24576
 s_waitcnt lgkmcnt(0)
 v_mfma_f32_16x16x32_bf16 v[40:43], v[52:55], v[52:55], v[40:43]
 v_mfma_f32_16x16x32_bf16 v[44:47], v[48:51], v[52:55], v[44:47]
 v_mfma_f32_16x16x32_bf16 v[40:43], v[56:59], v[56:59], v[40:43]
 v_mfma_f32_16x16x32_bf16 v[44:47], v[48:51], v[56:59], v[44:47]
 s_waitcnt vmcnt(16)
 s_barrier
 s_mov_b32 s24, 0x169e00
 s_mov_b32 m0, 0x8400
 s_nop 0
 buffer_load_dwordx4 v16, s[8:11], s24 offen lds
 s_mov_b32 s24, 0x171600
 s_mov_b32 m0, 0x8c00
 s_nop 0
 buffer_load_dwordx4 v17, s[8:11], s24 offen lds
 s_mov_b32 s24, 0x16da00
 s_mov_b32 m0, 0x9400
 s_nop 0
 buffer_load_dwordx4 v16, s[8:11], s24 offen lds
 s_mov_b32 s24, 0x175200
 s_mov_b32 m0, 0x9c00
 s_nop 0
 buffer_load_dwordx4 v17, s[8:11], s24 offen lds
 s_mov_b32 s24, 0x178e00
 s_mov_b32 m0, 0xa400
 s_nop 0
 buffer_load_dwordx4 v16, s[8:11], s24 offen lds
 s_mov_b32 s24, 0x180600
 s_mov_b32 m0, 0xac00
 s_nop 0
 buffer_load_dwordx4 v17, s[8:11], s24 offen lds
 s_mov_b32 s24, 0x17ca00
 s_mov_b32 m0, 0xb400
 s_nop 0
 buffer_load_dwordx4 v16, s[8:11], s24 offen lds
 s_mov_b32 s24, 0x184200
 s_mov_b32 m0, 0xbc00
 s_nop 0
 buffer_load_dwordx4 v17, s[8:11], s24 offen lds
 s_mov_b32 s24, 0x187e00
 s_mov_b32 m0, 0xc400
 s_nop 0
 buffer_load_dwordx4 v16, s[8:11], s24 offen lds
 s_mov_b32 s24, 0x18f600
 s_mov_b32 m0, 0xcc00
 s_nop 0
 buffer_load_dwordx4 v17, s[8:11], s24 offen lds
 s_mov_b32 s24, 0x18ba00
 s_mov_b32 m0, 0xd400
 s_nop 0
 buffer_load_dwordx4 v16, s[8:11], s24 offen lds
 s_mov_b32 s24, 0x193200
 s_mov_b32 m0, 0xdc00
 s_nop 0
 buffer_load_dwordx4 v17, s[8:11], s24 offen lds
 s_mov_b32 s24, 0x196e00
 s_mov_b32 m0, 0xe400
 s_nop 0
 buffer_load_dwordx4 v16, s[8:11], s24 offen lds
 s_mov_b32 s24, 0x19e600
 s_mov_b32 m0, 0xec00
 s_nop 0
 buffer_load_dwordx4 v17, s[8:11], s24 offen lds
 s_mov_b32 s24, 0x19aa00
 s_mov_b32 m0, 0xf400
 s_nop 0
 buffer_load_dwordx4 v16, s[8:11], s24 offen lds
 s_mov_b32 s24, 0x1a2200
 s_mov_b32 m0, 0xfc00
 s_nop 0
 buffer_load_dwordx4 v17, s[8:11], s24 offen lds
 ds_read_b128 v[52:55], v2 offset:0
 ds_read_b128 v[56:59], v3 offset:0
 s_waitcnt lgkmcnt(0)
 v_mfma_f32_16x16x32_bf16 v[40:43], v[52:55], v[52:55], v[40:43]
 v_mfma_f32_16x16x32_bf16 v[44:47], v[48:51], v[52:55], v[44:47]
 v_mfma_f32_16x16x32_bf16 v[40:43], v[56:59], v[56:59], v[40:43]
 v_mfma_f32_16x16x32_bf16 v[44:47], v[48:51], v[56:59], v[44:47]
 s_waitcnt vmcnt(16)
 s_barrier
 s_mov_b32 s24, 0x1a5e00
 s_mov_b32 m0, 0x10400
 s_nop 0
 buffer_load_dwordx4 v16, s[8:11], s24 offen lds
 s_mov_b32 s24, 0x1ad600
 s_mov_b32 m0, 0x10c00
 s_nop 0
 buffer_load_dwordx4 v17, s[8:11], s24 offen lds
 s_mov_b32 s24, 0x1a9a00
 s_mov_b32 m0, 0x11400
 s_nop 0
 buffer_load_dwordx4 v16, s[8:11], s24 offen lds
 s_mov_b32 s24, 0x1b1200
 s_mov_b32 m0, 0x11c00
 s_nop 0
 buffer_load_dwordx4 v17, s[8:11], s24 offen lds
 s_mov_b32 s24, 0x1b4e00
 s_mov_b32 m0, 0x12400
 s_nop 0
 buffer_load_dwordx4 v16, s[8:11], s24 offen lds
 s_mov_b32 s24, 0x1bc600
 s_mov_b32 m0, 0x12c00
 s_nop 0
 buffer_load_dwordx4 v17, s[8:11], s24 offen lds
 s_mov_b32 s24, 0x1b8a00
 s_mov_b32 m0, 0x13400
 s_nop 0
 buffer_load_dwordx4 v16, s[8:11], s24 offen lds
 s_mov_b32 s24, 0x1c0200
 s_mov_b32 m0, 0x13c00
 s_nop 0
 buffer_load_dwordx4 v17, s[8:11], s24 offen lds
 s_mov_b32 s24, 0x1c3e00
 s_mov_b32 m0, 0x14400
 s_nop 0
 buffer_load_dwordx4 v16, s[8:11], s24 offen lds
 s_mov_b32 s24, 0x1cb600
 s_mov_b32 m0, 0x14c00
 s_nop 0
 buffer_load_dwordx4 v17, s[8:11], s24 offen lds
 s_mov_b32 s24, 0x1c7a00
 s_mov_b32 m0, 0x15400
 s_nop 0
 buffer_load_dwordx4 v16, s[8:11], s24 offen lds
 s_mov_b32 s24, 0x1cf200
 s_mov_b32 m0, 0x15c00
 s_nop 0
 buffer_load_dwordx4 v17, s[8:11], s24 offen lds
 s_mov_b32 s24, 0x1d2e00
 s_mov_b32 m0, 0x16400
 s_nop 0
 buffer_load_dwordx4 v16, s[8:11], s24 offen lds
 s_mov_b32 s24, 0x1da600
 s_mov_b32 m0, 0x16c00
 s_nop 0
 buffer_load_dwordx4 v17, s[8:11], s24 offen lds
 s_mov_b32 s24, 0x1d6a00
 s_mov_b32 m0, 0x17400
 s_nop 0
 buffer_load_dwordx4 v16, s[8:11], s24 offen lds
 s_mov_b32 s24, 0x1de200
 s_mov_b32 m0, 0x17c00
 s_nop 0
 buffer_load_dwordx4 v17, s[8:11], s24 offen lds
 ds_read_b128 v[52:55], v2 offset:8192
 ds_read_b128 v[56:59], v3 offset:8192
 s_waitcnt lgkmcnt(0)
 v_mfma_f32_16x16x32_bf16 v[40:43], v[52:55], v[52:55], v[40:43]
 v_mfma_f32_16x16x32_bf16 v[44:47], v[48:51], v[52:55], v[44:47]
 v_mfma_f32_16x16x32_bf16 v[40:43], v[56:59], v[56:59], v[40:43]
 v_mfma_f32_16x16x32_bf16 v[44:47], v[48:51], v[56:59], v[44:47]
 s_waitcnt vmcnt(16)
 s_barrier
 s_mov_b32 s24, 0x1e1e00
 s_mov_b32 m0, 0x18400
 s_nop 0
 buffer_load_dwordx4 v16, s[8:11], s24 offen lds
 s_mov_b32 s24, 0x1e9600
 s_mov_b32 m0, 0x18c00
 s_nop 0
 buffer_load_dwordx4 v17, s[8:11], s24 offen lds
 s_mov_b32 s24, 0x1e5a00
 s_mov_b32 m0, 0x19400
 s_nop 0
 buffer_load_dwordx4 v16, s[8:11], s24 offen lds
 s_mov_b32 s24, 0x1ed200
 s_mov_b32 m0, 0x19c00
 s_nop 0
 buffer_load_dwordx4 v17, s[8:11], s24 offen lds
 s_mov_b32 s24, 0x1f0e00
 s_mov_b32 m0, 0x1a400
 s_nop 0
 buffer_load_dwordx4 v16, s[8:11], s24 offen lds
 s_mov_b32 s24, 0x1f8600
 s_mov_b32 m0, 0x1ac00
 s_nop 0
 buffer_load_dwordx4 v17, s[8:11], s24 offen lds
 s_mov_b32 s24, 0x1f4a00
 s_mov_b32 m0, 0x1b400
 s_nop 0
 buffer_load_dwordx4 v16, s[8:11], s24 offen lds
 s_mov_b32 s24, 0x1fc200
 s_mov_b32 m0, 0x1bc00
 s_nop 0
 buffer_load_dwordx4 v17, s[8:11], s24 offen lds
 s_mov_b32 s24, 0x1ffe00
 s_mov_b32 m0, 0x1c400
 s_nop 0
 buffer_load_dwordx4 v16, s[8:11], s24 offen lds
 s_mov_b32 s24, 0x207600
 s_mov_b32 m0, 0x1cc00
 s_nop 0
 buffer_load_dwordx4 v17, s[8:11], s24 offen lds
 s_mov_b32 s24, 0x203a00
 s_mov_b32 m0, 0x1d400
 s_nop 0
 buffer_load_dwordx4 v16, s[8:11], s24 offen lds
 s_mov_b32 s24, 0x20b200
 s_mov_b32 m0, 0x1dc00
 s_nop 0
 buffer_load_dwordx4 v17, s[8:11], s24 offen lds
 s_mov_b32 s24, 0x20ee00
 s_mov_b32 m0, 0x1e400
 s_nop 0
 buffer_load_dwordx4 v16, s[8:11], s24 offen lds
 s_mov_b32 s24, 0x216600
 s_mov_b32 m0, 0x1ec00
 s_nop 0
 buffer_load_dwordx4 v17, s[8:11], s24 offen lds
 s_mov_b32 s24, 0x212a00
 s_mov_b32 m0, 0x1f400
 s_nop 0
 buffer_load_dwordx4 v16, s[8:11], s24 offen lds
 s_mov_b32 s24, 0x21a200
 s_mov_b32 m0, 0x1fc00
 s_nop 0
 buffer_load_dwordx4 v17, s[8:11], s24 offen lds
 ds_read_b128 v[52:55], v2 offset:16384
 ds_read_b128 v[56:59], v3 offset:16384
 s_waitcnt lgkmcnt(0)
 v_mfma_f32_16x16x32_bf16 v[40:43], v[52:55], v[52:55], v[40:43]
 v_mfma_f32_16x16x32_bf16 v[44:47], v[48:51], v[52:55], v[44:47]
 v_mfma_f32_16x16x32_bf16 v[40:43], v[56:59], v[56:59], v[40:43]
 v_mfma_f32_16x16x32_bf16 v[44:47], v[48:51], v[56:59], v[44:47]
 s_waitcnt vmcnt(16)
 s_barrier
 s_mov_b32 s24, 0x21de00
 s_mov_b32 m0, 0x8400
 s_nop 0
 buffer_load_dwordx4 v16, s[8:11], s24 offen lds
 s_mov_b32 s24, 0x225600
 s_mov_b32 m0, 0x8c00
 s_nop 0
 buffer_load_dwordx4 v17, s[8:11], s24 offen lds
 s_mov_b32 s24, 0x221a00
 s_mov_b32 m0, 0x9400
 s_nop 0
 buffer_load_dwordx4 v16, s[8:11], s24 offen lds
 s_mov_b32 s24, 0x229200
 s_mov_b32 m0, 0x9c00
 s_nop 0
 buffer_load_dwordx4 v17, s[8:11], s24 offen lds
 s_mov_b32 s24, 0x22ce00
 s_mov_b32 m0, 0xa400
 s_nop 0
 buffer_load_dwordx4 v16, s[8:11], s24 offen lds
 s_mov_b32 s24, 0x234600
 s_mov_b32 m0, 0xac00
 s_nop 0
 buffer_load_dwordx4 v17, s[8:11], s24 offen lds
 s_mov_b32 s24, 0x230a00
 s_mov_b32 m0, 0xb400
 s_nop 0
 buffer_load_dwordx4 v16, s[8:11], s24 offen lds
 s_mov_b32 s24, 0x238200
 s_mov_b32 m0, 0xbc00
 s_nop 0
 buffer_load_dwordx4 v17, s[8:11], s24 offen lds
 s_mov_b32 s24, 0x23be00
 s_mov_b32 m0, 0xc400
 s_nop 0
 buffer_load_dwordx4 v16, s[8:11], s24 offen lds
 s_mov_b32 s24, 0x243600
 s_mov_b32 m0, 0xcc00
 s_nop 0
 buffer_load_dwordx4 v17, s[8:11], s24 offen lds
 s_mov_b32 s24, 0x23fa00
 s_mov_b32 m0, 0xd400
 s_nop 0
 buffer_load_dwordx4 v16, s[8:11], s24 offen lds
 s_mov_b32 s24, 0x247200
 s_mov_b32 m0, 0xdc00
 s_nop 0
 buffer_load_dwordx4 v17, s[8:11], s24 offen lds
 s_mov_b32 s24, 0x24ae00
 s_mov_b32 m0, 0xe400
 s_nop 0
 buffer_load_dwordx4 v16, s[8:11], s24 offen lds
 s_mov_b32 s24, 0x252600
 s_mov_b32 m0, 0xec00
 s_nop 0
 buffer_load_dwordx4 v17, s[8:11], s24 offen lds
 s_mov_b32 s24, 0x24ea00
 s_mov_b32 m0, 0xf400
 s_nop 0
 buffer_load_dwordx4 v16, s[8:11], s24 offen lds
 s_mov_b32 s24, 0x256200
 s_mov_b32 m0, 0xfc00
 s_nop 0
 buffer_load_dwordx4 v17, s[8:11], s24 offen lds
 ds_read_b128 v[52:55], v2 offset:24576
 ds_read_b128 v[56:59], v3 offset:24576
 s_waitcnt lgkmcnt(0)
 v_mfma_f32_16x16x32_bf16 v[40:43], v[52:55], v[52:55], v[40:43]
 v_mfma_f32_16x16x32_bf16 v[44:47], v[48:51], v[52:55], v[44:47]
 v_mfma_f32_16x16x32_bf16 v[40:43], v[56:59], v[56:59], v[40:43]
 v_mfma_f32_16x16x32_bf16 v[44:47], v[48:51], v[56:59], v[44:47]
 s_waitcnt vmcnt(16)
 s_barrier
 ds_read_b128 v[52:55], v2 offset:0
 ds_read_b128 v[56:59], v3 offset:0
 s_waitcnt lgkmcnt(0)
 v_mfma_f32_16x16x32_bf16 v[40:43], v[52:55], v[52:55], v[40:43]
 v_mfma_f32_16x16x32_bf16 v[44:47], v[48:51], v[52:55], v[44:47]
 v_mfma_f32_16x16x32_bf16 v[40:43], v[56:59], v[56:59], v[40:43]
 v_mfma_f32_16x16x32_bf16 v[44:47], v[48:51], v[56:59], v[44:47]
 s_waitcnt vmcnt(0)
 s_barrier
 ds_read_b128 v[52:55], v2 offset:8192
 ds_read_b128 v[56:59], v3 offset:8192
 s_waitcnt lgkmcnt(0)
 v_mfma_f32_16x16x32_bf16 v[40:43], v[52:55], v[52:55], v[40:43]
 v_mfma_f32_16x16x32_bf16 v[44:47], v[48:51], v[52:55], v[44:47]
 v_mfma_f32_16x16x32_bf16 v[40:43], v[56:59], v[56:59], v[40:43]
 v_mfma_f32_16x16x32_bf16 v[44:47], v[48:51], v[56:59], v[44:47]
 v_and_b32 v8, 3, v1
 v_and_b32 v9, 15, v1
 v_lshlrev_b32 v9, 2, v9
 s_sub_u32 s23, s20, 4
 s_lshl_b32 s23, s23, 6
 s_add_u32 s23, s23, 161792
 v_add_u32 v9, s23, v9
 v_cmp_eq_u32 vcc, 1, v8
 s_nop 1
 v_cndmask_b32 v10, v40, v41, vcc
 v_cmp_eq_u32 vcc, 2, v8
 s_nop 1
 v_cndmask_b32 v10, v10, v42, vcc
 v_cmp_eq_u32 vcc, 3, v8
 s_nop 1
 v_cndmask_b32 v10, v10, v43, vcc
 v_mul_f32 v11, 0x3acccccd, v44
 v_mul_f32 v10, 0x3acccccd, v10
 v_fma_f32 v10, -v11, v11, v10
 v_max_f32 v10, 0, v10
 v_add_f32 v10, 0x3727c5ac, v10
 v_rsq_f32 v10, v10
 s_nop 0
 v_mul_f32 v11, v11, v10
 s_mov_b32 exec_lo, 0x00f0000f
 s_mov_b32 exec_hi, 0xf0000f00
 ds_write_b32 v9, v10
 ds_write_b32 v9, v11 offset:256
 s_mov_b64 exec, -1
 s_waitcnt lgkmcnt(0)
 s_barrier
 s_endpgm
C0_al:
 s_load_dwordx2 s[16:17], s[0:1], 16
 s_load_dwordx2 s[38:39], s[0:1], 32
 s_load_dwordx2 s[40:41], s[0:1], 48
 s_sub_u32 s23, s20, 6
 s_lshl_b32 s25, s23, 12
 v_lshrrev_b32 v6, 3, v1
 v_and_b32 v7, 7, v1
 v_lshrrev_b32 v8, 4, v1
 v_xor_b32 v7, v7, v8
 v_mul_u32_u24 v6, 1280, v6
 v_lshlrev_b32 v8, 4, v7
 v_add_u32 v4, v6, v8
 v_xor_b32 v8, 64, v8
 v_add_u32 v5, v6, v8
 v_add_u32 v5, 10240, v5
 s_lshl_b32 s26, s21, 2
 s_lshl_b32 s27, s23, 1
 s_add_u32 s26, s26, s27
 s_mul_i32 s26, s26, 20480
 s_add_u32 s27, s26, 20480
 s_cmp_lt_u32 s2, 136
 s_cbranch_scc0 C0_u2a
 s_cmp_lt_u32 s2, 96
 s_cselect_b32 s32, 0, 1
 s_cselect_b32 s30, 0, 96
 s_sub_u32 s28, s2, s30
 s_lshr_b32 s33, s28, 2
 s_and_b32 s34, s28, 3
 s_mul_i32 s35, s34, 160
 s_branch C0_uja
C0_u2a:
 s_mov_b32 s32, 2
 s_sub_u32 s28, s2, 136
 s_mul_i32 s33, s28, 171
 s_lshr_b32 s33, s33, 11
 s_mul_i32 s30, s33, 12
 s_sub_u32 s34, s28, s30
 s_lshl_b32 s35, s34, 7
C0_uja:
 s_cmp_eq_u32 s32, 0
 s_mov_b32 s36, 1280
 s_cselect_b32 s36, 3072, s36
 s_lshl_b32 s33, s33, 1
 s_add_u32 s33, s33, s23
 s_mul_i32 s29, s23, 10240
 s_add_u32 s29, s29, 131072
 s_mul_i32 s35, s35, s36
 s_lshl_b32 s30, s33, 6
 s_add_u32 s35, s35, s30
 s_lshl_b32 s37, s36, 4
 v_lshrrev_b32 v6, 2, v1
 v_mul_lo_u32 v6, v6, s36
 v_and_b32 v7, 3, v1
 v_lshlrev_b32 v7, 4, v7
 v_add_u32 v6, v6, v7
 v_and_b32 v8, 15, v1
 v_lshrrev_b32 v9, 4, v1
 v_lshrrev_b32 v7, 1, v8
 v_xor_b32 v7, v7, v9
 v_lshlrev_b32 v7, 4, v7
 v_lshlrev_b32 v2, 7, v8
 v_add_u32 v2, v2, v7
 v_xor_b32 v3, 64, v2
 s_sub_u32 s23, s20, 4
 s_lshl_b32 s23, s23, 11
 v_add_u32 v2, s23, v2
 v_add_u32 v3, s23, v3
 v_mov_b32 v48, 0x3f803f80
 v_mov_b32 v49, 0x3f803f80
 v_mov_b32 v50, 0x3f803f80
 v_mov_b32 v51, 0x3f803f80
 s_waitcnt lgkmcnt(0)
 s_mov_b32 s8, s12
 s_mov_b32 s9, s13
 s_mov_b32 s10, 0x280000
 s_mov_b32 s11, 0x00020000
 s_cmp_eq_u32 s32, 0
 s_cselect_b32 s16, s38, s16
 s_cselect_b32 s17, s39, s17
 s_mov_b32 s18, 819200
 s_cselect_b32 s18, 1966080, s18
 s_cmp_eq_u32 s32, 2
 s_cselect_b32 s16, s40, s16
 s_cselect_b32 s17, s41, s17
 s_cselect_b32 s18, 1966080, s18
 s_mov_b32 s19, 0x00020000
 s_add_u32 m0, s25, 0x0
 s_nop 0
 buffer_load_dwordx4 v4, s[8:11], s26 offen lds
 s_add_u32 m0, s25, 0x400
 s_nop 0
 buffer_load_dwordx4 v5, s[8:11], s26 offen lds
 s_add_u32 m0, s25, 0x800
 s_nop 0
 buffer_load_dwordx4 v4, s[8:11], s27 offen lds
 s_add_u32 m0, s25, 0xc00
 s_nop 0
 buffer_load_dwordx4 v5, s[8:11], s27 offen lds
 s_add_u32 s26, s26, 128
 s_add_u32 s27, s27, 128
 s_add_u32 m0, s25, 0x2000
 s_nop 0
 buffer_load_dwordx4 v4, s[8:11], s26 offen lds
 s_add_u32 m0, s25, 0x2400
 s_nop 0
 buffer_load_dwordx4 v5, s[8:11], s26 offen lds
 s_add_u32 m0, s25, 0x2800
 s_nop 0
 buffer_load_dwordx4 v4, s[8:11], s27 offen lds
 s_add_u32 m0, s25, 0x2c00
 s_nop 0
 buffer_load_dwordx4 v5, s[8:11], s27 offen lds
 s_add_u32 s26, s26, 128
 s_add_u32 s27, s27, 128
 s_waitcnt vmcnt(4)
 s_barrier
 s_add_u32 m0, s25, 0x4000
 s_nop 0
 buffer_load_dwordx4 v4, s[8:11], s26 offen lds
 s_add_u32 m0, s25, 0x4400
 s_nop 0
 buffer_load_dwordx4 v5, s[8:11], s26 offen lds
 s_add_u32 m0, s25, 0x4800
 s_nop 0
 buffer_load_dwordx4 v4, s[8:11], s27 offen lds
 s_add_u32 m0, s25, 0x4c00
 s_nop 0
 buffer_load_dwordx4 v5, s[8:11], s27 offen lds
 s_add_u32 s26, s26, 128
 s_add_u32 s27, s27, 128
 ds_read_b128 v[52:55], v2 offset:0
 ds_read_b128 v[56:59], v3 offset:0
 s_waitcnt lgkmcnt(0)
 v_mfma_f32_16x16x32_bf16 v[40:43], v[52:55], v[52:55], 0
 v_mfma_f32_16x16x32_bf16 v[44:47], v[48:51], v[52:55], 0
 v_mfma_f32_16x16x32_bf16 v[40:43], v[56:59], v[56:59], v[40:43]
 v_mfma_f32_16x16x32_bf16 v[44:47], v[48:51], v[56:59], v[44:47]
 s_waitcnt vmcnt(4)
 s_barrier
 s_add_u32 m0, s25, 0x6000
 s_nop 0
 buffer_load_dwordx4 v4, s[8:11], s26 offen lds
 s_add_u32 m0, s25, 0x6400
 s_nop 0
 buffer_load_dwordx4 v5, s[8:11], s26 offen lds
 s_add_u32 m0, s25, 0x6800
 s_nop 0
 buffer_load_dwordx4 v4, s[8:11], s27 offen lds
 s_add_u32 m0, s25, 0x6c00
 s_nop 0
 buffer_load_dwordx4 v5, s[8:11], s27 offen lds
 s_add_u32 s26, s26, 128
 s_add_u32 s27, s27, 128
 ds_read_b128 v[52:55], v2 offset:8192
 ds_read_b128 v[56:59], v3 offset:8192
 s_waitcnt lgkmcnt(0)
 v_mfma_f32_16x16x32_bf16 v[40:43], v[52:55], v[52:55], v[40:43]
 v_mfma_f32_16x16x32_bf16 v[44:47], v[48:51], v[52:55], v[44:47]
 v_mfma_f32_16x16x32_bf16 v[40:43], v[56:59], v[56:59], v[40:43]
 v_mfma_f32_16x16x32_bf16 v[44:47], v[48:51], v[56:59], v[44:47]
 s_waitcnt vmcnt(4)
 s_barrier
 s_add_u32 m0, s25, 0x0
 s_nop 0
 buffer_load_dwordx4 v4, s[8:11], s26 offen lds
 s_add_u32 m0, s25, 0x400
 s_nop 0
 buffer_load_dwordx4 v5, s[8:11], s26 offen lds
 s_add_u32 m0, s25, 0x800
 s_nop 0
 buffer_load_dwordx4 v4, s[8:11], s27 offen lds
 s_add_u32 m0, s25, 0xc00
 s_nop 0
 buffer_load_dwordx4 v5, s[8:11], s27 offen lds
 s_add_u32 s26, s26, 128
 s_add_u32 s27, s27, 128
 ds_read_b128 v[52:55], v2 offset:16384
 ds_read_b128 v[56:59], v3 offset:16384
 s_waitcnt lgkmcnt(0)
 v_mfma_f32_16x16x32_bf16 v[40:43], v[52:55], v[52:55], v[40:43]
 v_mfma_f32_16x16x32_bf16 v[44:47], v[48:51], v[52:55], v[44:47]
 v_mfma_f32_16x16x32_bf16 v[40:43], v[56:59], v[56:59], v[40:43]
 v_mfma_f32_16x16x32_bf16 v[44:47], v[48:51], v[56:59], v[44:47]
 s_waitcnt vmcnt(4)
 s_barrier
 s_add_u32 m0, s25, 0x2000
 s_nop 0
 buffer_load_dwordx4 v4, s[8:11], s26 offen lds
 s_add_u32 m0, s25, 0x2400
 s_nop 0
 buffer_load_dwordx4 v5, s[8:11], s26 offen lds
 s_add_u32 m0, s25, 0x2800
 s_nop 0
 buffer_load_dwordx4 v4, s[8:11], s27 offen lds
 s_add_u32 m0, s25, 0x2c00
 s_nop 0
 buffer_load_dwordx4 v5, s[8:11], s27 offen lds
 s_add_u32 s26, s26, 128
 s_add_u32 s27, s27, 128
 ds_read_b128 v[52:55], v2 offset:24576
 ds_read_b128 v[56:59], v3 offset:24576
 s_waitcnt lgkmcnt(0)
 v_mfma_f32_16x16x32_bf16 v[40:43], v[52:55], v[52:55], v[40:43]
 v_mfma_f32_16x16x32_bf16 v[44:47], v[48:51], v[52:55], v[44:47]
 v_mfma_f32_16x16x32_bf16 v[40:43], v[56:59], v[56:59], v[40:43]
 v_mfma_f32_16x16x32_bf16 v[44:47], v[48:51], v[56:59], v[44:47]
 s_waitcnt vmcnt(4)
 s_barrier
 s_add_u32 m0, s25, 0x4000
 s_nop 0
 buffer_load_dwordx4 v4, s[8:11], s26 offen lds
 s_add_u32 m0, s25, 0x4400
 s_nop 0
 buffer_load_dwordx4 v5, s[8:11], s26 offen lds
 s_add_u32 m0, s25, 0x4800
 s_nop 0
 buffer_load_dwordx4 v4, s[8:11], s27 offen lds
 s_add_u32 m0, s25, 0x4c00
 s_nop 0
 buffer_load_dwordx4 v5, s[8:11], s27 offen lds
 s_add_u32 s26, s26, 128
 s_add_u32 s27, s27, 128
 s_mov_b32 m0, s29
 s_nop 0
 buffer_load_dwordx4 v6, s[16:19], s35 offen lds
 s_add_u32 s35, s35, s37
 s_add_u32 s29, s29, 0x400
 s_mov_b32 m0, s29
 s_nop 0
 buffer_load_dwordx4 v6, s[16:19], s35 offen lds
 s_add_u32 s35, s35, s37
 s_add_u32 s29, s29, 0x400
 s_mov_b32 m0, s29
 s_nop 0
 buffer_load_dwordx4 v6, s[16:19], s35 offen lds
 s_add_u32 s35, s35, s37
 s_add_u32 s29, s29, 0x400
 s_mov_b32 m0, s29
 s_nop 0
 buffer_load_dwordx4 v6, s[16:19], s35 offen lds
 s_add_u32 s35, s35, s37
 s_add_u32 s29, s29, 0x400
 s_mov_b32 m0, s29
 s_nop 0
 buffer_load_dwordx4 v6, s[16:19], s35 offen lds
 s_add_u32 s35, s35, s37
 s_add_u32 s29, s29, 0x400
 s_mov_b32 m0, s29
 s_nop 0
 buffer_load_dwordx4 v6, s[16:19], s35 offen lds
 s_add_u32 s35, s35, s37
 s_add_u32 s29, s29, 0x400
 s_mov_b32 m0, s29
 s_nop 0
 buffer_load_dwordx4 v6, s[16:19], s35 offen lds
 s_add_u32 s35, s35, s37
 s_add_u32 s29, s29, 0x400
 s_mov_b32 m0, s29
 s_nop 0
 buffer_load_dwordx4 v6, s[16:19], s35 offen lds
 s_add_u32 s35, s35, s37
 s_add_u32 s29, s29, 0x400
 s_mov_b32 m0, s29
 s_nop 0
 buffer_load_dwordx4 v6, s[16:19], s35 offen lds
 s_add_u32 s35, s35, s37
 s_add_u32 s29, s29, 0x400
 s_mov_b32 m0, s29
 s_nop 0
 buffer_load_dwordx4 v6, s[16:19], s35 offen lds
 s_sub_u32 s29, s29, 0x2400
 ds_read_b128 v[52:55], v2 offset:0
 ds_read_b128 v[56:59], v3 offset:0
 s_waitcnt lgkmcnt(0)
 v_mfma_f32_16x16x32_bf16 v[40:43], v[52:55], v[52:55], v[40:43]
 v_mfma_f32_16x16x32_bf16 v[44:47], v[48:51], v[52:55], v[44:47]
 v_mfma_f32_16x16x32_bf16 v[40:43], v[56:59], v[56:59], v[40:43]
 v_mfma_f32_16x16x32_bf16 v[44:47], v[48:51], v[56:59], v[44:47]
 s_waitcnt vmcnt(14)
 s_barrier
 s_add_u32 m0, s25, 0x6000
 s_nop 0
 buffer_load_dwordx4 v4, s[8:11], s26 offen lds
 s_add_u32 m0, s25, 0x6400
 s_nop 0
 buffer_load_dwordx4 v5, s[8:11], s26 offen lds
 s_add_u32 m0, s25, 0x6800
 s_nop 0
 buffer_load_dwordx4 v4, s[8:11], s27 offen lds
 s_add_u32 m0, s25, 0x6c00
 s_nop 0
 buffer_load_dwordx4 v5, s[8:11], s27 offen lds
 s_add_u32 s26, s26, 128
 s_add_u32 s27, s27, 128
 ds_read_b128 v[52:55], v2 offset:8192
 ds_read_b128 v[56:59], v3 offset:8192
 s_waitcnt lgkmcnt(0)
 v_mfma_f32_16x16x32_bf16 v[40:43], v[52:55], v[52:55], v[40:43]
 v_mfma_f32_16x16x32_bf16 v[44:47], v[48:51], v[52:55], v[44:47]
 v_mfma_f32_16x16x32_bf16 v[40:43], v[56:59], v[56:59], v[40:43]
 v_mfma_f32_16x16x32_bf16 v[44:47], v[48:51], v[56:59], v[44:47]
 s_waitcnt vmcnt(14)
 s_barrier
 s_add_u32 m0, s25, 0x0
 s_nop 0
 buffer_load_dwordx4 v4, s[8:11], s26 offen lds
 s_add_u32 m0, s25, 0x400
 s_nop 0
 buffer_load_dwordx4 v5, s[8:11], s26 offen lds
 s_add_u32 m0, s25, 0x800
 s_nop 0
 buffer_load_dwordx4 v4, s[8:11], s27 offen lds
 s_add_u32 m0, s25, 0xc00
 s_nop 0
 buffer_load_dwordx4 v5, s[8:11], s27 offen lds
 s_add_u32 s26, s26, 128
 s_add_u32 s27, s27, 128
 ds_read_b128 v[52:55], v2 offset:16384
 ds_read_b128 v[56:59], v3 offset:16384
 s_waitcnt lgkmcnt(0)
 v_mfma_f32_16x16x32_bf16 v[40:43], v[52:55], v[52:55], v[40:43]
 v_mfma_f32_16x16x32_bf16 v[44:47], v[48:51], v[52:55], v[44:47]
 v_mfma_f32_16x16x32_bf16 v[40:43], v[56:59], v[56:59], v[40:43]
 v_mfma_f32_16x16x32_bf16 v[44:47], v[48:51], v[56:59], v[44:47]
 s_waitcnt vmcnt(4)
 s_barrier
 s_add_u32 m0, s25, 0x2000
 s_nop 0
 buffer_load_dwordx4 v4, s[8:11], s26 offen lds
 s_add_u32 m0, s25, 0x2400
 s_nop 0
 buffer_load_dwordx4 v5, s[8:11], s26 offen lds
 s_add_u32 m0, s25, 0x2800
 s_nop 0
 buffer_load_dwordx4 v4, s[8:11], s27 offen lds
 s_add_u32 m0, s25, 0x2c00
 s_nop 0
 buffer_load_dwordx4 v5, s[8:11], s27 offen lds
 s_add_u32 s26, s26, 128
 s_add_u32 s27, s27, 128
 ds_read_b128 v[52:55], v2 offset:24576
 ds_read_b128 v[56:59], v3 offset:24576
 v_and_b32 v12, 15, v1
 v_lshrrev_b32 v12, 2, v12
 v_lshlrev_b32 v12, 6, v12
 v_and_b32 v13, 16, v1
 v_lshlrev_b32 v13, 1, v13
 v_add_u32 v12, v12, v13
 v_and_b32 v13, 3, v1
 v_lshlrev_b32 v13, 3, v13
 v_add_u32 v12, v12, v13
 v_add_u32 v12, s29, v12
 v_lshrrev_b32 v13, 5, v1
 s_cmp_eq_u32 s32, 1
 s_cbranch_scc1 C0_rwo
 v_lshlrev_b32 v14, 9, v13
 v_add_u32 v12, v12, v14
 ds_read_b64_tr_b16 v[64:65], v12 offset:0
 ds_read_b64_tr_b16 v[66:67], v12 offset:256
 ds_read_b64_tr_b16 v[68:69], v12 offset:1024
 ds_read_b64_tr_b16 v[70:71], v12 offset:1280
 ds_read_b64_tr_b16 v[72:73], v12 offset:2048
 ds_read_b64_tr_b16 v[74:75], v12 offset:2304
 ds_read_b64_tr_b16 v[76:77], v12 offset:3072
 ds_read_b64_tr_b16 v[78:79], v12 offset:3328
 ds_read_b64_tr_b16 v[80:81], v12 offset:4096
 ds_read_b64_tr_b16 v[82:83], v12 offset:4352
 ds_read_b64_tr_b16 v[84:85], v12 offset:5120
 ds_read_b64_tr_b16 v[86:87], v12 offset:5376
 ds_read_b64_tr_b16 v[88:89], v12 offset:6144
 ds_read_b64_tr_b16 v[90:91], v12 offset:6400
 ds_read_b64_tr_b16 v[92:93], v12 offset:7168
 ds_read_b64_tr_b16 v[94:95], v12 offset:7424
 ds_read_b64_tr_b16 v[96:97], v12 offset:8192
 ds_read_b64_tr_b16 v[98:99], v12 offset:8448
 ds_read_b64_tr_b16 v[100:101], v12 offset:9216
 ds_read_b64_tr_b16 v[102:103], v12 offset:9472
 s_branch C0_rj
C0_rwo:
 v_mul_i32_i24 v16, -768, v13
 v_add_u32 v16, v12, v16
 v_mul_i32_i24 v17, 256, v13
 v_add_u32 v17, v12, v17
 v_mul_i32_i24 v18, 512, v13
 v_add_u32 v18, v12, v18
 v_mul_i32_i24 v19, 768, v13
 v_add_u32 v19, v12, v19
 v_mul_i32_i24 v20, 1536, v13
 v_add_u32 v20, v12, v20
 ds_read_b64_tr_b16 v[64:65], v18 offset:0
 ds_read_b64_tr_b16 v[66:67], v18 offset:256
 ds_read_b64_tr_b16 v[68:69], v17 offset:1024
 ds_read_b64_tr_b16 v[70:71], v16 offset:2304
 ds_read_b64_tr_b16 v[72:73], v19 offset:1792
 ds_read_b64_tr_b16 v[74:75], v19 offset:2048
 ds_read_b64_tr_b16 v[76:77], v18 offset:3072
 ds_read_b64_tr_b16 v[78:79], v20 offset:3328
 ds_read_b64_tr_b16 v[80:81], v18 offset:3840
 ds_read_b64_tr_b16 v[82:83], v18 offset:4096
 ds_read_b64_tr_b16 v[84:85], v18 offset:5120
 ds_read_b64_tr_b16 v[86:87], v18 offset:5376
 ds_read_b64_tr_b16 v[88:89], v17 offset:6144
 ds_read_b64_tr_b16 v[90:91], v16 offset:7424
 ds_read_b64_tr_b16 v[92:93], v19 offset:6912
 ds_read_b64_tr_b16 v[94:95], v19 offset:7168
 ds_read_b64_tr_b16 v[96:97], v18 offset:8192
 ds_read_b64_tr_b16 v[98:99], v20 offset:8448
 ds_read_b64_tr_b16 v[100:101], v18 offset:8960
 ds_read_b64_tr_b16 v[102:103], v18 offset:9216
C0_rj:
 s_waitcnt lgkmcnt(0)
 v_mfma_f32_16x16x32_bf16 v[40:43], v[52:55], v[52:55], v[40:43]
 v_mfma_f32_16x16x32_bf16 v[44:47], v[48:51], v[52:55], v[44:47]
 v_mfma_f32_16x16x32_bf16 v[40:43], v[56:59], v[56:59], v[40:43]
 v_mfma_f32_16x16x32_bf16 v[44:47], v[48:51], v[56:59], v[44:47]
 s_waitcnt vmcnt(4)
 s_barrier
 ds_read_b128 v[52:55], v2 offset:0
 ds_read_b128 v[56:59], v3 offset:0
 v_and_b32 v12, 31, v1
 s_lshl_b32 s30, s33, 5
 v_add_u32 v12, s30, v12
 s_cmp_eq_u32 s32, 0
 s_mov_b32 s30, 3277
 s_cselect_b32 s30, 1366, s30
 s_cselect_b32 s31, 12, 5
 v_mul_lo_u32 v13, v12, s30
 v_lshrrev_b32 v13, 18, v13
 v_lshrrev_b32 v14, 4, v12
 v_mul_lo_u32 v15, v13, s31
 v_sub_u32 v14, v14, v15
 v_mul_u32_u24 v15, 901120, v13
 v_lshl_add_u32 v15, v14, 10, v15
 v_lshrrev_b32 v13, 5, v1
 v_lshl_add_u32 v15, v13, 8, v15
 v_and_b32 v13, 15, v12
 v_lshl_add_u32 v15, v13, 4, v15
 s_cmp_eq_u32 s32, 0
 s_mov_b32 s36, 5120
 s_cselect_b32 s36, 12288, s36
 s_mov_b32 s35, 0
 s_cselect_b32 s35, 102400, s35
 s_cmp_eq_u32 s32, 2
 s_cselect_b32 s35, 348160, s35
 s_cselect_b32 s30, 4, 5
 s_mul_i32 s30, s30, s34
 s_mul_i32 s30, s30, s36
 s_add_u32 s35, s35, s30
 s_sub_u32 s36, s36, 512
 s_mov_b32 s37, 0
 buffer_store_dwordx4 v[64:67], v15, s[4:7], s35 offen sc1
 s_add_u32 s35, s35, 512
 buffer_store_dwordx4 v[68:71], v15, s[4:7], s35 offen sc1
 s_add_u32 s35, s35, s36
 buffer_store_dwordx4 v[72:75], v15, s[4:7], s35 offen sc1
 s_add_u32 s35, s35, 512
 buffer_store_dwordx4 v[76:79], v15, s[4:7], s35 offen sc1
 s_add_u32 s35, s35, s36
 buffer_store_dwordx4 v[80:83], v15, s[4:7], s35 offen sc1
 s_add_u32 s35, s35, 512
 buffer_store_dwordx4 v[84:87], v15, s[4:7], s35 offen sc1
 s_add_u32 s35, s35, s36
 buffer_store_dwordx4 v[88:91], v15, s[4:7], s35 offen sc1
 s_add_u32 s35, s35, 512
 buffer_store_dwordx4 v[92:95], v15, s[4:7], s35 offen sc1
 s_add_u32 s35, s35, s36
 s_cmp_eq_u32 s32, 2
 s_cselect_b32 s35, 0x10000000, s35
 buffer_store_dwordx4 v[96:99], v15, s[4:7], s35 offen sc1
 s_add_u32 s35, s35, 512
 buffer_store_dwordx4 v[100:103], v15, s[4:7], s35 offen sc1
 v_mfma_f32_32x32x16_bf16 v[104:119], v[48:51], v[64:67], 0
 v_mfma_f32_32x32x16_bf16 v[104:119], v[48:51], v[68:71], v[104:119]
 v_mfma_f32_32x32x16_bf16 v[104:119], v[48:51], v[72:75], v[104:119]
 v_mfma_f32_32x32x16_bf16 v[104:119], v[48:51], v[76:79], v[104:119]
 v_mfma_f32_32x32x16_bf16 v[104:119], v[48:51], v[80:83], v[104:119]
 v_mfma_f32_32x32x16_bf16 v[104:119], v[48:51], v[84:87], v[104:119]
 v_mfma_f32_32x32x16_bf16 v[104:119], v[48:51], v[88:91], v[104:119]
 v_mfma_f32_32x32x16_bf16 v[104:119], v[48:51], v[92:95], v[104:119]
 v_mfma_f32_32x32x16_bf16 v[104:119], v[48:51], v[96:99], v[104:119]
 v_mfma_f32_32x32x16_bf16 v[104:119], v[48:51], v[100:103], v[104:119]
 v_lshlrev_b32 v12, 2, v12
 s_mul_i32 s30, s34, 6144
 s_add_u32 s30, s30, 0x6e1e00
 s_cmp_eq_u32 s32, 0
 s_cselect_b32 s30, s30, 0x10000000
 s_mov_b32 exec_hi, 0
 s_nop 5
 buffer_store_dword v104, v12, s[4:7], s30 offen
 s_mov_b32 exec_hi, -1
 v_lshlrev_b32 v12, 4, v1
 s_lshl_b32 s30, s2, 7
 s_add_u32 s30, s30, 0x6e8000
 v_mov_b32 v16, 0
 v_mov_b32 v17, 0
 v_mov_b32 v18, 0
 v_mov_b32 v19, 0
 s_lshl_b32 s31, s2, 5
 v_add_u32 v13, s31, v1
 v_mul_u32_u24 v13, 336, v13
 s_cmp_eq_u32 s20, 6
 s_cbranch_scc0 C0_ones
 s_mov_b64 exec, 0xff
 buffer_store_dwordx4 v[16:19], v12, s[4:7], s30 offen
 s_mul_i32 s30, s2, 32
 s_add_u32 s30, s30, 0x6f0000
 s_bfm_b64 exec, 2, 0
 buffer_store_dwordx4 v[16:19], v12, s[4:7], s30 offen offset:0
 s_branch C0_onej
C0_ones:
 s_mov_b32 s30, 0x192e140
 s_mov_b32 exec_hi, 0
 buffer_store_dwordx4 v[48:51], v13, s[4:7], s30 offen
C0_onej:
 s_mov_b64 exec, -1
 s_waitcnt lgkmcnt(0)
 v_mfma_f32_16x16x32_bf16 v[40:43], v[52:55], v[52:55], v[40:43]
 v_mfma_f32_16x16x32_bf16 v[44:47], v[48:51], v[52:55], v[44:47]
 v_mfma_f32_16x16x32_bf16 v[40:43], v[56:59], v[56:59], v[40:43]
 v_mfma_f32_16x16x32_bf16 v[44:47], v[48:51], v[56:59], v[44:47]
 s_waitcnt vmcnt(12)
 s_barrier
 ds_read_b128 v[52:55], v2 offset:8192
 ds_read_b128 v[56:59], v3 offset:8192
 s_waitcnt lgkmcnt(0)
 v_mfma_f32_16x16x32_bf16 v[40:43], v[52:55], v[52:55], v[40:43]
 v_mfma_f32_16x16x32_bf16 v[44:47], v[48:51], v[52:55], v[44:47]
 v_mfma_f32_16x16x32_bf16 v[40:43], v[56:59], v[56:59], v[40:43]
 v_mfma_f32_16x16x32_bf16 v[44:47], v[48:51], v[56:59], v[44:47]
 v_and_b32 v8, 3, v1
 v_and_b32 v9, 15, v1
 v_lshlrev_b32 v9, 2, v9
 s_sub_u32 s23, s20, 4
 s_lshl_b32 s23, s23, 6
 s_add_u32 s23, s23, 161792
 v_add_u32 v9, s23, v9
 v_cmp_eq_u32 vcc, 1, v8
 s_nop 1
 v_cndmask_b32 v10, v40, v41, vcc
 v_cmp_eq_u32 vcc, 2, v8
 s_nop 1
 v_cndmask_b32 v10, v10, v42, vcc
 v_cmp_eq_u32 vcc, 3, v8
 s_nop 1
 v_cndmask_b32 v10, v10, v43, vcc
 v_mul_f32 v11, 0x3acccccd, v44
 v_mul_f32 v10, 0x3acccccd, v10
 v_fma_f32 v10, -v11, v11, v10
 v_max_f32 v10, 0, v10
 v_add_f32 v10, 0x3727c5ac, v10
 v_rsq_f32 v10, v10
 s_nop 0
 v_mul_f32 v11, v11, v10
 s_mov_b32 exec_lo, 0x00f0000f
 s_mov_b32 exec_hi, 0xf0000f00
 ds_write_b32 v9, v10
 ds_write_b32 v9, v11 offset:256
 s_mov_b64 exec, -1
 s_waitcnt lgkmcnt(0)
 s_barrier
 s_endpgm
C0_end:
 s_endpgm
.globl c1_kernel
.p2align 8
.type c1_kernel,@function
c1_kernel:
C1_start:
 s_cmp_ge_u32 s2, 256
 s_cbranch_scc1 C1_end
 s_load_dwordx2 s[4:5], s[0:1], 80
 s_load_dwordx2 s[8:9], s[0:1], 40
 s_load_dwordx2 s[12:13], s[0:1], 56
 s_load_dwordx2 s[16:17], s[0:1], 0
 v_lshrrev_b32 v1, 6, v0
 s_nop 0
 v_readfirstlane_b32 s20, v1
 v_and_b32 v1, 63, v0
 s_mov_b32 s6, 0x10000000
 s_mov_b32 s7, 0x00020000
 s_mov_b32 s10, 3072
 s_mov_b32 s11, 0x00020000
 s_mov_b32 s14, 1280
 s_mov_b32 s15, 0x00020000
 s_mov_b32 s18, 2621440
 s_mov_b32 s19, 0x00020000
 s_and_b32 s21, s2, 31
 s_lshr_b32 s22, s2, 5
 s_cmp_ge_u32 s20, 6
 s_cbranch_scc1 C1_al
 s_cmp_eq_u32 s20, 4
 s_cbranch_scc1 C1_bl0
 s_cmp_eq_u32 s20, 5
 s_cbranch_scc1 C1_bl1
 v_lshrrev_b32 v1, 6, v0
 s_nop 0
 v_readfirstlane_b32 s40, v1
 v_and_b32 v1, 63, v0
 s_lshr_b32 s41, s2, 3
 s_and_b32 s42, s2, 7
 s_lshl_b32 s45, s40, 3
 s_add_u32 s42, s42, s45
 s_lshr_b32 s45, s41, 1
 s_and_b32 s46, s41, 1
 s_mul_i32 s45, s45, 5
 s_mul_i32 s47, s46, 3
 s_add_u32 s47, s47, s45
 s_lshl_b32 s47, s47, 8
 s_add_u32 s45, s45, 2
 s_lshl_b32 s45, s45, 8
 s_lshl_b32 s46, s46, 3
 s_add_u32 s45, s45, s46
 v_and_b32 v6, 15, v1
 v_lshlrev_b32 v6, 4, v6
 v_bfe_u32 v7, v1, 4, 1
 v_lshrrev_b32 v4, 5, v1
 v_lshlrev_b32 v5, 8, v4
 v_add_u32 v5, v5, v6
 v_add_u32 v5, s47, v5
 v_add_u32 v6, s45, v6
 v_mul_u32_u24 v2, 61440, v7
 v_add_u32 v3, v2, v6
 v_add_u32 v2, v2, v5
 v_mul_u32_u24 v7, 61440, v7
 v_add_u32 v168, v7, v5
 v_add_u32 v169, v7, v6
 v_and_b32 v5, 31, v1
 v_min_u32 v5, 20, v5
 v_lshlrev_b32 v5, 4, v5
 v_mul_u32_u24 v4, 336, v4
 v_add_u32 v4, v4, v5
 s_lshl_b32 s50, s42, 2
 s_mul_i32 s52, s50, 61440
 s_add_u32 s52, s52, 18333696
 s_add_u32 s53, s52, 122880
 s_mul_i32 s50, s50, 61440
 s_add_u32 s50, s50, 18292736
 s_add_u32 s51, s50, 122880
 s_mul_i32 s54, s41, 86016
 s_add_u32 s54, s54, 26402816
 v_mov_b32 v12, 0
 v_mov_b32 v13, 0
 v_mov_b32 v14, 0
 v_mov_b32 v15, 0
 v_mov_b32 v20, 0
 v_mov_b32 v21, 0
 v_mov_b32 v22, 0
 v_mov_b32 v23, 0
 v_mov_b32 v110, 0x3f803f80
 v_mov_b32 v111, 0
 v_mov_b32 v126, 0x3f803f80
 v_mov_b32 v127, 0
 v_mov_b32 v142, 0x3f803f80
 v_mov_b32 v143, 0
 v_mov_b32 v158, 0x3f803f80
 v_mov_b32 v159, 0
 s_mov_b32 s49, 0
 s_waitcnt lgkmcnt(0)
 buffer_load_dwordx4 v[8:11], v2, s[4:7], s50 offen
 buffer_load_dwordx4 v[16:19], v2, s[4:7], s51 offen
 s_mov_b32 exec_hi, 0
 buffer_load_dwordx2 v[12:13], v3, s[4:7], s50 offen
 buffer_load_dwordx2 v[20:21], v3, s[4:7], s51 offen
 s_mov_b32 exec_hi, -1
C1_ATT_start:
 s_mov_b32 s43, 18313216
 s_mov_b32 s44, s54
 buffer_load_dwordx4 v[152:155], v2, s[4:7], s43 offen
 buffer_load_dwordx2 v[156:157], v3, s[4:7], s43 offen
 s_add_u32 s43, s43, 122880
 buffer_load_dwordx4 v[104:107], v2, s[4:7], s43 offen
 buffer_load_dwordx2 v[108:109], v3, s[4:7], s43 offen
 buffer_load_dwordx4 v[112:115], v4, s[4:7], s44 offen
 buffer_load_dwordx4 v[116:119], v4, s[4:7], s44 offen offset:672
 s_add_u32 s43, s43, 122880
 s_add_u32 s44, s44, 1344
 buffer_load_dwordx4 v[120:123], v2, s[4:7], s43 offen
 buffer_load_dwordx2 v[124:125], v3, s[4:7], s43 offen
 buffer_load_dwordx4 v[128:131], v4, s[4:7], s44 offen
 buffer_load_dwordx4 v[132:135], v4, s[4:7], s44 offen offset:672
 s_add_u32 s43, s43, 122880
 s_add_u32 s44, s44, 1344
 buffer_load_dwordx4 v[136:139], v2, s[4:7], s43 offen
 buffer_load_dwordx2 v[140:141], v3, s[4:7], s43 offen
 buffer_load_dwordx4 v[144:147], v4, s[4:7], s44 offen
 buffer_load_dwordx4 v[148:151], v4, s[4:7], s44 offen offset:672
 s_add_u32 s43, s43, 122880
 s_sub_u32 s44, s44, 1344
 s_waitcnt vmcnt(12)
 s_cmp_lg_u32 s49, 0
 s_cbranch_scc1 C1_ATT_havem
 v_mfma_f32_32x32x16_bf16 v[24:39], v[152:155], v[8:11], 0
 v_mfma_f32_32x32x16_bf16 v[24:39], v[156:159], v[12:15], v[24:39]
 v_mfma_f32_32x32x16_bf16 v[40:55], v[152:155], v[16:19], 0
 v_mfma_f32_32x32x16_bf16 v[40:55], v[156:159], v[20:23], v[40:55]
 s_nop 7
 s_nop 1
 v_max3_f32 v6, v24, v25, v26
 v_max3_f32 v6, v6, v27, v28
 v_max3_f32 v6, v6, v29, v30
 v_max3_f32 v6, v6, v31, v32
 v_max3_f32 v6, v6, v33, v34
 v_max3_f32 v6, v6, v35, v36
 v_max3_f32 v6, v6, v37, v38
 v_max_f32 v6, v6, v39
 v_max3_f32 v7, v40, v41, v42
 v_max3_f32 v7, v7, v43, v44
 v_max3_f32 v7, v7, v45, v46
 v_max3_f32 v7, v7, v47, v48
 v_max3_f32 v7, v7, v49, v50
 v_max3_f32 v7, v7, v51, v52
 v_max3_f32 v7, v7, v53, v54
 v_max_f32 v7, v7, v55
 v_mov_b32 v5, v6
 s_nop 1
 v_permlane32_swap_b32 v6, v5
 v_max_f32 v6, v6, v5
 v_sub_f32 v6, 0, v6
 v_cvt_pk_bf16_f32 v6, v6, 0
 v_and_b32 v6, 0xffff, v6
 s_mov_b32 exec_hi, 0
 v_mov_b32 v14, v6
 s_mov_b32 exec_hi, -1
 v_mov_b32 v5, v7
 s_nop 1
 v_permlane32_swap_b32 v7, v5
 v_max_f32 v7, v7, v5
 v_sub_f32 v7, 0, v7
 v_cvt_pk_bf16_f32 v7, v7, 0
 v_and_b32 v7, 0xffff, v7
 s_mov_b32 exec_hi, 0
 v_mov_b32 v22, v7
 s_mov_b32 exec_hi, -1
C1_ATT_havem:
 s_nop 1
 v_mfma_f32_32x32x16_bf16 v[24:39], v[152:155], v[8:11], 0
 v_mfma_f32_32x32x16_bf16 v[24:39], v[156:159], v[12:15], v[24:39]
 v_mfma_f32_32x32x16_bf16 v[40:55], v[152:155], v[16:19], 0
 v_mfma_f32_32x32x16_bf16 v[40:55], v[156:159], v[20:23], v[40:55]
 v_mov_b32 v72, 0
 v_mov_b32 v73, 0
 v_mov_b32 v74, 0
 v_mov_b32 v75, 0
 v_mov_b32 v76, 0
 v_mov_b32 v77, 0
 v_mov_b32 v78, 0
 v_mov_b32 v79, 0
 v_mov_b32 v80, 0
 v_mov_b32 v81, 0
 v_mov_b32 v82, 0
 v_mov_b32 v83, 0
 v_mov_b32 v84, 0
 v_mov_b32 v85, 0
 v_mov_b32 v86, 0
 v_mov_b32 v87, 0
 v_mov_b32 v88, 0
 v_mov_b32 v89, 0
 v_mov_b32 v90, 0
 v_mov_b32 v91, 0
 v_mov_b32 v92, 0
 v_mov_b32 v93, 0
 v_mov_b32 v94, 0
 v_mov_b32 v95, 0
 v_mov_b32 v96, 0
 v_mov_b32 v97, 0
 v_mov_b32 v98, 0
 v_mov_b32 v99, 0
 v_mov_b32 v100, 0
 v_mov_b32 v101, 0
 v_mov_b32 v102, 0
 v_mov_b32 v103, 0
 v_exp_f32 v24, v24
 v_exp_f32 v25, v25
 v_exp_f32 v26, v26
 v_exp_f32 v27, v27
 v_cvt_pk_bf16_f32 v56, v24, v25
 v_cvt_pk_bf16_f32 v57, v26, v27
 v_exp_f32 v28, v28
 v_exp_f32 v29, v29
 v_exp_f32 v30, v30
 v_exp_f32 v31, v31
 v_cvt_pk_bf16_f32 v58, v28, v29
 v_cvt_pk_bf16_f32 v59, v30, v31
 v_exp_f32 v32, v32
 v_exp_f32 v33, v33
 v_exp_f32 v34, v34
 v_exp_f32 v35, v35
 v_cvt_pk_bf16_f32 v60, v32, v33
 v_cvt_pk_bf16_f32 v61, v34, v35
 v_exp_f32 v36, v36
 v_exp_f32 v37, v37
 v_exp_f32 v38, v38
 v_exp_f32 v39, v39
 v_cvt_pk_bf16_f32 v62, v36, v37
 v_cvt_pk_bf16_f32 v63, v38, v39
 s_mov_b32 s48, 7
 s_waitcnt vmcnt(8)
 v_mfma_f32_32x32x16_bf16 v[24:39], v[104:107], v[8:11], 0
C1_ATT_loop:
 v_exp_f32 v40, v40
 v_exp_f32 v41, v41
 v_exp_f32 v42, v42
 v_exp_f32 v43, v43
 v_cvt_pk_bf16_f32 v64, v40, v41
 v_cvt_pk_bf16_f32 v65, v42, v43
 v_mfma_f32_32x32x16_bf16 v[24:39], v[108:111], v[12:15], v[24:39]
 buffer_load_dwordx4 v[152:155], v2, s[4:7], s43 offen
 v_exp_f32 v44, v44
 v_exp_f32 v45, v45
 v_exp_f32 v46, v46
 v_exp_f32 v47, v47
 v_cvt_pk_bf16_f32 v66, v44, v45
 v_cvt_pk_bf16_f32 v67, v46, v47
 v_mfma_f32_32x32x16_bf16 v[72:87], v[112:115], v[56:59], v[72:87]
 buffer_load_dwordx2 v[156:157], v3, s[4:7], s43 offen
 v_exp_f32 v48, v48
 v_exp_f32 v49, v49
 v_exp_f32 v50, v50
 v_exp_f32 v51, v51
 v_cvt_pk_bf16_f32 v68, v48, v49
 v_cvt_pk_bf16_f32 v69, v50, v51
 v_mfma_f32_32x32x16_bf16 v[72:87], v[116:119], v[60:63], v[72:87]
 s_add_u32 s44, s44, 2688
 v_exp_f32 v52, v52
 v_exp_f32 v53, v53
 v_exp_f32 v54, v54
 v_exp_f32 v55, v55
 v_cvt_pk_bf16_f32 v70, v52, v53
 v_cvt_pk_bf16_f32 v71, v54, v55
 v_mfma_f32_32x32x16_bf16 v[40:55], v[104:107], v[16:19], 0
 buffer_load_dwordx4 v[160:163], v4, s[4:7], s44 offen
 v_exp_f32 v24, v24
 v_exp_f32 v25, v25
 v_exp_f32 v26, v26
 v_exp_f32 v27, v27
 v_cvt_pk_bf16_f32 v56, v24, v25
 v_cvt_pk_bf16_f32 v57, v26, v27
 v_mfma_f32_32x32x16_bf16 v[40:55], v[108:111], v[20:23], v[40:55]
 s_waitcnt vmcnt(7)
 v_exp_f32 v28, v28
 v_exp_f32 v29, v29
 v_exp_f32 v30, v30
 v_exp_f32 v31, v31
 v_cvt_pk_bf16_f32 v58, v28, v29
 v_cvt_pk_bf16_f32 v59, v30, v31
 v_mfma_f32_32x32x16_bf16 v[88:103], v[112:115], v[64:67], v[88:103]
 buffer_load_dwordx4 v[164:167], v4, s[4:7], s44 offen offset:672
 v_exp_f32 v32, v32
 v_exp_f32 v33, v33
 v_exp_f32 v34, v34
 v_exp_f32 v35, v35
 v_cvt_pk_bf16_f32 v60, v32, v33
 v_cvt_pk_bf16_f32 v61, v34, v35
 v_mfma_f32_32x32x16_bf16 v[88:103], v[116:119], v[68:71], v[88:103]
 s_add_u32 s43, s43, 122880
 v_exp_f32 v36, v36
 v_exp_f32 v37, v37
 v_exp_f32 v38, v38
 v_exp_f32 v39, v39
 v_cvt_pk_bf16_f32 v62, v36, v37
 v_cvt_pk_bf16_f32 v63, v38, v39
 v_mfma_f32_32x32x16_bf16 v[24:39], v[120:123], v[8:11], 0
 buffer_load_dwordx4 v[104:107], v2, s[4:7], s43 offen
 v_exp_f32 v40, v40
 v_exp_f32 v41, v41
 v_exp_f32 v42, v42
 v_exp_f32 v43, v43
 v_cvt_pk_bf16_f32 v64, v40, v41
 v_cvt_pk_bf16_f32 v65, v42, v43
 v_mfma_f32_32x32x16_bf16 v[24:39], v[124:127], v[12:15], v[24:39]
 v_exp_f32 v44, v44
 v_exp_f32 v45, v45
 v_exp_f32 v46, v46
 v_exp_f32 v47, v47
 v_cvt_pk_bf16_f32 v66, v44, v45
 v_cvt_pk_bf16_f32 v67, v46, v47
 v_mfma_f32_32x32x16_bf16 v[72:87], v[128:131], v[56:59], v[72:87]
 buffer_load_dwordx2 v[108:109], v3, s[4:7], s43 offen
 v_exp_f32 v48, v48
 v_exp_f32 v49, v49
 v_exp_f32 v50, v50
 v_exp_f32 v51, v51
 v_cvt_pk_bf16_f32 v68, v48, v49
 v_cvt_pk_bf16_f32 v69, v50, v51
 v_mfma_f32_32x32x16_bf16 v[72:87], v[132:135], v[60:63], v[72:87]
 s_add_u32 s43, s43, 122880
 v_exp_f32 v52, v52
 v_exp_f32 v53, v53
 v_exp_f32 v54, v54
 v_exp_f32 v55, v55
 v_cvt_pk_bf16_f32 v70, v52, v53
 v_cvt_pk_bf16_f32 v71, v54, v55
 v_mfma_f32_32x32x16_bf16 v[40:55], v[120:123], v[16:19], 0
 buffer_load_dwordx4 v[112:115], v4, s[4:7], s44 offen offset:1344
 v_exp_f32 v24, v24
 v_exp_f32 v25, v25
 v_exp_f32 v26, v26
 v_exp_f32 v27, v27
 v_cvt_pk_bf16_f32 v56, v24, v25
 v_cvt_pk_bf16_f32 v57, v26, v27
 v_mfma_f32_32x32x16_bf16 v[40:55], v[124:127], v[20:23], v[40:55]
 s_waitcnt vmcnt(7)
 v_exp_f32 v28, v28
 v_exp_f32 v29, v29
 v_exp_f32 v30, v30
 v_exp_f32 v31, v31
 v_cvt_pk_bf16_f32 v58, v28, v29
 v_cvt_pk_bf16_f32 v59, v30, v31
 v_mfma_f32_32x32x16_bf16 v[88:103], v[128:131], v[64:67], v[88:103]
 buffer_load_dwordx4 v[116:119], v4, s[4:7], s44 offen offset:2016
 v_exp_f32 v32, v32
 v_exp_f32 v33, v33
 v_exp_f32 v34, v34
 v_exp_f32 v35, v35
 v_cvt_pk_bf16_f32 v60, v32, v33
 v_cvt_pk_bf16_f32 v61, v34, v35
 v_mfma_f32_32x32x16_bf16 v[88:103], v[132:135], v[68:71], v[88:103]
 v_exp_f32 v36, v36
 v_exp_f32 v37, v37
 v_exp_f32 v38, v38
 v_exp_f32 v39, v39
 v_cvt_pk_bf16_f32 v62, v36, v37
 v_cvt_pk_bf16_f32 v63, v38, v39
 v_mfma_f32_32x32x16_bf16 v[24:39], v[136:139], v[8:11], 0
 buffer_load_dwordx4 v[120:123], v2, s[4:7], s43 offen
 v_exp_f32 v40, v40
 v_exp_f32 v41, v41
 v_exp_f32 v42, v42
 v_exp_f32 v43, v43
 v_cvt_pk_bf16_f32 v64, v40, v41
 v_cvt_pk_bf16_f32 v65, v42, v43
 v_mfma_f32_32x32x16_bf16 v[24:39], v[140:143], v[12:15], v[24:39]
 s_add_u32 s44, s44, 2688
 v_exp_f32 v44, v44
 v_exp_f32 v45, v45
 v_exp_f32 v46, v46
 v_exp_f32 v47, v47
 v_cvt_pk_bf16_f32 v66, v44, v45
 v_cvt_pk_bf16_f32 v67, v46, v47
 v_mfma_f32_32x32x16_bf16 v[72:87], v[144:147], v[56:59], v[72:87]
 buffer_load_dwordx2 v[124:125], v3, s[4:7], s43 offen
 v_exp_f32 v48, v48
 v_exp_f32 v49, v49
 v_exp_f32 v50, v50
 v_exp_f32 v51, v51
 v_cvt_pk_bf16_f32 v68, v48, v49
 v_cvt_pk_bf16_f32 v69, v50, v51
 v_mfma_f32_32x32x16_bf16 v[72:87], v[148:151], v[60:63], v[72:87]
 s_add_u32 s43, s43, 122880
 v_exp_f32 v52, v52
 v_exp_f32 v53, v53
 v_exp_f32 v54, v54
 v_exp_f32 v55, v55
 v_cvt_pk_bf16_f32 v70, v52, v53
 v_cvt_pk_bf16_f32 v71, v54, v55
 v_mfma_f32_32x32x16_bf16 v[40:55], v[136:139], v[16:19], 0
 buffer_load_dwordx4 v[128:131], v4, s[4:7], s44 offen
 v_exp_f32 v24, v24
 v_exp_f32 v25, v25
 v_exp_f32 v26, v26
 v_exp_f32 v27, v27
 v_cvt_pk_bf16_f32 v56, v24, v25
 v_cvt_pk_bf16_f32 v57, v26, v27
 v_mfma_f32_32x32x16_bf16 v[40:55], v[140:143], v[20:23], v[40:55]
 s_waitcnt vmcnt(7)
 v_exp_f32 v28, v28
 v_exp_f32 v29, v29
 v_exp_f32 v30, v30
 v_exp_f32 v31, v31
 v_cvt_pk_bf16_f32 v58, v28, v29
 v_cvt_pk_bf16_f32 v59, v30, v31
 v_mfma_f32_32x32x16_bf16 v[88:103], v[144:147], v[64:67], v[88:103]
 buffer_load_dwordx4 v[132:135], v4, s[4:7], s44 offen offset:672
 v_exp_f32 v32, v32
 v_exp_f32 v33, v33
 v_exp_f32 v34, v34
 v_exp_f32 v35, v35
 v_cvt_pk_bf16_f32 v60, v32, v33
 v_cvt_pk_bf16_f32 v61, v34, v35
 v_mfma_f32_32x32x16_bf16 v[88:103], v[148:151], v[68:71], v[88:103]
 v_exp_f32 v36, v36
 v_exp_f32 v37, v37
 v_exp_f32 v38, v38
 v_exp_f32 v39, v39
 v_cvt_pk_bf16_f32 v62, v36, v37
 v_cvt_pk_bf16_f32 v63, v38, v39
 v_mfma_f32_32x32x16_bf16 v[24:39], v[152:155], v[8:11], 0
 buffer_load_dwordx4 v[136:139], v2, s[4:7], s43 offen
 v_exp_f32 v40, v40
 v_exp_f32 v41, v41
 v_exp_f32 v42, v42
 v_exp_f32 v43, v43
 v_cvt_pk_bf16_f32 v64, v40, v41
 v_cvt_pk_bf16_f32 v65, v42, v43
 v_mfma_f32_32x32x16_bf16 v[24:39], v[156:159], v[12:15], v[24:39]
 v_exp_f32 v44, v44
 v_exp_f32 v45, v45
 v_exp_f32 v46, v46
 v_exp_f32 v47, v47
 v_cvt_pk_bf16_f32 v66, v44, v45
 v_cvt_pk_bf16_f32 v67, v46, v47
 v_mfma_f32_32x32x16_bf16 v[72:87], v[160:163], v[56:59], v[72:87]
 buffer_load_dwordx2 v[140:141], v3, s[4:7], s43 offen
 v_exp_f32 v48, v48
 v_exp_f32 v49, v49
 v_exp_f32 v50, v50
 v_exp_f32 v51, v51
 v_cvt_pk_bf16_f32 v68, v48, v49
 v_cvt_pk_bf16_f32 v69, v50, v51
 v_mfma_f32_32x32x16_bf16 v[72:87], v[164:167], v[60:63], v[72:87]
 s_add_u32 s43, s43, 122880
 v_exp_f32 v52, v52
 v_exp_f32 v53, v53
 v_exp_f32 v54, v54
 v_exp_f32 v55, v55
 v_cvt_pk_bf16_f32 v70, v52, v53
 v_cvt_pk_bf16_f32 v71, v54, v55
 v_mfma_f32_32x32x16_bf16 v[40:55], v[152:155], v[16:19], 0
 buffer_load_dwordx4 v[144:147], v4, s[4:7], s44 offen offset:1344
 v_exp_f32 v24, v24
 v_exp_f32 v25, v25
 v_exp_f32 v26, v26
 v_exp_f32 v27, v27
 v_cvt_pk_bf16_f32 v56, v24, v25
 v_cvt_pk_bf16_f32 v57, v26, v27
 v_mfma_f32_32x32x16_bf16 v[40:55], v[156:159], v[20:23], v[40:55]
 s_waitcnt vmcnt(7)
 v_exp_f32 v28, v28
 v_exp_f32 v29, v29
 v_exp_f32 v30, v30
 v_exp_f32 v31, v31
 v_cvt_pk_bf16_f32 v58, v28, v29
 v_cvt_pk_bf16_f32 v59, v30, v31
 v_mfma_f32_32x32x16_bf16 v[88:103], v[160:163], v[64:67], v[88:103]
 buffer_load_dwordx4 v[148:151], v4, s[4:7], s44 offen offset:2016
 v_exp_f32 v32, v32
 v_exp_f32 v33, v33
 v_exp_f32 v34, v34
 v_exp_f32 v35, v35
 v_cvt_pk_bf16_f32 v60, v32, v33
 v_cvt_pk_bf16_f32 v61, v34, v35
 v_mfma_f32_32x32x16_bf16 v[88:103], v[164:167], v[68:71], v[88:103]
 v_exp_f32 v36, v36
 v_exp_f32 v37, v37
 v_exp_f32 v38, v38
 v_exp_f32 v39, v39
 v_cvt_pk_bf16_f32 v62, v36, v37
 v_cvt_pk_bf16_f32 v63, v38, v39
 v_mfma_f32_32x32x16_bf16 v[24:39], v[104:107], v[8:11], 0
 v_exp_f32 v40, v40
 v_exp_f32 v41, v41
 v_exp_f32 v42, v42
 v_exp_f32 v43, v43
 v_cvt_pk_bf16_f32 v64, v40, v41
 v_cvt_pk_bf16_f32 v65, v42, v43
 v_mfma_f32_32x32x16_bf16 v[24:39], v[108:111], v[12:15], v[24:39]
 buffer_load_dwordx4 v[152:155], v2, s[4:7], s43 offen
 v_exp_f32 v44, v44
 v_exp_f32 v45, v45
 v_exp_f32 v46, v46
 v_exp_f32 v47, v47
 v_cvt_pk_bf16_f32 v66, v44, v45
 v_cvt_pk_bf16_f32 v67, v46, v47
 v_mfma_f32_32x32x16_bf16 v[72:87], v[112:115], v[56:59], v[72:87]
 buffer_load_dwordx2 v[156:157], v3, s[4:7], s43 offen
 v_exp_f32 v48, v48
 v_exp_f32 v49, v49
 v_exp_f32 v50, v50
 v_exp_f32 v51, v51
 v_cvt_pk_bf16_f32 v68, v48, v49
 v_cvt_pk_bf16_f32 v69, v50, v51
 v_mfma_f32_32x32x16_bf16 v[72:87], v[116:119], v[60:63], v[72:87]
 s_add_u32 s44, s44, 2688
 v_exp_f32 v52, v52
 v_exp_f32 v53, v53
 v_exp_f32 v54, v54
 v_exp_f32 v55, v55
 v_cvt_pk_bf16_f32 v70, v52, v53
 v_cvt_pk_bf16_f32 v71, v54, v55
 v_mfma_f32_32x32x16_bf16 v[40:55], v[104:107], v[16:19], 0
 buffer_load_dwordx4 v[160:163], v4, s[4:7], s44 offen
 v_exp_f32 v24, v24
 v_exp_f32 v25, v25
 v_exp_f32 v26, v26
 v_exp_f32 v27, v27
 v_cvt_pk_bf16_f32 v56, v24, v25
 v_cvt_pk_bf16_f32 v57, v26, v27
 v_mfma_f32_32x32x16_bf16 v[40:55], v[108:111], v[20:23], v[40:55]
 s_waitcnt vmcnt(7)
 v_exp_f32 v28, v28
 v_exp_f32 v29, v29
 v_exp_f32 v30, v30
 v_exp_f32 v31, v31
 v_cvt_pk_bf16_f32 v58, v28, v29
 v_cvt_pk_bf16_f32 v59, v30, v31
 v_mfma_f32_32x32x16_bf16 v[88:103], v[112:115], v[64:67], v[88:103]
 buffer_load_dwordx4 v[164:167], v4, s[4:7], s44 offen offset:672
 v_exp_f32 v32, v32
 v_exp_f32 v33, v33
 v_exp_f32 v34, v34
 v_exp_f32 v35, v35
 v_cvt_pk_bf16_f32 v60, v32, v33
 v_cvt_pk_bf16_f32 v61, v34, v35
 v_mfma_f32_32x32x16_bf16 v[88:103], v[116:119], v[68:71], v[88:103]
 s_add_u32 s43, s43, 122880
 v_exp_f32 v36, v36
 v_exp_f32 v37, v37
 v_exp_f32 v38, v38
 v_exp_f32 v39, v39
 v_cvt_pk_bf16_f32 v62, v36, v37
 v_cvt_pk_bf16_f32 v63, v38, v39
 v_mfma_f32_32x32x16_bf16 v[24:39], v[120:123], v[8:11], 0
 buffer_load_dwordx4 v[104:107], v2, s[4:7], s43 offen
 v_exp_f32 v40, v40
 v_exp_f32 v41, v41
 v_exp_f32 v42, v42
 v_exp_f32 v43, v43
 v_cvt_pk_bf16_f32 v64, v40, v41
 v_cvt_pk_bf16_f32 v65, v42, v43
 v_mfma_f32_32x32x16_bf16 v[24:39], v[124:127], v[12:15], v[24:39]
 v_exp_f32 v44, v44
 v_exp_f32 v45, v45
 v_exp_f32 v46, v46
 v_exp_f32 v47, v47
 v_cvt_pk_bf16_f32 v66, v44, v45
 v_cvt_pk_bf16_f32 v67, v46, v47
 v_mfma_f32_32x32x16_bf16 v[72:87], v[128:131], v[56:59], v[72:87]
 buffer_load_dwordx2 v[108:109], v3, s[4:7], s43 offen
 v_exp_f32 v48, v48
 v_exp_f32 v49, v49
 v_exp_f32 v50, v50
 v_exp_f32 v51, v51
 v_cvt_pk_bf16_f32 v68, v48, v49
 v_cvt_pk_bf16_f32 v69, v50, v51
 v_mfma_f32_32x32x16_bf16 v[72:87], v[132:135], v[60:63], v[72:87]
 s_add_u32 s43, s43, 122880
 v_exp_f32 v52, v52
 v_exp_f32 v53, v53
 v_exp_f32 v54, v54
 v_exp_f32 v55, v55
 v_cvt_pk_bf16_f32 v70, v52, v53
 v_cvt_pk_bf16_f32 v71, v54, v55
 v_mfma_f32_32x32x16_bf16 v[40:55], v[120:123], v[16:19], 0
 buffer_load_dwordx4 v[112:115], v4, s[4:7], s44 offen offset:1344
 v_exp_f32 v24, v24
 v_exp_f32 v25, v25
 v_exp_f32 v26, v26
 v_exp_f32 v27, v27
 v_cvt_pk_bf16_f32 v56, v24, v25
 v_cvt_pk_bf16_f32 v57, v26, v27
 v_mfma_f32_32x32x16_bf16 v[40:55], v[124:127], v[20:23], v[40:55]
 s_waitcnt vmcnt(7)
 v_exp_f32 v28, v28
 v_exp_f32 v29, v29
 v_exp_f32 v30, v30
 v_exp_f32 v31, v31
 v_cvt_pk_bf16_f32 v58, v28, v29
 v_cvt_pk_bf16_f32 v59, v30, v31
 v_mfma_f32_32x32x16_bf16 v[88:103], v[128:131], v[64:67], v[88:103]
 buffer_load_dwordx4 v[116:119], v4, s[4:7], s44 offen offset:2016
 v_exp_f32 v32, v32
 v_exp_f32 v33, v33
 v_exp_f32 v34, v34
 v_exp_f32 v35, v35
 v_cvt_pk_bf16_f32 v60, v32, v33
 v_cvt_pk_bf16_f32 v61, v34, v35
 v_mfma_f32_32x32x16_bf16 v[88:103], v[132:135], v[68:71], v[88:103]
 v_exp_f32 v36, v36
 v_exp_f32 v37, v37
 v_exp_f32 v38, v38
 v_exp_f32 v39, v39
 v_cvt_pk_bf16_f32 v62, v36, v37
 v_cvt_pk_bf16_f32 v63, v38, v39
 v_mfma_f32_32x32x16_bf16 v[24:39], v[136:139], v[8:11], 0
 buffer_load_dwordx4 v[120:123], v2, s[4:7], s43 offen
 v_exp_f32 v40, v40
 v_exp_f32 v41, v41
 v_exp_f32 v42, v42
 v_exp_f32 v43, v43
 v_cvt_pk_bf16_f32 v64, v40, v41
 v_cvt_pk_bf16_f32 v65, v42, v43
 v_mfma_f32_32x32x16_bf16 v[24:39], v[140:143], v[12:15], v[24:39]
 s_add_u32 s44, s44, 2688
 v_exp_f32 v44, v44
 v_exp_f32 v45, v45
 v_exp_f32 v46, v46
 v_exp_f32 v47, v47
 v_cvt_pk_bf16_f32 v66, v44, v45
 v_cvt_pk_bf16_f32 v67, v46, v47
 v_mfma_f32_32x32x16_bf16 v[72:87], v[144:147], v[56:59], v[72:87]
 buffer_load_dwordx2 v[124:125], v3, s[4:7], s43 offen
 v_exp_f32 v48, v48
 v_exp_f32 v49, v49
 v_exp_f32 v50, v50
 v_exp_f32 v51, v51
 v_cvt_pk_bf16_f32 v68, v48, v49
 v_cvt_pk_bf16_f32 v69, v50, v51
 v_mfma_f32_32x32x16_bf16 v[72:87], v[148:151], v[60:63], v[72:87]
 s_add_u32 s43, s43, 122880
 v_exp_f32 v52, v52
 v_exp_f32 v53, v53
 v_exp_f32 v54, v54
 v_exp_f32 v55, v55
 v_cvt_pk_bf16_f32 v70, v52, v53
 v_cvt_pk_bf16_f32 v71, v54, v55
 v_mfma_f32_32x32x16_bf16 v[40:55], v[136:139], v[16:19], 0
 buffer_load_dwordx4 v[128:131], v4, s[4:7], s44 offen
 v_exp_f32 v24, v24
 v_exp_f32 v25, v25
 v_exp_f32 v26, v26
 v_exp_f32 v27, v27
 v_cvt_pk_bf16_f32 v56, v24, v25
 v_cvt_pk_bf16_f32 v57, v26, v27
 v_mfma_f32_32x32x16_bf16 v[40:55], v[140:143], v[20:23], v[40:55]
 s_waitcnt vmcnt(7)
 v_exp_f32 v28, v28
 v_exp_f32 v29, v29
 v_exp_f32 v30, v30
 v_exp_f32 v31, v31
 v_cvt_pk_bf16_f32 v58, v28, v29
 v_cvt_pk_bf16_f32 v59, v30, v31
 v_mfma_f32_32x32x16_bf16 v[88:103], v[144:147], v[64:67], v[88:103]
 buffer_load_dwordx4 v[132:135], v4, s[4:7], s44 offen offset:672
 v_exp_f32 v32, v32
 v_exp_f32 v33, v33
 v_exp_f32 v34, v34
 v_exp_f32 v35, v35
 v_cvt_pk_bf16_f32 v60, v32, v33
 v_cvt_pk_bf16_f32 v61, v34, v35
 v_mfma_f32_32x32x16_bf16 v[88:103], v[148:151], v[68:71], v[88:103]
 v_exp_f32 v36, v36
 v_exp_f32 v37, v37
 v_exp_f32 v38, v38
 v_exp_f32 v39, v39
 v_cvt_pk_bf16_f32 v62, v36, v37
 v_cvt_pk_bf16_f32 v63, v38, v39
 v_mfma_f32_32x32x16_bf16 v[24:39], v[152:155], v[8:11], 0
 buffer_load_dwordx4 v[136:139], v2, s[4:7], s43 offen
 v_exp_f32 v40, v40
 v_exp_f32 v41, v41
 v_exp_f32 v42, v42
 v_exp_f32 v43, v43
 v_cvt_pk_bf16_f32 v64, v40, v41
 v_cvt_pk_bf16_f32 v65, v42, v43
 v_mfma_f32_32x32x16_bf16 v[24:39], v[156:159], v[12:15], v[24:39]
 v_exp_f32 v44, v44
 v_exp_f32 v45, v45
 v_exp_f32 v46, v46
 v_exp_f32 v47, v47
 v_cvt_pk_bf16_f32 v66, v44, v45
 v_cvt_pk_bf16_f32 v67, v46, v47
 v_mfma_f32_32x32x16_bf16 v[72:87], v[160:163], v[56:59], v[72:87]
 buffer_load_dwordx2 v[140:141], v3, s[4:7], s43 offen
 v_exp_f32 v48, v48
 v_exp_f32 v49, v49
 v_exp_f32 v50, v50
 v_exp_f32 v51, v51
 v_cvt_pk_bf16_f32 v68, v48, v49
 v_cvt_pk_bf16_f32 v69, v50, v51
 v_mfma_f32_32x32x16_bf16 v[72:87], v[164:167], v[60:63], v[72:87]
 s_add_u32 s43, s43, 122880
 v_exp_f32 v52, v52
 v_exp_f32 v53, v53
 v_exp_f32 v54, v54
 v_exp_f32 v55, v55
 v_cvt_pk_bf16_f32 v70, v52, v53
 v_cvt_pk_bf16_f32 v71, v54, v55
 v_mfma_f32_32x32x16_bf16 v[40:55], v[152:155], v[16:19], 0
 buffer_load_dwordx4 v[144:147], v4, s[4:7], s44 offen offset:1344
 v_exp_f32 v24, v24
 v_exp_f32 v25, v25
 v_exp_f32 v26, v26
 v_exp_f32 v27, v27
 v_cvt_pk_bf16_f32 v56, v24, v25
 v_cvt_pk_bf16_f32 v57, v26, v27
 v_mfma_f32_32x32x16_bf16 v[40:55], v[156:159], v[20:23], v[40:55]
 s_waitcnt vmcnt(7)
 v_exp_f32 v28, v28
 v_exp_f32 v29, v29
 v_exp_f32 v30, v30
 v_exp_f32 v31, v31
 v_cvt_pk_bf16_f32 v58, v28, v29
 v_cvt_pk_bf16_f32 v59, v30, v31
 v_mfma_f32_32x32x16_bf16 v[88:103], v[160:163], v[64:67], v[88:103]
 buffer_load_dwordx4 v[148:151], v4, s[4:7], s44 offen offset:2016
 v_exp_f32 v32, v32
 v_exp_f32 v33, v33
 v_exp_f32 v34, v34
 v_exp_f32 v35, v35
 v_cvt_pk_bf16_f32 v60, v32, v33
 v_cvt_pk_bf16_f32 v61, v34, v35
 v_mfma_f32_32x32x16_bf16 v[88:103], v[164:167], v[68:71], v[88:103]
 s_sub_u32 s48, s48, 1
 v_exp_f32 v36, v36
 v_exp_f32 v37, v37
 v_exp_f32 v38, v38
 v_exp_f32 v39, v39
 v_cvt_pk_bf16_f32 v62, v36, v37
 v_cvt_pk_bf16_f32 v63, v38, v39
 v_mfma_f32_32x32x16_bf16 v[24:39], v[104:107], v[8:11], 0
 s_cbranch_scc0 C1_ATT_loop
 s_nop 7
 s_nop 3
 s_mov_b32 s45, 0x53800000
 v_mov_b32 v5, s45
 v_cmp_nlt_f32 s[46:47], v84, v5
 v_cmp_nlt_f32 vcc, v100, v5
 s_nop 3
 s_or_b64 vcc, vcc, s[46:47]
 s_cbranch_vccz C1_ATT_fin
 s_cmp_lg_u32 s49, 0
 s_cbranch_scc1 C1_ATT_fin
 s_mov_b32 s49, 1
 s_waitcnt vmcnt(0)
 s_mov_b32 exec_hi, 0
 v_mov_b32 v14, 0
 v_mov_b32 v22, 0
 s_mov_b32 exec_hi, -1
 v_mov_b32 v6, 0xff61b1e6
 v_mov_b32 v7, 0xff61b1e6
 s_mov_b32 s43, 18313216
 s_mov_b32 s48, 64
C1_ATT_fb:
 buffer_load_dwordx4 v[152:155], v2, s[4:7], s43 offen
 buffer_load_dwordx2 v[156:157], v3, s[4:7], s43 offen
 s_add_u32 s43, s43, 122880
 s_waitcnt vmcnt(0)
 v_mfma_f32_32x32x16_bf16 v[24:39], v[152:155], v[8:11], 0
 v_mfma_f32_32x32x16_bf16 v[24:39], v[156:159], v[12:15], v[24:39]
 v_mfma_f32_32x32x16_bf16 v[40:55], v[152:155], v[16:19], 0
 v_mfma_f32_32x32x16_bf16 v[40:55], v[156:159], v[20:23], v[40:55]
 s_nop 7
 s_nop 1
 v_max3_f32 v6, v6, v24, v25
 v_max3_f32 v6, v6, v26, v27
 v_max3_f32 v6, v6, v28, v29
 v_max3_f32 v6, v6, v30, v31
 v_max3_f32 v6, v6, v32, v33
 v_max3_f32 v6, v6, v34, v35
 v_max3_f32 v6, v6, v36, v37
 v_max3_f32 v6, v6, v38, v39
 v_max3_f32 v7, v7, v40, v41
 v_max3_f32 v7, v7, v42, v43
 v_max3_f32 v7, v7, v44, v45
 v_max3_f32 v7, v7, v46, v47
 v_max3_f32 v7, v7, v48, v49
 v_max3_f32 v7, v7, v50, v51
 v_max3_f32 v7, v7, v52, v53
 v_max3_f32 v7, v7, v54, v55
 s_sub_u32 s48, s48, 1
 s_cmp_lg_u32 s48, 0
 s_cbranch_scc1 C1_ATT_fb
 v_mov_b32 v5, v6
 s_nop 1
 v_permlane32_swap_b32 v6, v5
 v_max_f32 v6, v6, v5
 v_sub_f32 v6, 0, v6
 v_cvt_pk_bf16_f32 v6, v6, 0
 v_and_b32 v6, 0xffff, v6
 s_mov_b32 exec_hi, 0
 v_mov_b32 v14, v6
 s_mov_b32 exec_hi, -1
 v_mov_b32 v5, v7
 s_nop 1
 v_permlane32_swap_b32 v7, v5
 v_max_f32 v7, v7, v5
 v_sub_f32 v7, 0, v7
 v_cvt_pk_bf16_f32 v7, v7, 0
 v_and_b32 v7, 0xffff, v7
 s_mov_b32 exec_hi, 0
 v_mov_b32 v22, v7
 s_mov_b32 exec_hi, -1
 s_branch C1_ATT_start
C1_ATT_fin:
 s_barrier
 v_mov_b32 v5, 162816
 ds_read_b32 v5, v5
 v_rcp_f32 v6, v84
 v_rcp_f32 v7, v100
 v_mul_f32 v72, v72, v6
 v_mul_f32 v73, v73, v6
 v_mul_f32 v74, v74, v6
 v_mul_f32 v75, v75, v6
 v_mul_f32 v76, v76, v6
 v_mul_f32 v77, v77, v6
 v_mul_f32 v78, v78, v6
 v_mul_f32 v79, v79, v6
 v_mul_f32 v80, v80, v6
 v_mul_f32 v81, v81, v6
 v_mul_f32 v82, v82, v6
 v_mul_f32 v83, v83, v6
 v_mul_f32 v88, v88, v7
 v_mul_f32 v89, v89, v7
 v_mul_f32 v90, v90, v7
 v_mul_f32 v91, v91, v7
 v_mul_f32 v92, v92, v7
 v_mul_f32 v93, v93, v7
 v_mul_f32 v94, v94, v7
 v_mul_f32 v95, v95, v7
 v_mul_f32 v96, v96, v7
 v_mul_f32 v97, v97, v7
 v_mul_f32 v98, v98, v7
 v_mul_f32 v99, v99, v7
 v_cvt_pk_bf16_f32 v24, v72, v73
 v_cvt_pk_bf16_f32 v25, v74, v75
 v_cvt_pk_bf16_f32 v26, v76, v77
 v_cvt_pk_bf16_f32 v27, v78, v79
 v_cvt_pk_bf16_f32 v28, v80, v81
 v_cvt_pk_bf16_f32 v29, v82, v83
 v_cvt_pk_bf16_f32 v32, v88, v89
 v_cvt_pk_bf16_f32 v33, v90, v91
 v_cvt_pk_bf16_f32 v34, v92, v93
 v_cvt_pk_bf16_f32 v35, v94, v95
 v_cvt_pk_bf16_f32 v36, v96, v97
 v_cvt_pk_bf16_f32 v37, v98, v99
 v_permlane32_swap_b32 v24, v26
 v_permlane32_swap_b32 v25, v27
 v_permlane32_swap_b32 v32, v34
 v_permlane32_swap_b32 v33, v35
 s_waitcnt lgkmcnt(0)
 v_readfirstlane_b32 s33, v5
 s_lshl_b32 s45, s42, 7
 s_lshl_b32 s46, s41, 2
 s_add_u32 s45, s45, s46
 s_add_u32 s47, s45, 0x6f0000
 s_add_u32 s45, s45, 0x6ee000
 s_cmp_eq_u32 s33, 0
 s_cbranch_scc1 C1_oe_slow
 buffer_store_dwordx4 v[24:27], v168, s[4:7], s52 offen
 buffer_store_dwordx4 v[32:35], v168, s[4:7], s53 offen
 s_mov_b32 exec_hi, 0
 buffer_store_dwordx2 v[28:29], v169, s[4:7], s52 offen
 buffer_store_dwordx2 v[36:37], v169, s[4:7], s53 offen
 s_mov_b64 exec, 1
 v_mov_b32 v8, 0
 v_mov_b32 v9, 1
 s_waitcnt vmcnt(0)
 buffer_store_dword v9, v8, s[4:7], s45 offen
 buffer_store_dword v9, v8, s[4:7], s47 offen sc1
 s_mov_b64 exec, -1
C1_oe_join:
 v_lshrrev_b32 v8, 4, v1
 v_and_b32 v9, 1, v8
 v_lshrrev_b32 v8, 1, v8
 v_and_b32 v7, 15, v1
 v_lshlrev_b32 v7, 4, v7
 v_lshlrev_b32 v6, 8, v8
 v_add_u32 v6, v6, v7
 v_lshlrev_b32 v5, 9, v9
 v_add_u32 v5, v5, v6
 v_lshlrev_b32 v9, 3, v9
 v_add_u32 v6, v6, v9
 v_lshlrev_b32 v3, 4, v1
 s_lshl_b32 s23, s20, 11
 v_add_u32 v2, s23, v3
 v_add_u32 v3, 49152, v3
 v_add_u32 v4, 0x10000, v3
 s_lshl_b32 s30, s21, 2
 s_add_u32 s30, s30, s20
 s_mul_i32 s30, s30, 20480
 s_mul_i32 s23, s22, 2560
 s_add_u32 s30, s30, s23
 v_and_b32 v8, 15, v1
 v_mul_u32_u24 v8, 1280, v8
 v_lshrrev_b32 v9, 4, v1
 v_lshl_add_u32 v8, v9, 3, v8
 s_lshl_b32 s24, s21, 2
 s_add_u32 s24, s24, s20
 s_mul_i32 s24, s24, 20480
 s_mul_i32 s23, s22, 160
 s_add_u32 s24, s24, s23
 buffer_load_dwordx2 v[10:11], v8, s[16:19], s24 offen offset:0
 buffer_load_dwordx2 v[12:13], v8, s[16:19], s24 offen offset:32
 buffer_load_dwordx2 v[14:15], v8, s[16:19], s24 offen offset:64
 buffer_load_dwordx2 v[16:17], v8, s[16:19], s24 offen offset:96
 buffer_load_dwordx2 v[18:19], v8, s[16:19], s24 offen offset:128
 s_waitcnt vmcnt(0)
 v_lshlrev_b32 v20, 16, v10
 v_and_b32 v21, 0xffff0000, v10
 v_lshlrev_b32 v22, 16, v11
 v_and_b32 v23, 0xffff0000, v11
 v_lshlrev_b32 v24, 16, v12
 v_and_b32 v25, 0xffff0000, v12
 v_lshlrev_b32 v26, 16, v13
 v_and_b32 v27, 0xffff0000, v13
 v_lshlrev_b32 v28, 16, v14
 v_and_b32 v29, 0xffff0000, v14
 v_lshlrev_b32 v30, 16, v15
 v_and_b32 v31, 0xffff0000, v15
 v_lshlrev_b32 v32, 16, v16
 v_and_b32 v33, 0xffff0000, v16
 v_lshlrev_b32 v34, 16, v17
 v_and_b32 v35, 0xffff0000, v17
 v_lshlrev_b32 v36, 16, v18
 v_and_b32 v37, 0xffff0000, v18
 v_lshlrev_b32 v38, 16, v19
 v_and_b32 v39, 0xffff0000, v19
 s_lshl_b32 s26, s21, 2
 s_add_u32 s26, s26, s20
 s_lshl_b32 s26, s26, 10
 s_lshr_b32 s23, s22, 1
 s_lshl_b32 s23, s23, 8
 s_add_u32 s26, s26, s23
 s_and_b32 s23, s22, 1
 s_lshl_b32 s23, s23, 3
 s_add_u32 s26, s26, s23
 s_add_u32 s26, s26, 0x1112000
 v_and_b32 v70, 15, v1
 v_lshlrev_b32 v70, 4, v70
 s_barrier
 ds_read_b128 v[104:107], v2 offset:0
 ds_read_b128 v[84:87], v3 offset:0
 ds_read_b128 v[88:91], v3 offset:1024
 ds_read_b128 v[92:95], v3 offset:2048
 ds_read_b128 v[96:99], v3 offset:3072
 ds_read_b128 v[100:103], v3 offset:4096
 ds_read_b128 v[128:131], v2 offset:1024
 ds_read_b128 v[108:111], v3 offset:5120
 ds_read_b128 v[112:115], v3 offset:6144
 ds_read_b128 v[116:119], v3 offset:7168
 ds_read_b128 v[120:123], v3 offset:8192
 ds_read_b128 v[124:127], v3 offset:9216
 s_waitcnt lgkmcnt(6)
 v_mfma_f32_16x16x32_bf16 v[20:23], v[84:87], v[104:107], v[20:23]
 s_barrier
 ds_read_b128 v[152:155], v2 offset:8192
 ds_read_b128 v[132:135], v3 offset:10240
 v_mfma_f32_16x16x32_bf16 v[24:27], v[88:91], v[104:107], v[24:27]
 ds_read_b128 v[136:139], v3 offset:11264
 v_mfma_f32_16x16x32_bf16 v[28:31], v[92:95], v[104:107], v[28:31]
 ds_read_b128 v[140:143], v3 offset:12288
 v_mfma_f32_16x16x32_bf16 v[32:35], v[96:99], v[104:107], v[32:35]
 ds_read_b128 v[144:147], v3 offset:13312
 v_mfma_f32_16x16x32_bf16 v[36:39], v[100:103], v[104:107], v[36:39]
 ds_read_b128 v[148:151], v3 offset:14336
 s_waitcnt lgkmcnt(6)
 v_mfma_f32_16x16x32_bf16 v[20:23], v[108:111], v[128:131], v[20:23]
 ds_read_b128 v[176:179], v2 offset:9216
 ds_read_b128 v[156:159], v3 offset:15360
 v_mfma_f32_16x16x32_bf16 v[24:27], v[112:115], v[128:131], v[24:27]
 ds_read_b128 v[160:163], v3 offset:16384
 v_mfma_f32_16x16x32_bf16 v[28:31], v[116:119], v[128:131], v[28:31]
 ds_read_b128 v[164:167], v3 offset:17408
 v_mfma_f32_16x16x32_bf16 v[32:35], v[120:123], v[128:131], v[32:35]
 ds_read_b128 v[168:171], v3 offset:18432
 v_mfma_f32_16x16x32_bf16 v[36:39], v[124:127], v[128:131], v[36:39]
 ds_read_b128 v[172:175], v3 offset:19456
 s_waitcnt lgkmcnt(6)
 v_mfma_f32_16x16x32_bf16 v[20:23], v[132:135], v[152:155], v[20:23]
 s_barrier
 ds_read_b128 v[104:107], v2 offset:16384
 ds_read_b128 v[84:87], v3 offset:20480
 v_mfma_f32_16x16x32_bf16 v[24:27], v[136:139], v[152:155], v[24:27]
 ds_read_b128 v[88:91], v3 offset:21504
 v_mfma_f32_16x16x32_bf16 v[28:31], v[140:143], v[152:155], v[28:31]
 ds_read_b128 v[92:95], v3 offset:22528
 v_mfma_f32_16x16x32_bf16 v[32:35], v[144:147], v[152:155], v[32:35]
 ds_read_b128 v[96:99], v3 offset:23552
 v_mfma_f32_16x16x32_bf16 v[36:39], v[148:151], v[152:155], v[36:39]
 ds_read_b128 v[100:103], v3 offset:24576
 s_waitcnt lgkmcnt(6)
 v_mfma_f32_16x16x32_bf16 v[20:23], v[156:159], v[176:179], v[20:23]
 ds_read_b128 v[128:131], v2 offset:17408
 ds_read_b128 v[108:111], v3 offset:25600
 v_mfma_f32_16x16x32_bf16 v[24:27], v[160:163], v[176:179], v[24:27]
 ds_read_b128 v[112:115], v3 offset:26624
 v_mfma_f32_16x16x32_bf16 v[28:31], v[164:167], v[176:179], v[28:31]
 ds_read_b128 v[116:119], v3 offset:27648
 v_mfma_f32_16x16x32_bf16 v[32:35], v[168:171], v[176:179], v[32:35]
 ds_read_b128 v[120:123], v3 offset:28672
 v_mfma_f32_16x16x32_bf16 v[36:39], v[172:175], v[176:179], v[36:39]
 ds_read_b128 v[124:127], v3 offset:29696
 s_waitcnt lgkmcnt(6)
 v_mfma_f32_16x16x32_bf16 v[20:23], v[84:87], v[104:107], v[20:23]
 s_barrier
 ds_read_b128 v[152:155], v2 offset:24576
 ds_read_b128 v[132:135], v3 offset:30720
 v_mfma_f32_16x16x32_bf16 v[24:27], v[88:91], v[104:107], v[24:27]
 ds_read_b128 v[136:139], v3 offset:31744
 v_mfma_f32_16x16x32_bf16 v[28:31], v[92:95], v[104:107], v[28:31]
 ds_read_b128 v[140:143], v3 offset:32768
 v_mfma_f32_16x16x32_bf16 v[32:35], v[96:99], v[104:107], v[32:35]
 ds_read_b128 v[144:147], v3 offset:33792
 v_mfma_f32_16x16x32_bf16 v[36:39], v[100:103], v[104:107], v[36:39]
 ds_read_b128 v[148:151], v3 offset:34816
 s_waitcnt lgkmcnt(6)
 v_mfma_f32_16x16x32_bf16 v[20:23], v[108:111], v[128:131], v[20:23]
 ds_read_b128 v[176:179], v2 offset:25600
 ds_read_b128 v[156:159], v3 offset:35840
 v_mfma_f32_16x16x32_bf16 v[24:27], v[112:115], v[128:131], v[24:27]
 ds_read_b128 v[160:163], v3 offset:36864
 v_mfma_f32_16x16x32_bf16 v[28:31], v[116:119], v[128:131], v[28:31]
 ds_read_b128 v[164:167], v3 offset:37888
 v_mfma_f32_16x16x32_bf16 v[32:35], v[120:123], v[128:131], v[32:35]
 ds_read_b128 v[168:171], v3 offset:38912
 v_mfma_f32_16x16x32_bf16 v[36:39], v[124:127], v[128:131], v[36:39]
 ds_read_b128 v[172:175], v3 offset:39936
 s_waitcnt lgkmcnt(6)
 v_mfma_f32_16x16x32_bf16 v[20:23], v[132:135], v[152:155], v[20:23]
 s_barrier
 ds_read_b128 v[104:107], v2 offset:32768
 ds_read_b128 v[84:87], v3 offset:40960
 v_mfma_f32_16x16x32_bf16 v[24:27], v[136:139], v[152:155], v[24:27]
 ds_read_b128 v[88:91], v3 offset:41984
 v_mfma_f32_16x16x32_bf16 v[28:31], v[140:143], v[152:155], v[28:31]
 ds_read_b128 v[92:95], v3 offset:43008
 v_mfma_f32_16x16x32_bf16 v[32:35], v[144:147], v[152:155], v[32:35]
 ds_read_b128 v[96:99], v3 offset:44032
 v_mfma_f32_16x16x32_bf16 v[36:39], v[148:151], v[152:155], v[36:39]
 ds_read_b128 v[100:103], v3 offset:45056
 s_waitcnt lgkmcnt(6)
 v_mfma_f32_16x16x32_bf16 v[20:23], v[156:159], v[176:179], v[20:23]
 ds_read_b128 v[128:131], v2 offset:33792
 ds_read_b128 v[108:111], v3 offset:46080
 v_mfma_f32_16x16x32_bf16 v[24:27], v[160:163], v[176:179], v[24:27]
 ds_read_b128 v[112:115], v3 offset:47104
 v_mfma_f32_16x16x32_bf16 v[28:31], v[164:167], v[176:179], v[28:31]
 ds_read_b128 v[116:119], v3 offset:48128
 v_mfma_f32_16x16x32_bf16 v[32:35], v[168:171], v[176:179], v[32:35]
 ds_read_b128 v[120:123], v3 offset:49152
 v_mfma_f32_16x16x32_bf16 v[36:39], v[172:175], v[176:179], v[36:39]
 ds_read_b128 v[124:127], v3 offset:50176
 s_waitcnt lgkmcnt(6)
 v_mfma_f32_16x16x32_bf16 v[20:23], v[84:87], v[104:107], v[20:23]
 s_barrier
 ds_read_b128 v[152:155], v2 offset:40960
 ds_read_b128 v[132:135], v3 offset:51200
 v_mfma_f32_16x16x32_bf16 v[24:27], v[88:91], v[104:107], v[24:27]
 ds_read_b128 v[136:139], v3 offset:52224
 v_mfma_f32_16x16x32_bf16 v[28:31], v[92:95], v[104:107], v[28:31]
 ds_read_b128 v[140:143], v3 offset:53248
 v_mfma_f32_16x16x32_bf16 v[32:35], v[96:99], v[104:107], v[32:35]
 ds_read_b128 v[144:147], v3 offset:54272
 v_mfma_f32_16x16x32_bf16 v[36:39], v[100:103], v[104:107], v[36:39]
 ds_read_b128 v[148:151], v3 offset:55296
 s_waitcnt lgkmcnt(6)
 v_mfma_f32_16x16x32_bf16 v[20:23], v[108:111], v[128:131], v[20:23]
 ds_read_b128 v[176:179], v2 offset:41984
 ds_read_b128 v[156:159], v3 offset:56320
 v_mfma_f32_16x16x32_bf16 v[24:27], v[112:115], v[128:131], v[24:27]
 ds_read_b128 v[160:163], v3 offset:57344
 v_mfma_f32_16x16x32_bf16 v[28:31], v[116:119], v[128:131], v[28:31]
 ds_read_b128 v[164:167], v3 offset:58368
 v_mfma_f32_16x16x32_bf16 v[32:35], v[120:123], v[128:131], v[32:35]
 ds_read_b128 v[168:171], v3 offset:59392
 v_mfma_f32_16x16x32_bf16 v[36:39], v[124:127], v[128:131], v[36:39]
 ds_read_b128 v[172:175], v3 offset:60416
 s_waitcnt lgkmcnt(6)
 v_mfma_f32_16x16x32_bf16 v[20:23], v[132:135], v[152:155], v[20:23]
 s_barrier
 ds_read_b128 v[104:107], v2 offset:0
 ds_read_b128 v[84:87], v3 offset:61440
 v_mfma_f32_16x16x32_bf16 v[24:27], v[136:139], v[152:155], v[24:27]
 ds_read_b128 v[88:91], v3 offset:62464
 v_mfma_f32_16x16x32_bf16 v[28:31], v[140:143], v[152:155], v[28:31]
 ds_read_b128 v[92:95], v3 offset:63488
 v_mfma_f32_16x16x32_bf16 v[32:35], v[144:147], v[152:155], v[32:35]
 ds_read_b128 v[96:99], v3 offset:64512
 v_mfma_f32_16x16x32_bf16 v[36:39], v[148:151], v[152:155], v[36:39]
 ds_read_b128 v[100:103], v4 offset:0
 s_waitcnt lgkmcnt(6)
 v_mfma_f32_16x16x32_bf16 v[20:23], v[156:159], v[176:179], v[20:23]
 ds_read_b128 v[128:131], v2 offset:1024
 ds_read_b128 v[108:111], v4 offset:1024
 v_mfma_f32_16x16x32_bf16 v[24:27], v[160:163], v[176:179], v[24:27]
 ds_read_b128 v[112:115], v4 offset:2048
 v_mfma_f32_16x16x32_bf16 v[28:31], v[164:167], v[176:179], v[28:31]
 ds_read_b128 v[116:119], v4 offset:3072
 v_mfma_f32_16x16x32_bf16 v[32:35], v[168:171], v[176:179], v[32:35]
 ds_read_b128 v[120:123], v4 offset:4096
 v_mfma_f32_16x16x32_bf16 v[36:39], v[172:175], v[176:179], v[36:39]
 ds_read_b128 v[124:127], v4 offset:5120
 s_waitcnt lgkmcnt(6)
 v_mfma_f32_16x16x32_bf16 v[20:23], v[84:87], v[104:107], v[20:23]
 s_barrier
 ds_read_b128 v[152:155], v2 offset:8192
 ds_read_b128 v[132:135], v4 offset:6144
 v_mfma_f32_16x16x32_bf16 v[24:27], v[88:91], v[104:107], v[24:27]
 ds_read_b128 v[136:139], v4 offset:7168
 v_mfma_f32_16x16x32_bf16 v[28:31], v[92:95], v[104:107], v[28:31]
 ds_read_b128 v[140:143], v4 offset:8192
 v_mfma_f32_16x16x32_bf16 v[32:35], v[96:99], v[104:107], v[32:35]
 ds_read_b128 v[144:147], v4 offset:9216
 v_mfma_f32_16x16x32_bf16 v[36:39], v[100:103], v[104:107], v[36:39]
 ds_read_b128 v[148:151], v4 offset:10240
 s_waitcnt lgkmcnt(6)
 v_mfma_f32_16x16x32_bf16 v[20:23], v[108:111], v[128:131], v[20:23]
 ds_read_b128 v[176:179], v2 offset:9216
 ds_read_b128 v[156:159], v4 offset:11264
 v_mfma_f32_16x16x32_bf16 v[24:27], v[112:115], v[128:131], v[24:27]
 ds_read_b128 v[160:163], v4 offset:12288
 v_mfma_f32_16x16x32_bf16 v[28:31], v[116:119], v[128:131], v[28:31]
 ds_read_b128 v[164:167], v4 offset:13312
 v_mfma_f32_16x16x32_bf16 v[32:35], v[120:123], v[128:131], v[32:35]
 ds_read_b128 v[168:171], v4 offset:14336
 v_mfma_f32_16x16x32_bf16 v[36:39], v[124:127], v[128:131], v[36:39]
 ds_read_b128 v[172:175], v4 offset:15360
 s_waitcnt lgkmcnt(6)
 v_mfma_f32_16x16x32_bf16 v[20:23], v[132:135], v[152:155], v[20:23]
 s_barrier
 ds_read_b128 v[104:107], v2 offset:16384
 ds_read_b128 v[84:87], v4 offset:16384
 v_mfma_f32_16x16x32_bf16 v[24:27], v[136:139], v[152:155], v[24:27]
 ds_read_b128 v[88:91], v4 offset:17408
 v_mfma_f32_16x16x32_bf16 v[28:31], v[140:143], v[152:155], v[28:31]
 ds_read_b128 v[92:95], v4 offset:18432
 v_mfma_f32_16x16x32_bf16 v[32:35], v[144:147], v[152:155], v[32:35]
 ds_read_b128 v[96:99], v4 offset:19456
 v_mfma_f32_16x16x32_bf16 v[36:39], v[148:151], v[152:155], v[36:39]
 ds_read_b128 v[100:103], v4 offset:20480
 s_waitcnt lgkmcnt(6)
 v_mfma_f32_16x16x32_bf16 v[20:23], v[156:159], v[176:179], v[20:23]
 ds_read_b128 v[128:131], v2 offset:17408
 ds_read_b128 v[108:111], v4 offset:21504
 v_mfma_f32_16x16x32_bf16 v[24:27], v[160:163], v[176:179], v[24:27]
 ds_read_b128 v[112:115], v4 offset:22528
 v_mfma_f32_16x16x32_bf16 v[28:31], v[164:167], v[176:179], v[28:31]
 ds_read_b128 v[116:119], v4 offset:23552
 v_mfma_f32_16x16x32_bf16 v[32:35], v[168:171], v[176:179], v[32:35]
 ds_read_b128 v[120:123], v4 offset:24576
 v_mfma_f32_16x16x32_bf16 v[36:39], v[172:175], v[176:179], v[36:39]
 ds_read_b128 v[124:127], v4 offset:25600
 s_waitcnt lgkmcnt(6)
 v_mfma_f32_16x16x32_bf16 v[20:23], v[84:87], v[104:107], v[20:23]
 s_barrier
 ds_read_b128 v[152:155], v2 offset:24576
 ds_read_b128 v[132:135], v4 offset:26624
 v_mfma_f32_16x16x32_bf16 v[24:27], v[88:91], v[104:107], v[24:27]
 ds_read_b128 v[136:139], v4 offset:27648
 v_mfma_f32_16x16x32_bf16 v[28:31], v[92:95], v[104:107], v[28:31]
 ds_read_b128 v[140:143], v4 offset:28672
 v_mfma_f32_16x16x32_bf16 v[32:35], v[96:99], v[104:107], v[32:35]
 ds_read_b128 v[144:147], v4 offset:29696
 v_mfma_f32_16x16x32_bf16 v[36:39], v[100:103], v[104:107], v[36:39]
 ds_read_b128 v[148:151], v4 offset:30720
 s_waitcnt lgkmcnt(6)
 v_mfma_f32_16x16x32_bf16 v[20:23], v[108:111], v[128:131], v[20:23]
 ds_read_b128 v[176:179], v2 offset:25600
 ds_read_b128 v[156:159], v4 offset:31744
 v_mfma_f32_16x16x32_bf16 v[24:27], v[112:115], v[128:131], v[24:27]
 ds_read_b128 v[160:163], v4 offset:32768
 v_mfma_f32_16x16x32_bf16 v[28:31], v[116:119], v[128:131], v[28:31]
 ds_read_b128 v[164:167], v4 offset:33792
 v_mfma_f32_16x16x32_bf16 v[32:35], v[120:123], v[128:131], v[32:35]
 ds_read_b128 v[168:171], v4 offset:34816
 v_mfma_f32_16x16x32_bf16 v[36:39], v[124:127], v[128:131], v[36:39]
 ds_read_b128 v[172:175], v4 offset:35840
 s_waitcnt lgkmcnt(6)
 v_mfma_f32_16x16x32_bf16 v[20:23], v[132:135], v[152:155], v[20:23]
 s_barrier
 v_mfma_f32_16x16x32_bf16 v[24:27], v[136:139], v[152:155], v[24:27]
 v_mfma_f32_16x16x32_bf16 v[28:31], v[140:143], v[152:155], v[28:31]
 v_mfma_f32_16x16x32_bf16 v[32:35], v[144:147], v[152:155], v[32:35]
 v_mfma_f32_16x16x32_bf16 v[36:39], v[148:151], v[152:155], v[36:39]
 s_waitcnt lgkmcnt(0)
 v_mfma_f32_16x16x32_bf16 v[20:23], v[156:159], v[176:179], v[20:23]
 v_mfma_f32_16x16x32_bf16 v[24:27], v[160:163], v[176:179], v[24:27]
 v_mfma_f32_16x16x32_bf16 v[28:31], v[164:167], v[176:179], v[28:31]
 v_mfma_f32_16x16x32_bf16 v[32:35], v[168:171], v[176:179], v[32:35]
 v_mfma_f32_16x16x32_bf16 v[36:39], v[172:175], v[176:179], v[36:39]
 s_nop 3
 v_cvt_pk_bf16_f32 v10, v20, v21
 v_cvt_pk_bf16_f32 v11, v22, v23
 v_cvt_pk_bf16_f32 v12, v24, v25
 v_cvt_pk_bf16_f32 v13, v26, v27
 v_cvt_pk_bf16_f32 v14, v28, v29
 v_cvt_pk_bf16_f32 v15, v30, v31
 v_cvt_pk_bf16_f32 v16, v32, v33
 v_cvt_pk_bf16_f32 v17, v34, v35
 v_cvt_pk_bf16_f32 v18, v36, v37
 v_cvt_pk_bf16_f32 v19, v38, v39
 v_permlane16_swap_b32 v10, v12
 v_permlane16_swap_b32 v11, v13
 v_permlane16_swap_b32 v14, v16
 v_permlane16_swap_b32 v15, v17
 s_cmp_eq_u32 s33, 0
 s_cbranch_scc1 C1_e0_slow
 s_add_u32 s24, s30, 0xbf2000
 buffer_store_dwordx4 v[10:13], v5, s[4:7], s24 offen offset:0
 buffer_store_dwordx4 v[14:17], v5, s[4:7], s24 offen offset:1024
 buffer_store_dwordx2 v[18:19], v6, s[4:7], s24 offen offset:2048
 v_pk_add_f32 v[204:205], v[20:21], v[22:23]
 v_pk_mul_f32 v[206:207], v[20:21], v[20:21]
 v_pk_fma_f32 v[206:207], v[22:23], v[22:23], v[206:207]
 v_pk_add_f32 v[208:209], v[24:25], v[26:27]
 v_pk_mul_f32 v[210:211], v[24:25], v[24:25]
 v_pk_fma_f32 v[210:211], v[26:27], v[26:27], v[210:211]
 v_pk_add_f32 v[204:205], v[204:205], v[28:29]
 v_pk_fma_f32 v[206:207], v[28:29], v[28:29], v[206:207]
 v_pk_add_f32 v[208:209], v[208:209], v[30:31]
 v_pk_fma_f32 v[210:211], v[30:31], v[30:31], v[210:211]
 v_pk_add_f32 v[204:205], v[204:205], v[32:33]
 v_pk_fma_f32 v[206:207], v[32:33], v[32:33], v[206:207]
 v_pk_add_f32 v[208:209], v[208:209], v[34:35]
 v_pk_fma_f32 v[210:211], v[34:35], v[34:35], v[210:211]
 v_pk_add_f32 v[204:205], v[204:205], v[36:37]
 v_pk_fma_f32 v[206:207], v[36:37], v[36:37], v[206:207]
 v_pk_add_f32 v[208:209], v[208:209], v[38:39]
 v_pk_fma_f32 v[210:211], v[38:39], v[38:39], v[210:211]
 v_pk_add_f32 v[204:205], v[204:205], v[208:209]
 v_pk_add_f32 v[206:207], v[206:207], v[210:211]
 v_add_f32 v212, v204, v205
 v_add_f32 v213, v206, v207
 v_mov_b32 v214, v212
 v_mov_b32 v215, v213
 s_nop 0
 v_permlane16_swap_b32 v212, v214
 v_permlane16_swap_b32 v213, v215
 v_add_f32 v212, v212, v214
 v_add_f32 v213, v213, v215
 v_mov_b32 v214, v212
 v_mov_b32 v215, v213
 s_nop 0
 v_permlane32_swap_b32 v212, v214
 v_permlane32_swap_b32 v213, v215
 v_add_f32 v212, v212, v214
 v_add_f32 v213, v213, v215
 s_mov_b64 exec, 0xffff
 buffer_store_dwordx2 v[212:213], v70, s[4:7], s26 offen
 s_mov_b64 exec, -1
 s_lshl_b32 s23, s21, 7
 s_lshl_b32 s24, s22, 4
 s_add_u32 s23, s23, s24
 s_lshl_b32 s24, s20, 2
 s_add_u32 s23, s23, s24
 s_add_u32 s23, s23, 0x6e8000
 v_mov_b32 v8, 0
 v_mov_b32 v9, 1
 s_mov_b64 exec, 1
 s_waitcnt vmcnt(0)
 buffer_store_dword v9, v8, s[4:7], s23 offen
 s_mov_b64 exec, -1
C1_e0_join:
 v_permlane16_swap_b32 v10, v12
 v_permlane16_swap_b32 v11, v13
 v_permlane16_swap_b32 v14, v16
 v_permlane16_swap_b32 v15, v17
 v_lshlrev_b32 v2, 4, v1
 s_mul_i32 s23, s20, 3072
 s_add_u32 s23, s23, 49152
 v_add_u32 v3, s23, v2
 v_add_u32 v4, 0x10000, v3
 v_lshrrev_b32 v8, 4, v1
 v_lshlrev_b32 v9, 3, v8
 v_lshlrev_b32 v8, 4, v8
 s_mul_i32 s23, s22, 12
 s_mul_i32 s24, s20, 3
 s_add_u32 s31, s23, s24
 s_lshl_b32 s23, s31, 6
 s_add_u32 s23, s23, 0x6e1e00
 s_lshl_b32 s24, s31, 5
 buffer_load_dwordx4 v[180:183], v8, s[4:7], s23 offen offset:0
 buffer_load_dwordx4 v[184:187], v8, s[4:7], s23 offen offset:64
 buffer_load_dwordx4 v[188:191], v8, s[4:7], s23 offen offset:128
 s_add_u32 s23, s23, 6144
 buffer_load_dwordx4 v[204:207], v8, s[4:7], s23 offen offset:0
 buffer_load_dwordx4 v[208:211], v8, s[4:7], s23 offen offset:64
 buffer_load_dwordx4 v[212:215], v8, s[4:7], s23 offen offset:128
 s_add_u32 s23, s23, 6144
 buffer_load_dwordx4 v[216:219], v8, s[4:7], s23 offen offset:0
 buffer_load_dwordx4 v[220:223], v8, s[4:7], s23 offen offset:64
 buffer_load_dwordx4 v[224:227], v8, s[4:7], s23 offen offset:128
 s_add_u32 s23, s23, 6144
 buffer_load_dwordx4 v[228:231], v8, s[4:7], s23 offen offset:0
 buffer_load_dwordx4 v[232:235], v8, s[4:7], s23 offen offset:64
 buffer_load_dwordx4 v[236:239], v8, s[4:7], s23 offen offset:128
 buffer_load_dwordx2 v[192:193], v9, s[8:11], s24 offen offset:0
 buffer_load_dwordx2 v[194:195], v9, s[8:11], s24 offen offset:32
 buffer_load_dwordx2 v[196:197], v9, s[8:11], s24 offen offset:64
 v_lshrrev_b32 v9, 4, v1
 v_and_b32 v198, 1, v9
 s_mov_b32 s23, 61440
 v_mul_lo_u32 v198, v198, s23
 v_lshrrev_b32 v9, 1, v9
 v_lshlrev_b32 v9, 8, v9
 v_add_u32 v198, v198, v9
 v_and_b32 v9, 15, v1
 v_lshlrev_b32 v9, 4, v9
 v_add_u32 v198, v198, v9
 s_mul_i32 s30, s21, 245760
 s_lshl_b32 s23, s31, 9
 s_add_u32 s30, s30, s23
 s_add_u32 s30, s30, 0x1172000
 s_add_u32 s29, s30, 122880
 s_waitcnt vmcnt(0)
 v_lshlrev_b32 v68, 16, v192
 v_and_b32 v69, 0xffff0000, v192
 v_lshlrev_b32 v70, 16, v193
 v_and_b32 v71, 0xffff0000, v193
 v_lshlrev_b32 v72, 16, v194
 v_and_b32 v73, 0xffff0000, v194
 v_lshlrev_b32 v74, 16, v195
 v_and_b32 v75, 0xffff0000, v195
 v_lshlrev_b32 v76, 16, v196
 v_and_b32 v77, 0xffff0000, v196
 v_lshlrev_b32 v78, 16, v197
 v_and_b32 v79, 0xffff0000, v197
 v_pk_add_f32 v[204:205], v[204:205], v[216:217]
 v_pk_add_f32 v[206:207], v[206:207], v[218:219]
 v_pk_add_f32 v[208:209], v[208:209], v[220:221]
 v_pk_add_f32 v[210:211], v[210:211], v[222:223]
 v_pk_add_f32 v[212:213], v[212:213], v[224:225]
 v_pk_add_f32 v[214:215], v[214:215], v[226:227]
 v_pk_add_f32 v[180:181], v[180:181], v[228:229]
 v_pk_add_f32 v[182:183], v[182:183], v[230:231]
 v_pk_add_f32 v[184:185], v[184:185], v[232:233]
 v_pk_add_f32 v[186:187], v[186:187], v[234:235]
 v_pk_add_f32 v[188:189], v[188:189], v[236:237]
 v_pk_add_f32 v[190:191], v[190:191], v[238:239]
 v_pk_add_f32 v[180:181], v[180:181], v[204:205]
 v_pk_add_f32 v[182:183], v[182:183], v[206:207]
 v_pk_add_f32 v[184:185], v[184:185], v[208:209]
 v_pk_add_f32 v[186:187], v[186:187], v[210:211]
 v_pk_add_f32 v[188:189], v[188:189], v[212:213]
 v_pk_add_f32 v[190:191], v[190:191], v[214:215]
 v_mov_b32 v80, 0xc0135761
 v_mov_b32 v81, 0xbdd2d3e8
 v_mov_b32 v82, 1.0
 v_mov_b32 v83, 1.0
 v_and_b32 v8, 15, v1
 v_lshlrev_b32 v8, 2, v8
 v_add_u32 v8, 161792, v8
 s_barrier
 ds_read_b128 v[84:87], v3 offset:0
 ds_read_b128 v[100:103], v2 offset:0
 ds_read_b128 v[88:91], v3 offset:1024
 ds_read_b128 v[92:95], v3 offset:2048
 ds_read_b128 v[104:107], v2 offset:2048
 ds_read_b128 v[108:111], v2 offset:4096
 ds_read_b128 v[112:115], v2 offset:6144
 s_waitcnt lgkmcnt(0)
 v_mfma_f32_16x16x32_bf16 v[20:23], v[84:87], v[100:103], 0
 ds_read_b128 v[116:119], v3 offset:12288
 v_mfma_f32_16x16x32_bf16 v[24:27], v[88:91], v[100:103], 0
 ds_read_b128 v[132:135], v2 offset:1024
 v_mfma_f32_16x16x32_bf16 v[28:31], v[92:95], v[100:103], 0
 ds_read_b128 v[120:123], v3 offset:13312
 v_mfma_f32_16x16x32_bf16 v[32:35], v[84:87], v[104:107], 0
 ds_read_b128 v[124:127], v3 offset:14336
 v_mfma_f32_16x16x32_bf16 v[36:39], v[88:91], v[104:107], 0
 ds_read_b128 v[136:139], v2 offset:3072
 v_mfma_f32_16x16x32_bf16 v[40:43], v[92:95], v[104:107], 0
 ds_read_b128 v[140:143], v2 offset:5120
 v_mfma_f32_16x16x32_bf16 v[44:47], v[84:87], v[108:111], 0
 ds_read_b128 v[144:147], v2 offset:7168
 v_mfma_f32_16x16x32_bf16 v[48:51], v[88:91], v[108:111], 0
 v_mfma_f32_16x16x32_bf16 v[52:55], v[92:95], v[108:111], 0
 v_mfma_f32_16x16x32_bf16 v[56:59], v[84:87], v[112:115], 0
 v_mfma_f32_16x16x32_bf16 v[60:63], v[88:91], v[112:115], 0
 v_mfma_f32_16x16x32_bf16 v[64:67], v[92:95], v[112:115], 0
 s_waitcnt lgkmcnt(0)
 v_mfma_f32_16x16x32_bf16 v[20:23], v[116:119], v[132:135], v[20:23]
 s_barrier
 ds_read_b128 v[84:87], v3 offset:24576
 v_mfma_f32_16x16x32_bf16 v[24:27], v[120:123], v[132:135], v[24:27]
 ds_read_b128 v[100:103], v2 offset:8192
 v_mfma_f32_16x16x32_bf16 v[28:31], v[124:127], v[132:135], v[28:31]
 ds_read_b128 v[88:91], v3 offset:25600
 v_mfma_f32_16x16x32_bf16 v[32:35], v[116:119], v[136:139], v[32:35]
 ds_read_b128 v[92:95], v3 offset:26624
 v_mfma_f32_16x16x32_bf16 v[36:39], v[120:123], v[136:139], v[36:39]
 ds_read_b128 v[104:107], v2 offset:10240
 v_mfma_f32_16x16x32_bf16 v[40:43], v[124:127], v[136:139], v[40:43]
 ds_read_b128 v[108:111], v2 offset:12288
 v_mfma_f32_16x16x32_bf16 v[44:47], v[116:119], v[140:143], v[44:47]
 ds_read_b128 v[112:115], v2 offset:14336
 v_mfma_f32_16x16x32_bf16 v[48:51], v[120:123], v[140:143], v[48:51]
 v_mfma_f32_16x16x32_bf16 v[52:55], v[124:127], v[140:143], v[52:55]
 v_mfma_f32_16x16x32_bf16 v[56:59], v[116:119], v[144:147], v[56:59]
 v_mfma_f32_16x16x32_bf16 v[60:63], v[120:123], v[144:147], v[60:63]
 v_mfma_f32_16x16x32_bf16 v[64:67], v[124:127], v[144:147], v[64:67]
 s_waitcnt lgkmcnt(0)
 v_mfma_f32_16x16x32_bf16 v[20:23], v[84:87], v[100:103], v[20:23]
 ds_read_b128 v[116:119], v3 offset:36864
 v_mfma_f32_16x16x32_bf16 v[24:27], v[88:91], v[100:103], v[24:27]
 ds_read_b128 v[132:135], v2 offset:9216
 v_mfma_f32_16x16x32_bf16 v[28:31], v[92:95], v[100:103], v[28:31]
 ds_read_b128 v[120:123], v3 offset:37888
 v_mfma_f32_16x16x32_bf16 v[32:35], v[84:87], v[104:107], v[32:35]
 ds_read_b128 v[124:127], v3 offset:38912
 v_mfma_f32_16x16x32_bf16 v[36:39], v[88:91], v[104:107], v[36:39]
 ds_read_b128 v[136:139], v2 offset:11264
 v_mfma_f32_16x16x32_bf16 v[40:43], v[92:95], v[104:107], v[40:43]
 ds_read_b128 v[140:143], v2 offset:13312
 v_mfma_f32_16x16x32_bf16 v[44:47], v[84:87], v[108:111], v[44:47]
 ds_read_b128 v[144:147], v2 offset:15360
 v_mfma_f32_16x16x32_bf16 v[48:51], v[88:91], v[108:111], v[48:51]
 v_mfma_f32_16x16x32_bf16 v[52:55], v[92:95], v[108:111], v[52:55]
 v_mfma_f32_16x16x32_bf16 v[56:59], v[84:87], v[112:115], v[56:59]
 v_mfma_f32_16x16x32_bf16 v[60:63], v[88:91], v[112:115], v[60:63]
 v_mfma_f32_16x16x32_bf16 v[64:67], v[92:95], v[112:115], v[64:67]
 s_waitcnt lgkmcnt(0)
 v_mfma_f32_16x16x32_bf16 v[20:23], v[116:119], v[132:135], v[20:23]
 s_barrier
 ds_read_b128 v[84:87], v3 offset:49152
 v_mfma_f32_16x16x32_bf16 v[24:27], v[120:123], v[132:135], v[24:27]
 ds_read_b128 v[100:103], v2 offset:16384
 v_mfma_f32_16x16x32_bf16 v[28:31], v[124:127], v[132:135], v[28:31]
 ds_read_b128 v[88:91], v3 offset:50176
 v_mfma_f32_16x16x32_bf16 v[32:35], v[116:119], v[136:139], v[32:35]
 ds_read_b128 v[92:95], v3 offset:51200
 v_mfma_f32_16x16x32_bf16 v[36:39], v[120:123], v[136:139], v[36:39]
 ds_read_b128 v[104:107], v2 offset:18432
 v_mfma_f32_16x16x32_bf16 v[40:43], v[124:127], v[136:139], v[40:43]
 ds_read_b128 v[108:111], v2 offset:20480
 v_mfma_f32_16x16x32_bf16 v[44:47], v[116:119], v[140:143], v[44:47]
 ds_read_b128 v[112:115], v2 offset:22528
 v_mfma_f32_16x16x32_bf16 v[48:51], v[120:123], v[140:143], v[48:51]
 v_mfma_f32_16x16x32_bf16 v[52:55], v[124:127], v[140:143], v[52:55]
 v_mfma_f32_16x16x32_bf16 v[56:59], v[116:119], v[144:147], v[56:59]
 v_mfma_f32_16x16x32_bf16 v[60:63], v[120:123], v[144:147], v[60:63]
 v_mfma_f32_16x16x32_bf16 v[64:67], v[124:127], v[144:147], v[64:67]
 s_waitcnt lgkmcnt(0)
 v_mfma_f32_16x16x32_bf16 v[20:23], v[84:87], v[100:103], v[20:23]
 ds_read_b128 v[116:119], v3 offset:61440
 v_mfma_f32_16x16x32_bf16 v[24:27], v[88:91], v[100:103], v[24:27]
 ds_read_b128 v[132:135], v2 offset:17408
 v_mfma_f32_16x16x32_bf16 v[28:31], v[92:95], v[100:103], v[28:31]
 ds_read_b128 v[120:123], v3 offset:62464
 v_mfma_f32_16x16x32_bf16 v[32:35], v[84:87], v[104:107], v[32:35]
 ds_read_b128 v[124:127], v3 offset:63488
 v_mfma_f32_16x16x32_bf16 v[36:39], v[88:91], v[104:107], v[36:39]
 ds_read_b128 v[136:139], v2 offset:19456
 v_mfma_f32_16x16x32_bf16 v[40:43], v[92:95], v[104:107], v[40:43]
 ds_read_b128 v[140:143], v2 offset:21504
 v_mfma_f32_16x16x32_bf16 v[44:47], v[84:87], v[108:111], v[44:47]
 ds_read_b128 v[144:147], v2 offset:23552
 v_mfma_f32_16x16x32_bf16 v[48:51], v[88:91], v[108:111], v[48:51]
 v_mfma_f32_16x16x32_bf16 v[52:55], v[92:95], v[108:111], v[52:55]
 v_mfma_f32_16x16x32_bf16 v[56:59], v[84:87], v[112:115], v[56:59]
 v_mfma_f32_16x16x32_bf16 v[60:63], v[88:91], v[112:115], v[60:63]
 v_mfma_f32_16x16x32_bf16 v[64:67], v[92:95], v[112:115], v[64:67]
 s_waitcnt lgkmcnt(0)
 v_mfma_f32_16x16x32_bf16 v[20:23], v[116:119], v[132:135], v[20:23]
 s_barrier
 ds_read_b128 v[84:87], v4 offset:8192
 v_mfma_f32_16x16x32_bf16 v[24:27], v[120:123], v[132:135], v[24:27]
 ds_read_b128 v[100:103], v2 offset:24576
 v_mfma_f32_16x16x32_bf16 v[28:31], v[124:127], v[132:135], v[28:31]
 ds_read_b128 v[88:91], v4 offset:9216
 v_mfma_f32_16x16x32_bf16 v[32:35], v[116:119], v[136:139], v[32:35]
 ds_read_b128 v[92:95], v4 offset:10240
 v_mfma_f32_16x16x32_bf16 v[36:39], v[120:123], v[136:139], v[36:39]
 ds_read_b128 v[104:107], v2 offset:26624
 v_mfma_f32_16x16x32_bf16 v[40:43], v[124:127], v[136:139], v[40:43]
 ds_read_b128 v[108:111], v2 offset:28672
 v_mfma_f32_16x16x32_bf16 v[44:47], v[116:119], v[140:143], v[44:47]
 ds_read_b128 v[112:115], v2 offset:30720
 v_mfma_f32_16x16x32_bf16 v[48:51], v[120:123], v[140:143], v[48:51]
 v_mfma_f32_16x16x32_bf16 v[52:55], v[124:127], v[140:143], v[52:55]
 v_mfma_f32_16x16x32_bf16 v[56:59], v[116:119], v[144:147], v[56:59]
 v_mfma_f32_16x16x32_bf16 v[60:63], v[120:123], v[144:147], v[60:63]
 v_mfma_f32_16x16x32_bf16 v[64:67], v[124:127], v[144:147], v[64:67]
 s_waitcnt lgkmcnt(0)
 v_mfma_f32_16x16x32_bf16 v[20:23], v[84:87], v[100:103], v[20:23]
 ds_read_b128 v[116:119], v4 offset:20480
 v_mfma_f32_16x16x32_bf16 v[24:27], v[88:91], v[100:103], v[24:27]
 ds_read_b128 v[132:135], v2 offset:25600
 v_mfma_f32_16x16x32_bf16 v[28:31], v[92:95], v[100:103], v[28:31]
 ds_read_b128 v[120:123], v4 offset:21504
 v_mfma_f32_16x16x32_bf16 v[32:35], v[84:87], v[104:107], v[32:35]
 ds_read_b128 v[124:127], v4 offset:22528
 v_mfma_f32_16x16x32_bf16 v[36:39], v[88:91], v[104:107], v[36:39]
 ds_read_b128 v[136:139], v2 offset:27648
 v_mfma_f32_16x16x32_bf16 v[40:43], v[92:95], v[104:107], v[40:43]
 ds_read_b128 v[140:143], v2 offset:29696
 v_mfma_f32_16x16x32_bf16 v[44:47], v[84:87], v[108:111], v[44:47]
 ds_read_b128 v[144:147], v2 offset:31744
 v_mfma_f32_16x16x32_bf16 v[48:51], v[88:91], v[108:111], v[48:51]
 v_mfma_f32_16x16x32_bf16 v[52:55], v[92:95], v[108:111], v[52:55]
 v_mfma_f32_16x16x32_bf16 v[56:59], v[84:87], v[112:115], v[56:59]
 v_mfma_f32_16x16x32_bf16 v[60:63], v[88:91], v[112:115], v[60:63]
 v_mfma_f32_16x16x32_bf16 v[64:67], v[92:95], v[112:115], v[64:67]
 s_waitcnt lgkmcnt(0)
 v_mfma_f32_16x16x32_bf16 v[20:23], v[116:119], v[132:135], v[20:23]
 s_barrier
 ds_read_b128 v[84:87], v4 offset:32768
 v_mfma_f32_16x16x32_bf16 v[24:27], v[120:123], v[132:135], v[24:27]
 ds_read_b128 v[100:103], v2 offset:32768
 v_mfma_f32_16x16x32_bf16 v[28:31], v[124:127], v[132:135], v[28:31]
 ds_read_b128 v[88:91], v4 offset:33792
 v_mfma_f32_16x16x32_bf16 v[32:35], v[116:119], v[136:139], v[32:35]
 ds_read_b128 v[92:95], v4 offset:34816
 v_mfma_f32_16x16x32_bf16 v[36:39], v[120:123], v[136:139], v[36:39]
 ds_read_b128 v[104:107], v2 offset:34816
 v_mfma_f32_16x16x32_bf16 v[40:43], v[124:127], v[136:139], v[40:43]
 ds_read_b128 v[108:111], v2 offset:36864
 v_mfma_f32_16x16x32_bf16 v[44:47], v[116:119], v[140:143], v[44:47]
 ds_read_b128 v[112:115], v2 offset:38912
 v_mfma_f32_16x16x32_bf16 v[48:51], v[120:123], v[140:143], v[48:51]
 v_mfma_f32_16x16x32_bf16 v[52:55], v[124:127], v[140:143], v[52:55]
 v_mfma_f32_16x16x32_bf16 v[56:59], v[116:119], v[144:147], v[56:59]
 v_mfma_f32_16x16x32_bf16 v[60:63], v[120:123], v[144:147], v[60:63]
 v_mfma_f32_16x16x32_bf16 v[64:67], v[124:127], v[144:147], v[64:67]
 s_waitcnt lgkmcnt(0)
 v_mfma_f32_16x16x32_bf16 v[20:23], v[84:87], v[100:103], v[20:23]
 ds_read_b128 v[116:119], v3 offset:0
 v_mfma_f32_16x16x32_bf16 v[24:27], v[88:91], v[100:103], v[24:27]
 ds_read_b128 v[132:135], v2 offset:33792
 v_mfma_f32_16x16x32_bf16 v[28:31], v[92:95], v[100:103], v[28:31]
 ds_read_b128 v[120:123], v3 offset:1024
 v_mfma_f32_16x16x32_bf16 v[32:35], v[84:87], v[104:107], v[32:35]
 ds_read_b128 v[124:127], v3 offset:2048
 v_mfma_f32_16x16x32_bf16 v[36:39], v[88:91], v[104:107], v[36:39]
 ds_read_b128 v[136:139], v2 offset:35840
 v_mfma_f32_16x16x32_bf16 v[40:43], v[92:95], v[104:107], v[40:43]
 ds_read_b128 v[140:143], v2 offset:37888
 v_mfma_f32_16x16x32_bf16 v[44:47], v[84:87], v[108:111], v[44:47]
 ds_read_b128 v[144:147], v2 offset:39936
 v_mfma_f32_16x16x32_bf16 v[48:51], v[88:91], v[108:111], v[48:51]
 v_mfma_f32_16x16x32_bf16 v[52:55], v[92:95], v[108:111], v[52:55]
 v_mfma_f32_16x16x32_bf16 v[56:59], v[84:87], v[112:115], v[56:59]
 v_mfma_f32_16x16x32_bf16 v[60:63], v[88:91], v[112:115], v[60:63]
 v_mfma_f32_16x16x32_bf16 v[64:67], v[92:95], v[112:115], v[64:67]
 s_waitcnt lgkmcnt(0)
 v_mfma_f32_16x16x32_bf16 v[20:23], v[116:119], v[132:135], v[20:23]
 s_barrier
 ds_read_b128 v[84:87], v3 offset:12288
 v_mfma_f32_16x16x32_bf16 v[24:27], v[120:123], v[132:135], v[24:27]
 ds_read_b128 v[100:103], v2 offset:40960
 v_mfma_f32_16x16x32_bf16 v[28:31], v[124:127], v[132:135], v[28:31]
 ds_read_b128 v[88:91], v3 offset:13312
 v_mfma_f32_16x16x32_bf16 v[32:35], v[116:119], v[136:139], v[32:35]
 ds_read_b128 v[92:95], v3 offset:14336
 v_mfma_f32_16x16x32_bf16 v[36:39], v[120:123], v[136:139], v[36:39]
 ds_read_b128 v[104:107], v2 offset:43008
 v_mfma_f32_16x16x32_bf16 v[40:43], v[124:127], v[136:139], v[40:43]
 ds_read_b128 v[108:111], v2 offset:45056
 v_mfma_f32_16x16x32_bf16 v[44:47], v[116:119], v[140:143], v[44:47]
 ds_read_b128 v[112:115], v2 offset:47104
 v_mfma_f32_16x16x32_bf16 v[48:51], v[120:123], v[140:143], v[48:51]
 v_mfma_f32_16x16x32_bf16 v[52:55], v[124:127], v[140:143], v[52:55]
 v_mfma_f32_16x16x32_bf16 v[56:59], v[116:119], v[144:147], v[56:59]
 v_mfma_f32_16x16x32_bf16 v[60:63], v[120:123], v[144:147], v[60:63]
 v_mfma_f32_16x16x32_bf16 v[64:67], v[124:127], v[144:147], v[64:67]
 s_waitcnt lgkmcnt(0)
 v_mfma_f32_16x16x32_bf16 v[20:23], v[84:87], v[100:103], v[20:23]
 ds_read_b128 v[116:119], v3 offset:24576
 v_mfma_f32_16x16x32_bf16 v[24:27], v[88:91], v[100:103], v[24:27]
 ds_read_b128 v[132:135], v2 offset:41984
 v_mfma_f32_16x16x32_bf16 v[28:31], v[92:95], v[100:103], v[28:31]
 ds_read_b128 v[120:123], v3 offset:25600
 v_mfma_f32_16x16x32_bf16 v[32:35], v[84:87], v[104:107], v[32:35]
 ds_read_b128 v[124:127], v3 offset:26624
 v_mfma_f32_16x16x32_bf16 v[36:39], v[88:91], v[104:107], v[36:39]
 ds_read_b128 v[136:139], v2 offset:44032
 v_mfma_f32_16x16x32_bf16 v[40:43], v[92:95], v[104:107], v[40:43]
 ds_read_b128 v[140:143], v2 offset:46080
 v_mfma_f32_16x16x32_bf16 v[44:47], v[84:87], v[108:111], v[44:47]
 ds_read_b128 v[144:147], v2 offset:48128
 v_mfma_f32_16x16x32_bf16 v[48:51], v[88:91], v[108:111], v[48:51]
 v_mfma_f32_16x16x32_bf16 v[52:55], v[92:95], v[108:111], v[52:55]
 v_mfma_f32_16x16x32_bf16 v[56:59], v[84:87], v[112:115], v[56:59]
 v_mfma_f32_16x16x32_bf16 v[60:63], v[88:91], v[112:115], v[60:63]
 v_mfma_f32_16x16x32_bf16 v[64:67], v[92:95], v[112:115], v[64:67]
 s_waitcnt lgkmcnt(0)
 v_mfma_f32_16x16x32_bf16 v[20:23], v[116:119], v[132:135], v[20:23]
 s_barrier
 ds_read_b128 v[84:87], v3 offset:36864
 v_mfma_f32_16x16x32_bf16 v[24:27], v[120:123], v[132:135], v[24:27]
 ds_read_b128 v[100:103], v2 offset:0
 v_mfma_f32_16x16x32_bf16 v[28:31], v[124:127], v[132:135], v[28:31]
 ds_read_b128 v[88:91], v3 offset:37888
 v_mfma_f32_16x16x32_bf16 v[32:35], v[116:119], v[136:139], v[32:35]
 ds_read_b128 v[92:95], v3 offset:38912
 v_mfma_f32_16x16x32_bf16 v[36:39], v[120:123], v[136:139], v[36:39]
 ds_read_b128 v[104:107], v2 offset:2048
 v_mfma_f32_16x16x32_bf16 v[40:43], v[124:127], v[136:139], v[40:43]
 ds_read_b128 v[108:111], v2 offset:4096
 v_mfma_f32_16x16x32_bf16 v[44:47], v[116:119], v[140:143], v[44:47]
 ds_read_b128 v[112:115], v2 offset:6144
 v_mfma_f32_16x16x32_bf16 v[48:51], v[120:123], v[140:143], v[48:51]
 v_mfma_f32_16x16x32_bf16 v[52:55], v[124:127], v[140:143], v[52:55]
 v_mfma_f32_16x16x32_bf16 v[56:59], v[116:119], v[144:147], v[56:59]
 v_mfma_f32_16x16x32_bf16 v[60:63], v[120:123], v[144:147], v[60:63]
 v_mfma_f32_16x16x32_bf16 v[64:67], v[124:127], v[144:147], v[64:67]
 s_waitcnt lgkmcnt(0)
 v_mfma_f32_16x16x32_bf16 v[20:23], v[84:87], v[100:103], v[20:23]
 ds_read_b128 v[116:119], v3 offset:49152
 v_mfma_f32_16x16x32_bf16 v[24:27], v[88:91], v[100:103], v[24:27]
 ds_read_b128 v[132:135], v2 offset:1024
 v_mfma_f32_16x16x32_bf16 v[28:31], v[92:95], v[100:103], v[28:31]
 ds_read_b128 v[120:123], v3 offset:50176
 v_mfma_f32_16x16x32_bf16 v[32:35], v[84:87], v[104:107], v[32:35]
 ds_read_b128 v[124:127], v3 offset:51200
 v_mfma_f32_16x16x32_bf16 v[36:39], v[88:91], v[104:107], v[36:39]
 ds_read_b128 v[136:139], v2 offset:3072
 v_mfma_f32_16x16x32_bf16 v[40:43], v[92:95], v[104:107], v[40:43]
 ds_read_b128 v[140:143], v2 offset:5120
 v_mfma_f32_16x16x32_bf16 v[44:47], v[84:87], v[108:111], v[44:47]
 ds_read_b128 v[144:147], v2 offset:7168
 v_mfma_f32_16x16x32_bf16 v[48:51], v[88:91], v[108:111], v[48:51]
 v_mfma_f32_16x16x32_bf16 v[52:55], v[92:95], v[108:111], v[52:55]
 v_mfma_f32_16x16x32_bf16 v[56:59], v[84:87], v[112:115], v[56:59]
 v_mfma_f32_16x16x32_bf16 v[60:63], v[88:91], v[112:115], v[60:63]
 v_mfma_f32_16x16x32_bf16 v[64:67], v[92:95], v[112:115], v[64:67]
 s_waitcnt lgkmcnt(0)
 v_mfma_f32_16x16x32_bf16 v[20:23], v[116:119], v[132:135], v[20:23]
 s_barrier
 ds_read_b128 v[84:87], v3 offset:61440
 v_mfma_f32_16x16x32_bf16 v[24:27], v[120:123], v[132:135], v[24:27]
 ds_read_b128 v[100:103], v2 offset:8192
 v_mfma_f32_16x16x32_bf16 v[28:31], v[124:127], v[132:135], v[28:31]
 ds_read_b128 v[88:91], v3 offset:62464
 v_mfma_f32_16x16x32_bf16 v[32:35], v[116:119], v[136:139], v[32:35]
 ds_read_b128 v[92:95], v3 offset:63488
 v_mfma_f32_16x16x32_bf16 v[36:39], v[120:123], v[136:139], v[36:39]
 ds_read_b128 v[104:107], v2 offset:10240
 v_mfma_f32_16x16x32_bf16 v[40:43], v[124:127], v[136:139], v[40:43]
 ds_read_b128 v[108:111], v2 offset:12288
 v_mfma_f32_16x16x32_bf16 v[44:47], v[116:119], v[140:143], v[44:47]
 ds_read_b128 v[112:115], v2 offset:14336
 v_mfma_f32_16x16x32_bf16 v[48:51], v[120:123], v[140:143], v[48:51]
 v_mfma_f32_16x16x32_bf16 v[52:55], v[124:127], v[140:143], v[52:55]
 v_mfma_f32_16x16x32_bf16 v[56:59], v[116:119], v[144:147], v[56:59]
 v_mfma_f32_16x16x32_bf16 v[60:63], v[120:123], v[144:147], v[60:63]
 v_mfma_f32_16x16x32_bf16 v[64:67], v[124:127], v[144:147], v[64:67]
 s_waitcnt lgkmcnt(0)
 v_mfma_f32_16x16x32_bf16 v[20:23], v[84:87], v[100:103], v[20:23]
 ds_read_b128 v[116:119], v4 offset:8192
 v_mfma_f32_16x16x32_bf16 v[24:27], v[88:91], v[100:103], v[24:27]
 ds_read_b128 v[132:135], v2 offset:9216
 v_mfma_f32_16x16x32_bf16 v[28:31], v[92:95], v[100:103], v[28:31]
 ds_read_b128 v[120:123], v4 offset:9216
 v_mfma_f32_16x16x32_bf16 v[32:35], v[84:87], v[104:107], v[32:35]
 ds_read_b128 v[124:127], v4 offset:10240
 v_mfma_f32_16x16x32_bf16 v[36:39], v[88:91], v[104:107], v[36:39]
 ds_read_b128 v[136:139], v2 offset:11264
 v_mfma_f32_16x16x32_bf16 v[40:43], v[92:95], v[104:107], v[40:43]
 ds_read_b128 v[140:143], v2 offset:13312
 v_mfma_f32_16x16x32_bf16 v[44:47], v[84:87], v[108:111], v[44:47]
 ds_read_b128 v[144:147], v2 offset:15360
 v_mfma_f32_16x16x32_bf16 v[48:51], v[88:91], v[108:111], v[48:51]
 v_mfma_f32_16x16x32_bf16 v[52:55], v[92:95], v[108:111], v[52:55]
 v_mfma_f32_16x16x32_bf16 v[56:59], v[84:87], v[112:115], v[56:59]
 v_mfma_f32_16x16x32_bf16 v[60:63], v[88:91], v[112:115], v[60:63]
 v_mfma_f32_16x16x32_bf16 v[64:67], v[92:95], v[112:115], v[64:67]
 s_waitcnt lgkmcnt(0)
 v_mfma_f32_16x16x32_bf16 v[20:23], v[116:119], v[132:135], v[20:23]
 s_barrier
 ds_read_b128 v[84:87], v4 offset:20480
 v_mfma_f32_16x16x32_bf16 v[24:27], v[120:123], v[132:135], v[24:27]
 ds_read_b128 v[100:103], v2 offset:16384
 v_mfma_f32_16x16x32_bf16 v[28:31], v[124:127], v[132:135], v[28:31]
 ds_read_b128 v[88:91], v4 offset:21504
 v_mfma_f32_16x16x32_bf16 v[32:35], v[116:119], v[136:139], v[32:35]
 ds_read_b128 v[92:95], v4 offset:22528
 v_mfma_f32_16x16x32_bf16 v[36:39], v[120:123], v[136:139], v[36:39]
 ds_read_b128 v[104:107], v2 offset:18432
 v_mfma_f32_16x16x32_bf16 v[40:43], v[124:127], v[136:139], v[40:43]
 ds_read_b128 v[108:111], v2 offset:20480
 v_mfma_f32_16x16x32_bf16 v[44:47], v[116:119], v[140:143], v[44:47]
 ds_read_b128 v[112:115], v2 offset:22528
 v_mfma_f32_16x16x32_bf16 v[48:51], v[120:123], v[140:143], v[48:51]
 v_mfma_f32_16x16x32_bf16 v[52:55], v[124:127], v[140:143], v[52:55]
 v_mfma_f32_16x16x32_bf16 v[56:59], v[116:119], v[144:147], v[56:59]
 v_mfma_f32_16x16x32_bf16 v[60:63], v[120:123], v[144:147], v[60:63]
 v_mfma_f32_16x16x32_bf16 v[64:67], v[124:127], v[144:147], v[64:67]
 s_waitcnt lgkmcnt(0)
 v_mfma_f32_16x16x32_bf16 v[20:23], v[84:87], v[100:103], v[20:23]
 ds_read_b128 v[116:119], v4 offset:32768
 v_mfma_f32_16x16x32_bf16 v[24:27], v[88:91], v[100:103], v[24:27]
 ds_read_b128 v[132:135], v2 offset:17408
 v_mfma_f32_16x16x32_bf16 v[28:31], v[92:95], v[100:103], v[28:31]
 ds_read_b128 v[120:123], v4 offset:33792
 v_mfma_f32_16x16x32_bf16 v[32:35], v[84:87], v[104:107], v[32:35]
 ds_read_b128 v[124:127], v4 offset:34816
 v_mfma_f32_16x16x32_bf16 v[36:39], v[88:91], v[104:107], v[36:39]
 ds_read_b128 v[136:139], v2 offset:19456
 v_mfma_f32_16x16x32_bf16 v[40:43], v[92:95], v[104:107], v[40:43]
 ds_read_b128 v[140:143], v2 offset:21504
 v_mfma_f32_16x16x32_bf16 v[44:47], v[84:87], v[108:111], v[44:47]
 ds_read_b128 v[144:147], v2 offset:23552
 v_mfma_f32_16x16x32_bf16 v[48:51], v[88:91], v[108:111], v[48:51]
 v_mfma_f32_16x16x32_bf16 v[52:55], v[92:95], v[108:111], v[52:55]
 v_mfma_f32_16x16x32_bf16 v[56:59], v[84:87], v[112:115], v[56:59]
 v_mfma_f32_16x16x32_bf16 v[60:63], v[88:91], v[112:115], v[60:63]
 v_mfma_f32_16x16x32_bf16 v[64:67], v[92:95], v[112:115], v[64:67]
 s_waitcnt lgkmcnt(0)
 v_mfma_f32_16x16x32_bf16 v[20:23], v[116:119], v[132:135], v[20:23]
 s_barrier
 ds_read_b128 v[84:87], v3 offset:0
 v_mfma_f32_16x16x32_bf16 v[24:27], v[120:123], v[132:135], v[24:27]
 ds_read_b128 v[100:103], v2 offset:24576
 v_mfma_f32_16x16x32_bf16 v[28:31], v[124:127], v[132:135], v[28:31]
 ds_read_b128 v[88:91], v3 offset:1024
 v_mfma_f32_16x16x32_bf16 v[32:35], v[116:119], v[136:139], v[32:35]
 ds_read_b128 v[92:95], v3 offset:2048
 v_mfma_f32_16x16x32_bf16 v[36:39], v[120:123], v[136:139], v[36:39]
 ds_read_b128 v[104:107], v2 offset:26624
 v_mfma_f32_16x16x32_bf16 v[40:43], v[124:127], v[136:139], v[40:43]
 ds_read_b128 v[108:111], v2 offset:28672
 v_mfma_f32_16x16x32_bf16 v[44:47], v[116:119], v[140:143], v[44:47]
 ds_read_b128 v[112:115], v2 offset:30720
 v_mfma_f32_16x16x32_bf16 v[48:51], v[120:123], v[140:143], v[48:51]
 v_mfma_f32_16x16x32_bf16 v[52:55], v[124:127], v[140:143], v[52:55]
 v_mfma_f32_16x16x32_bf16 v[56:59], v[116:119], v[144:147], v[56:59]
 v_mfma_f32_16x16x32_bf16 v[60:63], v[120:123], v[144:147], v[60:63]
 v_mfma_f32_16x16x32_bf16 v[64:67], v[124:127], v[144:147], v[64:67]
 s_waitcnt lgkmcnt(0)
 v_mfma_f32_16x16x32_bf16 v[20:23], v[84:87], v[100:103], v[20:23]
 ds_read_b128 v[116:119], v3 offset:12288
 v_mfma_f32_16x16x32_bf16 v[24:27], v[88:91], v[100:103], v[24:27]
 ds_read_b128 v[132:135], v2 offset:25600
 v_mfma_f32_16x16x32_bf16 v[28:31], v[92:95], v[100:103], v[28:31]
 ds_read_b128 v[120:123], v3 offset:13312
 v_mfma_f32_16x16x32_bf16 v[32:35], v[84:87], v[104:107], v[32:35]
 ds_read_b128 v[124:127], v3 offset:14336
 v_mfma_f32_16x16x32_bf16 v[36:39], v[88:91], v[104:107], v[36:39]
 ds_read_b128 v[136:139], v2 offset:27648
 v_mfma_f32_16x16x32_bf16 v[40:43], v[92:95], v[104:107], v[40:43]
 ds_read_b128 v[140:143], v2 offset:29696
 v_mfma_f32_16x16x32_bf16 v[44:47], v[84:87], v[108:111], v[44:47]
 ds_read_b128 v[144:147], v2 offset:31744
 v_mfma_f32_16x16x32_bf16 v[48:51], v[88:91], v[108:111], v[48:51]
 v_mfma_f32_16x16x32_bf16 v[52:55], v[92:95], v[108:111], v[52:55]
 v_mfma_f32_16x16x32_bf16 v[56:59], v[84:87], v[112:115], v[56:59]
 v_mfma_f32_16x16x32_bf16 v[60:63], v[88:91], v[112:115], v[60:63]
 v_mfma_f32_16x16x32_bf16 v[64:67], v[92:95], v[112:115], v[64:67]
 s_waitcnt lgkmcnt(0)
 v_mfma_f32_16x16x32_bf16 v[20:23], v[116:119], v[132:135], v[20:23]
 s_barrier
 v_mfma_f32_16x16x32_bf16 v[24:27], v[120:123], v[132:135], v[24:27]
 ds_read_b32 v84, v8 offset:0
 ds_read_b32 v85, v8 offset:64
 v_mfma_f32_16x16x32_bf16 v[28:31], v[124:127], v[132:135], v[28:31]
 ds_read_b32 v86, v8 offset:128
 ds_read_b32 v87, v8 offset:192
 v_mfma_f32_16x16x32_bf16 v[32:35], v[116:119], v[136:139], v[32:35]
 ds_read_b32 v88, v8 offset:256
 ds_read_b32 v89, v8 offset:320
 v_mfma_f32_16x16x32_bf16 v[36:39], v[120:123], v[136:139], v[36:39]
 ds_read_b32 v90, v8 offset:384
 ds_read_b32 v91, v8 offset:448
 v_mfma_f32_16x16x32_bf16 v[40:43], v[124:127], v[136:139], v[40:43]
 v_mfma_f32_16x16x32_bf16 v[44:47], v[116:119], v[140:143], v[44:47]
 v_mfma_f32_16x16x32_bf16 v[48:51], v[120:123], v[140:143], v[48:51]
 v_mfma_f32_16x16x32_bf16 v[52:55], v[124:127], v[140:143], v[52:55]
 v_mfma_f32_16x16x32_bf16 v[56:59], v[116:119], v[144:147], v[56:59]
 v_mfma_f32_16x16x32_bf16 v[60:63], v[120:123], v[144:147], v[60:63]
 v_mfma_f32_16x16x32_bf16 v[64:67], v[124:127], v[144:147], v[64:67]
 s_waitcnt lgkmcnt(0)
 s_cmp_eq_u32 s33, 0
 s_cbranch_scc1 C1_e1_slow
 v_pk_fma_f32 v[108:109], v[180:181], v[88:89], v[68:69] op_sel:[0,0,0] op_sel_hi:[1,0,1] neg_lo:[0,1,0] neg_hi:[0,1,0]
 v_pk_fma_f32 v[110:111], v[182:183], v[88:89], v[70:71] op_sel:[0,0,0] op_sel_hi:[1,0,1] neg_lo:[0,1,0] neg_hi:[0,1,0]
 v_pk_fma_f32 v[112:113], v[180:181], v[88:89], v[68:69] op_sel:[0,1,0] op_sel_hi:[1,1,1] neg_lo:[0,1,0] neg_hi:[0,1,0]
 v_pk_fma_f32 v[114:115], v[182:183], v[88:89], v[70:71] op_sel:[0,1,0] op_sel_hi:[1,1,1] neg_lo:[0,1,0] neg_hi:[0,1,0]
 v_pk_fma_f32 v[108:109], v[20:21], v[84:85], v[108:109] op_sel:[0,0,0] op_sel_hi:[1,0,1]
 v_pk_fma_f32 v[110:111], v[22:23], v[84:85], v[110:111] op_sel:[0,0,0] op_sel_hi:[1,0,1]
 v_pk_fma_f32 v[112:113], v[32:33], v[84:85], v[112:113] op_sel:[0,1,0] op_sel_hi:[1,1,1]
 v_pk_fma_f32 v[114:115], v[34:35], v[84:85], v[114:115] op_sel:[0,1,0] op_sel_hi:[1,1,1]
 v_pk_mul_f32 v[116:117], v[108:109], v[108:109]
 v_pk_mul_f32 v[118:119], v[110:111], v[110:111]
 v_pk_mul_f32 v[120:121], v[112:113], v[112:113]
 v_pk_mul_f32 v[122:123], v[114:115], v[114:115]
 v_pk_fma_f32 v[116:117], v[116:117], v[80:81], v[80:81] op_sel:[0,1,0] op_sel_hi:[1,1,0]
 v_pk_fma_f32 v[118:119], v[118:119], v[80:81], v[80:81] op_sel:[0,1,0] op_sel_hi:[1,1,0]
 v_pk_fma_f32 v[120:121], v[120:121], v[80:81], v[80:81] op_sel:[0,1,0] op_sel_hi:[1,1,0]
 v_pk_fma_f32 v[122:123], v[122:123], v[80:81], v[80:81] op_sel:[0,1,0] op_sel_hi:[1,1,0]
 v_pk_mul_f32 v[116:117], v[116:117], v[108:109]
 v_pk_mul_f32 v[118:119], v[118:119], v[110:111]
 v_pk_mul_f32 v[120:121], v[120:121], v[112:113]
 v_pk_mul_f32 v[122:123], v[122:123], v[114:115]
 v_exp_f32 v116, v116
 v_exp_f32 v117, v117
 v_exp_f32 v118, v118
 v_exp_f32 v119, v119
 v_exp_f32 v120, v120
 v_exp_f32 v121, v121
 v_exp_f32 v122, v122
 v_exp_f32 v123, v123
 v_pk_add_f32 v[116:117], v[116:117], v[82:83]
 v_pk_add_f32 v[118:119], v[118:119], v[82:83]
 v_pk_add_f32 v[120:121], v[120:121], v[82:83]
 v_pk_add_f32 v[122:123], v[122:123], v[82:83]
 v_rcp_f32 v116, v116
 v_rcp_f32 v117, v117
 v_rcp_f32 v118, v118
 v_rcp_f32 v119, v119
 v_rcp_f32 v120, v120
 v_rcp_f32 v121, v121
 v_rcp_f32 v122, v122
 v_rcp_f32 v123, v123
 v_pk_mul_f32 v[116:117], v[116:117], v[108:109]
 v_pk_mul_f32 v[118:119], v[118:119], v[110:111]
 v_pk_mul_f32 v[120:121], v[120:121], v[112:113]
 v_pk_mul_f32 v[122:123], v[122:123], v[114:115]
 v_cvt_pk_bf16_f32 v124, v116, v117
 v_cvt_pk_bf16_f32 v125, v118, v119
 v_cvt_pk_bf16_f32 v126, v120, v121
 v_cvt_pk_bf16_f32 v127, v122, v123
 s_nop 0
 v_permlane16_swap_b32 v124, v126
 v_permlane16_swap_b32 v125, v127
 buffer_store_dwordx4 v[124:127], v198, s[4:7], s30 offen offset:0
 v_pk_fma_f32 v[132:133], v[180:181], v[90:91], v[68:69] op_sel:[0,0,0] op_sel_hi:[1,0,1] neg_lo:[0,1,0] neg_hi:[0,1,0]
 v_pk_fma_f32 v[134:135], v[182:183], v[90:91], v[70:71] op_sel:[0,0,0] op_sel_hi:[1,0,1] neg_lo:[0,1,0] neg_hi:[0,1,0]
 v_pk_fma_f32 v[136:137], v[180:181], v[90:91], v[68:69] op_sel:[0,1,0] op_sel_hi:[1,1,1] neg_lo:[0,1,0] neg_hi:[0,1,0]
 v_pk_fma_f32 v[138:139], v[182:183], v[90:91], v[70:71] op_sel:[0,1,0] op_sel_hi:[1,1,1] neg_lo:[0,1,0] neg_hi:[0,1,0]
 v_pk_fma_f32 v[132:133], v[44:45], v[86:87], v[132:133] op_sel:[0,0,0] op_sel_hi:[1,0,1]
 v_pk_fma_f32 v[134:135], v[46:47], v[86:87], v[134:135] op_sel:[0,0,0] op_sel_hi:[1,0,1]
 v_pk_fma_f32 v[136:137], v[56:57], v[86:87], v[136:137] op_sel:[0,1,0] op_sel_hi:[1,1,1]
 v_pk_fma_f32 v[138:139], v[58:59], v[86:87], v[138:139] op_sel:[0,1,0] op_sel_hi:[1,1,1]
 v_pk_mul_f32 v[140:141], v[132:133], v[132:133]
 v_pk_mul_f32 v[142:143], v[134:135], v[134:135]
 v_pk_mul_f32 v[144:145], v[136:137], v[136:137]
 v_pk_mul_f32 v[146:147], v[138:139], v[138:139]
 v_pk_fma_f32 v[140:141], v[140:141], v[80:81], v[80:81] op_sel:[0,1,0] op_sel_hi:[1,1,0]
 v_pk_fma_f32 v[142:143], v[142:143], v[80:81], v[80:81] op_sel:[0,1,0] op_sel_hi:[1,1,0]
 v_pk_fma_f32 v[144:145], v[144:145], v[80:81], v[80:81] op_sel:[0,1,0] op_sel_hi:[1,1,0]
 v_pk_fma_f32 v[146:147], v[146:147], v[80:81], v[80:81] op_sel:[0,1,0] op_sel_hi:[1,1,0]
 v_pk_mul_f32 v[140:141], v[140:141], v[132:133]
 v_pk_mul_f32 v[142:143], v[142:143], v[134:135]
 v_pk_mul_f32 v[144:145], v[144:145], v[136:137]
 v_pk_mul_f32 v[146:147], v[146:147], v[138:139]
 v_exp_f32 v140, v140
 v_exp_f32 v141, v141
 v_exp_f32 v142, v142
 v_exp_f32 v143, v143
 v_exp_f32 v144, v144
 v_exp_f32 v145, v145
 v_exp_f32 v146, v146
 v_exp_f32 v147, v147
 v_pk_add_f32 v[140:141], v[140:141], v[82:83]
 v_pk_add_f32 v[142:143], v[142:143], v[82:83]
 v_pk_add_f32 v[144:145], v[144:145], v[82:83]
 v_pk_add_f32 v[146:147], v[146:147], v[82:83]
 v_rcp_f32 v140, v140
 v_rcp_f32 v141, v141
 v_rcp_f32 v142, v142
 v_rcp_f32 v143, v143
 v_rcp_f32 v144, v144
 v_rcp_f32 v145, v145
 v_rcp_f32 v146, v146
 v_rcp_f32 v147, v147
 v_pk_mul_f32 v[140:141], v[140:141], v[132:133]
 v_pk_mul_f32 v[142:143], v[142:143], v[134:135]
 v_pk_mul_f32 v[144:145], v[144:145], v[136:137]
 v_pk_mul_f32 v[146:147], v[146:147], v[138:139]
 v_cvt_pk_bf16_f32 v148, v140, v141
 v_cvt_pk_bf16_f32 v149, v142, v143
 v_cvt_pk_bf16_f32 v150, v144, v145
 v_cvt_pk_bf16_f32 v151, v146, v147
 s_nop 0
 v_permlane16_swap_b32 v148, v150
 v_permlane16_swap_b32 v149, v151
 buffer_store_dwordx4 v[148:151], v198, s[4:7], s29 offen offset:0
 v_pk_fma_f32 v[108:109], v[184:185], v[88:89], v[72:73] op_sel:[0,0,0] op_sel_hi:[1,0,1] neg_lo:[0,1,0] neg_hi:[0,1,0]
 v_pk_fma_f32 v[110:111], v[186:187], v[88:89], v[74:75] op_sel:[0,0,0] op_sel_hi:[1,0,1] neg_lo:[0,1,0] neg_hi:[0,1,0]
 v_pk_fma_f32 v[112:113], v[184:185], v[88:89], v[72:73] op_sel:[0,1,0] op_sel_hi:[1,1,1] neg_lo:[0,1,0] neg_hi:[0,1,0]
 v_pk_fma_f32 v[114:115], v[186:187], v[88:89], v[74:75] op_sel:[0,1,0] op_sel_hi:[1,1,1] neg_lo:[0,1,0] neg_hi:[0,1,0]
 v_pk_fma_f32 v[108:109], v[24:25], v[84:85], v[108:109] op_sel:[0,0,0] op_sel_hi:[1,0,1]
 v_pk_fma_f32 v[110:111], v[26:27], v[84:85], v[110:111] op_sel:[0,0,0] op_sel_hi:[1,0,1]
 v_pk_fma_f32 v[112:113], v[36:37], v[84:85], v[112:113] op_sel:[0,1,0] op_sel_hi:[1,1,1]
 v_pk_fma_f32 v[114:115], v[38:39], v[84:85], v[114:115] op_sel:[0,1,0] op_sel_hi:[1,1,1]
 v_pk_mul_f32 v[116:117], v[108:109], v[108:109]
 v_pk_mul_f32 v[118:119], v[110:111], v[110:111]
 v_pk_mul_f32 v[120:121], v[112:113], v[112:113]
 v_pk_mul_f32 v[122:123], v[114:115], v[114:115]
 v_pk_fma_f32 v[116:117], v[116:117], v[80:81], v[80:81] op_sel:[0,1,0] op_sel_hi:[1,1,0]
 v_pk_fma_f32 v[118:119], v[118:119], v[80:81], v[80:81] op_sel:[0,1,0] op_sel_hi:[1,1,0]
 v_pk_fma_f32 v[120:121], v[120:121], v[80:81], v[80:81] op_sel:[0,1,0] op_sel_hi:[1,1,0]
 v_pk_fma_f32 v[122:123], v[122:123], v[80:81], v[80:81] op_sel:[0,1,0] op_sel_hi:[1,1,0]
 v_pk_mul_f32 v[116:117], v[116:117], v[108:109]
 v_pk_mul_f32 v[118:119], v[118:119], v[110:111]
 v_pk_mul_f32 v[120:121], v[120:121], v[112:113]
 v_pk_mul_f32 v[122:123], v[122:123], v[114:115]
 v_exp_f32 v116, v116
 v_exp_f32 v117, v117
 v_exp_f32 v118, v118
 v_exp_f32 v119, v119
 v_exp_f32 v120, v120
 v_exp_f32 v121, v121
 v_exp_f32 v122, v122
 v_exp_f32 v123, v123
 v_pk_add_f32 v[116:117], v[116:117], v[82:83]
 v_pk_add_f32 v[118:119], v[118:119], v[82:83]
 v_pk_add_f32 v[120:121], v[120:121], v[82:83]
 v_pk_add_f32 v[122:123], v[122:123], v[82:83]
 v_rcp_f32 v116, v116
 v_rcp_f32 v117, v117
 v_rcp_f32 v118, v118
 v_rcp_f32 v119, v119
 v_rcp_f32 v120, v120
 v_rcp_f32 v121, v121
 v_rcp_f32 v122, v122
 v_rcp_f32 v123, v123
 v_pk_mul_f32 v[116:117], v[116:117], v[108:109]
 v_pk_mul_f32 v[118:119], v[118:119], v[110:111]
 v_pk_mul_f32 v[120:121], v[120:121], v[112:113]
 v_pk_mul_f32 v[122:123], v[122:123], v[114:115]
 v_cvt_pk_bf16_f32 v124, v116, v117
 v_cvt_pk_bf16_f32 v125, v118, v119
 v_cvt_pk_bf16_f32 v126, v120, v121
 v_cvt_pk_bf16_f32 v127, v122, v123
 s_nop 0
 v_permlane16_swap_b32 v124, v126
 v_permlane16_swap_b32 v125, v127
 buffer_store_dwordx4 v[124:127], v198, s[4:7], s30 offen offset:512
 v_pk_fma_f32 v[132:133], v[184:185], v[90:91], v[72:73] op_sel:[0,0,0] op_sel_hi:[1,0,1] neg_lo:[0,1,0] neg_hi:[0,1,0]
 v_pk_fma_f32 v[134:135], v[186:187], v[90:91], v[74:75] op_sel:[0,0,0] op_sel_hi:[1,0,1] neg_lo:[0,1,0] neg_hi:[0,1,0]
 v_pk_fma_f32 v[136:137], v[184:185], v[90:91], v[72:73] op_sel:[0,1,0] op_sel_hi:[1,1,1] neg_lo:[0,1,0] neg_hi:[0,1,0]
 v_pk_fma_f32 v[138:139], v[186:187], v[90:91], v[74:75] op_sel:[0,1,0] op_sel_hi:[1,1,1] neg_lo:[0,1,0] neg_hi:[0,1,0]
 v_pk_fma_f32 v[132:133], v[48:49], v[86:87], v[132:133] op_sel:[0,0,0] op_sel_hi:[1,0,1]
 v_pk_fma_f32 v[134:135], v[50:51], v[86:87], v[134:135] op_sel:[0,0,0] op_sel_hi:[1,0,1]
 v_pk_fma_f32 v[136:137], v[60:61], v[86:87], v[136:137] op_sel:[0,1,0] op_sel_hi:[1,1,1]
 v_pk_fma_f32 v[138:139], v[62:63], v[86:87], v[138:139] op_sel:[0,1,0] op_sel_hi:[1,1,1]
 v_pk_mul_f32 v[140:141], v[132:133], v[132:133]
 v_pk_mul_f32 v[142:143], v[134:135], v[134:135]
 v_pk_mul_f32 v[144:145], v[136:137], v[136:137]
 v_pk_mul_f32 v[146:147], v[138:139], v[138:139]
 v_pk_fma_f32 v[140:141], v[140:141], v[80:81], v[80:81] op_sel:[0,1,0] op_sel_hi:[1,1,0]
 v_pk_fma_f32 v[142:143], v[142:143], v[80:81], v[80:81] op_sel:[0,1,0] op_sel_hi:[1,1,0]
 v_pk_fma_f32 v[144:145], v[144:145], v[80:81], v[80:81] op_sel:[0,1,0] op_sel_hi:[1,1,0]
 v_pk_fma_f32 v[146:147], v[146:147], v[80:81], v[80:81] op_sel:[0,1,0] op_sel_hi:[1,1,0]
 v_pk_mul_f32 v[140:141], v[140:141], v[132:133]
 v_pk_mul_f32 v[142:143], v[142:143], v[134:135]
 v_pk_mul_f32 v[144:145], v[144:145], v[136:137]
 v_pk_mul_f32 v[146:147], v[146:147], v[138:139]
 v_exp_f32 v140, v140
 v_exp_f32 v141, v141
 v_exp_f32 v142, v142
 v_exp_f32 v143, v143
 v_exp_f32 v144, v144
 v_exp_f32 v145, v145
 v_exp_f32 v146, v146
 v_exp_f32 v147, v147
 v_pk_add_f32 v[140:141], v[140:141], v[82:83]
 v_pk_add_f32 v[142:143], v[142:143], v[82:83]
 v_pk_add_f32 v[144:145], v[144:145], v[82:83]
 v_pk_add_f32 v[146:147], v[146:147], v[82:83]
 v_rcp_f32 v140, v140
 v_rcp_f32 v141, v141
 v_rcp_f32 v142, v142
 v_rcp_f32 v143, v143
 v_rcp_f32 v144, v144
 v_rcp_f32 v145, v145
 v_rcp_f32 v146, v146
 v_rcp_f32 v147, v147
 v_pk_mul_f32 v[140:141], v[140:141], v[132:133]
 v_pk_mul_f32 v[142:143], v[142:143], v[134:135]
 v_pk_mul_f32 v[144:145], v[144:145], v[136:137]
 v_pk_mul_f32 v[146:147], v[146:147], v[138:139]
 v_cvt_pk_bf16_f32 v148, v140, v141
 v_cvt_pk_bf16_f32 v149, v142, v143
 v_cvt_pk_bf16_f32 v150, v144, v145
 v_cvt_pk_bf16_f32 v151, v146, v147
 s_nop 0
 v_permlane16_swap_b32 v148, v150
 v_permlane16_swap_b32 v149, v151
 buffer_store_dwordx4 v[148:151], v198, s[4:7], s29 offen offset:512
 v_pk_fma_f32 v[108:109], v[188:189], v[88:89], v[76:77] op_sel:[0,0,0] op_sel_hi:[1,0,1] neg_lo:[0,1,0] neg_hi:[0,1,0]
 v_pk_fma_f32 v[110:111], v[190:191], v[88:89], v[78:79] op_sel:[0,0,0] op_sel_hi:[1,0,1] neg_lo:[0,1,0] neg_hi:[0,1,0]
 v_pk_fma_f32 v[112:113], v[188:189], v[88:89], v[76:77] op_sel:[0,1,0] op_sel_hi:[1,1,1] neg_lo:[0,1,0] neg_hi:[0,1,0]
 v_pk_fma_f32 v[114:115], v[190:191], v[88:89], v[78:79] op_sel:[0,1,0] op_sel_hi:[1,1,1] neg_lo:[0,1,0] neg_hi:[0,1,0]
 v_pk_fma_f32 v[108:109], v[28:29], v[84:85], v[108:109] op_sel:[0,0,0] op_sel_hi:[1,0,1]
 v_pk_fma_f32 v[110:111], v[30:31], v[84:85], v[110:111] op_sel:[0,0,0] op_sel_hi:[1,0,1]
 v_pk_fma_f32 v[112:113], v[40:41], v[84:85], v[112:113] op_sel:[0,1,0] op_sel_hi:[1,1,1]
 v_pk_fma_f32 v[114:115], v[42:43], v[84:85], v[114:115] op_sel:[0,1,0] op_sel_hi:[1,1,1]
 v_pk_mul_f32 v[116:117], v[108:109], v[108:109]
 v_pk_mul_f32 v[118:119], v[110:111], v[110:111]
 v_pk_mul_f32 v[120:121], v[112:113], v[112:113]
 v_pk_mul_f32 v[122:123], v[114:115], v[114:115]
 v_pk_fma_f32 v[116:117], v[116:117], v[80:81], v[80:81] op_sel:[0,1,0] op_sel_hi:[1,1,0]
 v_pk_fma_f32 v[118:119], v[118:119], v[80:81], v[80:81] op_sel:[0,1,0] op_sel_hi:[1,1,0]
 v_pk_fma_f32 v[120:121], v[120:121], v[80:81], v[80:81] op_sel:[0,1,0] op_sel_hi:[1,1,0]
 v_pk_fma_f32 v[122:123], v[122:123], v[80:81], v[80:81] op_sel:[0,1,0] op_sel_hi:[1,1,0]
 v_pk_mul_f32 v[116:117], v[116:117], v[108:109]
 v_pk_mul_f32 v[118:119], v[118:119], v[110:111]
 v_pk_mul_f32 v[120:121], v[120:121], v[112:113]
 v_pk_mul_f32 v[122:123], v[122:123], v[114:115]
 v_exp_f32 v116, v116
 v_exp_f32 v117, v117
 v_exp_f32 v118, v118
 v_exp_f32 v119, v119
 v_exp_f32 v120, v120
 v_exp_f32 v121, v121
 v_exp_f32 v122, v122
 v_exp_f32 v123, v123
 v_pk_add_f32 v[116:117], v[116:117], v[82:83]
 v_pk_add_f32 v[118:119], v[118:119], v[82:83]
 v_pk_add_f32 v[120:121], v[120:121], v[82:83]
 v_pk_add_f32 v[122:123], v[122:123], v[82:83]
 v_rcp_f32 v116, v116
 v_rcp_f32 v117, v117
 v_rcp_f32 v118, v118
 v_rcp_f32 v119, v119
 v_rcp_f32 v120, v120
 v_rcp_f32 v121, v121
 v_rcp_f32 v122, v122
 v_rcp_f32 v123, v123
 v_pk_mul_f32 v[116:117], v[116:117], v[108:109]
 v_pk_mul_f32 v[118:119], v[118:119], v[110:111]
 v_pk_mul_f32 v[120:121], v[120:121], v[112:113]
 v_pk_mul_f32 v[122:123], v[122:123], v[114:115]
 v_cvt_pk_bf16_f32 v124, v116, v117
 v_cvt_pk_bf16_f32 v125, v118, v119
 v_cvt_pk_bf16_f32 v126, v120, v121
 v_cvt_pk_bf16_f32 v127, v122, v123
 s_nop 0
 v_permlane16_swap_b32 v124, v126
 v_permlane16_swap_b32 v125, v127
 buffer_store_dwordx4 v[124:127], v198, s[4:7], s30 offen offset:1024
 v_pk_fma_f32 v[132:133], v[188:189], v[90:91], v[76:77] op_sel:[0,0,0] op_sel_hi:[1,0,1] neg_lo:[0,1,0] neg_hi:[0,1,0]
 v_pk_fma_f32 v[134:135], v[190:191], v[90:91], v[78:79] op_sel:[0,0,0] op_sel_hi:[1,0,1] neg_lo:[0,1,0] neg_hi:[0,1,0]
 v_pk_fma_f32 v[136:137], v[188:189], v[90:91], v[76:77] op_sel:[0,1,0] op_sel_hi:[1,1,1] neg_lo:[0,1,0] neg_hi:[0,1,0]
 v_pk_fma_f32 v[138:139], v[190:191], v[90:91], v[78:79] op_sel:[0,1,0] op_sel_hi:[1,1,1] neg_lo:[0,1,0] neg_hi:[0,1,0]
 v_pk_fma_f32 v[132:133], v[52:53], v[86:87], v[132:133] op_sel:[0,0,0] op_sel_hi:[1,0,1]
 v_pk_fma_f32 v[134:135], v[54:55], v[86:87], v[134:135] op_sel:[0,0,0] op_sel_hi:[1,0,1]
 v_pk_fma_f32 v[136:137], v[64:65], v[86:87], v[136:137] op_sel:[0,1,0] op_sel_hi:[1,1,1]
 v_pk_fma_f32 v[138:139], v[66:67], v[86:87], v[138:139] op_sel:[0,1,0] op_sel_hi:[1,1,1]
 v_pk_mul_f32 v[140:141], v[132:133], v[132:133]
 v_pk_mul_f32 v[142:143], v[134:135], v[134:135]
 v_pk_mul_f32 v[144:145], v[136:137], v[136:137]
 v_pk_mul_f32 v[146:147], v[138:139], v[138:139]
 v_pk_fma_f32 v[140:141], v[140:141], v[80:81], v[80:81] op_sel:[0,1,0] op_sel_hi:[1,1,0]
 v_pk_fma_f32 v[142:143], v[142:143], v[80:81], v[80:81] op_sel:[0,1,0] op_sel_hi:[1,1,0]
 v_pk_fma_f32 v[144:145], v[144:145], v[80:81], v[80:81] op_sel:[0,1,0] op_sel_hi:[1,1,0]
 v_pk_fma_f32 v[146:147], v[146:147], v[80:81], v[80:81] op_sel:[0,1,0] op_sel_hi:[1,1,0]
 v_pk_mul_f32 v[140:141], v[140:141], v[132:133]
 v_pk_mul_f32 v[142:143], v[142:143], v[134:135]
 v_pk_mul_f32 v[144:145], v[144:145], v[136:137]
 v_pk_mul_f32 v[146:147], v[146:147], v[138:139]
 v_exp_f32 v140, v140
 v_exp_f32 v141, v141
 v_exp_f32 v142, v142
 v_exp_f32 v143, v143
 v_exp_f32 v144, v144
 v_exp_f32 v145, v145
 v_exp_f32 v146, v146
 v_exp_f32 v147, v147
 v_pk_add_f32 v[140:141], v[140:141], v[82:83]
 v_pk_add_f32 v[142:143], v[142:143], v[82:83]
 v_pk_add_f32 v[144:145], v[144:145], v[82:83]
 v_pk_add_f32 v[146:147], v[146:147], v[82:83]
 v_rcp_f32 v140, v140
 v_rcp_f32 v141, v141
 v_rcp_f32 v142, v142
 v_rcp_f32 v143, v143
 v_rcp_f32 v144, v144
 v_rcp_f32 v145, v145
 v_rcp_f32 v146, v146
 v_rcp_f32 v147, v147
 v_pk_mul_f32 v[140:141], v[140:141], v[132:133]
 v_pk_mul_f32 v[142:143], v[142:143], v[134:135]
 v_pk_mul_f32 v[144:145], v[144:145], v[136:137]
 v_pk_mul_f32 v[146:147], v[146:147], v[138:139]
 v_cvt_pk_bf16_f32 v148, v140, v141
 v_cvt_pk_bf16_f32 v149, v142, v143
 v_cvt_pk_bf16_f32 v150, v144, v145
 v_cvt_pk_bf16_f32 v151, v146, v147
 s_nop 0
 v_permlane16_swap_b32 v148, v150
 v_permlane16_swap_b32 v149, v151
 buffer_store_dwordx4 v[148:151], v198, s[4:7], s29 offen offset:1024
 s_lshl_b32 s23, s21, 7
 s_lshl_b32 s24, s22, 4
 s_add_u32 s23, s23, s24
 s_lshl_b32 s24, s20, 2
 s_add_u32 s23, s23, s24
 s_add_u32 s23, s23, 0x6e9000
 v_mov_b32 v8, 0
 v_mov_b32 v9, 1
 s_mov_b64 exec, 1
 s_waitcnt vmcnt(0)
 buffer_store_dword v9, v8, s[4:7], s23 offen
 s_mov_b64 exec, -1
C1_e1_join:
 v_lshlrev_b32 v3, 4, v1
 s_lshl_b32 s23, s20, 11
 v_add_u32 v2, s23, v3
 v_add_u32 v3, 49152, v3
 v_add_u32 v4, 0x10000, v3
 s_lshl_b32 s30, s21, 2
 s_add_u32 s30, s30, s20
 s_mul_i32 s30, s30, 20480
 s_mul_i32 s23, s22, 2560
 s_add_u32 s30, s30, s23
 v_lshrrev_b32 v8, 4, v1
 v_lshlrev_b32 v8, 3, v8
 s_mul_i32 s24, s22, 160
 buffer_load_dwordx2 v[180:181], v8, s[12:15], s24 offen offset:0
 buffer_load_dwordx2 v[182:183], v8, s[12:15], s24 offen offset:32
 buffer_load_dwordx2 v[184:185], v8, s[12:15], s24 offen offset:64
 buffer_load_dwordx2 v[186:187], v8, s[12:15], s24 offen offset:96
 buffer_load_dwordx2 v[188:189], v8, s[12:15], s24 offen offset:128
 v_lshlrev_b32 v20, 16, v10
 v_and_b32 v21, 0xffff0000, v10
 v_lshlrev_b32 v22, 16, v11
 v_and_b32 v23, 0xffff0000, v11
 v_lshlrev_b32 v24, 16, v12
 v_and_b32 v25, 0xffff0000, v12
 v_lshlrev_b32 v26, 16, v13
 v_and_b32 v27, 0xffff0000, v13
 v_lshlrev_b32 v28, 16, v14
 v_and_b32 v29, 0xffff0000, v14
 v_lshlrev_b32 v30, 16, v15
 v_and_b32 v31, 0xffff0000, v15
 v_lshlrev_b32 v32, 16, v16
 v_and_b32 v33, 0xffff0000, v16
 v_lshlrev_b32 v34, 16, v17
 v_and_b32 v35, 0xffff0000, v17
 v_lshlrev_b32 v36, 16, v18
 v_and_b32 v37, 0xffff0000, v18
 v_lshlrev_b32 v38, 16, v19
 v_and_b32 v39, 0xffff0000, v19
 s_waitcnt vmcnt(0)
 v_lshlrev_b32 v204, 16, v180
 v_and_b32 v205, 0xffff0000, v180
 v_lshlrev_b32 v206, 16, v181
 v_and_b32 v207, 0xffff0000, v181
 v_lshlrev_b32 v208, 16, v182
 v_and_b32 v209, 0xffff0000, v182
 v_lshlrev_b32 v210, 16, v183
 v_and_b32 v211, 0xffff0000, v183
 v_lshlrev_b32 v212, 16, v184
 v_and_b32 v213, 0xffff0000, v184
 v_lshlrev_b32 v214, 16, v185
 v_and_b32 v215, 0xffff0000, v185
 v_lshlrev_b32 v216, 16, v186
 v_and_b32 v217, 0xffff0000, v186
 v_lshlrev_b32 v218, 16, v187
 v_and_b32 v219, 0xffff0000, v187
 v_lshlrev_b32 v220, 16, v188
 v_and_b32 v221, 0xffff0000, v188
 v_lshlrev_b32 v222, 16, v189
 v_and_b32 v223, 0xffff0000, v189
 v_pk_add_f32 v[20:21], v[20:21], v[204:205]
 v_pk_add_f32 v[22:23], v[22:23], v[206:207]
 v_pk_add_f32 v[24:25], v[24:25], v[208:209]
 v_pk_add_f32 v[26:27], v[26:27], v[210:211]
 v_pk_add_f32 v[28:29], v[28:29], v[212:213]
 v_pk_add_f32 v[30:31], v[30:31], v[214:215]
 v_pk_add_f32 v[32:33], v[32:33], v[216:217]
 v_pk_add_f32 v[34:35], v[34:35], v[218:219]
 v_pk_add_f32 v[36:37], v[36:37], v[220:221]
 v_pk_add_f32 v[38:39], v[38:39], v[222:223]
 s_lshl_b32 s26, s21, 2
 s_add_u32 s26, s26, s20
 s_lshl_b32 s26, s26, 10
 s_lshr_b32 s23, s22, 1
 s_lshl_b32 s23, s23, 8
 s_add_u32 s26, s26, s23
 s_and_b32 s23, s22, 1
 s_lshl_b32 s23, s23, 3
 s_add_u32 s26, s26, s23
 s_add_u32 s26, s26, 0x1132000
 v_and_b32 v70, 15, v1
 v_lshlrev_b32 v70, 4, v70
 s_barrier
 ds_read_b128 v[104:107], v2 offset:0
 ds_read_b128 v[84:87], v3 offset:25600
 ds_read_b128 v[88:91], v3 offset:26624
 ds_read_b128 v[92:95], v3 offset:27648
 ds_read_b128 v[96:99], v3 offset:28672
 ds_read_b128 v[100:103], v3 offset:29696
 ds_read_b128 v[128:131], v2 offset:1024
 ds_read_b128 v[108:111], v3 offset:30720
 ds_read_b128 v[112:115], v3 offset:31744
 ds_read_b128 v[116:119], v3 offset:32768
 ds_read_b128 v[120:123], v3 offset:33792
 ds_read_b128 v[124:127], v3 offset:34816
 s_waitcnt lgkmcnt(6)
 v_mfma_f32_16x16x32_bf16 v[20:23], v[84:87], v[104:107], v[20:23]
 s_barrier
 ds_read_b128 v[152:155], v2 offset:8192
 ds_read_b128 v[132:135], v3 offset:35840
 v_mfma_f32_16x16x32_bf16 v[24:27], v[88:91], v[104:107], v[24:27]
 ds_read_b128 v[136:139], v3 offset:36864
 v_mfma_f32_16x16x32_bf16 v[28:31], v[92:95], v[104:107], v[28:31]
 ds_read_b128 v[140:143], v3 offset:37888
 v_mfma_f32_16x16x32_bf16 v[32:35], v[96:99], v[104:107], v[32:35]
 ds_read_b128 v[144:147], v3 offset:38912
 v_mfma_f32_16x16x32_bf16 v[36:39], v[100:103], v[104:107], v[36:39]
 ds_read_b128 v[148:151], v3 offset:39936
 s_waitcnt lgkmcnt(6)
 v_mfma_f32_16x16x32_bf16 v[20:23], v[108:111], v[128:131], v[20:23]
 ds_read_b128 v[176:179], v2 offset:9216
 ds_read_b128 v[156:159], v3 offset:40960
 v_mfma_f32_16x16x32_bf16 v[24:27], v[112:115], v[128:131], v[24:27]
 ds_read_b128 v[160:163], v3 offset:41984
 v_mfma_f32_16x16x32_bf16 v[28:31], v[116:119], v[128:131], v[28:31]
 ds_read_b128 v[164:167], v3 offset:43008
 v_mfma_f32_16x16x32_bf16 v[32:35], v[120:123], v[128:131], v[32:35]
 ds_read_b128 v[168:171], v3 offset:44032
 v_mfma_f32_16x16x32_bf16 v[36:39], v[124:127], v[128:131], v[36:39]
 ds_read_b128 v[172:175], v3 offset:45056
 s_waitcnt lgkmcnt(6)
 v_mfma_f32_16x16x32_bf16 v[20:23], v[132:135], v[152:155], v[20:23]
 s_barrier
 ds_read_b128 v[104:107], v2 offset:16384
 ds_read_b128 v[84:87], v3 offset:46080
 v_mfma_f32_16x16x32_bf16 v[24:27], v[136:139], v[152:155], v[24:27]
 ds_read_b128 v[88:91], v3 offset:47104
 v_mfma_f32_16x16x32_bf16 v[28:31], v[140:143], v[152:155], v[28:31]
 ds_read_b128 v[92:95], v3 offset:48128
 v_mfma_f32_16x16x32_bf16 v[32:35], v[144:147], v[152:155], v[32:35]
 ds_read_b128 v[96:99], v3 offset:49152
 v_mfma_f32_16x16x32_bf16 v[36:39], v[148:151], v[152:155], v[36:39]
 ds_read_b128 v[100:103], v3 offset:50176
 s_waitcnt lgkmcnt(6)
 v_mfma_f32_16x16x32_bf16 v[20:23], v[156:159], v[176:179], v[20:23]
 ds_read_b128 v[128:131], v2 offset:17408
 ds_read_b128 v[108:111], v3 offset:51200
 v_mfma_f32_16x16x32_bf16 v[24:27], v[160:163], v[176:179], v[24:27]
 ds_read_b128 v[112:115], v3 offset:52224
 v_mfma_f32_16x16x32_bf16 v[28:31], v[164:167], v[176:179], v[28:31]
 ds_read_b128 v[116:119], v3 offset:53248
 v_mfma_f32_16x16x32_bf16 v[32:35], v[168:171], v[176:179], v[32:35]
 ds_read_b128 v[120:123], v3 offset:54272
 v_mfma_f32_16x16x32_bf16 v[36:39], v[172:175], v[176:179], v[36:39]
 ds_read_b128 v[124:127], v3 offset:55296
 s_waitcnt lgkmcnt(6)
 v_mfma_f32_16x16x32_bf16 v[20:23], v[84:87], v[104:107], v[20:23]
 s_barrier
 ds_read_b128 v[152:155], v2 offset:24576
 ds_read_b128 v[132:135], v3 offset:56320
 v_mfma_f32_16x16x32_bf16 v[24:27], v[88:91], v[104:107], v[24:27]
 ds_read_b128 v[136:139], v3 offset:57344
 v_mfma_f32_16x16x32_bf16 v[28:31], v[92:95], v[104:107], v[28:31]
 ds_read_b128 v[140:143], v3 offset:58368
 v_mfma_f32_16x16x32_bf16 v[32:35], v[96:99], v[104:107], v[32:35]
 ds_read_b128 v[144:147], v3 offset:59392
 v_mfma_f32_16x16x32_bf16 v[36:39], v[100:103], v[104:107], v[36:39]
 ds_read_b128 v[148:151], v3 offset:60416
 s_waitcnt lgkmcnt(6)
 v_mfma_f32_16x16x32_bf16 v[20:23], v[108:111], v[128:131], v[20:23]
 ds_read_b128 v[176:179], v2 offset:25600
 ds_read_b128 v[156:159], v3 offset:61440
 v_mfma_f32_16x16x32_bf16 v[24:27], v[112:115], v[128:131], v[24:27]
 ds_read_b128 v[160:163], v3 offset:62464
 v_mfma_f32_16x16x32_bf16 v[28:31], v[116:119], v[128:131], v[28:31]
 ds_read_b128 v[164:167], v3 offset:63488
 v_mfma_f32_16x16x32_bf16 v[32:35], v[120:123], v[128:131], v[32:35]
 ds_read_b128 v[168:171], v3 offset:64512
 v_mfma_f32_16x16x32_bf16 v[36:39], v[124:127], v[128:131], v[36:39]
 ds_read_b128 v[172:175], v4 offset:0
 s_waitcnt lgkmcnt(6)
 v_mfma_f32_16x16x32_bf16 v[20:23], v[132:135], v[152:155], v[20:23]
 s_barrier
 ds_read_b128 v[104:107], v2 offset:32768
 ds_read_b128 v[84:87], v4 offset:1024
 v_mfma_f32_16x16x32_bf16 v[24:27], v[136:139], v[152:155], v[24:27]
 ds_read_b128 v[88:91], v4 offset:2048
 v_mfma_f32_16x16x32_bf16 v[28:31], v[140:143], v[152:155], v[28:31]
 ds_read_b128 v[92:95], v4 offset:3072
 v_mfma_f32_16x16x32_bf16 v[32:35], v[144:147], v[152:155], v[32:35]
 ds_read_b128 v[96:99], v4 offset:4096
 v_mfma_f32_16x16x32_bf16 v[36:39], v[148:151], v[152:155], v[36:39]
 ds_read_b128 v[100:103], v4 offset:5120
 s_waitcnt lgkmcnt(6)
 v_mfma_f32_16x16x32_bf16 v[20:23], v[156:159], v[176:179], v[20:23]
 ds_read_b128 v[128:131], v2 offset:33792
 ds_read_b128 v[108:111], v4 offset:6144
 v_mfma_f32_16x16x32_bf16 v[24:27], v[160:163], v[176:179], v[24:27]
 ds_read_b128 v[112:115], v4 offset:7168
 v_mfma_f32_16x16x32_bf16 v[28:31], v[164:167], v[176:179], v[28:31]
 ds_read_b128 v[116:119], v4 offset:8192
 v_mfma_f32_16x16x32_bf16 v[32:35], v[168:171], v[176:179], v[32:35]
 ds_read_b128 v[120:123], v4 offset:9216
 v_mfma_f32_16x16x32_bf16 v[36:39], v[172:175], v[176:179], v[36:39]
 ds_read_b128 v[124:127], v4 offset:10240
 s_waitcnt lgkmcnt(6)
 v_mfma_f32_16x16x32_bf16 v[20:23], v[84:87], v[104:107], v[20:23]
 s_barrier
 ds_read_b128 v[152:155], v2 offset:40960
 ds_read_b128 v[132:135], v4 offset:11264
 v_mfma_f32_16x16x32_bf16 v[24:27], v[88:91], v[104:107], v[24:27]
 ds_read_b128 v[136:139], v4 offset:12288
 v_mfma_f32_16x16x32_bf16 v[28:31], v[92:95], v[104:107], v[28:31]
 ds_read_b128 v[140:143], v4 offset:13312
 v_mfma_f32_16x16x32_bf16 v[32:35], v[96:99], v[104:107], v[32:35]
 ds_read_b128 v[144:147], v4 offset:14336
 v_mfma_f32_16x16x32_bf16 v[36:39], v[100:103], v[104:107], v[36:39]
 ds_read_b128 v[148:151], v4 offset:15360
 s_waitcnt lgkmcnt(6)
 v_mfma_f32_16x16x32_bf16 v[20:23], v[108:111], v[128:131], v[20:23]
 ds_read_b128 v[176:179], v2 offset:41984
 ds_read_b128 v[156:159], v4 offset:16384
 v_mfma_f32_16x16x32_bf16 v[24:27], v[112:115], v[128:131], v[24:27]
 ds_read_b128 v[160:163], v4 offset:17408
 v_mfma_f32_16x16x32_bf16 v[28:31], v[116:119], v[128:131], v[28:31]
 ds_read_b128 v[164:167], v4 offset:18432
 v_mfma_f32_16x16x32_bf16 v[32:35], v[120:123], v[128:131], v[32:35]
 ds_read_b128 v[168:171], v4 offset:19456
 v_mfma_f32_16x16x32_bf16 v[36:39], v[124:127], v[128:131], v[36:39]
 ds_read_b128 v[172:175], v4 offset:20480
 s_waitcnt lgkmcnt(6)
 v_mfma_f32_16x16x32_bf16 v[20:23], v[132:135], v[152:155], v[20:23]
 s_barrier
 ds_read_b128 v[104:107], v2 offset:0
 ds_read_b128 v[84:87], v4 offset:21504
 v_mfma_f32_16x16x32_bf16 v[24:27], v[136:139], v[152:155], v[24:27]
 ds_read_b128 v[88:91], v4 offset:22528
 v_mfma_f32_16x16x32_bf16 v[28:31], v[140:143], v[152:155], v[28:31]
 ds_read_b128 v[92:95], v4 offset:23552
 v_mfma_f32_16x16x32_bf16 v[32:35], v[144:147], v[152:155], v[32:35]
 ds_read_b128 v[96:99], v4 offset:24576
 v_mfma_f32_16x16x32_bf16 v[36:39], v[148:151], v[152:155], v[36:39]
 ds_read_b128 v[100:103], v4 offset:25600
 s_waitcnt lgkmcnt(6)
 v_mfma_f32_16x16x32_bf16 v[20:23], v[156:159], v[176:179], v[20:23]
 ds_read_b128 v[128:131], v2 offset:1024
 ds_read_b128 v[108:111], v4 offset:26624
 v_mfma_f32_16x16x32_bf16 v[24:27], v[160:163], v[176:179], v[24:27]
 ds_read_b128 v[112:115], v4 offset:27648
 v_mfma_f32_16x16x32_bf16 v[28:31], v[164:167], v[176:179], v[28:31]
 ds_read_b128 v[116:119], v4 offset:28672
 v_mfma_f32_16x16x32_bf16 v[32:35], v[168:171], v[176:179], v[32:35]
 ds_read_b128 v[120:123], v4 offset:29696
 v_mfma_f32_16x16x32_bf16 v[36:39], v[172:175], v[176:179], v[36:39]
 ds_read_b128 v[124:127], v4 offset:30720
 s_waitcnt lgkmcnt(6)
 v_mfma_f32_16x16x32_bf16 v[20:23], v[84:87], v[104:107], v[20:23]
 s_barrier
 ds_read_b128 v[152:155], v2 offset:8192
 ds_read_b128 v[132:135], v4 offset:31744
 v_mfma_f32_16x16x32_bf16 v[24:27], v[88:91], v[104:107], v[24:27]
 ds_read_b128 v[136:139], v4 offset:32768
 v_mfma_f32_16x16x32_bf16 v[28:31], v[92:95], v[104:107], v[28:31]
 ds_read_b128 v[140:143], v4 offset:33792
 v_mfma_f32_16x16x32_bf16 v[32:35], v[96:99], v[104:107], v[32:35]
 ds_read_b128 v[144:147], v4 offset:34816
 v_mfma_f32_16x16x32_bf16 v[36:39], v[100:103], v[104:107], v[36:39]
 ds_read_b128 v[148:151], v4 offset:35840
 s_waitcnt lgkmcnt(6)
 v_mfma_f32_16x16x32_bf16 v[20:23], v[108:111], v[128:131], v[20:23]
 ds_read_b128 v[176:179], v2 offset:9216
 ds_read_b128 v[156:159], v4 offset:36864
 v_mfma_f32_16x16x32_bf16 v[24:27], v[112:115], v[128:131], v[24:27]
 ds_read_b128 v[160:163], v4 offset:37888
 v_mfma_f32_16x16x32_bf16 v[28:31], v[116:119], v[128:131], v[28:31]
 ds_read_b128 v[164:167], v4 offset:38912
 v_mfma_f32_16x16x32_bf16 v[32:35], v[120:123], v[128:131], v[32:35]
 ds_read_b128 v[168:171], v4 offset:39936
 v_mfma_f32_16x16x32_bf16 v[36:39], v[124:127], v[128:131], v[36:39]
 ds_read_b128 v[172:175], v4 offset:40960
 s_waitcnt lgkmcnt(6)
 v_mfma_f32_16x16x32_bf16 v[20:23], v[132:135], v[152:155], v[20:23]
 s_barrier
 ds_read_b128 v[104:107], v2 offset:16384
 ds_read_b128 v[84:87], v4 offset:41984
 v_mfma_f32_16x16x32_bf16 v[24:27], v[136:139], v[152:155], v[24:27]
 ds_read_b128 v[88:91], v4 offset:43008
 v_mfma_f32_16x16x32_bf16 v[28:31], v[140:143], v[152:155], v[28:31]
 ds_read_b128 v[92:95], v4 offset:44032
 v_mfma_f32_16x16x32_bf16 v[32:35], v[144:147], v[152:155], v[32:35]
 ds_read_b128 v[96:99], v4 offset:45056
 v_mfma_f32_16x16x32_bf16 v[36:39], v[148:151], v[152:155], v[36:39]
 ds_read_b128 v[100:103], v4 offset:46080
 s_waitcnt lgkmcnt(6)
 v_mfma_f32_16x16x32_bf16 v[20:23], v[156:159], v[176:179], v[20:23]
 ds_read_b128 v[128:131], v2 offset:17408
 ds_read_b128 v[108:111], v3 offset:0
 v_mfma_f32_16x16x32_bf16 v[24:27], v[160:163], v[176:179], v[24:27]
 ds_read_b128 v[112:115], v3 offset:1024
 v_mfma_f32_16x16x32_bf16 v[28:31], v[164:167], v[176:179], v[28:31]
 ds_read_b128 v[116:119], v3 offset:2048
 v_mfma_f32_16x16x32_bf16 v[32:35], v[168:171], v[176:179], v[32:35]
 ds_read_b128 v[120:123], v3 offset:3072
 v_mfma_f32_16x16x32_bf16 v[36:39], v[172:175], v[176:179], v[36:39]
 ds_read_b128 v[124:127], v3 offset:4096
 s_waitcnt lgkmcnt(6)
 v_mfma_f32_16x16x32_bf16 v[20:23], v[84:87], v[104:107], v[20:23]
 s_barrier
 ds_read_b128 v[152:155], v2 offset:24576
 ds_read_b128 v[132:135], v3 offset:5120
 v_mfma_f32_16x16x32_bf16 v[24:27], v[88:91], v[104:107], v[24:27]
 ds_read_b128 v[136:139], v3 offset:6144
 v_mfma_f32_16x16x32_bf16 v[28:31], v[92:95], v[104:107], v[28:31]
 ds_read_b128 v[140:143], v3 offset:7168
 v_mfma_f32_16x16x32_bf16 v[32:35], v[96:99], v[104:107], v[32:35]
 ds_read_b128 v[144:147], v3 offset:8192
 v_mfma_f32_16x16x32_bf16 v[36:39], v[100:103], v[104:107], v[36:39]
 ds_read_b128 v[148:151], v3 offset:9216
 s_waitcnt lgkmcnt(6)
 v_mfma_f32_16x16x32_bf16 v[20:23], v[108:111], v[128:131], v[20:23]
 ds_read_b128 v[176:179], v2 offset:25600
 ds_read_b128 v[156:159], v3 offset:10240
 v_mfma_f32_16x16x32_bf16 v[24:27], v[112:115], v[128:131], v[24:27]
 ds_read_b128 v[160:163], v3 offset:11264
 v_mfma_f32_16x16x32_bf16 v[28:31], v[116:119], v[128:131], v[28:31]
 ds_read_b128 v[164:167], v3 offset:12288
 v_mfma_f32_16x16x32_bf16 v[32:35], v[120:123], v[128:131], v[32:35]
 ds_read_b128 v[168:171], v3 offset:13312
 v_mfma_f32_16x16x32_bf16 v[36:39], v[124:127], v[128:131], v[36:39]
 ds_read_b128 v[172:175], v3 offset:14336
 s_waitcnt lgkmcnt(6)
 v_mfma_f32_16x16x32_bf16 v[20:23], v[132:135], v[152:155], v[20:23]
 s_barrier
 ds_read_b128 v[104:107], v2 offset:32768
 ds_read_b128 v[84:87], v3 offset:15360
 v_mfma_f32_16x16x32_bf16 v[24:27], v[136:139], v[152:155], v[24:27]
 ds_read_b128 v[88:91], v3 offset:16384
 v_mfma_f32_16x16x32_bf16 v[28:31], v[140:143], v[152:155], v[28:31]
 ds_read_b128 v[92:95], v3 offset:17408
 v_mfma_f32_16x16x32_bf16 v[32:35], v[144:147], v[152:155], v[32:35]
 ds_read_b128 v[96:99], v3 offset:18432
 v_mfma_f32_16x16x32_bf16 v[36:39], v[148:151], v[152:155], v[36:39]
 ds_read_b128 v[100:103], v3 offset:19456
 s_waitcnt lgkmcnt(6)
 v_mfma_f32_16x16x32_bf16 v[20:23], v[156:159], v[176:179], v[20:23]
 ds_read_b128 v[128:131], v2 offset:33792
 ds_read_b128 v[108:111], v3 offset:20480
 v_mfma_f32_16x16x32_bf16 v[24:27], v[160:163], v[176:179], v[24:27]
 ds_read_b128 v[112:115], v3 offset:21504
 v_mfma_f32_16x16x32_bf16 v[28:31], v[164:167], v[176:179], v[28:31]
 ds_read_b128 v[116:119], v3 offset:22528
 v_mfma_f32_16x16x32_bf16 v[32:35], v[168:171], v[176:179], v[32:35]
 ds_read_b128 v[120:123], v3 offset:23552
 v_mfma_f32_16x16x32_bf16 v[36:39], v[172:175], v[176:179], v[36:39]
 ds_read_b128 v[124:127], v3 offset:24576
 s_waitcnt lgkmcnt(6)
 v_mfma_f32_16x16x32_bf16 v[20:23], v[84:87], v[104:107], v[20:23]
 s_barrier
 ds_read_b128 v[152:155], v2 offset:40960
 ds_read_b128 v[132:135], v3 offset:25600
 v_mfma_f32_16x16x32_bf16 v[24:27], v[88:91], v[104:107], v[24:27]
 ds_read_b128 v[136:139], v3 offset:26624
 v_mfma_f32_16x16x32_bf16 v[28:31], v[92:95], v[104:107], v[28:31]
 ds_read_b128 v[140:143], v3 offset:27648
 v_mfma_f32_16x16x32_bf16 v[32:35], v[96:99], v[104:107], v[32:35]
 ds_read_b128 v[144:147], v3 offset:28672
 v_mfma_f32_16x16x32_bf16 v[36:39], v[100:103], v[104:107], v[36:39]
 ds_read_b128 v[148:151], v3 offset:29696
 s_waitcnt lgkmcnt(6)
 v_mfma_f32_16x16x32_bf16 v[20:23], v[108:111], v[128:131], v[20:23]
 ds_read_b128 v[176:179], v2 offset:41984
 ds_read_b128 v[156:159], v3 offset:30720
 v_mfma_f32_16x16x32_bf16 v[24:27], v[112:115], v[128:131], v[24:27]
 ds_read_b128 v[160:163], v3 offset:31744
 v_mfma_f32_16x16x32_bf16 v[28:31], v[116:119], v[128:131], v[28:31]
 ds_read_b128 v[164:167], v3 offset:32768
 v_mfma_f32_16x16x32_bf16 v[32:35], v[120:123], v[128:131], v[32:35]
 ds_read_b128 v[168:171], v3 offset:33792
 v_mfma_f32_16x16x32_bf16 v[36:39], v[124:127], v[128:131], v[36:39]
 ds_read_b128 v[172:175], v3 offset:34816
 s_waitcnt lgkmcnt(6)
 v_mfma_f32_16x16x32_bf16 v[20:23], v[132:135], v[152:155], v[20:23]
 s_barrier
 ds_read_b128 v[104:107], v2 offset:0
 ds_read_b128 v[84:87], v3 offset:35840
 v_mfma_f32_16x16x32_bf16 v[24:27], v[136:139], v[152:155], v[24:27]
 ds_read_b128 v[88:91], v3 offset:36864
 v_mfma_f32_16x16x32_bf16 v[28:31], v[140:143], v[152:155], v[28:31]
 ds_read_b128 v[92:95], v3 offset:37888
 v_mfma_f32_16x16x32_bf16 v[32:35], v[144:147], v[152:155], v[32:35]
 ds_read_b128 v[96:99], v3 offset:38912
 v_mfma_f32_16x16x32_bf16 v[36:39], v[148:151], v[152:155], v[36:39]
 ds_read_b128 v[100:103], v3 offset:39936
 s_waitcnt lgkmcnt(6)
 v_mfma_f32_16x16x32_bf16 v[20:23], v[156:159], v[176:179], v[20:23]
 ds_read_b128 v[128:131], v2 offset:1024
 ds_read_b128 v[108:111], v3 offset:40960
 v_mfma_f32_16x16x32_bf16 v[24:27], v[160:163], v[176:179], v[24:27]
 ds_read_b128 v[112:115], v3 offset:41984
 v_mfma_f32_16x16x32_bf16 v[28:31], v[164:167], v[176:179], v[28:31]
 ds_read_b128 v[116:119], v3 offset:43008
 v_mfma_f32_16x16x32_bf16 v[32:35], v[168:171], v[176:179], v[32:35]
 ds_read_b128 v[120:123], v3 offset:44032
 v_mfma_f32_16x16x32_bf16 v[36:39], v[172:175], v[176:179], v[36:39]
 ds_read_b128 v[124:127], v3 offset:45056
 s_waitcnt lgkmcnt(6)
 v_mfma_f32_16x16x32_bf16 v[20:23], v[84:87], v[104:107], v[20:23]
 s_barrier
 ds_read_b128 v[152:155], v2 offset:8192
 ds_read_b128 v[132:135], v3 offset:46080
 v_mfma_f32_16x16x32_bf16 v[24:27], v[88:91], v[104:107], v[24:27]
 ds_read_b128 v[136:139], v3 offset:47104
 v_mfma_f32_16x16x32_bf16 v[28:31], v[92:95], v[104:107], v[28:31]
 ds_read_b128 v[140:143], v3 offset:48128
 v_mfma_f32_16x16x32_bf16 v[32:35], v[96:99], v[104:107], v[32:35]
 ds_read_b128 v[144:147], v3 offset:49152
 v_mfma_f32_16x16x32_bf16 v[36:39], v[100:103], v[104:107], v[36:39]
 ds_read_b128 v[148:151], v3 offset:50176
 s_waitcnt lgkmcnt(6)
 v_mfma_f32_16x16x32_bf16 v[20:23], v[108:111], v[128:131], v[20:23]
 ds_read_b128 v[176:179], v2 offset:9216
 ds_read_b128 v[156:159], v3 offset:51200
 v_mfma_f32_16x16x32_bf16 v[24:27], v[112:115], v[128:131], v[24:27]
 ds_read_b128 v[160:163], v3 offset:52224
 v_mfma_f32_16x16x32_bf16 v[28:31], v[116:119], v[128:131], v[28:31]
 ds_read_b128 v[164:167], v3 offset:53248
 v_mfma_f32_16x16x32_bf16 v[32:35], v[120:123], v[128:131], v[32:35]
 ds_read_b128 v[168:171], v3 offset:54272
 v_mfma_f32_16x16x32_bf16 v[36:39], v[124:127], v[128:131], v[36:39]
 ds_read_b128 v[172:175], v3 offset:55296
 s_waitcnt lgkmcnt(6)
 v_mfma_f32_16x16x32_bf16 v[20:23], v[132:135], v[152:155], v[20:23]
 s_barrier
 ds_read_b128 v[104:107], v2 offset:16384
 ds_read_b128 v[84:87], v3 offset:56320
 v_mfma_f32_16x16x32_bf16 v[24:27], v[136:139], v[152:155], v[24:27]
 ds_read_b128 v[88:91], v3 offset:57344
 v_mfma_f32_16x16x32_bf16 v[28:31], v[140:143], v[152:155], v[28:31]
 ds_read_b128 v[92:95], v3 offset:58368
 v_mfma_f32_16x16x32_bf16 v[32:35], v[144:147], v[152:155], v[32:35]
 ds_read_b128 v[96:99], v3 offset:59392
 v_mfma_f32_16x16x32_bf16 v[36:39], v[148:151], v[152:155], v[36:39]
 ds_read_b128 v[100:103], v3 offset:60416
 s_waitcnt lgkmcnt(6)
 v_mfma_f32_16x16x32_bf16 v[20:23], v[156:159], v[176:179], v[20:23]
 ds_read_b128 v[128:131], v2 offset:17408
 ds_read_b128 v[108:111], v3 offset:61440
 v_mfma_f32_16x16x32_bf16 v[24:27], v[160:163], v[176:179], v[24:27]
 ds_read_b128 v[112:115], v3 offset:62464
 v_mfma_f32_16x16x32_bf16 v[28:31], v[164:167], v[176:179], v[28:31]
 ds_read_b128 v[116:119], v3 offset:63488
 v_mfma_f32_16x16x32_bf16 v[32:35], v[168:171], v[176:179], v[32:35]
 ds_read_b128 v[120:123], v3 offset:64512
 v_mfma_f32_16x16x32_bf16 v[36:39], v[172:175], v[176:179], v[36:39]
 ds_read_b128 v[124:127], v4 offset:0
 s_waitcnt lgkmcnt(6)
 v_mfma_f32_16x16x32_bf16 v[20:23], v[84:87], v[104:107], v[20:23]
 s_barrier
 ds_read_b128 v[152:155], v2 offset:24576
 ds_read_b128 v[132:135], v4 offset:1024
 v_mfma_f32_16x16x32_bf16 v[24:27], v[88:91], v[104:107], v[24:27]
 ds_read_b128 v[136:139], v4 offset:2048
 v_mfma_f32_16x16x32_bf16 v[28:31], v[92:95], v[104:107], v[28:31]
 ds_read_b128 v[140:143], v4 offset:3072
 v_mfma_f32_16x16x32_bf16 v[32:35], v[96:99], v[104:107], v[32:35]
 ds_read_b128 v[144:147], v4 offset:4096
 v_mfma_f32_16x16x32_bf16 v[36:39], v[100:103], v[104:107], v[36:39]
 ds_read_b128 v[148:151], v4 offset:5120
 s_waitcnt lgkmcnt(6)
 v_mfma_f32_16x16x32_bf16 v[20:23], v[108:111], v[128:131], v[20:23]
 ds_read_b128 v[176:179], v2 offset:25600
 ds_read_b128 v[156:159], v4 offset:6144
 v_mfma_f32_16x16x32_bf16 v[24:27], v[112:115], v[128:131], v[24:27]
 ds_read_b128 v[160:163], v4 offset:7168
 v_mfma_f32_16x16x32_bf16 v[28:31], v[116:119], v[128:131], v[28:31]
 ds_read_b128 v[164:167], v4 offset:8192
 v_mfma_f32_16x16x32_bf16 v[32:35], v[120:123], v[128:131], v[32:35]
 ds_read_b128 v[168:171], v4 offset:9216
 v_mfma_f32_16x16x32_bf16 v[36:39], v[124:127], v[128:131], v[36:39]
 ds_read_b128 v[172:175], v4 offset:10240
 s_waitcnt lgkmcnt(6)
 v_mfma_f32_16x16x32_bf16 v[20:23], v[132:135], v[152:155], v[20:23]
 s_barrier
 ds_read_b128 v[104:107], v2 offset:32768
 ds_read_b128 v[84:87], v4 offset:11264
 v_mfma_f32_16x16x32_bf16 v[24:27], v[136:139], v[152:155], v[24:27]
 ds_read_b128 v[88:91], v4 offset:12288
 v_mfma_f32_16x16x32_bf16 v[28:31], v[140:143], v[152:155], v[28:31]
 ds_read_b128 v[92:95], v4 offset:13312
 v_mfma_f32_16x16x32_bf16 v[32:35], v[144:147], v[152:155], v[32:35]
 ds_read_b128 v[96:99], v4 offset:14336
 v_mfma_f32_16x16x32_bf16 v[36:39], v[148:151], v[152:155], v[36:39]
 ds_read_b128 v[100:103], v4 offset:15360
 s_waitcnt lgkmcnt(6)
 v_mfma_f32_16x16x32_bf16 v[20:23], v[156:159], v[176:179], v[20:23]
 ds_read_b128 v[128:131], v2 offset:33792
 ds_read_b128 v[108:111], v4 offset:16384
 v_mfma_f32_16x16x32_bf16 v[24:27], v[160:163], v[176:179], v[24:27]
 ds_read_b128 v[112:115], v4 offset:17408
 v_mfma_f32_16x16x32_bf16 v[28:31], v[164:167], v[176:179], v[28:31]
 ds_read_b128 v[116:119], v4 offset:18432
 v_mfma_f32_16x16x32_bf16 v[32:35], v[168:171], v[176:179], v[32:35]
 ds_read_b128 v[120:123], v4 offset:19456
 v_mfma_f32_16x16x32_bf16 v[36:39], v[172:175], v[176:179], v[36:39]
 ds_read_b128 v[124:127], v4 offset:20480
 s_waitcnt lgkmcnt(6)
 v_mfma_f32_16x16x32_bf16 v[20:23], v[84:87], v[104:107], v[20:23]
 s_barrier
 ds_read_b128 v[152:155], v2 offset:40960
 ds_read_b128 v[132:135], v4 offset:21504
 v_mfma_f32_16x16x32_bf16 v[24:27], v[88:91], v[104:107], v[24:27]
 ds_read_b128 v[136:139], v4 offset:22528
 v_mfma_f32_16x16x32_bf16 v[28:31], v[92:95], v[104:107], v[28:31]
 ds_read_b128 v[140:143], v4 offset:23552
 v_mfma_f32_16x16x32_bf16 v[32:35], v[96:99], v[104:107], v[32:35]
 ds_read_b128 v[144:147], v4 offset:24576
 v_mfma_f32_16x16x32_bf16 v[36:39], v[100:103], v[104:107], v[36:39]
 ds_read_b128 v[148:151], v4 offset:25600
 s_waitcnt lgkmcnt(6)
 v_mfma_f32_16x16x32_bf16 v[20:23], v[108:111], v[128:131], v[20:23]
 ds_read_b128 v[176:179], v2 offset:41984
 ds_read_b128 v[156:159], v4 offset:26624
 v_mfma_f32_16x16x32_bf16 v[24:27], v[112:115], v[128:131], v[24:27]
 ds_read_b128 v[160:163], v4 offset:27648
 v_mfma_f32_16x16x32_bf16 v[28:31], v[116:119], v[128:131], v[28:31]
 ds_read_b128 v[164:167], v4 offset:28672
 v_mfma_f32_16x16x32_bf16 v[32:35], v[120:123], v[128:131], v[32:35]
 ds_read_b128 v[168:171], v4 offset:29696
 v_mfma_f32_16x16x32_bf16 v[36:39], v[124:127], v[128:131], v[36:39]
 ds_read_b128 v[172:175], v4 offset:30720
 s_waitcnt lgkmcnt(6)
 v_mfma_f32_16x16x32_bf16 v[20:23], v[132:135], v[152:155], v[20:23]
 s_barrier
 ds_read_b128 v[104:107], v2 offset:0
 ds_read_b128 v[84:87], v4 offset:31744
 v_mfma_f32_16x16x32_bf16 v[24:27], v[136:139], v[152:155], v[24:27]
 ds_read_b128 v[88:91], v4 offset:32768
 v_mfma_f32_16x16x32_bf16 v[28:31], v[140:143], v[152:155], v[28:31]
 ds_read_b128 v[92:95], v4 offset:33792
 v_mfma_f32_16x16x32_bf16 v[32:35], v[144:147], v[152:155], v[32:35]
 ds_read_b128 v[96:99], v4 offset:34816
 v_mfma_f32_16x16x32_bf16 v[36:39], v[148:151], v[152:155], v[36:39]
 ds_read_b128 v[100:103], v4 offset:35840
 s_waitcnt lgkmcnt(6)
 v_mfma_f32_16x16x32_bf16 v[20:23], v[156:159], v[176:179], v[20:23]
 ds_read_b128 v[128:131], v2 offset:1024
 ds_read_b128 v[108:111], v4 offset:36864
 v_mfma_f32_16x16x32_bf16 v[24:27], v[160:163], v[176:179], v[24:27]
 ds_read_b128 v[112:115], v4 offset:37888
 v_mfma_f32_16x16x32_bf16 v[28:31], v[164:167], v[176:179], v[28:31]
 ds_read_b128 v[116:119], v4 offset:38912
 v_mfma_f32_16x16x32_bf16 v[32:35], v[168:171], v[176:179], v[32:35]
 ds_read_b128 v[120:123], v4 offset:39936
 v_mfma_f32_16x16x32_bf16 v[36:39], v[172:175], v[176:179], v[36:39]
 ds_read_b128 v[124:127], v4 offset:40960
 s_waitcnt lgkmcnt(6)
 v_mfma_f32_16x16x32_bf16 v[20:23], v[84:87], v[104:107], v[20:23]
 s_barrier
 ds_read_b128 v[152:155], v2 offset:8192
 ds_read_b128 v[132:135], v4 offset:41984
 v_mfma_f32_16x16x32_bf16 v[24:27], v[88:91], v[104:107], v[24:27]
 ds_read_b128 v[136:139], v4 offset:43008
 v_mfma_f32_16x16x32_bf16 v[28:31], v[92:95], v[104:107], v[28:31]
 ds_read_b128 v[140:143], v4 offset:44032
 v_mfma_f32_16x16x32_bf16 v[32:35], v[96:99], v[104:107], v[32:35]
 ds_read_b128 v[144:147], v4 offset:45056
 v_mfma_f32_16x16x32_bf16 v[36:39], v[100:103], v[104:107], v[36:39]
 ds_read_b128 v[148:151], v4 offset:46080
 s_waitcnt lgkmcnt(6)
 v_mfma_f32_16x16x32_bf16 v[20:23], v[108:111], v[128:131], v[20:23]
 ds_read_b128 v[176:179], v2 offset:9216
 ds_read_b128 v[156:159], v3 offset:0
 v_mfma_f32_16x16x32_bf16 v[24:27], v[112:115], v[128:131], v[24:27]
 ds_read_b128 v[160:163], v3 offset:1024
 v_mfma_f32_16x16x32_bf16 v[28:31], v[116:119], v[128:131], v[28:31]
 ds_read_b128 v[164:167], v3 offset:2048
 v_mfma_f32_16x16x32_bf16 v[32:35], v[120:123], v[128:131], v[32:35]
 ds_read_b128 v[168:171], v3 offset:3072
 v_mfma_f32_16x16x32_bf16 v[36:39], v[124:127], v[128:131], v[36:39]
 ds_read_b128 v[172:175], v3 offset:4096
 s_waitcnt lgkmcnt(6)
 v_mfma_f32_16x16x32_bf16 v[20:23], v[132:135], v[152:155], v[20:23]
 s_barrier
 ds_read_b128 v[104:107], v2 offset:16384
 ds_read_b128 v[84:87], v3 offset:5120
 v_mfma_f32_16x16x32_bf16 v[24:27], v[136:139], v[152:155], v[24:27]
 ds_read_b128 v[88:91], v3 offset:6144
 v_mfma_f32_16x16x32_bf16 v[28:31], v[140:143], v[152:155], v[28:31]
 ds_read_b128 v[92:95], v3 offset:7168
 v_mfma_f32_16x16x32_bf16 v[32:35], v[144:147], v[152:155], v[32:35]
 ds_read_b128 v[96:99], v3 offset:8192
 v_mfma_f32_16x16x32_bf16 v[36:39], v[148:151], v[152:155], v[36:39]
 ds_read_b128 v[100:103], v3 offset:9216
 s_waitcnt lgkmcnt(6)
 v_mfma_f32_16x16x32_bf16 v[20:23], v[156:159], v[176:179], v[20:23]
 ds_read_b128 v[128:131], v2 offset:17408
 ds_read_b128 v[108:111], v3 offset:10240
 v_mfma_f32_16x16x32_bf16 v[24:27], v[160:163], v[176:179], v[24:27]
 ds_read_b128 v[112:115], v3 offset:11264
 v_mfma_f32_16x16x32_bf16 v[28:31], v[164:167], v[176:179], v[28:31]
 ds_read_b128 v[116:119], v3 offset:12288
 v_mfma_f32_16x16x32_bf16 v[32:35], v[168:171], v[176:179], v[32:35]
 ds_read_b128 v[120:123], v3 offset:13312
 v_mfma_f32_16x16x32_bf16 v[36:39], v[172:175], v[176:179], v[36:39]
 ds_read_b128 v[124:127], v3 offset:14336
 s_waitcnt lgkmcnt(6)
 v_mfma_f32_16x16x32_bf16 v[20:23], v[84:87], v[104:107], v[20:23]
 s_barrier
 ds_read_b128 v[152:155], v2 offset:24576
 ds_read_b128 v[132:135], v3 offset:15360
 v_mfma_f32_16x16x32_bf16 v[24:27], v[88:91], v[104:107], v[24:27]
 ds_read_b128 v[136:139], v3 offset:16384
 v_mfma_f32_16x16x32_bf16 v[28:31], v[92:95], v[104:107], v[28:31]
 ds_read_b128 v[140:143], v3 offset:17408
 v_mfma_f32_16x16x32_bf16 v[32:35], v[96:99], v[104:107], v[32:35]
 ds_read_b128 v[144:147], v3 offset:18432
 v_mfma_f32_16x16x32_bf16 v[36:39], v[100:103], v[104:107], v[36:39]
 ds_read_b128 v[148:151], v3 offset:19456
 s_waitcnt lgkmcnt(6)
 v_mfma_f32_16x16x32_bf16 v[20:23], v[108:111], v[128:131], v[20:23]
 ds_read_b128 v[176:179], v2 offset:25600
 ds_read_b128 v[156:159], v3 offset:20480
 v_mfma_f32_16x16x32_bf16 v[24:27], v[112:115], v[128:131], v[24:27]
 ds_read_b128 v[160:163], v3 offset:21504
 v_mfma_f32_16x16x32_bf16 v[28:31], v[116:119], v[128:131], v[28:31]
 ds_read_b128 v[164:167], v3 offset:22528
 v_mfma_f32_16x16x32_bf16 v[32:35], v[120:123], v[128:131], v[32:35]
 ds_read_b128 v[168:171], v3 offset:23552
 v_mfma_f32_16x16x32_bf16 v[36:39], v[124:127], v[128:131], v[36:39]
 ds_read_b128 v[172:175], v3 offset:24576
 s_waitcnt lgkmcnt(6)
 v_mfma_f32_16x16x32_bf16 v[20:23], v[132:135], v[152:155], v[20:23]
 s_barrier
 ds_read_b128 v[104:107], v2 offset:32768
 ds_read_b128 v[84:87], v3 offset:25600
 v_mfma_f32_16x16x32_bf16 v[24:27], v[136:139], v[152:155], v[24:27]
 ds_read_b128 v[88:91], v3 offset:26624
 v_mfma_f32_16x16x32_bf16 v[28:31], v[140:143], v[152:155], v[28:31]
 ds_read_b128 v[92:95], v3 offset:27648
 v_mfma_f32_16x16x32_bf16 v[32:35], v[144:147], v[152:155], v[32:35]
 ds_read_b128 v[96:99], v3 offset:28672
 v_mfma_f32_16x16x32_bf16 v[36:39], v[148:151], v[152:155], v[36:39]
 ds_read_b128 v[100:103], v3 offset:29696
 s_waitcnt lgkmcnt(6)
 v_mfma_f32_16x16x32_bf16 v[20:23], v[156:159], v[176:179], v[20:23]
 ds_read_b128 v[128:131], v2 offset:33792
 ds_read_b128 v[108:111], v3 offset:30720
 v_mfma_f32_16x16x32_bf16 v[24:27], v[160:163], v[176:179], v[24:27]
 ds_read_b128 v[112:115], v3 offset:31744
 v_mfma_f32_16x16x32_bf16 v[28:31], v[164:167], v[176:179], v[28:31]
 ds_read_b128 v[116:119], v3 offset:32768
 v_mfma_f32_16x16x32_bf16 v[32:35], v[168:171], v[176:179], v[32:35]
 ds_read_b128 v[120:123], v3 offset:33792
 v_mfma_f32_16x16x32_bf16 v[36:39], v[172:175], v[176:179], v[36:39]
 ds_read_b128 v[124:127], v3 offset:34816
 s_waitcnt lgkmcnt(6)
 v_mfma_f32_16x16x32_bf16 v[20:23], v[84:87], v[104:107], v[20:23]
 s_barrier
 ds_read_b128 v[152:155], v2 offset:40960
 ds_read_b128 v[132:135], v3 offset:35840
 v_mfma_f32_16x16x32_bf16 v[24:27], v[88:91], v[104:107], v[24:27]
 ds_read_b128 v[136:139], v3 offset:36864
 v_mfma_f32_16x16x32_bf16 v[28:31], v[92:95], v[104:107], v[28:31]
 ds_read_b128 v[140:143], v3 offset:37888
 v_mfma_f32_16x16x32_bf16 v[32:35], v[96:99], v[104:107], v[32:35]
 ds_read_b128 v[144:147], v3 offset:38912
 v_mfma_f32_16x16x32_bf16 v[36:39], v[100:103], v[104:107], v[36:39]
 ds_read_b128 v[148:151], v3 offset:39936
 s_waitcnt lgkmcnt(6)
 v_mfma_f32_16x16x32_bf16 v[20:23], v[108:111], v[128:131], v[20:23]
 ds_read_b128 v[176:179], v2 offset:41984
 ds_read_b128 v[156:159], v3 offset:40960
 v_mfma_f32_16x16x32_bf16 v[24:27], v[112:115], v[128:131], v[24:27]
 ds_read_b128 v[160:163], v3 offset:41984
 v_mfma_f32_16x16x32_bf16 v[28:31], v[116:119], v[128:131], v[28:31]
 ds_read_b128 v[164:167], v3 offset:43008
 v_mfma_f32_16x16x32_bf16 v[32:35], v[120:123], v[128:131], v[32:35]
 ds_read_b128 v[168:171], v3 offset:44032
 v_mfma_f32_16x16x32_bf16 v[36:39], v[124:127], v[128:131], v[36:39]
 ds_read_b128 v[172:175], v3 offset:45056
 s_waitcnt lgkmcnt(6)
 v_mfma_f32_16x16x32_bf16 v[20:23], v[132:135], v[152:155], v[20:23]
 s_barrier
 v_mfma_f32_16x16x32_bf16 v[24:27], v[136:139], v[152:155], v[24:27]
 v_mfma_f32_16x16x32_bf16 v[28:31], v[140:143], v[152:155], v[28:31]
 v_mfma_f32_16x16x32_bf16 v[32:35], v[144:147], v[152:155], v[32:35]
 v_mfma_f32_16x16x32_bf16 v[36:39], v[148:151], v[152:155], v[36:39]
 s_waitcnt lgkmcnt(0)
 v_mfma_f32_16x16x32_bf16 v[20:23], v[156:159], v[176:179], v[20:23]
 v_mfma_f32_16x16x32_bf16 v[24:27], v[160:163], v[176:179], v[24:27]
 v_mfma_f32_16x16x32_bf16 v[28:31], v[164:167], v[176:179], v[28:31]
 v_mfma_f32_16x16x32_bf16 v[32:35], v[168:171], v[176:179], v[32:35]
 v_mfma_f32_16x16x32_bf16 v[36:39], v[172:175], v[176:179], v[36:39]
 s_nop 3
 v_cvt_pk_bf16_f32 v10, v20, v21
 v_cvt_pk_bf16_f32 v11, v22, v23
 v_cvt_pk_bf16_f32 v12, v24, v25
 v_cvt_pk_bf16_f32 v13, v26, v27
 v_cvt_pk_bf16_f32 v14, v28, v29
 v_cvt_pk_bf16_f32 v15, v30, v31
 v_cvt_pk_bf16_f32 v16, v32, v33
 v_cvt_pk_bf16_f32 v17, v34, v35
 v_cvt_pk_bf16_f32 v18, v36, v37
 v_cvt_pk_bf16_f32 v19, v38, v39
 v_permlane16_swap_b32 v10, v12
 v_permlane16_swap_b32 v11, v13
 v_permlane16_swap_b32 v14, v16
 v_permlane16_swap_b32 v15, v17
 s_cmp_eq_u32 s33, 0
 s_cbranch_scc1 C1_e2_slow
 s_add_u32 s24, s30, 0xbf2000
 buffer_store_dwordx4 v[10:13], v5, s[4:7], s24 offen offset:0
 buffer_store_dwordx4 v[14:17], v5, s[4:7], s24 offen offset:1024
 buffer_store_dwordx2 v[18:19], v6, s[4:7], s24 offen offset:2048
 v_pk_add_f32 v[204:205], v[20:21], v[22:23]
 v_pk_mul_f32 v[206:207], v[20:21], v[20:21]
 v_pk_fma_f32 v[206:207], v[22:23], v[22:23], v[206:207]
 v_pk_add_f32 v[208:209], v[24:25], v[26:27]
 v_pk_mul_f32 v[210:211], v[24:25], v[24:25]
 v_pk_fma_f32 v[210:211], v[26:27], v[26:27], v[210:211]
 v_pk_add_f32 v[204:205], v[204:205], v[28:29]
 v_pk_fma_f32 v[206:207], v[28:29], v[28:29], v[206:207]
 v_pk_add_f32 v[208:209], v[208:209], v[30:31]
 v_pk_fma_f32 v[210:211], v[30:31], v[30:31], v[210:211]
 v_pk_add_f32 v[204:205], v[204:205], v[32:33]
 v_pk_fma_f32 v[206:207], v[32:33], v[32:33], v[206:207]
 v_pk_add_f32 v[208:209], v[208:209], v[34:35]
 v_pk_fma_f32 v[210:211], v[34:35], v[34:35], v[210:211]
 v_pk_add_f32 v[204:205], v[204:205], v[36:37]
 v_pk_fma_f32 v[206:207], v[36:37], v[36:37], v[206:207]
 v_pk_add_f32 v[208:209], v[208:209], v[38:39]
 v_pk_fma_f32 v[210:211], v[38:39], v[38:39], v[210:211]
 v_pk_add_f32 v[204:205], v[204:205], v[208:209]
 v_pk_add_f32 v[206:207], v[206:207], v[210:211]
 v_add_f32 v212, v204, v205
 v_add_f32 v213, v206, v207
 v_mov_b32 v214, v212
 v_mov_b32 v215, v213
 s_nop 0
 v_permlane16_swap_b32 v212, v214
 v_permlane16_swap_b32 v213, v215
 v_add_f32 v212, v212, v214
 v_add_f32 v213, v213, v215
 v_mov_b32 v214, v212
 v_mov_b32 v215, v213
 s_nop 0
 v_permlane32_swap_b32 v212, v214
 v_permlane32_swap_b32 v213, v215
 v_add_f32 v212, v212, v214
 v_add_f32 v213, v213, v215
 s_mov_b64 exec, 0xffff
 buffer_store_dwordx2 v[212:213], v70, s[4:7], s26 offen
 s_mov_b64 exec, -1
 s_lshl_b32 s23, s21, 7
 s_lshl_b32 s24, s22, 4
 s_add_u32 s23, s23, s24
 s_lshl_b32 s24, s20, 2
 s_add_u32 s23, s23, s24
 s_add_u32 s23, s23, 0x6ea000
 v_mov_b32 v8, 0
 v_mov_b32 v9, 1
 s_mov_b64 exec, 1
 s_waitcnt vmcnt(0)
 buffer_store_dword v9, v8, s[4:7], s23 offen
 s_mov_b64 exec, -1
C1_e2_join:
 v_lshlrev_b32 v2, 4, v1
 s_lshl_b32 s23, s20, 12
 s_add_u32 s23, s23, 49152
 v_add_u32 v3, s23, v2
 v_add_u32 v4, 0x10000, v3
 s_mul_i32 s31, s22, 15
 s_lshl_b32 s23, s20, 2
 s_add_u32 s31, s31, s23
 s_lshl_b32 s31, s31, 6
 s_add_u32 s31, s31, 0x6e0000
 s_mul_i32 s30, s21, 245760
 s_mul_i32 s23, s22, 10
 s_lshl_b32 s24, s20, 2
 s_add_u32 s23, s23, s24
 s_lshl_b32 s23, s23, 9
 s_add_u32 s30, s30, s23
 s_add_u32 s30, s30, 0x1172000
 s_add_u32 s29, s30, 122880
 s_mul_i32 s28, s21, 2688
 s_add_u32 s28, s28, 0x192e000
 s_cmp_lt_u32 s22, 4
 s_cselect_b32 s27, 0x3ea52b5c, 1.0
 s_cmp_eq_u32 s20, 2
 s_cbranch_scc1 C1_q_mx
 s_cmp_eq_u32 s20, 3
 s_cbranch_scc1 C1_q_vv
 v_lshrrev_b32 v8, 4, v1
 v_lshlrev_b32 v8, 4, v8
 buffer_load_dwordx4 v[180:183], v8, s[4:7], s31 offen offset:0
 buffer_load_dwordx4 v[184:187], v8, s[4:7], s31 offen offset:64
 buffer_load_dwordx4 v[188:191], v8, s[4:7], s31 offen offset:128
 buffer_load_dwordx4 v[192:195], v8, s[4:7], s31 offen offset:192
 v_lshrrev_b32 v9, 4, v1
 v_and_b32 v203, 1, v9
 s_mov_b32 s23, 61440
 v_mul_lo_u32 v203, v203, s23
 v_lshrrev_b32 v9, 1, v9
 v_lshlrev_b32 v9, 8, v9
 v_add_u32 v203, v203, v9
 v_and_b32 v9, 15, v1
 v_lshlrev_b32 v9, 4, v9
 v_add_u32 v203, v203, v9
 v_and_b32 v8, 15, v1
 v_lshlrev_b32 v8, 2, v8
 v_add_u32 v8, 161792, v8
 s_barrier
 ds_read_b128 v[84:87], v3 offset:46080
 ds_read_b128 v[100:103], v2 offset:0
 ds_read_b128 v[88:91], v3 offset:47104
 ds_read_b128 v[92:95], v3 offset:48128
 ds_read_b128 v[96:99], v3 offset:49152
 ds_read_b128 v[104:107], v2 offset:2048
 ds_read_b128 v[108:111], v2 offset:4096
 ds_read_b128 v[112:115], v2 offset:6144
 s_waitcnt lgkmcnt(0)
 v_mfma_f32_16x16x32_bf16 v[20:23], v[84:87], v[100:103], 0
 ds_read_b128 v[116:119], v3 offset:61440
 v_mfma_f32_16x16x32_bf16 v[24:27], v[88:91], v[100:103], 0
 ds_read_b128 v[132:135], v2 offset:1024
 v_mfma_f32_16x16x32_bf16 v[28:31], v[92:95], v[100:103], 0
 ds_read_b128 v[120:123], v3 offset:62464
 v_mfma_f32_16x16x32_bf16 v[32:35], v[96:99], v[100:103], 0
 ds_read_b128 v[124:127], v3 offset:63488
 v_mfma_f32_16x16x32_bf16 v[36:39], v[84:87], v[104:107], 0
 ds_read_b128 v[128:131], v3 offset:64512
 v_mfma_f32_16x16x32_bf16 v[40:43], v[88:91], v[104:107], 0
 ds_read_b128 v[136:139], v2 offset:3072
 v_mfma_f32_16x16x32_bf16 v[44:47], v[92:95], v[104:107], 0
 ds_read_b128 v[140:143], v2 offset:5120
 v_mfma_f32_16x16x32_bf16 v[48:51], v[96:99], v[104:107], 0
 ds_read_b128 v[144:147], v2 offset:7168
 v_mfma_f32_16x16x32_bf16 v[52:55], v[84:87], v[108:111], 0
 v_mfma_f32_16x16x32_bf16 v[56:59], v[88:91], v[108:111], 0
 v_mfma_f32_16x16x32_bf16 v[60:63], v[92:95], v[108:111], 0
 v_mfma_f32_16x16x32_bf16 v[64:67], v[96:99], v[108:111], 0
 v_mfma_f32_16x16x32_bf16 v[68:71], v[84:87], v[112:115], 0
 v_mfma_f32_16x16x32_bf16 v[72:75], v[88:91], v[112:115], 0
 v_mfma_f32_16x16x32_bf16 v[76:79], v[92:95], v[112:115], 0
 v_mfma_f32_16x16x32_bf16 v[80:83], v[96:99], v[112:115], 0
 s_waitcnt lgkmcnt(0)
 v_mfma_f32_16x16x32_bf16 v[20:23], v[116:119], v[132:135], v[20:23]
 s_barrier
 ds_read_b128 v[84:87], v4 offset:11264
 v_mfma_f32_16x16x32_bf16 v[24:27], v[120:123], v[132:135], v[24:27]
 ds_read_b128 v[100:103], v2 offset:8192
 v_mfma_f32_16x16x32_bf16 v[28:31], v[124:127], v[132:135], v[28:31]
 ds_read_b128 v[88:91], v4 offset:12288
 v_mfma_f32_16x16x32_bf16 v[32:35], v[128:131], v[132:135], v[32:35]
 ds_read_b128 v[92:95], v4 offset:13312
 v_mfma_f32_16x16x32_bf16 v[36:39], v[116:119], v[136:139], v[36:39]
 ds_read_b128 v[96:99], v4 offset:14336
 v_mfma_f32_16x16x32_bf16 v[40:43], v[120:123], v[136:139], v[40:43]
 ds_read_b128 v[104:107], v2 offset:10240
 v_mfma_f32_16x16x32_bf16 v[44:47], v[124:127], v[136:139], v[44:47]
 ds_read_b128 v[108:111], v2 offset:12288
 v_mfma_f32_16x16x32_bf16 v[48:51], v[128:131], v[136:139], v[48:51]
 ds_read_b128 v[112:115], v2 offset:14336
 v_mfma_f32_16x16x32_bf16 v[52:55], v[116:119], v[140:143], v[52:55]
 v_mfma_f32_16x16x32_bf16 v[56:59], v[120:123], v[140:143], v[56:59]
 v_mfma_f32_16x16x32_bf16 v[60:63], v[124:127], v[140:143], v[60:63]
 v_mfma_f32_16x16x32_bf16 v[64:67], v[128:131], v[140:143], v[64:67]
 v_mfma_f32_16x16x32_bf16 v[68:71], v[116:119], v[144:147], v[68:71]
 v_mfma_f32_16x16x32_bf16 v[72:75], v[120:123], v[144:147], v[72:75]
 v_mfma_f32_16x16x32_bf16 v[76:79], v[124:127], v[144:147], v[76:79]
 v_mfma_f32_16x16x32_bf16 v[80:83], v[128:131], v[144:147], v[80:83]
 s_waitcnt lgkmcnt(0)
 v_mfma_f32_16x16x32_bf16 v[20:23], v[84:87], v[100:103], v[20:23]
 ds_read_b128 v[116:119], v4 offset:26624
 v_mfma_f32_16x16x32_bf16 v[24:27], v[88:91], v[100:103], v[24:27]
 ds_read_b128 v[132:135], v2 offset:9216
 v_mfma_f32_16x16x32_bf16 v[28:31], v[92:95], v[100:103], v[28:31]
 ds_read_b128 v[120:123], v4 offset:27648
 v_mfma_f32_16x16x32_bf16 v[32:35], v[96:99], v[100:103], v[32:35]
 ds_read_b128 v[124:127], v4 offset:28672
 v_mfma_f32_16x16x32_bf16 v[36:39], v[84:87], v[104:107], v[36:39]
 ds_read_b128 v[128:131], v4 offset:29696
 v_mfma_f32_16x16x32_bf16 v[40:43], v[88:91], v[104:107], v[40:43]
 ds_read_b128 v[136:139], v2 offset:11264
 v_mfma_f32_16x16x32_bf16 v[44:47], v[92:95], v[104:107], v[44:47]
 ds_read_b128 v[140:143], v2 offset:13312
 v_mfma_f32_16x16x32_bf16 v[48:51], v[96:99], v[104:107], v[48:51]
 ds_read_b128 v[144:147], v2 offset:15360
 v_mfma_f32_16x16x32_bf16 v[52:55], v[84:87], v[108:111], v[52:55]
 v_mfma_f32_16x16x32_bf16 v[56:59], v[88:91], v[108:111], v[56:59]
 v_mfma_f32_16x16x32_bf16 v[60:63], v[92:95], v[108:111], v[60:63]
 v_mfma_f32_16x16x32_bf16 v[64:67], v[96:99], v[108:111], v[64:67]
 v_mfma_f32_16x16x32_bf16 v[68:71], v[84:87], v[112:115], v[68:71]
 v_mfma_f32_16x16x32_bf16 v[72:75], v[88:91], v[112:115], v[72:75]
 v_mfma_f32_16x16x32_bf16 v[76:79], v[92:95], v[112:115], v[76:79]
 v_mfma_f32_16x16x32_bf16 v[80:83], v[96:99], v[112:115], v[80:83]
 s_waitcnt lgkmcnt(0)
 v_mfma_f32_16x16x32_bf16 v[20:23], v[116:119], v[132:135], v[20:23]
 s_barrier
 ds_read_b128 v[84:87], v3 offset:0
 v_mfma_f32_16x16x32_bf16 v[24:27], v[120:123], v[132:135], v[24:27]
 ds_read_b128 v[100:103], v2 offset:16384
 v_mfma_f32_16x16x32_bf16 v[28:31], v[124:127], v[132:135], v[28:31]
 ds_read_b128 v[88:91], v3 offset:1024
 v_mfma_f32_16x16x32_bf16 v[32:35], v[128:131], v[132:135], v[32:35]
 ds_read_b128 v[92:95], v3 offset:2048
 v_mfma_f32_16x16x32_bf16 v[36:39], v[116:119], v[136:139], v[36:39]
 ds_read_b128 v[96:99], v3 offset:3072
 v_mfma_f32_16x16x32_bf16 v[40:43], v[120:123], v[136:139], v[40:43]
 ds_read_b128 v[104:107], v2 offset:18432
 v_mfma_f32_16x16x32_bf16 v[44:47], v[124:127], v[136:139], v[44:47]
 ds_read_b128 v[108:111], v2 offset:20480
 v_mfma_f32_16x16x32_bf16 v[48:51], v[128:131], v[136:139], v[48:51]
 ds_read_b128 v[112:115], v2 offset:22528
 v_mfma_f32_16x16x32_bf16 v[52:55], v[116:119], v[140:143], v[52:55]
 v_mfma_f32_16x16x32_bf16 v[56:59], v[120:123], v[140:143], v[56:59]
 v_mfma_f32_16x16x32_bf16 v[60:63], v[124:127], v[140:143], v[60:63]
 v_mfma_f32_16x16x32_bf16 v[64:67], v[128:131], v[140:143], v[64:67]
 v_mfma_f32_16x16x32_bf16 v[68:71], v[116:119], v[144:147], v[68:71]
 v_mfma_f32_16x16x32_bf16 v[72:75], v[120:123], v[144:147], v[72:75]
 v_mfma_f32_16x16x32_bf16 v[76:79], v[124:127], v[144:147], v[76:79]
 v_mfma_f32_16x16x32_bf16 v[80:83], v[128:131], v[144:147], v[80:83]
 s_waitcnt lgkmcnt(0)
 v_mfma_f32_16x16x32_bf16 v[20:23], v[84:87], v[100:103], v[20:23]
 ds_read_b128 v[116:119], v3 offset:15360
 v_mfma_f32_16x16x32_bf16 v[24:27], v[88:91], v[100:103], v[24:27]
 ds_read_b128 v[132:135], v2 offset:17408
 v_mfma_f32_16x16x32_bf16 v[28:31], v[92:95], v[100:103], v[28:31]
 ds_read_b128 v[120:123], v3 offset:16384
 v_mfma_f32_16x16x32_bf16 v[32:35], v[96:99], v[100:103], v[32:35]
 ds_read_b128 v[124:127], v3 offset:17408
 v_mfma_f32_16x16x32_bf16 v[36:39], v[84:87], v[104:107], v[36:39]
 ds_read_b128 v[128:131], v3 offset:18432
 v_mfma_f32_16x16x32_bf16 v[40:43], v[88:91], v[104:107], v[40:43]
 ds_read_b128 v[136:139], v2 offset:19456
 v_mfma_f32_16x16x32_bf16 v[44:47], v[92:95], v[104:107], v[44:47]
 ds_read_b128 v[140:143], v2 offset:21504
 v_mfma_f32_16x16x32_bf16 v[48:51], v[96:99], v[104:107], v[48:51]
 ds_read_b128 v[144:147], v2 offset:23552
 v_mfma_f32_16x16x32_bf16 v[52:55], v[84:87], v[108:111], v[52:55]
 v_mfma_f32_16x16x32_bf16 v[56:59], v[88:91], v[108:111], v[56:59]
 v_mfma_f32_16x16x32_bf16 v[60:63], v[92:95], v[108:111], v[60:63]
 v_mfma_f32_16x16x32_bf16 v[64:67], v[96:99], v[108:111], v[64:67]
 v_mfma_f32_16x16x32_bf16 v[68:71], v[84:87], v[112:115], v[68:71]
 v_mfma_f32_16x16x32_bf16 v[72:75], v[88:91], v[112:115], v[72:75]
 v_mfma_f32_16x16x32_bf16 v[76:79], v[92:95], v[112:115], v[76:79]
 v_mfma_f32_16x16x32_bf16 v[80:83], v[96:99], v[112:115], v[80:83]
 s_waitcnt lgkmcnt(0)
 v_mfma_f32_16x16x32_bf16 v[20:23], v[116:119], v[132:135], v[20:23]
 s_barrier
 ds_read_b128 v[84:87], v3 offset:30720
 v_mfma_f32_16x16x32_bf16 v[24:27], v[120:123], v[132:135], v[24:27]
 ds_read_b128 v[100:103], v2 offset:24576
 v_mfma_f32_16x16x32_bf16 v[28:31], v[124:127], v[132:135], v[28:31]
 ds_read_b128 v[88:91], v3 offset:31744
 v_mfma_f32_16x16x32_bf16 v[32:35], v[128:131], v[132:135], v[32:35]
 ds_read_b128 v[92:95], v3 offset:32768
 v_mfma_f32_16x16x32_bf16 v[36:39], v[116:119], v[136:139], v[36:39]
 ds_read_b128 v[96:99], v3 offset:33792
 v_mfma_f32_16x16x32_bf16 v[40:43], v[120:123], v[136:139], v[40:43]
 ds_read_b128 v[104:107], v2 offset:26624
 v_mfma_f32_16x16x32_bf16 v[44:47], v[124:127], v[136:139], v[44:47]
 ds_read_b128 v[108:111], v2 offset:28672
 v_mfma_f32_16x16x32_bf16 v[48:51], v[128:131], v[136:139], v[48:51]
 ds_read_b128 v[112:115], v2 offset:30720
 v_mfma_f32_16x16x32_bf16 v[52:55], v[116:119], v[140:143], v[52:55]
 v_mfma_f32_16x16x32_bf16 v[56:59], v[120:123], v[140:143], v[56:59]
 v_mfma_f32_16x16x32_bf16 v[60:63], v[124:127], v[140:143], v[60:63]
 v_mfma_f32_16x16x32_bf16 v[64:67], v[128:131], v[140:143], v[64:67]
 v_mfma_f32_16x16x32_bf16 v[68:71], v[116:119], v[144:147], v[68:71]
 v_mfma_f32_16x16x32_bf16 v[72:75], v[120:123], v[144:147], v[72:75]
 v_mfma_f32_16x16x32_bf16 v[76:79], v[124:127], v[144:147], v[76:79]
 v_mfma_f32_16x16x32_bf16 v[80:83], v[128:131], v[144:147], v[80:83]
 s_waitcnt lgkmcnt(0)
 v_mfma_f32_16x16x32_bf16 v[20:23], v[84:87], v[100:103], v[20:23]
 ds_read_b128 v[116:119], v3 offset:46080
 v_mfma_f32_16x16x32_bf16 v[24:27], v[88:91], v[100:103], v[24:27]
 ds_read_b128 v[132:135], v2 offset:25600
 v_mfma_f32_16x16x32_bf16 v[28:31], v[92:95], v[100:103], v[28:31]
 ds_read_b128 v[120:123], v3 offset:47104
 v_mfma_f32_16x16x32_bf16 v[32:35], v[96:99], v[100:103], v[32:35]
 ds_read_b128 v[124:127], v3 offset:48128
 v_mfma_f32_16x16x32_bf16 v[36:39], v[84:87], v[104:107], v[36:39]
 ds_read_b128 v[128:131], v3 offset:49152
 v_mfma_f32_16x16x32_bf16 v[40:43], v[88:91], v[104:107], v[40:43]
 ds_read_b128 v[136:139], v2 offset:27648
 v_mfma_f32_16x16x32_bf16 v[44:47], v[92:95], v[104:107], v[44:47]
 ds_read_b128 v[140:143], v2 offset:29696
 v_mfma_f32_16x16x32_bf16 v[48:51], v[96:99], v[104:107], v[48:51]
 ds_read_b128 v[144:147], v2 offset:31744
 v_mfma_f32_16x16x32_bf16 v[52:55], v[84:87], v[108:111], v[52:55]
 v_mfma_f32_16x16x32_bf16 v[56:59], v[88:91], v[108:111], v[56:59]
 v_mfma_f32_16x16x32_bf16 v[60:63], v[92:95], v[108:111], v[60:63]
 v_mfma_f32_16x16x32_bf16 v[64:67], v[96:99], v[108:111], v[64:67]
 v_mfma_f32_16x16x32_bf16 v[68:71], v[84:87], v[112:115], v[68:71]
 v_mfma_f32_16x16x32_bf16 v[72:75], v[88:91], v[112:115], v[72:75]
 v_mfma_f32_16x16x32_bf16 v[76:79], v[92:95], v[112:115], v[76:79]
 v_mfma_f32_16x16x32_bf16 v[80:83], v[96:99], v[112:115], v[80:83]
 s_waitcnt lgkmcnt(0)
 v_mfma_f32_16x16x32_bf16 v[20:23], v[116:119], v[132:135], v[20:23]
 s_barrier
 ds_read_b128 v[84:87], v3 offset:61440
 v_mfma_f32_16x16x32_bf16 v[24:27], v[120:123], v[132:135], v[24:27]
 ds_read_b128 v[100:103], v2 offset:32768
 v_mfma_f32_16x16x32_bf16 v[28:31], v[124:127], v[132:135], v[28:31]
 ds_read_b128 v[88:91], v3 offset:62464
 v_mfma_f32_16x16x32_bf16 v[32:35], v[128:131], v[132:135], v[32:35]
 ds_read_b128 v[92:95], v3 offset:63488
 v_mfma_f32_16x16x32_bf16 v[36:39], v[116:119], v[136:139], v[36:39]
 ds_read_b128 v[96:99], v3 offset:64512
 v_mfma_f32_16x16x32_bf16 v[40:43], v[120:123], v[136:139], v[40:43]
 ds_read_b128 v[104:107], v2 offset:34816
 v_mfma_f32_16x16x32_bf16 v[44:47], v[124:127], v[136:139], v[44:47]
 ds_read_b128 v[108:111], v2 offset:36864
 v_mfma_f32_16x16x32_bf16 v[48:51], v[128:131], v[136:139], v[48:51]
 ds_read_b128 v[112:115], v2 offset:38912
 v_mfma_f32_16x16x32_bf16 v[52:55], v[116:119], v[140:143], v[52:55]
 v_mfma_f32_16x16x32_bf16 v[56:59], v[120:123], v[140:143], v[56:59]
 v_mfma_f32_16x16x32_bf16 v[60:63], v[124:127], v[140:143], v[60:63]
 v_mfma_f32_16x16x32_bf16 v[64:67], v[128:131], v[140:143], v[64:67]
 v_mfma_f32_16x16x32_bf16 v[68:71], v[116:119], v[144:147], v[68:71]
 v_mfma_f32_16x16x32_bf16 v[72:75], v[120:123], v[144:147], v[72:75]
 v_mfma_f32_16x16x32_bf16 v[76:79], v[124:127], v[144:147], v[76:79]
 v_mfma_f32_16x16x32_bf16 v[80:83], v[128:131], v[144:147], v[80:83]
 s_waitcnt lgkmcnt(0)
 v_mfma_f32_16x16x32_bf16 v[20:23], v[84:87], v[100:103], v[20:23]
 ds_read_b128 v[116:119], v4 offset:11264
 v_mfma_f32_16x16x32_bf16 v[24:27], v[88:91], v[100:103], v[24:27]
 ds_read_b128 v[132:135], v2 offset:33792
 v_mfma_f32_16x16x32_bf16 v[28:31], v[92:95], v[100:103], v[28:31]
 ds_read_b128 v[120:123], v4 offset:12288
 v_mfma_f32_16x16x32_bf16 v[32:35], v[96:99], v[100:103], v[32:35]
 ds_read_b128 v[124:127], v4 offset:13312
 v_mfma_f32_16x16x32_bf16 v[36:39], v[84:87], v[104:107], v[36:39]
 ds_read_b128 v[128:131], v4 offset:14336
 v_mfma_f32_16x16x32_bf16 v[40:43], v[88:91], v[104:107], v[40:43]
 ds_read_b128 v[136:139], v2 offset:35840
 v_mfma_f32_16x16x32_bf16 v[44:47], v[92:95], v[104:107], v[44:47]
 ds_read_b128 v[140:143], v2 offset:37888
 v_mfma_f32_16x16x32_bf16 v[48:51], v[96:99], v[104:107], v[48:51]
 ds_read_b128 v[144:147], v2 offset:39936
 v_mfma_f32_16x16x32_bf16 v[52:55], v[84:87], v[108:111], v[52:55]
 v_mfma_f32_16x16x32_bf16 v[56:59], v[88:91], v[108:111], v[56:59]
 v_mfma_f32_16x16x32_bf16 v[60:63], v[92:95], v[108:111], v[60:63]
 v_mfma_f32_16x16x32_bf16 v[64:67], v[96:99], v[108:111], v[64:67]
 v_mfma_f32_16x16x32_bf16 v[68:71], v[84:87], v[112:115], v[68:71]
 v_mfma_f32_16x16x32_bf16 v[72:75], v[88:91], v[112:115], v[72:75]
 v_mfma_f32_16x16x32_bf16 v[76:79], v[92:95], v[112:115], v[76:79]
 v_mfma_f32_16x16x32_bf16 v[80:83], v[96:99], v[112:115], v[80:83]
 s_waitcnt lgkmcnt(0)
 v_mfma_f32_16x16x32_bf16 v[20:23], v[116:119], v[132:135], v[20:23]
 s_barrier
 ds_read_b128 v[84:87], v4 offset:26624
 v_mfma_f32_16x16x32_bf16 v[24:27], v[120:123], v[132:135], v[24:27]
 ds_read_b128 v[100:103], v2 offset:40960
 v_mfma_f32_16x16x32_bf16 v[28:31], v[124:127], v[132:135], v[28:31]
 ds_read_b128 v[88:91], v4 offset:27648
 v_mfma_f32_16x16x32_bf16 v[32:35], v[128:131], v[132:135], v[32:35]
 ds_read_b128 v[92:95], v4 offset:28672
 v_mfma_f32_16x16x32_bf16 v[36:39], v[116:119], v[136:139], v[36:39]
 ds_read_b128 v[96:99], v4 offset:29696
 v_mfma_f32_16x16x32_bf16 v[40:43], v[120:123], v[136:139], v[40:43]
 ds_read_b128 v[104:107], v2 offset:43008
 v_mfma_f32_16x16x32_bf16 v[44:47], v[124:127], v[136:139], v[44:47]
 ds_read_b128 v[108:111], v2 offset:45056
 v_mfma_f32_16x16x32_bf16 v[48:51], v[128:131], v[136:139], v[48:51]
 ds_read_b128 v[112:115], v2 offset:47104
 v_mfma_f32_16x16x32_bf16 v[52:55], v[116:119], v[140:143], v[52:55]
 v_mfma_f32_16x16x32_bf16 v[56:59], v[120:123], v[140:143], v[56:59]
 v_mfma_f32_16x16x32_bf16 v[60:63], v[124:127], v[140:143], v[60:63]
 v_mfma_f32_16x16x32_bf16 v[64:67], v[128:131], v[140:143], v[64:67]
 v_mfma_f32_16x16x32_bf16 v[68:71], v[116:119], v[144:147], v[68:71]
 v_mfma_f32_16x16x32_bf16 v[72:75], v[120:123], v[144:147], v[72:75]
 v_mfma_f32_16x16x32_bf16 v[76:79], v[124:127], v[144:147], v[76:79]
 v_mfma_f32_16x16x32_bf16 v[80:83], v[128:131], v[144:147], v[80:83]
 s_waitcnt lgkmcnt(0)
 v_mfma_f32_16x16x32_bf16 v[20:23], v[84:87], v[100:103], v[20:23]
 ds_read_b128 v[116:119], v3 offset:0
 v_mfma_f32_16x16x32_bf16 v[24:27], v[88:91], v[100:103], v[24:27]
 ds_read_b128 v[132:135], v2 offset:41984
 v_mfma_f32_16x16x32_bf16 v[28:31], v[92:95], v[100:103], v[28:31]
 ds_read_b128 v[120:123], v3 offset:1024
 v_mfma_f32_16x16x32_bf16 v[32:35], v[96:99], v[100:103], v[32:35]
 ds_read_b128 v[124:127], v3 offset:2048
 v_mfma_f32_16x16x32_bf16 v[36:39], v[84:87], v[104:107], v[36:39]
 ds_read_b128 v[128:131], v3 offset:3072
 v_mfma_f32_16x16x32_bf16 v[40:43], v[88:91], v[104:107], v[40:43]
 ds_read_b128 v[136:139], v2 offset:44032
 v_mfma_f32_16x16x32_bf16 v[44:47], v[92:95], v[104:107], v[44:47]
 ds_read_b128 v[140:143], v2 offset:46080
 v_mfma_f32_16x16x32_bf16 v[48:51], v[96:99], v[104:107], v[48:51]
 ds_read_b128 v[144:147], v2 offset:48128
 v_mfma_f32_16x16x32_bf16 v[52:55], v[84:87], v[108:111], v[52:55]
 v_mfma_f32_16x16x32_bf16 v[56:59], v[88:91], v[108:111], v[56:59]
 v_mfma_f32_16x16x32_bf16 v[60:63], v[92:95], v[108:111], v[60:63]
 v_mfma_f32_16x16x32_bf16 v[64:67], v[96:99], v[108:111], v[64:67]
 v_mfma_f32_16x16x32_bf16 v[68:71], v[84:87], v[112:115], v[68:71]
 v_mfma_f32_16x16x32_bf16 v[72:75], v[88:91], v[112:115], v[72:75]
 v_mfma_f32_16x16x32_bf16 v[76:79], v[92:95], v[112:115], v[76:79]
 v_mfma_f32_16x16x32_bf16 v[80:83], v[96:99], v[112:115], v[80:83]
 s_waitcnt lgkmcnt(0)
 v_mfma_f32_16x16x32_bf16 v[20:23], v[116:119], v[132:135], v[20:23]
 s_barrier
 ds_read_b128 v[84:87], v3 offset:15360
 v_mfma_f32_16x16x32_bf16 v[24:27], v[120:123], v[132:135], v[24:27]
 ds_read_b128 v[100:103], v2 offset:0
 v_mfma_f32_16x16x32_bf16 v[28:31], v[124:127], v[132:135], v[28:31]
 ds_read_b128 v[88:91], v3 offset:16384
 v_mfma_f32_16x16x32_bf16 v[32:35], v[128:131], v[132:135], v[32:35]
 ds_read_b128 v[92:95], v3 offset:17408
 v_mfma_f32_16x16x32_bf16 v[36:39], v[116:119], v[136:139], v[36:39]
 ds_read_b128 v[96:99], v3 offset:18432
 v_mfma_f32_16x16x32_bf16 v[40:43], v[120:123], v[136:139], v[40:43]
 ds_read_b128 v[104:107], v2 offset:2048
 v_mfma_f32_16x16x32_bf16 v[44:47], v[124:127], v[136:139], v[44:47]
 ds_read_b128 v[108:111], v2 offset:4096
 v_mfma_f32_16x16x32_bf16 v[48:51], v[128:131], v[136:139], v[48:51]
 ds_read_b128 v[112:115], v2 offset:6144
 v_mfma_f32_16x16x32_bf16 v[52:55], v[116:119], v[140:143], v[52:55]
 v_mfma_f32_16x16x32_bf16 v[56:59], v[120:123], v[140:143], v[56:59]
 v_mfma_f32_16x16x32_bf16 v[60:63], v[124:127], v[140:143], v[60:63]
 v_mfma_f32_16x16x32_bf16 v[64:67], v[128:131], v[140:143], v[64:67]
 v_mfma_f32_16x16x32_bf16 v[68:71], v[116:119], v[144:147], v[68:71]
 v_mfma_f32_16x16x32_bf16 v[72:75], v[120:123], v[144:147], v[72:75]
 v_mfma_f32_16x16x32_bf16 v[76:79], v[124:127], v[144:147], v[76:79]
 v_mfma_f32_16x16x32_bf16 v[80:83], v[128:131], v[144:147], v[80:83]
 s_waitcnt lgkmcnt(0)
 v_mfma_f32_16x16x32_bf16 v[20:23], v[84:87], v[100:103], v[20:23]
 ds_read_b128 v[116:119], v3 offset:30720
 v_mfma_f32_16x16x32_bf16 v[24:27], v[88:91], v[100:103], v[24:27]
 ds_read_b128 v[132:135], v2 offset:1024
 v_mfma_f32_16x16x32_bf16 v[28:31], v[92:95], v[100:103], v[28:31]
 ds_read_b128 v[120:123], v3 offset:31744
 v_mfma_f32_16x16x32_bf16 v[32:35], v[96:99], v[100:103], v[32:35]
 ds_read_b128 v[124:127], v3 offset:32768
 v_mfma_f32_16x16x32_bf16 v[36:39], v[84:87], v[104:107], v[36:39]
 ds_read_b128 v[128:131], v3 offset:33792
 v_mfma_f32_16x16x32_bf16 v[40:43], v[88:91], v[104:107], v[40:43]
 ds_read_b128 v[136:139], v2 offset:3072
 v_mfma_f32_16x16x32_bf16 v[44:47], v[92:95], v[104:107], v[44:47]
 ds_read_b128 v[140:143], v2 offset:5120
 v_mfma_f32_16x16x32_bf16 v[48:51], v[96:99], v[104:107], v[48:51]
 ds_read_b128 v[144:147], v2 offset:7168
 v_mfma_f32_16x16x32_bf16 v[52:55], v[84:87], v[108:111], v[52:55]
 v_mfma_f32_16x16x32_bf16 v[56:59], v[88:91], v[108:111], v[56:59]
 v_mfma_f32_16x16x32_bf16 v[60:63], v[92:95], v[108:111], v[60:63]
 v_mfma_f32_16x16x32_bf16 v[64:67], v[96:99], v[108:111], v[64:67]
 v_mfma_f32_16x16x32_bf16 v[68:71], v[84:87], v[112:115], v[68:71]
 v_mfma_f32_16x16x32_bf16 v[72:75], v[88:91], v[112:115], v[72:75]
 v_mfma_f32_16x16x32_bf16 v[76:79], v[92:95], v[112:115], v[76:79]
 v_mfma_f32_16x16x32_bf16 v[80:83], v[96:99], v[112:115], v[80:83]
 s_waitcnt lgkmcnt(0)
 v_mfma_f32_16x16x32_bf16 v[20:23], v[116:119], v[132:135], v[20:23]
 s_barrier
 ds_read_b128 v[84:87], v3 offset:46080
 v_mfma_f32_16x16x32_bf16 v[24:27], v[120:123], v[132:135], v[24:27]
 ds_read_b128 v[100:103], v2 offset:8192
 v_mfma_f32_16x16x32_bf16 v[28:31], v[124:127], v[132:135], v[28:31]
 ds_read_b128 v[88:91], v3 offset:47104
 v_mfma_f32_16x16x32_bf16 v[32:35], v[128:131], v[132:135], v[32:35]
 ds_read_b128 v[92:95], v3 offset:48128
 v_mfma_f32_16x16x32_bf16 v[36:39], v[116:119], v[136:139], v[36:39]
 ds_read_b128 v[96:99], v3 offset:49152
 v_mfma_f32_16x16x32_bf16 v[40:43], v[120:123], v[136:139], v[40:43]
 ds_read_b128 v[104:107], v2 offset:10240
 v_mfma_f32_16x16x32_bf16 v[44:47], v[124:127], v[136:139], v[44:47]
 ds_read_b128 v[108:111], v2 offset:12288
 v_mfma_f32_16x16x32_bf16 v[48:51], v[128:131], v[136:139], v[48:51]
 ds_read_b128 v[112:115], v2 offset:14336
 v_mfma_f32_16x16x32_bf16 v[52:55], v[116:119], v[140:143], v[52:55]
 v_mfma_f32_16x16x32_bf16 v[56:59], v[120:123], v[140:143], v[56:59]
 v_mfma_f32_16x16x32_bf16 v[60:63], v[124:127], v[140:143], v[60:63]
 v_mfma_f32_16x16x32_bf16 v[64:67], v[128:131], v[140:143], v[64:67]
 v_mfma_f32_16x16x32_bf16 v[68:71], v[116:119], v[144:147], v[68:71]
 v_mfma_f32_16x16x32_bf16 v[72:75], v[120:123], v[144:147], v[72:75]
 v_mfma_f32_16x16x32_bf16 v[76:79], v[124:127], v[144:147], v[76:79]
 v_mfma_f32_16x16x32_bf16 v[80:83], v[128:131], v[144:147], v[80:83]
 s_waitcnt lgkmcnt(0)
 v_mfma_f32_16x16x32_bf16 v[20:23], v[84:87], v[100:103], v[20:23]
 ds_read_b128 v[116:119], v3 offset:61440
 v_mfma_f32_16x16x32_bf16 v[24:27], v[88:91], v[100:103], v[24:27]
 ds_read_b128 v[132:135], v2 offset:9216
 v_mfma_f32_16x16x32_bf16 v[28:31], v[92:95], v[100:103], v[28:31]
 ds_read_b128 v[120:123], v3 offset:62464
 v_mfma_f32_16x16x32_bf16 v[32:35], v[96:99], v[100:103], v[32:35]
 ds_read_b128 v[124:127], v3 offset:63488
 v_mfma_f32_16x16x32_bf16 v[36:39], v[84:87], v[104:107], v[36:39]
 ds_read_b128 v[128:131], v3 offset:64512
 v_mfma_f32_16x16x32_bf16 v[40:43], v[88:91], v[104:107], v[40:43]
 ds_read_b128 v[136:139], v2 offset:11264
 v_mfma_f32_16x16x32_bf16 v[44:47], v[92:95], v[104:107], v[44:47]
 ds_read_b128 v[140:143], v2 offset:13312
 v_mfma_f32_16x16x32_bf16 v[48:51], v[96:99], v[104:107], v[48:51]
 ds_read_b128 v[144:147], v2 offset:15360
 v_mfma_f32_16x16x32_bf16 v[52:55], v[84:87], v[108:111], v[52:55]
 v_mfma_f32_16x16x32_bf16 v[56:59], v[88:91], v[108:111], v[56:59]
 v_mfma_f32_16x16x32_bf16 v[60:63], v[92:95], v[108:111], v[60:63]
 v_mfma_f32_16x16x32_bf16 v[64:67], v[96:99], v[108:111], v[64:67]
 v_mfma_f32_16x16x32_bf16 v[68:71], v[84:87], v[112:115], v[68:71]
 v_mfma_f32_16x16x32_bf16 v[72:75], v[88:91], v[112:115], v[72:75]
 v_mfma_f32_16x16x32_bf16 v[76:79], v[92:95], v[112:115], v[76:79]
 v_mfma_f32_16x16x32_bf16 v[80:83], v[96:99], v[112:115], v[80:83]
 s_waitcnt lgkmcnt(0)
 v_mfma_f32_16x16x32_bf16 v[20:23], v[116:119], v[132:135], v[20:23]
 s_barrier
 ds_read_b128 v[84:87], v4 offset:11264
 v_mfma_f32_16x16x32_bf16 v[24:27], v[120:123], v[132:135], v[24:27]
 ds_read_b128 v[100:103], v2 offset:16384
 v_mfma_f32_16x16x32_bf16 v[28:31], v[124:127], v[132:135], v[28:31]
 ds_read_b128 v[88:91], v4 offset:12288
 v_mfma_f32_16x16x32_bf16 v[32:35], v[128:131], v[132:135], v[32:35]
 ds_read_b128 v[92:95], v4 offset:13312
 v_mfma_f32_16x16x32_bf16 v[36:39], v[116:119], v[136:139], v[36:39]
 ds_read_b128 v[96:99], v4 offset:14336
 v_mfma_f32_16x16x32_bf16 v[40:43], v[120:123], v[136:139], v[40:43]
 ds_read_b128 v[104:107], v2 offset:18432
 v_mfma_f32_16x16x32_bf16 v[44:47], v[124:127], v[136:139], v[44:47]
 ds_read_b128 v[108:111], v2 offset:20480
 v_mfma_f32_16x16x32_bf16 v[48:51], v[128:131], v[136:139], v[48:51]
 ds_read_b128 v[112:115], v2 offset:22528
 v_mfma_f32_16x16x32_bf16 v[52:55], v[116:119], v[140:143], v[52:55]
 v_mfma_f32_16x16x32_bf16 v[56:59], v[120:123], v[140:143], v[56:59]
 v_mfma_f32_16x16x32_bf16 v[60:63], v[124:127], v[140:143], v[60:63]
 v_mfma_f32_16x16x32_bf16 v[64:67], v[128:131], v[140:143], v[64:67]
 v_mfma_f32_16x16x32_bf16 v[68:71], v[116:119], v[144:147], v[68:71]
 v_mfma_f32_16x16x32_bf16 v[72:75], v[120:123], v[144:147], v[72:75]
 v_mfma_f32_16x16x32_bf16 v[76:79], v[124:127], v[144:147], v[76:79]
 v_mfma_f32_16x16x32_bf16 v[80:83], v[128:131], v[144:147], v[80:83]
 s_waitcnt lgkmcnt(0)
 v_mfma_f32_16x16x32_bf16 v[20:23], v[84:87], v[100:103], v[20:23]
 ds_read_b128 v[116:119], v4 offset:26624
 v_mfma_f32_16x16x32_bf16 v[24:27], v[88:91], v[100:103], v[24:27]
 ds_read_b128 v[132:135], v2 offset:17408
 v_mfma_f32_16x16x32_bf16 v[28:31], v[92:95], v[100:103], v[28:31]
 ds_read_b128 v[120:123], v4 offset:27648
 v_mfma_f32_16x16x32_bf16 v[32:35], v[96:99], v[100:103], v[32:35]
 ds_read_b128 v[124:127], v4 offset:28672
 v_mfma_f32_16x16x32_bf16 v[36:39], v[84:87], v[104:107], v[36:39]
 ds_read_b128 v[128:131], v4 offset:29696
 v_mfma_f32_16x16x32_bf16 v[40:43], v[88:91], v[104:107], v[40:43]
 ds_read_b128 v[136:139], v2 offset:19456
 v_mfma_f32_16x16x32_bf16 v[44:47], v[92:95], v[104:107], v[44:47]
 ds_read_b128 v[140:143], v2 offset:21504
 v_mfma_f32_16x16x32_bf16 v[48:51], v[96:99], v[104:107], v[48:51]
 ds_read_b128 v[144:147], v2 offset:23552
 v_mfma_f32_16x16x32_bf16 v[52:55], v[84:87], v[108:111], v[52:55]
 v_mfma_f32_16x16x32_bf16 v[56:59], v[88:91], v[108:111], v[56:59]
 v_mfma_f32_16x16x32_bf16 v[60:63], v[92:95], v[108:111], v[60:63]
 v_mfma_f32_16x16x32_bf16 v[64:67], v[96:99], v[108:111], v[64:67]
 v_mfma_f32_16x16x32_bf16 v[68:71], v[84:87], v[112:115], v[68:71]
 v_mfma_f32_16x16x32_bf16 v[72:75], v[88:91], v[112:115], v[72:75]
 v_mfma_f32_16x16x32_bf16 v[76:79], v[92:95], v[112:115], v[76:79]
 v_mfma_f32_16x16x32_bf16 v[80:83], v[96:99], v[112:115], v[80:83]
 s_waitcnt lgkmcnt(0)
 v_mfma_f32_16x16x32_bf16 v[20:23], v[116:119], v[132:135], v[20:23]
 s_barrier
 ds_read_b128 v[84:87], v3 offset:0
 v_mfma_f32_16x16x32_bf16 v[24:27], v[120:123], v[132:135], v[24:27]
 ds_read_b128 v[100:103], v2 offset:24576
 v_mfma_f32_16x16x32_bf16 v[28:31], v[124:127], v[132:135], v[28:31]
 ds_read_b128 v[88:91], v3 offset:1024
 v_mfma_f32_16x16x32_bf16 v[32:35], v[128:131], v[132:135], v[32:35]
 ds_read_b128 v[92:95], v3 offset:2048
 v_mfma_f32_16x16x32_bf16 v[36:39], v[116:119], v[136:139], v[36:39]
 ds_read_b128 v[96:99], v3 offset:3072
 v_mfma_f32_16x16x32_bf16 v[40:43], v[120:123], v[136:139], v[40:43]
 ds_read_b128 v[104:107], v2 offset:26624
 v_mfma_f32_16x16x32_bf16 v[44:47], v[124:127], v[136:139], v[44:47]
 ds_read_b128 v[108:111], v2 offset:28672
 v_mfma_f32_16x16x32_bf16 v[48:51], v[128:131], v[136:139], v[48:51]
 ds_read_b128 v[112:115], v2 offset:30720
 v_mfma_f32_16x16x32_bf16 v[52:55], v[116:119], v[140:143], v[52:55]
 v_mfma_f32_16x16x32_bf16 v[56:59], v[120:123], v[140:143], v[56:59]
 v_mfma_f32_16x16x32_bf16 v[60:63], v[124:127], v[140:143], v[60:63]
 v_mfma_f32_16x16x32_bf16 v[64:67], v[128:131], v[140:143], v[64:67]
 v_mfma_f32_16x16x32_bf16 v[68:71], v[116:119], v[144:147], v[68:71]
 v_mfma_f32_16x16x32_bf16 v[72:75], v[120:123], v[144:147], v[72:75]
 v_mfma_f32_16x16x32_bf16 v[76:79], v[124:127], v[144:147], v[76:79]
 v_mfma_f32_16x16x32_bf16 v[80:83], v[128:131], v[144:147], v[80:83]
 s_waitcnt lgkmcnt(0)
 v_mfma_f32_16x16x32_bf16 v[20:23], v[84:87], v[100:103], v[20:23]
 ds_read_b128 v[116:119], v3 offset:15360
 v_mfma_f32_16x16x32_bf16 v[24:27], v[88:91], v[100:103], v[24:27]
 ds_read_b128 v[132:135], v2 offset:25600
 v_mfma_f32_16x16x32_bf16 v[28:31], v[92:95], v[100:103], v[28:31]
 ds_read_b128 v[120:123], v3 offset:16384
 v_mfma_f32_16x16x32_bf16 v[32:35], v[96:99], v[100:103], v[32:35]
 ds_read_b128 v[124:127], v3 offset:17408
 v_mfma_f32_16x16x32_bf16 v[36:39], v[84:87], v[104:107], v[36:39]
 ds_read_b128 v[128:131], v3 offset:18432
 v_mfma_f32_16x16x32_bf16 v[40:43], v[88:91], v[104:107], v[40:43]
 ds_read_b128 v[136:139], v2 offset:27648
 v_mfma_f32_16x16x32_bf16 v[44:47], v[92:95], v[104:107], v[44:47]
 ds_read_b128 v[140:143], v2 offset:29696
 v_mfma_f32_16x16x32_bf16 v[48:51], v[96:99], v[104:107], v[48:51]
 ds_read_b128 v[144:147], v2 offset:31744
 v_mfma_f32_16x16x32_bf16 v[52:55], v[84:87], v[108:111], v[52:55]
 v_mfma_f32_16x16x32_bf16 v[56:59], v[88:91], v[108:111], v[56:59]
 v_mfma_f32_16x16x32_bf16 v[60:63], v[92:95], v[108:111], v[60:63]
 v_mfma_f32_16x16x32_bf16 v[64:67], v[96:99], v[108:111], v[64:67]
 v_mfma_f32_16x16x32_bf16 v[68:71], v[84:87], v[112:115], v[68:71]
 v_mfma_f32_16x16x32_bf16 v[72:75], v[88:91], v[112:115], v[72:75]
 v_mfma_f32_16x16x32_bf16 v[76:79], v[92:95], v[112:115], v[76:79]
 v_mfma_f32_16x16x32_bf16 v[80:83], v[96:99], v[112:115], v[80:83]
 s_waitcnt lgkmcnt(0)
 v_mfma_f32_16x16x32_bf16 v[20:23], v[116:119], v[132:135], v[20:23]
 s_barrier
 v_mfma_f32_16x16x32_bf16 v[24:27], v[120:123], v[132:135], v[24:27]
 ds_read_b32 v84, v8 offset:0
 ds_read_b32 v85, v8 offset:64
 v_mfma_f32_16x16x32_bf16 v[28:31], v[124:127], v[132:135], v[28:31]
 ds_read_b32 v86, v8 offset:128
 ds_read_b32 v87, v8 offset:192
 v_mfma_f32_16x16x32_bf16 v[32:35], v[128:131], v[132:135], v[32:35]
 ds_read_b32 v88, v8 offset:256
 ds_read_b32 v89, v8 offset:320
 v_mfma_f32_16x16x32_bf16 v[36:39], v[116:119], v[136:139], v[36:39]
 ds_read_b32 v90, v8 offset:384
 ds_read_b32 v91, v8 offset:448
 v_mfma_f32_16x16x32_bf16 v[40:43], v[120:123], v[136:139], v[40:43]
 v_mfma_f32_16x16x32_bf16 v[44:47], v[124:127], v[136:139], v[44:47]
 v_mfma_f32_16x16x32_bf16 v[48:51], v[128:131], v[136:139], v[48:51]
 v_mfma_f32_16x16x32_bf16 v[52:55], v[116:119], v[140:143], v[52:55]
 v_mfma_f32_16x16x32_bf16 v[56:59], v[120:123], v[140:143], v[56:59]
 v_mfma_f32_16x16x32_bf16 v[60:63], v[124:127], v[140:143], v[60:63]
 v_mfma_f32_16x16x32_bf16 v[64:67], v[128:131], v[140:143], v[64:67]
 v_mfma_f32_16x16x32_bf16 v[68:71], v[116:119], v[144:147], v[68:71]
 v_mfma_f32_16x16x32_bf16 v[72:75], v[120:123], v[144:147], v[72:75]
 v_mfma_f32_16x16x32_bf16 v[76:79], v[124:127], v[144:147], v[76:79]
 v_mfma_f32_16x16x32_bf16 v[80:83], v[128:131], v[144:147], v[80:83]
 s_waitcnt vmcnt(0) lgkmcnt(0)
 v_mul_f32 v84, s27, v84
 v_mul_f32 v85, s27, v85
 v_mul_f32 v86, s27, v86
 v_mul_f32 v87, s27, v87
 v_mul_f32 v88, s27, v88
 v_mul_f32 v89, s27, v89
 v_mul_f32 v90, s27, v90
 v_mul_f32 v91, s27, v91
 v_pk_mul_f32 v[204:205], v[180:181], v[88:89] op_sel:[0,0] op_sel_hi:[1,0]
 v_pk_mul_f32 v[206:207], v[182:183], v[88:89] op_sel:[0,0] op_sel_hi:[1,0]
 v_pk_mul_f32 v[208:209], v[180:181], v[88:89] op_sel:[0,1] op_sel_hi:[1,1]
 v_pk_mul_f32 v[210:211], v[182:183], v[88:89] op_sel:[0,1] op_sel_hi:[1,1]
 v_pk_fma_f32 v[204:205], v[20:21], v[84:85], v[204:205] op_sel:[0,0,0] op_sel_hi:[1,0,1] neg_lo:[0,0,1] neg_hi:[0,0,1]
 v_pk_fma_f32 v[206:207], v[22:23], v[84:85], v[206:207] op_sel:[0,0,0] op_sel_hi:[1,0,1] neg_lo:[0,0,1] neg_hi:[0,0,1]
 v_pk_fma_f32 v[208:209], v[36:37], v[84:85], v[208:209] op_sel:[0,1,0] op_sel_hi:[1,1,1] neg_lo:[0,0,1] neg_hi:[0,0,1]
 v_pk_fma_f32 v[210:211], v[38:39], v[84:85], v[210:211] op_sel:[0,1,0] op_sel_hi:[1,1,1] neg_lo:[0,0,1] neg_hi:[0,0,1]
 v_cvt_pk_bf16_f32 v212, v204, v205
 v_cvt_pk_bf16_f32 v213, v206, v207
 v_cvt_pk_bf16_f32 v214, v208, v209
 v_cvt_pk_bf16_f32 v215, v210, v211
 s_nop 0
 v_permlane16_swap_b32 v212, v214
 v_permlane16_swap_b32 v213, v215
 buffer_store_dwordx4 v[212:215], v203, s[4:7], s30 offen offset:0
 v_pk_mul_f32 v[220:221], v[180:181], v[90:91] op_sel:[0,0] op_sel_hi:[1,0]
 v_pk_mul_f32 v[222:223], v[182:183], v[90:91] op_sel:[0,0] op_sel_hi:[1,0]
 v_pk_mul_f32 v[224:225], v[180:181], v[90:91] op_sel:[0,1] op_sel_hi:[1,1]
 v_pk_mul_f32 v[226:227], v[182:183], v[90:91] op_sel:[0,1] op_sel_hi:[1,1]
 v_pk_fma_f32 v[220:221], v[52:53], v[86:87], v[220:221] op_sel:[0,0,0] op_sel_hi:[1,0,1] neg_lo:[0,0,1] neg_hi:[0,0,1]
 v_pk_fma_f32 v[222:223], v[54:55], v[86:87], v[222:223] op_sel:[0,0,0] op_sel_hi:[1,0,1] neg_lo:[0,0,1] neg_hi:[0,0,1]
 v_pk_fma_f32 v[224:225], v[68:69], v[86:87], v[224:225] op_sel:[0,1,0] op_sel_hi:[1,1,1] neg_lo:[0,0,1] neg_hi:[0,0,1]
 v_pk_fma_f32 v[226:227], v[70:71], v[86:87], v[226:227] op_sel:[0,1,0] op_sel_hi:[1,1,1] neg_lo:[0,0,1] neg_hi:[0,0,1]
 v_cvt_pk_bf16_f32 v228, v220, v221
 v_cvt_pk_bf16_f32 v229, v222, v223
 v_cvt_pk_bf16_f32 v230, v224, v225
 v_cvt_pk_bf16_f32 v231, v226, v227
 s_nop 0
 v_permlane16_swap_b32 v228, v230
 v_permlane16_swap_b32 v229, v231
 buffer_store_dwordx4 v[228:231], v203, s[4:7], s29 offen offset:0
 v_pk_mul_f32 v[204:205], v[184:185], v[88:89] op_sel:[0,0] op_sel_hi:[1,0]
 v_pk_mul_f32 v[206:207], v[186:187], v[88:89] op_sel:[0,0] op_sel_hi:[1,0]
 v_pk_mul_f32 v[208:209], v[184:185], v[88:89] op_sel:[0,1] op_sel_hi:[1,1]
 v_pk_mul_f32 v[210:211], v[186:187], v[88:89] op_sel:[0,1] op_sel_hi:[1,1]
 v_pk_fma_f32 v[204:205], v[24:25], v[84:85], v[204:205] op_sel:[0,0,0] op_sel_hi:[1,0,1] neg_lo:[0,0,1] neg_hi:[0,0,1]
 v_pk_fma_f32 v[206:207], v[26:27], v[84:85], v[206:207] op_sel:[0,0,0] op_sel_hi:[1,0,1] neg_lo:[0,0,1] neg_hi:[0,0,1]
 v_pk_fma_f32 v[208:209], v[40:41], v[84:85], v[208:209] op_sel:[0,1,0] op_sel_hi:[1,1,1] neg_lo:[0,0,1] neg_hi:[0,0,1]
 v_pk_fma_f32 v[210:211], v[42:43], v[84:85], v[210:211] op_sel:[0,1,0] op_sel_hi:[1,1,1] neg_lo:[0,0,1] neg_hi:[0,0,1]
 v_cvt_pk_bf16_f32 v212, v204, v205
 v_cvt_pk_bf16_f32 v213, v206, v207
 v_cvt_pk_bf16_f32 v214, v208, v209
 v_cvt_pk_bf16_f32 v215, v210, v211
 s_nop 0
 v_permlane16_swap_b32 v212, v214
 v_permlane16_swap_b32 v213, v215
 buffer_store_dwordx4 v[212:215], v203, s[4:7], s30 offen offset:512
 v_pk_mul_f32 v[220:221], v[184:185], v[90:91] op_sel:[0,0] op_sel_hi:[1,0]
 v_pk_mul_f32 v[222:223], v[186:187], v[90:91] op_sel:[0,0] op_sel_hi:[1,0]
 v_pk_mul_f32 v[224:225], v[184:185], v[90:91] op_sel:[0,1] op_sel_hi:[1,1]
 v_pk_mul_f32 v[226:227], v[186:187], v[90:91] op_sel:[0,1] op_sel_hi:[1,1]
 v_pk_fma_f32 v[220:221], v[56:57], v[86:87], v[220:221] op_sel:[0,0,0] op_sel_hi:[1,0,1] neg_lo:[0,0,1] neg_hi:[0,0,1]
 v_pk_fma_f32 v[222:223], v[58:59], v[86:87], v[222:223] op_sel:[0,0,0] op_sel_hi:[1,0,1] neg_lo:[0,0,1] neg_hi:[0,0,1]
 v_pk_fma_f32 v[224:225], v[72:73], v[86:87], v[224:225] op_sel:[0,1,0] op_sel_hi:[1,1,1] neg_lo:[0,0,1] neg_hi:[0,0,1]
 v_pk_fma_f32 v[226:227], v[74:75], v[86:87], v[226:227] op_sel:[0,1,0] op_sel_hi:[1,1,1] neg_lo:[0,0,1] neg_hi:[0,0,1]
 v_cvt_pk_bf16_f32 v228, v220, v221
 v_cvt_pk_bf16_f32 v229, v222, v223
 v_cvt_pk_bf16_f32 v230, v224, v225
 v_cvt_pk_bf16_f32 v231, v226, v227
 s_nop 0
 v_permlane16_swap_b32 v228, v230
 v_permlane16_swap_b32 v229, v231
 buffer_store_dwordx4 v[228:231], v203, s[4:7], s29 offen offset:512
 v_pk_mul_f32 v[204:205], v[188:189], v[88:89] op_sel:[0,0] op_sel_hi:[1,0]
 v_pk_mul_f32 v[206:207], v[190:191], v[88:89] op_sel:[0,0] op_sel_hi:[1,0]
 v_pk_mul_f32 v[208:209], v[188:189], v[88:89] op_sel:[0,1] op_sel_hi:[1,1]
 v_pk_mul_f32 v[210:211], v[190:191], v[88:89] op_sel:[0,1] op_sel_hi:[1,1]
 v_pk_fma_f32 v[204:205], v[28:29], v[84:85], v[204:205] op_sel:[0,0,0] op_sel_hi:[1,0,1] neg_lo:[0,0,1] neg_hi:[0,0,1]
 v_pk_fma_f32 v[206:207], v[30:31], v[84:85], v[206:207] op_sel:[0,0,0] op_sel_hi:[1,0,1] neg_lo:[0,0,1] neg_hi:[0,0,1]
 v_pk_fma_f32 v[208:209], v[44:45], v[84:85], v[208:209] op_sel:[0,1,0] op_sel_hi:[1,1,1] neg_lo:[0,0,1] neg_hi:[0,0,1]
 v_pk_fma_f32 v[210:211], v[46:47], v[84:85], v[210:211] op_sel:[0,1,0] op_sel_hi:[1,1,1] neg_lo:[0,0,1] neg_hi:[0,0,1]
 v_cvt_pk_bf16_f32 v212, v204, v205
 v_cvt_pk_bf16_f32 v213, v206, v207
 v_cvt_pk_bf16_f32 v214, v208, v209
 v_cvt_pk_bf16_f32 v215, v210, v211
 s_nop 0
 v_permlane16_swap_b32 v212, v214
 v_permlane16_swap_b32 v213, v215
 buffer_store_dwordx4 v[212:215], v203, s[4:7], s30 offen offset:1024
 v_pk_mul_f32 v[220:221], v[188:189], v[90:91] op_sel:[0,0] op_sel_hi:[1,0]
 v_pk_mul_f32 v[222:223], v[190:191], v[90:91] op_sel:[0,0] op_sel_hi:[1,0]
 v_pk_mul_f32 v[224:225], v[188:189], v[90:91] op_sel:[0,1] op_sel_hi:[1,1]
 v_pk_mul_f32 v[226:227], v[190:191], v[90:91] op_sel:[0,1] op_sel_hi:[1,1]
 v_pk_fma_f32 v[220:221], v[60:61], v[86:87], v[220:221] op_sel:[0,0,0] op_sel_hi:[1,0,1] neg_lo:[0,0,1] neg_hi:[0,0,1]
 v_pk_fma_f32 v[222:223], v[62:63], v[86:87], v[222:223] op_sel:[0,0,0] op_sel_hi:[1,0,1] neg_lo:[0,0,1] neg_hi:[0,0,1]
 v_pk_fma_f32 v[224:225], v[76:77], v[86:87], v[224:225] op_sel:[0,1,0] op_sel_hi:[1,1,1] neg_lo:[0,0,1] neg_hi:[0,0,1]
 v_pk_fma_f32 v[226:227], v[78:79], v[86:87], v[226:227] op_sel:[0,1,0] op_sel_hi:[1,1,1] neg_lo:[0,0,1] neg_hi:[0,0,1]
 v_cvt_pk_bf16_f32 v228, v220, v221
 v_cvt_pk_bf16_f32 v229, v222, v223
 v_cvt_pk_bf16_f32 v230, v224, v225
 v_cvt_pk_bf16_f32 v231, v226, v227
 s_nop 0
 v_permlane16_swap_b32 v228, v230
 v_permlane16_swap_b32 v229, v231
 buffer_store_dwordx4 v[228:231], v203, s[4:7], s29 offen offset:1024
 v_pk_mul_f32 v[204:205], v[192:193], v[88:89] op_sel:[0,0] op_sel_hi:[1,0]
 v_pk_mul_f32 v[206:207], v[194:195], v[88:89] op_sel:[0,0] op_sel_hi:[1,0]
 v_pk_mul_f32 v[208:209], v[192:193], v[88:89] op_sel:[0,1] op_sel_hi:[1,1]
 v_pk_mul_f32 v[210:211], v[194:195], v[88:89] op_sel:[0,1] op_sel_hi:[1,1]
 v_pk_fma_f32 v[204:205], v[32:33], v[84:85], v[204:205] op_sel:[0,0,0] op_sel_hi:[1,0,1] neg_lo:[0,0,1] neg_hi:[0,0,1]
 v_pk_fma_f32 v[206:207], v[34:35], v[84:85], v[206:207] op_sel:[0,0,0] op_sel_hi:[1,0,1] neg_lo:[0,0,1] neg_hi:[0,0,1]
 v_pk_fma_f32 v[208:209], v[48:49], v[84:85], v[208:209] op_sel:[0,1,0] op_sel_hi:[1,1,1] neg_lo:[0,0,1] neg_hi:[0,0,1]
 v_pk_fma_f32 v[210:211], v[50:51], v[84:85], v[210:211] op_sel:[0,1,0] op_sel_hi:[1,1,1] neg_lo:[0,0,1] neg_hi:[0,0,1]
 v_cvt_pk_bf16_f32 v212, v204, v205
 v_cvt_pk_bf16_f32 v213, v206, v207
 v_cvt_pk_bf16_f32 v214, v208, v209
 v_cvt_pk_bf16_f32 v215, v210, v211
 s_nop 0
 v_permlane16_swap_b32 v212, v214
 v_permlane16_swap_b32 v213, v215
 buffer_store_dwordx4 v[212:215], v203, s[4:7], s30 offen offset:1536
 v_pk_mul_f32 v[220:221], v[192:193], v[90:91] op_sel:[0,0] op_sel_hi:[1,0]
 v_pk_mul_f32 v[222:223], v[194:195], v[90:91] op_sel:[0,0] op_sel_hi:[1,0]
 v_pk_mul_f32 v[224:225], v[192:193], v[90:91] op_sel:[0,1] op_sel_hi:[1,1]
 v_pk_mul_f32 v[226:227], v[194:195], v[90:91] op_sel:[0,1] op_sel_hi:[1,1]
 v_pk_fma_f32 v[220:221], v[64:65], v[86:87], v[220:221] op_sel:[0,0,0] op_sel_hi:[1,0,1] neg_lo:[0,0,1] neg_hi:[0,0,1]
 v_pk_fma_f32 v[222:223], v[66:67], v[86:87], v[222:223] op_sel:[0,0,0] op_sel_hi:[1,0,1] neg_lo:[0,0,1] neg_hi:[0,0,1]
 v_pk_fma_f32 v[224:225], v[80:81], v[86:87], v[224:225] op_sel:[0,1,0] op_sel_hi:[1,1,1] neg_lo:[0,0,1] neg_hi:[0,0,1]
 v_pk_fma_f32 v[226:227], v[82:83], v[86:87], v[226:227] op_sel:[0,1,0] op_sel_hi:[1,1,1] neg_lo:[0,0,1] neg_hi:[0,0,1]
 v_cvt_pk_bf16_f32 v228, v220, v221
 v_cvt_pk_bf16_f32 v229, v222, v223
 v_cvt_pk_bf16_f32 v230, v224, v225
 v_cvt_pk_bf16_f32 v231, v226, v227
 s_nop 0
 v_permlane16_swap_b32 v228, v230
 v_permlane16_swap_b32 v229, v231
 buffer_store_dwordx4 v[228:231], v203, s[4:7], s29 offen offset:1536
 s_endpgm
C1_q_mx:
 v_lshrrev_b32 v8, 4, v1
 v_lshlrev_b32 v8, 4, v8
 buffer_load_dwordx4 v[180:183], v8, s[4:7], s31 offen offset:0
 buffer_load_dwordx4 v[184:187], v8, s[4:7], s31 offen offset:64
 v_lshrrev_b32 v9, 4, v1
 v_and_b32 v203, 1, v9
 s_mov_b32 s23, 61440
 v_mul_lo_u32 v203, v203, s23
 v_lshrrev_b32 v9, 1, v9
 v_lshlrev_b32 v9, 8, v9
 v_add_u32 v203, v203, v9
 v_and_b32 v9, 15, v1
 v_lshlrev_b32 v9, 4, v9
 v_add_u32 v203, v203, v9
 v_and_b32 v8, 15, v1
 v_lshlrev_b32 v9, 2, v8
 buffer_load_dword v196, v9, s[4:7], s31 offen offset:128
 buffer_load_dword v197, v9, s[4:7], s31 offen offset:192
 v_lshrrev_b32 v9, 5, v1
 v_mul_u32_u24 v9, 672, v9
 v_bfe_u32 v204, v1, 4, 1
 v_mul_u32_u24 v204, 336, v204
 v_add_u32 v9, v9, v204
 s_mul_i32 s23, s22, 80
 s_lshl_b32 s24, s20, 6
 s_add_u32 s23, s23, s24
 s_sub_u32 s23, s23, 160
 v_add_u32 v8, s23, v8
 s_mov_b32 s24, 86016
 v_add_u32 v204, 32, v8
 v_mul_u32_u24 v205, 3277, v204
 v_lshrrev_b32 v205, 16, v205
 v_mul_u32_u24 v206, 20, v205
 v_sub_u32 v206, v204, v206
 v_lshlrev_b32 v206, 4, v206
 v_mul_lo_u32 v205, v205, s24
 v_add_u32 v205, v205, v206
 v_add_u32 v200, v205, v9
 v_add_u32 v204, 48, v8
 v_mul_u32_u24 v205, 3277, v204
 v_lshrrev_b32 v205, 16, v205
 v_mul_u32_u24 v206, 20, v205
 v_sub_u32 v206, v204, v206
 v_lshlrev_b32 v206, 4, v206
 v_mul_lo_u32 v205, v205, s24
 v_add_u32 v205, v205, v206
 v_add_u32 v201, v205, v9
 v_and_b32 v8, 15, v1
 v_lshlrev_b32 v8, 2, v8
 v_add_u32 v8, 161792, v8
 v_lshrrev_b32 v9, 4, v1
 v_lshlrev_b32 v9, 4, v9
 v_add_u32 v9, 161792, v9
 s_barrier
 ds_read_b128 v[84:87], v3 offset:46080
 ds_read_b128 v[100:103], v2 offset:0
 ds_read_b128 v[88:91], v3 offset:47104
 ds_read_b128 v[92:95], v3 offset:48128
 ds_read_b128 v[96:99], v3 offset:49152
 ds_read_b128 v[104:107], v2 offset:2048
 ds_read_b128 v[108:111], v2 offset:4096
 ds_read_b128 v[112:115], v2 offset:6144
 s_waitcnt lgkmcnt(0)
 v_mfma_f32_16x16x32_bf16 v[20:23], v[84:87], v[100:103], 0
 ds_read_b128 v[116:119], v3 offset:61440
 v_mfma_f32_16x16x32_bf16 v[24:27], v[88:91], v[100:103], 0
 ds_read_b128 v[132:135], v2 offset:1024
 v_mfma_f32_16x16x32_bf16 v[28:31], v[100:103], v[92:95], 0
 ds_read_b128 v[120:123], v3 offset:62464
 v_mfma_f32_16x16x32_bf16 v[32:35], v[100:103], v[96:99], 0
 ds_read_b128 v[124:127], v3 offset:63488
 v_mfma_f32_16x16x32_bf16 v[36:39], v[84:87], v[104:107], 0
 ds_read_b128 v[128:131], v3 offset:64512
 v_mfma_f32_16x16x32_bf16 v[40:43], v[88:91], v[104:107], 0
 ds_read_b128 v[136:139], v2 offset:3072
 v_mfma_f32_16x16x32_bf16 v[44:47], v[104:107], v[92:95], 0
 ds_read_b128 v[140:143], v2 offset:5120
 v_mfma_f32_16x16x32_bf16 v[48:51], v[104:107], v[96:99], 0
 ds_read_b128 v[144:147], v2 offset:7168
 v_mfma_f32_16x16x32_bf16 v[52:55], v[84:87], v[108:111], 0
 v_mfma_f32_16x16x32_bf16 v[56:59], v[88:91], v[108:111], 0
 v_mfma_f32_16x16x32_bf16 v[60:63], v[108:111], v[92:95], 0
 v_mfma_f32_16x16x32_bf16 v[64:67], v[108:111], v[96:99], 0
 v_mfma_f32_16x16x32_bf16 v[68:71], v[84:87], v[112:115], 0
 v_mfma_f32_16x16x32_bf16 v[72:75], v[88:91], v[112:115], 0
 v_mfma_f32_16x16x32_bf16 v[76:79], v[112:115], v[92:95], 0
 v_mfma_f32_16x16x32_bf16 v[80:83], v[112:115], v[96:99], 0
 s_waitcnt lgkmcnt(0)
 v_mfma_f32_16x16x32_bf16 v[20:23], v[116:119], v[132:135], v[20:23]
 s_barrier
 ds_read_b128 v[84:87], v4 offset:11264
 v_mfma_f32_16x16x32_bf16 v[24:27], v[120:123], v[132:135], v[24:27]
 ds_read_b128 v[100:103], v2 offset:8192
 v_mfma_f32_16x16x32_bf16 v[28:31], v[132:135], v[124:127], v[28:31]
 ds_read_b128 v[88:91], v4 offset:12288
 v_mfma_f32_16x16x32_bf16 v[32:35], v[132:135], v[128:131], v[32:35]
 ds_read_b128 v[92:95], v4 offset:13312
 v_mfma_f32_16x16x32_bf16 v[36:39], v[116:119], v[136:139], v[36:39]
 ds_read_b128 v[96:99], v4 offset:14336
 v_mfma_f32_16x16x32_bf16 v[40:43], v[120:123], v[136:139], v[40:43]
 ds_read_b128 v[104:107], v2 offset:10240
 v_mfma_f32_16x16x32_bf16 v[44:47], v[136:139], v[124:127], v[44:47]
 ds_read_b128 v[108:111], v2 offset:12288
 v_mfma_f32_16x16x32_bf16 v[48:51], v[136:139], v[128:131], v[48:51]
 ds_read_b128 v[112:115], v2 offset:14336
 v_mfma_f32_16x16x32_bf16 v[52:55], v[116:119], v[140:143], v[52:55]
 v_mfma_f32_16x16x32_bf16 v[56:59], v[120:123], v[140:143], v[56:59]
 v_mfma_f32_16x16x32_bf16 v[60:63], v[140:143], v[124:127], v[60:63]
 v_mfma_f32_16x16x32_bf16 v[64:67], v[140:143], v[128:131], v[64:67]
 v_mfma_f32_16x16x32_bf16 v[68:71], v[116:119], v[144:147], v[68:71]
 v_mfma_f32_16x16x32_bf16 v[72:75], v[120:123], v[144:147], v[72:75]
 v_mfma_f32_16x16x32_bf16 v[76:79], v[144:147], v[124:127], v[76:79]
 v_mfma_f32_16x16x32_bf16 v[80:83], v[144:147], v[128:131], v[80:83]
 s_waitcnt lgkmcnt(0)
 v_mfma_f32_16x16x32_bf16 v[20:23], v[84:87], v[100:103], v[20:23]
 ds_read_b128 v[116:119], v4 offset:26624
 v_mfma_f32_16x16x32_bf16 v[24:27], v[88:91], v[100:103], v[24:27]
 ds_read_b128 v[132:135], v2 offset:9216
 v_mfma_f32_16x16x32_bf16 v[28:31], v[100:103], v[92:95], v[28:31]
 ds_read_b128 v[120:123], v4 offset:27648
 v_mfma_f32_16x16x32_bf16 v[32:35], v[100:103], v[96:99], v[32:35]
 ds_read_b128 v[124:127], v4 offset:28672
 v_mfma_f32_16x16x32_bf16 v[36:39], v[84:87], v[104:107], v[36:39]
 ds_read_b128 v[128:131], v4 offset:29696
 v_mfma_f32_16x16x32_bf16 v[40:43], v[88:91], v[104:107], v[40:43]
 ds_read_b128 v[136:139], v2 offset:11264
 v_mfma_f32_16x16x32_bf16 v[44:47], v[104:107], v[92:95], v[44:47]
 ds_read_b128 v[140:143], v2 offset:13312
 v_mfma_f32_16x16x32_bf16 v[48:51], v[104:107], v[96:99], v[48:51]
 ds_read_b128 v[144:147], v2 offset:15360
 v_mfma_f32_16x16x32_bf16 v[52:55], v[84:87], v[108:111], v[52:55]
 v_mfma_f32_16x16x32_bf16 v[56:59], v[88:91], v[108:111], v[56:59]
 v_mfma_f32_16x16x32_bf16 v[60:63], v[108:111], v[92:95], v[60:63]
 v_mfma_f32_16x16x32_bf16 v[64:67], v[108:111], v[96:99], v[64:67]
 v_mfma_f32_16x16x32_bf16 v[68:71], v[84:87], v[112:115], v[68:71]
 v_mfma_f32_16x16x32_bf16 v[72:75], v[88:91], v[112:115], v[72:75]
 v_mfma_f32_16x16x32_bf16 v[76:79], v[112:115], v[92:95], v[76:79]
 v_mfma_f32_16x16x32_bf16 v[80:83], v[112:115], v[96:99], v[80:83]
 s_waitcnt lgkmcnt(0)
 v_mfma_f32_16x16x32_bf16 v[20:23], v[116:119], v[132:135], v[20:23]
 s_barrier
 ds_read_b128 v[84:87], v3 offset:0
 v_mfma_f32_16x16x32_bf16 v[24:27], v[120:123], v[132:135], v[24:27]
 ds_read_b128 v[100:103], v2 offset:16384
 v_mfma_f32_16x16x32_bf16 v[28:31], v[132:135], v[124:127], v[28:31]
 ds_read_b128 v[88:91], v3 offset:1024
 v_mfma_f32_16x16x32_bf16 v[32:35], v[132:135], v[128:131], v[32:35]
 ds_read_b128 v[92:95], v3 offset:2048
 v_mfma_f32_16x16x32_bf16 v[36:39], v[116:119], v[136:139], v[36:39]
 ds_read_b128 v[96:99], v3 offset:3072
 v_mfma_f32_16x16x32_bf16 v[40:43], v[120:123], v[136:139], v[40:43]
 ds_read_b128 v[104:107], v2 offset:18432
 v_mfma_f32_16x16x32_bf16 v[44:47], v[136:139], v[124:127], v[44:47]
 ds_read_b128 v[108:111], v2 offset:20480
 v_mfma_f32_16x16x32_bf16 v[48:51], v[136:139], v[128:131], v[48:51]
 ds_read_b128 v[112:115], v2 offset:22528
 v_mfma_f32_16x16x32_bf16 v[52:55], v[116:119], v[140:143], v[52:55]
 v_mfma_f32_16x16x32_bf16 v[56:59], v[120:123], v[140:143], v[56:59]
 v_mfma_f32_16x16x32_bf16 v[60:63], v[140:143], v[124:127], v[60:63]
 v_mfma_f32_16x16x32_bf16 v[64:67], v[140:143], v[128:131], v[64:67]
 v_mfma_f32_16x16x32_bf16 v[68:71], v[116:119], v[144:147], v[68:71]
 v_mfma_f32_16x16x32_bf16 v[72:75], v[120:123], v[144:147], v[72:75]
 v_mfma_f32_16x16x32_bf16 v[76:79], v[144:147], v[124:127], v[76:79]
 v_mfma_f32_16x16x32_bf16 v[80:83], v[144:147], v[128:131], v[80:83]
 s_waitcnt lgkmcnt(0)
 v_mfma_f32_16x16x32_bf16 v[20:23], v[84:87], v[100:103], v[20:23]
 ds_read_b128 v[116:119], v3 offset:15360
 v_mfma_f32_16x16x32_bf16 v[24:27], v[88:91], v[100:103], v[24:27]
 ds_read_b128 v[132:135], v2 offset:17408
 v_mfma_f32_16x16x32_bf16 v[28:31], v[100:103], v[92:95], v[28:31]
 ds_read_b128 v[120:123], v3 offset:16384
 v_mfma_f32_16x16x32_bf16 v[32:35], v[100:103], v[96:99], v[32:35]
 ds_read_b128 v[124:127], v3 offset:17408
 v_mfma_f32_16x16x32_bf16 v[36:39], v[84:87], v[104:107], v[36:39]
 ds_read_b128 v[128:131], v3 offset:18432
 v_mfma_f32_16x16x32_bf16 v[40:43], v[88:91], v[104:107], v[40:43]
 ds_read_b128 v[136:139], v2 offset:19456
 v_mfma_f32_16x16x32_bf16 v[44:47], v[104:107], v[92:95], v[44:47]
 ds_read_b128 v[140:143], v2 offset:21504
 v_mfma_f32_16x16x32_bf16 v[48:51], v[104:107], v[96:99], v[48:51]
 ds_read_b128 v[144:147], v2 offset:23552
 v_mfma_f32_16x16x32_bf16 v[52:55], v[84:87], v[108:111], v[52:55]
 v_mfma_f32_16x16x32_bf16 v[56:59], v[88:91], v[108:111], v[56:59]
 v_mfma_f32_16x16x32_bf16 v[60:63], v[108:111], v[92:95], v[60:63]
 v_mfma_f32_16x16x32_bf16 v[64:67], v[108:111], v[96:99], v[64:67]
 v_mfma_f32_16x16x32_bf16 v[68:71], v[84:87], v[112:115], v[68:71]
 v_mfma_f32_16x16x32_bf16 v[72:75], v[88:91], v[112:115], v[72:75]
 v_mfma_f32_16x16x32_bf16 v[76:79], v[112:115], v[92:95], v[76:79]
 v_mfma_f32_16x16x32_bf16 v[80:83], v[112:115], v[96:99], v[80:83]
 s_waitcnt lgkmcnt(0)
 v_mfma_f32_16x16x32_bf16 v[20:23], v[116:119], v[132:135], v[20:23]
 s_barrier
 ds_read_b128 v[84:87], v3 offset:30720
 v_mfma_f32_16x16x32_bf16 v[24:27], v[120:123], v[132:135], v[24:27]
 ds_read_b128 v[100:103], v2 offset:24576
 v_mfma_f32_16x16x32_bf16 v[28:31], v[132:135], v[124:127], v[28:31]
 ds_read_b128 v[88:91], v3 offset:31744
 v_mfma_f32_16x16x32_bf16 v[32:35], v[132:135], v[128:131], v[32:35]
 ds_read_b128 v[92:95], v3 offset:32768
 v_mfma_f32_16x16x32_bf16 v[36:39], v[116:119], v[136:139], v[36:39]
 ds_read_b128 v[96:99], v3 offset:33792
 v_mfma_f32_16x16x32_bf16 v[40:43], v[120:123], v[136:139], v[40:43]
 ds_read_b128 v[104:107], v2 offset:26624
 v_mfma_f32_16x16x32_bf16 v[44:47], v[136:139], v[124:127], v[44:47]
 ds_read_b128 v[108:111], v2 offset:28672
 v_mfma_f32_16x16x32_bf16 v[48:51], v[136:139], v[128:131], v[48:51]
 ds_read_b128 v[112:115], v2 offset:30720
 v_mfma_f32_16x16x32_bf16 v[52:55], v[116:119], v[140:143], v[52:55]
 v_mfma_f32_16x16x32_bf16 v[56:59], v[120:123], v[140:143], v[56:59]
 v_mfma_f32_16x16x32_bf16 v[60:63], v[140:143], v[124:127], v[60:63]
 v_mfma_f32_16x16x32_bf16 v[64:67], v[140:143], v[128:131], v[64:67]
 v_mfma_f32_16x16x32_bf16 v[68:71], v[116:119], v[144:147], v[68:71]
 v_mfma_f32_16x16x32_bf16 v[72:75], v[120:123], v[144:147], v[72:75]
 v_mfma_f32_16x16x32_bf16 v[76:79], v[144:147], v[124:127], v[76:79]
 v_mfma_f32_16x16x32_bf16 v[80:83], v[144:147], v[128:131], v[80:83]
 s_waitcnt lgkmcnt(0)
 v_mfma_f32_16x16x32_bf16 v[20:23], v[84:87], v[100:103], v[20:23]
 ds_read_b128 v[116:119], v3 offset:46080
 v_mfma_f32_16x16x32_bf16 v[24:27], v[88:91], v[100:103], v[24:27]
 ds_read_b128 v[132:135], v2 offset:25600
 v_mfma_f32_16x16x32_bf16 v[28:31], v[100:103], v[92:95], v[28:31]
 ds_read_b128 v[120:123], v3 offset:47104
 v_mfma_f32_16x16x32_bf16 v[32:35], v[100:103], v[96:99], v[32:35]
 ds_read_b128 v[124:127], v3 offset:48128
 v_mfma_f32_16x16x32_bf16 v[36:39], v[84:87], v[104:107], v[36:39]
 ds_read_b128 v[128:131], v3 offset:49152
 v_mfma_f32_16x16x32_bf16 v[40:43], v[88:91], v[104:107], v[40:43]
 ds_read_b128 v[136:139], v2 offset:27648
 v_mfma_f32_16x16x32_bf16 v[44:47], v[104:107], v[92:95], v[44:47]
 ds_read_b128 v[140:143], v2 offset:29696
 v_mfma_f32_16x16x32_bf16 v[48:51], v[104:107], v[96:99], v[48:51]
 ds_read_b128 v[144:147], v2 offset:31744
 v_mfma_f32_16x16x32_bf16 v[52:55], v[84:87], v[108:111], v[52:55]
 v_mfma_f32_16x16x32_bf16 v[56:59], v[88:91], v[108:111], v[56:59]
 v_mfma_f32_16x16x32_bf16 v[60:63], v[108:111], v[92:95], v[60:63]
 v_mfma_f32_16x16x32_bf16 v[64:67], v[108:111], v[96:99], v[64:67]
 v_mfma_f32_16x16x32_bf16 v[68:71], v[84:87], v[112:115], v[68:71]
 v_mfma_f32_16x16x32_bf16 v[72:75], v[88:91], v[112:115], v[72:75]
 v_mfma_f32_16x16x32_bf16 v[76:79], v[112:115], v[92:95], v[76:79]
 v_mfma_f32_16x16x32_bf16 v[80:83], v[112:115], v[96:99], v[80:83]
 s_waitcnt lgkmcnt(0)
 v_mfma_f32_16x16x32_bf16 v[20:23], v[116:119], v[132:135], v[20:23]
 s_barrier
 ds_read_b128 v[84:87], v3 offset:61440
 v_mfma_f32_16x16x32_bf16 v[24:27], v[120:123], v[132:135], v[24:27]
 ds_read_b128 v[100:103], v2 offset:32768
 v_mfma_f32_16x16x32_bf16 v[28:31], v[132:135], v[124:127], v[28:31]
 ds_read_b128 v[88:91], v3 offset:62464
 v_mfma_f32_16x16x32_bf16 v[32:35], v[132:135], v[128:131], v[32:35]
 ds_read_b128 v[92:95], v3 offset:63488
 v_mfma_f32_16x16x32_bf16 v[36:39], v[116:119], v[136:139], v[36:39]
 ds_read_b128 v[96:99], v3 offset:64512
 v_mfma_f32_16x16x32_bf16 v[40:43], v[120:123], v[136:139], v[40:43]
 ds_read_b128 v[104:107], v2 offset:34816
 v_mfma_f32_16x16x32_bf16 v[44:47], v[136:139], v[124:127], v[44:47]
 ds_read_b128 v[108:111], v2 offset:36864
 v_mfma_f32_16x16x32_bf16 v[48:51], v[136:139], v[128:131], v[48:51]
 ds_read_b128 v[112:115], v2 offset:38912
 v_mfma_f32_16x16x32_bf16 v[52:55], v[116:119], v[140:143], v[52:55]
 v_mfma_f32_16x16x32_bf16 v[56:59], v[120:123], v[140:143], v[56:59]
 v_mfma_f32_16x16x32_bf16 v[60:63], v[140:143], v[124:127], v[60:63]
 v_mfma_f32_16x16x32_bf16 v[64:67], v[140:143], v[128:131], v[64:67]
 v_mfma_f32_16x16x32_bf16 v[68:71], v[116:119], v[144:147], v[68:71]
 v_mfma_f32_16x16x32_bf16 v[72:75], v[120:123], v[144:147], v[72:75]
 v_mfma_f32_16x16x32_bf16 v[76:79], v[144:147], v[124:127], v[76:79]
 v_mfma_f32_16x16x32_bf16 v[80:83], v[144:147], v[128:131], v[80:83]
 s_waitcnt lgkmcnt(0)
 v_mfma_f32_16x16x32_bf16 v[20:23], v[84:87], v[100:103], v[20:23]
 ds_read_b128 v[116:119], v4 offset:11264
 v_mfma_f32_16x16x32_bf16 v[24:27], v[88:91], v[100:103], v[24:27]
 ds_read_b128 v[132:135], v2 offset:33792
 v_mfma_f32_16x16x32_bf16 v[28:31], v[100:103], v[92:95], v[28:31]
 ds_read_b128 v[120:123], v4 offset:12288
 v_mfma_f32_16x16x32_bf16 v[32:35], v[100:103], v[96:99], v[32:35]
 ds_read_b128 v[124:127], v4 offset:13312
 v_mfma_f32_16x16x32_bf16 v[36:39], v[84:87], v[104:107], v[36:39]
 ds_read_b128 v[128:131], v4 offset:14336
 v_mfma_f32_16x16x32_bf16 v[40:43], v[88:91], v[104:107], v[40:43]
 ds_read_b128 v[136:139], v2 offset:35840
 v_mfma_f32_16x16x32_bf16 v[44:47], v[104:107], v[92:95], v[44:47]
 ds_read_b128 v[140:143], v2 offset:37888
 v_mfma_f32_16x16x32_bf16 v[48:51], v[104:107], v[96:99], v[48:51]
 ds_read_b128 v[144:147], v2 offset:39936
 v_mfma_f32_16x16x32_bf16 v[52:55], v[84:87], v[108:111], v[52:55]
 v_mfma_f32_16x16x32_bf16 v[56:59], v[88:91], v[108:111], v[56:59]
 v_mfma_f32_16x16x32_bf16 v[60:63], v[108:111], v[92:95], v[60:63]
 v_mfma_f32_16x16x32_bf16 v[64:67], v[108:111], v[96:99], v[64:67]
 v_mfma_f32_16x16x32_bf16 v[68:71], v[84:87], v[112:115], v[68:71]
 v_mfma_f32_16x16x32_bf16 v[72:75], v[88:91], v[112:115], v[72:75]
 v_mfma_f32_16x16x32_bf16 v[76:79], v[112:115], v[92:95], v[76:79]
 v_mfma_f32_16x16x32_bf16 v[80:83], v[112:115], v[96:99], v[80:83]
 s_waitcnt lgkmcnt(0)
 v_mfma_f32_16x16x32_bf16 v[20:23], v[116:119], v[132:135], v[20:23]
 s_barrier
 ds_read_b128 v[84:87], v4 offset:26624
 v_mfma_f32_16x16x32_bf16 v[24:27], v[120:123], v[132:135], v[24:27]
 ds_read_b128 v[100:103], v2 offset:40960
 v_mfma_f32_16x16x32_bf16 v[28:31], v[132:135], v[124:127], v[28:31]
 ds_read_b128 v[88:91], v4 offset:27648
 v_mfma_f32_16x16x32_bf16 v[32:35], v[132:135], v[128:131], v[32:35]
 ds_read_b128 v[92:95], v4 offset:28672
 v_mfma_f32_16x16x32_bf16 v[36:39], v[116:119], v[136:139], v[36:39]
 ds_read_b128 v[96:99], v4 offset:29696
 v_mfma_f32_16x16x32_bf16 v[40:43], v[120:123], v[136:139], v[40:43]
 ds_read_b128 v[104:107], v2 offset:43008
 v_mfma_f32_16x16x32_bf16 v[44:47], v[136:139], v[124:127], v[44:47]
 ds_read_b128 v[108:111], v2 offset:45056
 v_mfma_f32_16x16x32_bf16 v[48:51], v[136:139], v[128:131], v[48:51]
 ds_read_b128 v[112:115], v2 offset:47104
 v_mfma_f32_16x16x32_bf16 v[52:55], v[116:119], v[140:143], v[52:55]
 v_mfma_f32_16x16x32_bf16 v[56:59], v[120:123], v[140:143], v[56:59]
 v_mfma_f32_16x16x32_bf16 v[60:63], v[140:143], v[124:127], v[60:63]
 v_mfma_f32_16x16x32_bf16 v[64:67], v[140:143], v[128:131], v[64:67]
 v_mfma_f32_16x16x32_bf16 v[68:71], v[116:119], v[144:147], v[68:71]
 v_mfma_f32_16x16x32_bf16 v[72:75], v[120:123], v[144:147], v[72:75]
 v_mfma_f32_16x16x32_bf16 v[76:79], v[144:147], v[124:127], v[76:79]
 v_mfma_f32_16x16x32_bf16 v[80:83], v[144:147], v[128:131], v[80:83]
 s_waitcnt lgkmcnt(0)
 v_mfma_f32_16x16x32_bf16 v[20:23], v[84:87], v[100:103], v[20:23]
 ds_read_b128 v[116:119], v3 offset:0
 v_mfma_f32_16x16x32_bf16 v[24:27], v[88:91], v[100:103], v[24:27]
 ds_read_b128 v[132:135], v2 offset:41984
 v_mfma_f32_16x16x32_bf16 v[28:31], v[100:103], v[92:95], v[28:31]
 ds_read_b128 v[120:123], v3 offset:1024
 v_mfma_f32_16x16x32_bf16 v[32:35], v[100:103], v[96:99], v[32:35]
 ds_read_b128 v[124:127], v3 offset:2048
 v_mfma_f32_16x16x32_bf16 v[36:39], v[84:87], v[104:107], v[36:39]
 ds_read_b128 v[128:131], v3 offset:3072
 v_mfma_f32_16x16x32_bf16 v[40:43], v[88:91], v[104:107], v[40:43]
 ds_read_b128 v[136:139], v2 offset:44032
 v_mfma_f32_16x16x32_bf16 v[44:47], v[104:107], v[92:95], v[44:47]
 ds_read_b128 v[140:143], v2 offset:46080
 v_mfma_f32_16x16x32_bf16 v[48:51], v[104:107], v[96:99], v[48:51]
 ds_read_b128 v[144:147], v2 offset:48128
 v_mfma_f32_16x16x32_bf16 v[52:55], v[84:87], v[108:111], v[52:55]
 v_mfma_f32_16x16x32_bf16 v[56:59], v[88:91], v[108:111], v[56:59]
 v_mfma_f32_16x16x32_bf16 v[60:63], v[108:111], v[92:95], v[60:63]
 v_mfma_f32_16x16x32_bf16 v[64:67], v[108:111], v[96:99], v[64:67]
 v_mfma_f32_16x16x32_bf16 v[68:71], v[84:87], v[112:115], v[68:71]
 v_mfma_f32_16x16x32_bf16 v[72:75], v[88:91], v[112:115], v[72:75]
 v_mfma_f32_16x16x32_bf16 v[76:79], v[112:115], v[92:95], v[76:79]
 v_mfma_f32_16x16x32_bf16 v[80:83], v[112:115], v[96:99], v[80:83]
 s_waitcnt lgkmcnt(0)
 v_mfma_f32_16x16x32_bf16 v[20:23], v[116:119], v[132:135], v[20:23]
 s_barrier
 ds_read_b128 v[84:87], v3 offset:15360
 v_mfma_f32_16x16x32_bf16 v[24:27], v[120:123], v[132:135], v[24:27]
 ds_read_b128 v[100:103], v2 offset:0
 v_mfma_f32_16x16x32_bf16 v[28:31], v[132:135], v[124:127], v[28:31]
 ds_read_b128 v[88:91], v3 offset:16384
 v_mfma_f32_16x16x32_bf16 v[32:35], v[132:135], v[128:131], v[32:35]
 ds_read_b128 v[92:95], v3 offset:17408
 v_mfma_f32_16x16x32_bf16 v[36:39], v[116:119], v[136:139], v[36:39]
 ds_read_b128 v[96:99], v3 offset:18432
 v_mfma_f32_16x16x32_bf16 v[40:43], v[120:123], v[136:139], v[40:43]
 ds_read_b128 v[104:107], v2 offset:2048
 v_mfma_f32_16x16x32_bf16 v[44:47], v[136:139], v[124:127], v[44:47]
 ds_read_b128 v[108:111], v2 offset:4096
 v_mfma_f32_16x16x32_bf16 v[48:51], v[136:139], v[128:131], v[48:51]
 ds_read_b128 v[112:115], v2 offset:6144
 v_mfma_f32_16x16x32_bf16 v[52:55], v[116:119], v[140:143], v[52:55]
 v_mfma_f32_16x16x32_bf16 v[56:59], v[120:123], v[140:143], v[56:59]
 v_mfma_f32_16x16x32_bf16 v[60:63], v[140:143], v[124:127], v[60:63]
 v_mfma_f32_16x16x32_bf16 v[64:67], v[140:143], v[128:131], v[64:67]
 v_mfma_f32_16x16x32_bf16 v[68:71], v[116:119], v[144:147], v[68:71]
 v_mfma_f32_16x16x32_bf16 v[72:75], v[120:123], v[144:147], v[72:75]
 v_mfma_f32_16x16x32_bf16 v[76:79], v[144:147], v[124:127], v[76:79]
 v_mfma_f32_16x16x32_bf16 v[80:83], v[144:147], v[128:131], v[80:83]
 s_waitcnt lgkmcnt(0)
 v_mfma_f32_16x16x32_bf16 v[20:23], v[84:87], v[100:103], v[20:23]
 ds_read_b128 v[116:119], v3 offset:30720
 v_mfma_f32_16x16x32_bf16 v[24:27], v[88:91], v[100:103], v[24:27]
 ds_read_b128 v[132:135], v2 offset:1024
 v_mfma_f32_16x16x32_bf16 v[28:31], v[100:103], v[92:95], v[28:31]
 ds_read_b128 v[120:123], v3 offset:31744
 v_mfma_f32_16x16x32_bf16 v[32:35], v[100:103], v[96:99], v[32:35]
 ds_read_b128 v[124:127], v3 offset:32768
 v_mfma_f32_16x16x32_bf16 v[36:39], v[84:87], v[104:107], v[36:39]
 ds_read_b128 v[128:131], v3 offset:33792
 v_mfma_f32_16x16x32_bf16 v[40:43], v[88:91], v[104:107], v[40:43]
 ds_read_b128 v[136:139], v2 offset:3072
 v_mfma_f32_16x16x32_bf16 v[44:47], v[104:107], v[92:95], v[44:47]
 ds_read_b128 v[140:143], v2 offset:5120
 v_mfma_f32_16x16x32_bf16 v[48:51], v[104:107], v[96:99], v[48:51]
 ds_read_b128 v[144:147], v2 offset:7168
 v_mfma_f32_16x16x32_bf16 v[52:55], v[84:87], v[108:111], v[52:55]
 v_mfma_f32_16x16x32_bf16 v[56:59], v[88:91], v[108:111], v[56:59]
 v_mfma_f32_16x16x32_bf16 v[60:63], v[108:111], v[92:95], v[60:63]
 v_mfma_f32_16x16x32_bf16 v[64:67], v[108:111], v[96:99], v[64:67]
 v_mfma_f32_16x16x32_bf16 v[68:71], v[84:87], v[112:115], v[68:71]
 v_mfma_f32_16x16x32_bf16 v[72:75], v[88:91], v[112:115], v[72:75]
 v_mfma_f32_16x16x32_bf16 v[76:79], v[112:115], v[92:95], v[76:79]
 v_mfma_f32_16x16x32_bf16 v[80:83], v[112:115], v[96:99], v[80:83]
 s_waitcnt lgkmcnt(0)
 v_mfma_f32_16x16x32_bf16 v[20:23], v[116:119], v[132:135], v[20:23]
 s_barrier
 ds_read_b128 v[84:87], v3 offset:46080
 v_mfma_f32_16x16x32_bf16 v[24:27], v[120:123], v[132:135], v[24:27]
 ds_read_b128 v[100:103], v2 offset:8192
 v_mfma_f32_16x16x32_bf16 v[28:31], v[132:135], v[124:127], v[28:31]
 ds_read_b128 v[88:91], v3 offset:47104
 v_mfma_f32_16x16x32_bf16 v[32:35], v[132:135], v[128:131], v[32:35]
 ds_read_b128 v[92:95], v3 offset:48128
 v_mfma_f32_16x16x32_bf16 v[36:39], v[116:119], v[136:139], v[36:39]
 ds_read_b128 v[96:99], v3 offset:49152
 v_mfma_f32_16x16x32_bf16 v[40:43], v[120:123], v[136:139], v[40:43]
 ds_read_b128 v[104:107], v2 offset:10240
 v_mfma_f32_16x16x32_bf16 v[44:47], v[136:139], v[124:127], v[44:47]
 ds_read_b128 v[108:111], v2 offset:12288
 v_mfma_f32_16x16x32_bf16 v[48:51], v[136:139], v[128:131], v[48:51]
 ds_read_b128 v[112:115], v2 offset:14336
 v_mfma_f32_16x16x32_bf16 v[52:55], v[116:119], v[140:143], v[52:55]
 v_mfma_f32_16x16x32_bf16 v[56:59], v[120:123], v[140:143], v[56:59]
 v_mfma_f32_16x16x32_bf16 v[60:63], v[140:143], v[124:127], v[60:63]
 v_mfma_f32_16x16x32_bf16 v[64:67], v[140:143], v[128:131], v[64:67]
 v_mfma_f32_16x16x32_bf16 v[68:71], v[116:119], v[144:147], v[68:71]
 v_mfma_f32_16x16x32_bf16 v[72:75], v[120:123], v[144:147], v[72:75]
 v_mfma_f32_16x16x32_bf16 v[76:79], v[144:147], v[124:127], v[76:79]
 v_mfma_f32_16x16x32_bf16 v[80:83], v[144:147], v[128:131], v[80:83]
 s_waitcnt lgkmcnt(0)
 v_mfma_f32_16x16x32_bf16 v[20:23], v[84:87], v[100:103], v[20:23]
 ds_read_b128 v[116:119], v3 offset:61440
 v_mfma_f32_16x16x32_bf16 v[24:27], v[88:91], v[100:103], v[24:27]
 ds_read_b128 v[132:135], v2 offset:9216
 v_mfma_f32_16x16x32_bf16 v[28:31], v[100:103], v[92:95], v[28:31]
 ds_read_b128 v[120:123], v3 offset:62464
 v_mfma_f32_16x16x32_bf16 v[32:35], v[100:103], v[96:99], v[32:35]
 ds_read_b128 v[124:127], v3 offset:63488
 v_mfma_f32_16x16x32_bf16 v[36:39], v[84:87], v[104:107], v[36:39]
 ds_read_b128 v[128:131], v3 offset:64512
 v_mfma_f32_16x16x32_bf16 v[40:43], v[88:91], v[104:107], v[40:43]
 ds_read_b128 v[136:139], v2 offset:11264
 v_mfma_f32_16x16x32_bf16 v[44:47], v[104:107], v[92:95], v[44:47]
 ds_read_b128 v[140:143], v2 offset:13312
 v_mfma_f32_16x16x32_bf16 v[48:51], v[104:107], v[96:99], v[48:51]
 ds_read_b128 v[144:147], v2 offset:15360
 v_mfma_f32_16x16x32_bf16 v[52:55], v[84:87], v[108:111], v[52:55]
 v_mfma_f32_16x16x32_bf16 v[56:59], v[88:91], v[108:111], v[56:59]
 v_mfma_f32_16x16x32_bf16 v[60:63], v[108:111], v[92:95], v[60:63]
 v_mfma_f32_16x16x32_bf16 v[64:67], v[108:111], v[96:99], v[64:67]
 v_mfma_f32_16x16x32_bf16 v[68:71], v[84:87], v[112:115], v[68:71]
 v_mfma_f32_16x16x32_bf16 v[72:75], v[88:91], v[112:115], v[72:75]
 v_mfma_f32_16x16x32_bf16 v[76:79], v[112:115], v[92:95], v[76:79]
 v_mfma_f32_16x16x32_bf16 v[80:83], v[112:115], v[96:99], v[80:83]
 s_waitcnt lgkmcnt(0)
 v_mfma_f32_16x16x32_bf16 v[20:23], v[116:119], v[132:135], v[20:23]
 s_barrier
 ds_read_b128 v[84:87], v4 offset:11264
 v_mfma_f32_16x16x32_bf16 v[24:27], v[120:123], v[132:135], v[24:27]
 ds_read_b128 v[100:103], v2 offset:16384
 v_mfma_f32_16x16x32_bf16 v[28:31], v[132:135], v[124:127], v[28:31]
 ds_read_b128 v[88:91], v4 offset:12288
 v_mfma_f32_16x16x32_bf16 v[32:35], v[132:135], v[128:131], v[32:35]
 ds_read_b128 v[92:95], v4 offset:13312
 v_mfma_f32_16x16x32_bf16 v[36:39], v[116:119], v[136:139], v[36:39]
 ds_read_b128 v[96:99], v4 offset:14336
 v_mfma_f32_16x16x32_bf16 v[40:43], v[120:123], v[136:139], v[40:43]
 ds_read_b128 v[104:107], v2 offset:18432
 v_mfma_f32_16x16x32_bf16 v[44:47], v[136:139], v[124:127], v[44:47]
 ds_read_b128 v[108:111], v2 offset:20480
 v_mfma_f32_16x16x32_bf16 v[48:51], v[136:139], v[128:131], v[48:51]
 ds_read_b128 v[112:115], v2 offset:22528
 v_mfma_f32_16x16x32_bf16 v[52:55], v[116:119], v[140:143], v[52:55]
 v_mfma_f32_16x16x32_bf16 v[56:59], v[120:123], v[140:143], v[56:59]
 v_mfma_f32_16x16x32_bf16 v[60:63], v[140:143], v[124:127], v[60:63]
 v_mfma_f32_16x16x32_bf16 v[64:67], v[140:143], v[128:131], v[64:67]
 v_mfma_f32_16x16x32_bf16 v[68:71], v[116:119], v[144:147], v[68:71]
 v_mfma_f32_16x16x32_bf16 v[72:75], v[120:123], v[144:147], v[72:75]
 v_mfma_f32_16x16x32_bf16 v[76:79], v[144:147], v[124:127], v[76:79]
 v_mfma_f32_16x16x32_bf16 v[80:83], v[144:147], v[128:131], v[80:83]
 s_waitcnt lgkmcnt(0)
 v_mfma_f32_16x16x32_bf16 v[20:23], v[84:87], v[100:103], v[20:23]
 ds_read_b128 v[116:119], v4 offset:26624
 v_mfma_f32_16x16x32_bf16 v[24:27], v[88:91], v[100:103], v[24:27]
 ds_read_b128 v[132:135], v2 offset:17408
 v_mfma_f32_16x16x32_bf16 v[28:31], v[100:103], v[92:95], v[28:31]
 ds_read_b128 v[120:123], v4 offset:27648
 v_mfma_f32_16x16x32_bf16 v[32:35], v[100:103], v[96:99], v[32:35]
 ds_read_b128 v[124:127], v4 offset:28672
 v_mfma_f32_16x16x32_bf16 v[36:39], v[84:87], v[104:107], v[36:39]
 ds_read_b128 v[128:131], v4 offset:29696
 v_mfma_f32_16x16x32_bf16 v[40:43], v[88:91], v[104:107], v[40:43]
 ds_read_b128 v[136:139], v2 offset:19456
 v_mfma_f32_16x16x32_bf16 v[44:47], v[104:107], v[92:95], v[44:47]
 ds_read_b128 v[140:143], v2 offset:21504
 v_mfma_f32_16x16x32_bf16 v[48:51], v[104:107], v[96:99], v[48:51]
 ds_read_b128 v[144:147], v2 offset:23552
 v_mfma_f32_16x16x32_bf16 v[52:55], v[84:87], v[108:111], v[52:55]
 v_mfma_f32_16x16x32_bf16 v[56:59], v[88:91], v[108:111], v[56:59]
 v_mfma_f32_16x16x32_bf16 v[60:63], v[108:111], v[92:95], v[60:63]
 v_mfma_f32_16x16x32_bf16 v[64:67], v[108:111], v[96:99], v[64:67]
 v_mfma_f32_16x16x32_bf16 v[68:71], v[84:87], v[112:115], v[68:71]
 v_mfma_f32_16x16x32_bf16 v[72:75], v[88:91], v[112:115], v[72:75]
 v_mfma_f32_16x16x32_bf16 v[76:79], v[112:115], v[92:95], v[76:79]
 v_mfma_f32_16x16x32_bf16 v[80:83], v[112:115], v[96:99], v[80:83]
 s_waitcnt lgkmcnt(0)
 v_mfma_f32_16x16x32_bf16 v[20:23], v[116:119], v[132:135], v[20:23]
 s_barrier
 ds_read_b128 v[84:87], v3 offset:0
 v_mfma_f32_16x16x32_bf16 v[24:27], v[120:123], v[132:135], v[24:27]
 ds_read_b128 v[100:103], v2 offset:24576
 v_mfma_f32_16x16x32_bf16 v[28:31], v[132:135], v[124:127], v[28:31]
 ds_read_b128 v[88:91], v3 offset:1024
 v_mfma_f32_16x16x32_bf16 v[32:35], v[132:135], v[128:131], v[32:35]
 ds_read_b128 v[92:95], v3 offset:2048
 v_mfma_f32_16x16x32_bf16 v[36:39], v[116:119], v[136:139], v[36:39]
 ds_read_b128 v[96:99], v3 offset:3072
 v_mfma_f32_16x16x32_bf16 v[40:43], v[120:123], v[136:139], v[40:43]
 ds_read_b128 v[104:107], v2 offset:26624
 v_mfma_f32_16x16x32_bf16 v[44:47], v[136:139], v[124:127], v[44:47]
 ds_read_b128 v[108:111], v2 offset:28672
 v_mfma_f32_16x16x32_bf16 v[48:51], v[136:139], v[128:131], v[48:51]
 ds_read_b128 v[112:115], v2 offset:30720
 v_mfma_f32_16x16x32_bf16 v[52:55], v[116:119], v[140:143], v[52:55]
 v_mfma_f32_16x16x32_bf16 v[56:59], v[120:123], v[140:143], v[56:59]
 v_mfma_f32_16x16x32_bf16 v[60:63], v[140:143], v[124:127], v[60:63]
 v_mfma_f32_16x16x32_bf16 v[64:67], v[140:143], v[128:131], v[64:67]
 v_mfma_f32_16x16x32_bf16 v[68:71], v[116:119], v[144:147], v[68:71]
 v_mfma_f32_16x16x32_bf16 v[72:75], v[120:123], v[144:147], v[72:75]
 v_mfma_f32_16x16x32_bf16 v[76:79], v[144:147], v[124:127], v[76:79]
 v_mfma_f32_16x16x32_bf16 v[80:83], v[144:147], v[128:131], v[80:83]
 s_waitcnt lgkmcnt(0)
 v_mfma_f32_16x16x32_bf16 v[20:23], v[84:87], v[100:103], v[20:23]
 ds_read_b128 v[116:119], v3 offset:15360
 v_mfma_f32_16x16x32_bf16 v[24:27], v[88:91], v[100:103], v[24:27]
 ds_read_b128 v[132:135], v2 offset:25600
 v_mfma_f32_16x16x32_bf16 v[28:31], v[100:103], v[92:95], v[28:31]
 ds_read_b128 v[120:123], v3 offset:16384
 v_mfma_f32_16x16x32_bf16 v[32:35], v[100:103], v[96:99], v[32:35]
 ds_read_b128 v[124:127], v3 offset:17408
 v_mfma_f32_16x16x32_bf16 v[36:39], v[84:87], v[104:107], v[36:39]
 ds_read_b128 v[128:131], v3 offset:18432
 v_mfma_f32_16x16x32_bf16 v[40:43], v[88:91], v[104:107], v[40:43]
 ds_read_b128 v[136:139], v2 offset:27648
 v_mfma_f32_16x16x32_bf16 v[44:47], v[104:107], v[92:95], v[44:47]
 ds_read_b128 v[140:143], v2 offset:29696
 v_mfma_f32_16x16x32_bf16 v[48:51], v[104:107], v[96:99], v[48:51]
 ds_read_b128 v[144:147], v2 offset:31744
 v_mfma_f32_16x16x32_bf16 v[52:55], v[84:87], v[108:111], v[52:55]
 v_mfma_f32_16x16x32_bf16 v[56:59], v[88:91], v[108:111], v[56:59]
 v_mfma_f32_16x16x32_bf16 v[60:63], v[108:111], v[92:95], v[60:63]
 v_mfma_f32_16x16x32_bf16 v[64:67], v[108:111], v[96:99], v[64:67]
 v_mfma_f32_16x16x32_bf16 v[68:71], v[84:87], v[112:115], v[68:71]
 v_mfma_f32_16x16x32_bf16 v[72:75], v[88:91], v[112:115], v[72:75]
 v_mfma_f32_16x16x32_bf16 v[76:79], v[112:115], v[92:95], v[76:79]
 v_mfma_f32_16x16x32_bf16 v[80:83], v[112:115], v[96:99], v[80:83]
 s_waitcnt lgkmcnt(0)
 v_mfma_f32_16x16x32_bf16 v[20:23], v[116:119], v[132:135], v[20:23]
 s_barrier
 v_mfma_f32_16x16x32_bf16 v[24:27], v[120:123], v[132:135], v[24:27]
 ds_read_b32 v84, v8 offset:0
 ds_read_b32 v85, v8 offset:64
 v_mfma_f32_16x16x32_bf16 v[28:31], v[132:135], v[124:127], v[28:31]
 ds_read_b32 v86, v8 offset:128
 ds_read_b32 v87, v8 offset:192
 v_mfma_f32_16x16x32_bf16 v[32:35], v[132:135], v[128:131], v[32:35]
 ds_read_b32 v88, v8 offset:256
 ds_read_b32 v89, v8 offset:320
 v_mfma_f32_16x16x32_bf16 v[36:39], v[116:119], v[136:139], v[36:39]
 ds_read_b32 v90, v8 offset:384
 ds_read_b32 v91, v8 offset:448
 v_mfma_f32_16x16x32_bf16 v[40:43], v[120:123], v[136:139], v[40:43]
 ds_read_b128 v[148:151], v9 offset:0
 ds_read_b128 v[164:167], v9 offset:256
 v_mfma_f32_16x16x32_bf16 v[44:47], v[136:139], v[124:127], v[44:47]
 ds_read_b128 v[152:155], v9 offset:64
 ds_read_b128 v[168:171], v9 offset:320
 v_mfma_f32_16x16x32_bf16 v[48:51], v[136:139], v[128:131], v[48:51]
 ds_read_b128 v[156:159], v9 offset:128
 ds_read_b128 v[172:175], v9 offset:384
 v_mfma_f32_16x16x32_bf16 v[52:55], v[116:119], v[140:143], v[52:55]
 ds_read_b128 v[160:163], v9 offset:192
 ds_read_b128 v[176:179], v9 offset:448
 v_mfma_f32_16x16x32_bf16 v[56:59], v[120:123], v[140:143], v[56:59]
 v_mfma_f32_16x16x32_bf16 v[60:63], v[140:143], v[124:127], v[60:63]
 v_mfma_f32_16x16x32_bf16 v[64:67], v[140:143], v[128:131], v[64:67]
 v_mfma_f32_16x16x32_bf16 v[68:71], v[116:119], v[144:147], v[68:71]
 v_mfma_f32_16x16x32_bf16 v[72:75], v[120:123], v[144:147], v[72:75]
 v_mfma_f32_16x16x32_bf16 v[76:79], v[144:147], v[124:127], v[76:79]
 v_mfma_f32_16x16x32_bf16 v[80:83], v[144:147], v[128:131], v[80:83]
 s_waitcnt vmcnt(0) lgkmcnt(0)
 v_mul_f32 v84, s27, v84
 v_mul_f32 v85, s27, v85
 v_mul_f32 v86, s27, v86
 v_mul_f32 v87, s27, v87
 v_mul_f32 v88, s27, v88
 v_mul_f32 v89, s27, v89
 v_mul_f32 v90, s27, v90
 v_mul_f32 v91, s27, v91
 v_pk_mul_f32 v[204:205], v[180:181], v[88:89] op_sel:[0,0] op_sel_hi:[1,0]
 v_pk_mul_f32 v[206:207], v[182:183], v[88:89] op_sel:[0,0] op_sel_hi:[1,0]
 v_pk_mul_f32 v[208:209], v[180:181], v[88:89] op_sel:[0,1] op_sel_hi:[1,1]
 v_pk_mul_f32 v[210:211], v[182:183], v[88:89] op_sel:[0,1] op_sel_hi:[1,1]
 v_pk_fma_f32 v[204:205], v[20:21], v[84:85], v[204:205] op_sel:[0,0,0] op_sel_hi:[1,0,1] neg_lo:[0,0,1] neg_hi:[0,0,1]
 v_pk_fma_f32 v[206:207], v[22:23], v[84:85], v[206:207] op_sel:[0,0,0] op_sel_hi:[1,0,1] neg_lo:[0,0,1] neg_hi:[0,0,1]
 v_pk_fma_f32 v[208:209], v[36:37], v[84:85], v[208:209] op_sel:[0,1,0] op_sel_hi:[1,1,1] neg_lo:[0,0,1] neg_hi:[0,0,1]
 v_pk_fma_f32 v[210:211], v[38:39], v[84:85], v[210:211] op_sel:[0,1,0] op_sel_hi:[1,1,1] neg_lo:[0,0,1] neg_hi:[0,0,1]
 v_cvt_pk_bf16_f32 v212, v204, v205
 v_cvt_pk_bf16_f32 v213, v206, v207
 v_cvt_pk_bf16_f32 v214, v208, v209
 v_cvt_pk_bf16_f32 v215, v210, v211
 s_nop 0
 v_permlane16_swap_b32 v212, v214
 v_permlane16_swap_b32 v213, v215
 buffer_store_dwordx4 v[212:215], v203, s[4:7], s30 offen offset:0
 v_pk_mul_f32 v[220:221], v[180:181], v[90:91] op_sel:[0,0] op_sel_hi:[1,0]
 v_pk_mul_f32 v[222:223], v[182:183], v[90:91] op_sel:[0,0] op_sel_hi:[1,0]
 v_pk_mul_f32 v[224:225], v[180:181], v[90:91] op_sel:[0,1] op_sel_hi:[1,1]
 v_pk_mul_f32 v[226:227], v[182:183], v[90:91] op_sel:[0,1] op_sel_hi:[1,1]
 v_pk_fma_f32 v[220:221], v[52:53], v[86:87], v[220:221] op_sel:[0,0,0] op_sel_hi:[1,0,1] neg_lo:[0,0,1] neg_hi:[0,0,1]
 v_pk_fma_f32 v[222:223], v[54:55], v[86:87], v[222:223] op_sel:[0,0,0] op_sel_hi:[1,0,1] neg_lo:[0,0,1] neg_hi:[0,0,1]
 v_pk_fma_f32 v[224:225], v[68:69], v[86:87], v[224:225] op_sel:[0,1,0] op_sel_hi:[1,1,1] neg_lo:[0,0,1] neg_hi:[0,0,1]
 v_pk_fma_f32 v[226:227], v[70:71], v[86:87], v[226:227] op_sel:[0,1,0] op_sel_hi:[1,1,1] neg_lo:[0,0,1] neg_hi:[0,0,1]
 v_cvt_pk_bf16_f32 v228, v220, v221
 v_cvt_pk_bf16_f32 v229, v222, v223
 v_cvt_pk_bf16_f32 v230, v224, v225
 v_cvt_pk_bf16_f32 v231, v226, v227
 s_nop 0
 v_permlane16_swap_b32 v228, v230
 v_permlane16_swap_b32 v229, v231
 buffer_store_dwordx4 v[228:231], v203, s[4:7], s29 offen offset:0
 v_pk_mul_f32 v[204:205], v[184:185], v[88:89] op_sel:[0,0] op_sel_hi:[1,0]
 v_pk_mul_f32 v[206:207], v[186:187], v[88:89] op_sel:[0,0] op_sel_hi:[1,0]
 v_pk_mul_f32 v[208:209], v[184:185], v[88:89] op_sel:[0,1] op_sel_hi:[1,1]
 v_pk_mul_f32 v[210:211], v[186:187], v[88:89] op_sel:[0,1] op_sel_hi:[1,1]
 v_pk_fma_f32 v[204:205], v[24:25], v[84:85], v[204:205] op_sel:[0,0,0] op_sel_hi:[1,0,1] neg_lo:[0,0,1] neg_hi:[0,0,1]
 v_pk_fma_f32 v[206:207], v[26:27], v[84:85], v[206:207] op_sel:[0,0,0] op_sel_hi:[1,0,1] neg_lo:[0,0,1] neg_hi:[0,0,1]
 v_pk_fma_f32 v[208:209], v[40:41], v[84:85], v[208:209] op_sel:[0,1,0] op_sel_hi:[1,1,1] neg_lo:[0,0,1] neg_hi:[0,0,1]
 v_pk_fma_f32 v[210:211], v[42:43], v[84:85], v[210:211] op_sel:[0,1,0] op_sel_hi:[1,1,1] neg_lo:[0,0,1] neg_hi:[0,0,1]
 v_cvt_pk_bf16_f32 v212, v204, v205
 v_cvt_pk_bf16_f32 v213, v206, v207
 v_cvt_pk_bf16_f32 v214, v208, v209
 v_cvt_pk_bf16_f32 v215, v210, v211
 s_nop 0
 v_permlane16_swap_b32 v212, v214
 v_permlane16_swap_b32 v213, v215
 buffer_store_dwordx4 v[212:215], v203, s[4:7], s30 offen offset:512
 v_pk_mul_f32 v[220:221], v[184:185], v[90:91] op_sel:[0,0] op_sel_hi:[1,0]
 v_pk_mul_f32 v[222:223], v[186:187], v[90:91] op_sel:[0,0] op_sel_hi:[1,0]
 v_pk_mul_f32 v[224:225], v[184:185], v[90:91] op_sel:[0,1] op_sel_hi:[1,1]
 v_pk_mul_f32 v[226:227], v[186:187], v[90:91] op_sel:[0,1] op_sel_hi:[1,1]
 v_pk_fma_f32 v[220:221], v[56:57], v[86:87], v[220:221] op_sel:[0,0,0] op_sel_hi:[1,0,1] neg_lo:[0,0,1] neg_hi:[0,0,1]
 v_pk_fma_f32 v[222:223], v[58:59], v[86:87], v[222:223] op_sel:[0,0,0] op_sel_hi:[1,0,1] neg_lo:[0,0,1] neg_hi:[0,0,1]
 v_pk_fma_f32 v[224:225], v[72:73], v[86:87], v[224:225] op_sel:[0,1,0] op_sel_hi:[1,1,1] neg_lo:[0,0,1] neg_hi:[0,0,1]
 v_pk_fma_f32 v[226:227], v[74:75], v[86:87], v[226:227] op_sel:[0,1,0] op_sel_hi:[1,1,1] neg_lo:[0,0,1] neg_hi:[0,0,1]
 v_cvt_pk_bf16_f32 v228, v220, v221
 v_cvt_pk_bf16_f32 v229, v222, v223
 v_cvt_pk_bf16_f32 v230, v224, v225
 v_cvt_pk_bf16_f32 v231, v226, v227
 s_nop 0
 v_permlane16_swap_b32 v228, v230
 v_permlane16_swap_b32 v229, v231
 buffer_store_dwordx4 v[228:231], v203, s[4:7], s29 offen offset:512
 v_pk_mul_f32 v[204:205], v[164:165], v[196:197] op_sel:[0,0] op_sel_hi:[1,0]
 v_pk_mul_f32 v[206:207], v[166:167], v[196:197] op_sel:[0,0] op_sel_hi:[1,0]
 v_pk_mul_f32 v[208:209], v[168:169], v[196:197] op_sel:[0,0] op_sel_hi:[1,0]
 v_pk_mul_f32 v[210:211], v[170:171], v[196:197] op_sel:[0,0] op_sel_hi:[1,0]
 v_pk_fma_f32 v[204:205], v[28:29], v[148:149], v[204:205] neg_lo:[0,0,1] neg_hi:[0,0,1]
 v_pk_fma_f32 v[206:207], v[30:31], v[150:151], v[206:207] neg_lo:[0,0,1] neg_hi:[0,0,1]
 v_pk_fma_f32 v[208:209], v[44:45], v[152:153], v[208:209] neg_lo:[0,0,1] neg_hi:[0,0,1]
 v_pk_fma_f32 v[210:211], v[46:47], v[154:155], v[210:211] neg_lo:[0,0,1] neg_hi:[0,0,1]
 v_cvt_pk_bf16_f32 v212, v204, v205
 v_cvt_pk_bf16_f32 v213, v206, v207
 v_cvt_pk_bf16_f32 v214, v208, v209
 v_cvt_pk_bf16_f32 v215, v210, v211
 s_nop 0
 v_permlane32_swap_b32 v212, v214
 v_permlane32_swap_b32 v213, v215
 buffer_store_dwordx4 v[212:215], v200, s[4:7], s28 offen offset:0
 v_pk_mul_f32 v[220:221], v[172:173], v[196:197] op_sel:[0,0] op_sel_hi:[1,0]
 v_pk_mul_f32 v[222:223], v[174:175], v[196:197] op_sel:[0,0] op_sel_hi:[1,0]
 v_pk_mul_f32 v[224:225], v[176:177], v[196:197] op_sel:[0,0] op_sel_hi:[1,0]
 v_pk_mul_f32 v[226:227], v[178:179], v[196:197] op_sel:[0,0] op_sel_hi:[1,0]
 v_pk_fma_f32 v[220:221], v[60:61], v[156:157], v[220:221] neg_lo:[0,0,1] neg_hi:[0,0,1]
 v_pk_fma_f32 v[222:223], v[62:63], v[158:159], v[222:223] neg_lo:[0,0,1] neg_hi:[0,0,1]
 v_pk_fma_f32 v[224:225], v[76:77], v[160:161], v[224:225] neg_lo:[0,0,1] neg_hi:[0,0,1]
 v_pk_fma_f32 v[226:227], v[78:79], v[162:163], v[226:227] neg_lo:[0,0,1] neg_hi:[0,0,1]
 v_cvt_pk_bf16_f32 v228, v220, v221
 v_cvt_pk_bf16_f32 v229, v222, v223
 v_cvt_pk_bf16_f32 v230, v224, v225
 v_cvt_pk_bf16_f32 v231, v226, v227
 s_nop 0
 v_permlane32_swap_b32 v228, v230
 v_permlane32_swap_b32 v229, v231
 buffer_store_dwordx4 v[228:231], v200, s[4:7], s28 offen offset:1344
 v_pk_mul_f32 v[204:205], v[164:165], v[196:197] op_sel:[0,1] op_sel_hi:[1,1]
 v_pk_mul_f32 v[206:207], v[166:167], v[196:197] op_sel:[0,1] op_sel_hi:[1,1]
 v_pk_mul_f32 v[208:209], v[168:169], v[196:197] op_sel:[0,1] op_sel_hi:[1,1]
 v_pk_mul_f32 v[210:211], v[170:171], v[196:197] op_sel:[0,1] op_sel_hi:[1,1]
 v_pk_fma_f32 v[204:205], v[32:33], v[148:149], v[204:205] neg_lo:[0,0,1] neg_hi:[0,0,1]
 v_pk_fma_f32 v[206:207], v[34:35], v[150:151], v[206:207] neg_lo:[0,0,1] neg_hi:[0,0,1]
 v_pk_fma_f32 v[208:209], v[48:49], v[152:153], v[208:209] neg_lo:[0,0,1] neg_hi:[0,0,1]
 v_pk_fma_f32 v[210:211], v[50:51], v[154:155], v[210:211] neg_lo:[0,0,1] neg_hi:[0,0,1]
 v_cvt_pk_bf16_f32 v212, v204, v205
 v_cvt_pk_bf16_f32 v213, v206, v207
 v_cvt_pk_bf16_f32 v214, v208, v209
 v_cvt_pk_bf16_f32 v215, v210, v211
 s_nop 0
 v_permlane32_swap_b32 v212, v214
 v_permlane32_swap_b32 v213, v215
 buffer_store_dwordx4 v[212:215], v201, s[4:7], s28 offen offset:0
 v_pk_mul_f32 v[220:221], v[172:173], v[196:197] op_sel:[0,1] op_sel_hi:[1,1]
 v_pk_mul_f32 v[222:223], v[174:175], v[196:197] op_sel:[0,1] op_sel_hi:[1,1]
 v_pk_mul_f32 v[224:225], v[176:177], v[196:197] op_sel:[0,1] op_sel_hi:[1,1]
 v_pk_mul_f32 v[226:227], v[178:179], v[196:197] op_sel:[0,1] op_sel_hi:[1,1]
 v_pk_fma_f32 v[220:221], v[64:65], v[156:157], v[220:221] neg_lo:[0,0,1] neg_hi:[0,0,1]
 v_pk_fma_f32 v[222:223], v[66:67], v[158:159], v[222:223] neg_lo:[0,0,1] neg_hi:[0,0,1]
 v_pk_fma_f32 v[224:225], v[80:81], v[160:161], v[224:225] neg_lo:[0,0,1] neg_hi:[0,0,1]
 v_pk_fma_f32 v[226:227], v[82:83], v[162:163], v[226:227] neg_lo:[0,0,1] neg_hi:[0,0,1]
 v_cvt_pk_bf16_f32 v228, v220, v221
 v_cvt_pk_bf16_f32 v229, v222, v223
 v_cvt_pk_bf16_f32 v230, v224, v225
 v_cvt_pk_bf16_f32 v231, v226, v227
 s_nop 0
 v_permlane32_swap_b32 v228, v230
 v_permlane32_swap_b32 v229, v231
 buffer_store_dwordx4 v[228:231], v201, s[4:7], s28 offen offset:1344
 s_endpgm
C1_q_vv:
 v_and_b32 v8, 15, v1
 v_lshlrev_b32 v9, 2, v8
 buffer_load_dword v196, v9, s[4:7], s31 offen offset:0
 buffer_load_dword v197, v9, s[4:7], s31 offen offset:64
 buffer_load_dword v198, v9, s[4:7], s31 offen offset:128
 v_lshrrev_b32 v9, 5, v1
 v_mul_u32_u24 v9, 672, v9
 v_bfe_u32 v204, v1, 4, 1
 v_mul_u32_u24 v204, 336, v204
 v_add_u32 v9, v9, v204
 s_mul_i32 s23, s22, 80
 s_lshl_b32 s24, s20, 6
 s_add_u32 s23, s23, s24
 s_sub_u32 s23, s23, 160
 v_add_u32 v8, s23, v8
 s_mov_b32 s24, 86016
 v_add_u32 v204, 0, v8
 v_mul_u32_u24 v205, 3277, v204
 v_lshrrev_b32 v205, 16, v205
 v_mul_u32_u24 v206, 20, v205
 v_sub_u32 v206, v204, v206
 v_lshlrev_b32 v206, 4, v206
 v_mul_lo_u32 v205, v205, s24
 v_add_u32 v205, v205, v206
 v_add_u32 v200, v205, v9
 v_add_u32 v204, 16, v8
 v_mul_u32_u24 v205, 3277, v204
 v_lshrrev_b32 v205, 16, v205
 v_mul_u32_u24 v206, 20, v205
 v_sub_u32 v206, v204, v206
 v_lshlrev_b32 v206, 4, v206
 v_mul_lo_u32 v205, v205, s24
 v_add_u32 v205, v205, v206
 v_add_u32 v201, v205, v9
 v_add_u32 v204, 32, v8
 v_mul_u32_u24 v205, 3277, v204
 v_lshrrev_b32 v205, 16, v205
 v_mul_u32_u24 v206, 20, v205
 v_sub_u32 v206, v204, v206
 v_lshlrev_b32 v206, 4, v206
 v_mul_lo_u32 v205, v205, s24
 v_add_u32 v205, v205, v206
 v_add_u32 v202, v205, v9
 v_lshrrev_b32 v9, 4, v1
 v_lshlrev_b32 v9, 4, v9
 v_add_u32 v9, 161792, v9
 s_barrier
 ds_read_b128 v[84:87], v3 offset:46080
 ds_read_b128 v[100:103], v2 offset:0
 ds_read_b128 v[88:91], v3 offset:47104
 ds_read_b128 v[92:95], v3 offset:48128
 ds_read_b128 v[104:107], v2 offset:2048
 ds_read_b128 v[108:111], v2 offset:4096
 ds_read_b128 v[112:115], v2 offset:6144
 s_waitcnt lgkmcnt(0)
 v_mfma_f32_16x16x32_bf16 v[20:23], v[100:103], v[84:87], 0
 ds_read_b128 v[116:119], v3 offset:61440
 v_mfma_f32_16x16x32_bf16 v[24:27], v[100:103], v[88:91], 0
 ds_read_b128 v[132:135], v2 offset:1024
 v_mfma_f32_16x16x32_bf16 v[28:31], v[100:103], v[92:95], 0
 ds_read_b128 v[120:123], v3 offset:62464
 v_mfma_f32_16x16x32_bf16 v[32:35], v[104:107], v[84:87], 0
 ds_read_b128 v[124:127], v3 offset:63488
 v_mfma_f32_16x16x32_bf16 v[36:39], v[104:107], v[88:91], 0
 ds_read_b128 v[136:139], v2 offset:3072
 v_mfma_f32_16x16x32_bf16 v[40:43], v[104:107], v[92:95], 0
 ds_read_b128 v[140:143], v2 offset:5120
 v_mfma_f32_16x16x32_bf16 v[44:47], v[108:111], v[84:87], 0
 ds_read_b128 v[144:147], v2 offset:7168
 v_mfma_f32_16x16x32_bf16 v[48:51], v[108:111], v[88:91], 0
 v_mfma_f32_16x16x32_bf16 v[52:55], v[108:111], v[92:95], 0
 v_mfma_f32_16x16x32_bf16 v[56:59], v[112:115], v[84:87], 0
 v_mfma_f32_16x16x32_bf16 v[60:63], v[112:115], v[88:91], 0
 v_mfma_f32_16x16x32_bf16 v[64:67], v[112:115], v[92:95], 0
 s_waitcnt lgkmcnt(0)
 v_mfma_f32_16x16x32_bf16 v[20:23], v[132:135], v[116:119], v[20:23]
 s_barrier
 ds_read_b128 v[84:87], v4 offset:11264
 v_mfma_f32_16x16x32_bf16 v[24:27], v[132:135], v[120:123], v[24:27]
 ds_read_b128 v[100:103], v2 offset:8192
 v_mfma_f32_16x16x32_bf16 v[28:31], v[132:135], v[124:127], v[28:31]
 ds_read_b128 v[88:91], v4 offset:12288
 v_mfma_f32_16x16x32_bf16 v[32:35], v[136:139], v[116:119], v[32:35]
 ds_read_b128 v[92:95], v4 offset:13312
 v_mfma_f32_16x16x32_bf16 v[36:39], v[136:139], v[120:123], v[36:39]
 ds_read_b128 v[104:107], v2 offset:10240
 v_mfma_f32_16x16x32_bf16 v[40:43], v[136:139], v[124:127], v[40:43]
 ds_read_b128 v[108:111], v2 offset:12288
 v_mfma_f32_16x16x32_bf16 v[44:47], v[140:143], v[116:119], v[44:47]
 ds_read_b128 v[112:115], v2 offset:14336
 v_mfma_f32_16x16x32_bf16 v[48:51], v[140:143], v[120:123], v[48:51]
 v_mfma_f32_16x16x32_bf16 v[52:55], v[140:143], v[124:127], v[52:55]
 v_mfma_f32_16x16x32_bf16 v[56:59], v[144:147], v[116:119], v[56:59]
 v_mfma_f32_16x16x32_bf16 v[60:63], v[144:147], v[120:123], v[60:63]
 v_mfma_f32_16x16x32_bf16 v[64:67], v[144:147], v[124:127], v[64:67]
 s_waitcnt lgkmcnt(0)
 v_mfma_f32_16x16x32_bf16 v[20:23], v[100:103], v[84:87], v[20:23]
 ds_read_b128 v[116:119], v4 offset:26624
 v_mfma_f32_16x16x32_bf16 v[24:27], v[100:103], v[88:91], v[24:27]
 ds_read_b128 v[132:135], v2 offset:9216
 v_mfma_f32_16x16x32_bf16 v[28:31], v[100:103], v[92:95], v[28:31]
 ds_read_b128 v[120:123], v4 offset:27648
 v_mfma_f32_16x16x32_bf16 v[32:35], v[104:107], v[84:87], v[32:35]
 ds_read_b128 v[124:127], v4 offset:28672
 v_mfma_f32_16x16x32_bf16 v[36:39], v[104:107], v[88:91], v[36:39]
 ds_read_b128 v[136:139], v2 offset:11264
 v_mfma_f32_16x16x32_bf16 v[40:43], v[104:107], v[92:95], v[40:43]
 ds_read_b128 v[140:143], v2 offset:13312
 v_mfma_f32_16x16x32_bf16 v[44:47], v[108:111], v[84:87], v[44:47]
 ds_read_b128 v[144:147], v2 offset:15360
 v_mfma_f32_16x16x32_bf16 v[48:51], v[108:111], v[88:91], v[48:51]
 v_mfma_f32_16x16x32_bf16 v[52:55], v[108:111], v[92:95], v[52:55]
 v_mfma_f32_16x16x32_bf16 v[56:59], v[112:115], v[84:87], v[56:59]
 v_mfma_f32_16x16x32_bf16 v[60:63], v[112:115], v[88:91], v[60:63]
 v_mfma_f32_16x16x32_bf16 v[64:67], v[112:115], v[92:95], v[64:67]
 s_waitcnt lgkmcnt(0)
 v_mfma_f32_16x16x32_bf16 v[20:23], v[132:135], v[116:119], v[20:23]
 s_barrier
 ds_read_b128 v[84:87], v3 offset:0
 v_mfma_f32_16x16x32_bf16 v[24:27], v[132:135], v[120:123], v[24:27]
 ds_read_b128 v[100:103], v2 offset:16384
 v_mfma_f32_16x16x32_bf16 v[28:31], v[132:135], v[124:127], v[28:31]
 ds_read_b128 v[88:91], v3 offset:1024
 v_mfma_f32_16x16x32_bf16 v[32:35], v[136:139], v[116:119], v[32:35]
 ds_read_b128 v[92:95], v3 offset:2048
 v_mfma_f32_16x16x32_bf16 v[36:39], v[136:139], v[120:123], v[36:39]
 ds_read_b128 v[104:107], v2 offset:18432
 v_mfma_f32_16x16x32_bf16 v[40:43], v[136:139], v[124:127], v[40:43]
 ds_read_b128 v[108:111], v2 offset:20480
 v_mfma_f32_16x16x32_bf16 v[44:47], v[140:143], v[116:119], v[44:47]
 ds_read_b128 v[112:115], v2 offset:22528
 v_mfma_f32_16x16x32_bf16 v[48:51], v[140:143], v[120:123], v[48:51]
 v_mfma_f32_16x16x32_bf16 v[52:55], v[140:143], v[124:127], v[52:55]
 v_mfma_f32_16x16x32_bf16 v[56:59], v[144:147], v[116:119], v[56:59]
 v_mfma_f32_16x16x32_bf16 v[60:63], v[144:147], v[120:123], v[60:63]
 v_mfma_f32_16x16x32_bf16 v[64:67], v[144:147], v[124:127], v[64:67]
 s_waitcnt lgkmcnt(0)
 v_mfma_f32_16x16x32_bf16 v[20:23], v[100:103], v[84:87], v[20:23]
 ds_read_b128 v[116:119], v3 offset:15360
 v_mfma_f32_16x16x32_bf16 v[24:27], v[100:103], v[88:91], v[24:27]
 ds_read_b128 v[132:135], v2 offset:17408
 v_mfma_f32_16x16x32_bf16 v[28:31], v[100:103], v[92:95], v[28:31]
 ds_read_b128 v[120:123], v3 offset:16384
 v_mfma_f32_16x16x32_bf16 v[32:35], v[104:107], v[84:87], v[32:35]
 ds_read_b128 v[124:127], v3 offset:17408
 v_mfma_f32_16x16x32_bf16 v[36:39], v[104:107], v[88:91], v[36:39]
 ds_read_b128 v[136:139], v2 offset:19456
 v_mfma_f32_16x16x32_bf16 v[40:43], v[104:107], v[92:95], v[40:43]
 ds_read_b128 v[140:143], v2 offset:21504
 v_mfma_f32_16x16x32_bf16 v[44:47], v[108:111], v[84:87], v[44:47]
 ds_read_b128 v[144:147], v2 offset:23552
 v_mfma_f32_16x16x32_bf16 v[48:51], v[108:111], v[88:91], v[48:51]
 v_mfma_f32_16x16x32_bf16 v[52:55], v[108:111], v[92:95], v[52:55]
 v_mfma_f32_16x16x32_bf16 v[56:59], v[112:115], v[84:87], v[56:59]
 v_mfma_f32_16x16x32_bf16 v[60:63], v[112:115], v[88:91], v[60:63]
 v_mfma_f32_16x16x32_bf16 v[64:67], v[112:115], v[92:95], v[64:67]
 s_waitcnt lgkmcnt(0)
 v_mfma_f32_16x16x32_bf16 v[20:23], v[132:135], v[116:119], v[20:23]
 s_barrier
 ds_read_b128 v[84:87], v3 offset:30720
 v_mfma_f32_16x16x32_bf16 v[24:27], v[132:135], v[120:123], v[24:27]
 ds_read_b128 v[100:103], v2 offset:24576
 v_mfma_f32_16x16x32_bf16 v[28:31], v[132:135], v[124:127], v[28:31]
 ds_read_b128 v[88:91], v3 offset:31744
 v_mfma_f32_16x16x32_bf16 v[32:35], v[136:139], v[116:119], v[32:35]
 ds_read_b128 v[92:95], v3 offset:32768
 v_mfma_f32_16x16x32_bf16 v[36:39], v[136:139], v[120:123], v[36:39]
 ds_read_b128 v[104:107], v2 offset:26624
 v_mfma_f32_16x16x32_bf16 v[40:43], v[136:139], v[124:127], v[40:43]
 ds_read_b128 v[108:111], v2 offset:28672
 v_mfma_f32_16x16x32_bf16 v[44:47], v[140:143], v[116:119], v[44:47]
 ds_read_b128 v[112:115], v2 offset:30720
 v_mfma_f32_16x16x32_bf16 v[48:51], v[140:143], v[120:123], v[48:51]
 v_mfma_f32_16x16x32_bf16 v[52:55], v[140:143], v[124:127], v[52:55]
 v_mfma_f32_16x16x32_bf16 v[56:59], v[144:147], v[116:119], v[56:59]
 v_mfma_f32_16x16x32_bf16 v[60:63], v[144:147], v[120:123], v[60:63]
 v_mfma_f32_16x16x32_bf16 v[64:67], v[144:147], v[124:127], v[64:67]
 s_waitcnt lgkmcnt(0)
 v_mfma_f32_16x16x32_bf16 v[20:23], v[100:103], v[84:87], v[20:23]
 ds_read_b128 v[116:119], v3 offset:46080
 v_mfma_f32_16x16x32_bf16 v[24:27], v[100:103], v[88:91], v[24:27]
 ds_read_b128 v[132:135], v2 offset:25600
 v_mfma_f32_16x16x32_bf16 v[28:31], v[100:103], v[92:95], v[28:31]
 ds_read_b128 v[120:123], v3 offset:47104
 v_mfma_f32_16x16x32_bf16 v[32:35], v[104:107], v[84:87], v[32:35]
 ds_read_b128 v[124:127], v3 offset:48128
 v_mfma_f32_16x16x32_bf16 v[36:39], v[104:107], v[88:91], v[36:39]
 ds_read_b128 v[136:139], v2 offset:27648
 v_mfma_f32_16x16x32_bf16 v[40:43], v[104:107], v[92:95], v[40:43]
 ds_read_b128 v[140:143], v2 offset:29696
 v_mfma_f32_16x16x32_bf16 v[44:47], v[108:111], v[84:87], v[44:47]
 ds_read_b128 v[144:147], v2 offset:31744
 v_mfma_f32_16x16x32_bf16 v[48:51], v[108:111], v[88:91], v[48:51]
 v_mfma_f32_16x16x32_bf16 v[52:55], v[108:111], v[92:95], v[52:55]
 v_mfma_f32_16x16x32_bf16 v[56:59], v[112:115], v[84:87], v[56:59]
 v_mfma_f32_16x16x32_bf16 v[60:63], v[112:115], v[88:91], v[60:63]
 v_mfma_f32_16x16x32_bf16 v[64:67], v[112:115], v[92:95], v[64:67]
 s_waitcnt lgkmcnt(0)
 v_mfma_f32_16x16x32_bf16 v[20:23], v[132:135], v[116:119], v[20:23]
 s_barrier
 ds_read_b128 v[84:87], v3 offset:61440
 v_mfma_f32_16x16x32_bf16 v[24:27], v[132:135], v[120:123], v[24:27]
 ds_read_b128 v[100:103], v2 offset:32768
 v_mfma_f32_16x16x32_bf16 v[28:31], v[132:135], v[124:127], v[28:31]
 ds_read_b128 v[88:91], v3 offset:62464
 v_mfma_f32_16x16x32_bf16 v[32:35], v[136:139], v[116:119], v[32:35]
 ds_read_b128 v[92:95], v3 offset:63488
 v_mfma_f32_16x16x32_bf16 v[36:39], v[136:139], v[120:123], v[36:39]
 ds_read_b128 v[104:107], v2 offset:34816
 v_mfma_f32_16x16x32_bf16 v[40:43], v[136:139], v[124:127], v[40:43]
 ds_read_b128 v[108:111], v2 offset:36864
 v_mfma_f32_16x16x32_bf16 v[44:47], v[140:143], v[116:119], v[44:47]
 ds_read_b128 v[112:115], v2 offset:38912
 v_mfma_f32_16x16x32_bf16 v[48:51], v[140:143], v[120:123], v[48:51]
 v_mfma_f32_16x16x32_bf16 v[52:55], v[140:143], v[124:127], v[52:55]
 v_mfma_f32_16x16x32_bf16 v[56:59], v[144:147], v[116:119], v[56:59]
 v_mfma_f32_16x16x32_bf16 v[60:63], v[144:147], v[120:123], v[60:63]
 v_mfma_f32_16x16x32_bf16 v[64:67], v[144:147], v[124:127], v[64:67]
 s_waitcnt lgkmcnt(0)
 v_mfma_f32_16x16x32_bf16 v[20:23], v[100:103], v[84:87], v[20:23]
 ds_read_b128 v[116:119], v4 offset:11264
 v_mfma_f32_16x16x32_bf16 v[24:27], v[100:103], v[88:91], v[24:27]
 ds_read_b128 v[132:135], v2 offset:33792
 v_mfma_f32_16x16x32_bf16 v[28:31], v[100:103], v[92:95], v[28:31]
 ds_read_b128 v[120:123], v4 offset:12288
 v_mfma_f32_16x16x32_bf16 v[32:35], v[104:107], v[84:87], v[32:35]
 ds_read_b128 v[124:127], v4 offset:13312
 v_mfma_f32_16x16x32_bf16 v[36:39], v[104:107], v[88:91], v[36:39]
 ds_read_b128 v[136:139], v2 offset:35840
 v_mfma_f32_16x16x32_bf16 v[40:43], v[104:107], v[92:95], v[40:43]
 ds_read_b128 v[140:143], v2 offset:37888
 v_mfma_f32_16x16x32_bf16 v[44:47], v[108:111], v[84:87], v[44:47]
 ds_read_b128 v[144:147], v2 offset:39936
 v_mfma_f32_16x16x32_bf16 v[48:51], v[108:111], v[88:91], v[48:51]
 v_mfma_f32_16x16x32_bf16 v[52:55], v[108:111], v[92:95], v[52:55]
 v_mfma_f32_16x16x32_bf16 v[56:59], v[112:115], v[84:87], v[56:59]
 v_mfma_f32_16x16x32_bf16 v[60:63], v[112:115], v[88:91], v[60:63]
 v_mfma_f32_16x16x32_bf16 v[64:67], v[112:115], v[92:95], v[64:67]
 s_waitcnt lgkmcnt(0)
 v_mfma_f32_16x16x32_bf16 v[20:23], v[132:135], v[116:119], v[20:23]
 s_barrier
 ds_read_b128 v[84:87], v4 offset:26624
 v_mfma_f32_16x16x32_bf16 v[24:27], v[132:135], v[120:123], v[24:27]
 ds_read_b128 v[100:103], v2 offset:40960
 v_mfma_f32_16x16x32_bf16 v[28:31], v[132:135], v[124:127], v[28:31]
 ds_read_b128 v[88:91], v4 offset:27648
 v_mfma_f32_16x16x32_bf16 v[32:35], v[136:139], v[116:119], v[32:35]
 ds_read_b128 v[92:95], v4 offset:28672
 v_mfma_f32_16x16x32_bf16 v[36:39], v[136:139], v[120:123], v[36:39]
 ds_read_b128 v[104:107], v2 offset:43008
 v_mfma_f32_16x16x32_bf16 v[40:43], v[136:139], v[124:127], v[40:43]
 ds_read_b128 v[108:111], v2 offset:45056
 v_mfma_f32_16x16x32_bf16 v[44:47], v[140:143], v[116:119], v[44:47]
 ds_read_b128 v[112:115], v2 offset:47104
 v_mfma_f32_16x16x32_bf16 v[48:51], v[140:143], v[120:123], v[48:51]
 v_mfma_f32_16x16x32_bf16 v[52:55], v[140:143], v[124:127], v[52:55]
 v_mfma_f32_16x16x32_bf16 v[56:59], v[144:147], v[116:119], v[56:59]
 v_mfma_f32_16x16x32_bf16 v[60:63], v[144:147], v[120:123], v[60:63]
 v_mfma_f32_16x16x32_bf16 v[64:67], v[144:147], v[124:127], v[64:67]
 s_waitcnt lgkmcnt(0)
 v_mfma_f32_16x16x32_bf16 v[20:23], v[100:103], v[84:87], v[20:23]
 ds_read_b128 v[116:119], v3 offset:0
 v_mfma_f32_16x16x32_bf16 v[24:27], v[100:103], v[88:91], v[24:27]
 ds_read_b128 v[132:135], v2 offset:41984
 v_mfma_f32_16x16x32_bf16 v[28:31], v[100:103], v[92:95], v[28:31]
 ds_read_b128 v[120:123], v3 offset:1024
 v_mfma_f32_16x16x32_bf16 v[32:35], v[104:107], v[84:87], v[32:35]
 ds_read_b128 v[124:127], v3 offset:2048
 v_mfma_f32_16x16x32_bf16 v[36:39], v[104:107], v[88:91], v[36:39]
 ds_read_b128 v[136:139], v2 offset:44032
 v_mfma_f32_16x16x32_bf16 v[40:43], v[104:107], v[92:95], v[40:43]
 ds_read_b128 v[140:143], v2 offset:46080
 v_mfma_f32_16x16x32_bf16 v[44:47], v[108:111], v[84:87], v[44:47]
 ds_read_b128 v[144:147], v2 offset:48128
 v_mfma_f32_16x16x32_bf16 v[48:51], v[108:111], v[88:91], v[48:51]
 v_mfma_f32_16x16x32_bf16 v[52:55], v[108:111], v[92:95], v[52:55]
 v_mfma_f32_16x16x32_bf16 v[56:59], v[112:115], v[84:87], v[56:59]
 v_mfma_f32_16x16x32_bf16 v[60:63], v[112:115], v[88:91], v[60:63]
 v_mfma_f32_16x16x32_bf16 v[64:67], v[112:115], v[92:95], v[64:67]
 s_waitcnt lgkmcnt(0)
 v_mfma_f32_16x16x32_bf16 v[20:23], v[132:135], v[116:119], v[20:23]
 s_barrier
 ds_read_b128 v[84:87], v3 offset:15360
 v_mfma_f32_16x16x32_bf16 v[24:27], v[132:135], v[120:123], v[24:27]
 ds_read_b128 v[100:103], v2 offset:0
 v_mfma_f32_16x16x32_bf16 v[28:31], v[132:135], v[124:127], v[28:31]
 ds_read_b128 v[88:91], v3 offset:16384
 v_mfma_f32_16x16x32_bf16 v[32:35], v[136:139], v[116:119], v[32:35]
 ds_read_b128 v[92:95], v3 offset:17408
 v_mfma_f32_16x16x32_bf16 v[36:39], v[136:139], v[120:123], v[36:39]
 ds_read_b128 v[104:107], v2 offset:2048
 v_mfma_f32_16x16x32_bf16 v[40:43], v[136:139], v[124:127], v[40:43]
 ds_read_b128 v[108:111], v2 offset:4096
 v_mfma_f32_16x16x32_bf16 v[44:47], v[140:143], v[116:119], v[44:47]
 ds_read_b128 v[112:115], v2 offset:6144
 v_mfma_f32_16x16x32_bf16 v[48:51], v[140:143], v[120:123], v[48:51]
 v_mfma_f32_16x16x32_bf16 v[52:55], v[140:143], v[124:127], v[52:55]
 v_mfma_f32_16x16x32_bf16 v[56:59], v[144:147], v[116:119], v[56:59]
 v_mfma_f32_16x16x32_bf16 v[60:63], v[144:147], v[120:123], v[60:63]
 v_mfma_f32_16x16x32_bf16 v[64:67], v[144:147], v[124:127], v[64:67]
 s_waitcnt lgkmcnt(0)
 v_mfma_f32_16x16x32_bf16 v[20:23], v[100:103], v[84:87], v[20:23]
 ds_read_b128 v[116:119], v3 offset:30720
 v_mfma_f32_16x16x32_bf16 v[24:27], v[100:103], v[88:91], v[24:27]
 ds_read_b128 v[132:135], v2 offset:1024
 v_mfma_f32_16x16x32_bf16 v[28:31], v[100:103], v[92:95], v[28:31]
 ds_read_b128 v[120:123], v3 offset:31744
 v_mfma_f32_16x16x32_bf16 v[32:35], v[104:107], v[84:87], v[32:35]
 ds_read_b128 v[124:127], v3 offset:32768
 v_mfma_f32_16x16x32_bf16 v[36:39], v[104:107], v[88:91], v[36:39]
 ds_read_b128 v[136:139], v2 offset:3072
 v_mfma_f32_16x16x32_bf16 v[40:43], v[104:107], v[92:95], v[40:43]
 ds_read_b128 v[140:143], v2 offset:5120
 v_mfma_f32_16x16x32_bf16 v[44:47], v[108:111], v[84:87], v[44:47]
 ds_read_b128 v[144:147], v2 offset:7168
 v_mfma_f32_16x16x32_bf16 v[48:51], v[108:111], v[88:91], v[48:51]
 v_mfma_f32_16x16x32_bf16 v[52:55], v[108:111], v[92:95], v[52:55]
 v_mfma_f32_16x16x32_bf16 v[56:59], v[112:115], v[84:87], v[56:59]
 v_mfma_f32_16x16x32_bf16 v[60:63], v[112:115], v[88:91], v[60:63]
 v_mfma_f32_16x16x32_bf16 v[64:67], v[112:115], v[92:95], v[64:67]
 s_waitcnt lgkmcnt(0)
 v_mfma_f32_16x16x32_bf16 v[20:23], v[132:135], v[116:119], v[20:23]
 s_barrier
 ds_read_b128 v[84:87], v3 offset:46080
 v_mfma_f32_16x16x32_bf16 v[24:27], v[132:135], v[120:123], v[24:27]
 ds_read_b128 v[100:103], v2 offset:8192
 v_mfma_f32_16x16x32_bf16 v[28:31], v[132:135], v[124:127], v[28:31]
 ds_read_b128 v[88:91], v3 offset:47104
 v_mfma_f32_16x16x32_bf16 v[32:35], v[136:139], v[116:119], v[32:35]
 ds_read_b128 v[92:95], v3 offset:48128
 v_mfma_f32_16x16x32_bf16 v[36:39], v[136:139], v[120:123], v[36:39]
 ds_read_b128 v[104:107], v2 offset:10240
 v_mfma_f32_16x16x32_bf16 v[40:43], v[136:139], v[124:127], v[40:43]
 ds_read_b128 v[108:111], v2 offset:12288
 v_mfma_f32_16x16x32_bf16 v[44:47], v[140:143], v[116:119], v[44:47]
 ds_read_b128 v[112:115], v2 offset:14336
 v_mfma_f32_16x16x32_bf16 v[48:51], v[140:143], v[120:123], v[48:51]
 v_mfma_f32_16x16x32_bf16 v[52:55], v[140:143], v[124:127], v[52:55]
 v_mfma_f32_16x16x32_bf16 v[56:59], v[144:147], v[116:119], v[56:59]
 v_mfma_f32_16x16x32_bf16 v[60:63], v[144:147], v[120:123], v[60:63]
 v_mfma_f32_16x16x32_bf16 v[64:67], v[144:147], v[124:127], v[64:67]
 s_waitcnt lgkmcnt(0)
 v_mfma_f32_16x16x32_bf16 v[20:23], v[100:103], v[84:87], v[20:23]
 ds_read_b128 v[116:119], v3 offset:61440
 v_mfma_f32_16x16x32_bf16 v[24:27], v[100:103], v[88:91], v[24:27]
 ds_read_b128 v[132:135], v2 offset:9216
 v_mfma_f32_16x16x32_bf16 v[28:31], v[100:103], v[92:95], v[28:31]
 ds_read_b128 v[120:123], v3 offset:62464
 v_mfma_f32_16x16x32_bf16 v[32:35], v[104:107], v[84:87], v[32:35]
 ds_read_b128 v[124:127], v3 offset:63488
 v_mfma_f32_16x16x32_bf16 v[36:39], v[104:107], v[88:91], v[36:39]
 ds_read_b128 v[136:139], v2 offset:11264
 v_mfma_f32_16x16x32_bf16 v[40:43], v[104:107], v[92:95], v[40:43]
 ds_read_b128 v[140:143], v2 offset:13312
 v_mfma_f32_16x16x32_bf16 v[44:47], v[108:111], v[84:87], v[44:47]
 ds_read_b128 v[144:147], v2 offset:15360
 v_mfma_f32_16x16x32_bf16 v[48:51], v[108:111], v[88:91], v[48:51]
 v_mfma_f32_16x16x32_bf16 v[52:55], v[108:111], v[92:95], v[52:55]
 v_mfma_f32_16x16x32_bf16 v[56:59], v[112:115], v[84:87], v[56:59]
 v_mfma_f32_16x16x32_bf16 v[60:63], v[112:115], v[88:91], v[60:63]
 v_mfma_f32_16x16x32_bf16 v[64:67], v[112:115], v[92:95], v[64:67]
 s_waitcnt lgkmcnt(0)
 v_mfma_f32_16x16x32_bf16 v[20:23], v[132:135], v[116:119], v[20:23]
 s_barrier
 ds_read_b128 v[84:87], v4 offset:11264
 v_mfma_f32_16x16x32_bf16 v[24:27], v[132:135], v[120:123], v[24:27]
 ds_read_b128 v[100:103], v2 offset:16384
 v_mfma_f32_16x16x32_bf16 v[28:31], v[132:135], v[124:127], v[28:31]
 ds_read_b128 v[88:91], v4 offset:12288
 v_mfma_f32_16x16x32_bf16 v[32:35], v[136:139], v[116:119], v[32:35]
 ds_read_b128 v[92:95], v4 offset:13312
 v_mfma_f32_16x16x32_bf16 v[36:39], v[136:139], v[120:123], v[36:39]
 ds_read_b128 v[104:107], v2 offset:18432
 v_mfma_f32_16x16x32_bf16 v[40:43], v[136:139], v[124:127], v[40:43]
 ds_read_b128 v[108:111], v2 offset:20480
 v_mfma_f32_16x16x32_bf16 v[44:47], v[140:143], v[116:119], v[44:47]
 ds_read_b128 v[112:115], v2 offset:22528
 v_mfma_f32_16x16x32_bf16 v[48:51], v[140:143], v[120:123], v[48:51]
 v_mfma_f32_16x16x32_bf16 v[52:55], v[140:143], v[124:127], v[52:55]
 v_mfma_f32_16x16x32_bf16 v[56:59], v[144:147], v[116:119], v[56:59]
 v_mfma_f32_16x16x32_bf16 v[60:63], v[144:147], v[120:123], v[60:63]
 v_mfma_f32_16x16x32_bf16 v[64:67], v[144:147], v[124:127], v[64:67]
 s_waitcnt lgkmcnt(0)
 v_mfma_f32_16x16x32_bf16 v[20:23], v[100:103], v[84:87], v[20:23]
 ds_read_b128 v[116:119], v4 offset:26624
 v_mfma_f32_16x16x32_bf16 v[24:27], v[100:103], v[88:91], v[24:27]
 ds_read_b128 v[132:135], v2 offset:17408
 v_mfma_f32_16x16x32_bf16 v[28:31], v[100:103], v[92:95], v[28:31]
 ds_read_b128 v[120:123], v4 offset:27648
 v_mfma_f32_16x16x32_bf16 v[32:35], v[104:107], v[84:87], v[32:35]
 ds_read_b128 v[124:127], v4 offset:28672
 v_mfma_f32_16x16x32_bf16 v[36:39], v[104:107], v[88:91], v[36:39]
 ds_read_b128 v[136:139], v2 offset:19456
 v_mfma_f32_16x16x32_bf16 v[40:43], v[104:107], v[92:95], v[40:43]
 ds_read_b128 v[140:143], v2 offset:21504
 v_mfma_f32_16x16x32_bf16 v[44:47], v[108:111], v[84:87], v[44:47]
 ds_read_b128 v[144:147], v2 offset:23552
 v_mfma_f32_16x16x32_bf16 v[48:51], v[108:111], v[88:91], v[48:51]
 v_mfma_f32_16x16x32_bf16 v[52:55], v[108:111], v[92:95], v[52:55]
 v_mfma_f32_16x16x32_bf16 v[56:59], v[112:115], v[84:87], v[56:59]
 v_mfma_f32_16x16x32_bf16 v[60:63], v[112:115], v[88:91], v[60:63]
 v_mfma_f32_16x16x32_bf16 v[64:67], v[112:115], v[92:95], v[64:67]
 s_waitcnt lgkmcnt(0)
 v_mfma_f32_16x16x32_bf16 v[20:23], v[132:135], v[116:119], v[20:23]
 s_barrier
 ds_read_b128 v[84:87], v3 offset:0
 v_mfma_f32_16x16x32_bf16 v[24:27], v[132:135], v[120:123], v[24:27]
 ds_read_b128 v[100:103], v2 offset:24576
 v_mfma_f32_16x16x32_bf16 v[28:31], v[132:135], v[124:127], v[28:31]
 ds_read_b128 v[88:91], v3 offset:1024
 v_mfma_f32_16x16x32_bf16 v[32:35], v[136:139], v[116:119], v[32:35]
 ds_read_b128 v[92:95], v3 offset:2048
 v_mfma_f32_16x16x32_bf16 v[36:39], v[136:139], v[120:123], v[36:39]
 ds_read_b128 v[104:107], v2 offset:26624
 v_mfma_f32_16x16x32_bf16 v[40:43], v[136:139], v[124:127], v[40:43]
 ds_read_b128 v[108:111], v2 offset:28672
 v_mfma_f32_16x16x32_bf16 v[44:47], v[140:143], v[116:119], v[44:47]
 ds_read_b128 v[112:115], v2 offset:30720
 v_mfma_f32_16x16x32_bf16 v[48:51], v[140:143], v[120:123], v[48:51]
 v_mfma_f32_16x16x32_bf16 v[52:55], v[140:143], v[124:127], v[52:55]
 v_mfma_f32_16x16x32_bf16 v[56:59], v[144:147], v[116:119], v[56:59]
 v_mfma_f32_16x16x32_bf16 v[60:63], v[144:147], v[120:123], v[60:63]
 v_mfma_f32_16x16x32_bf16 v[64:67], v[144:147], v[124:127], v[64:67]
 s_waitcnt lgkmcnt(0)
 v_mfma_f32_16x16x32_bf16 v[20:23], v[100:103], v[84:87], v[20:23]
 ds_read_b128 v[116:119], v3 offset:15360
 v_mfma_f32_16x16x32_bf16 v[24:27], v[100:103], v[88:91], v[24:27]
 ds_read_b128 v[132:135], v2 offset:25600
 v_mfma_f32_16x16x32_bf16 v[28:31], v[100:103], v[92:95], v[28:31]
 ds_read_b128 v[120:123], v3 offset:16384
 v_mfma_f32_16x16x32_bf16 v[32:35], v[104:107], v[84:87], v[32:35]
 ds_read_b128 v[124:127], v3 offset:17408
 v_mfma_f32_16x16x32_bf16 v[36:39], v[104:107], v[88:91], v[36:39]
 ds_read_b128 v[136:139], v2 offset:27648
 v_mfma_f32_16x16x32_bf16 v[40:43], v[104:107], v[92:95], v[40:43]
 ds_read_b128 v[140:143], v2 offset:29696
 v_mfma_f32_16x16x32_bf16 v[44:47], v[108:111], v[84:87], v[44:47]
 ds_read_b128 v[144:147], v2 offset:31744
 v_mfma_f32_16x16x32_bf16 v[48:51], v[108:111], v[88:91], v[48:51]
 v_mfma_f32_16x16x32_bf16 v[52:55], v[108:111], v[92:95], v[52:55]
 v_mfma_f32_16x16x32_bf16 v[56:59], v[112:115], v[84:87], v[56:59]
 v_mfma_f32_16x16x32_bf16 v[60:63], v[112:115], v[88:91], v[60:63]
 v_mfma_f32_16x16x32_bf16 v[64:67], v[112:115], v[92:95], v[64:67]
 s_waitcnt lgkmcnt(0)
 v_mfma_f32_16x16x32_bf16 v[20:23], v[132:135], v[116:119], v[20:23]
 s_barrier
 v_mfma_f32_16x16x32_bf16 v[24:27], v[132:135], v[120:123], v[24:27]
 ds_read_b128 v[148:151], v9 offset:0
 ds_read_b128 v[164:167], v9 offset:256
 v_mfma_f32_16x16x32_bf16 v[28:31], v[132:135], v[124:127], v[28:31]
 ds_read_b128 v[152:155], v9 offset:64
 ds_read_b128 v[168:171], v9 offset:320
 v_mfma_f32_16x16x32_bf16 v[32:35], v[136:139], v[116:119], v[32:35]
 ds_read_b128 v[156:159], v9 offset:128
 ds_read_b128 v[172:175], v9 offset:384
 v_mfma_f32_16x16x32_bf16 v[36:39], v[136:139], v[120:123], v[36:39]
 ds_read_b128 v[160:163], v9 offset:192
 ds_read_b128 v[176:179], v9 offset:448
 v_mfma_f32_16x16x32_bf16 v[40:43], v[136:139], v[124:127], v[40:43]
 v_mfma_f32_16x16x32_bf16 v[44:47], v[140:143], v[116:119], v[44:47]
 v_mfma_f32_16x16x32_bf16 v[48:51], v[140:143], v[120:123], v[48:51]
 v_mfma_f32_16x16x32_bf16 v[52:55], v[140:143], v[124:127], v[52:55]
 v_mfma_f32_16x16x32_bf16 v[56:59], v[144:147], v[116:119], v[56:59]
 v_mfma_f32_16x16x32_bf16 v[60:63], v[144:147], v[120:123], v[60:63]
 v_mfma_f32_16x16x32_bf16 v[64:67], v[144:147], v[124:127], v[64:67]
 s_waitcnt vmcnt(0) lgkmcnt(0)
 v_pk_mul_f32 v[204:205], v[164:165], v[196:197] op_sel:[0,0] op_sel_hi:[1,0]
 v_pk_mul_f32 v[206:207], v[166:167], v[196:197] op_sel:[0,0] op_sel_hi:[1,0]
 v_pk_mul_f32 v[208:209], v[168:169], v[196:197] op_sel:[0,0] op_sel_hi:[1,0]
 v_pk_mul_f32 v[210:211], v[170:171], v[196:197] op_sel:[0,0] op_sel_hi:[1,0]
 v_pk_fma_f32 v[204:205], v[20:21], v[148:149], v[204:205] neg_lo:[0,0,1] neg_hi:[0,0,1]
 v_pk_fma_f32 v[206:207], v[22:23], v[150:151], v[206:207] neg_lo:[0,0,1] neg_hi:[0,0,1]
 v_pk_fma_f32 v[208:209], v[32:33], v[152:153], v[208:209] neg_lo:[0,0,1] neg_hi:[0,0,1]
 v_pk_fma_f32 v[210:211], v[34:35], v[154:155], v[210:211] neg_lo:[0,0,1] neg_hi:[0,0,1]
 v_cvt_pk_bf16_f32 v212, v204, v205
 v_cvt_pk_bf16_f32 v213, v206, v207
 v_cvt_pk_bf16_f32 v214, v208, v209
 v_cvt_pk_bf16_f32 v215, v210, v211
 s_nop 0
 v_permlane32_swap_b32 v212, v214
 v_permlane32_swap_b32 v213, v215
 buffer_store_dwordx4 v[212:215], v200, s[4:7], s28 offen offset:0
 v_pk_mul_f32 v[220:221], v[172:173], v[196:197] op_sel:[0,0] op_sel_hi:[1,0]
 v_pk_mul_f32 v[222:223], v[174:175], v[196:197] op_sel:[0,0] op_sel_hi:[1,0]
 v_pk_mul_f32 v[224:225], v[176:177], v[196:197] op_sel:[0,0] op_sel_hi:[1,0]
 v_pk_mul_f32 v[226:227], v[178:179], v[196:197] op_sel:[0,0] op_sel_hi:[1,0]
 v_pk_fma_f32 v[220:221], v[44:45], v[156:157], v[220:221] neg_lo:[0,0,1] neg_hi:[0,0,1]
 v_pk_fma_f32 v[222:223], v[46:47], v[158:159], v[222:223] neg_lo:[0,0,1] neg_hi:[0,0,1]
 v_pk_fma_f32 v[224:225], v[56:57], v[160:161], v[224:225] neg_lo:[0,0,1] neg_hi:[0,0,1]
 v_pk_fma_f32 v[226:227], v[58:59], v[162:163], v[226:227] neg_lo:[0,0,1] neg_hi:[0,0,1]
 v_cvt_pk_bf16_f32 v228, v220, v221
 v_cvt_pk_bf16_f32 v229, v222, v223
 v_cvt_pk_bf16_f32 v230, v224, v225
 v_cvt_pk_bf16_f32 v231, v226, v227
 s_nop 0
 v_permlane32_swap_b32 v228, v230
 v_permlane32_swap_b32 v229, v231
 buffer_store_dwordx4 v[228:231], v200, s[4:7], s28 offen offset:1344
 v_pk_mul_f32 v[204:205], v[164:165], v[196:197] op_sel:[0,1] op_sel_hi:[1,1]
 v_pk_mul_f32 v[206:207], v[166:167], v[196:197] op_sel:[0,1] op_sel_hi:[1,1]
 v_pk_mul_f32 v[208:209], v[168:169], v[196:197] op_sel:[0,1] op_sel_hi:[1,1]
 v_pk_mul_f32 v[210:211], v[170:171], v[196:197] op_sel:[0,1] op_sel_hi:[1,1]
 v_pk_fma_f32 v[204:205], v[24:25], v[148:149], v[204:205] neg_lo:[0,0,1] neg_hi:[0,0,1]
 v_pk_fma_f32 v[206:207], v[26:27], v[150:151], v[206:207] neg_lo:[0,0,1] neg_hi:[0,0,1]
 v_pk_fma_f32 v[208:209], v[36:37], v[152:153], v[208:209] neg_lo:[0,0,1] neg_hi:[0,0,1]
 v_pk_fma_f32 v[210:211], v[38:39], v[154:155], v[210:211] neg_lo:[0,0,1] neg_hi:[0,0,1]
 v_cvt_pk_bf16_f32 v212, v204, v205
 v_cvt_pk_bf16_f32 v213, v206, v207
 v_cvt_pk_bf16_f32 v214, v208, v209
 v_cvt_pk_bf16_f32 v215, v210, v211
 s_nop 0
 v_permlane32_swap_b32 v212, v214
 v_permlane32_swap_b32 v213, v215
 buffer_store_dwordx4 v[212:215], v201, s[4:7], s28 offen offset:0
 v_pk_mul_f32 v[220:221], v[172:173], v[196:197] op_sel:[0,1] op_sel_hi:[1,1]
 v_pk_mul_f32 v[222:223], v[174:175], v[196:197] op_sel:[0,1] op_sel_hi:[1,1]
 v_pk_mul_f32 v[224:225], v[176:177], v[196:197] op_sel:[0,1] op_sel_hi:[1,1]
 v_pk_mul_f32 v[226:227], v[178:179], v[196:197] op_sel:[0,1] op_sel_hi:[1,1]
 v_pk_fma_f32 v[220:221], v[48:49], v[156:157], v[220:221] neg_lo:[0,0,1] neg_hi:[0,0,1]
 v_pk_fma_f32 v[222:223], v[50:51], v[158:159], v[222:223] neg_lo:[0,0,1] neg_hi:[0,0,1]
 v_pk_fma_f32 v[224:225], v[60:61], v[160:161], v[224:225] neg_lo:[0,0,1] neg_hi:[0,0,1]
 v_pk_fma_f32 v[226:227], v[62:63], v[162:163], v[226:227] neg_lo:[0,0,1] neg_hi:[0,0,1]
 v_cvt_pk_bf16_f32 v228, v220, v221
 v_cvt_pk_bf16_f32 v229, v222, v223
 v_cvt_pk_bf16_f32 v230, v224, v225
 v_cvt_pk_bf16_f32 v231, v226, v227
 s_nop 0
 v_permlane32_swap_b32 v228, v230
 v_permlane32_swap_b32 v229, v231
 buffer_store_dwordx4 v[228:231], v201, s[4:7], s28 offen offset:1344
 v_pk_mul_f32 v[204:205], v[164:165], v[198:199] op_sel:[0,0] op_sel_hi:[1,0]
 v_pk_mul_f32 v[206:207], v[166:167], v[198:199] op_sel:[0,0] op_sel_hi:[1,0]
 v_pk_mul_f32 v[208:209], v[168:169], v[198:199] op_sel:[0,0] op_sel_hi:[1,0]
 v_pk_mul_f32 v[210:211], v[170:171], v[198:199] op_sel:[0,0] op_sel_hi:[1,0]
 v_pk_fma_f32 v[204:205], v[28:29], v[148:149], v[204:205] neg_lo:[0,0,1] neg_hi:[0,0,1]
 v_pk_fma_f32 v[206:207], v[30:31], v[150:151], v[206:207] neg_lo:[0,0,1] neg_hi:[0,0,1]
 v_pk_fma_f32 v[208:209], v[40:41], v[152:153], v[208:209] neg_lo:[0,0,1] neg_hi:[0,0,1]
 v_pk_fma_f32 v[210:211], v[42:43], v[154:155], v[210:211] neg_lo:[0,0,1] neg_hi:[0,0,1]
 v_cvt_pk_bf16_f32 v212, v204, v205
 v_cvt_pk_bf16_f32 v213, v206, v207
 v_cvt_pk_bf16_f32 v214, v208, v209
 v_cvt_pk_bf16_f32 v215, v210, v211
 s_nop 0
 v_permlane32_swap_b32 v212, v214
 v_permlane32_swap_b32 v213, v215
 buffer_store_dwordx4 v[212:215], v202, s[4:7], s28 offen offset:0
 v_pk_mul_f32 v[220:221], v[172:173], v[198:199] op_sel:[0,0] op_sel_hi:[1,0]
 v_pk_mul_f32 v[222:223], v[174:175], v[198:199] op_sel:[0,0] op_sel_hi:[1,0]
 v_pk_mul_f32 v[224:225], v[176:177], v[198:199] op_sel:[0,0] op_sel_hi:[1,0]
 v_pk_mul_f32 v[226:227], v[178:179], v[198:199] op_sel:[0,0] op_sel_hi:[1,0]
 v_pk_fma_f32 v[220:221], v[52:53], v[156:157], v[220:221] neg_lo:[0,0,1] neg_hi:[0,0,1]
 v_pk_fma_f32 v[222:223], v[54:55], v[158:159], v[222:223] neg_lo:[0,0,1] neg_hi:[0,0,1]
 v_pk_fma_f32 v[224:225], v[64:65], v[160:161], v[224:225] neg_lo:[0,0,1] neg_hi:[0,0,1]
 v_pk_fma_f32 v[226:227], v[66:67], v[162:163], v[226:227] neg_lo:[0,0,1] neg_hi:[0,0,1]
 v_cvt_pk_bf16_f32 v228, v220, v221
 v_cvt_pk_bf16_f32 v229, v222, v223
 v_cvt_pk_bf16_f32 v230, v224, v225
 v_cvt_pk_bf16_f32 v231, v226, v227
 s_nop 0
 v_permlane32_swap_b32 v228, v230
 v_permlane32_swap_b32 v229, v231
 buffer_store_dwordx4 v[228:231], v202, s[4:7], s28 offen offset:1344
 s_endpgm
C1_oe_slow:
 s_nop 7
 s_nop 7
 s_nop 3
 buffer_store_dwordx4 v[24:27], v168, s[4:7], s52 offen sc1
 buffer_store_dwordx4 v[32:35], v168, s[4:7], s53 offen sc1
 s_mov_b32 exec_hi, 0
 buffer_store_dwordx2 v[28:29], v169, s[4:7], s52 offen sc1
 buffer_store_dwordx2 v[36:37], v169, s[4:7], s53 offen sc1
 s_mov_b64 exec, 1
 v_mov_b32 v8, 0
 v_mov_b32 v9, 1
 s_waitcnt vmcnt(0)
 buffer_store_dword v9, v8, s[4:7], s45 offen sc1
 buffer_store_dword v9, v8, s[4:7], s47 offen sc1
 s_mov_b64 exec, -1
 s_branch C1_oe_join
C1_e0_slow:
 s_nop 7
 s_nop 7
 s_nop 3
 s_add_u32 s24, s30, 0xbf2000
 buffer_store_dwordx4 v[10:13], v5, s[4:7], s24 offen offset:0 sc1
 buffer_store_dwordx4 v[14:17], v5, s[4:7], s24 offen offset:1024 sc1
 buffer_store_dwordx2 v[18:19], v6, s[4:7], s24 offen offset:2048 sc1
 v_pk_add_f32 v[204:205], v[20:21], v[22:23]
 v_pk_mul_f32 v[206:207], v[20:21], v[20:21]
 v_pk_fma_f32 v[206:207], v[22:23], v[22:23], v[206:207]
 v_pk_add_f32 v[208:209], v[24:25], v[26:27]
 v_pk_mul_f32 v[210:211], v[24:25], v[24:25]
 v_pk_fma_f32 v[210:211], v[26:27], v[26:27], v[210:211]
 v_pk_add_f32 v[204:205], v[204:205], v[28:29]
 v_pk_fma_f32 v[206:207], v[28:29], v[28:29], v[206:207]
 v_pk_add_f32 v[208:209], v[208:209], v[30:31]
 v_pk_fma_f32 v[210:211], v[30:31], v[30:31], v[210:211]
 v_pk_add_f32 v[204:205], v[204:205], v[32:33]
 v_pk_fma_f32 v[206:207], v[32:33], v[32:33], v[206:207]
 v_pk_add_f32 v[208:209], v[208:209], v[34:35]
 v_pk_fma_f32 v[210:211], v[34:35], v[34:35], v[210:211]
 v_pk_add_f32 v[204:205], v[204:205], v[36:37]
 v_pk_fma_f32 v[206:207], v[36:37], v[36:37], v[206:207]
 v_pk_add_f32 v[208:209], v[208:209], v[38:39]
 v_pk_fma_f32 v[210:211], v[38:39], v[38:39], v[210:211]
 v_pk_add_f32 v[204:205], v[204:205], v[208:209]
 v_pk_add_f32 v[206:207], v[206:207], v[210:211]
 v_add_f32 v212, v204, v205
 v_add_f32 v213, v206, v207
 v_mov_b32 v214, v212
 v_mov_b32 v215, v213
 s_nop 0
 v_permlane16_swap_b32 v212, v214
 v_permlane16_swap_b32 v213, v215
 v_add_f32 v212, v212, v214
 v_add_f32 v213, v213, v215
 v_mov_b32 v214, v212
 v_mov_b32 v215, v213
 s_nop 0
 v_permlane32_swap_b32 v212, v214
 v_permlane32_swap_b32 v213, v215
 v_add_f32 v212, v212, v214
 v_add_f32 v213, v213, v215
 s_mov_b64 exec, 0xffff
 buffer_store_dwordx2 v[212:213], v70, s[4:7], s26 offen sc1
 s_mov_b64 exec, -1
 s_lshl_b32 s23, s21, 7
 s_lshl_b32 s24, s22, 4
 s_add_u32 s23, s23, s24
 s_lshl_b32 s24, s20, 2
 s_add_u32 s23, s23, s24
 s_add_u32 s23, s23, 0x6e8000
 v_mov_b32 v8, 0
 v_mov_b32 v9, 1
 s_mov_b64 exec, 1
 s_waitcnt vmcnt(0)
 buffer_store_dword v9, v8, s[4:7], s23 offen sc1
 s_mov_b64 exec, -1
 s_branch C1_e0_join
C1_e1_slow:
 s_nop 7
 s_nop 7
 s_nop 3
 v_pk_fma_f32 v[108:109], v[180:181], v[88:89], v[68:69] op_sel:[0,0,0] op_sel_hi:[1,0,1] neg_lo:[0,1,0] neg_hi:[0,1,0]
 v_pk_fma_f32 v[110:111], v[182:183], v[88:89], v[70:71] op_sel:[0,0,0] op_sel_hi:[1,0,1] neg_lo:[0,1,0] neg_hi:[0,1,0]
 v_pk_fma_f32 v[112:113], v[180:181], v[88:89], v[68:69] op_sel:[0,1,0] op_sel_hi:[1,1,1] neg_lo:[0,1,0] neg_hi:[0,1,0]
 v_pk_fma_f32 v[114:115], v[182:183], v[88:89], v[70:71] op_sel:[0,1,0] op_sel_hi:[1,1,1] neg_lo:[0,1,0] neg_hi:[0,1,0]
 v_pk_fma_f32 v[108:109], v[20:21], v[84:85], v[108:109] op_sel:[0,0,0] op_sel_hi:[1,0,1]
 v_pk_fma_f32 v[110:111], v[22:23], v[84:85], v[110:111] op_sel:[0,0,0] op_sel_hi:[1,0,1]
 v_pk_fma_f32 v[112:113], v[32:33], v[84:85], v[112:113] op_sel:[0,1,0] op_sel_hi:[1,1,1]
 v_pk_fma_f32 v[114:115], v[34:35], v[84:85], v[114:115] op_sel:[0,1,0] op_sel_hi:[1,1,1]
 v_pk_mul_f32 v[116:117], v[108:109], v[108:109]
 v_pk_mul_f32 v[118:119], v[110:111], v[110:111]
 v_pk_mul_f32 v[120:121], v[112:113], v[112:113]
 v_pk_mul_f32 v[122:123], v[114:115], v[114:115]
 v_pk_fma_f32 v[116:117], v[116:117], v[80:81], v[80:81] op_sel:[0,1,0] op_sel_hi:[1,1,0]
 v_pk_fma_f32 v[118:119], v[118:119], v[80:81], v[80:81] op_sel:[0,1,0] op_sel_hi:[1,1,0]
 v_pk_fma_f32 v[120:121], v[120:121], v[80:81], v[80:81] op_sel:[0,1,0] op_sel_hi:[1,1,0]
 v_pk_fma_f32 v[122:123], v[122:123], v[80:81], v[80:81] op_sel:[0,1,0] op_sel_hi:[1,1,0]
 v_pk_mul_f32 v[116:117], v[116:117], v[108:109]
 v_pk_mul_f32 v[118:119], v[118:119], v[110:111]
 v_pk_mul_f32 v[120:121], v[120:121], v[112:113]
 v_pk_mul_f32 v[122:123], v[122:123], v[114:115]
 v_exp_f32 v116, v116
 v_exp_f32 v117, v117
 v_exp_f32 v118, v118
 v_exp_f32 v119, v119
 v_exp_f32 v120, v120
 v_exp_f32 v121, v121
 v_exp_f32 v122, v122
 v_exp_f32 v123, v123
 v_pk_add_f32 v[116:117], v[116:117], v[82:83]
 v_pk_add_f32 v[118:119], v[118:119], v[82:83]
 v_pk_add_f32 v[120:121], v[120:121], v[82:83]
 v_pk_add_f32 v[122:123], v[122:123], v[82:83]
 v_rcp_f32 v116, v116
 v_rcp_f32 v117, v117
 v_rcp_f32 v118, v118
 v_rcp_f32 v119, v119
 v_rcp_f32 v120, v120
 v_rcp_f32 v121, v121
 v_rcp_f32 v122, v122
 v_rcp_f32 v123, v123
 v_pk_mul_f32 v[116:117], v[116:117], v[108:109]
 v_pk_mul_f32 v[118:119], v[118:119], v[110:111]
 v_pk_mul_f32 v[120:121], v[120:121], v[112:113]
 v_pk_mul_f32 v[122:123], v[122:123], v[114:115]
 v_cvt_pk_bf16_f32 v124, v116, v117
 v_cvt_pk_bf16_f32 v125, v118, v119
 v_cvt_pk_bf16_f32 v126, v120, v121
 v_cvt_pk_bf16_f32 v127, v122, v123
 s_nop 0
 v_permlane16_swap_b32 v124, v126
 v_permlane16_swap_b32 v125, v127
 buffer_store_dwordx4 v[124:127], v198, s[4:7], s30 offen offset:0 sc1
 v_pk_fma_f32 v[132:133], v[180:181], v[90:91], v[68:69] op_sel:[0,0,0] op_sel_hi:[1,0,1] neg_lo:[0,1,0] neg_hi:[0,1,0]
 v_pk_fma_f32 v[134:135], v[182:183], v[90:91], v[70:71] op_sel:[0,0,0] op_sel_hi:[1,0,1] neg_lo:[0,1,0] neg_hi:[0,1,0]
 v_pk_fma_f32 v[136:137], v[180:181], v[90:91], v[68:69] op_sel:[0,1,0] op_sel_hi:[1,1,1] neg_lo:[0,1,0] neg_hi:[0,1,0]
 v_pk_fma_f32 v[138:139], v[182:183], v[90:91], v[70:71] op_sel:[0,1,0] op_sel_hi:[1,1,1] neg_lo:[0,1,0] neg_hi:[0,1,0]
 v_pk_fma_f32 v[132:133], v[44:45], v[86:87], v[132:133] op_sel:[0,0,0] op_sel_hi:[1,0,1]
 v_pk_fma_f32 v[134:135], v[46:47], v[86:87], v[134:135] op_sel:[0,0,0] op_sel_hi:[1,0,1]
 v_pk_fma_f32 v[136:137], v[56:57], v[86:87], v[136:137] op_sel:[0,1,0] op_sel_hi:[1,1,1]
 v_pk_fma_f32 v[138:139], v[58:59], v[86:87], v[138:139] op_sel:[0,1,0] op_sel_hi:[1,1,1]
 v_pk_mul_f32 v[140:141], v[132:133], v[132:133]
 v_pk_mul_f32 v[142:143], v[134:135], v[134:135]
 v_pk_mul_f32 v[144:145], v[136:137], v[136:137]
 v_pk_mul_f32 v[146:147], v[138:139], v[138:139]
 v_pk_fma_f32 v[140:141], v[140:141], v[80:81], v[80:81] op_sel:[0,1,0] op_sel_hi:[1,1,0]
 v_pk_fma_f32 v[142:143], v[142:143], v[80:81], v[80:81] op_sel:[0,1,0] op_sel_hi:[1,1,0]
 v_pk_fma_f32 v[144:145], v[144:145], v[80:81], v[80:81] op_sel:[0,1,0] op_sel_hi:[1,1,0]
 v_pk_fma_f32 v[146:147], v[146:147], v[80:81], v[80:81] op_sel:[0,1,0] op_sel_hi:[1,1,0]
 v_pk_mul_f32 v[140:141], v[140:141], v[132:133]
 v_pk_mul_f32 v[142:143], v[142:143], v[134:135]
 v_pk_mul_f32 v[144:145], v[144:145], v[136:137]
 v_pk_mul_f32 v[146:147], v[146:147], v[138:139]
 v_exp_f32 v140, v140
 v_exp_f32 v141, v141
 v_exp_f32 v142, v142
 v_exp_f32 v143, v143
 v_exp_f32 v144, v144
 v_exp_f32 v145, v145
 v_exp_f32 v146, v146
 v_exp_f32 v147, v147
 v_pk_add_f32 v[140:141], v[140:141], v[82:83]
 v_pk_add_f32 v[142:143], v[142:143], v[82:83]
 v_pk_add_f32 v[144:145], v[144:145], v[82:83]
 v_pk_add_f32 v[146:147], v[146:147], v[82:83]
 v_rcp_f32 v140, v140
 v_rcp_f32 v141, v141
 v_rcp_f32 v142, v142
 v_rcp_f32 v143, v143
 v_rcp_f32 v144, v144
 v_rcp_f32 v145, v145
 v_rcp_f32 v146, v146
 v_rcp_f32 v147, v147
 v_pk_mul_f32 v[140:141], v[140:141], v[132:133]
 v_pk_mul_f32 v[142:143], v[142:143], v[134:135]
 v_pk_mul_f32 v[144:145], v[144:145], v[136:137]
 v_pk_mul_f32 v[146:147], v[146:147], v[138:139]
 v_cvt_pk_bf16_f32 v148, v140, v141
 v_cvt_pk_bf16_f32 v149, v142, v143
 v_cvt_pk_bf16_f32 v150, v144, v145
 v_cvt_pk_bf16_f32 v151, v146, v147
 s_nop 0
 v_permlane16_swap_b32 v148, v150
 v_permlane16_swap_b32 v149, v151
 buffer_store_dwordx4 v[148:151], v198, s[4:7], s29 offen offset:0 sc1
 v_pk_fma_f32 v[108:109], v[184:185], v[88:89], v[72:73] op_sel:[0,0,0] op_sel_hi:[1,0,1] neg_lo:[0,1,0] neg_hi:[0,1,0]
 v_pk_fma_f32 v[110:111], v[186:187], v[88:89], v[74:75] op_sel:[0,0,0] op_sel_hi:[1,0,1] neg_lo:[0,1,0] neg_hi:[0,1,0]
 v_pk_fma_f32 v[112:113], v[184:185], v[88:89], v[72:73] op_sel:[0,1,0] op_sel_hi:[1,1,1] neg_lo:[0,1,0] neg_hi:[0,1,0]
 v_pk_fma_f32 v[114:115], v[186:187], v[88:89], v[74:75] op_sel:[0,1,0] op_sel_hi:[1,1,1] neg_lo:[0,1,0] neg_hi:[0,1,0]
 v_pk_fma_f32 v[108:109], v[24:25], v[84:85], v[108:109] op_sel:[0,0,0] op_sel_hi:[1,0,1]
 v_pk_fma_f32 v[110:111], v[26:27], v[84:85], v[110:111] op_sel:[0,0,0] op_sel_hi:[1,0,1]
 v_pk_fma_f32 v[112:113], v[36:37], v[84:85], v[112:113] op_sel:[0,1,0] op_sel_hi:[1,1,1]
 v_pk_fma_f32 v[114:115], v[38:39], v[84:85], v[114:115] op_sel:[0,1,0] op_sel_hi:[1,1,1]
 v_pk_mul_f32 v[116:117], v[108:109], v[108:109]
 v_pk_mul_f32 v[118:119], v[110:111], v[110:111]
 v_pk_mul_f32 v[120:121], v[112:113], v[112:113]
 v_pk_mul_f32 v[122:123], v[114:115], v[114:115]
 v_pk_fma_f32 v[116:117], v[116:117], v[80:81], v[80:81] op_sel:[0,1,0] op_sel_hi:[1,1,0]
 v_pk_fma_f32 v[118:119], v[118:119], v[80:81], v[80:81] op_sel:[0,1,0] op_sel_hi:[1,1,0]
 v_pk_fma_f32 v[120:121], v[120:121], v[80:81], v[80:81] op_sel:[0,1,0] op_sel_hi:[1,1,0]
 v_pk_fma_f32 v[122:123], v[122:123], v[80:81], v[80:81] op_sel:[0,1,0] op_sel_hi:[1,1,0]
 v_pk_mul_f32 v[116:117], v[116:117], v[108:109]
 v_pk_mul_f32 v[118:119], v[118:119], v[110:111]
 v_pk_mul_f32 v[120:121], v[120:121], v[112:113]
 v_pk_mul_f32 v[122:123], v[122:123], v[114:115]
 v_exp_f32 v116, v116
 v_exp_f32 v117, v117
 v_exp_f32 v118, v118
 v_exp_f32 v119, v119
 v_exp_f32 v120, v120
 v_exp_f32 v121, v121
 v_exp_f32 v122, v122
 v_exp_f32 v123, v123
 v_pk_add_f32 v[116:117], v[116:117], v[82:83]
 v_pk_add_f32 v[118:119], v[118:119], v[82:83]
 v_pk_add_f32 v[120:121], v[120:121], v[82:83]
 v_pk_add_f32 v[122:123], v[122:123], v[82:83]
 v_rcp_f32 v116, v116
 v_rcp_f32 v117, v117
 v_rcp_f32 v118, v118
 v_rcp_f32 v119, v119
 v_rcp_f32 v120, v120
 v_rcp_f32 v121, v121
 v_rcp_f32 v122, v122
 v_rcp_f32 v123, v123
 v_pk_mul_f32 v[116:117], v[116:117], v[108:109]
 v_pk_mul_f32 v[118:119], v[118:119], v[110:111]
 v_pk_mul_f32 v[120:121], v[120:121], v[112:113]
 v_pk_mul_f32 v[122:123], v[122:123], v[114:115]
 v_cvt_pk_bf16_f32 v124, v116, v117
 v_cvt_pk_bf16_f32 v125, v118, v119
 v_cvt_pk_bf16_f32 v126, v120, v121
 v_cvt_pk_bf16_f32 v127, v122, v123
 s_nop 0
 v_permlane16_swap_b32 v124, v126
 v_permlane16_swap_b32 v125, v127
 buffer_store_dwordx4 v[124:127], v198, s[4:7], s30 offen offset:512 sc1
 v_pk_fma_f32 v[132:133], v[184:185], v[90:91], v[72:73] op_sel:[0,0,0] op_sel_hi:[1,0,1] neg_lo:[0,1,0] neg_hi:[0,1,0]
 v_pk_fma_f32 v[134:135], v[186:187], v[90:91], v[74:75] op_sel:[0,0,0] op_sel_hi:[1,0,1] neg_lo:[0,1,0] neg_hi:[0,1,0]
 v_pk_fma_f32 v[136:137], v[184:185], v[90:91], v[72:73] op_sel:[0,1,0] op_sel_hi:[1,1,1] neg_lo:[0,1,0] neg_hi:[0,1,0]
 v_pk_fma_f32 v[138:139], v[186:187], v[90:91], v[74:75] op_sel:[0,1,0] op_sel_hi:[1,1,1] neg_lo:[0,1,0] neg_hi:[0,1,0]
 v_pk_fma_f32 v[132:133], v[48:49], v[86:87], v[132:133] op_sel:[0,0,0] op_sel_hi:[1,0,1]
 v_pk_fma_f32 v[134:135], v[50:51], v[86:87], v[134:135] op_sel:[0,0,0] op_sel_hi:[1,0,1]
 v_pk_fma_f32 v[136:137], v[60:61], v[86:87], v[136:137] op_sel:[0,1,0] op_sel_hi:[1,1,1]
 v_pk_fma_f32 v[138:139], v[62:63], v[86:87], v[138:139] op_sel:[0,1,0] op_sel_hi:[1,1,1]
 v_pk_mul_f32 v[140:141], v[132:133], v[132:133]
 v_pk_mul_f32 v[142:143], v[134:135], v[134:135]
 v_pk_mul_f32 v[144:145], v[136:137], v[136:137]
 v_pk_mul_f32 v[146:147], v[138:139], v[138:139]
 v_pk_fma_f32 v[140:141], v[140:141], v[80:81], v[80:81] op_sel:[0,1,0] op_sel_hi:[1,1,0]
 v_pk_fma_f32 v[142:143], v[142:143], v[80:81], v[80:81] op_sel:[0,1,0] op_sel_hi:[1,1,0]
 v_pk_fma_f32 v[144:145], v[144:145], v[80:81], v[80:81] op_sel:[0,1,0] op_sel_hi:[1,1,0]
 v_pk_fma_f32 v[146:147], v[146:147], v[80:81], v[80:81] op_sel:[0,1,0] op_sel_hi:[1,1,0]
 v_pk_mul_f32 v[140:141], v[140:141], v[132:133]
 v_pk_mul_f32 v[142:143], v[142:143], v[134:135]
 v_pk_mul_f32 v[144:145], v[144:145], v[136:137]
 v_pk_mul_f32 v[146:147], v[146:147], v[138:139]
 v_exp_f32 v140, v140
 v_exp_f32 v141, v141
 v_exp_f32 v142, v142
 v_exp_f32 v143, v143
 v_exp_f32 v144, v144
 v_exp_f32 v145, v145
 v_exp_f32 v146, v146
 v_exp_f32 v147, v147
 v_pk_add_f32 v[140:141], v[140:141], v[82:83]
 v_pk_add_f32 v[142:143], v[142:143], v[82:83]
 v_pk_add_f32 v[144:145], v[144:145], v[82:83]
 v_pk_add_f32 v[146:147], v[146:147], v[82:83]
 v_rcp_f32 v140, v140
 v_rcp_f32 v141, v141
 v_rcp_f32 v142, v142
 v_rcp_f32 v143, v143
 v_rcp_f32 v144, v144
 v_rcp_f32 v145, v145
 v_rcp_f32 v146, v146
 v_rcp_f32 v147, v147
 v_pk_mul_f32 v[140:141], v[140:141], v[132:133]
 v_pk_mul_f32 v[142:143], v[142:143], v[134:135]
 v_pk_mul_f32 v[144:145], v[144:145], v[136:137]
 v_pk_mul_f32 v[146:147], v[146:147], v[138:139]
 v_cvt_pk_bf16_f32 v148, v140, v141
 v_cvt_pk_bf16_f32 v149, v142, v143
 v_cvt_pk_bf16_f32 v150, v144, v145
 v_cvt_pk_bf16_f32 v151, v146, v147
 s_nop 0
 v_permlane16_swap_b32 v148, v150
 v_permlane16_swap_b32 v149, v151
 buffer_store_dwordx4 v[148:151], v198, s[4:7], s29 offen offset:512 sc1
 v_pk_fma_f32 v[108:109], v[188:189], v[88:89], v[76:77] op_sel:[0,0,0] op_sel_hi:[1,0,1] neg_lo:[0,1,0] neg_hi:[0,1,0]
 v_pk_fma_f32 v[110:111], v[190:191], v[88:89], v[78:79] op_sel:[0,0,0] op_sel_hi:[1,0,1] neg_lo:[0,1,0] neg_hi:[0,1,0]
 v_pk_fma_f32 v[112:113], v[188:189], v[88:89], v[76:77] op_sel:[0,1,0] op_sel_hi:[1,1,1] neg_lo:[0,1,0] neg_hi:[0,1,0]
 v_pk_fma_f32 v[114:115], v[190:191], v[88:89], v[78:79] op_sel:[0,1,0] op_sel_hi:[1,1,1] neg_lo:[0,1,0] neg_hi:[0,1,0]
 v_pk_fma_f32 v[108:109], v[28:29], v[84:85], v[108:109] op_sel:[0,0,0] op_sel_hi:[1,0,1]
 v_pk_fma_f32 v[110:111], v[30:31], v[84:85], v[110:111] op_sel:[0,0,0] op_sel_hi:[1,0,1]
 v_pk_fma_f32 v[112:113], v[40:41], v[84:85], v[112:113] op_sel:[0,1,0] op_sel_hi:[1,1,1]
 v_pk_fma_f32 v[114:115], v[42:43], v[84:85], v[114:115] op_sel:[0,1,0] op_sel_hi:[1,1,1]
 v_pk_mul_f32 v[116:117], v[108:109], v[108:109]
 v_pk_mul_f32 v[118:119], v[110:111], v[110:111]
 v_pk_mul_f32 v[120:121], v[112:113], v[112:113]
 v_pk_mul_f32 v[122:123], v[114:115], v[114:115]
 v_pk_fma_f32 v[116:117], v[116:117], v[80:81], v[80:81] op_sel:[0,1,0] op_sel_hi:[1,1,0]
 v_pk_fma_f32 v[118:119], v[118:119], v[80:81], v[80:81] op_sel:[0,1,0] op_sel_hi:[1,1,0]
 v_pk_fma_f32 v[120:121], v[120:121], v[80:81], v[80:81] op_sel:[0,1,0] op_sel_hi:[1,1,0]
 v_pk_fma_f32 v[122:123], v[122:123], v[80:81], v[80:81] op_sel:[0,1,0] op_sel_hi:[1,1,0]
 v_pk_mul_f32 v[116:117], v[116:117], v[108:109]
 v_pk_mul_f32 v[118:119], v[118:119], v[110:111]
 v_pk_mul_f32 v[120:121], v[120:121], v[112:113]
 v_pk_mul_f32 v[122:123], v[122:123], v[114:115]
 v_exp_f32 v116, v116
 v_exp_f32 v117, v117
 v_exp_f32 v118, v118
 v_exp_f32 v119, v119
 v_exp_f32 v120, v120
 v_exp_f32 v121, v121
 v_exp_f32 v122, v122
 v_exp_f32 v123, v123
 v_pk_add_f32 v[116:117], v[116:117], v[82:83]
 v_pk_add_f32 v[118:119], v[118:119], v[82:83]
 v_pk_add_f32 v[120:121], v[120:121], v[82:83]
 v_pk_add_f32 v[122:123], v[122:123], v[82:83]
 v_rcp_f32 v116, v116
 v_rcp_f32 v117, v117
 v_rcp_f32 v118, v118
 v_rcp_f32 v119, v119
 v_rcp_f32 v120, v120
 v_rcp_f32 v121, v121
 v_rcp_f32 v122, v122
 v_rcp_f32 v123, v123
 v_pk_mul_f32 v[116:117], v[116:117], v[108:109]
 v_pk_mul_f32 v[118:119], v[118:119], v[110:111]
 v_pk_mul_f32 v[120:121], v[120:121], v[112:113]
 v_pk_mul_f32 v[122:123], v[122:123], v[114:115]
 v_cvt_pk_bf16_f32 v124, v116, v117
 v_cvt_pk_bf16_f32 v125, v118, v119
 v_cvt_pk_bf16_f32 v126, v120, v121
 v_cvt_pk_bf16_f32 v127, v122, v123
 s_nop 0
 v_permlane16_swap_b32 v124, v126
 v_permlane16_swap_b32 v125, v127
 buffer_store_dwordx4 v[124:127], v198, s[4:7], s30 offen offset:1024 sc1
 v_pk_fma_f32 v[132:133], v[188:189], v[90:91], v[76:77] op_sel:[0,0,0] op_sel_hi:[1,0,1] neg_lo:[0,1,0] neg_hi:[0,1,0]
 v_pk_fma_f32 v[134:135], v[190:191], v[90:91], v[78:79] op_sel:[0,0,0] op_sel_hi:[1,0,1] neg_lo:[0,1,0] neg_hi:[0,1,0]
 v_pk_fma_f32 v[136:137], v[188:189], v[90:91], v[76:77] op_sel:[0,1,0] op_sel_hi:[1,1,1] neg_lo:[0,1,0] neg_hi:[0,1,0]
 v_pk_fma_f32 v[138:139], v[190:191], v[90:91], v[78:79] op_sel:[0,1,0] op_sel_hi:[1,1,1] neg_lo:[0,1,0] neg_hi:[0,1,0]
 v_pk_fma_f32 v[132:133], v[52:53], v[86:87], v[132:133] op_sel:[0,0,0] op_sel_hi:[1,0,1]
 v_pk_fma_f32 v[134:135], v[54:55], v[86:87], v[134:135] op_sel:[0,0,0] op_sel_hi:[1,0,1]
 v_pk_fma_f32 v[136:137], v[64:65], v[86:87], v[136:137] op_sel:[0,1,0] op_sel_hi:[1,1,1]
 v_pk_fma_f32 v[138:139], v[66:67], v[86:87], v[138:139] op_sel:[0,1,0] op_sel_hi:[1,1,1]
 v_pk_mul_f32 v[140:141], v[132:133], v[132:133]
 v_pk_mul_f32 v[142:143], v[134:135], v[134:135]
 v_pk_mul_f32 v[144:145], v[136:137], v[136:137]
 v_pk_mul_f32 v[146:147], v[138:139], v[138:139]
 v_pk_fma_f32 v[140:141], v[140:141], v[80:81], v[80:81] op_sel:[0,1,0] op_sel_hi:[1,1,0]
 v_pk_fma_f32 v[142:143], v[142:143], v[80:81], v[80:81] op_sel:[0,1,0] op_sel_hi:[1,1,0]
 v_pk_fma_f32 v[144:145], v[144:145], v[80:81], v[80:81] op_sel:[0,1,0] op_sel_hi:[1,1,0]
 v_pk_fma_f32 v[146:147], v[146:147], v[80:81], v[80:81] op_sel:[0,1,0] op_sel_hi:[1,1,0]
 v_pk_mul_f32 v[140:141], v[140:141], v[132:133]
 v_pk_mul_f32 v[142:143], v[142:143], v[134:135]
 v_pk_mul_f32 v[144:145], v[144:145], v[136:137]
 v_pk_mul_f32 v[146:147], v[146:147], v[138:139]
 v_exp_f32 v140, v140
 v_exp_f32 v141, v141
 v_exp_f32 v142, v142
 v_exp_f32 v143, v143
 v_exp_f32 v144, v144
 v_exp_f32 v145, v145
 v_exp_f32 v146, v146
 v_exp_f32 v147, v147
 v_pk_add_f32 v[140:141], v[140:141], v[82:83]
 v_pk_add_f32 v[142:143], v[142:143], v[82:83]
 v_pk_add_f32 v[144:145], v[144:145], v[82:83]
 v_pk_add_f32 v[146:147], v[146:147], v[82:83]
 v_rcp_f32 v140, v140
 v_rcp_f32 v141, v141
 v_rcp_f32 v142, v142
 v_rcp_f32 v143, v143
 v_rcp_f32 v144, v144
 v_rcp_f32 v145, v145
 v_rcp_f32 v146, v146
 v_rcp_f32 v147, v147
 v_pk_mul_f32 v[140:141], v[140:141], v[132:133]
 v_pk_mul_f32 v[142:143], v[142:143], v[134:135]
 v_pk_mul_f32 v[144:145], v[144:145], v[136:137]
 v_pk_mul_f32 v[146:147], v[146:147], v[138:139]
 v_cvt_pk_bf16_f32 v148, v140, v141
 v_cvt_pk_bf16_f32 v149, v142, v143
 v_cvt_pk_bf16_f32 v150, v144, v145
 v_cvt_pk_bf16_f32 v151, v146, v147
 s_nop 0
 v_permlane16_swap_b32 v148, v150
 v_permlane16_swap_b32 v149, v151
 buffer_store_dwordx4 v[148:151], v198, s[4:7], s29 offen offset:1024 sc1
 s_lshl_b32 s23, s21, 7
 s_lshl_b32 s24, s22, 4
 s_add_u32 s23, s23, s24
 s_lshl_b32 s24, s20, 2
 s_add_u32 s23, s23, s24
 s_add_u32 s23, s23, 0x6e9000
 v_mov_b32 v8, 0
 v_mov_b32 v9, 1
 s_mov_b64 exec, 1
 s_waitcnt vmcnt(0)
 buffer_store_dword v9, v8, s[4:7], s23 offen sc1
 s_mov_b64 exec, -1
 s_branch C1_e1_join
C1_e2_slow:
 s_nop 7
 s_nop 7
 s_nop 3
 s_add_u32 s24, s30, 0xbf2000
 buffer_store_dwordx4 v[10:13], v5, s[4:7], s24 offen offset:0 sc1
 buffer_store_dwordx4 v[14:17], v5, s[4:7], s24 offen offset:1024 sc1
 buffer_store_dwordx2 v[18:19], v6, s[4:7], s24 offen offset:2048 sc1
 v_pk_add_f32 v[204:205], v[20:21], v[22:23]
 v_pk_mul_f32 v[206:207], v[20:21], v[20:21]
 v_pk_fma_f32 v[206:207], v[22:23], v[22:23], v[206:207]
 v_pk_add_f32 v[208:209], v[24:25], v[26:27]
 v_pk_mul_f32 v[210:211], v[24:25], v[24:25]
 v_pk_fma_f32 v[210:211], v[26:27], v[26:27], v[210:211]
 v_pk_add_f32 v[204:205], v[204:205], v[28:29]
 v_pk_fma_f32 v[206:207], v[28:29], v[28:29], v[206:207]
 v_pk_add_f32 v[208:209], v[208:209], v[30:31]
 v_pk_fma_f32 v[210:211], v[30:31], v[30:31], v[210:211]
 v_pk_add_f32 v[204:205], v[204:205], v[32:33]
 v_pk_fma_f32 v[206:207], v[32:33], v[32:33], v[206:207]
 v_pk_add_f32 v[208:209], v[208:209], v[34:35]
 v_pk_fma_f32 v[210:211], v[34:35], v[34:35], v[210:211]
 v_pk_add_f32 v[204:205], v[204:205], v[36:37]
 v_pk_fma_f32 v[206:207], v[36:37], v[36:37], v[206:207]
 v_pk_add_f32 v[208:209], v[208:209], v[38:39]
 v_pk_fma_f32 v[210:211], v[38:39], v[38:39], v[210:211]
 v_pk_add_f32 v[204:205], v[204:205], v[208:209]
 v_pk_add_f32 v[206:207], v[206:207], v[210:211]
 v_add_f32 v212, v204, v205
 v_add_f32 v213, v206, v207
 v_mov_b32 v214, v212
 v_mov_b32 v215, v213
 s_nop 0
 v_permlane16_swap_b32 v212, v214
 v_permlane16_swap_b32 v213, v215
 v_add_f32 v212, v212, v214
 v_add_f32 v213, v213, v215
 v_mov_b32 v214, v212
 v_mov_b32 v215, v213
 s_nop 0
 v_permlane32_swap_b32 v212, v214
 v_permlane32_swap_b32 v213, v215
 v_add_f32 v212, v212, v214
 v_add_f32 v213, v213, v215
 s_mov_b64 exec, 0xffff
 buffer_store_dwordx2 v[212:213], v70, s[4:7], s26 offen sc1
 s_mov_b64 exec, -1
 s_lshl_b32 s23, s21, 7
 s_lshl_b32 s24, s22, 4
 s_add_u32 s23, s23, s24
 s_lshl_b32 s24, s20, 2
 s_add_u32 s23, s23, s24
 s_add_u32 s23, s23, 0x6ea000
 v_mov_b32 v8, 0
 v_mov_b32 v9, 1
 s_mov_b64 exec, 1
 s_waitcnt vmcnt(0)
 buffer_store_dword v9, v8, s[4:7], s23 offen sc1
 s_mov_b64 exec, -1
 s_branch C1_e2_join
C1_bl0:
 s_waitcnt lgkmcnt(0)
 s_getreg_b32 s34, hwreg(HW_REG_XCC_ID, 0, 4)
 s_add_u32 s34, s34, 1
 s_and_b32 s35, s2, 7
 s_lshl_b32 s35, s35, 7
 s_add_u32 s35, s35, 0x6ed000
 s_lshr_b32 s36, s2, 3
 s_lshl_b32 s36, s36, 2
 s_add_u32 s36, s36, s35
 v_mov_b32 v8, 0
 v_mov_b32 v9, s34
 s_mov_b64 exec, 1
 buffer_store_dword v9, v8, s[4:7], s36 offen sc1
 s_mov_b64 exec, -1
 s_mul_i32 s23, s22, 901120
 v_lshlrev_b32 v2, 4, v1
 v_add_u32 v2, s23, v2
 s_mov_b32 m0, 0xc000
 s_mov_b32 s24, 0x0
 buffer_load_dwordx4 v2, s[4:7], s24 offen offset:0 lds
 buffer_load_dwordx4 v2, s[4:7], s24 offen offset:1024 lds
 buffer_load_dwordx4 v2, s[4:7], s24 offen offset:2048 lds
 buffer_load_dwordx4 v2, s[4:7], s24 offen offset:3072 lds
 s_mov_b32 m0, 0xd000
 s_mov_b32 s24, 0x1000
 buffer_load_dwordx4 v2, s[4:7], s24 offen offset:0 lds
 s_mov_b32 m0, 0xe800
 s_mov_b32 s24, 0x2800
 buffer_load_dwordx4 v2, s[4:7], s24 offen offset:0 lds
 buffer_load_dwordx4 v2, s[4:7], s24 offen offset:1024 lds
 buffer_load_dwordx4 v2, s[4:7], s24 offen offset:2048 lds
 buffer_load_dwordx4 v2, s[4:7], s24 offen offset:3072 lds
 s_mov_b32 m0, 0xf800
 s_mov_b32 s24, 0x3800
 buffer_load_dwordx4 v2, s[4:7], s24 offen offset:0 lds
 s_mov_b32 m0, 0x11000
 s_mov_b32 s24, 0x5000
 buffer_load_dwordx4 v2, s[4:7], s24 offen offset:0 lds
 buffer_load_dwordx4 v2, s[4:7], s24 offen offset:1024 lds
 buffer_load_dwordx4 v2, s[4:7], s24 offen offset:2048 lds
 buffer_load_dwordx4 v2, s[4:7], s24 offen offset:3072 lds
 s_mov_b32 m0, 0x12000
 s_mov_b32 s24, 0x6000
 buffer_load_dwordx4 v2, s[4:7], s24 offen offset:0 lds
 s_waitcnt vmcnt(0)
 v_and_b32 v8, 31, v1
 v_lshlrev_b32 v8, 2, v8
 s_mov_b32 s36, 20000
 s_mov_b32 s33, 0
C1_xq:
 buffer_load_dword v9, v8, s[4:7], s35 offen sc1
 s_sub_u32 s36, s36, 1
 s_waitcnt vmcnt(0)
 v_cmp_eq_u32 vcc, 0, v9
 s_cmp_eq_u32 s36, 0
 s_cbranch_scc1 C1_xqx
 s_nop 1
 s_cbranch_vccnz C1_xq
 v_cmp_ne_u32 vcc, s34, v9
 s_nop 4
 s_cbranch_vccnz C1_xqx
 s_mov_b32 s33, 1
C1_xqx:
 v_mov_b32 v8, 162816
 v_mov_b32 v9, s33
 ds_write_b32 v8, v9
 s_waitcnt lgkmcnt(0)
 s_sub_u32 s38, s20, 4
 s_lshl_b32 s59, s22, 2
 s_add_u32 s59, s59, s38
 s_lshl_b32 s58, s21, 2
 s_lshr_b32 s37, s59, 3
 s_add_u32 s58, s58, s37
 s_mul_i32 s58, s58, 61440
 s_and_b32 s37, s59, 7
 s_mul_i32 s37, s37, 2560
 s_add_u32 s58, s58, s37
 s_add_u32 s56, s4, s58
 s_addc_u32 s57, s5, 0
 s_add_u32 s56, s56, 0x117c000
 s_addc_u32 s57, s57, 0
 s_load_dword s40, s[56:57], 0
 s_load_dword s41, s[56:57], 32
 s_load_dword s42, s[56:57], 64
 s_load_dword s43, s[56:57], 96
 s_load_dword s44, s[56:57], 128
 s_load_dword s45, s[56:57], 160
 s_load_dword s46, s[56:57], 192
 s_load_dword s47, s[56:57], 224
 s_load_dword s48, s[56:57], 256
 s_load_dword s49, s[56:57], 288
 s_load_dword s50, s[56:57], 320
 s_load_dword s51, s[56:57], 352
 s_load_dword s52, s[56:57], 384
 s_load_dword s53, s[56:57], 416
 s_waitcnt lgkmcnt(0)
 s_load_dword s40, s[56:57], 448
 s_load_dword s41, s[56:57], 480
 s_load_dword s42, s[56:57], 512
 s_load_dword s43, s[56:57], 544
 s_load_dword s44, s[56:57], 576
 s_load_dword s45, s[56:57], 608
 s_load_dword s46, s[56:57], 640
 s_load_dword s47, s[56:57], 672
 s_load_dword s48, s[56:57], 704
 s_load_dword s49, s[56:57], 736
 s_load_dword s50, s[56:57], 768
 s_load_dword s51, s[56:57], 800
 s_load_dword s52, s[56:57], 832
 s_load_dword s53, s[56:57], 864
 s_waitcnt lgkmcnt(0)
 s_load_dword s40, s[56:57], 896
 s_load_dword s41, s[56:57], 928
 s_load_dword s42, s[56:57], 960
 s_load_dword s43, s[56:57], 992
 s_load_dword s44, s[56:57], 1024
 s_load_dword s45, s[56:57], 1056
 s_load_dword s46, s[56:57], 1088
 s_load_dword s47, s[56:57], 1120
 s_load_dword s48, s[56:57], 1152
 s_load_dword s49, s[56:57], 1184
 s_load_dword s50, s[56:57], 1216
 s_load_dword s51, s[56:57], 1248
 s_load_dword s52, s[56:57], 1280
 s_load_dword s53, s[56:57], 1312
 s_waitcnt lgkmcnt(0)
 s_load_dword s40, s[56:57], 1344
 s_load_dword s41, s[56:57], 1376
 s_load_dword s42, s[56:57], 1408
 s_load_dword s43, s[56:57], 1440
 s_load_dword s44, s[56:57], 1472
 s_load_dword s45, s[56:57], 1504
 s_load_dword s46, s[56:57], 1536
 s_load_dword s47, s[56:57], 1568
 s_load_dword s48, s[56:57], 1600
 s_load_dword s49, s[56:57], 1632
 s_load_dword s50, s[56:57], 1664
 s_load_dword s51, s[56:57], 1696
 s_load_dword s52, s[56:57], 1728
 s_load_dword s53, s[56:57], 1760
 s_waitcnt lgkmcnt(0)
 s_load_dword s40, s[56:57], 1792
 s_load_dword s41, s[56:57], 1824
 s_load_dword s42, s[56:57], 1856
 s_load_dword s43, s[56:57], 1888
 s_load_dword s44, s[56:57], 1920
 s_load_dword s45, s[56:57], 1952
 s_load_dword s46, s[56:57], 1984
 s_load_dword s47, s[56:57], 2016
 s_load_dword s48, s[56:57], 2048
 s_load_dword s49, s[56:57], 2080
 s_load_dword s50, s[56:57], 2112
 s_load_dword s51, s[56:57], 2144
 s_load_dword s52, s[56:57], 2176
 s_load_dword s53, s[56:57], 2208
 s_waitcnt lgkmcnt(0)
 s_load_dword s40, s[56:57], 2240
 s_load_dword s41, s[56:57], 2272
 s_load_dword s42, s[56:57], 2304
 s_load_dword s43, s[56:57], 2336
 s_load_dword s44, s[56:57], 2368
 s_load_dword s45, s[56:57], 2400
 s_load_dword s46, s[56:57], 2432
 s_load_dword s47, s[56:57], 2464
 s_load_dword s48, s[56:57], 2496
 s_load_dword s49, s[56:57], 2528
 s_lshl_b32 s58, s2, 2
 s_add_u32 s58, s58, s38
 s_mul_i32 s58, s58, 7040
 s_add_u32 s56, s4, s58
 s_addc_u32 s57, s5, 0
 s_load_dword s50, s[56:57], 0
 s_load_dword s51, s[56:57], 32
 s_load_dword s52, s[56:57], 64
 s_load_dword s53, s[56:57], 96
 s_waitcnt lgkmcnt(0)
 s_load_dword s40, s[56:57], 128
 s_load_dword s41, s[56:57], 160
 s_load_dword s42, s[56:57], 192
 s_load_dword s43, s[56:57], 224
 s_load_dword s44, s[56:57], 256
 s_load_dword s45, s[56:57], 288
 s_load_dword s46, s[56:57], 320
 s_load_dword s47, s[56:57], 352
 s_load_dword s48, s[56:57], 384
 s_load_dword s49, s[56:57], 416
 s_load_dword s50, s[56:57], 448
 s_load_dword s51, s[56:57], 480
 s_load_dword s52, s[56:57], 512
 s_load_dword s53, s[56:57], 544
 s_waitcnt lgkmcnt(0)
 s_load_dword s40, s[56:57], 576
 s_load_dword s41, s[56:57], 608
 s_load_dword s42, s[56:57], 640
 s_load_dword s43, s[56:57], 672
 s_load_dword s44, s[56:57], 704
 s_load_dword s45, s[56:57], 736
 s_load_dword s46, s[56:57], 768
 s_load_dword s47, s[56:57], 800
 s_load_dword s48, s[56:57], 832
 s_load_dword s49, s[56:57], 864
 s_load_dword s50, s[56:57], 896
 s_load_dword s51, s[56:57], 928
 s_load_dword s52, s[56:57], 960
 s_load_dword s53, s[56:57], 992
 s_waitcnt lgkmcnt(0)
 s_load_dword s40, s[56:57], 1024
 s_load_dword s41, s[56:57], 1056
 s_load_dword s42, s[56:57], 1088
 s_load_dword s43, s[56:57], 1120
 s_load_dword s44, s[56:57], 1152
 s_load_dword s45, s[56:57], 1184
 s_load_dword s46, s[56:57], 1216
 s_load_dword s47, s[56:57], 1248
 s_load_dword s48, s[56:57], 1280
 s_load_dword s49, s[56:57], 1312
 s_load_dword s50, s[56:57], 1344
 s_load_dword s51, s[56:57], 1376
 s_load_dword s52, s[56:57], 1408
 s_load_dword s53, s[56:57], 1440
 s_waitcnt lgkmcnt(0)
 s_load_dword s40, s[56:57], 1472
 s_load_dword s41, s[56:57], 1504
 s_load_dword s42, s[56:57], 1536
 s_load_dword s43, s[56:57], 1568
 s_load_dword s44, s[56:57], 1600
 s_load_dword s45, s[56:57], 1632
 s_load_dword s46, s[56:57], 1664
 s_load_dword s47, s[56:57], 1696
 s_load_dword s48, s[56:57], 1728
 s_load_dword s49, s[56:57], 1760
 s_load_dword s50, s[56:57], 1792
 s_load_dword s51, s[56:57], 1824
 s_load_dword s52, s[56:57], 1856
 s_load_dword s53, s[56:57], 1888
 s_waitcnt lgkmcnt(0)
 s_load_dword s40, s[56:57], 1920
 s_load_dword s41, s[56:57], 1952
 s_load_dword s42, s[56:57], 1984
 s_load_dword s43, s[56:57], 2016
 s_load_dword s44, s[56:57], 2048
 s_load_dword s45, s[56:57], 2080
 s_load_dword s46, s[56:57], 2112
 s_load_dword s47, s[56:57], 2144
 s_load_dword s48, s[56:57], 2176
 s_load_dword s49, s[56:57], 2208
 s_load_dword s50, s[56:57], 2240
 s_load_dword s51, s[56:57], 2272
 s_load_dword s52, s[56:57], 2304
 s_load_dword s53, s[56:57], 2336
 s_waitcnt lgkmcnt(0)
 s_load_dword s40, s[56:57], 2368
 s_load_dword s41, s[56:57], 2400
 s_load_dword s42, s[56:57], 2432
 s_load_dword s43, s[56:57], 2464
 s_load_dword s44, s[56:57], 2496
 s_load_dword s45, s[56:57], 2528
 s_load_dword s46, s[56:57], 2560
 s_load_dword s47, s[56:57], 2592
 s_load_dword s48, s[56:57], 2624
 s_load_dword s49, s[56:57], 2656
 s_load_dword s50, s[56:57], 2688
 s_load_dword s51, s[56:57], 2720
 s_load_dword s52, s[56:57], 2752
 s_load_dword s53, s[56:57], 2784
 s_waitcnt lgkmcnt(0)
 s_load_dword s40, s[56:57], 2816
 s_load_dword s41, s[56:57], 2848
 s_load_dword s42, s[56:57], 2880
 s_load_dword s43, s[56:57], 2912
 s_load_dword s44, s[56:57], 2944
 s_load_dword s45, s[56:57], 2976
 s_load_dword s46, s[56:57], 3008
 s_load_dword s47, s[56:57], 3040
 s_load_dword s48, s[56:57], 3072
 s_load_dword s49, s[56:57], 3104
 s_load_dword s50, s[56:57], 3136
 s_load_dword s51, s[56:57], 3168
 s_load_dword s52, s[56:57], 3200
 s_load_dword s53, s[56:57], 3232
 s_waitcnt lgkmcnt(0)
 s_load_dword s40, s[56:57], 3264
 s_load_dword s41, s[56:57], 3296
 s_load_dword s42, s[56:57], 3328
 s_load_dword s43, s[56:57], 3360
 s_load_dword s44, s[56:57], 3392
 s_load_dword s45, s[56:57], 3424
 s_load_dword s46, s[56:57], 3456
 s_load_dword s47, s[56:57], 3488
 s_load_dword s48, s[56:57], 3520
 s_load_dword s49, s[56:57], 3552
 s_load_dword s50, s[56:57], 3584
 s_load_dword s51, s[56:57], 3616
 s_load_dword s52, s[56:57], 3648
 s_load_dword s53, s[56:57], 3680
 s_waitcnt lgkmcnt(0)
 s_load_dword s40, s[56:57], 3712
 s_load_dword s41, s[56:57], 3744
 s_load_dword s42, s[56:57], 3776
 s_load_dword s43, s[56:57], 3808
 s_load_dword s44, s[56:57], 3840
 s_load_dword s45, s[56:57], 3872
 s_load_dword s46, s[56:57], 3904
 s_load_dword s47, s[56:57], 3936
 s_load_dword s48, s[56:57], 3968
 s_load_dword s49, s[56:57], 4000
 s_load_dword s50, s[56:57], 4032
 s_load_dword s51, s[56:57], 4064
 s_load_dword s52, s[56:57], 4096
 s_load_dword s53, s[56:57], 4128
 s_waitcnt lgkmcnt(0)
 s_load_dword s40, s[56:57], 4160
 s_load_dword s41, s[56:57], 4192
 s_load_dword s42, s[56:57], 4224
 s_load_dword s43, s[56:57], 4256
 s_load_dword s44, s[56:57], 4288
 s_load_dword s45, s[56:57], 4320
 s_load_dword s46, s[56:57], 4352
 s_load_dword s47, s[56:57], 4384
 s_load_dword s48, s[56:57], 4416
 s_load_dword s49, s[56:57], 4448
 s_load_dword s50, s[56:57], 4480
 s_load_dword s51, s[56:57], 4512
 s_load_dword s52, s[56:57], 4544
 s_load_dword s53, s[56:57], 4576
 s_waitcnt lgkmcnt(0)
 s_load_dword s40, s[56:57], 4608
 s_load_dword s41, s[56:57], 4640
 s_load_dword s42, s[56:57], 4672
 s_load_dword s43, s[56:57], 4704
 s_load_dword s44, s[56:57], 4736
 s_load_dword s45, s[56:57], 4768
 s_load_dword s46, s[56:57], 4800
 s_load_dword s47, s[56:57], 4832
 s_load_dword s48, s[56:57], 4864
 s_load_dword s49, s[56:57], 4896
 s_load_dword s50, s[56:57], 4928
 s_load_dword s51, s[56:57], 4960
 s_load_dword s52, s[56:57], 4992
 s_load_dword s53, s[56:57], 5024
 s_waitcnt lgkmcnt(0)
 s_load_dword s40, s[56:57], 5056
 s_load_dword s41, s[56:57], 5088
 s_load_dword s42, s[56:57], 5120
 s_load_dword s43, s[56:57], 5152
 s_load_dword s44, s[56:57], 5184
 s_load_dword s45, s[56:57], 5216
 s_load_dword s46, s[56:57], 5248
 s_load_dword s47, s[56:57], 5280
 s_load_dword s48, s[56:57], 5312
 s_load_dword s49, s[56:57], 5344
 s_load_dword s50, s[56:57], 5376
 s_load_dword s51, s[56:57], 5408
 s_load_dword s52, s[56:57], 5440
 s_load_dword s53, s[56:57], 5472
 s_waitcnt lgkmcnt(0)
 s_load_dword s40, s[56:57], 5504
 s_load_dword s41, s[56:57], 5536
 s_load_dword s42, s[56:57], 5568
 s_load_dword s43, s[56:57], 5600
 s_load_dword s44, s[56:57], 5632
 s_load_dword s45, s[56:57], 5664
 s_load_dword s46, s[56:57], 5696
 s_load_dword s47, s[56:57], 5728
 s_load_dword s48, s[56:57], 5760
 s_load_dword s49, s[56:57], 5792
 s_load_dword s50, s[56:57], 5824
 s_load_dword s51, s[56:57], 5856
 s_load_dword s52, s[56:57], 5888
 s_load_dword s53, s[56:57], 5920
 s_waitcnt lgkmcnt(0)
 s_load_dword s40, s[56:57], 5952
 s_load_dword s41, s[56:57], 5984
 s_load_dword s42, s[56:57], 6016
 s_load_dword s43, s[56:57], 6048
 s_load_dword s44, s[56:57], 6080
 s_load_dword s45, s[56:57], 6112
 s_load_dword s46, s[56:57], 6144
 s_load_dword s47, s[56:57], 6176
 s_load_dword s48, s[56:57], 6208
 s_load_dword s49, s[56:57], 6240
 s_load_dword s50, s[56:57], 6272
 s_load_dword s51, s[56:57], 6304
 s_load_dword s52, s[56:57], 6336
 s_load_dword s53, s[56:57], 6368
 s_waitcnt lgkmcnt(0)
 s_load_dword s40, s[56:57], 6400
 s_load_dword s41, s[56:57], 6432
 s_load_dword s42, s[56:57], 6464
 s_load_dword s43, s[56:57], 6496
 s_load_dword s44, s[56:57], 6528
 s_load_dword s45, s[56:57], 6560
 s_load_dword s46, s[56:57], 6592
 s_load_dword s47, s[56:57], 6624
 s_load_dword s48, s[56:57], 6656
 s_load_dword s49, s[56:57], 6688
 s_load_dword s50, s[56:57], 6720
 s_load_dword s51, s[56:57], 6752
 s_load_dword s52, s[56:57], 6784
 s_load_dword s53, s[56:57], 6816
 s_waitcnt lgkmcnt(0)
 s_load_dword s40, s[56:57], 6848
 s_load_dword s41, s[56:57], 6880
 s_load_dword s42, s[56:57], 6912
 s_load_dword s43, s[56:57], 6944
 s_load_dword s44, s[56:57], 6976
 s_load_dword s45, s[56:57], 7008
 s_mul_i32 s58, s21, 81920
 s_mul_i32 s37, s59, 2560
 s_add_u32 s58, s58, s37
 s_add_u32 s56, s4, s58
 s_addc_u32 s57, s5, 0
 s_add_u32 s56, s56, 0xbf2000
 s_addc_u32 s57, s57, 0
 s_load_dword s46, s[56:57], 0
 s_load_dword s47, s[56:57], 32
 s_load_dword s48, s[56:57], 64
 s_load_dword s49, s[56:57], 96
 s_load_dword s50, s[56:57], 128
 s_load_dword s51, s[56:57], 160
 s_load_dword s52, s[56:57], 192
 s_load_dword s53, s[56:57], 224
 s_waitcnt lgkmcnt(0)
 s_load_dword s40, s[56:57], 256
 s_load_dword s41, s[56:57], 288
 s_load_dword s42, s[56:57], 320
 s_load_dword s43, s[56:57], 352
 s_load_dword s44, s[56:57], 384
 s_load_dword s45, s[56:57], 416
 s_load_dword s46, s[56:57], 448
 s_load_dword s47, s[56:57], 480
 s_load_dword s48, s[56:57], 512
 s_load_dword s49, s[56:57], 544
 s_load_dword s50, s[56:57], 576
 s_load_dword s51, s[56:57], 608
 s_load_dword s52, s[56:57], 640
 s_load_dword s53, s[56:57], 672
 s_waitcnt lgkmcnt(0)
 s_load_dword s40, s[56:57], 704
 s_load_dword s41, s[56:57], 736
 s_load_dword s42, s[56:57], 768
 s_load_dword s43, s[56:57], 800
 s_load_dword s44, s[56:57], 832
 s_load_dword s45, s[56:57], 864
 s_load_dword s46, s[56:57], 896
 s_load_dword s47, s[56:57], 928
 s_load_dword s48, s[56:57], 960
 s_load_dword s49, s[56:57], 992
 s_load_dword s50, s[56:57], 1024
 s_load_dword s51, s[56:57], 1056
 s_load_dword s52, s[56:57], 1088
 s_load_dword s53, s[56:57], 1120
 s_waitcnt lgkmcnt(0)
 s_load_dword s40, s[56:57], 1152
 s_load_dword s41, s[56:57], 1184
 s_load_dword s42, s[56:57], 1216
 s_load_dword s43, s[56:57], 1248
 s_load_dword s44, s[56:57], 1280
 s_load_dword s45, s[56:57], 1312
 s_load_dword s46, s[56:57], 1344
 s_load_dword s47, s[56:57], 1376
 s_load_dword s48, s[56:57], 1408
 s_load_dword s49, s[56:57], 1440
 s_load_dword s50, s[56:57], 1472
 s_load_dword s51, s[56:57], 1504
 s_load_dword s52, s[56:57], 1536
 s_load_dword s53, s[56:57], 1568
 s_waitcnt lgkmcnt(0)
 s_load_dword s40, s[56:57], 1600
 s_load_dword s41, s[56:57], 1632
 s_load_dword s42, s[56:57], 1664
 s_load_dword s43, s[56:57], 1696
 s_load_dword s44, s[56:57], 1728
 s_load_dword s45, s[56:57], 1760
 s_load_dword s46, s[56:57], 1792
 s_load_dword s47, s[56:57], 1824
 s_load_dword s48, s[56:57], 1856
 s_load_dword s49, s[56:57], 1888
 s_load_dword s50, s[56:57], 1920
 s_load_dword s51, s[56:57], 1952
 s_load_dword s52, s[56:57], 1984
 s_load_dword s53, s[56:57], 2016
 s_waitcnt lgkmcnt(0)
 s_load_dword s40, s[56:57], 2048
 s_load_dword s41, s[56:57], 2080
 s_load_dword s42, s[56:57], 2112
 s_load_dword s43, s[56:57], 2144
 s_load_dword s44, s[56:57], 2176
 s_load_dword s45, s[56:57], 2208
 s_load_dword s46, s[56:57], 2240
 s_load_dword s47, s[56:57], 2272
 s_load_dword s48, s[56:57], 2304
 s_load_dword s49, s[56:57], 2336
 s_load_dword s50, s[56:57], 2368
 s_load_dword s51, s[56:57], 2400
 s_load_dword s52, s[56:57], 2432
 s_load_dword s53, s[56:57], 2464
 s_waitcnt lgkmcnt(0)
 s_load_dword s40, s[56:57], 2496
 s_load_dword s41, s[56:57], 2528
 s_lshl_b32 s58, s21, 12
 s_lshl_b32 s37, s59, 7
 s_add_u32 s58, s58, s37
 s_add_u32 s56, s4, s58
 s_addc_u32 s57, s5, 0
 s_add_u32 s56, s56, 0x1112000
 s_addc_u32 s57, s57, 0
 s_load_dword s42, s[56:57], 0
 s_load_dword s43, s[56:57], 32
 s_load_dword s44, s[56:57], 64
 s_load_dword s45, s[56:57], 96
 s_add_u32 s56, s4, s58
 s_addc_u32 s57, s5, 0
 s_add_u32 s56, s56, 0x1132000
 s_addc_u32 s57, s57, 0
 s_load_dword s46, s[56:57], 0
 s_load_dword s47, s[56:57], 32
 s_load_dword s48, s[56:57], 64
 s_load_dword s49, s[56:57], 96
 s_lshl_b32 s58, s2, 2
 s_add_u32 s58, s58, s38
 s_getpc_b64 s[56:57]
C1_pc1:
 s_add_u32 s56, s56, C2_start-C1_pc1
 s_addc_u32 s57, s57, 0
 s_mul_i32 s58, s58, 32
 s_add_u32 s37, s58, 0
 s_min_u32 s37, s37, C2_end-C2_start
 s_load_dword s50, s[56:57], s37
 s_add_u32 s37, s58, 32768
 s_min_u32 s37, s37, C2_end-C2_start
 s_load_dword s51, s[56:57], s37
 s_lshr_b32 s58, s2, 3
 s_lshl_b32 s58, s58, 2
 s_add_u32 s58, s58, s38
 s_getpc_b64 s[56:57]
C1_pc2:
 s_sub_u32 s56, s56, C1_pc2-C1_start
 s_subb_u32 s57, s57, 0
 s_mul_i32 s58, s58, 32
 s_add_u32 s37, s58, 0
 s_min_u32 s37, s37, C1_end-C1_start
 s_load_dword s52, s[56:57], s37
 s_add_u32 s37, s58, 4096
 s_min_u32 s37, s37, C1_end-C1_start
 s_load_dword s53, s[56:57], s37
 s_waitcnt lgkmcnt(0)
 s_add_u32 s37, s58, 8192
 s_min_u32 s37, s37, C1_end-C1_start
 s_load_dword s40, s[56:57], s37
 s_add_u32 s37, s58, 12288
 s_min_u32 s37, s37, C1_end-C1_start
 s_load_dword s41, s[56:57], s37
 s_add_u32 s37, s58, 16384
 s_min_u32 s37, s37, C1_end-C1_start
 s_load_dword s42, s[56:57], s37
 s_add_u32 s37, s58, 20480
 s_min_u32 s37, s37, C1_end-C1_start
 s_load_dword s43, s[56:57], s37
 s_add_u32 s37, s58, 24576
 s_min_u32 s37, s37, C1_end-C1_start
 s_load_dword s44, s[56:57], s37
 s_add_u32 s37, s58, 28672
 s_min_u32 s37, s37, C1_end-C1_start
 s_load_dword s45, s[56:57], s37
 s_add_u32 s37, s58, 32768
 s_min_u32 s37, s37, C1_end-C1_start
 s_load_dword s46, s[56:57], s37
 s_add_u32 s37, s58, 36864
 s_min_u32 s37, s37, C1_end-C1_start
 s_load_dword s47, s[56:57], s37
 s_add_u32 s37, s58, 40960
 s_min_u32 s37, s37, C1_end-C1_start
 s_load_dword s48, s[56:57], s37
 s_add_u32 s37, s58, 45056
 s_min_u32 s37, s37, C1_end-C1_start
 s_load_dword s49, s[56:57], s37
 s_add_u32 s37, s58, 49152
 s_min_u32 s37, s37, C1_end-C1_start
 s_load_dword s50, s[56:57], s37
 s_add_u32 s37, s58, 53248
 s_min_u32 s37, s37, C1_end-C1_start
 s_load_dword s51, s[56:57], s37
 s_add_u32 s37, s58, 57344
 s_min_u32 s37, s37, C1_end-C1_start
 s_load_dword s52, s[56:57], s37
 s_add_u32 s37, s58, 61440
 s_min_u32 s37, s37, C1_end-C1_start
 s_load_dword s53, s[56:57], s37
 s_waitcnt lgkmcnt(0)
 s_waitcnt lgkmcnt(0)
 s_mov_b32 m0, 0x13800
 s_mov_b32 s24, 0x7800
 buffer_load_dwordx4 v2, s[4:7], s24 offen offset:0 lds
 buffer_load_dwordx4 v2, s[4:7], s24 offen offset:1024 lds
 buffer_load_dwordx4 v2, s[4:7], s24 offen offset:2048 lds
 buffer_load_dwordx4 v2, s[4:7], s24 offen offset:3072 lds
 s_mov_b32 m0, 0x14800
 s_mov_b32 s24, 0x8800
 buffer_load_dwordx4 v2, s[4:7], s24 offen offset:0 lds
 s_mov_b32 m0, 0x16000
 s_mov_b32 s24, 0xa000
 buffer_load_dwordx4 v2, s[4:7], s24 offen offset:0 lds
 buffer_load_dwordx4 v2, s[4:7], s24 offen offset:1024 lds
 buffer_load_dwordx4 v2, s[4:7], s24 offen offset:2048 lds
 buffer_load_dwordx4 v2, s[4:7], s24 offen offset:3072 lds
 s_mov_b32 m0, 0x17000
 s_mov_b32 s24, 0xb000
 buffer_load_dwordx4 v2, s[4:7], s24 offen offset:0 lds
 s_mov_b32 m0, 0x18800
 s_mov_b32 s24, 0xc800
 buffer_load_dwordx4 v2, s[4:7], s24 offen offset:0 lds
 buffer_load_dwordx4 v2, s[4:7], s24 offen offset:1024 lds
 buffer_load_dwordx4 v2, s[4:7], s24 offen offset:2048 lds
 buffer_load_dwordx4 v2, s[4:7], s24 offen offset:3072 lds
 s_mov_b32 m0, 0x19800
 s_mov_b32 s24, 0xd800
 buffer_load_dwordx4 v2, s[4:7], s24 offen offset:0 lds
 s_mov_b32 m0, 0x1b000
 s_mov_b32 s24, 0xf000
 buffer_load_dwordx4 v2, s[4:7], s24 offen offset:0 lds
 buffer_load_dwordx4 v2, s[4:7], s24 offen offset:1024 lds
 buffer_load_dwordx4 v2, s[4:7], s24 offen offset:2048 lds
 buffer_load_dwordx4 v2, s[4:7], s24 offen offset:3072 lds
 s_mov_b32 m0, 0x1c000
 s_mov_b32 s24, 0x10000
 buffer_load_dwordx4 v2, s[4:7], s24 offen offset:0 lds
 s_mov_b32 m0, 0x1d800
 s_mov_b32 s24, 0x11800
 buffer_load_dwordx4 v2, s[4:7], s24 offen offset:0 lds
 buffer_load_dwordx4 v2, s[4:7], s24 offen offset:1024 lds
 buffer_load_dwordx4 v2, s[4:7], s24 offen offset:2048 lds
 buffer_load_dwordx4 v2, s[4:7], s24 offen offset:3072 lds
 s_mov_b32 m0, 0x1e800
 s_mov_b32 s24, 0x12800
 buffer_load_dwordx4 v2, s[4:7], s24 offen offset:0 lds
 s_mov_b32 m0, 0x20000
 s_mov_b32 s24, 0x14000
 buffer_load_dwordx4 v2, s[4:7], s24 offen offset:0 lds
 buffer_load_dwordx4 v2, s[4:7], s24 offen offset:1024 lds
 buffer_load_dwordx4 v2, s[4:7], s24 offen offset:2048 lds
 buffer_load_dwordx4 v2, s[4:7], s24 offen offset:3072 lds
 s_mov_b32 m0, 0x21000
 s_mov_b32 s24, 0x15000
 buffer_load_dwordx4 v2, s[4:7], s24 offen offset:0 lds
 s_mov_b32 m0, 0x22800
 s_mov_b32 s24, 0x16800
 buffer_load_dwordx4 v2, s[4:7], s24 offen offset:0 lds
 buffer_load_dwordx4 v2, s[4:7], s24 offen offset:1024 lds
 buffer_load_dwordx4 v2, s[4:7], s24 offen offset:2048 lds
 buffer_load_dwordx4 v2, s[4:7], s24 offen offset:3072 lds
 s_mov_b32 m0, 0x23800
 s_mov_b32 s24, 0x17800
 buffer_load_dwordx4 v2, s[4:7], s24 offen offset:0 lds
 s_barrier
 s_barrier
 s_barrier
 s_barrier
 s_waitcnt vmcnt(30)
 s_barrier
 s_waitcnt vmcnt(25)
 s_barrier
 s_waitcnt vmcnt(20)
 s_barrier
 s_waitcnt vmcnt(15)
 s_barrier
 s_mov_b32 m0, 0xc000
 s_mov_b32 s24, 0x19000
 buffer_load_dwordx4 v2, s[4:7], s24 offen offset:0 lds
 buffer_load_dwordx4 v2, s[4:7], s24 offen offset:1024 lds
 buffer_load_dwordx4 v2, s[4:7], s24 offen offset:2048 lds
 buffer_load_dwordx4 v2, s[4:7], s24 offen offset:3072 lds
 s_mov_b32 m0, 0xd000
 s_mov_b32 s24, 0x1a000
 buffer_load_dwordx4 v2, s[4:7], s24 offen offset:0 lds
 buffer_load_dwordx4 v2, s[4:7], s24 offen offset:1024 lds
 buffer_load_dwordx4 v2, s[4:7], s24 offen offset:2048 lds
 buffer_load_dwordx4 v2, s[4:7], s24 offen offset:3072 lds
 s_mov_b32 m0, 0xe000
 s_mov_b32 s24, 0x1b000
 buffer_load_dwordx4 v2, s[4:7], s24 offen offset:0 lds
 buffer_load_dwordx4 v2, s[4:7], s24 offen offset:1024 lds
 buffer_load_dwordx4 v2, s[4:7], s24 offen offset:2048 lds
 buffer_load_dwordx4 v2, s[4:7], s24 offen offset:3072 lds
 s_waitcnt vmcnt(22)
 s_barrier
 s_mov_b32 m0, 0x12000
 s_mov_b32 s24, 0x1f000
 buffer_load_dwordx4 v2, s[4:7], s24 offen offset:0 lds
 buffer_load_dwordx4 v2, s[4:7], s24 offen offset:1024 lds
 buffer_load_dwordx4 v2, s[4:7], s24 offen offset:2048 lds
 buffer_load_dwordx4 v2, s[4:7], s24 offen offset:3072 lds
 s_mov_b32 m0, 0x13000
 s_mov_b32 s24, 0x20000
 buffer_load_dwordx4 v2, s[4:7], s24 offen offset:0 lds
 buffer_load_dwordx4 v2, s[4:7], s24 offen offset:1024 lds
 buffer_load_dwordx4 v2, s[4:7], s24 offen offset:2048 lds
 buffer_load_dwordx4 v2, s[4:7], s24 offen offset:3072 lds
 s_mov_b32 m0, 0x14000
 s_mov_b32 s24, 0x21000
 buffer_load_dwordx4 v2, s[4:7], s24 offen offset:0 lds
 buffer_load_dwordx4 v2, s[4:7], s24 offen offset:1024 lds
 buffer_load_dwordx4 v2, s[4:7], s24 offen offset:2048 lds
 buffer_load_dwordx4 v2, s[4:7], s24 offen offset:3072 lds
 s_waitcnt vmcnt(29)
 s_barrier
 s_mov_b32 m0, 0x18000
 s_mov_b32 s24, 0x25000
 buffer_load_dwordx4 v2, s[4:7], s24 offen offset:0 lds
 buffer_load_dwordx4 v2, s[4:7], s24 offen offset:1024 lds
 buffer_load_dwordx4 v2, s[4:7], s24 offen offset:2048 lds
 buffer_load_dwordx4 v2, s[4:7], s24 offen offset:3072 lds
 s_mov_b32 m0, 0x19000
 s_mov_b32 s24, 0x26000
 buffer_load_dwordx4 v2, s[4:7], s24 offen offset:0 lds
 buffer_load_dwordx4 v2, s[4:7], s24 offen offset:1024 lds
 buffer_load_dwordx4 v2, s[4:7], s24 offen offset:2048 lds
 buffer_load_dwordx4 v2, s[4:7], s24 offen offset:3072 lds
 s_mov_b32 m0, 0x1a000
 s_mov_b32 s24, 0x27000
 buffer_load_dwordx4 v2, s[4:7], s24 offen offset:0 lds
 buffer_load_dwordx4 v2, s[4:7], s24 offen offset:1024 lds
 buffer_load_dwordx4 v2, s[4:7], s24 offen offset:2048 lds
 buffer_load_dwordx4 v2, s[4:7], s24 offen offset:3072 lds
 s_waitcnt vmcnt(36)
 s_barrier
 s_barrier
 s_mov_b32 m0, 0x1e000
 s_mov_b32 s24, 0x2b000
 buffer_load_dwordx4 v2, s[4:7], s24 offen offset:0 lds
 buffer_load_dwordx4 v2, s[4:7], s24 offen offset:1024 lds
 buffer_load_dwordx4 v2, s[4:7], s24 offen offset:2048 lds
 buffer_load_dwordx4 v2, s[4:7], s24 offen offset:3072 lds
 s_mov_b32 m0, 0x1f000
 s_mov_b32 s24, 0x2c000
 buffer_load_dwordx4 v2, s[4:7], s24 offen offset:0 lds
 buffer_load_dwordx4 v2, s[4:7], s24 offen offset:1024 lds
 buffer_load_dwordx4 v2, s[4:7], s24 offen offset:2048 lds
 buffer_load_dwordx4 v2, s[4:7], s24 offen offset:3072 lds
 s_mov_b32 m0, 0x20000
 s_mov_b32 s24, 0x2d000
 buffer_load_dwordx4 v2, s[4:7], s24 offen offset:0 lds
 buffer_load_dwordx4 v2, s[4:7], s24 offen offset:1024 lds
 buffer_load_dwordx4 v2, s[4:7], s24 offen offset:2048 lds
 buffer_load_dwordx4 v2, s[4:7], s24 offen offset:3072 lds
 s_waitcnt vmcnt(36)
 s_barrier
 s_mov_b32 m0, 0x24000
 s_mov_b32 s24, 0x31000
 buffer_load_dwordx4 v2, s[4:7], s24 offen offset:0 lds
 buffer_load_dwordx4 v2, s[4:7], s24 offen offset:1024 lds
 buffer_load_dwordx4 v2, s[4:7], s24 offen offset:2048 lds
 buffer_load_dwordx4 v2, s[4:7], s24 offen offset:3072 lds
 s_mov_b32 m0, 0x25000
 s_mov_b32 s24, 0x32000
 buffer_load_dwordx4 v2, s[4:7], s24 offen offset:0 lds
 buffer_load_dwordx4 v2, s[4:7], s24 offen offset:1024 lds
 buffer_load_dwordx4 v2, s[4:7], s24 offen offset:2048 lds
 buffer_load_dwordx4 v2, s[4:7], s24 offen offset:3072 lds
 s_mov_b32 m0, 0x26000
 s_mov_b32 s24, 0x33000
 buffer_load_dwordx4 v2, s[4:7], s24 offen offset:0 lds
 buffer_load_dwordx4 v2, s[4:7], s24 offen offset:1024 lds
 buffer_load_dwordx4 v2, s[4:7], s24 offen offset:2048 lds
 buffer_load_dwordx4 v2, s[4:7], s24 offen offset:3072 lds
 s_waitcnt vmcnt(36)
 s_barrier
 s_mov_b32 m0, 0xf000
 s_mov_b32 s24, 0x37000
 buffer_load_dwordx4 v2, s[4:7], s24 offen offset:0 lds
 buffer_load_dwordx4 v2, s[4:7], s24 offen offset:1024 lds
 buffer_load_dwordx4 v2, s[4:7], s24 offen offset:2048 lds
 buffer_load_dwordx4 v2, s[4:7], s24 offen offset:3072 lds
 s_mov_b32 m0, 0x10000
 s_mov_b32 s24, 0x38000
 buffer_load_dwordx4 v2, s[4:7], s24 offen offset:0 lds
 buffer_load_dwordx4 v2, s[4:7], s24 offen offset:1024 lds
 buffer_load_dwordx4 v2, s[4:7], s24 offen offset:2048 lds
 buffer_load_dwordx4 v2, s[4:7], s24 offen offset:3072 lds
 s_mov_b32 m0, 0x11000
 s_mov_b32 s24, 0x39000
 buffer_load_dwordx4 v2, s[4:7], s24 offen offset:0 lds
 buffer_load_dwordx4 v2, s[4:7], s24 offen offset:1024 lds
 buffer_load_dwordx4 v2, s[4:7], s24 offen offset:2048 lds
 buffer_load_dwordx4 v2, s[4:7], s24 offen offset:3072 lds
 s_waitcnt vmcnt(36)
 s_barrier
 s_mov_b32 m0, 0x15000
 s_mov_b32 s24, 0x3d000
 buffer_load_dwordx4 v2, s[4:7], s24 offen offset:0 lds
 buffer_load_dwordx4 v2, s[4:7], s24 offen offset:1024 lds
 buffer_load_dwordx4 v2, s[4:7], s24 offen offset:2048 lds
 buffer_load_dwordx4 v2, s[4:7], s24 offen offset:3072 lds
 s_mov_b32 m0, 0x16000
 s_mov_b32 s24, 0x3e000
 buffer_load_dwordx4 v2, s[4:7], s24 offen offset:0 lds
 buffer_load_dwordx4 v2, s[4:7], s24 offen offset:1024 lds
 buffer_load_dwordx4 v2, s[4:7], s24 offen offset:2048 lds
 buffer_load_dwordx4 v2, s[4:7], s24 offen offset:3072 lds
 s_mov_b32 m0, 0x17000
 s_mov_b32 s24, 0x3f000
 buffer_load_dwordx4 v2, s[4:7], s24 offen offset:0 lds
 buffer_load_dwordx4 v2, s[4:7], s24 offen offset:1024 lds
 buffer_load_dwordx4 v2, s[4:7], s24 offen offset:2048 lds
 buffer_load_dwordx4 v2, s[4:7], s24 offen offset:3072 lds
 s_waitcnt vmcnt(36)
 s_barrier
 s_mov_b32 m0, 0x1b000
 s_mov_b32 s24, 0x43000
 buffer_load_dwordx4 v2, s[4:7], s24 offen offset:0 lds
 buffer_load_dwordx4 v2, s[4:7], s24 offen offset:1024 lds
 buffer_load_dwordx4 v2, s[4:7], s24 offen offset:2048 lds
 buffer_load_dwordx4 v2, s[4:7], s24 offen offset:3072 lds
 s_mov_b32 m0, 0x1c000
 s_mov_b32 s24, 0x44000
 buffer_load_dwordx4 v2, s[4:7], s24 offen offset:0 lds
 buffer_load_dwordx4 v2, s[4:7], s24 offen offset:1024 lds
 buffer_load_dwordx4 v2, s[4:7], s24 offen offset:2048 lds
 buffer_load_dwordx4 v2, s[4:7], s24 offen offset:3072 lds
 s_mov_b32 m0, 0x1d000
 s_mov_b32 s24, 0x45000
 buffer_load_dwordx4 v2, s[4:7], s24 offen offset:0 lds
 buffer_load_dwordx4 v2, s[4:7], s24 offen offset:1024 lds
 buffer_load_dwordx4 v2, s[4:7], s24 offen offset:2048 lds
 buffer_load_dwordx4 v2, s[4:7], s24 offen offset:3072 lds
 s_waitcnt vmcnt(36)
 s_barrier
 s_mov_b32 m0, 0x21000
 s_mov_b32 s24, 0x49000
 buffer_load_dwordx4 v2, s[4:7], s24 offen offset:0 lds
 buffer_load_dwordx4 v2, s[4:7], s24 offen offset:1024 lds
 buffer_load_dwordx4 v2, s[4:7], s24 offen offset:2048 lds
 buffer_load_dwordx4 v2, s[4:7], s24 offen offset:3072 lds
 s_mov_b32 m0, 0x22000
 s_mov_b32 s24, 0x4a000
 buffer_load_dwordx4 v2, s[4:7], s24 offen offset:0 lds
 buffer_load_dwordx4 v2, s[4:7], s24 offen offset:1024 lds
 buffer_load_dwordx4 v2, s[4:7], s24 offen offset:2048 lds
 buffer_load_dwordx4 v2, s[4:7], s24 offen offset:3072 lds
 s_mov_b32 m0, 0x23000
 s_mov_b32 s24, 0x4b000
 buffer_load_dwordx4 v2, s[4:7], s24 offen offset:0 lds
 buffer_load_dwordx4 v2, s[4:7], s24 offen offset:1024 lds
 buffer_load_dwordx4 v2, s[4:7], s24 offen offset:2048 lds
 buffer_load_dwordx4 v2, s[4:7], s24 offen offset:3072 lds
 s_waitcnt vmcnt(36)
 s_barrier
 s_mov_b32 m0, 0xc000
 s_mov_b32 s24, 0x4f000
 buffer_load_dwordx4 v2, s[4:7], s24 offen offset:0 lds
 buffer_load_dwordx4 v2, s[4:7], s24 offen offset:1024 lds
 buffer_load_dwordx4 v2, s[4:7], s24 offen offset:2048 lds
 buffer_load_dwordx4 v2, s[4:7], s24 offen offset:3072 lds
 s_mov_b32 m0, 0xd000
 s_mov_b32 s24, 0x50000
 buffer_load_dwordx4 v2, s[4:7], s24 offen offset:0 lds
 buffer_load_dwordx4 v2, s[4:7], s24 offen offset:1024 lds
 buffer_load_dwordx4 v2, s[4:7], s24 offen offset:2048 lds
 buffer_load_dwordx4 v2, s[4:7], s24 offen offset:3072 lds
 s_mov_b32 m0, 0xe000
 s_mov_b32 s24, 0x51000
 buffer_load_dwordx4 v2, s[4:7], s24 offen offset:0 lds
 buffer_load_dwordx4 v2, s[4:7], s24 offen offset:1024 lds
 buffer_load_dwordx4 v2, s[4:7], s24 offen offset:2048 lds
 buffer_load_dwordx4 v2, s[4:7], s24 offen offset:3072 lds
 s_waitcnt vmcnt(36)
 s_barrier
 s_mov_b32 m0, 0x12400
 s_mov_b32 s24, 0x55000
 buffer_load_dwordx4 v2, s[4:7], s24 offen offset:0 lds
 buffer_load_dwordx4 v2, s[4:7], s24 offen offset:1024 lds
 buffer_load_dwordx4 v2, s[4:7], s24 offen offset:2048 lds
 buffer_load_dwordx4 v2, s[4:7], s24 offen offset:3072 lds
 s_mov_b32 m0, 0x13400
 s_mov_b32 s24, 0x56000
 buffer_load_dwordx4 v2, s[4:7], s24 offen offset:0 lds
 s_waitcnt vmcnt(29)
 s_barrier
 s_mov_b32 m0, 0x14c00
 s_mov_b32 s24, 0x57800
 buffer_load_dwordx4 v2, s[4:7], s24 offen offset:0 lds
 buffer_load_dwordx4 v2, s[4:7], s24 offen offset:1024 lds
 buffer_load_dwordx4 v2, s[4:7], s24 offen offset:2048 lds
 buffer_load_dwordx4 v2, s[4:7], s24 offen offset:3072 lds
 s_mov_b32 m0, 0x15c00
 s_mov_b32 s24, 0x58800
 buffer_load_dwordx4 v2, s[4:7], s24 offen offset:0 lds
 s_waitcnt vmcnt(22)
 s_barrier
 s_mov_b32 m0, 0x17400
 s_mov_b32 s24, 0x5a000
 buffer_load_dwordx4 v2, s[4:7], s24 offen offset:0 lds
 buffer_load_dwordx4 v2, s[4:7], s24 offen offset:1024 lds
 buffer_load_dwordx4 v2, s[4:7], s24 offen offset:2048 lds
 buffer_load_dwordx4 v2, s[4:7], s24 offen offset:3072 lds
 s_mov_b32 m0, 0x18400
 s_mov_b32 s24, 0x5b000
 buffer_load_dwordx4 v2, s[4:7], s24 offen offset:0 lds
 s_waitcnt vmcnt(15)
 s_barrier
 s_mov_b32 m0, 0x19c00
 s_mov_b32 s24, 0x5c800
 buffer_load_dwordx4 v2, s[4:7], s24 offen offset:0 lds
 buffer_load_dwordx4 v2, s[4:7], s24 offen offset:1024 lds
 buffer_load_dwordx4 v2, s[4:7], s24 offen offset:2048 lds
 buffer_load_dwordx4 v2, s[4:7], s24 offen offset:3072 lds
 s_mov_b32 m0, 0x1ac00
 s_mov_b32 s24, 0x5d800
 buffer_load_dwordx4 v2, s[4:7], s24 offen offset:0 lds
 s_barrier
 s_mov_b32 m0, 0x1c400
 s_mov_b32 s24, 0x5f000
 buffer_load_dwordx4 v2, s[4:7], s24 offen offset:0 lds
 buffer_load_dwordx4 v2, s[4:7], s24 offen offset:1024 lds
 buffer_load_dwordx4 v2, s[4:7], s24 offen offset:2048 lds
 buffer_load_dwordx4 v2, s[4:7], s24 offen offset:3072 lds
 s_mov_b32 m0, 0x1d400
 s_mov_b32 s24, 0x60000
 buffer_load_dwordx4 v2, s[4:7], s24 offen offset:0 lds
 s_mov_b32 m0, 0x1ec00
 s_mov_b32 s24, 0x61800
 buffer_load_dwordx4 v2, s[4:7], s24 offen offset:0 lds
 buffer_load_dwordx4 v2, s[4:7], s24 offen offset:1024 lds
 buffer_load_dwordx4 v2, s[4:7], s24 offen offset:2048 lds
 buffer_load_dwordx4 v2, s[4:7], s24 offen offset:3072 lds
 s_mov_b32 m0, 0x1fc00
 s_mov_b32 s24, 0x62800
 buffer_load_dwordx4 v2, s[4:7], s24 offen offset:0 lds
 s_mov_b32 m0, 0x21400
 s_mov_b32 s24, 0x64000
 buffer_load_dwordx4 v2, s[4:7], s24 offen offset:0 lds
 buffer_load_dwordx4 v2, s[4:7], s24 offen offset:1024 lds
 buffer_load_dwordx4 v2, s[4:7], s24 offen offset:2048 lds
 buffer_load_dwordx4 v2, s[4:7], s24 offen offset:3072 lds
 s_mov_b32 m0, 0x22400
 s_mov_b32 s24, 0x65000
 buffer_load_dwordx4 v2, s[4:7], s24 offen offset:0 lds
 s_mov_b32 m0, 0x23c00
 s_mov_b32 s24, 0x66800
 buffer_load_dwordx4 v2, s[4:7], s24 offen offset:0 lds
 buffer_load_dwordx4 v2, s[4:7], s24 offen offset:1024 lds
 buffer_load_dwordx4 v2, s[4:7], s24 offen offset:2048 lds
 buffer_load_dwordx4 v2, s[4:7], s24 offen offset:3072 lds
 s_mov_b32 m0, 0x24c00
 s_mov_b32 s24, 0x67800
 buffer_load_dwordx4 v2, s[4:7], s24 offen offset:0 lds
 s_mov_b32 m0, 0x26400
 s_mov_b32 s24, 0x69000
 buffer_load_dwordx4 v2, s[4:7], s24 offen offset:0 lds
 buffer_load_dwordx4 v2, s[4:7], s24 offen offset:1024 lds
 buffer_load_dwordx4 v2, s[4:7], s24 offen offset:2048 lds
 buffer_load_dwordx4 v2, s[4:7], s24 offen offset:3072 lds
 s_mov_b32 m0, 0x27400
 s_mov_b32 s24, 0x6a000
 buffer_load_dwordx4 v2, s[4:7], s24 offen offset:0 lds
 s_mov_b32 m0, 0xd400
 s_mov_b32 s24, 0x6b800
 buffer_load_dwordx4 v2, s[4:7], s24 offen offset:0 lds
 buffer_load_dwordx4 v2, s[4:7], s24 offen offset:1024 lds
 buffer_load_dwordx4 v2, s[4:7], s24 offen offset:2048 lds
 buffer_load_dwordx4 v2, s[4:7], s24 offen offset:3072 lds
 s_mov_b32 m0, 0xe400
 s_mov_b32 s24, 0x6c800
 buffer_load_dwordx4 v2, s[4:7], s24 offen offset:0 lds
 s_mov_b32 m0, 0xfc00
 s_mov_b32 s24, 0x6e000
 buffer_load_dwordx4 v2, s[4:7], s24 offen offset:0 lds
 buffer_load_dwordx4 v2, s[4:7], s24 offen offset:1024 lds
 buffer_load_dwordx4 v2, s[4:7], s24 offen offset:2048 lds
 buffer_load_dwordx4 v2, s[4:7], s24 offen offset:3072 lds
 s_mov_b32 m0, 0x10c00
 s_mov_b32 s24, 0x6f000
 buffer_load_dwordx4 v2, s[4:7], s24 offen offset:0 lds
 s_waitcnt vmcnt(50)
 s_barrier
 s_waitcnt vmcnt(45)
 s_barrier
 s_waitcnt vmcnt(40)
 s_barrier
 s_waitcnt vmcnt(35)
 s_barrier
 s_waitcnt vmcnt(30)
 s_barrier
 s_waitcnt vmcnt(25)
 s_barrier
 s_waitcnt vmcnt(20)
 s_barrier
 s_mov_b32 m0, 0x12400
 s_mov_b32 s24, 0x70800
 buffer_load_dwordx4 v2, s[4:7], s24 offen offset:0 lds
 buffer_load_dwordx4 v2, s[4:7], s24 offen offset:1024 lds
 buffer_load_dwordx4 v2, s[4:7], s24 offen offset:2048 lds
 buffer_load_dwordx4 v2, s[4:7], s24 offen offset:3072 lds
 s_mov_b32 m0, 0x13400
 s_mov_b32 s24, 0x71800
 buffer_load_dwordx4 v2, s[4:7], s24 offen offset:0 lds
 s_waitcnt vmcnt(20)
 s_barrier
 s_mov_b32 m0, 0x14c00
 s_mov_b32 s24, 0x73000
 buffer_load_dwordx4 v2, s[4:7], s24 offen offset:0 lds
 buffer_load_dwordx4 v2, s[4:7], s24 offen offset:1024 lds
 buffer_load_dwordx4 v2, s[4:7], s24 offen offset:2048 lds
 buffer_load_dwordx4 v2, s[4:7], s24 offen offset:3072 lds
 s_mov_b32 m0, 0x15c00
 s_mov_b32 s24, 0x74000
 buffer_load_dwordx4 v2, s[4:7], s24 offen offset:0 lds
 s_waitcnt vmcnt(20)
 s_barrier
 s_mov_b32 m0, 0x17400
 s_mov_b32 s24, 0x75800
 buffer_load_dwordx4 v2, s[4:7], s24 offen offset:0 lds
 buffer_load_dwordx4 v2, s[4:7], s24 offen offset:1024 lds
 buffer_load_dwordx4 v2, s[4:7], s24 offen offset:2048 lds
 buffer_load_dwordx4 v2, s[4:7], s24 offen offset:3072 lds
 s_mov_b32 m0, 0x18400
 s_mov_b32 s24, 0x76800
 buffer_load_dwordx4 v2, s[4:7], s24 offen offset:0 lds
 s_waitcnt vmcnt(20)
 s_barrier
 s_mov_b32 m0, 0x19c00
 s_mov_b32 s24, 0x78000
 buffer_load_dwordx4 v2, s[4:7], s24 offen offset:0 lds
 buffer_load_dwordx4 v2, s[4:7], s24 offen offset:1024 lds
 buffer_load_dwordx4 v2, s[4:7], s24 offen offset:2048 lds
 buffer_load_dwordx4 v2, s[4:7], s24 offen offset:3072 lds
 s_mov_b32 m0, 0x1ac00
 s_mov_b32 s24, 0x79000
 buffer_load_dwordx4 v2, s[4:7], s24 offen offset:0 lds
 s_waitcnt vmcnt(20)
 s_barrier
 s_mov_b32 m0, 0x1c400
 s_mov_b32 s24, 0x7a800
 buffer_load_dwordx4 v2, s[4:7], s24 offen offset:0 lds
 buffer_load_dwordx4 v2, s[4:7], s24 offen offset:1024 lds
 buffer_load_dwordx4 v2, s[4:7], s24 offen offset:2048 lds
 buffer_load_dwordx4 v2, s[4:7], s24 offen offset:3072 lds
 s_mov_b32 m0, 0x1d400
 s_mov_b32 s24, 0x7b800
 buffer_load_dwordx4 v2, s[4:7], s24 offen offset:0 lds
 s_waitcnt vmcnt(20)
 s_barrier
 s_mov_b32 m0, 0x1ec00
 s_mov_b32 s24, 0x7d000
 buffer_load_dwordx4 v2, s[4:7], s24 offen offset:0 lds
 buffer_load_dwordx4 v2, s[4:7], s24 offen offset:1024 lds
 buffer_load_dwordx4 v2, s[4:7], s24 offen offset:2048 lds
 buffer_load_dwordx4 v2, s[4:7], s24 offen offset:3072 lds
 s_mov_b32 m0, 0x1fc00
 s_mov_b32 s24, 0x7e000
 buffer_load_dwordx4 v2, s[4:7], s24 offen offset:0 lds
 s_waitcnt vmcnt(20)
 s_barrier
 s_mov_b32 m0, 0x21400
 s_mov_b32 s24, 0x7f800
 buffer_load_dwordx4 v2, s[4:7], s24 offen offset:0 lds
 buffer_load_dwordx4 v2, s[4:7], s24 offen offset:1024 lds
 buffer_load_dwordx4 v2, s[4:7], s24 offen offset:2048 lds
 buffer_load_dwordx4 v2, s[4:7], s24 offen offset:3072 lds
 s_mov_b32 m0, 0x22400
 s_mov_b32 s24, 0x80800
 buffer_load_dwordx4 v2, s[4:7], s24 offen offset:0 lds
 s_waitcnt vmcnt(20)
 s_barrier
 s_mov_b32 m0, 0x23c00
 s_mov_b32 s24, 0x82000
 buffer_load_dwordx4 v2, s[4:7], s24 offen offset:0 lds
 buffer_load_dwordx4 v2, s[4:7], s24 offen offset:1024 lds
 buffer_load_dwordx4 v2, s[4:7], s24 offen offset:2048 lds
 buffer_load_dwordx4 v2, s[4:7], s24 offen offset:3072 lds
 s_mov_b32 m0, 0x24c00
 s_mov_b32 s24, 0x83000
 buffer_load_dwordx4 v2, s[4:7], s24 offen offset:0 lds
 s_waitcnt vmcnt(20)
 s_barrier
 s_mov_b32 m0, 0x26400
 s_mov_b32 s24, 0x84800
 buffer_load_dwordx4 v2, s[4:7], s24 offen offset:0 lds
 buffer_load_dwordx4 v2, s[4:7], s24 offen offset:1024 lds
 buffer_load_dwordx4 v2, s[4:7], s24 offen offset:2048 lds
 buffer_load_dwordx4 v2, s[4:7], s24 offen offset:3072 lds
 s_mov_b32 m0, 0x27400
 s_mov_b32 s24, 0x85800
 buffer_load_dwordx4 v2, s[4:7], s24 offen offset:0 lds
 s_waitcnt vmcnt(20)
 s_barrier
 s_mov_b32 m0, 0xd400
 s_mov_b32 s24, 0x87000
 buffer_load_dwordx4 v2, s[4:7], s24 offen offset:0 lds
 buffer_load_dwordx4 v2, s[4:7], s24 offen offset:1024 lds
 buffer_load_dwordx4 v2, s[4:7], s24 offen offset:2048 lds
 buffer_load_dwordx4 v2, s[4:7], s24 offen offset:3072 lds
 s_mov_b32 m0, 0xe400
 s_mov_b32 s24, 0x88000
 buffer_load_dwordx4 v2, s[4:7], s24 offen offset:0 lds
 s_waitcnt vmcnt(20)
 s_barrier
 s_mov_b32 m0, 0xfc00
 s_mov_b32 s24, 0x89800
 buffer_load_dwordx4 v2, s[4:7], s24 offen offset:0 lds
 buffer_load_dwordx4 v2, s[4:7], s24 offen offset:1024 lds
 buffer_load_dwordx4 v2, s[4:7], s24 offen offset:2048 lds
 buffer_load_dwordx4 v2, s[4:7], s24 offen offset:3072 lds
 s_mov_b32 m0, 0x10c00
 s_mov_b32 s24, 0x8a800
 buffer_load_dwordx4 v2, s[4:7], s24 offen offset:0 lds
 s_waitcnt vmcnt(20)
 s_barrier
 s_mov_b32 m0, 0x12400
 s_mov_b32 s24, 0x8c000
 buffer_load_dwordx4 v2, s[4:7], s24 offen offset:0 lds
 buffer_load_dwordx4 v2, s[4:7], s24 offen offset:1024 lds
 buffer_load_dwordx4 v2, s[4:7], s24 offen offset:2048 lds
 buffer_load_dwordx4 v2, s[4:7], s24 offen offset:3072 lds
 s_mov_b32 m0, 0x13400
 s_mov_b32 s24, 0x8d000
 buffer_load_dwordx4 v2, s[4:7], s24 offen offset:0 lds
 s_waitcnt vmcnt(20)
 s_barrier
 s_mov_b32 m0, 0x14c00
 s_mov_b32 s24, 0x8e800
 buffer_load_dwordx4 v2, s[4:7], s24 offen offset:0 lds
 buffer_load_dwordx4 v2, s[4:7], s24 offen offset:1024 lds
 buffer_load_dwordx4 v2, s[4:7], s24 offen offset:2048 lds
 buffer_load_dwordx4 v2, s[4:7], s24 offen offset:3072 lds
 s_mov_b32 m0, 0x15c00
 s_mov_b32 s24, 0x8f800
 buffer_load_dwordx4 v2, s[4:7], s24 offen offset:0 lds
 s_waitcnt vmcnt(20)
 s_barrier
 s_waitcnt vmcnt(15)
 s_barrier
 s_mov_b32 m0, 0x17400
 s_mov_b32 s24, 0x91000
 buffer_load_dwordx4 v2, s[4:7], s24 offen offset:0 lds
 buffer_load_dwordx4 v2, s[4:7], s24 offen offset:1024 lds
 buffer_load_dwordx4 v2, s[4:7], s24 offen offset:2048 lds
 buffer_load_dwordx4 v2, s[4:7], s24 offen offset:3072 lds
 s_mov_b32 m0, 0x18400
 s_mov_b32 s24, 0x92000
 buffer_load_dwordx4 v2, s[4:7], s24 offen offset:0 lds
 buffer_load_dwordx4 v2, s[4:7], s24 offen offset:1024 lds
 buffer_load_dwordx4 v2, s[4:7], s24 offen offset:2048 lds
 buffer_load_dwordx4 v2, s[4:7], s24 offen offset:3072 lds
 s_mov_b32 m0, 0x19400
 s_mov_b32 s24, 0x93000
 buffer_load_dwordx4 v2, s[4:7], s24 offen offset:0 lds
 buffer_load_dwordx4 v2, s[4:7], s24 offen offset:1024 lds
 buffer_load_dwordx4 v2, s[4:7], s24 offen offset:2048 lds
 buffer_load_dwordx4 v2, s[4:7], s24 offen offset:3072 lds
 s_mov_b32 m0, 0x1a400
 s_mov_b32 s24, 0x94000
 buffer_load_dwordx4 v2, s[4:7], s24 offen offset:0 lds
 buffer_load_dwordx4 v2, s[4:7], s24 offen offset:1024 lds
 buffer_load_dwordx4 v2, s[4:7], s24 offen offset:2048 lds
 s_waitcnt vmcnt(25)
 s_barrier
 s_mov_b32 m0, 0x1ec00
 s_mov_b32 s24, 0x98800
 buffer_load_dwordx4 v2, s[4:7], s24 offen offset:0 lds
 buffer_load_dwordx4 v2, s[4:7], s24 offen offset:1024 lds
 buffer_load_dwordx4 v2, s[4:7], s24 offen offset:2048 lds
 buffer_load_dwordx4 v2, s[4:7], s24 offen offset:3072 lds
 s_mov_b32 m0, 0x1fc00
 s_mov_b32 s24, 0x99800
 buffer_load_dwordx4 v2, s[4:7], s24 offen offset:0 lds
 buffer_load_dwordx4 v2, s[4:7], s24 offen offset:1024 lds
 buffer_load_dwordx4 v2, s[4:7], s24 offen offset:2048 lds
 buffer_load_dwordx4 v2, s[4:7], s24 offen offset:3072 lds
 s_mov_b32 m0, 0x20c00
 s_mov_b32 s24, 0x9a800
 buffer_load_dwordx4 v2, s[4:7], s24 offen offset:0 lds
 buffer_load_dwordx4 v2, s[4:7], s24 offen offset:1024 lds
 buffer_load_dwordx4 v2, s[4:7], s24 offen offset:2048 lds
 buffer_load_dwordx4 v2, s[4:7], s24 offen offset:3072 lds
 s_mov_b32 m0, 0x21c00
 s_mov_b32 s24, 0x9b800
 buffer_load_dwordx4 v2, s[4:7], s24 offen offset:0 lds
 buffer_load_dwordx4 v2, s[4:7], s24 offen offset:1024 lds
 buffer_load_dwordx4 v2, s[4:7], s24 offen offset:2048 lds
 s_waitcnt vmcnt(35)
 s_barrier
 s_mov_b32 m0, 0xc000
 s_mov_b32 s24, 0xa0000
 buffer_load_dwordx4 v2, s[4:7], s24 offen offset:0 lds
 buffer_load_dwordx4 v2, s[4:7], s24 offen offset:1024 lds
 buffer_load_dwordx4 v2, s[4:7], s24 offen offset:2048 lds
 buffer_load_dwordx4 v2, s[4:7], s24 offen offset:3072 lds
 s_mov_b32 m0, 0xd000
 s_mov_b32 s24, 0xa1000
 buffer_load_dwordx4 v2, s[4:7], s24 offen offset:0 lds
 buffer_load_dwordx4 v2, s[4:7], s24 offen offset:1024 lds
 buffer_load_dwordx4 v2, s[4:7], s24 offen offset:2048 lds
 buffer_load_dwordx4 v2, s[4:7], s24 offen offset:3072 lds
 s_mov_b32 m0, 0xe000
 s_mov_b32 s24, 0xa2000
 buffer_load_dwordx4 v2, s[4:7], s24 offen offset:0 lds
 buffer_load_dwordx4 v2, s[4:7], s24 offen offset:1024 lds
 buffer_load_dwordx4 v2, s[4:7], s24 offen offset:2048 lds
 buffer_load_dwordx4 v2, s[4:7], s24 offen offset:3072 lds
 s_mov_b32 m0, 0xf000
 s_mov_b32 s24, 0xa3000
 buffer_load_dwordx4 v2, s[4:7], s24 offen offset:0 lds
 buffer_load_dwordx4 v2, s[4:7], s24 offen offset:1024 lds
 buffer_load_dwordx4 v2, s[4:7], s24 offen offset:2048 lds
 s_waitcnt vmcnt(45)
 s_barrier
 s_barrier
 s_waitcnt vmcnt(30)
 s_barrier
 s_mov_b32 m0, 0x13800
 s_mov_b32 s24, 0xa7800
 buffer_load_dwordx4 v2, s[4:7], s24 offen offset:0 lds
 buffer_load_dwordx4 v2, s[4:7], s24 offen offset:1024 lds
 buffer_load_dwordx4 v2, s[4:7], s24 offen offset:2048 lds
 buffer_load_dwordx4 v2, s[4:7], s24 offen offset:3072 lds
 s_mov_b32 m0, 0x14800
 s_mov_b32 s24, 0xa8800
 buffer_load_dwordx4 v2, s[4:7], s24 offen offset:0 lds
 buffer_load_dwordx4 v2, s[4:7], s24 offen offset:1024 lds
 buffer_load_dwordx4 v2, s[4:7], s24 offen offset:2048 lds
 buffer_load_dwordx4 v2, s[4:7], s24 offen offset:3072 lds
 s_mov_b32 m0, 0x15800
 s_mov_b32 s24, 0xa9800
 buffer_load_dwordx4 v2, s[4:7], s24 offen offset:0 lds
 buffer_load_dwordx4 v2, s[4:7], s24 offen offset:1024 lds
 buffer_load_dwordx4 v2, s[4:7], s24 offen offset:2048 lds
 buffer_load_dwordx4 v2, s[4:7], s24 offen offset:3072 lds
 s_mov_b32 m0, 0x16800
 s_mov_b32 s24, 0xaa800
 buffer_load_dwordx4 v2, s[4:7], s24 offen offset:0 lds
 buffer_load_dwordx4 v2, s[4:7], s24 offen offset:1024 lds
 buffer_load_dwordx4 v2, s[4:7], s24 offen offset:2048 lds
 s_waitcnt vmcnt(30)
 s_barrier
 s_mov_b32 m0, 0x1b000
 s_mov_b32 s24, 0xaf000
 buffer_load_dwordx4 v2, s[4:7], s24 offen offset:0 lds
 buffer_load_dwordx4 v2, s[4:7], s24 offen offset:1024 lds
 buffer_load_dwordx4 v2, s[4:7], s24 offen offset:2048 lds
 buffer_load_dwordx4 v2, s[4:7], s24 offen offset:3072 lds
 s_mov_b32 m0, 0x1c000
 s_mov_b32 s24, 0xb0000
 buffer_load_dwordx4 v2, s[4:7], s24 offen offset:0 lds
 buffer_load_dwordx4 v2, s[4:7], s24 offen offset:1024 lds
 buffer_load_dwordx4 v2, s[4:7], s24 offen offset:2048 lds
 buffer_load_dwordx4 v2, s[4:7], s24 offen offset:3072 lds
 s_mov_b32 m0, 0x1d000
 s_mov_b32 s24, 0xb1000
 buffer_load_dwordx4 v2, s[4:7], s24 offen offset:0 lds
 buffer_load_dwordx4 v2, s[4:7], s24 offen offset:1024 lds
 buffer_load_dwordx4 v2, s[4:7], s24 offen offset:2048 lds
 buffer_load_dwordx4 v2, s[4:7], s24 offen offset:3072 lds
 s_mov_b32 m0, 0x1e000
 s_mov_b32 s24, 0xb2000
 buffer_load_dwordx4 v2, s[4:7], s24 offen offset:0 lds
 buffer_load_dwordx4 v2, s[4:7], s24 offen offset:1024 lds
 buffer_load_dwordx4 v2, s[4:7], s24 offen offset:2048 lds
 s_waitcnt vmcnt(30)
 s_barrier
 s_mov_b32 m0, 0x22800
 s_mov_b32 s24, 0xb6800
 buffer_load_dwordx4 v2, s[4:7], s24 offen offset:0 lds
 buffer_load_dwordx4 v2, s[4:7], s24 offen offset:1024 lds
 buffer_load_dwordx4 v2, s[4:7], s24 offen offset:2048 lds
 buffer_load_dwordx4 v2, s[4:7], s24 offen offset:3072 lds
 s_mov_b32 m0, 0x23800
 s_mov_b32 s24, 0xb7800
 buffer_load_dwordx4 v2, s[4:7], s24 offen offset:0 lds
 buffer_load_dwordx4 v2, s[4:7], s24 offen offset:1024 lds
 buffer_load_dwordx4 v2, s[4:7], s24 offen offset:2048 lds
 buffer_load_dwordx4 v2, s[4:7], s24 offen offset:3072 lds
 s_mov_b32 m0, 0x24800
 s_mov_b32 s24, 0xb8800
 buffer_load_dwordx4 v2, s[4:7], s24 offen offset:0 lds
 buffer_load_dwordx4 v2, s[4:7], s24 offen offset:1024 lds
 buffer_load_dwordx4 v2, s[4:7], s24 offen offset:2048 lds
 buffer_load_dwordx4 v2, s[4:7], s24 offen offset:3072 lds
 s_mov_b32 m0, 0x25800
 s_mov_b32 s24, 0xb9800
 buffer_load_dwordx4 v2, s[4:7], s24 offen offset:0 lds
 buffer_load_dwordx4 v2, s[4:7], s24 offen offset:1024 lds
 buffer_load_dwordx4 v2, s[4:7], s24 offen offset:2048 lds
 s_waitcnt vmcnt(30)
 s_barrier
 s_mov_b32 m0, 0xfc00
 s_mov_b32 s24, 0xbe000
 buffer_load_dwordx4 v2, s[4:7], s24 offen offset:0 lds
 buffer_load_dwordx4 v2, s[4:7], s24 offen offset:1024 lds
 buffer_load_dwordx4 v2, s[4:7], s24 offen offset:2048 lds
 buffer_load_dwordx4 v2, s[4:7], s24 offen offset:3072 lds
 s_mov_b32 m0, 0x10c00
 s_mov_b32 s24, 0xbf000
 buffer_load_dwordx4 v2, s[4:7], s24 offen offset:0 lds
 buffer_load_dwordx4 v2, s[4:7], s24 offen offset:1024 lds
 buffer_load_dwordx4 v2, s[4:7], s24 offen offset:2048 lds
 buffer_load_dwordx4 v2, s[4:7], s24 offen offset:3072 lds
 s_mov_b32 m0, 0x11c00
 s_mov_b32 s24, 0xc0000
 buffer_load_dwordx4 v2, s[4:7], s24 offen offset:0 lds
 buffer_load_dwordx4 v2, s[4:7], s24 offen offset:1024 lds
 buffer_load_dwordx4 v2, s[4:7], s24 offen offset:2048 lds
 buffer_load_dwordx4 v2, s[4:7], s24 offen offset:3072 lds
 s_mov_b32 m0, 0x12c00
 s_mov_b32 s24, 0xc1000
 buffer_load_dwordx4 v2, s[4:7], s24 offen offset:0 lds
 buffer_load_dwordx4 v2, s[4:7], s24 offen offset:1024 lds
 buffer_load_dwordx4 v2, s[4:7], s24 offen offset:2048 lds
 s_waitcnt vmcnt(30)
 s_barrier
 s_mov_b32 m0, 0x17400
 s_mov_b32 s24, 0xc5800
 buffer_load_dwordx4 v2, s[4:7], s24 offen offset:0 lds
 buffer_load_dwordx4 v2, s[4:7], s24 offen offset:1024 lds
 buffer_load_dwordx4 v2, s[4:7], s24 offen offset:2048 lds
 buffer_load_dwordx4 v2, s[4:7], s24 offen offset:3072 lds
 s_mov_b32 m0, 0x18400
 s_mov_b32 s24, 0xc6800
 buffer_load_dwordx4 v2, s[4:7], s24 offen offset:0 lds
 buffer_load_dwordx4 v2, s[4:7], s24 offen offset:1024 lds
 buffer_load_dwordx4 v2, s[4:7], s24 offen offset:2048 lds
 buffer_load_dwordx4 v2, s[4:7], s24 offen offset:3072 lds
 s_mov_b32 m0, 0x19400
 s_mov_b32 s24, 0xc7800
 buffer_load_dwordx4 v2, s[4:7], s24 offen offset:0 lds
 buffer_load_dwordx4 v2, s[4:7], s24 offen offset:1024 lds
 buffer_load_dwordx4 v2, s[4:7], s24 offen offset:2048 lds
 buffer_load_dwordx4 v2, s[4:7], s24 offen offset:3072 lds
 s_mov_b32 m0, 0x1a400
 s_mov_b32 s24, 0xc8800
 buffer_load_dwordx4 v2, s[4:7], s24 offen offset:0 lds
 buffer_load_dwordx4 v2, s[4:7], s24 offen offset:1024 lds
 buffer_load_dwordx4 v2, s[4:7], s24 offen offset:2048 lds
 s_waitcnt vmcnt(30)
 s_barrier
 s_mov_b32 m0, 0x1ec00
 s_mov_b32 s24, 0xcd000
 buffer_load_dwordx4 v2, s[4:7], s24 offen offset:0 lds
 buffer_load_dwordx4 v2, s[4:7], s24 offen offset:1024 lds
 buffer_load_dwordx4 v2, s[4:7], s24 offen offset:2048 lds
 buffer_load_dwordx4 v2, s[4:7], s24 offen offset:3072 lds
 s_mov_b32 m0, 0x1fc00
 s_mov_b32 s24, 0xce000
 buffer_load_dwordx4 v2, s[4:7], s24 offen offset:0 lds
 buffer_load_dwordx4 v2, s[4:7], s24 offen offset:1024 lds
 buffer_load_dwordx4 v2, s[4:7], s24 offen offset:2048 lds
 buffer_load_dwordx4 v2, s[4:7], s24 offen offset:3072 lds
 s_mov_b32 m0, 0x20c00
 s_mov_b32 s24, 0xcf000
 buffer_load_dwordx4 v2, s[4:7], s24 offen offset:0 lds
 buffer_load_dwordx4 v2, s[4:7], s24 offen offset:1024 lds
 buffer_load_dwordx4 v2, s[4:7], s24 offen offset:2048 lds
 buffer_load_dwordx4 v2, s[4:7], s24 offen offset:3072 lds
 s_mov_b32 m0, 0x21c00
 s_mov_b32 s24, 0xd0000
 buffer_load_dwordx4 v2, s[4:7], s24 offen offset:0 lds
 buffer_load_dwordx4 v2, s[4:7], s24 offen offset:1024 lds
 buffer_load_dwordx4 v2, s[4:7], s24 offen offset:2048 lds
 s_waitcnt vmcnt(30)
 s_barrier
 s_mov_b32 m0, 0xc000
 s_mov_b32 s24, 0xd4800
 buffer_load_dwordx4 v2, s[4:7], s24 offen offset:0 lds
 buffer_load_dwordx4 v2, s[4:7], s24 offen offset:1024 lds
 buffer_load_dwordx4 v2, s[4:7], s24 offen offset:2048 lds
 buffer_load_dwordx4 v2, s[4:7], s24 offen offset:3072 lds
 s_mov_b32 m0, 0xd000
 s_mov_b32 s24, 0xd5800
 buffer_load_dwordx4 v2, s[4:7], s24 offen offset:0 lds
 buffer_load_dwordx4 v2, s[4:7], s24 offen offset:1024 lds
 buffer_load_dwordx4 v2, s[4:7], s24 offen offset:2048 lds
 buffer_load_dwordx4 v2, s[4:7], s24 offen offset:3072 lds
 s_mov_b32 m0, 0xe000
 s_mov_b32 s24, 0xd6800
 buffer_load_dwordx4 v2, s[4:7], s24 offen offset:0 lds
 buffer_load_dwordx4 v2, s[4:7], s24 offen offset:1024 lds
 buffer_load_dwordx4 v2, s[4:7], s24 offen offset:2048 lds
 buffer_load_dwordx4 v2, s[4:7], s24 offen offset:3072 lds
 s_mov_b32 m0, 0xf000
 s_mov_b32 s24, 0xd7800
 buffer_load_dwordx4 v2, s[4:7], s24 offen offset:0 lds
 buffer_load_dwordx4 v2, s[4:7], s24 offen offset:1024 lds
 buffer_load_dwordx4 v2, s[4:7], s24 offen offset:2048 lds
 s_waitcnt vmcnt(30)
 s_barrier
 s_waitcnt vmcnt(15)
 s_barrier
 s_waitcnt vmcnt(0)
 s_barrier
 s_barrier
 s_endpgm
C1_bl1:
 s_waitcnt lgkmcnt(0)
 s_mul_i32 s23, s22, 901120
 v_lshlrev_b32 v2, 4, v1
 v_add_u32 v2, s23, v2
 s_mov_b32 m0, 0xd400
 s_mov_b32 s24, 0x1400
 buffer_load_dwordx4 v2, s[4:7], s24 offen offset:0 lds
 buffer_load_dwordx4 v2, s[4:7], s24 offen offset:1024 lds
 buffer_load_dwordx4 v2, s[4:7], s24 offen offset:2048 lds
 buffer_load_dwordx4 v2, s[4:7], s24 offen offset:3072 lds
 s_mov_b32 m0, 0xe400
 s_mov_b32 s24, 0x2400
 buffer_load_dwordx4 v2, s[4:7], s24 offen offset:0 lds
 s_mov_b32 m0, 0xfc00
 s_mov_b32 s24, 0x3c00
 buffer_load_dwordx4 v2, s[4:7], s24 offen offset:0 lds
 buffer_load_dwordx4 v2, s[4:7], s24 offen offset:1024 lds
 buffer_load_dwordx4 v2, s[4:7], s24 offen offset:2048 lds
 buffer_load_dwordx4 v2, s[4:7], s24 offen offset:3072 lds
 s_mov_b32 m0, 0x10c00
 s_mov_b32 s24, 0x4c00
 buffer_load_dwordx4 v2, s[4:7], s24 offen offset:0 lds
 s_mov_b32 m0, 0x12400
 s_mov_b32 s24, 0x6400
 buffer_load_dwordx4 v2, s[4:7], s24 offen offset:0 lds
 buffer_load_dwordx4 v2, s[4:7], s24 offen offset:1024 lds
 buffer_load_dwordx4 v2, s[4:7], s24 offen offset:2048 lds
 buffer_load_dwordx4 v2, s[4:7], s24 offen offset:3072 lds
 s_mov_b32 m0, 0x13400
 s_mov_b32 s24, 0x7400
 buffer_load_dwordx4 v2, s[4:7], s24 offen offset:0 lds
 s_sub_u32 s38, s20, 4
 s_lshl_b32 s59, s22, 2
 s_add_u32 s59, s59, s38
 s_lshl_b32 s58, s21, 2
 s_lshr_b32 s37, s59, 3
 s_add_u32 s58, s58, s37
 s_mul_i32 s58, s58, 61440
 s_and_b32 s37, s59, 7
 s_mul_i32 s37, s37, 2560
 s_add_u32 s58, s58, s37
 s_add_u32 s56, s4, s58
 s_addc_u32 s57, s5, 0
 s_add_u32 s56, s56, 0x117c000
 s_addc_u32 s57, s57, 0
 s_load_dword s40, s[56:57], 0
 s_load_dword s41, s[56:57], 32
 s_load_dword s42, s[56:57], 64
 s_load_dword s43, s[56:57], 96
 s_load_dword s44, s[56:57], 128
 s_load_dword s45, s[56:57], 160
 s_load_dword s46, s[56:57], 192
 s_load_dword s47, s[56:57], 224
 s_load_dword s48, s[56:57], 256
 s_load_dword s49, s[56:57], 288
 s_load_dword s50, s[56:57], 320
 s_load_dword s51, s[56:57], 352
 s_load_dword s52, s[56:57], 384
 s_load_dword s53, s[56:57], 416
 s_waitcnt lgkmcnt(0)
 s_load_dword s40, s[56:57], 448
 s_load_dword s41, s[56:57], 480
 s_load_dword s42, s[56:57], 512
 s_load_dword s43, s[56:57], 544
 s_load_dword s44, s[56:57], 576
 s_load_dword s45, s[56:57], 608
 s_load_dword s46, s[56:57], 640
 s_load_dword s47, s[56:57], 672
 s_load_dword s48, s[56:57], 704
 s_load_dword s49, s[56:57], 736
 s_load_dword s50, s[56:57], 768
 s_load_dword s51, s[56:57], 800
 s_load_dword s52, s[56:57], 832
 s_load_dword s53, s[56:57], 864
 s_waitcnt lgkmcnt(0)
 s_load_dword s40, s[56:57], 896
 s_load_dword s41, s[56:57], 928
 s_load_dword s42, s[56:57], 960
 s_load_dword s43, s[56:57], 992
 s_load_dword s44, s[56:57], 1024
 s_load_dword s45, s[56:57], 1056
 s_load_dword s46, s[56:57], 1088
 s_load_dword s47, s[56:57], 1120
 s_load_dword s48, s[56:57], 1152
 s_load_dword s49, s[56:57], 1184
 s_load_dword s50, s[56:57], 1216
 s_load_dword s51, s[56:57], 1248
 s_load_dword s52, s[56:57], 1280
 s_load_dword s53, s[56:57], 1312
 s_waitcnt lgkmcnt(0)
 s_load_dword s40, s[56:57], 1344
 s_load_dword s41, s[56:57], 1376
 s_load_dword s42, s[56:57], 1408
 s_load_dword s43, s[56:57], 1440
 s_load_dword s44, s[56:57], 1472
 s_load_dword s45, s[56:57], 1504
 s_load_dword s46, s[56:57], 1536
 s_load_dword s47, s[56:57], 1568
 s_load_dword s48, s[56:57], 1600
 s_load_dword s49, s[56:57], 1632
 s_load_dword s50, s[56:57], 1664
 s_load_dword s51, s[56:57], 1696
 s_load_dword s52, s[56:57], 1728
 s_load_dword s53, s[56:57], 1760
 s_waitcnt lgkmcnt(0)
 s_load_dword s40, s[56:57], 1792
 s_load_dword s41, s[56:57], 1824
 s_load_dword s42, s[56:57], 1856
 s_load_dword s43, s[56:57], 1888
 s_load_dword s44, s[56:57], 1920
 s_load_dword s45, s[56:57], 1952
 s_load_dword s46, s[56:57], 1984
 s_load_dword s47, s[56:57], 2016
 s_load_dword s48, s[56:57], 2048
 s_load_dword s49, s[56:57], 2080
 s_load_dword s50, s[56:57], 2112
 s_load_dword s51, s[56:57], 2144
 s_load_dword s52, s[56:57], 2176
 s_load_dword s53, s[56:57], 2208
 s_waitcnt lgkmcnt(0)
 s_load_dword s40, s[56:57], 2240
 s_load_dword s41, s[56:57], 2272
 s_load_dword s42, s[56:57], 2304
 s_load_dword s43, s[56:57], 2336
 s_load_dword s44, s[56:57], 2368
 s_load_dword s45, s[56:57], 2400
 s_load_dword s46, s[56:57], 2432
 s_load_dword s47, s[56:57], 2464
 s_load_dword s48, s[56:57], 2496
 s_load_dword s49, s[56:57], 2528
 s_lshl_b32 s58, s2, 2
 s_add_u32 s58, s58, s38
 s_mul_i32 s58, s58, 7040
 s_add_u32 s56, s4, s58
 s_addc_u32 s57, s5, 0
 s_load_dword s50, s[56:57], 0
 s_load_dword s51, s[56:57], 32
 s_load_dword s52, s[56:57], 64
 s_load_dword s53, s[56:57], 96
 s_waitcnt lgkmcnt(0)
 s_load_dword s40, s[56:57], 128
 s_load_dword s41, s[56:57], 160
 s_load_dword s42, s[56:57], 192
 s_load_dword s43, s[56:57], 224
 s_load_dword s44, s[56:57], 256
 s_load_dword s45, s[56:57], 288
 s_load_dword s46, s[56:57], 320
 s_load_dword s47, s[56:57], 352
 s_load_dword s48, s[56:57], 384
 s_load_dword s49, s[56:57], 416
 s_load_dword s50, s[56:57], 448
 s_load_dword s51, s[56:57], 480
 s_load_dword s52, s[56:57], 512
 s_load_dword s53, s[56:57], 544
 s_waitcnt lgkmcnt(0)
 s_load_dword s40, s[56:57], 576
 s_load_dword s41, s[56:57], 608
 s_load_dword s42, s[56:57], 640
 s_load_dword s43, s[56:57], 672
 s_load_dword s44, s[56:57], 704
 s_load_dword s45, s[56:57], 736
 s_load_dword s46, s[56:57], 768
 s_load_dword s47, s[56:57], 800
 s_load_dword s48, s[56:57], 832
 s_load_dword s49, s[56:57], 864
 s_load_dword s50, s[56:57], 896
 s_load_dword s51, s[56:57], 928
 s_load_dword s52, s[56:57], 960
 s_load_dword s53, s[56:57], 992
 s_waitcnt lgkmcnt(0)
 s_load_dword s40, s[56:57], 1024
 s_load_dword s41, s[56:57], 1056
 s_load_dword s42, s[56:57], 1088
 s_load_dword s43, s[56:57], 1120
 s_load_dword s44, s[56:57], 1152
 s_load_dword s45, s[56:57], 1184
 s_load_dword s46, s[56:57], 1216
 s_load_dword s47, s[56:57], 1248
 s_load_dword s48, s[56:57], 1280
 s_load_dword s49, s[56:57], 1312
 s_load_dword s50, s[56:57], 1344
 s_load_dword s51, s[56:57], 1376
 s_load_dword s52, s[56:57], 1408
 s_load_dword s53, s[56:57], 1440
 s_waitcnt lgkmcnt(0)
 s_load_dword s40, s[56:57], 1472
 s_load_dword s41, s[56:57], 1504
 s_load_dword s42, s[56:57], 1536
 s_load_dword s43, s[56:57], 1568
 s_load_dword s44, s[56:57], 1600
 s_load_dword s45, s[56:57], 1632
 s_load_dword s46, s[56:57], 1664
 s_load_dword s47, s[56:57], 1696
 s_load_dword s48, s[56:57], 1728
 s_load_dword s49, s[56:57], 1760
 s_load_dword s50, s[56:57], 1792
 s_load_dword s51, s[56:57], 1824
 s_load_dword s52, s[56:57], 1856
 s_load_dword s53, s[56:57], 1888
 s_waitcnt lgkmcnt(0)
 s_load_dword s40, s[56:57], 1920
 s_load_dword s41, s[56:57], 1952
 s_load_dword s42, s[56:57], 1984
 s_load_dword s43, s[56:57], 2016
 s_load_dword s44, s[56:57], 2048
 s_load_dword s45, s[56:57], 2080
 s_load_dword s46, s[56:57], 2112
 s_load_dword s47, s[56:57], 2144
 s_load_dword s48, s[56:57], 2176
 s_load_dword s49, s[56:57], 2208
 s_load_dword s50, s[56:57], 2240
 s_load_dword s51, s[56:57], 2272
 s_load_dword s52, s[56:57], 2304
 s_load_dword s53, s[56:57], 2336
 s_waitcnt lgkmcnt(0)
 s_load_dword s40, s[56:57], 2368
 s_load_dword s41, s[56:57], 2400
 s_load_dword s42, s[56:57], 2432
 s_load_dword s43, s[56:57], 2464
 s_load_dword s44, s[56:57], 2496
 s_load_dword s45, s[56:57], 2528
 s_load_dword s46, s[56:57], 2560
 s_load_dword s47, s[56:57], 2592
 s_load_dword s48, s[56:57], 2624
 s_load_dword s49, s[56:57], 2656
 s_load_dword s50, s[56:57], 2688
 s_load_dword s51, s[56:57], 2720
 s_load_dword s52, s[56:57], 2752
 s_load_dword s53, s[56:57], 2784
 s_waitcnt lgkmcnt(0)
 s_load_dword s40, s[56:57], 2816
 s_load_dword s41, s[56:57], 2848
 s_load_dword s42, s[56:57], 2880
 s_load_dword s43, s[56:57], 2912
 s_load_dword s44, s[56:57], 2944
 s_load_dword s45, s[56:57], 2976
 s_load_dword s46, s[56:57], 3008
 s_load_dword s47, s[56:57], 3040
 s_load_dword s48, s[56:57], 3072
 s_load_dword s49, s[56:57], 3104
 s_load_dword s50, s[56:57], 3136
 s_load_dword s51, s[56:57], 3168
 s_load_dword s52, s[56:57], 3200
 s_load_dword s53, s[56:57], 3232
 s_waitcnt lgkmcnt(0)
 s_load_dword s40, s[56:57], 3264
 s_load_dword s41, s[56:57], 3296
 s_load_dword s42, s[56:57], 3328
 s_load_dword s43, s[56:57], 3360
 s_load_dword s44, s[56:57], 3392
 s_load_dword s45, s[56:57], 3424
 s_load_dword s46, s[56:57], 3456
 s_load_dword s47, s[56:57], 3488
 s_load_dword s48, s[56:57], 3520
 s_load_dword s49, s[56:57], 3552
 s_load_dword s50, s[56:57], 3584
 s_load_dword s51, s[56:57], 3616
 s_load_dword s52, s[56:57], 3648
 s_load_dword s53, s[56:57], 3680
 s_waitcnt lgkmcnt(0)
 s_load_dword s40, s[56:57], 3712
 s_load_dword s41, s[56:57], 3744
 s_load_dword s42, s[56:57], 3776
 s_load_dword s43, s[56:57], 3808
 s_load_dword s44, s[56:57], 3840
 s_load_dword s45, s[56:57], 3872
 s_load_dword s46, s[56:57], 3904
 s_load_dword s47, s[56:57], 3936
 s_load_dword s48, s[56:57], 3968
 s_load_dword s49, s[56:57], 4000
 s_load_dword s50, s[56:57], 4032
 s_load_dword s51, s[56:57], 4064
 s_load_dword s52, s[56:57], 4096
 s_load_dword s53, s[56:57], 4128
 s_waitcnt lgkmcnt(0)
 s_load_dword s40, s[56:57], 4160
 s_load_dword s41, s[56:57], 4192
 s_load_dword s42, s[56:57], 4224
 s_load_dword s43, s[56:57], 4256
 s_load_dword s44, s[56:57], 4288
 s_load_dword s45, s[56:57], 4320
 s_load_dword s46, s[56:57], 4352
 s_load_dword s47, s[56:57], 4384
 s_load_dword s48, s[56:57], 4416
 s_load_dword s49, s[56:57], 4448
 s_load_dword s50, s[56:57], 4480
 s_load_dword s51, s[56:57], 4512
 s_load_dword s52, s[56:57], 4544
 s_load_dword s53, s[56:57], 4576
 s_waitcnt lgkmcnt(0)
 s_load_dword s40, s[56:57], 4608
 s_load_dword s41, s[56:57], 4640
 s_load_dword s42, s[56:57], 4672
 s_load_dword s43, s[56:57], 4704
 s_load_dword s44, s[56:57], 4736
 s_load_dword s45, s[56:57], 4768
 s_load_dword s46, s[56:57], 4800
 s_load_dword s47, s[56:57], 4832
 s_load_dword s48, s[56:57], 4864
 s_load_dword s49, s[56:57], 4896
 s_load_dword s50, s[56:57], 4928
 s_load_dword s51, s[56:57], 4960
 s_load_dword s52, s[56:57], 4992
 s_load_dword s53, s[56:57], 5024
 s_waitcnt lgkmcnt(0)
 s_load_dword s40, s[56:57], 5056
 s_load_dword s41, s[56:57], 5088
 s_load_dword s42, s[56:57], 5120
 s_load_dword s43, s[56:57], 5152
 s_load_dword s44, s[56:57], 5184
 s_load_dword s45, s[56:57], 5216
 s_load_dword s46, s[56:57], 5248
 s_load_dword s47, s[56:57], 5280
 s_load_dword s48, s[56:57], 5312
 s_load_dword s49, s[56:57], 5344
 s_load_dword s50, s[56:57], 5376
 s_load_dword s51, s[56:57], 5408
 s_load_dword s52, s[56:57], 5440
 s_load_dword s53, s[56:57], 5472
 s_waitcnt lgkmcnt(0)
 s_load_dword s40, s[56:57], 5504
 s_load_dword s41, s[56:57], 5536
 s_load_dword s42, s[56:57], 5568
 s_load_dword s43, s[56:57], 5600
 s_load_dword s44, s[56:57], 5632
 s_load_dword s45, s[56:57], 5664
 s_load_dword s46, s[56:57], 5696
 s_load_dword s47, s[56:57], 5728
 s_load_dword s48, s[56:57], 5760
 s_load_dword s49, s[56:57], 5792
 s_load_dword s50, s[56:57], 5824
 s_load_dword s51, s[56:57], 5856
 s_load_dword s52, s[56:57], 5888
 s_load_dword s53, s[56:57], 5920
 s_waitcnt lgkmcnt(0)
 s_load_dword s40, s[56:57], 5952
 s_load_dword s41, s[56:57], 5984
 s_load_dword s42, s[56:57], 6016
 s_load_dword s43, s[56:57], 6048
 s_load_dword s44, s[56:57], 6080
 s_load_dword s45, s[56:57], 6112
 s_load_dword s46, s[56:57], 6144
 s_load_dword s47, s[56:57], 6176
 s_load_dword s48, s[56:57], 6208
 s_load_dword s49, s[56:57], 6240
 s_load_dword s50, s[56:57], 6272
 s_load_dword s51, s[56:57], 6304
 s_load_dword s52, s[56:57], 6336
 s_load_dword s53, s[56:57], 6368
 s_waitcnt lgkmcnt(0)
 s_load_dword s40, s[56:57], 6400
 s_load_dword s41, s[56:57], 6432
 s_load_dword s42, s[56:57], 6464
 s_load_dword s43, s[56:57], 6496
 s_load_dword s44, s[56:57], 6528
 s_load_dword s45, s[56:57], 6560
 s_load_dword s46, s[56:57], 6592
 s_load_dword s47, s[56:57], 6624
 s_load_dword s48, s[56:57], 6656
 s_load_dword s49, s[56:57], 6688
 s_load_dword s50, s[56:57], 6720
 s_load_dword s51, s[56:57], 6752
 s_load_dword s52, s[56:57], 6784
 s_load_dword s53, s[56:57], 6816
 s_waitcnt lgkmcnt(0)
 s_load_dword s40, s[56:57], 6848
 s_load_dword s41, s[56:57], 6880
 s_load_dword s42, s[56:57], 6912
 s_load_dword s43, s[56:57], 6944
 s_load_dword s44, s[56:57], 6976
 s_load_dword s45, s[56:57], 7008
 s_mul_i32 s58, s21, 81920
 s_mul_i32 s37, s59, 2560
 s_add_u32 s58, s58, s37
 s_add_u32 s56, s4, s58
 s_addc_u32 s57, s5, 0
 s_add_u32 s56, s56, 0xbf2000
 s_addc_u32 s57, s57, 0
 s_load_dword s46, s[56:57], 0
 s_load_dword s47, s[56:57], 32
 s_load_dword s48, s[56:57], 64
 s_load_dword s49, s[56:57], 96
 s_load_dword s50, s[56:57], 128
 s_load_dword s51, s[56:57], 160
 s_load_dword s52, s[56:57], 192
 s_load_dword s53, s[56:57], 224
 s_waitcnt lgkmcnt(0)
 s_load_dword s40, s[56:57], 256
 s_load_dword s41, s[56:57], 288
 s_load_dword s42, s[56:57], 320
 s_load_dword s43, s[56:57], 352
 s_load_dword s44, s[56:57], 384
 s_load_dword s45, s[56:57], 416
 s_load_dword s46, s[56:57], 448
 s_load_dword s47, s[56:57], 480
 s_load_dword s48, s[56:57], 512
 s_load_dword s49, s[56:57], 544
 s_load_dword s50, s[56:57], 576
 s_load_dword s51, s[56:57], 608
 s_load_dword s52, s[56:57], 640
 s_load_dword s53, s[56:57], 672
 s_waitcnt lgkmcnt(0)
 s_load_dword s40, s[56:57], 704
 s_load_dword s41, s[56:57], 736
 s_load_dword s42, s[56:57], 768
 s_load_dword s43, s[56:57], 800
 s_load_dword s44, s[56:57], 832
 s_load_dword s45, s[56:57], 864
 s_load_dword s46, s[56:57], 896
 s_load_dword s47, s[56:57], 928
 s_load_dword s48, s[56:57], 960
 s_load_dword s49, s[56:57], 992
 s_load_dword s50, s[56:57], 1024
 s_load_dword s51, s[56:57], 1056
 s_load_dword s52, s[56:57], 1088
 s_load_dword s53, s[56:57], 1120
 s_waitcnt lgkmcnt(0)
 s_load_dword s40, s[56:57], 1152
 s_load_dword s41, s[56:57], 1184
 s_load_dword s42, s[56:57], 1216
 s_load_dword s43, s[56:57], 1248
 s_load_dword s44, s[56:57], 1280
 s_load_dword s45, s[56:57], 1312
 s_load_dword s46, s[56:57], 1344
 s_load_dword s47, s[56:57], 1376
 s_load_dword s48, s[56:57], 1408
 s_load_dword s49, s[56:57], 1440
 s_load_dword s50, s[56:57], 1472
 s_load_dword s51, s[56:57], 1504
 s_load_dword s52, s[56:57], 1536
 s_load_dword s53, s[56:57], 1568
 s_waitcnt lgkmcnt(0)
 s_load_dword s40, s[56:57], 1600
 s_load_dword s41, s[56:57], 1632
 s_load_dword s42, s[56:57], 1664
 s_load_dword s43, s[56:57], 1696
 s_load_dword s44, s[56:57], 1728
 s_load_dword s45, s[56:57], 1760
 s_load_dword s46, s[56:57], 1792
 s_load_dword s47, s[56:57], 1824
 s_load_dword s48, s[56:57], 1856
 s_load_dword s49, s[56:57], 1888
 s_load_dword s50, s[56:57], 1920
 s_load_dword s51, s[56:57], 1952
 s_load_dword s52, s[56:57], 1984
 s_load_dword s53, s[56:57], 2016
 s_waitcnt lgkmcnt(0)
 s_load_dword s40, s[56:57], 2048
 s_load_dword s41, s[56:57], 2080
 s_load_dword s42, s[56:57], 2112
 s_load_dword s43, s[56:57], 2144
 s_load_dword s44, s[56:57], 2176
 s_load_dword s45, s[56:57], 2208
 s_load_dword s46, s[56:57], 2240
 s_load_dword s47, s[56:57], 2272
 s_load_dword s48, s[56:57], 2304
 s_load_dword s49, s[56:57], 2336
 s_load_dword s50, s[56:57], 2368
 s_load_dword s51, s[56:57], 2400
 s_load_dword s52, s[56:57], 2432
 s_load_dword s53, s[56:57], 2464
 s_waitcnt lgkmcnt(0)
 s_load_dword s40, s[56:57], 2496
 s_load_dword s41, s[56:57], 2528
 s_lshl_b32 s58, s21, 12
 s_lshl_b32 s37, s59, 7
 s_add_u32 s58, s58, s37
 s_add_u32 s56, s4, s58
 s_addc_u32 s57, s5, 0
 s_add_u32 s56, s56, 0x1112000
 s_addc_u32 s57, s57, 0
 s_load_dword s42, s[56:57], 0
 s_load_dword s43, s[56:57], 32
 s_load_dword s44, s[56:57], 64
 s_load_dword s45, s[56:57], 96
 s_add_u32 s56, s4, s58
 s_addc_u32 s57, s5, 0
 s_add_u32 s56, s56, 0x1132000
 s_addc_u32 s57, s57, 0
 s_load_dword s46, s[56:57], 0
 s_load_dword s47, s[56:57], 32
 s_load_dword s48, s[56:57], 64
 s_load_dword s49, s[56:57], 96
 s_lshl_b32 s58, s2, 2
 s_add_u32 s58, s58, s38
 s_getpc_b64 s[56:57]
C1_pc3:
 s_add_u32 s56, s56, C2_start-C1_pc3
 s_addc_u32 s57, s57, 0
 s_mul_i32 s58, s58, 32
 s_add_u32 s37, s58, 0
 s_min_u32 s37, s37, C2_end-C2_start
 s_load_dword s50, s[56:57], s37
 s_add_u32 s37, s58, 32768
 s_min_u32 s37, s37, C2_end-C2_start
 s_load_dword s51, s[56:57], s37
 s_lshr_b32 s58, s2, 3
 s_lshl_b32 s58, s58, 2
 s_add_u32 s58, s58, s38
 s_getpc_b64 s[56:57]
C1_pc4:
 s_sub_u32 s56, s56, C1_pc4-C1_start
 s_subb_u32 s57, s57, 0
 s_mul_i32 s58, s58, 32
 s_add_u32 s37, s58, 0
 s_min_u32 s37, s37, C1_end-C1_start
 s_load_dword s52, s[56:57], s37
 s_add_u32 s37, s58, 4096
 s_min_u32 s37, s37, C1_end-C1_start
 s_load_dword s53, s[56:57], s37
 s_waitcnt lgkmcnt(0)
 s_add_u32 s37, s58, 8192
 s_min_u32 s37, s37, C1_end-C1_start
 s_load_dword s40, s[56:57], s37
 s_add_u32 s37, s58, 12288
 s_min_u32 s37, s37, C1_end-C1_start
 s_load_dword s41, s[56:57], s37
 s_add_u32 s37, s58, 16384
 s_min_u32 s37, s37, C1_end-C1_start
 s_load_dword s42, s[56:57], s37
 s_add_u32 s37, s58, 20480
 s_min_u32 s37, s37, C1_end-C1_start
 s_load_dword s43, s[56:57], s37
 s_add_u32 s37, s58, 24576
 s_min_u32 s37, s37, C1_end-C1_start
 s_load_dword s44, s[56:57], s37
 s_add_u32 s37, s58, 28672
 s_min_u32 s37, s37, C1_end-C1_start
 s_load_dword s45, s[56:57], s37
 s_add_u32 s37, s58, 32768
 s_min_u32 s37, s37, C1_end-C1_start
 s_load_dword s46, s[56:57], s37
 s_add_u32 s37, s58, 36864
 s_min_u32 s37, s37, C1_end-C1_start
 s_load_dword s47, s[56:57], s37
 s_add_u32 s37, s58, 40960
 s_min_u32 s37, s37, C1_end-C1_start
 s_load_dword s48, s[56:57], s37
 s_add_u32 s37, s58, 45056
 s_min_u32 s37, s37, C1_end-C1_start
 s_load_dword s49, s[56:57], s37
 s_add_u32 s37, s58, 49152
 s_min_u32 s37, s37, C1_end-C1_start
 s_load_dword s50, s[56:57], s37
 s_add_u32 s37, s58, 53248
 s_min_u32 s37, s37, C1_end-C1_start
 s_load_dword s51, s[56:57], s37
 s_add_u32 s37, s58, 57344
 s_min_u32 s37, s37, C1_end-C1_start
 s_load_dword s52, s[56:57], s37
 s_add_u32 s37, s58, 61440
 s_min_u32 s37, s37, C1_end-C1_start
 s_load_dword s53, s[56:57], s37
 s_waitcnt lgkmcnt(0)
 s_waitcnt lgkmcnt(0)
 s_mov_b32 m0, 0x14c00
 s_mov_b32 s24, 0x8c00
 buffer_load_dwordx4 v2, s[4:7], s24 offen offset:0 lds
 buffer_load_dwordx4 v2, s[4:7], s24 offen offset:1024 lds
 buffer_load_dwordx4 v2, s[4:7], s24 offen offset:2048 lds
 buffer_load_dwordx4 v2, s[4:7], s24 offen offset:3072 lds
 s_mov_b32 m0, 0x15c00
 s_mov_b32 s24, 0x9c00
 buffer_load_dwordx4 v2, s[4:7], s24 offen offset:0 lds
 s_mov_b32 m0, 0x17400
 s_mov_b32 s24, 0xb400
 buffer_load_dwordx4 v2, s[4:7], s24 offen offset:0 lds
 buffer_load_dwordx4 v2, s[4:7], s24 offen offset:1024 lds
 buffer_load_dwordx4 v2, s[4:7], s24 offen offset:2048 lds
 buffer_load_dwordx4 v2, s[4:7], s24 offen offset:3072 lds
 s_mov_b32 m0, 0x18400
 s_mov_b32 s24, 0xc400
 buffer_load_dwordx4 v2, s[4:7], s24 offen offset:0 lds
 s_mov_b32 m0, 0x19c00
 s_mov_b32 s24, 0xdc00
 buffer_load_dwordx4 v2, s[4:7], s24 offen offset:0 lds
 buffer_load_dwordx4 v2, s[4:7], s24 offen offset:1024 lds
 buffer_load_dwordx4 v2, s[4:7], s24 offen offset:2048 lds
 buffer_load_dwordx4 v2, s[4:7], s24 offen offset:3072 lds
 s_mov_b32 m0, 0x1ac00
 s_mov_b32 s24, 0xec00
 buffer_load_dwordx4 v2, s[4:7], s24 offen offset:0 lds
 s_mov_b32 m0, 0x1c400
 s_mov_b32 s24, 0x10400
 buffer_load_dwordx4 v2, s[4:7], s24 offen offset:0 lds
 buffer_load_dwordx4 v2, s[4:7], s24 offen offset:1024 lds
 buffer_load_dwordx4 v2, s[4:7], s24 offen offset:2048 lds
 buffer_load_dwordx4 v2, s[4:7], s24 offen offset:3072 lds
 s_mov_b32 m0, 0x1d400
 s_mov_b32 s24, 0x11400
 buffer_load_dwordx4 v2, s[4:7], s24 offen offset:0 lds
 s_mov_b32 m0, 0x1ec00
 s_mov_b32 s24, 0x12c00
 buffer_load_dwordx4 v2, s[4:7], s24 offen offset:0 lds
 buffer_load_dwordx4 v2, s[4:7], s24 offen offset:1024 lds
 buffer_load_dwordx4 v2, s[4:7], s24 offen offset:2048 lds
 buffer_load_dwordx4 v2, s[4:7], s24 offen offset:3072 lds
 s_mov_b32 m0, 0x1fc00
 s_mov_b32 s24, 0x13c00
 buffer_load_dwordx4 v2, s[4:7], s24 offen offset:0 lds
 s_mov_b32 m0, 0x21400
 s_mov_b32 s24, 0x15400
 buffer_load_dwordx4 v2, s[4:7], s24 offen offset:0 lds
 buffer_load_dwordx4 v2, s[4:7], s24 offen offset:1024 lds
 buffer_load_dwordx4 v2, s[4:7], s24 offen offset:2048 lds
 buffer_load_dwordx4 v2, s[4:7], s24 offen offset:3072 lds
 s_mov_b32 m0, 0x22400
 s_mov_b32 s24, 0x16400
 buffer_load_dwordx4 v2, s[4:7], s24 offen offset:0 lds
 s_mov_b32 m0, 0x23c00
 s_mov_b32 s24, 0x17c00
 buffer_load_dwordx4 v2, s[4:7], s24 offen offset:0 lds
 buffer_load_dwordx4 v2, s[4:7], s24 offen offset:1024 lds
 buffer_load_dwordx4 v2, s[4:7], s24 offen offset:2048 lds
 buffer_load_dwordx4 v2, s[4:7], s24 offen offset:3072 lds
 s_mov_b32 m0, 0x24c00
 s_mov_b32 s24, 0x18c00
 buffer_load_dwordx4 v2, s[4:7], s24 offen offset:0 lds
 s_barrier
 s_waitcnt vmcnt(45)
 s_barrier
 s_waitcnt vmcnt(40)
 s_barrier
 s_waitcnt vmcnt(35)
 s_barrier
 s_waitcnt vmcnt(30)
 s_barrier
 s_waitcnt vmcnt(25)
 s_barrier
 s_waitcnt vmcnt(20)
 s_barrier
 s_waitcnt vmcnt(15)
 s_barrier
 s_mov_b32 m0, 0xf000
 s_mov_b32 s24, 0x1c000
 buffer_load_dwordx4 v2, s[4:7], s24 offen offset:0 lds
 buffer_load_dwordx4 v2, s[4:7], s24 offen offset:1024 lds
 buffer_load_dwordx4 v2, s[4:7], s24 offen offset:2048 lds
 buffer_load_dwordx4 v2, s[4:7], s24 offen offset:3072 lds
 s_mov_b32 m0, 0x10000
 s_mov_b32 s24, 0x1d000
 buffer_load_dwordx4 v2, s[4:7], s24 offen offset:0 lds
 buffer_load_dwordx4 v2, s[4:7], s24 offen offset:1024 lds
 buffer_load_dwordx4 v2, s[4:7], s24 offen offset:2048 lds
 buffer_load_dwordx4 v2, s[4:7], s24 offen offset:3072 lds
 s_mov_b32 m0, 0x11000
 s_mov_b32 s24, 0x1e000
 buffer_load_dwordx4 v2, s[4:7], s24 offen offset:0 lds
 buffer_load_dwordx4 v2, s[4:7], s24 offen offset:1024 lds
 buffer_load_dwordx4 v2, s[4:7], s24 offen offset:2048 lds
 buffer_load_dwordx4 v2, s[4:7], s24 offen offset:3072 lds
 s_waitcnt vmcnt(22)
 s_barrier
 s_mov_b32 m0, 0x15000
 s_mov_b32 s24, 0x22000
 buffer_load_dwordx4 v2, s[4:7], s24 offen offset:0 lds
 buffer_load_dwordx4 v2, s[4:7], s24 offen offset:1024 lds
 buffer_load_dwordx4 v2, s[4:7], s24 offen offset:2048 lds
 buffer_load_dwordx4 v2, s[4:7], s24 offen offset:3072 lds
 s_mov_b32 m0, 0x16000
 s_mov_b32 s24, 0x23000
 buffer_load_dwordx4 v2, s[4:7], s24 offen offset:0 lds
 buffer_load_dwordx4 v2, s[4:7], s24 offen offset:1024 lds
 buffer_load_dwordx4 v2, s[4:7], s24 offen offset:2048 lds
 buffer_load_dwordx4 v2, s[4:7], s24 offen offset:3072 lds
 s_mov_b32 m0, 0x17000
 s_mov_b32 s24, 0x24000
 buffer_load_dwordx4 v2, s[4:7], s24 offen offset:0 lds
 buffer_load_dwordx4 v2, s[4:7], s24 offen offset:1024 lds
 buffer_load_dwordx4 v2, s[4:7], s24 offen offset:2048 lds
 buffer_load_dwordx4 v2, s[4:7], s24 offen offset:3072 lds
 s_waitcnt vmcnt(29)
 s_barrier
 s_waitcnt vmcnt(24)
 s_barrier
 s_mov_b32 m0, 0x1b000
 s_mov_b32 s24, 0x28000
 buffer_load_dwordx4 v2, s[4:7], s24 offen offset:0 lds
 buffer_load_dwordx4 v2, s[4:7], s24 offen offset:1024 lds
 buffer_load_dwordx4 v2, s[4:7], s24 offen offset:2048 lds
 buffer_load_dwordx4 v2, s[4:7], s24 offen offset:3072 lds
 s_mov_b32 m0, 0x1c000
 s_mov_b32 s24, 0x29000
 buffer_load_dwordx4 v2, s[4:7], s24 offen offset:0 lds
 buffer_load_dwordx4 v2, s[4:7], s24 offen offset:1024 lds
 buffer_load_dwordx4 v2, s[4:7], s24 offen offset:2048 lds
 buffer_load_dwordx4 v2, s[4:7], s24 offen offset:3072 lds
 s_mov_b32 m0, 0x1d000
 s_mov_b32 s24, 0x2a000
 buffer_load_dwordx4 v2, s[4:7], s24 offen offset:0 lds
 buffer_load_dwordx4 v2, s[4:7], s24 offen offset:1024 lds
 buffer_load_dwordx4 v2, s[4:7], s24 offen offset:2048 lds
 buffer_load_dwordx4 v2, s[4:7], s24 offen offset:3072 lds
 s_barrier
 s_waitcnt vmcnt(24)
 s_barrier
 s_mov_b32 m0, 0x21000
 s_mov_b32 s24, 0x2e000
 buffer_load_dwordx4 v2, s[4:7], s24 offen offset:0 lds
 buffer_load_dwordx4 v2, s[4:7], s24 offen offset:1024 lds
 buffer_load_dwordx4 v2, s[4:7], s24 offen offset:2048 lds
 buffer_load_dwordx4 v2, s[4:7], s24 offen offset:3072 lds
 s_mov_b32 m0, 0x22000
 s_mov_b32 s24, 0x2f000
 buffer_load_dwordx4 v2, s[4:7], s24 offen offset:0 lds
 buffer_load_dwordx4 v2, s[4:7], s24 offen offset:1024 lds
 buffer_load_dwordx4 v2, s[4:7], s24 offen offset:2048 lds
 buffer_load_dwordx4 v2, s[4:7], s24 offen offset:3072 lds
 s_mov_b32 m0, 0x23000
 s_mov_b32 s24, 0x30000
 buffer_load_dwordx4 v2, s[4:7], s24 offen offset:0 lds
 buffer_load_dwordx4 v2, s[4:7], s24 offen offset:1024 lds
 buffer_load_dwordx4 v2, s[4:7], s24 offen offset:2048 lds
 buffer_load_dwordx4 v2, s[4:7], s24 offen offset:3072 lds
 s_waitcnt vmcnt(24)
 s_barrier
 s_mov_b32 m0, 0xc000
 s_mov_b32 s24, 0x34000
 buffer_load_dwordx4 v2, s[4:7], s24 offen offset:0 lds
 buffer_load_dwordx4 v2, s[4:7], s24 offen offset:1024 lds
 buffer_load_dwordx4 v2, s[4:7], s24 offen offset:2048 lds
 buffer_load_dwordx4 v2, s[4:7], s24 offen offset:3072 lds
 s_mov_b32 m0, 0xd000
 s_mov_b32 s24, 0x35000
 buffer_load_dwordx4 v2, s[4:7], s24 offen offset:0 lds
 buffer_load_dwordx4 v2, s[4:7], s24 offen offset:1024 lds
 buffer_load_dwordx4 v2, s[4:7], s24 offen offset:2048 lds
 buffer_load_dwordx4 v2, s[4:7], s24 offen offset:3072 lds
 s_mov_b32 m0, 0xe000
 s_mov_b32 s24, 0x36000
 buffer_load_dwordx4 v2, s[4:7], s24 offen offset:0 lds
 buffer_load_dwordx4 v2, s[4:7], s24 offen offset:1024 lds
 buffer_load_dwordx4 v2, s[4:7], s24 offen offset:2048 lds
 buffer_load_dwordx4 v2, s[4:7], s24 offen offset:3072 lds
 s_waitcnt vmcnt(24)
 s_barrier
 s_mov_b32 m0, 0x12000
 s_mov_b32 s24, 0x3a000
 buffer_load_dwordx4 v2, s[4:7], s24 offen offset:0 lds
 buffer_load_dwordx4 v2, s[4:7], s24 offen offset:1024 lds
 buffer_load_dwordx4 v2, s[4:7], s24 offen offset:2048 lds
 buffer_load_dwordx4 v2, s[4:7], s24 offen offset:3072 lds
 s_mov_b32 m0, 0x13000
 s_mov_b32 s24, 0x3b000
 buffer_load_dwordx4 v2, s[4:7], s24 offen offset:0 lds
 buffer_load_dwordx4 v2, s[4:7], s24 offen offset:1024 lds
 buffer_load_dwordx4 v2, s[4:7], s24 offen offset:2048 lds
 buffer_load_dwordx4 v2, s[4:7], s24 offen offset:3072 lds
 s_mov_b32 m0, 0x14000
 s_mov_b32 s24, 0x3c000
 buffer_load_dwordx4 v2, s[4:7], s24 offen offset:0 lds
 buffer_load_dwordx4 v2, s[4:7], s24 offen offset:1024 lds
 buffer_load_dwordx4 v2, s[4:7], s24 offen offset:2048 lds
 buffer_load_dwordx4 v2, s[4:7], s24 offen offset:3072 lds
 s_waitcnt vmcnt(24)
 s_barrier
 s_mov_b32 m0, 0x18000
 s_mov_b32 s24, 0x40000
 buffer_load_dwordx4 v2, s[4:7], s24 offen offset:0 lds
 buffer_load_dwordx4 v2, s[4:7], s24 offen offset:1024 lds
 buffer_load_dwordx4 v2, s[4:7], s24 offen offset:2048 lds
 buffer_load_dwordx4 v2, s[4:7], s24 offen offset:3072 lds
 s_mov_b32 m0, 0x19000
 s_mov_b32 s24, 0x41000
 buffer_load_dwordx4 v2, s[4:7], s24 offen offset:0 lds
 buffer_load_dwordx4 v2, s[4:7], s24 offen offset:1024 lds
 buffer_load_dwordx4 v2, s[4:7], s24 offen offset:2048 lds
 buffer_load_dwordx4 v2, s[4:7], s24 offen offset:3072 lds
 s_mov_b32 m0, 0x1a000
 s_mov_b32 s24, 0x42000
 buffer_load_dwordx4 v2, s[4:7], s24 offen offset:0 lds
 buffer_load_dwordx4 v2, s[4:7], s24 offen offset:1024 lds
 buffer_load_dwordx4 v2, s[4:7], s24 offen offset:2048 lds
 buffer_load_dwordx4 v2, s[4:7], s24 offen offset:3072 lds
 s_waitcnt vmcnt(24)
 s_barrier
 s_mov_b32 m0, 0x1e000
 s_mov_b32 s24, 0x46000
 buffer_load_dwordx4 v2, s[4:7], s24 offen offset:0 lds
 buffer_load_dwordx4 v2, s[4:7], s24 offen offset:1024 lds
 buffer_load_dwordx4 v2, s[4:7], s24 offen offset:2048 lds
 buffer_load_dwordx4 v2, s[4:7], s24 offen offset:3072 lds
 s_mov_b32 m0, 0x1f000
 s_mov_b32 s24, 0x47000
 buffer_load_dwordx4 v2, s[4:7], s24 offen offset:0 lds
 buffer_load_dwordx4 v2, s[4:7], s24 offen offset:1024 lds
 buffer_load_dwordx4 v2, s[4:7], s24 offen offset:2048 lds
 buffer_load_dwordx4 v2, s[4:7], s24 offen offset:3072 lds
 s_mov_b32 m0, 0x20000
 s_mov_b32 s24, 0x48000
 buffer_load_dwordx4 v2, s[4:7], s24 offen offset:0 lds
 buffer_load_dwordx4 v2, s[4:7], s24 offen offset:1024 lds
 buffer_load_dwordx4 v2, s[4:7], s24 offen offset:2048 lds
 buffer_load_dwordx4 v2, s[4:7], s24 offen offset:3072 lds
 s_waitcnt vmcnt(24)
 s_barrier
 s_mov_b32 m0, 0x24000
 s_mov_b32 s24, 0x4c000
 buffer_load_dwordx4 v2, s[4:7], s24 offen offset:0 lds
 buffer_load_dwordx4 v2, s[4:7], s24 offen offset:1024 lds
 buffer_load_dwordx4 v2, s[4:7], s24 offen offset:2048 lds
 buffer_load_dwordx4 v2, s[4:7], s24 offen offset:3072 lds
 s_mov_b32 m0, 0x25000
 s_mov_b32 s24, 0x4d000
 buffer_load_dwordx4 v2, s[4:7], s24 offen offset:0 lds
 buffer_load_dwordx4 v2, s[4:7], s24 offen offset:1024 lds
 buffer_load_dwordx4 v2, s[4:7], s24 offen offset:2048 lds
 buffer_load_dwordx4 v2, s[4:7], s24 offen offset:3072 lds
 s_mov_b32 m0, 0x26000
 s_mov_b32 s24, 0x4e000
 buffer_load_dwordx4 v2, s[4:7], s24 offen offset:0 lds
 buffer_load_dwordx4 v2, s[4:7], s24 offen offset:1024 lds
 buffer_load_dwordx4 v2, s[4:7], s24 offen offset:2048 lds
 buffer_load_dwordx4 v2, s[4:7], s24 offen offset:3072 lds
 s_waitcnt vmcnt(24)
 s_barrier
 s_mov_b32 m0, 0xf000
 s_mov_b32 s24, 0x52000
 buffer_load_dwordx4 v2, s[4:7], s24 offen offset:0 lds
 buffer_load_dwordx4 v2, s[4:7], s24 offen offset:1024 lds
 buffer_load_dwordx4 v2, s[4:7], s24 offen offset:2048 lds
 buffer_load_dwordx4 v2, s[4:7], s24 offen offset:3072 lds
 s_mov_b32 m0, 0x10000
 s_mov_b32 s24, 0x53000
 buffer_load_dwordx4 v2, s[4:7], s24 offen offset:0 lds
 buffer_load_dwordx4 v2, s[4:7], s24 offen offset:1024 lds
 buffer_load_dwordx4 v2, s[4:7], s24 offen offset:2048 lds
 buffer_load_dwordx4 v2, s[4:7], s24 offen offset:3072 lds
 s_mov_b32 m0, 0x11000
 s_mov_b32 s24, 0x54000
 buffer_load_dwordx4 v2, s[4:7], s24 offen offset:0 lds
 buffer_load_dwordx4 v2, s[4:7], s24 offen offset:1024 lds
 buffer_load_dwordx4 v2, s[4:7], s24 offen offset:2048 lds
 buffer_load_dwordx4 v2, s[4:7], s24 offen offset:3072 lds
 s_mov_b32 m0, 0x13800
 s_mov_b32 s24, 0x56400
 buffer_load_dwordx4 v2, s[4:7], s24 offen offset:0 lds
 buffer_load_dwordx4 v2, s[4:7], s24 offen offset:1024 lds
 buffer_load_dwordx4 v2, s[4:7], s24 offen offset:2048 lds
 buffer_load_dwordx4 v2, s[4:7], s24 offen offset:3072 lds
 s_mov_b32 m0, 0x14800
 s_mov_b32 s24, 0x57400
 buffer_load_dwordx4 v2, s[4:7], s24 offen offset:0 lds
 s_waitcnt vmcnt(29)
 s_barrier
 s_mov_b32 m0, 0x16000
 s_mov_b32 s24, 0x58c00
 buffer_load_dwordx4 v2, s[4:7], s24 offen offset:0 lds
 buffer_load_dwordx4 v2, s[4:7], s24 offen offset:1024 lds
 buffer_load_dwordx4 v2, s[4:7], s24 offen offset:2048 lds
 buffer_load_dwordx4 v2, s[4:7], s24 offen offset:3072 lds
 s_mov_b32 m0, 0x17000
 s_mov_b32 s24, 0x59c00
 buffer_load_dwordx4 v2, s[4:7], s24 offen offset:0 lds
 s_waitcnt vmcnt(22)
 s_barrier
 s_mov_b32 m0, 0x18800
 s_mov_b32 s24, 0x5b400
 buffer_load_dwordx4 v2, s[4:7], s24 offen offset:0 lds
 buffer_load_dwordx4 v2, s[4:7], s24 offen offset:1024 lds
 buffer_load_dwordx4 v2, s[4:7], s24 offen offset:2048 lds
 buffer_load_dwordx4 v2, s[4:7], s24 offen offset:3072 lds
 s_mov_b32 m0, 0x19800
 s_mov_b32 s24, 0x5c400
 buffer_load_dwordx4 v2, s[4:7], s24 offen offset:0 lds
 s_waitcnt vmcnt(15)
 s_barrier
 s_mov_b32 m0, 0x1b000
 s_mov_b32 s24, 0x5dc00
 buffer_load_dwordx4 v2, s[4:7], s24 offen offset:0 lds
 buffer_load_dwordx4 v2, s[4:7], s24 offen offset:1024 lds
 buffer_load_dwordx4 v2, s[4:7], s24 offen offset:2048 lds
 buffer_load_dwordx4 v2, s[4:7], s24 offen offset:3072 lds
 s_mov_b32 m0, 0x1c000
 s_mov_b32 s24, 0x5ec00
 buffer_load_dwordx4 v2, s[4:7], s24 offen offset:0 lds
 s_barrier
 s_mov_b32 m0, 0x1d800
 s_mov_b32 s24, 0x60400
 buffer_load_dwordx4 v2, s[4:7], s24 offen offset:0 lds
 buffer_load_dwordx4 v2, s[4:7], s24 offen offset:1024 lds
 buffer_load_dwordx4 v2, s[4:7], s24 offen offset:2048 lds
 buffer_load_dwordx4 v2, s[4:7], s24 offen offset:3072 lds
 s_mov_b32 m0, 0x1e800
 s_mov_b32 s24, 0x61400
 buffer_load_dwordx4 v2, s[4:7], s24 offen offset:0 lds
 s_mov_b32 m0, 0x20000
 s_mov_b32 s24, 0x62c00
 buffer_load_dwordx4 v2, s[4:7], s24 offen offset:0 lds
 buffer_load_dwordx4 v2, s[4:7], s24 offen offset:1024 lds
 buffer_load_dwordx4 v2, s[4:7], s24 offen offset:2048 lds
 buffer_load_dwordx4 v2, s[4:7], s24 offen offset:3072 lds
 s_mov_b32 m0, 0x21000
 s_mov_b32 s24, 0x63c00
 buffer_load_dwordx4 v2, s[4:7], s24 offen offset:0 lds
 s_mov_b32 m0, 0x22800
 s_mov_b32 s24, 0x65400
 buffer_load_dwordx4 v2, s[4:7], s24 offen offset:0 lds
 buffer_load_dwordx4 v2, s[4:7], s24 offen offset:1024 lds
 buffer_load_dwordx4 v2, s[4:7], s24 offen offset:2048 lds
 buffer_load_dwordx4 v2, s[4:7], s24 offen offset:3072 lds
 s_mov_b32 m0, 0x23800
 s_mov_b32 s24, 0x66400
 buffer_load_dwordx4 v2, s[4:7], s24 offen offset:0 lds
 s_mov_b32 m0, 0x25000
 s_mov_b32 s24, 0x67c00
 buffer_load_dwordx4 v2, s[4:7], s24 offen offset:0 lds
 buffer_load_dwordx4 v2, s[4:7], s24 offen offset:1024 lds
 buffer_load_dwordx4 v2, s[4:7], s24 offen offset:2048 lds
 buffer_load_dwordx4 v2, s[4:7], s24 offen offset:3072 lds
 s_mov_b32 m0, 0x26000
 s_mov_b32 s24, 0x68c00
 buffer_load_dwordx4 v2, s[4:7], s24 offen offset:0 lds
 s_mov_b32 m0, 0xc000
 s_mov_b32 s24, 0x6a400
 buffer_load_dwordx4 v2, s[4:7], s24 offen offset:0 lds
 buffer_load_dwordx4 v2, s[4:7], s24 offen offset:1024 lds
 buffer_load_dwordx4 v2, s[4:7], s24 offen offset:2048 lds
 buffer_load_dwordx4 v2, s[4:7], s24 offen offset:3072 lds
 s_mov_b32 m0, 0xd000
 s_mov_b32 s24, 0x6b400
 buffer_load_dwordx4 v2, s[4:7], s24 offen offset:0 lds
 s_mov_b32 m0, 0xe800
 s_mov_b32 s24, 0x6cc00
 buffer_load_dwordx4 v2, s[4:7], s24 offen offset:0 lds
 buffer_load_dwordx4 v2, s[4:7], s24 offen offset:1024 lds
 buffer_load_dwordx4 v2, s[4:7], s24 offen offset:2048 lds
 buffer_load_dwordx4 v2, s[4:7], s24 offen offset:3072 lds
 s_mov_b32 m0, 0xf800
 s_mov_b32 s24, 0x6dc00
 buffer_load_dwordx4 v2, s[4:7], s24 offen offset:0 lds
 s_mov_b32 m0, 0x11000
 s_mov_b32 s24, 0x6f400
 buffer_load_dwordx4 v2, s[4:7], s24 offen offset:0 lds
 buffer_load_dwordx4 v2, s[4:7], s24 offen offset:1024 lds
 buffer_load_dwordx4 v2, s[4:7], s24 offen offset:2048 lds
 buffer_load_dwordx4 v2, s[4:7], s24 offen offset:3072 lds
 s_mov_b32 m0, 0x12000
 s_mov_b32 s24, 0x70400
 buffer_load_dwordx4 v2, s[4:7], s24 offen offset:0 lds
 s_waitcnt vmcnt(50)
 s_barrier
 s_waitcnt vmcnt(45)
 s_barrier
 s_waitcnt vmcnt(40)
 s_barrier
 s_waitcnt vmcnt(35)
 s_barrier
 s_waitcnt vmcnt(30)
 s_barrier
 s_waitcnt vmcnt(25)
 s_barrier
 s_waitcnt vmcnt(20)
 s_barrier
 s_mov_b32 m0, 0x13800
 s_mov_b32 s24, 0x71c00
 buffer_load_dwordx4 v2, s[4:7], s24 offen offset:0 lds
 buffer_load_dwordx4 v2, s[4:7], s24 offen offset:1024 lds
 buffer_load_dwordx4 v2, s[4:7], s24 offen offset:2048 lds
 buffer_load_dwordx4 v2, s[4:7], s24 offen offset:3072 lds
 s_mov_b32 m0, 0x14800
 s_mov_b32 s24, 0x72c00
 buffer_load_dwordx4 v2, s[4:7], s24 offen offset:0 lds
 s_waitcnt vmcnt(20)
 s_barrier
 s_mov_b32 m0, 0x16000
 s_mov_b32 s24, 0x74400
 buffer_load_dwordx4 v2, s[4:7], s24 offen offset:0 lds
 buffer_load_dwordx4 v2, s[4:7], s24 offen offset:1024 lds
 buffer_load_dwordx4 v2, s[4:7], s24 offen offset:2048 lds
 buffer_load_dwordx4 v2, s[4:7], s24 offen offset:3072 lds
 s_mov_b32 m0, 0x17000
 s_mov_b32 s24, 0x75400
 buffer_load_dwordx4 v2, s[4:7], s24 offen offset:0 lds
 s_waitcnt vmcnt(20)
 s_barrier
 s_mov_b32 m0, 0x18800
 s_mov_b32 s24, 0x76c00
 buffer_load_dwordx4 v2, s[4:7], s24 offen offset:0 lds
 buffer_load_dwordx4 v2, s[4:7], s24 offen offset:1024 lds
 buffer_load_dwordx4 v2, s[4:7], s24 offen offset:2048 lds
 buffer_load_dwordx4 v2, s[4:7], s24 offen offset:3072 lds
 s_mov_b32 m0, 0x19800
 s_mov_b32 s24, 0x77c00
 buffer_load_dwordx4 v2, s[4:7], s24 offen offset:0 lds
 s_waitcnt vmcnt(20)
 s_barrier
 s_mov_b32 m0, 0x1b000
 s_mov_b32 s24, 0x79400
 buffer_load_dwordx4 v2, s[4:7], s24 offen offset:0 lds
 buffer_load_dwordx4 v2, s[4:7], s24 offen offset:1024 lds
 buffer_load_dwordx4 v2, s[4:7], s24 offen offset:2048 lds
 buffer_load_dwordx4 v2, s[4:7], s24 offen offset:3072 lds
 s_mov_b32 m0, 0x1c000
 s_mov_b32 s24, 0x7a400
 buffer_load_dwordx4 v2, s[4:7], s24 offen offset:0 lds
 s_waitcnt vmcnt(20)
 s_barrier
 s_mov_b32 m0, 0x1d800
 s_mov_b32 s24, 0x7bc00
 buffer_load_dwordx4 v2, s[4:7], s24 offen offset:0 lds
 buffer_load_dwordx4 v2, s[4:7], s24 offen offset:1024 lds
 buffer_load_dwordx4 v2, s[4:7], s24 offen offset:2048 lds
 buffer_load_dwordx4 v2, s[4:7], s24 offen offset:3072 lds
 s_mov_b32 m0, 0x1e800
 s_mov_b32 s24, 0x7cc00
 buffer_load_dwordx4 v2, s[4:7], s24 offen offset:0 lds
 s_waitcnt vmcnt(20)
 s_barrier
 s_mov_b32 m0, 0x20000
 s_mov_b32 s24, 0x7e400
 buffer_load_dwordx4 v2, s[4:7], s24 offen offset:0 lds
 buffer_load_dwordx4 v2, s[4:7], s24 offen offset:1024 lds
 buffer_load_dwordx4 v2, s[4:7], s24 offen offset:2048 lds
 buffer_load_dwordx4 v2, s[4:7], s24 offen offset:3072 lds
 s_mov_b32 m0, 0x21000
 s_mov_b32 s24, 0x7f400
 buffer_load_dwordx4 v2, s[4:7], s24 offen offset:0 lds
 s_waitcnt vmcnt(20)
 s_barrier
 s_mov_b32 m0, 0x22800
 s_mov_b32 s24, 0x80c00
 buffer_load_dwordx4 v2, s[4:7], s24 offen offset:0 lds
 buffer_load_dwordx4 v2, s[4:7], s24 offen offset:1024 lds
 buffer_load_dwordx4 v2, s[4:7], s24 offen offset:2048 lds
 buffer_load_dwordx4 v2, s[4:7], s24 offen offset:3072 lds
 s_mov_b32 m0, 0x23800
 s_mov_b32 s24, 0x81c00
 buffer_load_dwordx4 v2, s[4:7], s24 offen offset:0 lds
 s_waitcnt vmcnt(20)
 s_barrier
 s_mov_b32 m0, 0x25000
 s_mov_b32 s24, 0x83400
 buffer_load_dwordx4 v2, s[4:7], s24 offen offset:0 lds
 buffer_load_dwordx4 v2, s[4:7], s24 offen offset:1024 lds
 buffer_load_dwordx4 v2, s[4:7], s24 offen offset:2048 lds
 buffer_load_dwordx4 v2, s[4:7], s24 offen offset:3072 lds
 s_mov_b32 m0, 0x26000
 s_mov_b32 s24, 0x84400
 buffer_load_dwordx4 v2, s[4:7], s24 offen offset:0 lds
 s_waitcnt vmcnt(20)
 s_barrier
 s_mov_b32 m0, 0xc000
 s_mov_b32 s24, 0x85c00
 buffer_load_dwordx4 v2, s[4:7], s24 offen offset:0 lds
 buffer_load_dwordx4 v2, s[4:7], s24 offen offset:1024 lds
 buffer_load_dwordx4 v2, s[4:7], s24 offen offset:2048 lds
 buffer_load_dwordx4 v2, s[4:7], s24 offen offset:3072 lds
 s_mov_b32 m0, 0xd000
 s_mov_b32 s24, 0x86c00
 buffer_load_dwordx4 v2, s[4:7], s24 offen offset:0 lds
 s_waitcnt vmcnt(20)
 s_barrier
 s_mov_b32 m0, 0xe800
 s_mov_b32 s24, 0x88400
 buffer_load_dwordx4 v2, s[4:7], s24 offen offset:0 lds
 buffer_load_dwordx4 v2, s[4:7], s24 offen offset:1024 lds
 buffer_load_dwordx4 v2, s[4:7], s24 offen offset:2048 lds
 buffer_load_dwordx4 v2, s[4:7], s24 offen offset:3072 lds
 s_mov_b32 m0, 0xf800
 s_mov_b32 s24, 0x89400
 buffer_load_dwordx4 v2, s[4:7], s24 offen offset:0 lds
 s_waitcnt vmcnt(20)
 s_barrier
 s_mov_b32 m0, 0x11000
 s_mov_b32 s24, 0x8ac00
 buffer_load_dwordx4 v2, s[4:7], s24 offen offset:0 lds
 buffer_load_dwordx4 v2, s[4:7], s24 offen offset:1024 lds
 buffer_load_dwordx4 v2, s[4:7], s24 offen offset:2048 lds
 buffer_load_dwordx4 v2, s[4:7], s24 offen offset:3072 lds
 s_mov_b32 m0, 0x12000
 s_mov_b32 s24, 0x8bc00
 buffer_load_dwordx4 v2, s[4:7], s24 offen offset:0 lds
 s_waitcnt vmcnt(20)
 s_barrier
 s_mov_b32 m0, 0x13800
 s_mov_b32 s24, 0x8d400
 buffer_load_dwordx4 v2, s[4:7], s24 offen offset:0 lds
 buffer_load_dwordx4 v2, s[4:7], s24 offen offset:1024 lds
 buffer_load_dwordx4 v2, s[4:7], s24 offen offset:2048 lds
 buffer_load_dwordx4 v2, s[4:7], s24 offen offset:3072 lds
 s_mov_b32 m0, 0x14800
 s_mov_b32 s24, 0x8e400
 buffer_load_dwordx4 v2, s[4:7], s24 offen offset:0 lds
 s_waitcnt vmcnt(20)
 s_barrier
 s_mov_b32 m0, 0x16000
 s_mov_b32 s24, 0x8fc00
 buffer_load_dwordx4 v2, s[4:7], s24 offen offset:0 lds
 buffer_load_dwordx4 v2, s[4:7], s24 offen offset:1024 lds
 buffer_load_dwordx4 v2, s[4:7], s24 offen offset:2048 lds
 buffer_load_dwordx4 v2, s[4:7], s24 offen offset:3072 lds
 s_mov_b32 m0, 0x17000
 s_mov_b32 s24, 0x90c00
 buffer_load_dwordx4 v2, s[4:7], s24 offen offset:0 lds
 s_waitcnt vmcnt(20)
 s_barrier
 s_waitcnt vmcnt(15)
 s_barrier
 s_mov_b32 m0, 0x1b000
 s_mov_b32 s24, 0x94c00
 buffer_load_dwordx4 v2, s[4:7], s24 offen offset:0 lds
 buffer_load_dwordx4 v2, s[4:7], s24 offen offset:1024 lds
 buffer_load_dwordx4 v2, s[4:7], s24 offen offset:2048 lds
 buffer_load_dwordx4 v2, s[4:7], s24 offen offset:3072 lds
 s_mov_b32 m0, 0x1c000
 s_mov_b32 s24, 0x95c00
 buffer_load_dwordx4 v2, s[4:7], s24 offen offset:0 lds
 buffer_load_dwordx4 v2, s[4:7], s24 offen offset:1024 lds
 buffer_load_dwordx4 v2, s[4:7], s24 offen offset:2048 lds
 buffer_load_dwordx4 v2, s[4:7], s24 offen offset:3072 lds
 s_mov_b32 m0, 0x1d000
 s_mov_b32 s24, 0x96c00
 buffer_load_dwordx4 v2, s[4:7], s24 offen offset:0 lds
 buffer_load_dwordx4 v2, s[4:7], s24 offen offset:1024 lds
 buffer_load_dwordx4 v2, s[4:7], s24 offen offset:2048 lds
 buffer_load_dwordx4 v2, s[4:7], s24 offen offset:3072 lds
 s_mov_b32 m0, 0x1e000
 s_mov_b32 s24, 0x97c00
 buffer_load_dwordx4 v2, s[4:7], s24 offen offset:0 lds
 buffer_load_dwordx4 v2, s[4:7], s24 offen offset:1024 lds
 buffer_load_dwordx4 v2, s[4:7], s24 offen offset:2048 lds
 s_waitcnt vmcnt(25)
 s_barrier
 s_mov_b32 m0, 0x22800
 s_mov_b32 s24, 0x9c400
 buffer_load_dwordx4 v2, s[4:7], s24 offen offset:0 lds
 buffer_load_dwordx4 v2, s[4:7], s24 offen offset:1024 lds
 buffer_load_dwordx4 v2, s[4:7], s24 offen offset:2048 lds
 buffer_load_dwordx4 v2, s[4:7], s24 offen offset:3072 lds
 s_mov_b32 m0, 0x23800
 s_mov_b32 s24, 0x9d400
 buffer_load_dwordx4 v2, s[4:7], s24 offen offset:0 lds
 buffer_load_dwordx4 v2, s[4:7], s24 offen offset:1024 lds
 buffer_load_dwordx4 v2, s[4:7], s24 offen offset:2048 lds
 buffer_load_dwordx4 v2, s[4:7], s24 offen offset:3072 lds
 s_mov_b32 m0, 0x24800
 s_mov_b32 s24, 0x9e400
 buffer_load_dwordx4 v2, s[4:7], s24 offen offset:0 lds
 buffer_load_dwordx4 v2, s[4:7], s24 offen offset:1024 lds
 buffer_load_dwordx4 v2, s[4:7], s24 offen offset:2048 lds
 buffer_load_dwordx4 v2, s[4:7], s24 offen offset:3072 lds
 s_mov_b32 m0, 0x25800
 s_mov_b32 s24, 0x9f400
 buffer_load_dwordx4 v2, s[4:7], s24 offen offset:0 lds
 buffer_load_dwordx4 v2, s[4:7], s24 offen offset:1024 lds
 buffer_load_dwordx4 v2, s[4:7], s24 offen offset:2048 lds
 s_waitcnt vmcnt(35)
 s_barrier
 s_waitcnt vmcnt(30)
 s_barrier
 s_barrier
 s_mov_b32 m0, 0xfc00
 s_mov_b32 s24, 0xa3c00
 buffer_load_dwordx4 v2, s[4:7], s24 offen offset:0 lds
 buffer_load_dwordx4 v2, s[4:7], s24 offen offset:1024 lds
 buffer_load_dwordx4 v2, s[4:7], s24 offen offset:2048 lds
 buffer_load_dwordx4 v2, s[4:7], s24 offen offset:3072 lds
 s_mov_b32 m0, 0x10c00
 s_mov_b32 s24, 0xa4c00
 buffer_load_dwordx4 v2, s[4:7], s24 offen offset:0 lds
 buffer_load_dwordx4 v2, s[4:7], s24 offen offset:1024 lds
 buffer_load_dwordx4 v2, s[4:7], s24 offen offset:2048 lds
 buffer_load_dwordx4 v2, s[4:7], s24 offen offset:3072 lds
 s_mov_b32 m0, 0x11c00
 s_mov_b32 s24, 0xa5c00
 buffer_load_dwordx4 v2, s[4:7], s24 offen offset:0 lds
 buffer_load_dwordx4 v2, s[4:7], s24 offen offset:1024 lds
 buffer_load_dwordx4 v2, s[4:7], s24 offen offset:2048 lds
 buffer_load_dwordx4 v2, s[4:7], s24 offen offset:3072 lds
 s_mov_b32 m0, 0x12c00
 s_mov_b32 s24, 0xa6c00
 buffer_load_dwordx4 v2, s[4:7], s24 offen offset:0 lds
 buffer_load_dwordx4 v2, s[4:7], s24 offen offset:1024 lds
 buffer_load_dwordx4 v2, s[4:7], s24 offen offset:2048 lds
 s_waitcnt vmcnt(30)
 s_barrier
 s_waitcnt vmcnt(15)
 s_barrier
 s_mov_b32 m0, 0x17400
 s_mov_b32 s24, 0xab400
 buffer_load_dwordx4 v2, s[4:7], s24 offen offset:0 lds
 buffer_load_dwordx4 v2, s[4:7], s24 offen offset:1024 lds
 buffer_load_dwordx4 v2, s[4:7], s24 offen offset:2048 lds
 buffer_load_dwordx4 v2, s[4:7], s24 offen offset:3072 lds
 s_mov_b32 m0, 0x18400
 s_mov_b32 s24, 0xac400
 buffer_load_dwordx4 v2, s[4:7], s24 offen offset:0 lds
 buffer_load_dwordx4 v2, s[4:7], s24 offen offset:1024 lds
 buffer_load_dwordx4 v2, s[4:7], s24 offen offset:2048 lds
 buffer_load_dwordx4 v2, s[4:7], s24 offen offset:3072 lds
 s_mov_b32 m0, 0x19400
 s_mov_b32 s24, 0xad400
 buffer_load_dwordx4 v2, s[4:7], s24 offen offset:0 lds
 buffer_load_dwordx4 v2, s[4:7], s24 offen offset:1024 lds
 buffer_load_dwordx4 v2, s[4:7], s24 offen offset:2048 lds
 buffer_load_dwordx4 v2, s[4:7], s24 offen offset:3072 lds
 s_mov_b32 m0, 0x1a400
 s_mov_b32 s24, 0xae400
 buffer_load_dwordx4 v2, s[4:7], s24 offen offset:0 lds
 buffer_load_dwordx4 v2, s[4:7], s24 offen offset:1024 lds
 buffer_load_dwordx4 v2, s[4:7], s24 offen offset:2048 lds
 s_waitcnt vmcnt(15)
 s_barrier
 s_mov_b32 m0, 0x1ec00
 s_mov_b32 s24, 0xb2c00
 buffer_load_dwordx4 v2, s[4:7], s24 offen offset:0 lds
 buffer_load_dwordx4 v2, s[4:7], s24 offen offset:1024 lds
 buffer_load_dwordx4 v2, s[4:7], s24 offen offset:2048 lds
 buffer_load_dwordx4 v2, s[4:7], s24 offen offset:3072 lds
 s_mov_b32 m0, 0x1fc00
 s_mov_b32 s24, 0xb3c00
 buffer_load_dwordx4 v2, s[4:7], s24 offen offset:0 lds
 buffer_load_dwordx4 v2, s[4:7], s24 offen offset:1024 lds
 buffer_load_dwordx4 v2, s[4:7], s24 offen offset:2048 lds
 buffer_load_dwordx4 v2, s[4:7], s24 offen offset:3072 lds
 s_mov_b32 m0, 0x20c00
 s_mov_b32 s24, 0xb4c00
 buffer_load_dwordx4 v2, s[4:7], s24 offen offset:0 lds
 buffer_load_dwordx4 v2, s[4:7], s24 offen offset:1024 lds
 buffer_load_dwordx4 v2, s[4:7], s24 offen offset:2048 lds
 buffer_load_dwordx4 v2, s[4:7], s24 offen offset:3072 lds
 s_mov_b32 m0, 0x21c00
 s_mov_b32 s24, 0xb5c00
 buffer_load_dwordx4 v2, s[4:7], s24 offen offset:0 lds
 buffer_load_dwordx4 v2, s[4:7], s24 offen offset:1024 lds
 buffer_load_dwordx4 v2, s[4:7], s24 offen offset:2048 lds
 s_waitcnt vmcnt(15)
 s_barrier
 s_mov_b32 m0, 0xc000
 s_mov_b32 s24, 0xba400
 buffer_load_dwordx4 v2, s[4:7], s24 offen offset:0 lds
 buffer_load_dwordx4 v2, s[4:7], s24 offen offset:1024 lds
 buffer_load_dwordx4 v2, s[4:7], s24 offen offset:2048 lds
 buffer_load_dwordx4 v2, s[4:7], s24 offen offset:3072 lds
 s_mov_b32 m0, 0xd000
 s_mov_b32 s24, 0xbb400
 buffer_load_dwordx4 v2, s[4:7], s24 offen offset:0 lds
 buffer_load_dwordx4 v2, s[4:7], s24 offen offset:1024 lds
 buffer_load_dwordx4 v2, s[4:7], s24 offen offset:2048 lds
 buffer_load_dwordx4 v2, s[4:7], s24 offen offset:3072 lds
 s_mov_b32 m0, 0xe000
 s_mov_b32 s24, 0xbc400
 buffer_load_dwordx4 v2, s[4:7], s24 offen offset:0 lds
 buffer_load_dwordx4 v2, s[4:7], s24 offen offset:1024 lds
 buffer_load_dwordx4 v2, s[4:7], s24 offen offset:2048 lds
 buffer_load_dwordx4 v2, s[4:7], s24 offen offset:3072 lds
 s_mov_b32 m0, 0xf000
 s_mov_b32 s24, 0xbd400
 buffer_load_dwordx4 v2, s[4:7], s24 offen offset:0 lds
 buffer_load_dwordx4 v2, s[4:7], s24 offen offset:1024 lds
 buffer_load_dwordx4 v2, s[4:7], s24 offen offset:2048 lds
 s_waitcnt vmcnt(15)
 s_barrier
 s_mov_b32 m0, 0x13800
 s_mov_b32 s24, 0xc1c00
 buffer_load_dwordx4 v2, s[4:7], s24 offen offset:0 lds
 buffer_load_dwordx4 v2, s[4:7], s24 offen offset:1024 lds
 buffer_load_dwordx4 v2, s[4:7], s24 offen offset:2048 lds
 buffer_load_dwordx4 v2, s[4:7], s24 offen offset:3072 lds
 s_mov_b32 m0, 0x14800
 s_mov_b32 s24, 0xc2c00
 buffer_load_dwordx4 v2, s[4:7], s24 offen offset:0 lds
 buffer_load_dwordx4 v2, s[4:7], s24 offen offset:1024 lds
 buffer_load_dwordx4 v2, s[4:7], s24 offen offset:2048 lds
 buffer_load_dwordx4 v2, s[4:7], s24 offen offset:3072 lds
 s_mov_b32 m0, 0x15800
 s_mov_b32 s24, 0xc3c00
 buffer_load_dwordx4 v2, s[4:7], s24 offen offset:0 lds
 buffer_load_dwordx4 v2, s[4:7], s24 offen offset:1024 lds
 buffer_load_dwordx4 v2, s[4:7], s24 offen offset:2048 lds
 buffer_load_dwordx4 v2, s[4:7], s24 offen offset:3072 lds
 s_mov_b32 m0, 0x16800
 s_mov_b32 s24, 0xc4c00
 buffer_load_dwordx4 v2, s[4:7], s24 offen offset:0 lds
 buffer_load_dwordx4 v2, s[4:7], s24 offen offset:1024 lds
 buffer_load_dwordx4 v2, s[4:7], s24 offen offset:2048 lds
 s_waitcnt vmcnt(15)
 s_barrier
 s_mov_b32 m0, 0x1b000
 s_mov_b32 s24, 0xc9400
 buffer_load_dwordx4 v2, s[4:7], s24 offen offset:0 lds
 buffer_load_dwordx4 v2, s[4:7], s24 offen offset:1024 lds
 buffer_load_dwordx4 v2, s[4:7], s24 offen offset:2048 lds
 buffer_load_dwordx4 v2, s[4:7], s24 offen offset:3072 lds
 s_mov_b32 m0, 0x1c000
 s_mov_b32 s24, 0xca400
 buffer_load_dwordx4 v2, s[4:7], s24 offen offset:0 lds
 buffer_load_dwordx4 v2, s[4:7], s24 offen offset:1024 lds
 buffer_load_dwordx4 v2, s[4:7], s24 offen offset:2048 lds
 buffer_load_dwordx4 v2, s[4:7], s24 offen offset:3072 lds
 s_mov_b32 m0, 0x1d000
 s_mov_b32 s24, 0xcb400
 buffer_load_dwordx4 v2, s[4:7], s24 offen offset:0 lds
 buffer_load_dwordx4 v2, s[4:7], s24 offen offset:1024 lds
 buffer_load_dwordx4 v2, s[4:7], s24 offen offset:2048 lds
 buffer_load_dwordx4 v2, s[4:7], s24 offen offset:3072 lds
 s_mov_b32 m0, 0x1e000
 s_mov_b32 s24, 0xcc400
 buffer_load_dwordx4 v2, s[4:7], s24 offen offset:0 lds
 buffer_load_dwordx4 v2, s[4:7], s24 offen offset:1024 lds
 buffer_load_dwordx4 v2, s[4:7], s24 offen offset:2048 lds
 s_waitcnt vmcnt(15)
 s_barrier
 s_mov_b32 m0, 0x22800
 s_mov_b32 s24, 0xd0c00
 buffer_load_dwordx4 v2, s[4:7], s24 offen offset:0 lds
 buffer_load_dwordx4 v2, s[4:7], s24 offen offset:1024 lds
 buffer_load_dwordx4 v2, s[4:7], s24 offen offset:2048 lds
 buffer_load_dwordx4 v2, s[4:7], s24 offen offset:3072 lds
 s_mov_b32 m0, 0x23800
 s_mov_b32 s24, 0xd1c00
 buffer_load_dwordx4 v2, s[4:7], s24 offen offset:0 lds
 buffer_load_dwordx4 v2, s[4:7], s24 offen offset:1024 lds
 buffer_load_dwordx4 v2, s[4:7], s24 offen offset:2048 lds
 buffer_load_dwordx4 v2, s[4:7], s24 offen offset:3072 lds
 s_mov_b32 m0, 0x24800
 s_mov_b32 s24, 0xd2c00
 buffer_load_dwordx4 v2, s[4:7], s24 offen offset:0 lds
 buffer_load_dwordx4 v2, s[4:7], s24 offen offset:1024 lds
 buffer_load_dwordx4 v2, s[4:7], s24 offen offset:2048 lds
 buffer_load_dwordx4 v2, s[4:7], s24 offen offset:3072 lds
 s_mov_b32 m0, 0x25800
 s_mov_b32 s24, 0xd3c00
 buffer_load_dwordx4 v2, s[4:7], s24 offen offset:0 lds
 buffer_load_dwordx4 v2, s[4:7], s24 offen offset:1024 lds
 buffer_load_dwordx4 v2, s[4:7], s24 offen offset:2048 lds
 s_waitcnt vmcnt(15)
 s_barrier
 s_mov_b32 m0, 0xfc00
 s_mov_b32 s24, 0xd8400
 buffer_load_dwordx4 v2, s[4:7], s24 offen offset:0 lds
 buffer_load_dwordx4 v2, s[4:7], s24 offen offset:1024 lds
 buffer_load_dwordx4 v2, s[4:7], s24 offen offset:2048 lds
 buffer_load_dwordx4 v2, s[4:7], s24 offen offset:3072 lds
 s_mov_b32 m0, 0x10c00
 s_mov_b32 s24, 0xd9400
 buffer_load_dwordx4 v2, s[4:7], s24 offen offset:0 lds
 buffer_load_dwordx4 v2, s[4:7], s24 offen offset:1024 lds
 buffer_load_dwordx4 v2, s[4:7], s24 offen offset:2048 lds
 buffer_load_dwordx4 v2, s[4:7], s24 offen offset:3072 lds
 s_mov_b32 m0, 0x11c00
 s_mov_b32 s24, 0xda400
 buffer_load_dwordx4 v2, s[4:7], s24 offen offset:0 lds
 buffer_load_dwordx4 v2, s[4:7], s24 offen offset:1024 lds
 buffer_load_dwordx4 v2, s[4:7], s24 offen offset:2048 lds
 buffer_load_dwordx4 v2, s[4:7], s24 offen offset:3072 lds
 s_mov_b32 m0, 0x12c00
 s_mov_b32 s24, 0xdb400
 buffer_load_dwordx4 v2, s[4:7], s24 offen offset:0 lds
 buffer_load_dwordx4 v2, s[4:7], s24 offen offset:1024 lds
 buffer_load_dwordx4 v2, s[4:7], s24 offen offset:2048 lds
 s_waitcnt vmcnt(15)
 s_barrier
 s_waitcnt vmcnt(0)
 s_barrier
 s_barrier
 s_endpgm
C1_al:
 s_waitcnt lgkmcnt(0)
 s_sub_u32 s23, s20, 6
 s_lshl_b32 s25, s23, 12
 v_lshlrev_b32 v4, 4, v1
 s_lshl_b32 s26, s21, 2
 s_lshl_b32 s27, s23, 1
 s_add_u32 s26, s26, s27
 v_and_b32 v5, 31, v1
 v_lshlrev_b32 v5, 2, v5
 s_lshl_b32 s27, s21, 7
 v_add_u32 v5, s27, v5
 v_and_b32 v6, 15, v1
 v_lshlrev_b32 v6, 2, v6
 s_lshl_b32 s27, s23, 7
 s_add_u32 s27, s27, 161792
 v_add_u32 v6, s27, v6
 s_lshl_b32 s27, s26, 10
 v_add_u32 v7, s27, v4
 s_sub_u32 s38, s20, 4
 s_lshl_b32 s59, s22, 2
 s_add_u32 s59, s59, s38
 s_lshl_b32 s58, s21, 2
 s_lshr_b32 s37, s59, 3
 s_add_u32 s58, s58, s37
 s_mul_i32 s58, s58, 61440
 s_and_b32 s37, s59, 7
 s_mul_i32 s37, s37, 2560
 s_add_u32 s58, s58, s37
 s_add_u32 s56, s4, s58
 s_addc_u32 s57, s5, 0
 s_add_u32 s56, s56, 0x117c000
 s_addc_u32 s57, s57, 0
 s_load_dword s40, s[56:57], 0
 s_load_dword s41, s[56:57], 32
 s_load_dword s42, s[56:57], 64
 s_load_dword s43, s[56:57], 96
 s_load_dword s44, s[56:57], 128
 s_load_dword s45, s[56:57], 160
 s_load_dword s46, s[56:57], 192
 s_load_dword s47, s[56:57], 224
 s_load_dword s48, s[56:57], 256
 s_load_dword s49, s[56:57], 288
 s_load_dword s50, s[56:57], 320
 s_load_dword s51, s[56:57], 352
 s_load_dword s52, s[56:57], 384
 s_load_dword s53, s[56:57], 416
 s_waitcnt lgkmcnt(0)
 s_load_dword s40, s[56:57], 448
 s_load_dword s41, s[56:57], 480
 s_load_dword s42, s[56:57], 512
 s_load_dword s43, s[56:57], 544
 s_load_dword s44, s[56:57], 576
 s_load_dword s45, s[56:57], 608
 s_load_dword s46, s[56:57], 640
 s_load_dword s47, s[56:57], 672
 s_load_dword s48, s[56:57], 704
 s_load_dword s49, s[56:57], 736
 s_load_dword s50, s[56:57], 768
 s_load_dword s51, s[56:57], 800
 s_load_dword s52, s[56:57], 832
 s_load_dword s53, s[56:57], 864
 s_waitcnt lgkmcnt(0)
 s_load_dword s40, s[56:57], 896
 s_load_dword s41, s[56:57], 928
 s_load_dword s42, s[56:57], 960
 s_load_dword s43, s[56:57], 992
 s_load_dword s44, s[56:57], 1024
 s_load_dword s45, s[56:57], 1056
 s_load_dword s46, s[56:57], 1088
 s_load_dword s47, s[56:57], 1120
 s_load_dword s48, s[56:57], 1152
 s_load_dword s49, s[56:57], 1184
 s_load_dword s50, s[56:57], 1216
 s_load_dword s51, s[56:57], 1248
 s_load_dword s52, s[56:57], 1280
 s_load_dword s53, s[56:57], 1312
 s_waitcnt lgkmcnt(0)
 s_load_dword s40, s[56:57], 1344
 s_load_dword s41, s[56:57], 1376
 s_load_dword s42, s[56:57], 1408
 s_load_dword s43, s[56:57], 1440
 s_load_dword s44, s[56:57], 1472
 s_load_dword s45, s[56:57], 1504
 s_load_dword s46, s[56:57], 1536
 s_load_dword s47, s[56:57], 1568
 s_load_dword s48, s[56:57], 1600
 s_load_dword s49, s[56:57], 1632
 s_load_dword s50, s[56:57], 1664
 s_load_dword s51, s[56:57], 1696
 s_load_dword s52, s[56:57], 1728
 s_load_dword s53, s[56:57], 1760
 s_waitcnt lgkmcnt(0)
 s_load_dword s40, s[56:57], 1792
 s_load_dword s41, s[56:57], 1824
 s_load_dword s42, s[56:57], 1856
 s_load_dword s43, s[56:57], 1888
 s_load_dword s44, s[56:57], 1920
 s_load_dword s45, s[56:57], 1952
 s_load_dword s46, s[56:57], 1984
 s_load_dword s47, s[56:57], 2016
 s_load_dword s48, s[56:57], 2048
 s_load_dword s49, s[56:57], 2080
 s_load_dword s50, s[56:57], 2112
 s_load_dword s51, s[56:57], 2144
 s_load_dword s52, s[56:57], 2176
 s_load_dword s53, s[56:57], 2208
 s_waitcnt lgkmcnt(0)
 s_load_dword s40, s[56:57], 2240
 s_load_dword s41, s[56:57], 2272
 s_load_dword s42, s[56:57], 2304
 s_load_dword s43, s[56:57], 2336
 s_load_dword s44, s[56:57], 2368
 s_load_dword s45, s[56:57], 2400
 s_load_dword s46, s[56:57], 2432
 s_load_dword s47, s[56:57], 2464
 s_load_dword s48, s[56:57], 2496
 s_load_dword s49, s[56:57], 2528
 s_lshl_b32 s58, s2, 2
 s_add_u32 s58, s58, s38
 s_mul_i32 s58, s58, 7040
 s_add_u32 s56, s4, s58
 s_addc_u32 s57, s5, 0
 s_load_dword s50, s[56:57], 0
 s_load_dword s51, s[56:57], 32
 s_load_dword s52, s[56:57], 64
 s_load_dword s53, s[56:57], 96
 s_waitcnt lgkmcnt(0)
 s_load_dword s40, s[56:57], 128
 s_load_dword s41, s[56:57], 160
 s_load_dword s42, s[56:57], 192
 s_load_dword s43, s[56:57], 224
 s_load_dword s44, s[56:57], 256
 s_load_dword s45, s[56:57], 288
 s_load_dword s46, s[56:57], 320
 s_load_dword s47, s[56:57], 352
 s_load_dword s48, s[56:57], 384
 s_load_dword s49, s[56:57], 416
 s_load_dword s50, s[56:57], 448
 s_load_dword s51, s[56:57], 480
 s_load_dword s52, s[56:57], 512
 s_load_dword s53, s[56:57], 544
 s_waitcnt lgkmcnt(0)
 s_load_dword s40, s[56:57], 576
 s_load_dword s41, s[56:57], 608
 s_load_dword s42, s[56:57], 640
 s_load_dword s43, s[56:57], 672
 s_load_dword s44, s[56:57], 704
 s_load_dword s45, s[56:57], 736
 s_load_dword s46, s[56:57], 768
 s_load_dword s47, s[56:57], 800
 s_load_dword s48, s[56:57], 832
 s_load_dword s49, s[56:57], 864
 s_load_dword s50, s[56:57], 896
 s_load_dword s51, s[56:57], 928
 s_load_dword s52, s[56:57], 960
 s_load_dword s53, s[56:57], 992
 s_waitcnt lgkmcnt(0)
 s_load_dword s40, s[56:57], 1024
 s_load_dword s41, s[56:57], 1056
 s_load_dword s42, s[56:57], 1088
 s_load_dword s43, s[56:57], 1120
 s_load_dword s44, s[56:57], 1152
 s_load_dword s45, s[56:57], 1184
 s_load_dword s46, s[56:57], 1216
 s_load_dword s47, s[56:57], 1248
 s_load_dword s48, s[56:57], 1280
 s_load_dword s49, s[56:57], 1312
 s_load_dword s50, s[56:57], 1344
 s_load_dword s51, s[56:57], 1376
 s_load_dword s52, s[56:57], 1408
 s_load_dword s53, s[56:57], 1440
 s_waitcnt lgkmcnt(0)
 s_load_dword s40, s[56:57], 1472
 s_load_dword s41, s[56:57], 1504
 s_load_dword s42, s[56:57], 1536
 s_load_dword s43, s[56:57], 1568
 s_load_dword s44, s[56:57], 1600
 s_load_dword s45, s[56:57], 1632
 s_load_dword s46, s[56:57], 1664
 s_load_dword s47, s[56:57], 1696
 s_load_dword s48, s[56:57], 1728
 s_load_dword s49, s[56:57], 1760
 s_load_dword s50, s[56:57], 1792
 s_load_dword s51, s[56:57], 1824
 s_load_dword s52, s[56:57], 1856
 s_load_dword s53, s[56:57], 1888
 s_waitcnt lgkmcnt(0)
 s_load_dword s40, s[56:57], 1920
 s_load_dword s41, s[56:57], 1952
 s_load_dword s42, s[56:57], 1984
 s_load_dword s43, s[56:57], 2016
 s_load_dword s44, s[56:57], 2048
 s_load_dword s45, s[56:57], 2080
 s_load_dword s46, s[56:57], 2112
 s_load_dword s47, s[56:57], 2144
 s_load_dword s48, s[56:57], 2176
 s_load_dword s49, s[56:57], 2208
 s_load_dword s50, s[56:57], 2240
 s_load_dword s51, s[56:57], 2272
 s_load_dword s52, s[56:57], 2304
 s_load_dword s53, s[56:57], 2336
 s_waitcnt lgkmcnt(0)
 s_load_dword s40, s[56:57], 2368
 s_load_dword s41, s[56:57], 2400
 s_load_dword s42, s[56:57], 2432
 s_load_dword s43, s[56:57], 2464
 s_load_dword s44, s[56:57], 2496
 s_load_dword s45, s[56:57], 2528
 s_load_dword s46, s[56:57], 2560
 s_load_dword s47, s[56:57], 2592
 s_load_dword s48, s[56:57], 2624
 s_load_dword s49, s[56:57], 2656
 s_load_dword s50, s[56:57], 2688
 s_load_dword s51, s[56:57], 2720
 s_load_dword s52, s[56:57], 2752
 s_load_dword s53, s[56:57], 2784
 s_waitcnt lgkmcnt(0)
 s_load_dword s40, s[56:57], 2816
 s_load_dword s41, s[56:57], 2848
 s_load_dword s42, s[56:57], 2880
 s_load_dword s43, s[56:57], 2912
 s_load_dword s44, s[56:57], 2944
 s_load_dword s45, s[56:57], 2976
 s_load_dword s46, s[56:57], 3008
 s_load_dword s47, s[56:57], 3040
 s_load_dword s48, s[56:57], 3072
 s_load_dword s49, s[56:57], 3104
 s_load_dword s50, s[56:57], 3136
 s_load_dword s51, s[56:57], 3168
 s_load_dword s52, s[56:57], 3200
 s_load_dword s53, s[56:57], 3232
 s_waitcnt lgkmcnt(0)
 s_load_dword s40, s[56:57], 3264
 s_load_dword s41, s[56:57], 3296
 s_load_dword s42, s[56:57], 3328
 s_load_dword s43, s[56:57], 3360
 s_load_dword s44, s[56:57], 3392
 s_load_dword s45, s[56:57], 3424
 s_load_dword s46, s[56:57], 3456
 s_load_dword s47, s[56:57], 3488
 s_load_dword s48, s[56:57], 3520
 s_load_dword s49, s[56:57], 3552
 s_load_dword s50, s[56:57], 3584
 s_load_dword s51, s[56:57], 3616
 s_load_dword s52, s[56:57], 3648
 s_load_dword s53, s[56:57], 3680
 s_waitcnt lgkmcnt(0)
 s_load_dword s40, s[56:57], 3712
 s_load_dword s41, s[56:57], 3744
 s_load_dword s42, s[56:57], 3776
 s_load_dword s43, s[56:57], 3808
 s_load_dword s44, s[56:57], 3840
 s_load_dword s45, s[56:57], 3872
 s_load_dword s46, s[56:57], 3904
 s_load_dword s47, s[56:57], 3936
 s_load_dword s48, s[56:57], 3968
 s_load_dword s49, s[56:57], 4000
 s_load_dword s50, s[56:57], 4032
 s_load_dword s51, s[56:57], 4064
 s_load_dword s52, s[56:57], 4096
 s_load_dword s53, s[56:57], 4128
 s_waitcnt lgkmcnt(0)
 s_load_dword s40, s[56:57], 4160
 s_load_dword s41, s[56:57], 4192
 s_load_dword s42, s[56:57], 4224
 s_load_dword s43, s[56:57], 4256
 s_load_dword s44, s[56:57], 4288
 s_load_dword s45, s[56:57], 4320
 s_load_dword s46, s[56:57], 4352
 s_load_dword s47, s[56:57], 4384
 s_load_dword s48, s[56:57], 4416
 s_load_dword s49, s[56:57], 4448
 s_load_dword s50, s[56:57], 4480
 s_load_dword s51, s[56:57], 4512
 s_load_dword s52, s[56:57], 4544
 s_load_dword s53, s[56:57], 4576
 s_waitcnt lgkmcnt(0)
 s_load_dword s40, s[56:57], 4608
 s_load_dword s41, s[56:57], 4640
 s_load_dword s42, s[56:57], 4672
 s_load_dword s43, s[56:57], 4704
 s_load_dword s44, s[56:57], 4736
 s_load_dword s45, s[56:57], 4768
 s_load_dword s46, s[56:57], 4800
 s_load_dword s47, s[56:57], 4832
 s_load_dword s48, s[56:57], 4864
 s_load_dword s49, s[56:57], 4896
 s_load_dword s50, s[56:57], 4928
 s_load_dword s51, s[56:57], 4960
 s_load_dword s52, s[56:57], 4992
 s_load_dword s53, s[56:57], 5024
 s_waitcnt lgkmcnt(0)
 s_load_dword s40, s[56:57], 5056
 s_load_dword s41, s[56:57], 5088
 s_load_dword s42, s[56:57], 5120
 s_load_dword s43, s[56:57], 5152
 s_load_dword s44, s[56:57], 5184
 s_load_dword s45, s[56:57], 5216
 s_load_dword s46, s[56:57], 5248
 s_load_dword s47, s[56:57], 5280
 s_load_dword s48, s[56:57], 5312
 s_load_dword s49, s[56:57], 5344
 s_load_dword s50, s[56:57], 5376
 s_load_dword s51, s[56:57], 5408
 s_load_dword s52, s[56:57], 5440
 s_load_dword s53, s[56:57], 5472
 s_waitcnt lgkmcnt(0)
 s_load_dword s40, s[56:57], 5504
 s_load_dword s41, s[56:57], 5536
 s_load_dword s42, s[56:57], 5568
 s_load_dword s43, s[56:57], 5600
 s_load_dword s44, s[56:57], 5632
 s_load_dword s45, s[56:57], 5664
 s_load_dword s46, s[56:57], 5696
 s_load_dword s47, s[56:57], 5728
 s_load_dword s48, s[56:57], 5760
 s_load_dword s49, s[56:57], 5792
 s_load_dword s50, s[56:57], 5824
 s_load_dword s51, s[56:57], 5856
 s_load_dword s52, s[56:57], 5888
 s_load_dword s53, s[56:57], 5920
 s_waitcnt lgkmcnt(0)
 s_load_dword s40, s[56:57], 5952
 s_load_dword s41, s[56:57], 5984
 s_load_dword s42, s[56:57], 6016
 s_load_dword s43, s[56:57], 6048
 s_load_dword s44, s[56:57], 6080
 s_load_dword s45, s[56:57], 6112
 s_load_dword s46, s[56:57], 6144
 s_load_dword s47, s[56:57], 6176
 s_load_dword s48, s[56:57], 6208
 s_load_dword s49, s[56:57], 6240
 s_load_dword s50, s[56:57], 6272
 s_load_dword s51, s[56:57], 6304
 s_load_dword s52, s[56:57], 6336
 s_load_dword s53, s[56:57], 6368
 s_waitcnt lgkmcnt(0)
 s_load_dword s40, s[56:57], 6400
 s_load_dword s41, s[56:57], 6432
 s_load_dword s42, s[56:57], 6464
 s_load_dword s43, s[56:57], 6496
 s_load_dword s44, s[56:57], 6528
 s_load_dword s45, s[56:57], 6560
 s_load_dword s46, s[56:57], 6592
 s_load_dword s47, s[56:57], 6624
 s_load_dword s48, s[56:57], 6656
 s_load_dword s49, s[56:57], 6688
 s_load_dword s50, s[56:57], 6720
 s_load_dword s51, s[56:57], 6752
 s_load_dword s52, s[56:57], 6784
 s_load_dword s53, s[56:57], 6816
 s_waitcnt lgkmcnt(0)
 s_load_dword s40, s[56:57], 6848
 s_load_dword s41, s[56:57], 6880
 s_load_dword s42, s[56:57], 6912
 s_load_dword s43, s[56:57], 6944
 s_load_dword s44, s[56:57], 6976
 s_load_dword s45, s[56:57], 7008
 s_mul_i32 s58, s21, 81920
 s_mul_i32 s37, s59, 2560
 s_add_u32 s58, s58, s37
 s_add_u32 s56, s4, s58
 s_addc_u32 s57, s5, 0
 s_add_u32 s56, s56, 0xbf2000
 s_addc_u32 s57, s57, 0
 s_load_dword s46, s[56:57], 0
 s_load_dword s47, s[56:57], 32
 s_load_dword s48, s[56:57], 64
 s_load_dword s49, s[56:57], 96
 s_load_dword s50, s[56:57], 128
 s_load_dword s51, s[56:57], 160
 s_load_dword s52, s[56:57], 192
 s_load_dword s53, s[56:57], 224
 s_waitcnt lgkmcnt(0)
 s_load_dword s40, s[56:57], 256
 s_load_dword s41, s[56:57], 288
 s_load_dword s42, s[56:57], 320
 s_load_dword s43, s[56:57], 352
 s_load_dword s44, s[56:57], 384
 s_load_dword s45, s[56:57], 416
 s_load_dword s46, s[56:57], 448
 s_load_dword s47, s[56:57], 480
 s_load_dword s48, s[56:57], 512
 s_load_dword s49, s[56:57], 544
 s_load_dword s50, s[56:57], 576
 s_load_dword s51, s[56:57], 608
 s_load_dword s52, s[56:57], 640
 s_load_dword s53, s[56:57], 672
 s_waitcnt lgkmcnt(0)
 s_load_dword s40, s[56:57], 704
 s_load_dword s41, s[56:57], 736
 s_load_dword s42, s[56:57], 768
 s_load_dword s43, s[56:57], 800
 s_load_dword s44, s[56:57], 832
 s_load_dword s45, s[56:57], 864
 s_load_dword s46, s[56:57], 896
 s_load_dword s47, s[56:57], 928
 s_load_dword s48, s[56:57], 960
 s_load_dword s49, s[56:57], 992
 s_load_dword s50, s[56:57], 1024
 s_load_dword s51, s[56:57], 1056
 s_load_dword s52, s[56:57], 1088
 s_load_dword s53, s[56:57], 1120
 s_waitcnt lgkmcnt(0)
 s_load_dword s40, s[56:57], 1152
 s_load_dword s41, s[56:57], 1184
 s_load_dword s42, s[56:57], 1216
 s_load_dword s43, s[56:57], 1248
 s_load_dword s44, s[56:57], 1280
 s_load_dword s45, s[56:57], 1312
 s_load_dword s46, s[56:57], 1344
 s_load_dword s47, s[56:57], 1376
 s_load_dword s48, s[56:57], 1408
 s_load_dword s49, s[56:57], 1440
 s_load_dword s50, s[56:57], 1472
 s_load_dword s51, s[56:57], 1504
 s_load_dword s52, s[56:57], 1536
 s_load_dword s53, s[56:57], 1568
 s_waitcnt lgkmcnt(0)
 s_load_dword s40, s[56:57], 1600
 s_load_dword s41, s[56:57], 1632
 s_load_dword s42, s[56:57], 1664
 s_load_dword s43, s[56:57], 1696
 s_load_dword s44, s[56:57], 1728
 s_load_dword s45, s[56:57], 1760
 s_load_dword s46, s[56:57], 1792
 s_load_dword s47, s[56:57], 1824
 s_load_dword s48, s[56:57], 1856
 s_load_dword s49, s[56:57], 1888
 s_load_dword s50, s[56:57], 1920
 s_load_dword s51, s[56:57], 1952
 s_load_dword s52, s[56:57], 1984
 s_load_dword s53, s[56:57], 2016
 s_waitcnt lgkmcnt(0)
 s_load_dword s40, s[56:57], 2048
 s_load_dword s41, s[56:57], 2080
 s_load_dword s42, s[56:57], 2112
 s_load_dword s43, s[56:57], 2144
 s_load_dword s44, s[56:57], 2176
 s_load_dword s45, s[56:57], 2208
 s_load_dword s46, s[56:57], 2240
 s_load_dword s47, s[56:57], 2272
 s_load_dword s48, s[56:57], 2304
 s_load_dword s49, s[56:57], 2336
 s_load_dword s50, s[56:57], 2368
 s_load_dword s51, s[56:57], 2400
 s_load_dword s52, s[56:57], 2432
 s_load_dword s53, s[56:57], 2464
 s_waitcnt lgkmcnt(0)
 s_load_dword s40, s[56:57], 2496
 s_load_dword s41, s[56:57], 2528
 s_lshl_b32 s58, s21, 12
 s_lshl_b32 s37, s59, 7
 s_add_u32 s58, s58, s37
 s_add_u32 s56, s4, s58
 s_addc_u32 s57, s5, 0
 s_add_u32 s56, s56, 0x1112000
 s_addc_u32 s57, s57, 0
 s_load_dword s42, s[56:57], 0
 s_load_dword s43, s[56:57], 32
 s_load_dword s44, s[56:57], 64
 s_load_dword s45, s[56:57], 96
 s_add_u32 s56, s4, s58
 s_addc_u32 s57, s5, 0
 s_add_u32 s56, s56, 0x1132000
 s_addc_u32 s57, s57, 0
 s_load_dword s46, s[56:57], 0
 s_load_dword s47, s[56:57], 32
 s_load_dword s48, s[56:57], 64
 s_load_dword s49, s[56:57], 96
 s_lshl_b32 s58, s2, 2
 s_add_u32 s58, s58, s38
 s_getpc_b64 s[56:57]
C1_pc5:
 s_add_u32 s56, s56, C2_start-C1_pc5
 s_addc_u32 s57, s57, 0
 s_mul_i32 s58, s58, 32
 s_add_u32 s37, s58, 0
 s_min_u32 s37, s37, C2_end-C2_start
 s_load_dword s50, s[56:57], s37
 s_add_u32 s37, s58, 32768
 s_min_u32 s37, s37, C2_end-C2_start
 s_load_dword s51, s[56:57], s37
 s_lshr_b32 s58, s2, 3
 s_lshl_b32 s58, s58, 2
 s_add_u32 s58, s58, s38
 s_getpc_b64 s[56:57]
C1_pc6:
 s_sub_u32 s56, s56, C1_pc6-C1_start
 s_subb_u32 s57, s57, 0
 s_mul_i32 s58, s58, 32
 s_add_u32 s37, s58, 0
 s_min_u32 s37, s37, C1_end-C1_start
 s_load_dword s52, s[56:57], s37
 s_add_u32 s37, s58, 4096
 s_min_u32 s37, s37, C1_end-C1_start
 s_load_dword s53, s[56:57], s37
 s_waitcnt lgkmcnt(0)
 s_add_u32 s37, s58, 8192
 s_min_u32 s37, s37, C1_end-C1_start
 s_load_dword s40, s[56:57], s37
 s_add_u32 s37, s58, 12288
 s_min_u32 s37, s37, C1_end-C1_start
 s_load_dword s41, s[56:57], s37
 s_add_u32 s37, s58, 16384
 s_min_u32 s37, s37, C1_end-C1_start
 s_load_dword s42, s[56:57], s37
 s_add_u32 s37, s58, 20480
 s_min_u32 s37, s37, C1_end-C1_start
 s_load_dword s43, s[56:57], s37
 s_add_u32 s37, s58, 24576
 s_min_u32 s37, s37, C1_end-C1_start
 s_load_dword s44, s[56:57], s37
 s_add_u32 s37, s58, 28672
 s_min_u32 s37, s37, C1_end-C1_start
 s_load_dword s45, s[56:57], s37
 s_add_u32 s37, s58, 32768
 s_min_u32 s37, s37, C1_end-C1_start
 s_load_dword s46, s[56:57], s37
 s_add_u32 s37, s58, 36864
 s_min_u32 s37, s37, C1_end-C1_start
 s_load_dword s47, s[56:57], s37
 s_add_u32 s37, s58, 40960
 s_min_u32 s37, s37, C1_end-C1_start
 s_load_dword s48, s[56:57], s37
 s_add_u32 s37, s58, 45056
 s_min_u32 s37, s37, C1_end-C1_start
 s_load_dword s49, s[56:57], s37
 s_add_u32 s37, s58, 49152
 s_min_u32 s37, s37, C1_end-C1_start
 s_load_dword s50, s[56:57], s37
 s_add_u32 s37, s58, 53248
 s_min_u32 s37, s37, C1_end-C1_start
 s_load_dword s51, s[56:57], s37
 s_add_u32 s37, s58, 57344
 s_min_u32 s37, s37, C1_end-C1_start
 s_load_dword s52, s[56:57], s37
 s_add_u32 s37, s58, 61440
 s_min_u32 s37, s37, C1_end-C1_start
 s_load_dword s53, s[56:57], s37
 s_waitcnt lgkmcnt(0)
 s_waitcnt lgkmcnt(0)
 s_barrier
 s_mul_i32 s27, s26, 61440
 v_add_u32 v2, s27, v4
 v_add_u32 v3, 59392, v2
 s_mov_b32 s28, 0x6ee000
 s_mov_b32 s29, 20000
C1_poll0:
 buffer_load_dword v8, v5, s[4:7], s28 offen sc1
 s_sub_u32 s29, s29, 1
 s_waitcnt vmcnt(0)
 v_cmp_ne_u32 vcc, 1, v8
 s_cmp_eq_u32 s29, 0
 s_cbranch_scc1 C1_pollx0
 s_nop 1
 s_cbranch_vccnz C1_poll0
C1_pollx0:
 s_add_u32 m0, s25, 0x0
 s_mov_b32 s28, 0x117c000
 buffer_load_dwordx4 v2, s[4:7], s28 offen offset:0 sc1 lds
 buffer_load_dwordx4 v2, s[4:7], s28 offen offset:1024 sc1 lds
 buffer_load_dwordx4 v3, s[4:7], s28 offen offset:2048 sc1 lds
 buffer_load_dwordx4 v3, s[4:7], s28 offen offset:3072 sc1 lds
 s_add_u32 m0, s25, 0x2000
 s_mov_b32 s28, 0x117c800
 buffer_load_dwordx4 v2, s[4:7], s28 offen offset:0 sc1 lds
 buffer_load_dwordx4 v2, s[4:7], s28 offen offset:1024 sc1 lds
 buffer_load_dwordx4 v3, s[4:7], s28 offen offset:2048 sc1 lds
 buffer_load_dwordx4 v3, s[4:7], s28 offen offset:3072 sc1 lds
 s_add_u32 m0, s25, 0x4000
 s_mov_b32 s28, 0x117d000
 buffer_load_dwordx4 v2, s[4:7], s28 offen offset:0 sc1 lds
 buffer_load_dwordx4 v2, s[4:7], s28 offen offset:1024 sc1 lds
 buffer_load_dwordx4 v3, s[4:7], s28 offen offset:2048 sc1 lds
 buffer_load_dwordx4 v3, s[4:7], s28 offen offset:3072 sc1 lds
 s_add_u32 m0, s25, 0x6000
 s_mov_b32 s28, 0x117d800
 buffer_load_dwordx4 v2, s[4:7], s28 offen offset:0 sc1 lds
 buffer_load_dwordx4 v2, s[4:7], s28 offen offset:1024 sc1 lds
 buffer_load_dwordx4 v3, s[4:7], s28 offen offset:2048 sc1 lds
 buffer_load_dwordx4 v3, s[4:7], s28 offen offset:3072 sc1 lds
 s_add_u32 m0, s25, 0x8000
 s_mov_b32 s28, 0x117e000
 buffer_load_dwordx4 v2, s[4:7], s28 offen offset:0 sc1 lds
 buffer_load_dwordx4 v2, s[4:7], s28 offen offset:1024 sc1 lds
 buffer_load_dwordx4 v3, s[4:7], s28 offen offset:2048 sc1 lds
 buffer_load_dwordx4 v3, s[4:7], s28 offen offset:3072 sc1 lds
 s_add_u32 m0, s25, 0xa000
 s_mov_b32 s28, 0x117e800
 buffer_load_dwordx4 v2, s[4:7], s28 offen offset:0 sc1 lds
 buffer_load_dwordx4 v2, s[4:7], s28 offen offset:1024 sc1 lds
 buffer_load_dwordx4 v3, s[4:7], s28 offen offset:2048 sc1 lds
 buffer_load_dwordx4 v3, s[4:7], s28 offen offset:3072 sc1 lds
 s_waitcnt vmcnt(20)
 s_barrier
 s_waitcnt vmcnt(16)
 s_barrier
 s_waitcnt vmcnt(12)
 s_barrier
 s_add_u32 m0, s25, 0x0
 s_mov_b32 s28, 0x117f000
 buffer_load_dwordx4 v2, s[4:7], s28 offen offset:0 sc1 lds
 buffer_load_dwordx4 v2, s[4:7], s28 offen offset:1024 sc1 lds
 buffer_load_dwordx4 v3, s[4:7], s28 offen offset:2048 sc1 lds
 buffer_load_dwordx4 v3, s[4:7], s28 offen offset:3072 sc1 lds
 s_waitcnt vmcnt(12)
 s_barrier
 s_add_u32 m0, s25, 0x2000
 s_mov_b32 s28, 0x117f800
 buffer_load_dwordx4 v2, s[4:7], s28 offen offset:0 sc1 lds
 buffer_load_dwordx4 v2, s[4:7], s28 offen offset:1024 sc1 lds
 buffer_load_dwordx4 v3, s[4:7], s28 offen offset:2048 sc1 lds
 buffer_load_dwordx4 v3, s[4:7], s28 offen offset:3072 sc1 lds
 s_waitcnt vmcnt(12)
 s_barrier
 s_add_u32 m0, s25, 0x4000
 s_mov_b32 s28, 0x1180000
 buffer_load_dwordx4 v2, s[4:7], s28 offen offset:0 sc1 lds
 buffer_load_dwordx4 v2, s[4:7], s28 offen offset:1024 sc1 lds
 buffer_load_dwordx4 v3, s[4:7], s28 offen offset:2048 sc1 lds
 buffer_load_dwordx4 v3, s[4:7], s28 offen offset:3072 sc1 lds
 s_waitcnt vmcnt(12)
 s_barrier
 s_add_u32 m0, s25, 0x6000
 s_mov_b32 s28, 0x1180800
 buffer_load_dwordx4 v2, s[4:7], s28 offen offset:0 sc1 lds
 buffer_load_dwordx4 v2, s[4:7], s28 offen offset:1024 sc1 lds
 buffer_load_dwordx4 v3, s[4:7], s28 offen offset:2048 sc1 lds
 buffer_load_dwordx4 v3, s[4:7], s28 offen offset:3072 sc1 lds
 s_waitcnt vmcnt(12)
 s_barrier
 s_waitcnt vmcnt(8)
 s_barrier
 s_waitcnt vmcnt(4)
 s_barrier
 s_waitcnt vmcnt(0)
 s_barrier
 s_barrier
 s_mul_i32 s27, s26, 20480
 v_add_u32 v2, s27, v4
 v_add_u32 v3, 18432, v2
 s_mov_b32 s28, 0x6e8000
 s_mov_b32 s29, 20000
 v_lshlrev_b32 v20, 5, v1
 s_lshl_b32 s30, s23, 11
 s_add_u32 s30, s30, 0x6f0000
C1_poll1:
 buffer_load_dword v8, v5, s[4:7], s28 offen sc1
 buffer_load_dwordx4 v[12:15], v20, s[4:7], s30 offen sc1
 buffer_load_dwordx4 v[16:19], v20, s[4:7], s30 offen offset:16 sc1
 s_sub_u32 s29, s29, 1
 s_waitcnt vmcnt(0)
 v_and_b32 v8, v8, v12
 v_and_b32 v8, v8, v13
 v_and_b32 v8, v8, v14
 v_and_b32 v8, v8, v15
 v_and_b32 v8, v8, v16
 v_and_b32 v8, v8, v17
 v_and_b32 v8, v8, v18
 v_and_b32 v8, v8, v19
 v_cmp_ne_u32 vcc, 1, v8
 s_cmp_eq_u32 s29, 0
 s_cbranch_scc1 C1_pollx1
 s_nop 1
 s_cbranch_vccnz C1_poll1
C1_pollx1:
 s_mov_b32 s28, 0x1112000
 buffer_load_dwordx4 v[8:11], v7, s[4:7], s28 offen sc1
 buffer_load_dwordx4 v[12:15], v7, s[4:7], s28 offen offset:1024 sc1
 s_add_u32 m0, s25, 0x0
 s_mov_b32 s28, 0xbf2000
 buffer_load_dwordx4 v2, s[4:7], s28 offen offset:0 sc1 lds
 buffer_load_dwordx4 v2, s[4:7], s28 offen offset:1024 sc1 lds
 buffer_load_dwordx4 v3, s[4:7], s28 offen offset:2048 sc1 lds
 buffer_load_dwordx4 v3, s[4:7], s28 offen offset:3072 sc1 lds
 s_add_u32 m0, s25, 0x2000
 s_mov_b32 s28, 0xbf2800
 buffer_load_dwordx4 v2, s[4:7], s28 offen offset:0 sc1 lds
 buffer_load_dwordx4 v2, s[4:7], s28 offen offset:1024 sc1 lds
 buffer_load_dwordx4 v3, s[4:7], s28 offen offset:2048 sc1 lds
 buffer_load_dwordx4 v3, s[4:7], s28 offen offset:3072 sc1 lds
 s_add_u32 m0, s25, 0x4000
 s_mov_b32 s28, 0xbf3000
 buffer_load_dwordx4 v2, s[4:7], s28 offen offset:0 sc1 lds
 buffer_load_dwordx4 v2, s[4:7], s28 offen offset:1024 sc1 lds
 buffer_load_dwordx4 v3, s[4:7], s28 offen offset:2048 sc1 lds
 buffer_load_dwordx4 v3, s[4:7], s28 offen offset:3072 sc1 lds
 s_add_u32 m0, s25, 0x6000
 s_mov_b32 s28, 0xbf3800
 buffer_load_dwordx4 v2, s[4:7], s28 offen offset:0 sc1 lds
 buffer_load_dwordx4 v2, s[4:7], s28 offen offset:1024 sc1 lds
 buffer_load_dwordx4 v3, s[4:7], s28 offen offset:2048 sc1 lds
 buffer_load_dwordx4 v3, s[4:7], s28 offen offset:3072 sc1 lds
 s_add_u32 m0, s25, 0x8000
 s_mov_b32 s28, 0xbf4000
 buffer_load_dwordx4 v2, s[4:7], s28 offen offset:0 sc1 lds
 buffer_load_dwordx4 v2, s[4:7], s28 offen offset:1024 sc1 lds
 buffer_load_dwordx4 v3, s[4:7], s28 offen offset:2048 sc1 lds
 buffer_load_dwordx4 v3, s[4:7], s28 offen offset:3072 sc1 lds
 s_add_u32 m0, s25, 0xa000
 s_mov_b32 s28, 0xbf4800
 buffer_load_dwordx4 v2, s[4:7], s28 offen offset:0 sc1 lds
 buffer_load_dwordx4 v2, s[4:7], s28 offen offset:1024 sc1 lds
 buffer_load_dwordx4 v3, s[4:7], s28 offen offset:2048 sc1 lds
 buffer_load_dwordx4 v3, s[4:7], s28 offen offset:3072 sc1 lds
 s_waitcnt vmcnt(20)
 s_barrier
 v_add_f32 v8, v8, v10
 v_add_f32 v9, v9, v11
 v_add_f32 v12, v12, v14
 v_add_f32 v13, v13, v15
 v_mov_b32 v16, v8
 v_mov_b32 v17, v9
 v_mov_b32 v20, v12
 v_mov_b32 v21, v13
 v_permlane16_swap_b32 v8, v16
 v_permlane16_swap_b32 v9, v17
 v_permlane16_swap_b32 v12, v20
 v_permlane16_swap_b32 v13, v21
 v_add_f32 v8, v8, v16
 v_add_f32 v9, v9, v17
 v_add_f32 v12, v12, v20
 v_add_f32 v13, v13, v21
 v_mov_b32 v16, v8
 v_mov_b32 v17, v9
 v_mov_b32 v20, v12
 v_mov_b32 v21, v13
 v_permlane32_swap_b32 v8, v16
 v_permlane32_swap_b32 v9, v17
 v_permlane32_swap_b32 v12, v20
 v_permlane32_swap_b32 v13, v21
 v_add_f32 v8, v8, v16
 v_add_f32 v9, v9, v17
 v_add_f32 v12, v12, v20
 v_add_f32 v13, v13, v21
 v_mul_f32 v8, 0x3acccccd, v8
 v_mul_f32 v9, 0x3acccccd, v9
 v_mul_f32 v12, 0x3acccccd, v12
 v_mul_f32 v13, 0x3acccccd, v13
 v_fma_f32 v9, -v8, v8, v9
 v_fma_f32 v13, -v12, v12, v13
 v_max_f32 v9, 0, v9
 v_max_f32 v13, 0, v13
 v_add_f32 v10, 0x3727c5ac, v9
 v_add_f32 v14, 0x3727c5ac, v13
 v_rsq_f32 v10, v10
 v_rsq_f32 v14, v14
 v_mul_f32 v11, v10, v10
 v_mul_f32 v15, v14, v14
 v_mul_f32 v11, v9, v11
 v_mul_f32 v15, v13, v15
 v_add_f32 v11, 0x3727c5ac, v11
 v_add_f32 v15, 0x3727c5ac, v15
 v_rsq_f32 v11, v11
 v_rsq_f32 v15, v15
 v_mul_f32 v10, v10, v11
 v_mul_f32 v14, v14, v15
 v_mul_f32 v11, v8, v10
 v_mul_f32 v15, v12, v14
 s_mov_b64 exec, 0xffff
 ds_write_b32 v6, v10
 ds_write_b32 v6, v11 offset:256
 ds_write_b32 v6, v14 offset:64
 ds_write_b32 v6, v15 offset:320
 s_mov_b64 exec, -1
 s_waitcnt vmcnt(16)
 s_waitcnt lgkmcnt(0)
 s_barrier
 s_add_u32 m0, s25, 0x0
 s_mov_b32 s28, 0xbf5000
 buffer_load_dwordx4 v2, s[4:7], s28 offen offset:0 sc1 lds
 buffer_load_dwordx4 v2, s[4:7], s28 offen offset:1024 sc1 lds
 buffer_load_dwordx4 v3, s[4:7], s28 offen offset:2048 sc1 lds
 buffer_load_dwordx4 v3, s[4:7], s28 offen offset:3072 sc1 lds
 s_waitcnt vmcnt(16)
 s_barrier
 s_add_u32 m0, s25, 0x2000
 s_mov_b32 s28, 0xbf5800
 buffer_load_dwordx4 v2, s[4:7], s28 offen offset:0 sc1 lds
 buffer_load_dwordx4 v2, s[4:7], s28 offen offset:1024 sc1 lds
 buffer_load_dwordx4 v3, s[4:7], s28 offen offset:2048 sc1 lds
 buffer_load_dwordx4 v3, s[4:7], s28 offen offset:3072 sc1 lds
 s_waitcnt vmcnt(16)
 s_barrier
 s_add_u32 m0, s25, 0x4000
 s_mov_b32 s28, 0xbf6000
 buffer_load_dwordx4 v2, s[4:7], s28 offen offset:0 sc1 lds
 buffer_load_dwordx4 v2, s[4:7], s28 offen offset:1024 sc1 lds
 buffer_load_dwordx4 v3, s[4:7], s28 offen offset:2048 sc1 lds
 buffer_load_dwordx4 v3, s[4:7], s28 offen offset:3072 sc1 lds
 s_waitcnt vmcnt(16)
 s_barrier
 s_add_u32 m0, s25, 0x6000
 s_mov_b32 s28, 0xbf6800
 buffer_load_dwordx4 v2, s[4:7], s28 offen offset:0 sc1 lds
 buffer_load_dwordx4 v2, s[4:7], s28 offen offset:1024 sc1 lds
 buffer_load_dwordx4 v3, s[4:7], s28 offen offset:2048 sc1 lds
 buffer_load_dwordx4 v3, s[4:7], s28 offen offset:3072 sc1 lds
 s_waitcnt vmcnt(16)
 s_barrier
 s_waitcnt vmcnt(12)
 s_barrier
 s_waitcnt vmcnt(8)
 s_barrier
 s_waitcnt vmcnt(4)
 s_barrier
 s_waitcnt vmcnt(0)
 s_barrier
 s_barrier
 s_mul_i32 s27, s26, 61440
 v_add_u32 v2, s27, v4
 v_add_u32 v3, 59392, v2
 s_mov_b32 s28, 0x6e9000
 s_mov_b32 s29, 20000
C1_poll2:
 buffer_load_dword v8, v5, s[4:7], s28 offen sc1
 s_sub_u32 s29, s29, 1
 s_waitcnt vmcnt(0)
 v_cmp_ne_u32 vcc, 1, v8
 s_cmp_eq_u32 s29, 0
 s_cbranch_scc1 C1_pollx2
 s_nop 1
 s_cbranch_vccnz C1_poll2
C1_pollx2:
 s_add_u32 m0, s25, 0x0
 s_mov_b32 s28, 0x1172000
 buffer_load_dwordx4 v2, s[4:7], s28 offen offset:0 sc1 lds
 buffer_load_dwordx4 v2, s[4:7], s28 offen offset:1024 sc1 lds
 buffer_load_dwordx4 v3, s[4:7], s28 offen offset:2048 sc1 lds
 buffer_load_dwordx4 v3, s[4:7], s28 offen offset:3072 sc1 lds
 s_add_u32 m0, s25, 0x2000
 s_mov_b32 s28, 0x1172800
 buffer_load_dwordx4 v2, s[4:7], s28 offen offset:0 sc1 lds
 buffer_load_dwordx4 v2, s[4:7], s28 offen offset:1024 sc1 lds
 buffer_load_dwordx4 v3, s[4:7], s28 offen offset:2048 sc1 lds
 buffer_load_dwordx4 v3, s[4:7], s28 offen offset:3072 sc1 lds
 s_add_u32 m0, s25, 0x4000
 s_mov_b32 s28, 0x1173000
 buffer_load_dwordx4 v2, s[4:7], s28 offen offset:0 sc1 lds
 buffer_load_dwordx4 v2, s[4:7], s28 offen offset:1024 sc1 lds
 buffer_load_dwordx4 v3, s[4:7], s28 offen offset:2048 sc1 lds
 buffer_load_dwordx4 v3, s[4:7], s28 offen offset:3072 sc1 lds
 s_add_u32 m0, s25, 0x6000
 s_mov_b32 s28, 0x1173800
 buffer_load_dwordx4 v2, s[4:7], s28 offen offset:0 sc1 lds
 buffer_load_dwordx4 v2, s[4:7], s28 offen offset:1024 sc1 lds
 buffer_load_dwordx4 v3, s[4:7], s28 offen offset:2048 sc1 lds
 buffer_load_dwordx4 v3, s[4:7], s28 offen offset:3072 sc1 lds
 s_add_u32 m0, s25, 0x8000
 s_mov_b32 s28, 0x1174000
 buffer_load_dwordx4 v2, s[4:7], s28 offen offset:0 sc1 lds
 buffer_load_dwordx4 v2, s[4:7], s28 offen offset:1024 sc1 lds
 buffer_load_dwordx4 v3, s[4:7], s28 offen offset:2048 sc1 lds
 buffer_load_dwordx4 v3, s[4:7], s28 offen offset:3072 sc1 lds
 s_add_u32 m0, s25, 0xa000
 s_mov_b32 s28, 0x1174800
 buffer_load_dwordx4 v2, s[4:7], s28 offen offset:0 sc1 lds
 buffer_load_dwordx4 v2, s[4:7], s28 offen offset:1024 sc1 lds
 buffer_load_dwordx4 v3, s[4:7], s28 offen offset:2048 sc1 lds
 buffer_load_dwordx4 v3, s[4:7], s28 offen offset:3072 sc1 lds
 s_waitcnt vmcnt(20)
 s_barrier
 s_waitcnt vmcnt(16)
 s_barrier
 s_waitcnt vmcnt(12)
 s_barrier
 s_add_u32 m0, s25, 0x0
 s_mov_b32 s28, 0x1175000
 buffer_load_dwordx4 v2, s[4:7], s28 offen offset:0 sc1 lds
 buffer_load_dwordx4 v2, s[4:7], s28 offen offset:1024 sc1 lds
 buffer_load_dwordx4 v3, s[4:7], s28 offen offset:2048 sc1 lds
 buffer_load_dwordx4 v3, s[4:7], s28 offen offset:3072 sc1 lds
 s_waitcnt vmcnt(12)
 s_barrier
 s_add_u32 m0, s25, 0x2000
 s_mov_b32 s28, 0x1175800
 buffer_load_dwordx4 v2, s[4:7], s28 offen offset:0 sc1 lds
 buffer_load_dwordx4 v2, s[4:7], s28 offen offset:1024 sc1 lds
 buffer_load_dwordx4 v3, s[4:7], s28 offen offset:2048 sc1 lds
 buffer_load_dwordx4 v3, s[4:7], s28 offen offset:3072 sc1 lds
 s_waitcnt vmcnt(12)
 s_barrier
 s_add_u32 m0, s25, 0x4000
 s_mov_b32 s28, 0x1176000
 buffer_load_dwordx4 v2, s[4:7], s28 offen offset:0 sc1 lds
 buffer_load_dwordx4 v2, s[4:7], s28 offen offset:1024 sc1 lds
 buffer_load_dwordx4 v3, s[4:7], s28 offen offset:2048 sc1 lds
 buffer_load_dwordx4 v3, s[4:7], s28 offen offset:3072 sc1 lds
 s_waitcnt vmcnt(12)
 s_barrier
 s_add_u32 m0, s25, 0x6000
 s_mov_b32 s28, 0x1176800
 buffer_load_dwordx4 v2, s[4:7], s28 offen offset:0 sc1 lds
 buffer_load_dwordx4 v2, s[4:7], s28 offen offset:1024 sc1 lds
 buffer_load_dwordx4 v3, s[4:7], s28 offen offset:2048 sc1 lds
 buffer_load_dwordx4 v3, s[4:7], s28 offen offset:3072 sc1 lds
 s_waitcnt vmcnt(12)
 s_barrier
 s_add_u32 m0, s25, 0x8000
 s_mov_b32 s28, 0x1177000
 buffer_load_dwordx4 v2, s[4:7], s28 offen offset:0 sc1 lds
 buffer_load_dwordx4 v2, s[4:7], s28 offen offset:1024 sc1 lds
 buffer_load_dwordx4 v3, s[4:7], s28 offen offset:2048 sc1 lds
 buffer_load_dwordx4 v3, s[4:7], s28 offen offset:3072 sc1 lds
 s_waitcnt vmcnt(12)
 s_barrier
 s_add_u32 m0, s25, 0xa000
 s_mov_b32 s28, 0x1177800
 buffer_load_dwordx4 v2, s[4:7], s28 offen offset:0 sc1 lds
 buffer_load_dwordx4 v2, s[4:7], s28 offen offset:1024 sc1 lds
 buffer_load_dwordx4 v3, s[4:7], s28 offen offset:2048 sc1 lds
 buffer_load_dwordx4 v3, s[4:7], s28 offen offset:3072 sc1 lds
 s_waitcnt vmcnt(12)
 s_barrier
 s_add_u32 m0, s25, 0x0
 s_mov_b32 s28, 0x1178000
 buffer_load_dwordx4 v2, s[4:7], s28 offen offset:0 sc1 lds
 buffer_load_dwordx4 v2, s[4:7], s28 offen offset:1024 sc1 lds
 buffer_load_dwordx4 v3, s[4:7], s28 offen offset:2048 sc1 lds
 buffer_load_dwordx4 v3, s[4:7], s28 offen offset:3072 sc1 lds
 s_waitcnt vmcnt(12)
 s_barrier
 s_add_u32 m0, s25, 0x2000
 s_mov_b32 s28, 0x1178800
 buffer_load_dwordx4 v2, s[4:7], s28 offen offset:0 sc1 lds
 buffer_load_dwordx4 v2, s[4:7], s28 offen offset:1024 sc1 lds
 buffer_load_dwordx4 v3, s[4:7], s28 offen offset:2048 sc1 lds
 buffer_load_dwordx4 v3, s[4:7], s28 offen offset:3072 sc1 lds
 s_waitcnt vmcnt(12)
 s_barrier
 s_add_u32 m0, s25, 0x4000
 s_mov_b32 s28, 0x1179000
 buffer_load_dwordx4 v2, s[4:7], s28 offen offset:0 sc1 lds
 buffer_load_dwordx4 v2, s[4:7], s28 offen offset:1024 sc1 lds
 buffer_load_dwordx4 v3, s[4:7], s28 offen offset:2048 sc1 lds
 buffer_load_dwordx4 v3, s[4:7], s28 offen offset:3072 sc1 lds
 s_waitcnt vmcnt(12)
 s_barrier
 s_add_u32 m0, s25, 0x6000
 s_mov_b32 s28, 0x1179800
 buffer_load_dwordx4 v2, s[4:7], s28 offen offset:0 sc1 lds
 buffer_load_dwordx4 v2, s[4:7], s28 offen offset:1024 sc1 lds
 buffer_load_dwordx4 v3, s[4:7], s28 offen offset:2048 sc1 lds
 buffer_load_dwordx4 v3, s[4:7], s28 offen offset:3072 sc1 lds
 s_waitcnt vmcnt(12)
 s_barrier
 s_add_u32 m0, s25, 0x8000
 s_mov_b32 s28, 0x117a000
 buffer_load_dwordx4 v2, s[4:7], s28 offen offset:0 sc1 lds
 buffer_load_dwordx4 v2, s[4:7], s28 offen offset:1024 sc1 lds
 buffer_load_dwordx4 v3, s[4:7], s28 offen offset:2048 sc1 lds
 buffer_load_dwordx4 v3, s[4:7], s28 offen offset:3072 sc1 lds
 s_waitcnt vmcnt(12)
 s_barrier
 s_add_u32 m0, s25, 0xa000
 s_mov_b32 s28, 0x117a800
 buffer_load_dwordx4 v2, s[4:7], s28 offen offset:0 sc1 lds
 buffer_load_dwordx4 v2, s[4:7], s28 offen offset:1024 sc1 lds
 buffer_load_dwordx4 v3, s[4:7], s28 offen offset:2048 sc1 lds
 buffer_load_dwordx4 v3, s[4:7], s28 offen offset:3072 sc1 lds
 s_waitcnt vmcnt(12)
 s_barrier
 s_add_u32 m0, s25, 0x0
 s_mov_b32 s28, 0x117b000
 buffer_load_dwordx4 v2, s[4:7], s28 offen offset:0 sc1 lds
 buffer_load_dwordx4 v2, s[4:7], s28 offen offset:1024 sc1 lds
 buffer_load_dwordx4 v3, s[4:7], s28 offen offset:2048 sc1 lds
 buffer_load_dwordx4 v3, s[4:7], s28 offen offset:3072 sc1 lds
 s_waitcnt vmcnt(12)
 s_barrier
 s_add_u32 m0, s25, 0x2000
 s_mov_b32 s28, 0x117b800
 buffer_load_dwordx4 v2, s[4:7], s28 offen offset:0 sc1 lds
 buffer_load_dwordx4 v2, s[4:7], s28 offen offset:1024 sc1 lds
 buffer_load_dwordx4 v3, s[4:7], s28 offen offset:2048 sc1 lds
 buffer_load_dwordx4 v3, s[4:7], s28 offen offset:3072 sc1 lds
 s_waitcnt vmcnt(12)
 s_barrier
 s_add_u32 m0, s25, 0x4000
 s_mov_b32 s28, 0x117c000
 buffer_load_dwordx4 v2, s[4:7], s28 offen offset:0 sc1 lds
 buffer_load_dwordx4 v2, s[4:7], s28 offen offset:1024 sc1 lds
 buffer_load_dwordx4 v3, s[4:7], s28 offen offset:2048 sc1 lds
 buffer_load_dwordx4 v3, s[4:7], s28 offen offset:3072 sc1 lds
 s_waitcnt vmcnt(12)
 s_barrier
 s_add_u32 m0, s25, 0x6000
 s_mov_b32 s28, 0x117c800
 buffer_load_dwordx4 v2, s[4:7], s28 offen offset:0 sc1 lds
 buffer_load_dwordx4 v2, s[4:7], s28 offen offset:1024 sc1 lds
 buffer_load_dwordx4 v3, s[4:7], s28 offen offset:2048 sc1 lds
 buffer_load_dwordx4 v3, s[4:7], s28 offen offset:3072 sc1 lds
 s_waitcnt vmcnt(12)
 s_barrier
 s_add_u32 m0, s25, 0x8000
 s_mov_b32 s28, 0x117d000
 buffer_load_dwordx4 v2, s[4:7], s28 offen offset:0 sc1 lds
 buffer_load_dwordx4 v2, s[4:7], s28 offen offset:1024 sc1 lds
 buffer_load_dwordx4 v3, s[4:7], s28 offen offset:2048 sc1 lds
 buffer_load_dwordx4 v3, s[4:7], s28 offen offset:3072 sc1 lds
 s_waitcnt vmcnt(12)
 s_barrier
 s_add_u32 m0, s25, 0xa000
 s_mov_b32 s28, 0x117d800
 buffer_load_dwordx4 v2, s[4:7], s28 offen offset:0 sc1 lds
 buffer_load_dwordx4 v2, s[4:7], s28 offen offset:1024 sc1 lds
 buffer_load_dwordx4 v3, s[4:7], s28 offen offset:2048 sc1 lds
 buffer_load_dwordx4 v3, s[4:7], s28 offen offset:3072 sc1 lds
 s_waitcnt vmcnt(12)
 s_barrier
 s_waitcnt vmcnt(8)
 s_barrier
 s_waitcnt vmcnt(4)
 s_barrier
 s_waitcnt vmcnt(0)
 s_barrier
 s_barrier
 s_mul_i32 s27, s26, 20480
 v_add_u32 v2, s27, v4
 v_add_u32 v3, 18432, v2
 s_mov_b32 s28, 0x6ea000
 s_mov_b32 s29, 20000
C1_poll3:
 buffer_load_dword v8, v5, s[4:7], s28 offen sc1
 s_sub_u32 s29, s29, 1
 s_waitcnt vmcnt(0)
 v_cmp_ne_u32 vcc, 1, v8
 s_cmp_eq_u32 s29, 0
 s_cbranch_scc1 C1_pollx3
 s_nop 1
 s_cbranch_vccnz C1_poll3
C1_pollx3:
 s_mov_b32 s28, 0x1132000
 buffer_load_dwordx4 v[8:11], v7, s[4:7], s28 offen sc1
 buffer_load_dwordx4 v[12:15], v7, s[4:7], s28 offen offset:1024 sc1
 s_add_u32 m0, s25, 0x0
 s_mov_b32 s28, 0xbf2000
 buffer_load_dwordx4 v2, s[4:7], s28 offen offset:0 sc1 lds
 buffer_load_dwordx4 v2, s[4:7], s28 offen offset:1024 sc1 lds
 buffer_load_dwordx4 v3, s[4:7], s28 offen offset:2048 sc1 lds
 buffer_load_dwordx4 v3, s[4:7], s28 offen offset:3072 sc1 lds
 s_add_u32 m0, s25, 0x2000
 s_mov_b32 s28, 0xbf2800
 buffer_load_dwordx4 v2, s[4:7], s28 offen offset:0 sc1 lds
 buffer_load_dwordx4 v2, s[4:7], s28 offen offset:1024 sc1 lds
 buffer_load_dwordx4 v3, s[4:7], s28 offen offset:2048 sc1 lds
 buffer_load_dwordx4 v3, s[4:7], s28 offen offset:3072 sc1 lds
 s_add_u32 m0, s25, 0x4000
 s_mov_b32 s28, 0xbf3000
 buffer_load_dwordx4 v2, s[4:7], s28 offen offset:0 sc1 lds
 buffer_load_dwordx4 v2, s[4:7], s28 offen offset:1024 sc1 lds
 buffer_load_dwordx4 v3, s[4:7], s28 offen offset:2048 sc1 lds
 buffer_load_dwordx4 v3, s[4:7], s28 offen offset:3072 sc1 lds
 s_add_u32 m0, s25, 0x6000
 s_mov_b32 s28, 0xbf3800
 buffer_load_dwordx4 v2, s[4:7], s28 offen offset:0 sc1 lds
 buffer_load_dwordx4 v2, s[4:7], s28 offen offset:1024 sc1 lds
 buffer_load_dwordx4 v3, s[4:7], s28 offen offset:2048 sc1 lds
 buffer_load_dwordx4 v3, s[4:7], s28 offen offset:3072 sc1 lds
 s_add_u32 m0, s25, 0x8000
 s_mov_b32 s28, 0xbf4000
 buffer_load_dwordx4 v2, s[4:7], s28 offen offset:0 sc1 lds
 buffer_load_dwordx4 v2, s[4:7], s28 offen offset:1024 sc1 lds
 buffer_load_dwordx4 v3, s[4:7], s28 offen offset:2048 sc1 lds
 buffer_load_dwordx4 v3, s[4:7], s28 offen offset:3072 sc1 lds
 s_add_u32 m0, s25, 0xa000
 s_mov_b32 s28, 0xbf4800
 buffer_load_dwordx4 v2, s[4:7], s28 offen offset:0 sc1 lds
 buffer_load_dwordx4 v2, s[4:7], s28 offen offset:1024 sc1 lds
 buffer_load_dwordx4 v3, s[4:7], s28 offen offset:2048 sc1 lds
 buffer_load_dwordx4 v3, s[4:7], s28 offen offset:3072 sc1 lds
 s_waitcnt vmcnt(20)
 s_barrier
 v_add_f32 v8, v8, v10
 v_add_f32 v9, v9, v11
 v_add_f32 v12, v12, v14
 v_add_f32 v13, v13, v15
 v_mov_b32 v16, v8
 v_mov_b32 v17, v9
 v_mov_b32 v20, v12
 v_mov_b32 v21, v13
 v_permlane16_swap_b32 v8, v16
 v_permlane16_swap_b32 v9, v17
 v_permlane16_swap_b32 v12, v20
 v_permlane16_swap_b32 v13, v21
 v_add_f32 v8, v8, v16
 v_add_f32 v9, v9, v17
 v_add_f32 v12, v12, v20
 v_add_f32 v13, v13, v21
 v_mov_b32 v16, v8
 v_mov_b32 v17, v9
 v_mov_b32 v20, v12
 v_mov_b32 v21, v13
 v_permlane32_swap_b32 v8, v16
 v_permlane32_swap_b32 v9, v17
 v_permlane32_swap_b32 v12, v20
 v_permlane32_swap_b32 v13, v21
 v_add_f32 v8, v8, v16
 v_add_f32 v9, v9, v17
 v_add_f32 v12, v12, v20
 v_add_f32 v13, v13, v21
 v_mul_f32 v8, 0x3acccccd, v8
 v_mul_f32 v9, 0x3acccccd, v9
 v_mul_f32 v12, 0x3acccccd, v12
 v_mul_f32 v13, 0x3acccccd, v13
 v_fma_f32 v9, -v8, v8, v9
 v_fma_f32 v13, -v12, v12, v13
 v_max_f32 v9, 0, v9
 v_max_f32 v13, 0, v13
 v_add_f32 v10, 0x3727c5ac, v9
 v_add_f32 v14, 0x3727c5ac, v13
 v_rsq_f32 v10, v10
 v_rsq_f32 v14, v14
 v_mul_f32 v11, v8, v10
 v_mul_f32 v15, v12, v14
 s_mov_b64 exec, 0xffff
 ds_write_b32 v6, v10
 ds_write_b32 v6, v11 offset:256
 ds_write_b32 v6, v14 offset:64
 ds_write_b32 v6, v15 offset:320
 s_mov_b64 exec, -1
 s_waitcnt vmcnt(16)
 s_waitcnt lgkmcnt(0)
 s_barrier
 s_add_u32 m0, s25, 0x0
 s_mov_b32 s28, 0xbf5000
 buffer_load_dwordx4 v2, s[4:7], s28 offen offset:0 sc1 lds
 buffer_load_dwordx4 v2, s[4:7], s28 offen offset:1024 sc1 lds
 buffer_load_dwordx4 v3, s[4:7], s28 offen offset:2048 sc1 lds
 buffer_load_dwordx4 v3, s[4:7], s28 offen offset:3072 sc1 lds
 s_waitcnt vmcnt(16)
 s_barrier
 s_add_u32 m0, s25, 0x2000
 s_mov_b32 s28, 0xbf5800
 buffer_load_dwordx4 v2, s[4:7], s28 offen offset:0 sc1 lds
 buffer_load_dwordx4 v2, s[4:7], s28 offen offset:1024 sc1 lds
 buffer_load_dwordx4 v3, s[4:7], s28 offen offset:2048 sc1 lds
 buffer_load_dwordx4 v3, s[4:7], s28 offen offset:3072 sc1 lds
 s_waitcnt vmcnt(16)
 s_barrier
 s_add_u32 m0, s25, 0x4000
 s_mov_b32 s28, 0xbf6000
 buffer_load_dwordx4 v2, s[4:7], s28 offen offset:0 sc1 lds
 buffer_load_dwordx4 v2, s[4:7], s28 offen offset:1024 sc1 lds
 buffer_load_dwordx4 v3, s[4:7], s28 offen offset:2048 sc1 lds
 buffer_load_dwordx4 v3, s[4:7], s28 offen offset:3072 sc1 lds
 s_waitcnt vmcnt(16)
 s_barrier
 s_add_u32 m0, s25, 0x6000
 s_mov_b32 s28, 0xbf6800
 buffer_load_dwordx4 v2, s[4:7], s28 offen offset:0 sc1 lds
 buffer_load_dwordx4 v2, s[4:7], s28 offen offset:1024 sc1 lds
 buffer_load_dwordx4 v3, s[4:7], s28 offen offset:2048 sc1 lds
 buffer_load_dwordx4 v3, s[4:7], s28 offen offset:3072 sc1 lds
 s_waitcnt vmcnt(16)
 s_barrier
 s_waitcnt vmcnt(12)
 s_barrier
 s_waitcnt vmcnt(8)
 s_barrier
 s_waitcnt vmcnt(4)
 s_barrier
 s_waitcnt vmcnt(0)
 s_barrier
 s_barrier
 s_endpgm
C1_end:
 s_endpgm
.globl c2_kernel
.p2align 8
.type c2_kernel,@function
c2_kernel:
C2_start:
 s_cmp_ge_u32 s2, 256
 s_cbranch_scc1 C2_end
 s_load_dwordx2 s[4:5], s[0:1], 80
 s_load_dwordx2 s[8:9], s[0:1], 40
 s_load_dwordx2 s[12:13], s[0:1], 56
 s_load_dwordx2 s[16:17], s[0:1], 64
 v_lshrrev_b32 v1, 6, v0
 s_nop 0
 v_readfirstlane_b32 s20, v1
 v_and_b32 v1, 63, v0
 s_mov_b32 s6, 0x10000000
 s_mov_b32 s7, 0x00020000
 s_mov_b32 s10, 3072
 s_mov_b32 s11, 0x00020000
 s_mov_b32 s14, 1280
 s_mov_b32 s15, 0x00020000
 s_mov_b32 s18, 2621440
 s_mov_b32 s19, 0x00020000
 s_and_b32 s21, s2, 31
 s_lshr_b32 s22, s2, 5
 s_cmp_ge_u32 s20, 6
 s_cbranch_scc1 C2_al
 s_cmp_eq_u32 s20, 4
 s_cbranch_scc1 C2_bl0
 s_cmp_eq_u32 s20, 5
 s_cbranch_scc1 C2_bl1
 v_lshrrev_b32 v1, 6, v0
 s_nop 0
 v_readfirstlane_b32 s40, v1
 v_and_b32 v1, 63, v0
 s_lshr_b32 s41, s2, 3
 s_and_b32 s42, s2, 7
 s_lshl_b32 s45, s40, 3
 s_add_u32 s42, s42, s45
 s_lshr_b32 s45, s41, 1
 s_and_b32 s46, s41, 1
 s_mul_i32 s45, s45, 5
 s_mul_i32 s47, s46, 3
 s_add_u32 s47, s47, s45
 s_lshl_b32 s47, s47, 8
 s_add_u32 s45, s45, 2
 s_lshl_b32 s45, s45, 8
 s_lshl_b32 s46, s46, 3
 s_add_u32 s45, s45, s46
 v_and_b32 v6, 15, v1
 v_lshlrev_b32 v6, 4, v6
 v_bfe_u32 v7, v1, 4, 1
 v_lshrrev_b32 v4, 5, v1
 v_lshlrev_b32 v5, 8, v4
 v_add_u32 v5, v5, v6
 v_add_u32 v5, s47, v5
 v_add_u32 v6, s45, v6
 v_mul_u32_u24 v2, 61440, v7
 v_add_u32 v3, v2, v6
 v_add_u32 v2, v2, v5
 v_mul_u32_u24 v7, 61440, v7
 v_add_u32 v168, v7, v5
 v_add_u32 v169, v7, v6
 v_and_b32 v5, 31, v1
 v_min_u32 v5, 20, v5
 v_lshlrev_b32 v5, 4, v5
 v_mul_u32_u24 v4, 336, v4
 v_add_u32 v4, v4, v5
 s_lshl_b32 s50, s42, 2
 s_mul_i32 s52, s50, 61440
 s_add_u32 s52, s52, 18333696
 s_add_u32 s53, s52, 122880
 s_mul_i32 s50, s50, 61440
 s_add_u32 s50, s50, 18292736
 s_add_u32 s51, s50, 122880
 s_mul_i32 s54, s41, 86016
 s_add_u32 s54, s54, 26402816
 v_mov_b32 v12, 0
 v_mov_b32 v13, 0
 v_mov_b32 v14, 0
 v_mov_b32 v15, 0
 v_mov_b32 v20, 0
 v_mov_b32 v21, 0
 v_mov_b32 v22, 0
 v_mov_b32 v23, 0
 v_mov_b32 v110, 0x3f803f80
 v_mov_b32 v111, 0
 v_mov_b32 v126, 0x3f803f80
 v_mov_b32 v127, 0
 v_mov_b32 v142, 0x3f803f80
 v_mov_b32 v143, 0
 v_mov_b32 v158, 0x3f803f80
 v_mov_b32 v159, 0
 s_mov_b32 s49, 0
 s_waitcnt lgkmcnt(0)
 buffer_load_dwordx4 v[8:11], v2, s[4:7], s50 offen
 buffer_load_dwordx4 v[16:19], v2, s[4:7], s51 offen
 s_mov_b32 exec_hi, 0
 buffer_load_dwordx2 v[12:13], v3, s[4:7], s50 offen
 buffer_load_dwordx2 v[20:21], v3, s[4:7], s51 offen
 s_mov_b32 exec_hi, -1
C2_ATT_start:
 s_mov_b32 s43, 18313216
 s_mov_b32 s44, s54
 buffer_load_dwordx4 v[152:155], v2, s[4:7], s43 offen
 buffer_load_dwordx2 v[156:157], v3, s[4:7], s43 offen
 s_add_u32 s43, s43, 122880
 buffer_load_dwordx4 v[104:107], v2, s[4:7], s43 offen
 buffer_load_dwordx2 v[108:109], v3, s[4:7], s43 offen
 buffer_load_dwordx4 v[112:115], v4, s[4:7], s44 offen
 buffer_load_dwordx4 v[116:119], v4, s[4:7], s44 offen offset:672
 s_add_u32 s43, s43, 122880
 s_add_u32 s44, s44, 1344
 buffer_load_dwordx4 v[120:123], v2, s[4:7], s43 offen
 buffer_load_dwordx2 v[124:125], v3, s[4:7], s43 offen
 buffer_load_dwordx4 v[128:131], v4, s[4:7], s44 offen
 buffer_load_dwordx4 v[132:135], v4, s[4:7], s44 offen offset:672
 s_add_u32 s43, s43, 122880
 s_add_u32 s44, s44, 1344
 buffer_load_dwordx4 v[136:139], v2, s[4:7], s43 offen
 buffer_load_dwordx2 v[140:141], v3, s[4:7], s43 offen
 buffer_load_dwordx4 v[144:147], v4, s[4:7], s44 offen
 buffer_load_dwordx4 v[148:151], v4, s[4:7], s44 offen offset:672
 s_add_u32 s43, s43, 122880
 s_sub_u32 s44, s44, 1344
 s_waitcnt vmcnt(12)
 s_cmp_lg_u32 s49, 0
 s_cbranch_scc1 C2_ATT_havem
 v_mfma_f32_32x32x16_bf16 v[24:39], v[152:155], v[8:11], 0
 v_mfma_f32_32x32x16_bf16 v[24:39], v[156:159], v[12:15], v[24:39]
 v_mfma_f32_32x32x16_bf16 v[40:55], v[152:155], v[16:19], 0
 v_mfma_f32_32x32x16_bf16 v[40:55], v[156:159], v[20:23], v[40:55]
 s_nop 7
 s_nop 1
 v_max3_f32 v6, v24, v25, v26
 v_max3_f32 v6, v6, v27, v28
 v_max3_f32 v6, v6, v29, v30
 v_max3_f32 v6, v6, v31, v32
 v_max3_f32 v6, v6, v33, v34
 v_max3_f32 v6, v6, v35, v36
 v_max3_f32 v6, v6, v37, v38
 v_max_f32 v6, v6, v39
 v_max3_f32 v7, v40, v41, v42
 v_max3_f32 v7, v7, v43, v44
 v_max3_f32 v7, v7, v45, v46
 v_max3_f32 v7, v7, v47, v48
 v_max3_f32 v7, v7, v49, v50
 v_max3_f32 v7, v7, v51, v52
 v_max3_f32 v7, v7, v53, v54
 v_max_f32 v7, v7, v55
 v_mov_b32 v5, v6
 s_nop 1
 v_permlane32_swap_b32 v6, v5
 v_max_f32 v6, v6, v5
 v_sub_f32 v6, 0, v6
 v_cvt_pk_bf16_f32 v6, v6, 0
 v_and_b32 v6, 0xffff, v6
 s_mov_b32 exec_hi, 0
 v_mov_b32 v14, v6
 s_mov_b32 exec_hi, -1
 v_mov_b32 v5, v7
 s_nop 1
 v_permlane32_swap_b32 v7, v5
 v_max_f32 v7, v7, v5
 v_sub_f32 v7, 0, v7
 v_cvt_pk_bf16_f32 v7, v7, 0
 v_and_b32 v7, 0xffff, v7
 s_mov_b32 exec_hi, 0
 v_mov_b32 v22, v7
 s_mov_b32 exec_hi, -1
C2_ATT_havem:
 s_nop 1
 v_mfma_f32_32x32x16_bf16 v[24:39], v[152:155], v[8:11], 0
 v_mfma_f32_32x32x16_bf16 v[24:39], v[156:159], v[12:15], v[24:39]
 v_mfma_f32_32x32x16_bf16 v[40:55], v[152:155], v[16:19], 0
 v_mfma_f32_32x32x16_bf16 v[40:55], v[156:159], v[20:23], v[40:55]
 v_mov_b32 v72, 0
 v_mov_b32 v73, 0
 v_mov_b32 v74, 0
 v_mov_b32 v75, 0
 v_mov_b32 v76, 0
 v_mov_b32 v77, 0
 v_mov_b32 v78, 0
 v_mov_b32 v79, 0
 v_mov_b32 v80, 0
 v_mov_b32 v81, 0
 v_mov_b32 v82, 0
 v_mov_b32 v83, 0
 v_mov_b32 v84, 0
 v_mov_b32 v85, 0
 v_mov_b32 v86, 0
 v_mov_b32 v87, 0
 v_mov_b32 v88, 0
 v_mov_b32 v89, 0
 v_mov_b32 v90, 0
 v_mov_b32 v91, 0
 v_mov_b32 v92, 0
 v_mov_b32 v93, 0
 v_mov_b32 v94, 0
 v_mov_b32 v95, 0
 v_mov_b32 v96, 0
 v_mov_b32 v97, 0
 v_mov_b32 v98, 0
 v_mov_b32 v99, 0
 v_mov_b32 v100, 0
 v_mov_b32 v101, 0
 v_mov_b32 v102, 0
 v_mov_b32 v103, 0
 v_exp_f32 v24, v24
 v_exp_f32 v25, v25
 v_exp_f32 v26, v26
 v_exp_f32 v27, v27
 v_cvt_pk_bf16_f32 v56, v24, v25
 v_cvt_pk_bf16_f32 v57, v26, v27
 v_exp_f32 v28, v28
 v_exp_f32 v29, v29
 v_exp_f32 v30, v30
 v_exp_f32 v31, v31
 v_cvt_pk_bf16_f32 v58, v28, v29
 v_cvt_pk_bf16_f32 v59, v30, v31
 v_exp_f32 v32, v32
 v_exp_f32 v33, v33
 v_exp_f32 v34, v34
 v_exp_f32 v35, v35
 v_cvt_pk_bf16_f32 v60, v32, v33
 v_cvt_pk_bf16_f32 v61, v34, v35
 v_exp_f32 v36, v36
 v_exp_f32 v37, v37
 v_exp_f32 v38, v38
 v_exp_f32 v39, v39
 v_cvt_pk_bf16_f32 v62, v36, v37
 v_cvt_pk_bf16_f32 v63, v38, v39
 s_mov_b32 s48, 7
 s_waitcnt vmcnt(8)
 v_mfma_f32_32x32x16_bf16 v[24:39], v[104:107], v[8:11], 0
C2_ATT_loop:
 v_exp_f32 v40, v40
 v_exp_f32 v41, v41
 v_exp_f32 v42, v42
 v_exp_f32 v43, v43
 v_cvt_pk_bf16_f32 v64, v40, v41
 v_cvt_pk_bf16_f32 v65, v42, v43
 v_mfma_f32_32x32x16_bf16 v[24:39], v[108:111], v[12:15], v[24:39]
 buffer_load_dwordx4 v[152:155], v2, s[4:7], s43 offen
 v_exp_f32 v44, v44
 v_exp_f32 v45, v45
 v_exp_f32 v46, v46
 v_exp_f32 v47, v47
 v_cvt_pk_bf16_f32 v66, v44, v45
 v_cvt_pk_bf16_f32 v67, v46, v47
 v_mfma_f32_32x32x16_bf16 v[72:87], v[112:115], v[56:59], v[72:87]
 buffer_load_dwordx2 v[156:157], v3, s[4:7], s43 offen
 v_exp_f32 v48, v48
 v_exp_f32 v49, v49
 v_exp_f32 v50, v50
 v_exp_f32 v51, v51
 v_cvt_pk_bf16_f32 v68, v48, v49
 v_cvt_pk_bf16_f32 v69, v50, v51
 v_mfma_f32_32x32x16_bf16 v[72:87], v[116:119], v[60:63], v[72:87]
 s_add_u32 s44, s44, 2688
 v_exp_f32 v52, v52
 v_exp_f32 v53, v53
 v_exp_f32 v54, v54
 v_exp_f32 v55, v55
 v_cvt_pk_bf16_f32 v70, v52, v53
 v_cvt_pk_bf16_f32 v71, v54, v55
 v_mfma_f32_32x32x16_bf16 v[40:55], v[104:107], v[16:19], 0
 buffer_load_dwordx4 v[160:163], v4, s[4:7], s44 offen
 v_exp_f32 v24, v24
 v_exp_f32 v25, v25
 v_exp_f32 v26, v26
 v_exp_f32 v27, v27
 v_cvt_pk_bf16_f32 v56, v24, v25
 v_cvt_pk_bf16_f32 v57, v26, v27
 v_mfma_f32_32x32x16_bf16 v[40:55], v[108:111], v[20:23], v[40:55]
 s_waitcnt vmcnt(7)
 v_exp_f32 v28, v28
 v_exp_f32 v29, v29
 v_exp_f32 v30, v30
 v_exp_f32 v31, v31
 v_cvt_pk_bf16_f32 v58, v28, v29
 v_cvt_pk_bf16_f32 v59, v30, v31
 v_mfma_f32_32x32x16_bf16 v[88:103], v[112:115], v[64:67], v[88:103]
 buffer_load_dwordx4 v[164:167], v4, s[4:7], s44 offen offset:672
 v_exp_f32 v32, v32
 v_exp_f32 v33, v33
 v_exp_f32 v34, v34
 v_exp_f32 v35, v35
 v_cvt_pk_bf16_f32 v60, v32, v33
 v_cvt_pk_bf16_f32 v61, v34, v35
 v_mfma_f32_32x32x16_bf16 v[88:103], v[116:119], v[68:71], v[88:103]
 s_add_u32 s43, s43, 122880
 v_exp_f32 v36, v36
 v_exp_f32 v37, v37
 v_exp_f32 v38, v38
 v_exp_f32 v39, v39
 v_cvt_pk_bf16_f32 v62, v36, v37
 v_cvt_pk_bf16_f32 v63, v38, v39
 v_mfma_f32_32x32x16_bf16 v[24:39], v[120:123], v[8:11], 0
 buffer_load_dwordx4 v[104:107], v2, s[4:7], s43 offen
 v_exp_f32 v40, v40
 v_exp_f32 v41, v41
 v_exp_f32 v42, v42
 v_exp_f32 v43, v43
 v_cvt_pk_bf16_f32 v64, v40, v41
 v_cvt_pk_bf16_f32 v65, v42, v43
 v_mfma_f32_32x32x16_bf16 v[24:39], v[124:127], v[12:15], v[24:39]
 v_exp_f32 v44, v44
 v_exp_f32 v45, v45
 v_exp_f32 v46, v46
 v_exp_f32 v47, v47
 v_cvt_pk_bf16_f32 v66, v44, v45
 v_cvt_pk_bf16_f32 v67, v46, v47
 v_mfma_f32_32x32x16_bf16 v[72:87], v[128:131], v[56:59], v[72:87]
 buffer_load_dwordx2 v[108:109], v3, s[4:7], s43 offen
 v_exp_f32 v48, v48
 v_exp_f32 v49, v49
 v_exp_f32 v50, v50
 v_exp_f32 v51, v51
 v_cvt_pk_bf16_f32 v68, v48, v49
 v_cvt_pk_bf16_f32 v69, v50, v51
 v_mfma_f32_32x32x16_bf16 v[72:87], v[132:135], v[60:63], v[72:87]
 s_add_u32 s43, s43, 122880
 v_exp_f32 v52, v52
 v_exp_f32 v53, v53
 v_exp_f32 v54, v54
 v_exp_f32 v55, v55
 v_cvt_pk_bf16_f32 v70, v52, v53
 v_cvt_pk_bf16_f32 v71, v54, v55
 v_mfma_f32_32x32x16_bf16 v[40:55], v[120:123], v[16:19], 0
 buffer_load_dwordx4 v[112:115], v4, s[4:7], s44 offen offset:1344
 v_exp_f32 v24, v24
 v_exp_f32 v25, v25
 v_exp_f32 v26, v26
 v_exp_f32 v27, v27
 v_cvt_pk_bf16_f32 v56, v24, v25
 v_cvt_pk_bf16_f32 v57, v26, v27
 v_mfma_f32_32x32x16_bf16 v[40:55], v[124:127], v[20:23], v[40:55]
 s_waitcnt vmcnt(7)
 v_exp_f32 v28, v28
 v_exp_f32 v29, v29
 v_exp_f32 v30, v30
 v_exp_f32 v31, v31
 v_cvt_pk_bf16_f32 v58, v28, v29
 v_cvt_pk_bf16_f32 v59, v30, v31
 v_mfma_f32_32x32x16_bf16 v[88:103], v[128:131], v[64:67], v[88:103]
 buffer_load_dwordx4 v[116:119], v4, s[4:7], s44 offen offset:2016
 v_exp_f32 v32, v32
 v_exp_f32 v33, v33
 v_exp_f32 v34, v34
 v_exp_f32 v35, v35
 v_cvt_pk_bf16_f32 v60, v32, v33
 v_cvt_pk_bf16_f32 v61, v34, v35
 v_mfma_f32_32x32x16_bf16 v[88:103], v[132:135], v[68:71], v[88:103]
 v_exp_f32 v36, v36
 v_exp_f32 v37, v37
 v_exp_f32 v38, v38
 v_exp_f32 v39, v39
 v_cvt_pk_bf16_f32 v62, v36, v37
 v_cvt_pk_bf16_f32 v63, v38, v39
 v_mfma_f32_32x32x16_bf16 v[24:39], v[136:139], v[8:11], 0
 buffer_load_dwordx4 v[120:123], v2, s[4:7], s43 offen
 v_exp_f32 v40, v40
 v_exp_f32 v41, v41
 v_exp_f32 v42, v42
 v_exp_f32 v43, v43
 v_cvt_pk_bf16_f32 v64, v40, v41
 v_cvt_pk_bf16_f32 v65, v42, v43
 v_mfma_f32_32x32x16_bf16 v[24:39], v[140:143], v[12:15], v[24:39]
 s_add_u32 s44, s44, 2688
 v_exp_f32 v44, v44
 v_exp_f32 v45, v45
 v_exp_f32 v46, v46
 v_exp_f32 v47, v47
 v_cvt_pk_bf16_f32 v66, v44, v45
 v_cvt_pk_bf16_f32 v67, v46, v47
 v_mfma_f32_32x32x16_bf16 v[72:87], v[144:147], v[56:59], v[72:87]
 buffer_load_dwordx2 v[124:125], v3, s[4:7], s43 offen
 v_exp_f32 v48, v48
 v_exp_f32 v49, v49
 v_exp_f32 v50, v50
 v_exp_f32 v51, v51
 v_cvt_pk_bf16_f32 v68, v48, v49
 v_cvt_pk_bf16_f32 v69, v50, v51
 v_mfma_f32_32x32x16_bf16 v[72:87], v[148:151], v[60:63], v[72:87]
 s_add_u32 s43, s43, 122880
 v_exp_f32 v52, v52
 v_exp_f32 v53, v53
 v_exp_f32 v54, v54
 v_exp_f32 v55, v55
 v_cvt_pk_bf16_f32 v70, v52, v53
 v_cvt_pk_bf16_f32 v71, v54, v55
 v_mfma_f32_32x32x16_bf16 v[40:55], v[136:139], v[16:19], 0
 buffer_load_dwordx4 v[128:131], v4, s[4:7], s44 offen
 v_exp_f32 v24, v24
 v_exp_f32 v25, v25
 v_exp_f32 v26, v26
 v_exp_f32 v27, v27
 v_cvt_pk_bf16_f32 v56, v24, v25
 v_cvt_pk_bf16_f32 v57, v26, v27
 v_mfma_f32_32x32x16_bf16 v[40:55], v[140:143], v[20:23], v[40:55]
 s_waitcnt vmcnt(7)
 v_exp_f32 v28, v28
 v_exp_f32 v29, v29
 v_exp_f32 v30, v30
 v_exp_f32 v31, v31
 v_cvt_pk_bf16_f32 v58, v28, v29
 v_cvt_pk_bf16_f32 v59, v30, v31
 v_mfma_f32_32x32x16_bf16 v[88:103], v[144:147], v[64:67], v[88:103]
 buffer_load_dwordx4 v[132:135], v4, s[4:7], s44 offen offset:672
 v_exp_f32 v32, v32
 v_exp_f32 v33, v33
 v_exp_f32 v34, v34
 v_exp_f32 v35, v35
 v_cvt_pk_bf16_f32 v60, v32, v33
 v_cvt_pk_bf16_f32 v61, v34, v35
 v_mfma_f32_32x32x16_bf16 v[88:103], v[148:151], v[68:71], v[88:103]
 v_exp_f32 v36, v36
 v_exp_f32 v37, v37
 v_exp_f32 v38, v38
 v_exp_f32 v39, v39
 v_cvt_pk_bf16_f32 v62, v36, v37
 v_cvt_pk_bf16_f32 v63, v38, v39
 v_mfma_f32_32x32x16_bf16 v[24:39], v[152:155], v[8:11], 0
 buffer_load_dwordx4 v[136:139], v2, s[4:7], s43 offen
 v_exp_f32 v40, v40
 v_exp_f32 v41, v41
 v_exp_f32 v42, v42
 v_exp_f32 v43, v43
 v_cvt_pk_bf16_f32 v64, v40, v41
 v_cvt_pk_bf16_f32 v65, v42, v43
 v_mfma_f32_32x32x16_bf16 v[24:39], v[156:159], v[12:15], v[24:39]
 v_exp_f32 v44, v44
 v_exp_f32 v45, v45
 v_exp_f32 v46, v46
 v_exp_f32 v47, v47
 v_cvt_pk_bf16_f32 v66, v44, v45
 v_cvt_pk_bf16_f32 v67, v46, v47
 v_mfma_f32_32x32x16_bf16 v[72:87], v[160:163], v[56:59], v[72:87]
 buffer_load_dwordx2 v[140:141], v3, s[4:7], s43 offen
 v_exp_f32 v48, v48
 v_exp_f32 v49, v49
 v_exp_f32 v50, v50
 v_exp_f32 v51, v51
 v_cvt_pk_bf16_f32 v68, v48, v49
 v_cvt_pk_bf16_f32 v69, v50, v51
 v_mfma_f32_32x32x16_bf16 v[72:87], v[164:167], v[60:63], v[72:87]
 s_add_u32 s43, s43, 122880
 v_exp_f32 v52, v52
 v_exp_f32 v53, v53
 v_exp_f32 v54, v54
 v_exp_f32 v55, v55
 v_cvt_pk_bf16_f32 v70, v52, v53
 v_cvt_pk_bf16_f32 v71, v54, v55
 v_mfma_f32_32x32x16_bf16 v[40:55], v[152:155], v[16:19], 0
 buffer_load_dwordx4 v[144:147], v4, s[4:7], s44 offen offset:1344
 v_exp_f32 v24, v24
 v_exp_f32 v25, v25
 v_exp_f32 v26, v26
 v_exp_f32 v27, v27
 v_cvt_pk_bf16_f32 v56, v24, v25
 v_cvt_pk_bf16_f32 v57, v26, v27
 v_mfma_f32_32x32x16_bf16 v[40:55], v[156:159], v[20:23], v[40:55]
 s_waitcnt vmcnt(7)
 v_exp_f32 v28, v28
 v_exp_f32 v29, v29
 v_exp_f32 v30, v30
 v_exp_f32 v31, v31
 v_cvt_pk_bf16_f32 v58, v28, v29
 v_cvt_pk_bf16_f32 v59, v30, v31
 v_mfma_f32_32x32x16_bf16 v[88:103], v[160:163], v[64:67], v[88:103]
 buffer_load_dwordx4 v[148:151], v4, s[4:7], s44 offen offset:2016
 v_exp_f32 v32, v32
 v_exp_f32 v33, v33
 v_exp_f32 v34, v34
 v_exp_f32 v35, v35
 v_cvt_pk_bf16_f32 v60, v32, v33
 v_cvt_pk_bf16_f32 v61, v34, v35
 v_mfma_f32_32x32x16_bf16 v[88:103], v[164:167], v[68:71], v[88:103]
 v_exp_f32 v36, v36
 v_exp_f32 v37, v37
 v_exp_f32 v38, v38
 v_exp_f32 v39, v39
 v_cvt_pk_bf16_f32 v62, v36, v37
 v_cvt_pk_bf16_f32 v63, v38, v39
 v_mfma_f32_32x32x16_bf16 v[24:39], v[104:107], v[8:11], 0
 v_exp_f32 v40, v40
 v_exp_f32 v41, v41
 v_exp_f32 v42, v42
 v_exp_f32 v43, v43
 v_cvt_pk_bf16_f32 v64, v40, v41
 v_cvt_pk_bf16_f32 v65, v42, v43
 v_mfma_f32_32x32x16_bf16 v[24:39], v[108:111], v[12:15], v[24:39]
 buffer_load_dwordx4 v[152:155], v2, s[4:7], s43 offen
 v_exp_f32 v44, v44
 v_exp_f32 v45, v45
 v_exp_f32 v46, v46
 v_exp_f32 v47, v47
 v_cvt_pk_bf16_f32 v66, v44, v45
 v_cvt_pk_bf16_f32 v67, v46, v47
 v_mfma_f32_32x32x16_bf16 v[72:87], v[112:115], v[56:59], v[72:87]
 buffer_load_dwordx2 v[156:157], v3, s[4:7], s43 offen
 v_exp_f32 v48, v48
 v_exp_f32 v49, v49
 v_exp_f32 v50, v50
 v_exp_f32 v51, v51
 v_cvt_pk_bf16_f32 v68, v48, v49
 v_cvt_pk_bf16_f32 v69, v50, v51
 v_mfma_f32_32x32x16_bf16 v[72:87], v[116:119], v[60:63], v[72:87]
 s_add_u32 s44, s44, 2688
 v_exp_f32 v52, v52
 v_exp_f32 v53, v53
 v_exp_f32 v54, v54
 v_exp_f32 v55, v55
 v_cvt_pk_bf16_f32 v70, v52, v53
 v_cvt_pk_bf16_f32 v71, v54, v55
 v_mfma_f32_32x32x16_bf16 v[40:55], v[104:107], v[16:19], 0
 buffer_load_dwordx4 v[160:163], v4, s[4:7], s44 offen
 v_exp_f32 v24, v24
 v_exp_f32 v25, v25
 v_exp_f32 v26, v26
 v_exp_f32 v27, v27
 v_cvt_pk_bf16_f32 v56, v24, v25
 v_cvt_pk_bf16_f32 v57, v26, v27
 v_mfma_f32_32x32x16_bf16 v[40:55], v[108:111], v[20:23], v[40:55]
 s_waitcnt vmcnt(7)
 v_exp_f32 v28, v28
 v_exp_f32 v29, v29
 v_exp_f32 v30, v30
 v_exp_f32 v31, v31
 v_cvt_pk_bf16_f32 v58, v28, v29
 v_cvt_pk_bf16_f32 v59, v30, v31
 v_mfma_f32_32x32x16_bf16 v[88:103], v[112:115], v[64:67], v[88:103]
 buffer_load_dwordx4 v[164:167], v4, s[4:7], s44 offen offset:672
 v_exp_f32 v32, v32
 v_exp_f32 v33, v33
 v_exp_f32 v34, v34
 v_exp_f32 v35, v35
 v_cvt_pk_bf16_f32 v60, v32, v33
 v_cvt_pk_bf16_f32 v61, v34, v35
 v_mfma_f32_32x32x16_bf16 v[88:103], v[116:119], v[68:71], v[88:103]
 s_add_u32 s43, s43, 122880
 v_exp_f32 v36, v36
 v_exp_f32 v37, v37
 v_exp_f32 v38, v38
 v_exp_f32 v39, v39
 v_cvt_pk_bf16_f32 v62, v36, v37
 v_cvt_pk_bf16_f32 v63, v38, v39
 v_mfma_f32_32x32x16_bf16 v[24:39], v[120:123], v[8:11], 0
 buffer_load_dwordx4 v[104:107], v2, s[4:7], s43 offen
 v_exp_f32 v40, v40
 v_exp_f32 v41, v41
 v_exp_f32 v42, v42
 v_exp_f32 v43, v43
 v_cvt_pk_bf16_f32 v64, v40, v41
 v_cvt_pk_bf16_f32 v65, v42, v43
 v_mfma_f32_32x32x16_bf16 v[24:39], v[124:127], v[12:15], v[24:39]
 v_exp_f32 v44, v44
 v_exp_f32 v45, v45
 v_exp_f32 v46, v46
 v_exp_f32 v47, v47
 v_cvt_pk_bf16_f32 v66, v44, v45
 v_cvt_pk_bf16_f32 v67, v46, v47
 v_mfma_f32_32x32x16_bf16 v[72:87], v[128:131], v[56:59], v[72:87]
 buffer_load_dwordx2 v[108:109], v3, s[4:7], s43 offen
 v_exp_f32 v48, v48
 v_exp_f32 v49, v49
 v_exp_f32 v50, v50
 v_exp_f32 v51, v51
 v_cvt_pk_bf16_f32 v68, v48, v49
 v_cvt_pk_bf16_f32 v69, v50, v51
 v_mfma_f32_32x32x16_bf16 v[72:87], v[132:135], v[60:63], v[72:87]
 s_add_u32 s43, s43, 122880
 v_exp_f32 v52, v52
 v_exp_f32 v53, v53
 v_exp_f32 v54, v54
 v_exp_f32 v55, v55
 v_cvt_pk_bf16_f32 v70, v52, v53
 v_cvt_pk_bf16_f32 v71, v54, v55
 v_mfma_f32_32x32x16_bf16 v[40:55], v[120:123], v[16:19], 0
 buffer_load_dwordx4 v[112:115], v4, s[4:7], s44 offen offset:1344
 v_exp_f32 v24, v24
 v_exp_f32 v25, v25
 v_exp_f32 v26, v26
 v_exp_f32 v27, v27
 v_cvt_pk_bf16_f32 v56, v24, v25
 v_cvt_pk_bf16_f32 v57, v26, v27
 v_mfma_f32_32x32x16_bf16 v[40:55], v[124:127], v[20:23], v[40:55]
 s_waitcnt vmcnt(7)
 v_exp_f32 v28, v28
 v_exp_f32 v29, v29
 v_exp_f32 v30, v30
 v_exp_f32 v31, v31
 v_cvt_pk_bf16_f32 v58, v28, v29
 v_cvt_pk_bf16_f32 v59, v30, v31
 v_mfma_f32_32x32x16_bf16 v[88:103], v[128:131], v[64:67], v[88:103]
 buffer_load_dwordx4 v[116:119], v4, s[4:7], s44 offen offset:2016
 v_exp_f32 v32, v32
 v_exp_f32 v33, v33
 v_exp_f32 v34, v34
 v_exp_f32 v35, v35
 v_cvt_pk_bf16_f32 v60, v32, v33
 v_cvt_pk_bf16_f32 v61, v34, v35
 v_mfma_f32_32x32x16_bf16 v[88:103], v[132:135], v[68:71], v[88:103]
 v_exp_f32 v36, v36
 v_exp_f32 v37, v37
 v_exp_f32 v38, v38
 v_exp_f32 v39, v39
 v_cvt_pk_bf16_f32 v62, v36, v37
 v_cvt_pk_bf16_f32 v63, v38, v39
 v_mfma_f32_32x32x16_bf16 v[24:39], v[136:139], v[8:11], 0
 buffer_load_dwordx4 v[120:123], v2, s[4:7], s43 offen
 v_exp_f32 v40, v40
 v_exp_f32 v41, v41
 v_exp_f32 v42, v42
 v_exp_f32 v43, v43
 v_cvt_pk_bf16_f32 v64, v40, v41
 v_cvt_pk_bf16_f32 v65, v42, v43
 v_mfma_f32_32x32x16_bf16 v[24:39], v[140:143], v[12:15], v[24:39]
 s_add_u32 s44, s44, 2688
 v_exp_f32 v44, v44
 v_exp_f32 v45, v45
 v_exp_f32 v46, v46
 v_exp_f32 v47, v47
 v_cvt_pk_bf16_f32 v66, v44, v45
 v_cvt_pk_bf16_f32 v67, v46, v47
 v_mfma_f32_32x32x16_bf16 v[72:87], v[144:147], v[56:59], v[72:87]
 buffer_load_dwordx2 v[124:125], v3, s[4:7], s43 offen
 v_exp_f32 v48, v48
 v_exp_f32 v49, v49
 v_exp_f32 v50, v50
 v_exp_f32 v51, v51
 v_cvt_pk_bf16_f32 v68, v48, v49
 v_cvt_pk_bf16_f32 v69, v50, v51
 v_mfma_f32_32x32x16_bf16 v[72:87], v[148:151], v[60:63], v[72:87]
 s_add_u32 s43, s43, 122880
 v_exp_f32 v52, v52
 v_exp_f32 v53, v53
 v_exp_f32 v54, v54
 v_exp_f32 v55, v55
 v_cvt_pk_bf16_f32 v70, v52, v53
 v_cvt_pk_bf16_f32 v71, v54, v55
 v_mfma_f32_32x32x16_bf16 v[40:55], v[136:139], v[16:19], 0
 buffer_load_dwordx4 v[128:131], v4, s[4:7], s44 offen
 v_exp_f32 v24, v24
 v_exp_f32 v25, v25
 v_exp_f32 v26, v26
 v_exp_f32 v27, v27
 v_cvt_pk_bf16_f32 v56, v24, v25
 v_cvt_pk_bf16_f32 v57, v26, v27
 v_mfma_f32_32x32x16_bf16 v[40:55], v[140:143], v[20:23], v[40:55]
 s_waitcnt vmcnt(7)
 v_exp_f32 v28, v28
 v_exp_f32 v29, v29
 v_exp_f32 v30, v30
 v_exp_f32 v31, v31
 v_cvt_pk_bf16_f32 v58, v28, v29
 v_cvt_pk_bf16_f32 v59, v30, v31
 v_mfma_f32_32x32x16_bf16 v[88:103], v[144:147], v[64:67], v[88:103]
 buffer_load_dwordx4 v[132:135], v4, s[4:7], s44 offen offset:672
 v_exp_f32 v32, v32
 v_exp_f32 v33, v33
 v_exp_f32 v34, v34
 v_exp_f32 v35, v35
 v_cvt_pk_bf16_f32 v60, v32, v33
 v_cvt_pk_bf16_f32 v61, v34, v35
 v_mfma_f32_32x32x16_bf16 v[88:103], v[148:151], v[68:71], v[88:103]
 v_exp_f32 v36, v36
 v_exp_f32 v37, v37
 v_exp_f32 v38, v38
 v_exp_f32 v39, v39
 v_cvt_pk_bf16_f32 v62, v36, v37
 v_cvt_pk_bf16_f32 v63, v38, v39
 v_mfma_f32_32x32x16_bf16 v[24:39], v[152:155], v[8:11], 0
 buffer_load_dwordx4 v[136:139], v2, s[4:7], s43 offen
 v_exp_f32 v40, v40
 v_exp_f32 v41, v41
 v_exp_f32 v42, v42
 v_exp_f32 v43, v43
 v_cvt_pk_bf16_f32 v64, v40, v41
 v_cvt_pk_bf16_f32 v65, v42, v43
 v_mfma_f32_32x32x16_bf16 v[24:39], v[156:159], v[12:15], v[24:39]
 v_exp_f32 v44, v44
 v_exp_f32 v45, v45
 v_exp_f32 v46, v46
 v_exp_f32 v47, v47
 v_cvt_pk_bf16_f32 v66, v44, v45
 v_cvt_pk_bf16_f32 v67, v46, v47
 v_mfma_f32_32x32x16_bf16 v[72:87], v[160:163], v[56:59], v[72:87]
 buffer_load_dwordx2 v[140:141], v3, s[4:7], s43 offen
 v_exp_f32 v48, v48
 v_exp_f32 v49, v49
 v_exp_f32 v50, v50
 v_exp_f32 v51, v51
 v_cvt_pk_bf16_f32 v68, v48, v49
 v_cvt_pk_bf16_f32 v69, v50, v51
 v_mfma_f32_32x32x16_bf16 v[72:87], v[164:167], v[60:63], v[72:87]
 s_add_u32 s43, s43, 122880
 v_exp_f32 v52, v52
 v_exp_f32 v53, v53
 v_exp_f32 v54, v54
 v_exp_f32 v55, v55
 v_cvt_pk_bf16_f32 v70, v52, v53
 v_cvt_pk_bf16_f32 v71, v54, v55
 v_mfma_f32_32x32x16_bf16 v[40:55], v[152:155], v[16:19], 0
 buffer_load_dwordx4 v[144:147], v4, s[4:7], s44 offen offset:1344
 v_exp_f32 v24, v24
 v_exp_f32 v25, v25
 v_exp_f32 v26, v26
 v_exp_f32 v27, v27
 v_cvt_pk_bf16_f32 v56, v24, v25
 v_cvt_pk_bf16_f32 v57, v26, v27
 v_mfma_f32_32x32x16_bf16 v[40:55], v[156:159], v[20:23], v[40:55]
 s_waitcnt vmcnt(7)
 v_exp_f32 v28, v28
 v_exp_f32 v29, v29
 v_exp_f32 v30, v30
 v_exp_f32 v31, v31
 v_cvt_pk_bf16_f32 v58, v28, v29
 v_cvt_pk_bf16_f32 v59, v30, v31
 v_mfma_f32_32x32x16_bf16 v[88:103], v[160:163], v[64:67], v[88:103]
 buffer_load_dwordx4 v[148:151], v4, s[4:7], s44 offen offset:2016
 v_exp_f32 v32, v32
 v_exp_f32 v33, v33
 v_exp_f32 v34, v34
 v_exp_f32 v35, v35
 v_cvt_pk_bf16_f32 v60, v32, v33
 v_cvt_pk_bf16_f32 v61, v34, v35
 v_mfma_f32_32x32x16_bf16 v[88:103], v[164:167], v[68:71], v[88:103]
 s_sub_u32 s48, s48, 1
 v_exp_f32 v36, v36
 v_exp_f32 v37, v37
 v_exp_f32 v38, v38
 v_exp_f32 v39, v39
 v_cvt_pk_bf16_f32 v62, v36, v37
 v_cvt_pk_bf16_f32 v63, v38, v39
 v_mfma_f32_32x32x16_bf16 v[24:39], v[104:107], v[8:11], 0
 s_cbranch_scc0 C2_ATT_loop
 s_nop 7
 s_nop 3
 s_mov_b32 s45, 0x53800000
 v_mov_b32 v5, s45
 v_cmp_nlt_f32 s[46:47], v84, v5
 v_cmp_nlt_f32 vcc, v100, v5
 s_nop 3
 s_or_b64 vcc, vcc, s[46:47]
 s_cbranch_vccz C2_ATT_fin
 s_cmp_lg_u32 s49, 0
 s_cbranch_scc1 C2_ATT_fin
 s_mov_b32 s49, 1
 s_waitcnt vmcnt(0)
 s_mov_b32 exec_hi, 0
 v_mov_b32 v14, 0
 v_mov_b32 v22, 0
 s_mov_b32 exec_hi, -1
 v_mov_b32 v6, 0xff61b1e6
 v_mov_b32 v7, 0xff61b1e6
 s_mov_b32 s43, 18313216
 s_mov_b32 s48, 64
C2_ATT_fb:
 buffer_load_dwordx4 v[152:155], v2, s[4:7], s43 offen
 buffer_load_dwordx2 v[156:157], v3, s[4:7], s43 offen
 s_add_u32 s43, s43, 122880
 s_waitcnt vmcnt(0)
 v_mfma_f32_32x32x16_bf16 v[24:39], v[152:155], v[8:11], 0
 v_mfma_f32_32x32x16_bf16 v[24:39], v[156:159], v[12:15], v[24:39]
 v_mfma_f32_32x32x16_bf16 v[40:55], v[152:155], v[16:19], 0
 v_mfma_f32_32x32x16_bf16 v[40:55], v[156:159], v[20:23], v[40:55]
 s_nop 7
 s_nop 1
 v_max3_f32 v6, v6, v24, v25
 v_max3_f32 v6, v6, v26, v27
 v_max3_f32 v6, v6, v28, v29
 v_max3_f32 v6, v6, v30, v31
 v_max3_f32 v6, v6, v32, v33
 v_max3_f32 v6, v6, v34, v35
 v_max3_f32 v6, v6, v36, v37
 v_max3_f32 v6, v6, v38, v39
 v_max3_f32 v7, v7, v40, v41
 v_max3_f32 v7, v7, v42, v43
 v_max3_f32 v7, v7, v44, v45
 v_max3_f32 v7, v7, v46, v47
 v_max3_f32 v7, v7, v48, v49
 v_max3_f32 v7, v7, v50, v51
 v_max3_f32 v7, v7, v52, v53
 v_max3_f32 v7, v7, v54, v55
 s_sub_u32 s48, s48, 1
 s_cmp_lg_u32 s48, 0
 s_cbranch_scc1 C2_ATT_fb
 v_mov_b32 v5, v6
 s_nop 1
 v_permlane32_swap_b32 v6, v5
 v_max_f32 v6, v6, v5
 v_sub_f32 v6, 0, v6
 v_cvt_pk_bf16_f32 v6, v6, 0
 v_and_b32 v6, 0xffff, v6
 s_mov_b32 exec_hi, 0
 v_mov_b32 v14, v6
 s_mov_b32 exec_hi, -1
 v_mov_b32 v5, v7
 s_nop 1
 v_permlane32_swap_b32 v7, v5
 v_max_f32 v7, v7, v5
 v_sub_f32 v7, 0, v7
 v_cvt_pk_bf16_f32 v7, v7, 0
 v_and_b32 v7, 0xffff, v7
 s_mov_b32 exec_hi, 0
 v_mov_b32 v22, v7
 s_mov_b32 exec_hi, -1
 s_branch C2_ATT_start
C2_ATT_fin:
 s_barrier
 v_mov_b32 v5, 162816
 ds_read_b32 v5, v5
 v_rcp_f32 v6, v84
 v_rcp_f32 v7, v100
 v_mul_f32 v72, v72, v6
 v_mul_f32 v73, v73, v6
 v_mul_f32 v74, v74, v6
 v_mul_f32 v75, v75, v6
 v_mul_f32 v76, v76, v6
 v_mul_f32 v77, v77, v6
 v_mul_f32 v78, v78, v6
 v_mul_f32 v79, v79, v6
 v_mul_f32 v80, v80, v6
 v_mul_f32 v81, v81, v6
 v_mul_f32 v82, v82, v6
 v_mul_f32 v83, v83, v6
 v_mul_f32 v88, v88, v7
 v_mul_f32 v89, v89, v7
 v_mul_f32 v90, v90, v7
 v_mul_f32 v91, v91, v7
 v_mul_f32 v92, v92, v7
 v_mul_f32 v93, v93, v7
 v_mul_f32 v94, v94, v7
 v_mul_f32 v95, v95, v7
 v_mul_f32 v96, v96, v7
 v_mul_f32 v97, v97, v7
 v_mul_f32 v98, v98, v7
 v_mul_f32 v99, v99, v7
 v_cvt_pk_bf16_f32 v24, v72, v73
 v_cvt_pk_bf16_f32 v25, v74, v75
 v_cvt_pk_bf16_f32 v26, v76, v77
 v_cvt_pk_bf16_f32 v27, v78, v79
 v_cvt_pk_bf16_f32 v28, v80, v81
 v_cvt_pk_bf16_f32 v29, v82, v83
 v_cvt_pk_bf16_f32 v32, v88, v89
 v_cvt_pk_bf16_f32 v33, v90, v91
 v_cvt_pk_bf16_f32 v34, v92, v93
 v_cvt_pk_bf16_f32 v35, v94, v95
 v_cvt_pk_bf16_f32 v36, v96, v97
 v_cvt_pk_bf16_f32 v37, v98, v99
 v_permlane32_swap_b32 v24, v26
 v_permlane32_swap_b32 v25, v27
 v_permlane32_swap_b32 v32, v34
 v_permlane32_swap_b32 v33, v35
 s_waitcnt lgkmcnt(0)
 v_readfirstlane_b32 s33, v5
 s_lshl_b32 s45, s42, 7
 s_lshl_b32 s46, s41, 2
 s_add_u32 s45, s45, s46
 s_add_u32 s47, s45, 0x6f1000
 s_add_u32 s45, s45, 0x6ef000
 s_cmp_eq_u32 s33, 0
 s_cbranch_scc1 C2_oe_slow
 buffer_store_dwordx4 v[24:27], v168, s[4:7], s52 offen
 buffer_store_dwordx4 v[32:35], v168, s[4:7], s53 offen
 s_mov_b32 exec_hi, 0
 buffer_store_dwordx2 v[28:29], v169, s[4:7], s52 offen
 buffer_store_dwordx2 v[36:37], v169, s[4:7], s53 offen
 s_mov_b64 exec, 1
 v_mov_b32 v8, 0
 v_mov_b32 v9, 1
 s_waitcnt vmcnt(0)
 buffer_store_dword v9, v8, s[4:7], s45 offen
 buffer_store_dword v9, v8, s[4:7], s47 offen sc1
 s_mov_b64 exec, -1
C2_oe_join:
 v_lshrrev_b32 v8, 4, v1
 v_and_b32 v9, 1, v8
 v_lshrrev_b32 v8, 1, v8
 v_and_b32 v7, 15, v1
 v_lshlrev_b32 v7, 4, v7
 v_lshlrev_b32 v6, 8, v8
 v_add_u32 v6, v6, v7
 v_lshlrev_b32 v5, 9, v9
 v_add_u32 v5, v5, v6
 v_lshlrev_b32 v9, 3, v9
 v_add_u32 v6, v6, v9
 v_lshlrev_b32 v3, 4, v1
 s_lshl_b32 s23, s20, 11
 v_add_u32 v2, s23, v3
 v_add_u32 v3, 49152, v3
 v_add_u32 v4, 0x10000, v3
 s_lshl_b32 s30, s21, 2
 s_add_u32 s30, s30, s20
 s_mul_i32 s30, s30, 20480
 s_mul_i32 s23, s22, 2560
 s_add_u32 s30, s30, s23
 s_add_u32 s24, s30, 0xbf2000
 buffer_load_dwordx2 v[10:11], v6, s[4:7], s24 offen offset:0
 buffer_load_dwordx2 v[12:13], v6, s[4:7], s24 offen offset:512
 buffer_load_dwordx2 v[14:15], v6, s[4:7], s24 offen offset:1024
 buffer_load_dwordx2 v[16:17], v6, s[4:7], s24 offen offset:1536
 buffer_load_dwordx2 v[18:19], v6, s[4:7], s24 offen offset:2048
 s_waitcnt vmcnt(0)
 v_lshlrev_b32 v20, 16, v10
 v_and_b32 v21, 0xffff0000, v10
 v_lshlrev_b32 v22, 16, v11
 v_and_b32 v23, 0xffff0000, v11
 v_lshlrev_b32 v24, 16, v12
 v_and_b32 v25, 0xffff0000, v12
 v_lshlrev_b32 v26, 16, v13
 v_and_b32 v27, 0xffff0000, v13
 v_lshlrev_b32 v28, 16, v14
 v_and_b32 v29, 0xffff0000, v14
 v_lshlrev_b32 v30, 16, v15
 v_and_b32 v31, 0xffff0000, v15
 v_lshlrev_b32 v32, 16, v16
 v_and_b32 v33, 0xffff0000, v16
 v_lshlrev_b32 v34, 16, v17
 v_and_b32 v35, 0xffff0000, v17
 v_lshlrev_b32 v36, 16, v18
 v_and_b32 v37, 0xffff0000, v18
 v_lshlrev_b32 v38, 16, v19
 v_and_b32 v39, 0xffff0000, v19
 s_lshl_b32 s26, s21, 2
 s_add_u32 s26, s26, s20
 s_lshl_b32 s26, s26, 10
 s_lshr_b32 s23, s22, 1
 s_lshl_b32 s23, s23, 8
 s_add_u32 s26, s26, s23
 s_and_b32 s23, s22, 1
 s_lshl_b32 s23, s23, 3
 s_add_u32 s26, s26, s23
 s_add_u32 s26, s26, 0x1112000
 v_and_b32 v70, 15, v1
 v_lshlrev_b32 v70, 4, v70
 s_barrier
 ds_read_b128 v[104:107], v2 offset:0
 ds_read_b128 v[84:87], v3 offset:0
 ds_read_b128 v[88:91], v3 offset:1024
 ds_read_b128 v[92:95], v3 offset:2048
 ds_read_b128 v[96:99], v3 offset:3072
 ds_read_b128 v[100:103], v3 offset:4096
 ds_read_b128 v[128:131], v2 offset:1024
 ds_read_b128 v[108:111], v3 offset:5120
 ds_read_b128 v[112:115], v3 offset:6144
 ds_read_b128 v[116:119], v3 offset:7168
 ds_read_b128 v[120:123], v3 offset:8192
 ds_read_b128 v[124:127], v3 offset:9216
 s_waitcnt lgkmcnt(6)
 v_mfma_f32_16x16x32_bf16 v[20:23], v[84:87], v[104:107], v[20:23]
 s_barrier
 ds_read_b128 v[152:155], v2 offset:8192
 ds_read_b128 v[132:135], v3 offset:10240
 v_mfma_f32_16x16x32_bf16 v[24:27], v[88:91], v[104:107], v[24:27]
 ds_read_b128 v[136:139], v3 offset:11264
 v_mfma_f32_16x16x32_bf16 v[28:31], v[92:95], v[104:107], v[28:31]
 ds_read_b128 v[140:143], v3 offset:12288
 v_mfma_f32_16x16x32_bf16 v[32:35], v[96:99], v[104:107], v[32:35]
 ds_read_b128 v[144:147], v3 offset:13312
 v_mfma_f32_16x16x32_bf16 v[36:39], v[100:103], v[104:107], v[36:39]
 ds_read_b128 v[148:151], v3 offset:14336
 s_waitcnt lgkmcnt(6)
 v_mfma_f32_16x16x32_bf16 v[20:23], v[108:111], v[128:131], v[20:23]
 ds_read_b128 v[176:179], v2 offset:9216
 ds_read_b128 v[156:159], v3 offset:15360
 v_mfma_f32_16x16x32_bf16 v[24:27], v[112:115], v[128:131], v[24:27]
 ds_read_b128 v[160:163], v3 offset:16384
 v_mfma_f32_16x16x32_bf16 v[28:31], v[116:119], v[128:131], v[28:31]
 ds_read_b128 v[164:167], v3 offset:17408
 v_mfma_f32_16x16x32_bf16 v[32:35], v[120:123], v[128:131], v[32:35]
 ds_read_b128 v[168:171], v3 offset:18432
 v_mfma_f32_16x16x32_bf16 v[36:39], v[124:127], v[128:131], v[36:39]
 ds_read_b128 v[172:175], v3 offset:19456
 s_waitcnt lgkmcnt(6)
 v_mfma_f32_16x16x32_bf16 v[20:23], v[132:135], v[152:155], v[20:23]
 s_barrier
 ds_read_b128 v[104:107], v2 offset:16384
 ds_read_b128 v[84:87], v3 offset:20480
 v_mfma_f32_16x16x32_bf16 v[24:27], v[136:139], v[152:155], v[24:27]
 ds_read_b128 v[88:91], v3 offset:21504
 v_mfma_f32_16x16x32_bf16 v[28:31], v[140:143], v[152:155], v[28:31]
 ds_read_b128 v[92:95], v3 offset:22528
 v_mfma_f32_16x16x32_bf16 v[32:35], v[144:147], v[152:155], v[32:35]
 ds_read_b128 v[96:99], v3 offset:23552
 v_mfma_f32_16x16x32_bf16 v[36:39], v[148:151], v[152:155], v[36:39]
 ds_read_b128 v[100:103], v3 offset:24576
 s_waitcnt lgkmcnt(6)
 v_mfma_f32_16x16x32_bf16 v[20:23], v[156:159], v[176:179], v[20:23]
 ds_read_b128 v[128:131], v2 offset:17408
 ds_read_b128 v[108:111], v3 offset:25600
 v_mfma_f32_16x16x32_bf16 v[24:27], v[160:163], v[176:179], v[24:27]
 ds_read_b128 v[112:115], v3 offset:26624
 v_mfma_f32_16x16x32_bf16 v[28:31], v[164:167], v[176:179], v[28:31]
 ds_read_b128 v[116:119], v3 offset:27648
 v_mfma_f32_16x16x32_bf16 v[32:35], v[168:171], v[176:179], v[32:35]
 ds_read_b128 v[120:123], v3 offset:28672
 v_mfma_f32_16x16x32_bf16 v[36:39], v[172:175], v[176:179], v[36:39]
 ds_read_b128 v[124:127], v3 offset:29696
 s_waitcnt lgkmcnt(6)
 v_mfma_f32_16x16x32_bf16 v[20:23], v[84:87], v[104:107], v[20:23]
 s_barrier
 ds_read_b128 v[152:155], v2 offset:24576
 ds_read_b128 v[132:135], v3 offset:30720
 v_mfma_f32_16x16x32_bf16 v[24:27], v[88:91], v[104:107], v[24:27]
 ds_read_b128 v[136:139], v3 offset:31744
 v_mfma_f32_16x16x32_bf16 v[28:31], v[92:95], v[104:107], v[28:31]
 ds_read_b128 v[140:143], v3 offset:32768
 v_mfma_f32_16x16x32_bf16 v[32:35], v[96:99], v[104:107], v[32:35]
 ds_read_b128 v[144:147], v3 offset:33792
 v_mfma_f32_16x16x32_bf16 v[36:39], v[100:103], v[104:107], v[36:39]
 ds_read_b128 v[148:151], v3 offset:34816
 s_waitcnt lgkmcnt(6)
 v_mfma_f32_16x16x32_bf16 v[20:23], v[108:111], v[128:131], v[20:23]
 ds_read_b128 v[176:179], v2 offset:25600
 ds_read_b128 v[156:159], v3 offset:35840
 v_mfma_f32_16x16x32_bf16 v[24:27], v[112:115], v[128:131], v[24:27]
 ds_read_b128 v[160:163], v3 offset:36864
 v_mfma_f32_16x16x32_bf16 v[28:31], v[116:119], v[128:131], v[28:31]
 ds_read_b128 v[164:167], v3 offset:37888
 v_mfma_f32_16x16x32_bf16 v[32:35], v[120:123], v[128:131], v[32:35]
 ds_read_b128 v[168:171], v3 offset:38912
 v_mfma_f32_16x16x32_bf16 v[36:39], v[124:127], v[128:131], v[36:39]
 ds_read_b128 v[172:175], v3 offset:39936
 s_waitcnt lgkmcnt(6)
 v_mfma_f32_16x16x32_bf16 v[20:23], v[132:135], v[152:155], v[20:23]
 s_barrier
 ds_read_b128 v[104:107], v2 offset:32768
 ds_read_b128 v[84:87], v3 offset:40960
 v_mfma_f32_16x16x32_bf16 v[24:27], v[136:139], v[152:155], v[24:27]
 ds_read_b128 v[88:91], v3 offset:41984
 v_mfma_f32_16x16x32_bf16 v[28:31], v[140:143], v[152:155], v[28:31]
 ds_read_b128 v[92:95], v3 offset:43008
 v_mfma_f32_16x16x32_bf16 v[32:35], v[144:147], v[152:155], v[32:35]
 ds_read_b128 v[96:99], v3 offset:44032
 v_mfma_f32_16x16x32_bf16 v[36:39], v[148:151], v[152:155], v[36:39]
 ds_read_b128 v[100:103], v3 offset:45056
 s_waitcnt lgkmcnt(6)
 v_mfma_f32_16x16x32_bf16 v[20:23], v[156:159], v[176:179], v[20:23]
 ds_read_b128 v[128:131], v2 offset:33792
 ds_read_b128 v[108:111], v3 offset:46080
 v_mfma_f32_16x16x32_bf16 v[24:27], v[160:163], v[176:179], v[24:27]
 ds_read_b128 v[112:115], v3 offset:47104
 v_mfma_f32_16x16x32_bf16 v[28:31], v[164:167], v[176:179], v[28:31]
 ds_read_b128 v[116:119], v3 offset:48128
 v_mfma_f32_16x16x32_bf16 v[32:35], v[168:171], v[176:179], v[32:35]
 ds_read_b128 v[120:123], v3 offset:49152
 v_mfma_f32_16x16x32_bf16 v[36:39], v[172:175], v[176:179], v[36:39]
 ds_read_b128 v[124:127], v3 offset:50176
 s_waitcnt lgkmcnt(6)
 v_mfma_f32_16x16x32_bf16 v[20:23], v[84:87], v[104:107], v[20:23]
 s_barrier
 ds_read_b128 v[152:155], v2 offset:40960
 ds_read_b128 v[132:135], v3 offset:51200
 v_mfma_f32_16x16x32_bf16 v[24:27], v[88:91], v[104:107], v[24:27]
 ds_read_b128 v[136:139], v3 offset:52224
 v_mfma_f32_16x16x32_bf16 v[28:31], v[92:95], v[104:107], v[28:31]
 ds_read_b128 v[140:143], v3 offset:53248
 v_mfma_f32_16x16x32_bf16 v[32:35], v[96:99], v[104:107], v[32:35]
 ds_read_b128 v[144:147], v3 offset:54272
 v_mfma_f32_16x16x32_bf16 v[36:39], v[100:103], v[104:107], v[36:39]
 ds_read_b128 v[148:151], v3 offset:55296
 s_waitcnt lgkmcnt(6)
 v_mfma_f32_16x16x32_bf16 v[20:23], v[108:111], v[128:131], v[20:23]
 ds_read_b128 v[176:179], v2 offset:41984
 ds_read_b128 v[156:159], v3 offset:56320
 v_mfma_f32_16x16x32_bf16 v[24:27], v[112:115], v[128:131], v[24:27]
 ds_read_b128 v[160:163], v3 offset:57344
 v_mfma_f32_16x16x32_bf16 v[28:31], v[116:119], v[128:131], v[28:31]
 ds_read_b128 v[164:167], v3 offset:58368
 v_mfma_f32_16x16x32_bf16 v[32:35], v[120:123], v[128:131], v[32:35]
 ds_read_b128 v[168:171], v3 offset:59392
 v_mfma_f32_16x16x32_bf16 v[36:39], v[124:127], v[128:131], v[36:39]
 ds_read_b128 v[172:175], v3 offset:60416
 s_waitcnt lgkmcnt(6)
 v_mfma_f32_16x16x32_bf16 v[20:23], v[132:135], v[152:155], v[20:23]
 s_barrier
 ds_read_b128 v[104:107], v2 offset:0
 ds_read_b128 v[84:87], v3 offset:61440
 v_mfma_f32_16x16x32_bf16 v[24:27], v[136:139], v[152:155], v[24:27]
 ds_read_b128 v[88:91], v3 offset:62464
 v_mfma_f32_16x16x32_bf16 v[28:31], v[140:143], v[152:155], v[28:31]
 ds_read_b128 v[92:95], v3 offset:63488
 v_mfma_f32_16x16x32_bf16 v[32:35], v[144:147], v[152:155], v[32:35]
 ds_read_b128 v[96:99], v3 offset:64512
 v_mfma_f32_16x16x32_bf16 v[36:39], v[148:151], v[152:155], v[36:39]
 ds_read_b128 v[100:103], v4 offset:0
 s_waitcnt lgkmcnt(6)
 v_mfma_f32_16x16x32_bf16 v[20:23], v[156:159], v[176:179], v[20:23]
 ds_read_b128 v[128:131], v2 offset:1024
 ds_read_b128 v[108:111], v4 offset:1024
 v_mfma_f32_16x16x32_bf16 v[24:27], v[160:163], v[176:179], v[24:27]
 ds_read_b128 v[112:115], v4 offset:2048
 v_mfma_f32_16x16x32_bf16 v[28:31], v[164:167], v[176:179], v[28:31]
 ds_read_b128 v[116:119], v4 offset:3072
 v_mfma_f32_16x16x32_bf16 v[32:35], v[168:171], v[176:179], v[32:35]
 ds_read_b128 v[120:123], v4 offset:4096
 v_mfma_f32_16x16x32_bf16 v[36:39], v[172:175], v[176:179], v[36:39]
 ds_read_b128 v[124:127], v4 offset:5120
 s_waitcnt lgkmcnt(6)
 v_mfma_f32_16x16x32_bf16 v[20:23], v[84:87], v[104:107], v[20:23]
 s_barrier
 ds_read_b128 v[152:155], v2 offset:8192
 ds_read_b128 v[132:135], v4 offset:6144
 v_mfma_f32_16x16x32_bf16 v[24:27], v[88:91], v[104:107], v[24:27]
 ds_read_b128 v[136:139], v4 offset:7168
 v_mfma_f32_16x16x32_bf16 v[28:31], v[92:95], v[104:107], v[28:31]
 ds_read_b128 v[140:143], v4 offset:8192
 v_mfma_f32_16x16x32_bf16 v[32:35], v[96:99], v[104:107], v[32:35]
 ds_read_b128 v[144:147], v4 offset:9216
 v_mfma_f32_16x16x32_bf16 v[36:39], v[100:103], v[104:107], v[36:39]
 ds_read_b128 v[148:151], v4 offset:10240
 s_waitcnt lgkmcnt(6)
 v_mfma_f32_16x16x32_bf16 v[20:23], v[108:111], v[128:131], v[20:23]
 ds_read_b128 v[176:179], v2 offset:9216
 ds_read_b128 v[156:159], v4 offset:11264
 v_mfma_f32_16x16x32_bf16 v[24:27], v[112:115], v[128:131], v[24:27]
 ds_read_b128 v[160:163], v4 offset:12288
 v_mfma_f32_16x16x32_bf16 v[28:31], v[116:119], v[128:131], v[28:31]
 ds_read_b128 v[164:167], v4 offset:13312
 v_mfma_f32_16x16x32_bf16 v[32:35], v[120:123], v[128:131], v[32:35]
 ds_read_b128 v[168:171], v4 offset:14336
 v_mfma_f32_16x16x32_bf16 v[36:39], v[124:127], v[128:131], v[36:39]
 ds_read_b128 v[172:175], v4 offset:15360
 s_waitcnt lgkmcnt(6)
 v_mfma_f32_16x16x32_bf16 v[20:23], v[132:135], v[152:155], v[20:23]
 s_barrier
 ds_read_b128 v[104:107], v2 offset:16384
 ds_read_b128 v[84:87], v4 offset:16384
 v_mfma_f32_16x16x32_bf16 v[24:27], v[136:139], v[152:155], v[24:27]
 ds_read_b128 v[88:91], v4 offset:17408
 v_mfma_f32_16x16x32_bf16 v[28:31], v[140:143], v[152:155], v[28:31]
 ds_read_b128 v[92:95], v4 offset:18432
 v_mfma_f32_16x16x32_bf16 v[32:35], v[144:147], v[152:155], v[32:35]
 ds_read_b128 v[96:99], v4 offset:19456
 v_mfma_f32_16x16x32_bf16 v[36:39], v[148:151], v[152:155], v[36:39]
 ds_read_b128 v[100:103], v4 offset:20480
 s_waitcnt lgkmcnt(6)
 v_mfma_f32_16x16x32_bf16 v[20:23], v[156:159], v[176:179], v[20:23]
 ds_read_b128 v[128:131], v2 offset:17408
 ds_read_b128 v[108:111], v4 offset:21504
 v_mfma_f32_16x16x32_bf16 v[24:27], v[160:163], v[176:179], v[24:27]
 ds_read_b128 v[112:115], v4 offset:22528
 v_mfma_f32_16x16x32_bf16 v[28:31], v[164:167], v[176:179], v[28:31]
 ds_read_b128 v[116:119], v4 offset:23552
 v_mfma_f32_16x16x32_bf16 v[32:35], v[168:171], v[176:179], v[32:35]
 ds_read_b128 v[120:123], v4 offset:24576
 v_mfma_f32_16x16x32_bf16 v[36:39], v[172:175], v[176:179], v[36:39]
 ds_read_b128 v[124:127], v4 offset:25600
 s_waitcnt lgkmcnt(6)
 v_mfma_f32_16x16x32_bf16 v[20:23], v[84:87], v[104:107], v[20:23]
 s_barrier
 ds_read_b128 v[152:155], v2 offset:24576
 ds_read_b128 v[132:135], v4 offset:26624
 v_mfma_f32_16x16x32_bf16 v[24:27], v[88:91], v[104:107], v[24:27]
 ds_read_b128 v[136:139], v4 offset:27648
 v_mfma_f32_16x16x32_bf16 v[28:31], v[92:95], v[104:107], v[28:31]
 ds_read_b128 v[140:143], v4 offset:28672
 v_mfma_f32_16x16x32_bf16 v[32:35], v[96:99], v[104:107], v[32:35]
 ds_read_b128 v[144:147], v4 offset:29696
 v_mfma_f32_16x16x32_bf16 v[36:39], v[100:103], v[104:107], v[36:39]
 ds_read_b128 v[148:151], v4 offset:30720
 s_waitcnt lgkmcnt(6)
 v_mfma_f32_16x16x32_bf16 v[20:23], v[108:111], v[128:131], v[20:23]
 ds_read_b128 v[176:179], v2 offset:25600
 ds_read_b128 v[156:159], v4 offset:31744
 v_mfma_f32_16x16x32_bf16 v[24:27], v[112:115], v[128:131], v[24:27]
 ds_read_b128 v[160:163], v4 offset:32768
 v_mfma_f32_16x16x32_bf16 v[28:31], v[116:119], v[128:131], v[28:31]
 ds_read_b128 v[164:167], v4 offset:33792
 v_mfma_f32_16x16x32_bf16 v[32:35], v[120:123], v[128:131], v[32:35]
 ds_read_b128 v[168:171], v4 offset:34816
 v_mfma_f32_16x16x32_bf16 v[36:39], v[124:127], v[128:131], v[36:39]
 ds_read_b128 v[172:175], v4 offset:35840
 s_waitcnt lgkmcnt(6)
 v_mfma_f32_16x16x32_bf16 v[20:23], v[132:135], v[152:155], v[20:23]
 s_barrier
 v_mfma_f32_16x16x32_bf16 v[24:27], v[136:139], v[152:155], v[24:27]
 v_mfma_f32_16x16x32_bf16 v[28:31], v[140:143], v[152:155], v[28:31]
 v_mfma_f32_16x16x32_bf16 v[32:35], v[144:147], v[152:155], v[32:35]
 v_mfma_f32_16x16x32_bf16 v[36:39], v[148:151], v[152:155], v[36:39]
 s_waitcnt lgkmcnt(0)
 v_mfma_f32_16x16x32_bf16 v[20:23], v[156:159], v[176:179], v[20:23]
 v_mfma_f32_16x16x32_bf16 v[24:27], v[160:163], v[176:179], v[24:27]
 v_mfma_f32_16x16x32_bf16 v[28:31], v[164:167], v[176:179], v[28:31]
 v_mfma_f32_16x16x32_bf16 v[32:35], v[168:171], v[176:179], v[32:35]
 v_mfma_f32_16x16x32_bf16 v[36:39], v[172:175], v[176:179], v[36:39]
 s_nop 3
 v_cvt_pk_bf16_f32 v10, v20, v21
 v_cvt_pk_bf16_f32 v11, v22, v23
 v_cvt_pk_bf16_f32 v12, v24, v25
 v_cvt_pk_bf16_f32 v13, v26, v27
 v_cvt_pk_bf16_f32 v14, v28, v29
 v_cvt_pk_bf16_f32 v15, v30, v31
 v_cvt_pk_bf16_f32 v16, v32, v33
 v_cvt_pk_bf16_f32 v17, v34, v35
 v_cvt_pk_bf16_f32 v18, v36, v37
 v_cvt_pk_bf16_f32 v19, v38, v39
 v_permlane16_swap_b32 v10, v12
 v_permlane16_swap_b32 v11, v13
 v_permlane16_swap_b32 v14, v16
 v_permlane16_swap_b32 v15, v17
 s_cmp_eq_u32 s33, 0
 s_cbranch_scc1 C2_e0_slow
 s_add_u32 s24, s30, 0xbf2000
 buffer_store_dwordx4 v[10:13], v5, s[4:7], s24 offen offset:0
 buffer_store_dwordx4 v[14:17], v5, s[4:7], s24 offen offset:1024
 buffer_store_dwordx2 v[18:19], v6, s[4:7], s24 offen offset:2048
 v_pk_add_f32 v[204:205], v[20:21], v[22:23]
 v_pk_mul_f32 v[206:207], v[20:21], v[20:21]
 v_pk_fma_f32 v[206:207], v[22:23], v[22:23], v[206:207]
 v_pk_add_f32 v[208:209], v[24:25], v[26:27]
 v_pk_mul_f32 v[210:211], v[24:25], v[24:25]
 v_pk_fma_f32 v[210:211], v[26:27], v[26:27], v[210:211]
 v_pk_add_f32 v[204:205], v[204:205], v[28:29]
 v_pk_fma_f32 v[206:207], v[28:29], v[28:29], v[206:207]
 v_pk_add_f32 v[208:209], v[208:209], v[30:31]
 v_pk_fma_f32 v[210:211], v[30:31], v[30:31], v[210:211]
 v_pk_add_f32 v[204:205], v[204:205], v[32:33]
 v_pk_fma_f32 v[206:207], v[32:33], v[32:33], v[206:207]
 v_pk_add_f32 v[208:209], v[208:209], v[34:35]
 v_pk_fma_f32 v[210:211], v[34:35], v[34:35], v[210:211]
 v_pk_add_f32 v[204:205], v[204:205], v[36:37]
 v_pk_fma_f32 v[206:207], v[36:37], v[36:37], v[206:207]
 v_pk_add_f32 v[208:209], v[208:209], v[38:39]
 v_pk_fma_f32 v[210:211], v[38:39], v[38:39], v[210:211]
 v_pk_add_f32 v[204:205], v[204:205], v[208:209]
 v_pk_add_f32 v[206:207], v[206:207], v[210:211]
 v_add_f32 v212, v204, v205
 v_add_f32 v213, v206, v207
 v_mov_b32 v214, v212
 v_mov_b32 v215, v213
 s_nop 0
 v_permlane16_swap_b32 v212, v214
 v_permlane16_swap_b32 v213, v215
 v_add_f32 v212, v212, v214
 v_add_f32 v213, v213, v215
 v_mov_b32 v214, v212
 v_mov_b32 v215, v213
 s_nop 0
 v_permlane32_swap_b32 v212, v214
 v_permlane32_swap_b32 v213, v215
 v_add_f32 v212, v212, v214
 v_add_f32 v213, v213, v215
 s_mov_b64 exec, 0xffff
 buffer_store_dwordx2 v[212:213], v70, s[4:7], s26 offen
 s_mov_b64 exec, -1
 s_lshl_b32 s23, s21, 7
 s_lshl_b32 s24, s22, 4
 s_add_u32 s23, s23, s24
 s_lshl_b32 s24, s20, 2
 s_add_u32 s23, s23, s24
 s_add_u32 s23, s23, 0x6eb000
 v_mov_b32 v8, 0
 v_mov_b32 v9, 1
 s_mov_b64 exec, 1
 s_waitcnt vmcnt(0)
 buffer_store_dword v9, v8, s[4:7], s23 offen
 s_mov_b64 exec, -1
C2_e0_join:
 v_permlane16_swap_b32 v10, v12
 v_permlane16_swap_b32 v11, v13
 v_permlane16_swap_b32 v14, v16
 v_permlane16_swap_b32 v15, v17
 v_lshlrev_b32 v2, 4, v1
 s_mul_i32 s23, s20, 3072
 s_add_u32 s23, s23, 49152
 v_add_u32 v3, s23, v2
 v_add_u32 v4, 0x10000, v3
 v_lshrrev_b32 v8, 4, v1
 v_lshlrev_b32 v9, 3, v8
 v_lshlrev_b32 v8, 4, v8
 s_mul_i32 s23, s22, 12
 s_mul_i32 s24, s20, 3
 s_add_u32 s31, s23, s24
 s_lshl_b32 s23, s31, 6
 s_add_u32 s23, s23, 0x6e1e00
 s_lshl_b32 s24, s31, 5
 buffer_load_dwordx4 v[180:183], v8, s[4:7], s23 offen offset:0
 buffer_load_dwordx4 v[184:187], v8, s[4:7], s23 offen offset:64
 buffer_load_dwordx4 v[188:191], v8, s[4:7], s23 offen offset:128
 s_add_u32 s23, s23, 6144
 buffer_load_dwordx4 v[204:207], v8, s[4:7], s23 offen offset:0
 buffer_load_dwordx4 v[208:211], v8, s[4:7], s23 offen offset:64
 buffer_load_dwordx4 v[212:215], v8, s[4:7], s23 offen offset:128
 s_add_u32 s23, s23, 6144
 buffer_load_dwordx4 v[216:219], v8, s[4:7], s23 offen offset:0
 buffer_load_dwordx4 v[220:223], v8, s[4:7], s23 offen offset:64
 buffer_load_dwordx4 v[224:227], v8, s[4:7], s23 offen offset:128
 s_add_u32 s23, s23, 6144
 buffer_load_dwordx4 v[228:231], v8, s[4:7], s23 offen offset:0
 buffer_load_dwordx4 v[232:235], v8, s[4:7], s23 offen offset:64
 buffer_load_dwordx4 v[236:239], v8, s[4:7], s23 offen offset:128
 buffer_load_dwordx2 v[192:193], v9, s[8:11], s24 offen offset:0
 buffer_load_dwordx2 v[194:195], v9, s[8:11], s24 offen offset:32
 buffer_load_dwordx2 v[196:197], v9, s[8:11], s24 offen offset:64
 v_lshrrev_b32 v9, 4, v1
 v_and_b32 v198, 1, v9
 s_mov_b32 s23, 61440
 v_mul_lo_u32 v198, v198, s23
 v_lshrrev_b32 v9, 1, v9
 v_lshlrev_b32 v9, 8, v9
 v_add_u32 v198, v198, v9
 v_and_b32 v9, 15, v1
 v_lshlrev_b32 v9, 4, v9
 v_add_u32 v198, v198, v9
 s_mul_i32 s30, s21, 245760
 s_lshl_b32 s23, s31, 9
 s_add_u32 s30, s30, s23
 s_add_u32 s30, s30, 0x1172000
 s_add_u32 s29, s30, 122880
 s_waitcnt vmcnt(0)
 v_lshlrev_b32 v68, 16, v192
 v_and_b32 v69, 0xffff0000, v192
 v_lshlrev_b32 v70, 16, v193
 v_and_b32 v71, 0xffff0000, v193
 v_lshlrev_b32 v72, 16, v194
 v_and_b32 v73, 0xffff0000, v194
 v_lshlrev_b32 v74, 16, v195
 v_and_b32 v75, 0xffff0000, v195
 v_lshlrev_b32 v76, 16, v196
 v_and_b32 v77, 0xffff0000, v196
 v_lshlrev_b32 v78, 16, v197
 v_and_b32 v79, 0xffff0000, v197
 v_pk_add_f32 v[204:205], v[204:205], v[216:217]
 v_pk_add_f32 v[206:207], v[206:207], v[218:219]
 v_pk_add_f32 v[208:209], v[208:209], v[220:221]
 v_pk_add_f32 v[210:211], v[210:211], v[222:223]
 v_pk_add_f32 v[212:213], v[212:213], v[224:225]
 v_pk_add_f32 v[214:215], v[214:215], v[226:227]
 v_pk_add_f32 v[180:181], v[180:181], v[228:229]
 v_pk_add_f32 v[182:183], v[182:183], v[230:231]
 v_pk_add_f32 v[184:185], v[184:185], v[232:233]
 v_pk_add_f32 v[186:187], v[186:187], v[234:235]
 v_pk_add_f32 v[188:189], v[188:189], v[236:237]
 v_pk_add_f32 v[190:191], v[190:191], v[238:239]
 v_pk_add_f32 v[180:181], v[180:181], v[204:205]
 v_pk_add_f32 v[182:183], v[182:183], v[206:207]
 v_pk_add_f32 v[184:185], v[184:185], v[208:209]
 v_pk_add_f32 v[186:187], v[186:187], v[210:211]
 v_pk_add_f32 v[188:189], v[188:189], v[212:213]
 v_pk_add_f32 v[190:191], v[190:191], v[214:215]
 v_mov_b32 v80, 0xc0135761
 v_mov_b32 v81, 0xbdd2d3e8
 v_mov_b32 v82, 1.0
 v_mov_b32 v83, 1.0
 v_and_b32 v8, 15, v1
 v_lshlrev_b32 v8, 2, v8
 v_add_u32 v8, 161792, v8
 s_barrier
 ds_read_b128 v[84:87], v3 offset:0
 ds_read_b128 v[100:103], v2 offset:0
 ds_read_b128 v[88:91], v3 offset:1024
 ds_read_b128 v[92:95], v3 offset:2048
 ds_read_b128 v[104:107], v2 offset:2048
 ds_read_b128 v[108:111], v2 offset:4096
 ds_read_b128 v[112:115], v2 offset:6144
 s_waitcnt lgkmcnt(0)
 v_mfma_f32_16x16x32_bf16 v[20:23], v[84:87], v[100:103], 0
 ds_read_b128 v[116:119], v3 offset:12288
 v_mfma_f32_16x16x32_bf16 v[24:27], v[88:91], v[100:103], 0
 ds_read_b128 v[132:135], v2 offset:1024
 v_mfma_f32_16x16x32_bf16 v[28:31], v[92:95], v[100:103], 0
 ds_read_b128 v[120:123], v3 offset:13312
 v_mfma_f32_16x16x32_bf16 v[32:35], v[84:87], v[104:107], 0
 ds_read_b128 v[124:127], v3 offset:14336
 v_mfma_f32_16x16x32_bf16 v[36:39], v[88:91], v[104:107], 0
 ds_read_b128 v[136:139], v2 offset:3072
 v_mfma_f32_16x16x32_bf16 v[40:43], v[92:95], v[104:107], 0
 ds_read_b128 v[140:143], v2 offset:5120
 v_mfma_f32_16x16x32_bf16 v[44:47], v[84:87], v[108:111], 0
 ds_read_b128 v[144:147], v2 offset:7168
 v_mfma_f32_16x16x32_bf16 v[48:51], v[88:91], v[108:111], 0
 v_mfma_f32_16x16x32_bf16 v[52:55], v[92:95], v[108:111], 0
 v_mfma_f32_16x16x32_bf16 v[56:59], v[84:87], v[112:115], 0
 v_mfma_f32_16x16x32_bf16 v[60:63], v[88:91], v[112:115], 0
 v_mfma_f32_16x16x32_bf16 v[64:67], v[92:95], v[112:115], 0
 s_waitcnt lgkmcnt(0)
 v_mfma_f32_16x16x32_bf16 v[20:23], v[116:119], v[132:135], v[20:23]
 s_barrier
 ds_read_b128 v[84:87], v3 offset:24576
 v_mfma_f32_16x16x32_bf16 v[24:27], v[120:123], v[132:135], v[24:27]
 ds_read_b128 v[100:103], v2 offset:8192
 v_mfma_f32_16x16x32_bf16 v[28:31], v[124:127], v[132:135], v[28:31]
 ds_read_b128 v[88:91], v3 offset:25600
 v_mfma_f32_16x16x32_bf16 v[32:35], v[116:119], v[136:139], v[32:35]
 ds_read_b128 v[92:95], v3 offset:26624
 v_mfma_f32_16x16x32_bf16 v[36:39], v[120:123], v[136:139], v[36:39]
 ds_read_b128 v[104:107], v2 offset:10240
 v_mfma_f32_16x16x32_bf16 v[40:43], v[124:127], v[136:139], v[40:43]
 ds_read_b128 v[108:111], v2 offset:12288
 v_mfma_f32_16x16x32_bf16 v[44:47], v[116:119], v[140:143], v[44:47]
 ds_read_b128 v[112:115], v2 offset:14336
 v_mfma_f32_16x16x32_bf16 v[48:51], v[120:123], v[140:143], v[48:51]
 v_mfma_f32_16x16x32_bf16 v[52:55], v[124:127], v[140:143], v[52:55]
 v_mfma_f32_16x16x32_bf16 v[56:59], v[116:119], v[144:147], v[56:59]
 v_mfma_f32_16x16x32_bf16 v[60:63], v[120:123], v[144:147], v[60:63]
 v_mfma_f32_16x16x32_bf16 v[64:67], v[124:127], v[144:147], v[64:67]
 s_waitcnt lgkmcnt(0)
 v_mfma_f32_16x16x32_bf16 v[20:23], v[84:87], v[100:103], v[20:23]
 ds_read_b128 v[116:119], v3 offset:36864
 v_mfma_f32_16x16x32_bf16 v[24:27], v[88:91], v[100:103], v[24:27]
 ds_read_b128 v[132:135], v2 offset:9216
 v_mfma_f32_16x16x32_bf16 v[28:31], v[92:95], v[100:103], v[28:31]
 ds_read_b128 v[120:123], v3 offset:37888
 v_mfma_f32_16x16x32_bf16 v[32:35], v[84:87], v[104:107], v[32:35]
 ds_read_b128 v[124:127], v3 offset:38912
 v_mfma_f32_16x16x32_bf16 v[36:39], v[88:91], v[104:107], v[36:39]
 ds_read_b128 v[136:139], v2 offset:11264
 v_mfma_f32_16x16x32_bf16 v[40:43], v[92:95], v[104:107], v[40:43]
 ds_read_b128 v[140:143], v2 offset:13312
 v_mfma_f32_16x16x32_bf16 v[44:47], v[84:87], v[108:111], v[44:47]
 ds_read_b128 v[144:147], v2 offset:15360
 v_mfma_f32_16x16x32_bf16 v[48:51], v[88:91], v[108:111], v[48:51]
 v_mfma_f32_16x16x32_bf16 v[52:55], v[92:95], v[108:111], v[52:55]
 v_mfma_f32_16x16x32_bf16 v[56:59], v[84:87], v[112:115], v[56:59]
 v_mfma_f32_16x16x32_bf16 v[60:63], v[88:91], v[112:115], v[60:63]
 v_mfma_f32_16x16x32_bf16 v[64:67], v[92:95], v[112:115], v[64:67]
 s_waitcnt lgkmcnt(0)
 v_mfma_f32_16x16x32_bf16 v[20:23], v[116:119], v[132:135], v[20:23]
 s_barrier
 ds_read_b128 v[84:87], v3 offset:49152
 v_mfma_f32_16x16x32_bf16 v[24:27], v[120:123], v[132:135], v[24:27]
 ds_read_b128 v[100:103], v2 offset:16384
 v_mfma_f32_16x16x32_bf16 v[28:31], v[124:127], v[132:135], v[28:31]
 ds_read_b128 v[88:91], v3 offset:50176
 v_mfma_f32_16x16x32_bf16 v[32:35], v[116:119], v[136:139], v[32:35]
 ds_read_b128 v[92:95], v3 offset:51200
 v_mfma_f32_16x16x32_bf16 v[36:39], v[120:123], v[136:139], v[36:39]
 ds_read_b128 v[104:107], v2 offset:18432
 v_mfma_f32_16x16x32_bf16 v[40:43], v[124:127], v[136:139], v[40:43]
 ds_read_b128 v[108:111], v2 offset:20480
 v_mfma_f32_16x16x32_bf16 v[44:47], v[116:119], v[140:143], v[44:47]
 ds_read_b128 v[112:115], v2 offset:22528
 v_mfma_f32_16x16x32_bf16 v[48:51], v[120:123], v[140:143], v[48:51]
 v_mfma_f32_16x16x32_bf16 v[52:55], v[124:127], v[140:143], v[52:55]
 v_mfma_f32_16x16x32_bf16 v[56:59], v[116:119], v[144:147], v[56:59]
 v_mfma_f32_16x16x32_bf16 v[60:63], v[120:123], v[144:147], v[60:63]
 v_mfma_f32_16x16x32_bf16 v[64:67], v[124:127], v[144:147], v[64:67]
 s_waitcnt lgkmcnt(0)
 v_mfma_f32_16x16x32_bf16 v[20:23], v[84:87], v[100:103], v[20:23]
 ds_read_b128 v[116:119], v3 offset:61440
 v_mfma_f32_16x16x32_bf16 v[24:27], v[88:91], v[100:103], v[24:27]
 ds_read_b128 v[132:135], v2 offset:17408
 v_mfma_f32_16x16x32_bf16 v[28:31], v[92:95], v[100:103], v[28:31]
 ds_read_b128 v[120:123], v3 offset:62464
 v_mfma_f32_16x16x32_bf16 v[32:35], v[84:87], v[104:107], v[32:35]
 ds_read_b128 v[124:127], v3 offset:63488
 v_mfma_f32_16x16x32_bf16 v[36:39], v[88:91], v[104:107], v[36:39]
 ds_read_b128 v[136:139], v2 offset:19456
 v_mfma_f32_16x16x32_bf16 v[40:43], v[92:95], v[104:107], v[40:43]
 ds_read_b128 v[140:143], v2 offset:21504
 v_mfma_f32_16x16x32_bf16 v[44:47], v[84:87], v[108:111], v[44:47]
 ds_read_b128 v[144:147], v2 offset:23552
 v_mfma_f32_16x16x32_bf16 v[48:51], v[88:91], v[108:111], v[48:51]
 v_mfma_f32_16x16x32_bf16 v[52:55], v[92:95], v[108:111], v[52:55]
 v_mfma_f32_16x16x32_bf16 v[56:59], v[84:87], v[112:115], v[56:59]
 v_mfma_f32_16x16x32_bf16 v[60:63], v[88:91], v[112:115], v[60:63]
 v_mfma_f32_16x16x32_bf16 v[64:67], v[92:95], v[112:115], v[64:67]
 s_waitcnt lgkmcnt(0)
 v_mfma_f32_16x16x32_bf16 v[20:23], v[116:119], v[132:135], v[20:23]
 s_barrier
 ds_read_b128 v[84:87], v4 offset:8192
 v_mfma_f32_16x16x32_bf16 v[24:27], v[120:123], v[132:135], v[24:27]
 ds_read_b128 v[100:103], v2 offset:24576
 v_mfma_f32_16x16x32_bf16 v[28:31], v[124:127], v[132:135], v[28:31]
 ds_read_b128 v[88:91], v4 offset:9216
 v_mfma_f32_16x16x32_bf16 v[32:35], v[116:119], v[136:139], v[32:35]
 ds_read_b128 v[92:95], v4 offset:10240
 v_mfma_f32_16x16x32_bf16 v[36:39], v[120:123], v[136:139], v[36:39]
 ds_read_b128 v[104:107], v2 offset:26624
 v_mfma_f32_16x16x32_bf16 v[40:43], v[124:127], v[136:139], v[40:43]
 ds_read_b128 v[108:111], v2 offset:28672
 v_mfma_f32_16x16x32_bf16 v[44:47], v[116:119], v[140:143], v[44:47]
 ds_read_b128 v[112:115], v2 offset:30720
 v_mfma_f32_16x16x32_bf16 v[48:51], v[120:123], v[140:143], v[48:51]
 v_mfma_f32_16x16x32_bf16 v[52:55], v[124:127], v[140:143], v[52:55]
 v_mfma_f32_16x16x32_bf16 v[56:59], v[116:119], v[144:147], v[56:59]
 v_mfma_f32_16x16x32_bf16 v[60:63], v[120:123], v[144:147], v[60:63]
 v_mfma_f32_16x16x32_bf16 v[64:67], v[124:127], v[144:147], v[64:67]
 s_waitcnt lgkmcnt(0)
 v_mfma_f32_16x16x32_bf16 v[20:23], v[84:87], v[100:103], v[20:23]
 ds_read_b128 v[116:119], v4 offset:20480
 v_mfma_f32_16x16x32_bf16 v[24:27], v[88:91], v[100:103], v[24:27]
 ds_read_b128 v[132:135], v2 offset:25600
 v_mfma_f32_16x16x32_bf16 v[28:31], v[92:95], v[100:103], v[28:31]
 ds_read_b128 v[120:123], v4 offset:21504
 v_mfma_f32_16x16x32_bf16 v[32:35], v[84:87], v[104:107], v[32:35]
 ds_read_b128 v[124:127], v4 offset:22528
 v_mfma_f32_16x16x32_bf16 v[36:39], v[88:91], v[104:107], v[36:39]
 ds_read_b128 v[136:139], v2 offset:27648
 v_mfma_f32_16x16x32_bf16 v[40:43], v[92:95], v[104:107], v[40:43]
 ds_read_b128 v[140:143], v2 offset:29696
 v_mfma_f32_16x16x32_bf16 v[44:47], v[84:87], v[108:111], v[44:47]
 ds_read_b128 v[144:147], v2 offset:31744
 v_mfma_f32_16x16x32_bf16 v[48:51], v[88:91], v[108:111], v[48:51]
 v_mfma_f32_16x16x32_bf16 v[52:55], v[92:95], v[108:111], v[52:55]
 v_mfma_f32_16x16x32_bf16 v[56:59], v[84:87], v[112:115], v[56:59]
 v_mfma_f32_16x16x32_bf16 v[60:63], v[88:91], v[112:115], v[60:63]
 v_mfma_f32_16x16x32_bf16 v[64:67], v[92:95], v[112:115], v[64:67]
 s_waitcnt lgkmcnt(0)
 v_mfma_f32_16x16x32_bf16 v[20:23], v[116:119], v[132:135], v[20:23]
 s_barrier
 ds_read_b128 v[84:87], v4 offset:32768
 v_mfma_f32_16x16x32_bf16 v[24:27], v[120:123], v[132:135], v[24:27]
 ds_read_b128 v[100:103], v2 offset:32768
 v_mfma_f32_16x16x32_bf16 v[28:31], v[124:127], v[132:135], v[28:31]
 ds_read_b128 v[88:91], v4 offset:33792
 v_mfma_f32_16x16x32_bf16 v[32:35], v[116:119], v[136:139], v[32:35]
 ds_read_b128 v[92:95], v4 offset:34816
 v_mfma_f32_16x16x32_bf16 v[36:39], v[120:123], v[136:139], v[36:39]
 ds_read_b128 v[104:107], v2 offset:34816
 v_mfma_f32_16x16x32_bf16 v[40:43], v[124:127], v[136:139], v[40:43]
 ds_read_b128 v[108:111], v2 offset:36864
 v_mfma_f32_16x16x32_bf16 v[44:47], v[116:119], v[140:143], v[44:47]
 ds_read_b128 v[112:115], v2 offset:38912
 v_mfma_f32_16x16x32_bf16 v[48:51], v[120:123], v[140:143], v[48:51]
 v_mfma_f32_16x16x32_bf16 v[52:55], v[124:127], v[140:143], v[52:55]
 v_mfma_f32_16x16x32_bf16 v[56:59], v[116:119], v[144:147], v[56:59]
 v_mfma_f32_16x16x32_bf16 v[60:63], v[120:123], v[144:147], v[60:63]
 v_mfma_f32_16x16x32_bf16 v[64:67], v[124:127], v[144:147], v[64:67]
 s_waitcnt lgkmcnt(0)
 v_mfma_f32_16x16x32_bf16 v[20:23], v[84:87], v[100:103], v[20:23]
 ds_read_b128 v[116:119], v3 offset:0
 v_mfma_f32_16x16x32_bf16 v[24:27], v[88:91], v[100:103], v[24:27]
 ds_read_b128 v[132:135], v2 offset:33792
 v_mfma_f32_16x16x32_bf16 v[28:31], v[92:95], v[100:103], v[28:31]
 ds_read_b128 v[120:123], v3 offset:1024
 v_mfma_f32_16x16x32_bf16 v[32:35], v[84:87], v[104:107], v[32:35]
 ds_read_b128 v[124:127], v3 offset:2048
 v_mfma_f32_16x16x32_bf16 v[36:39], v[88:91], v[104:107], v[36:39]
 ds_read_b128 v[136:139], v2 offset:35840
 v_mfma_f32_16x16x32_bf16 v[40:43], v[92:95], v[104:107], v[40:43]
 ds_read_b128 v[140:143], v2 offset:37888
 v_mfma_f32_16x16x32_bf16 v[44:47], v[84:87], v[108:111], v[44:47]
 ds_read_b128 v[144:147], v2 offset:39936
 v_mfma_f32_16x16x32_bf16 v[48:51], v[88:91], v[108:111], v[48:51]
 v_mfma_f32_16x16x32_bf16 v[52:55], v[92:95], v[108:111], v[52:55]
 v_mfma_f32_16x16x32_bf16 v[56:59], v[84:87], v[112:115], v[56:59]
 v_mfma_f32_16x16x32_bf16 v[60:63], v[88:91], v[112:115], v[60:63]
 v_mfma_f32_16x16x32_bf16 v[64:67], v[92:95], v[112:115], v[64:67]
 s_waitcnt lgkmcnt(0)
 v_mfma_f32_16x16x32_bf16 v[20:23], v[116:119], v[132:135], v[20:23]
 s_barrier
 ds_read_b128 v[84:87], v3 offset:12288
 v_mfma_f32_16x16x32_bf16 v[24:27], v[120:123], v[132:135], v[24:27]
 ds_read_b128 v[100:103], v2 offset:40960
 v_mfma_f32_16x16x32_bf16 v[28:31], v[124:127], v[132:135], v[28:31]
 ds_read_b128 v[88:91], v3 offset:13312
 v_mfma_f32_16x16x32_bf16 v[32:35], v[116:119], v[136:139], v[32:35]
 ds_read_b128 v[92:95], v3 offset:14336
 v_mfma_f32_16x16x32_bf16 v[36:39], v[120:123], v[136:139], v[36:39]
 ds_read_b128 v[104:107], v2 offset:43008
 v_mfma_f32_16x16x32_bf16 v[40:43], v[124:127], v[136:139], v[40:43]
 ds_read_b128 v[108:111], v2 offset:45056
 v_mfma_f32_16x16x32_bf16 v[44:47], v[116:119], v[140:143], v[44:47]
 ds_read_b128 v[112:115], v2 offset:47104
 v_mfma_f32_16x16x32_bf16 v[48:51], v[120:123], v[140:143], v[48:51]
 v_mfma_f32_16x16x32_bf16 v[52:55], v[124:127], v[140:143], v[52:55]
 v_mfma_f32_16x16x32_bf16 v[56:59], v[116:119], v[144:147], v[56:59]
 v_mfma_f32_16x16x32_bf16 v[60:63], v[120:123], v[144:147], v[60:63]
 v_mfma_f32_16x16x32_bf16 v[64:67], v[124:127], v[144:147], v[64:67]
 s_waitcnt lgkmcnt(0)
 v_mfma_f32_16x16x32_bf16 v[20:23], v[84:87], v[100:103], v[20:23]
 ds_read_b128 v[116:119], v3 offset:24576
 v_mfma_f32_16x16x32_bf16 v[24:27], v[88:91], v[100:103], v[24:27]
 ds_read_b128 v[132:135], v2 offset:41984
 v_mfma_f32_16x16x32_bf16 v[28:31], v[92:95], v[100:103], v[28:31]
 ds_read_b128 v[120:123], v3 offset:25600
 v_mfma_f32_16x16x32_bf16 v[32:35], v[84:87], v[104:107], v[32:35]
 ds_read_b128 v[124:127], v3 offset:26624
 v_mfma_f32_16x16x32_bf16 v[36:39], v[88:91], v[104:107], v[36:39]
 ds_read_b128 v[136:139], v2 offset:44032
 v_mfma_f32_16x16x32_bf16 v[40:43], v[92:95], v[104:107], v[40:43]
 ds_read_b128 v[140:143], v2 offset:46080
 v_mfma_f32_16x16x32_bf16 v[44:47], v[84:87], v[108:111], v[44:47]
 ds_read_b128 v[144:147], v2 offset:48128
 v_mfma_f32_16x16x32_bf16 v[48:51], v[88:91], v[108:111], v[48:51]
 v_mfma_f32_16x16x32_bf16 v[52:55], v[92:95], v[108:111], v[52:55]
 v_mfma_f32_16x16x32_bf16 v[56:59], v[84:87], v[112:115], v[56:59]
 v_mfma_f32_16x16x32_bf16 v[60:63], v[88:91], v[112:115], v[60:63]
 v_mfma_f32_16x16x32_bf16 v[64:67], v[92:95], v[112:115], v[64:67]
 s_waitcnt lgkmcnt(0)
 v_mfma_f32_16x16x32_bf16 v[20:23], v[116:119], v[132:135], v[20:23]
 s_barrier
 ds_read_b128 v[84:87], v3 offset:36864
 v_mfma_f32_16x16x32_bf16 v[24:27], v[120:123], v[132:135], v[24:27]
 ds_read_b128 v[100:103], v2 offset:0
 v_mfma_f32_16x16x32_bf16 v[28:31], v[124:127], v[132:135], v[28:31]
 ds_read_b128 v[88:91], v3 offset:37888
 v_mfma_f32_16x16x32_bf16 v[32:35], v[116:119], v[136:139], v[32:35]
 ds_read_b128 v[92:95], v3 offset:38912
 v_mfma_f32_16x16x32_bf16 v[36:39], v[120:123], v[136:139], v[36:39]
 ds_read_b128 v[104:107], v2 offset:2048
 v_mfma_f32_16x16x32_bf16 v[40:43], v[124:127], v[136:139], v[40:43]
 ds_read_b128 v[108:111], v2 offset:4096
 v_mfma_f32_16x16x32_bf16 v[44:47], v[116:119], v[140:143], v[44:47]
 ds_read_b128 v[112:115], v2 offset:6144
 v_mfma_f32_16x16x32_bf16 v[48:51], v[120:123], v[140:143], v[48:51]
 v_mfma_f32_16x16x32_bf16 v[52:55], v[124:127], v[140:143], v[52:55]
 v_mfma_f32_16x16x32_bf16 v[56:59], v[116:119], v[144:147], v[56:59]
 v_mfma_f32_16x16x32_bf16 v[60:63], v[120:123], v[144:147], v[60:63]
 v_mfma_f32_16x16x32_bf16 v[64:67], v[124:127], v[144:147], v[64:67]
 s_waitcnt lgkmcnt(0)
 v_mfma_f32_16x16x32_bf16 v[20:23], v[84:87], v[100:103], v[20:23]
 ds_read_b128 v[116:119], v3 offset:49152
 v_mfma_f32_16x16x32_bf16 v[24:27], v[88:91], v[100:103], v[24:27]
 ds_read_b128 v[132:135], v2 offset:1024
 v_mfma_f32_16x16x32_bf16 v[28:31], v[92:95], v[100:103], v[28:31]
 ds_read_b128 v[120:123], v3 offset:50176
 v_mfma_f32_16x16x32_bf16 v[32:35], v[84:87], v[104:107], v[32:35]
 ds_read_b128 v[124:127], v3 offset:51200
 v_mfma_f32_16x16x32_bf16 v[36:39], v[88:91], v[104:107], v[36:39]
 ds_read_b128 v[136:139], v2 offset:3072
 v_mfma_f32_16x16x32_bf16 v[40:43], v[92:95], v[104:107], v[40:43]
 ds_read_b128 v[140:143], v2 offset:5120
 v_mfma_f32_16x16x32_bf16 v[44:47], v[84:87], v[108:111], v[44:47]
 ds_read_b128 v[144:147], v2 offset:7168
 v_mfma_f32_16x16x32_bf16 v[48:51], v[88:91], v[108:111], v[48:51]
 v_mfma_f32_16x16x32_bf16 v[52:55], v[92:95], v[108:111], v[52:55]
 v_mfma_f32_16x16x32_bf16 v[56:59], v[84:87], v[112:115], v[56:59]
 v_mfma_f32_16x16x32_bf16 v[60:63], v[88:91], v[112:115], v[60:63]
 v_mfma_f32_16x16x32_bf16 v[64:67], v[92:95], v[112:115], v[64:67]
 s_waitcnt lgkmcnt(0)
 v_mfma_f32_16x16x32_bf16 v[20:23], v[116:119], v[132:135], v[20:23]
 s_barrier
 ds_read_b128 v[84:87], v3 offset:61440
 v_mfma_f32_16x16x32_bf16 v[24:27], v[120:123], v[132:135], v[24:27]
 ds_read_b128 v[100:103], v2 offset:8192
 v_mfma_f32_16x16x32_bf16 v[28:31], v[124:127], v[132:135], v[28:31]
 ds_read_b128 v[88:91], v3 offset:62464
 v_mfma_f32_16x16x32_bf16 v[32:35], v[116:119], v[136:139], v[32:35]
 ds_read_b128 v[92:95], v3 offset:63488
 v_mfma_f32_16x16x32_bf16 v[36:39], v[120:123], v[136:139], v[36:39]
 ds_read_b128 v[104:107], v2 offset:10240
 v_mfma_f32_16x16x32_bf16 v[40:43], v[124:127], v[136:139], v[40:43]
 ds_read_b128 v[108:111], v2 offset:12288
 v_mfma_f32_16x16x32_bf16 v[44:47], v[116:119], v[140:143], v[44:47]
 ds_read_b128 v[112:115], v2 offset:14336
 v_mfma_f32_16x16x32_bf16 v[48:51], v[120:123], v[140:143], v[48:51]
 v_mfma_f32_16x16x32_bf16 v[52:55], v[124:127], v[140:143], v[52:55]
 v_mfma_f32_16x16x32_bf16 v[56:59], v[116:119], v[144:147], v[56:59]
 v_mfma_f32_16x16x32_bf16 v[60:63], v[120:123], v[144:147], v[60:63]
 v_mfma_f32_16x16x32_bf16 v[64:67], v[124:127], v[144:147], v[64:67]
 s_waitcnt lgkmcnt(0)
 v_mfma_f32_16x16x32_bf16 v[20:23], v[84:87], v[100:103], v[20:23]
 ds_read_b128 v[116:119], v4 offset:8192
 v_mfma_f32_16x16x32_bf16 v[24:27], v[88:91], v[100:103], v[24:27]
 ds_read_b128 v[132:135], v2 offset:9216
 v_mfma_f32_16x16x32_bf16 v[28:31], v[92:95], v[100:103], v[28:31]
 ds_read_b128 v[120:123], v4 offset:9216
 v_mfma_f32_16x16x32_bf16 v[32:35], v[84:87], v[104:107], v[32:35]
 ds_read_b128 v[124:127], v4 offset:10240
 v_mfma_f32_16x16x32_bf16 v[36:39], v[88:91], v[104:107], v[36:39]
 ds_read_b128 v[136:139], v2 offset:11264
 v_mfma_f32_16x16x32_bf16 v[40:43], v[92:95], v[104:107], v[40:43]
 ds_read_b128 v[140:143], v2 offset:13312
 v_mfma_f32_16x16x32_bf16 v[44:47], v[84:87], v[108:111], v[44:47]
 ds_read_b128 v[144:147], v2 offset:15360
 v_mfma_f32_16x16x32_bf16 v[48:51], v[88:91], v[108:111], v[48:51]
 v_mfma_f32_16x16x32_bf16 v[52:55], v[92:95], v[108:111], v[52:55]
 v_mfma_f32_16x16x32_bf16 v[56:59], v[84:87], v[112:115], v[56:59]
 v_mfma_f32_16x16x32_bf16 v[60:63], v[88:91], v[112:115], v[60:63]
 v_mfma_f32_16x16x32_bf16 v[64:67], v[92:95], v[112:115], v[64:67]
 s_waitcnt lgkmcnt(0)
 v_mfma_f32_16x16x32_bf16 v[20:23], v[116:119], v[132:135], v[20:23]
 s_barrier
 ds_read_b128 v[84:87], v4 offset:20480
 v_mfma_f32_16x16x32_bf16 v[24:27], v[120:123], v[132:135], v[24:27]
 ds_read_b128 v[100:103], v2 offset:16384
 v_mfma_f32_16x16x32_bf16 v[28:31], v[124:127], v[132:135], v[28:31]
 ds_read_b128 v[88:91], v4 offset:21504
 v_mfma_f32_16x16x32_bf16 v[32:35], v[116:119], v[136:139], v[32:35]
 ds_read_b128 v[92:95], v4 offset:22528
 v_mfma_f32_16x16x32_bf16 v[36:39], v[120:123], v[136:139], v[36:39]
 ds_read_b128 v[104:107], v2 offset:18432
 v_mfma_f32_16x16x32_bf16 v[40:43], v[124:127], v[136:139], v[40:43]
 ds_read_b128 v[108:111], v2 offset:20480
 v_mfma_f32_16x16x32_bf16 v[44:47], v[116:119], v[140:143], v[44:47]
 ds_read_b128 v[112:115], v2 offset:22528
 v_mfma_f32_16x16x32_bf16 v[48:51], v[120:123], v[140:143], v[48:51]
 v_mfma_f32_16x16x32_bf16 v[52:55], v[124:127], v[140:143], v[52:55]
 v_mfma_f32_16x16x32_bf16 v[56:59], v[116:119], v[144:147], v[56:59]
 v_mfma_f32_16x16x32_bf16 v[60:63], v[120:123], v[144:147], v[60:63]
 v_mfma_f32_16x16x32_bf16 v[64:67], v[124:127], v[144:147], v[64:67]
 s_waitcnt lgkmcnt(0)
 v_mfma_f32_16x16x32_bf16 v[20:23], v[84:87], v[100:103], v[20:23]
 ds_read_b128 v[116:119], v4 offset:32768
 v_mfma_f32_16x16x32_bf16 v[24:27], v[88:91], v[100:103], v[24:27]
 ds_read_b128 v[132:135], v2 offset:17408
 v_mfma_f32_16x16x32_bf16 v[28:31], v[92:95], v[100:103], v[28:31]
 ds_read_b128 v[120:123], v4 offset:33792
 v_mfma_f32_16x16x32_bf16 v[32:35], v[84:87], v[104:107], v[32:35]
 ds_read_b128 v[124:127], v4 offset:34816
 v_mfma_f32_16x16x32_bf16 v[36:39], v[88:91], v[104:107], v[36:39]
 ds_read_b128 v[136:139], v2 offset:19456
 v_mfma_f32_16x16x32_bf16 v[40:43], v[92:95], v[104:107], v[40:43]
 ds_read_b128 v[140:143], v2 offset:21504
 v_mfma_f32_16x16x32_bf16 v[44:47], v[84:87], v[108:111], v[44:47]
 ds_read_b128 v[144:147], v2 offset:23552
 v_mfma_f32_16x16x32_bf16 v[48:51], v[88:91], v[108:111], v[48:51]
 v_mfma_f32_16x16x32_bf16 v[52:55], v[92:95], v[108:111], v[52:55]
 v_mfma_f32_16x16x32_bf16 v[56:59], v[84:87], v[112:115], v[56:59]
 v_mfma_f32_16x16x32_bf16 v[60:63], v[88:91], v[112:115], v[60:63]
 v_mfma_f32_16x16x32_bf16 v[64:67], v[92:95], v[112:115], v[64:67]
 s_waitcnt lgkmcnt(0)
 v_mfma_f32_16x16x32_bf16 v[20:23], v[116:119], v[132:135], v[20:23]
 s_barrier
 ds_read_b128 v[84:87], v3 offset:0
 v_mfma_f32_16x16x32_bf16 v[24:27], v[120:123], v[132:135], v[24:27]
 ds_read_b128 v[100:103], v2 offset:24576
 v_mfma_f32_16x16x32_bf16 v[28:31], v[124:127], v[132:135], v[28:31]
 ds_read_b128 v[88:91], v3 offset:1024
 v_mfma_f32_16x16x32_bf16 v[32:35], v[116:119], v[136:139], v[32:35]
 ds_read_b128 v[92:95], v3 offset:2048
 v_mfma_f32_16x16x32_bf16 v[36:39], v[120:123], v[136:139], v[36:39]
 ds_read_b128 v[104:107], v2 offset:26624
 v_mfma_f32_16x16x32_bf16 v[40:43], v[124:127], v[136:139], v[40:43]
 ds_read_b128 v[108:111], v2 offset:28672
 v_mfma_f32_16x16x32_bf16 v[44:47], v[116:119], v[140:143], v[44:47]
 ds_read_b128 v[112:115], v2 offset:30720
 v_mfma_f32_16x16x32_bf16 v[48:51], v[120:123], v[140:143], v[48:51]
 v_mfma_f32_16x16x32_bf16 v[52:55], v[124:127], v[140:143], v[52:55]
 v_mfma_f32_16x16x32_bf16 v[56:59], v[116:119], v[144:147], v[56:59]
 v_mfma_f32_16x16x32_bf16 v[60:63], v[120:123], v[144:147], v[60:63]
 v_mfma_f32_16x16x32_bf16 v[64:67], v[124:127], v[144:147], v[64:67]
 s_waitcnt lgkmcnt(0)
 v_mfma_f32_16x16x32_bf16 v[20:23], v[84:87], v[100:103], v[20:23]
 ds_read_b128 v[116:119], v3 offset:12288
 v_mfma_f32_16x16x32_bf16 v[24:27], v[88:91], v[100:103], v[24:27]
 ds_read_b128 v[132:135], v2 offset:25600
 v_mfma_f32_16x16x32_bf16 v[28:31], v[92:95], v[100:103], v[28:31]
 ds_read_b128 v[120:123], v3 offset:13312
 v_mfma_f32_16x16x32_bf16 v[32:35], v[84:87], v[104:107], v[32:35]
 ds_read_b128 v[124:127], v3 offset:14336
 v_mfma_f32_16x16x32_bf16 v[36:39], v[88:91], v[104:107], v[36:39]
 ds_read_b128 v[136:139], v2 offset:27648
 v_mfma_f32_16x16x32_bf16 v[40:43], v[92:95], v[104:107], v[40:43]
 ds_read_b128 v[140:143], v2 offset:29696
 v_mfma_f32_16x16x32_bf16 v[44:47], v[84:87], v[108:111], v[44:47]
 ds_read_b128 v[144:147], v2 offset:31744
 v_mfma_f32_16x16x32_bf16 v[48:51], v[88:91], v[108:111], v[48:51]
 v_mfma_f32_16x16x32_bf16 v[52:55], v[92:95], v[108:111], v[52:55]
 v_mfma_f32_16x16x32_bf16 v[56:59], v[84:87], v[112:115], v[56:59]
 v_mfma_f32_16x16x32_bf16 v[60:63], v[88:91], v[112:115], v[60:63]
 v_mfma_f32_16x16x32_bf16 v[64:67], v[92:95], v[112:115], v[64:67]
 s_waitcnt lgkmcnt(0)
 v_mfma_f32_16x16x32_bf16 v[20:23], v[116:119], v[132:135], v[20:23]
 s_barrier
 v_mfma_f32_16x16x32_bf16 v[24:27], v[120:123], v[132:135], v[24:27]
 ds_read_b32 v84, v8 offset:0
 ds_read_b32 v85, v8 offset:64
 v_mfma_f32_16x16x32_bf16 v[28:31], v[124:127], v[132:135], v[28:31]
 ds_read_b32 v86, v8 offset:128
 ds_read_b32 v87, v8 offset:192
 v_mfma_f32_16x16x32_bf16 v[32:35], v[116:119], v[136:139], v[32:35]
 ds_read_b32 v88, v8 offset:256
 ds_read_b32 v89, v8 offset:320
 v_mfma_f32_16x16x32_bf16 v[36:39], v[120:123], v[136:139], v[36:39]
 ds_read_b32 v90, v8 offset:384
 ds_read_b32 v91, v8 offset:448
 v_mfma_f32_16x16x32_bf16 v[40:43], v[124:127], v[136:139], v[40:43]
 v_mfma_f32_16x16x32_bf16 v[44:47], v[116:119], v[140:143], v[44:47]
 v_mfma_f32_16x16x32_bf16 v[48:51], v[120:123], v[140:143], v[48:51]
 v_mfma_f32_16x16x32_bf16 v[52:55], v[124:127], v[140:143], v[52:55]
 v_mfma_f32_16x16x32_bf16 v[56:59], v[116:119], v[144:147], v[56:59]
 v_mfma_f32_16x16x32_bf16 v[60:63], v[120:123], v[144:147], v[60:63]
 v_mfma_f32_16x16x32_bf16 v[64:67], v[124:127], v[144:147], v[64:67]
 s_waitcnt lgkmcnt(0)
 s_cmp_eq_u32 s33, 0
 s_cbranch_scc1 C2_e1_slow
 v_pk_fma_f32 v[108:109], v[180:181], v[88:89], v[68:69] op_sel:[0,0,0] op_sel_hi:[1,0,1] neg_lo:[0,1,0] neg_hi:[0,1,0]
 v_pk_fma_f32 v[110:111], v[182:183], v[88:89], v[70:71] op_sel:[0,0,0] op_sel_hi:[1,0,1] neg_lo:[0,1,0] neg_hi:[0,1,0]
 v_pk_fma_f32 v[112:113], v[180:181], v[88:89], v[68:69] op_sel:[0,1,0] op_sel_hi:[1,1,1] neg_lo:[0,1,0] neg_hi:[0,1,0]
 v_pk_fma_f32 v[114:115], v[182:183], v[88:89], v[70:71] op_sel:[0,1,0] op_sel_hi:[1,1,1] neg_lo:[0,1,0] neg_hi:[0,1,0]
 v_pk_fma_f32 v[108:109], v[20:21], v[84:85], v[108:109] op_sel:[0,0,0] op_sel_hi:[1,0,1]
 v_pk_fma_f32 v[110:111], v[22:23], v[84:85], v[110:111] op_sel:[0,0,0] op_sel_hi:[1,0,1]
 v_pk_fma_f32 v[112:113], v[32:33], v[84:85], v[112:113] op_sel:[0,1,0] op_sel_hi:[1,1,1]
 v_pk_fma_f32 v[114:115], v[34:35], v[84:85], v[114:115] op_sel:[0,1,0] op_sel_hi:[1,1,1]
 v_pk_mul_f32 v[116:117], v[108:109], v[108:109]
 v_pk_mul_f32 v[118:119], v[110:111], v[110:111]
 v_pk_mul_f32 v[120:121], v[112:113], v[112:113]
 v_pk_mul_f32 v[122:123], v[114:115], v[114:115]
 v_pk_fma_f32 v[116:117], v[116:117], v[80:81], v[80:81] op_sel:[0,1,0] op_sel_hi:[1,1,0]
 v_pk_fma_f32 v[118:119], v[118:119], v[80:81], v[80:81] op_sel:[0,1,0] op_sel_hi:[1,1,0]
 v_pk_fma_f32 v[120:121], v[120:121], v[80:81], v[80:81] op_sel:[0,1,0] op_sel_hi:[1,1,0]
 v_pk_fma_f32 v[122:123], v[122:123], v[80:81], v[80:81] op_sel:[0,1,0] op_sel_hi:[1,1,0]
 v_pk_mul_f32 v[116:117], v[116:117], v[108:109]
 v_pk_mul_f32 v[118:119], v[118:119], v[110:111]
 v_pk_mul_f32 v[120:121], v[120:121], v[112:113]
 v_pk_mul_f32 v[122:123], v[122:123], v[114:115]
 v_exp_f32 v116, v116
 v_exp_f32 v117, v117
 v_exp_f32 v118, v118
 v_exp_f32 v119, v119
 v_exp_f32 v120, v120
 v_exp_f32 v121, v121
 v_exp_f32 v122, v122
 v_exp_f32 v123, v123
 v_pk_add_f32 v[116:117], v[116:117], v[82:83]
 v_pk_add_f32 v[118:119], v[118:119], v[82:83]
 v_pk_add_f32 v[120:121], v[120:121], v[82:83]
 v_pk_add_f32 v[122:123], v[122:123], v[82:83]
 v_rcp_f32 v116, v116
 v_rcp_f32 v117, v117
 v_rcp_f32 v118, v118
 v_rcp_f32 v119, v119
 v_rcp_f32 v120, v120
 v_rcp_f32 v121, v121
 v_rcp_f32 v122, v122
 v_rcp_f32 v123, v123
 v_pk_mul_f32 v[116:117], v[116:117], v[108:109]
 v_pk_mul_f32 v[118:119], v[118:119], v[110:111]
 v_pk_mul_f32 v[120:121], v[120:121], v[112:113]
 v_pk_mul_f32 v[122:123], v[122:123], v[114:115]
 v_cvt_pk_bf16_f32 v124, v116, v117
 v_cvt_pk_bf16_f32 v125, v118, v119
 v_cvt_pk_bf16_f32 v126, v120, v121
 v_cvt_pk_bf16_f32 v127, v122, v123
 s_nop 0
 v_permlane16_swap_b32 v124, v126
 v_permlane16_swap_b32 v125, v127
 buffer_store_dwordx4 v[124:127], v198, s[4:7], s30 offen offset:0
 v_pk_fma_f32 v[132:133], v[180:181], v[90:91], v[68:69] op_sel:[0,0,0] op_sel_hi:[1,0,1] neg_lo:[0,1,0] neg_hi:[0,1,0]
 v_pk_fma_f32 v[134:135], v[182:183], v[90:91], v[70:71] op_sel:[0,0,0] op_sel_hi:[1,0,1] neg_lo:[0,1,0] neg_hi:[0,1,0]
 v_pk_fma_f32 v[136:137], v[180:181], v[90:91], v[68:69] op_sel:[0,1,0] op_sel_hi:[1,1,1] neg_lo:[0,1,0] neg_hi:[0,1,0]
 v_pk_fma_f32 v[138:139], v[182:183], v[90:91], v[70:71] op_sel:[0,1,0] op_sel_hi:[1,1,1] neg_lo:[0,1,0] neg_hi:[0,1,0]
 v_pk_fma_f32 v[132:133], v[44:45], v[86:87], v[132:133] op_sel:[0,0,0] op_sel_hi:[1,0,1]
 v_pk_fma_f32 v[134:135], v[46:47], v[86:87], v[134:135] op_sel:[0,0,0] op_sel_hi:[1,0,1]
 v_pk_fma_f32 v[136:137], v[56:57], v[86:87], v[136:137] op_sel:[0,1,0] op_sel_hi:[1,1,1]
 v_pk_fma_f32 v[138:139], v[58:59], v[86:87], v[138:139] op_sel:[0,1,0] op_sel_hi:[1,1,1]
 v_pk_mul_f32 v[140:141], v[132:133], v[132:133]
 v_pk_mul_f32 v[142:143], v[134:135], v[134:135]
 v_pk_mul_f32 v[144:145], v[136:137], v[136:137]
 v_pk_mul_f32 v[146:147], v[138:139], v[138:139]
 v_pk_fma_f32 v[140:141], v[140:141], v[80:81], v[80:81] op_sel:[0,1,0] op_sel_hi:[1,1,0]
 v_pk_fma_f32 v[142:143], v[142:143], v[80:81], v[80:81] op_sel:[0,1,0] op_sel_hi:[1,1,0]
 v_pk_fma_f32 v[144:145], v[144:145], v[80:81], v[80:81] op_sel:[0,1,0] op_sel_hi:[1,1,0]
 v_pk_fma_f32 v[146:147], v[146:147], v[80:81], v[80:81] op_sel:[0,1,0] op_sel_hi:[1,1,0]
 v_pk_mul_f32 v[140:141], v[140:141], v[132:133]
 v_pk_mul_f32 v[142:143], v[142:143], v[134:135]
 v_pk_mul_f32 v[144:145], v[144:145], v[136:137]
 v_pk_mul_f32 v[146:147], v[146:147], v[138:139]
 v_exp_f32 v140, v140
 v_exp_f32 v141, v141
 v_exp_f32 v142, v142
 v_exp_f32 v143, v143
 v_exp_f32 v144, v144
 v_exp_f32 v145, v145
 v_exp_f32 v146, v146
 v_exp_f32 v147, v147
 v_pk_add_f32 v[140:141], v[140:141], v[82:83]
 v_pk_add_f32 v[142:143], v[142:143], v[82:83]
 v_pk_add_f32 v[144:145], v[144:145], v[82:83]
 v_pk_add_f32 v[146:147], v[146:147], v[82:83]
 v_rcp_f32 v140, v140
 v_rcp_f32 v141, v141
 v_rcp_f32 v142, v142
 v_rcp_f32 v143, v143
 v_rcp_f32 v144, v144
 v_rcp_f32 v145, v145
 v_rcp_f32 v146, v146
 v_rcp_f32 v147, v147
 v_pk_mul_f32 v[140:141], v[140:141], v[132:133]
 v_pk_mul_f32 v[142:143], v[142:143], v[134:135]
 v_pk_mul_f32 v[144:145], v[144:145], v[136:137]
 v_pk_mul_f32 v[146:147], v[146:147], v[138:139]
 v_cvt_pk_bf16_f32 v148, v140, v141
 v_cvt_pk_bf16_f32 v149, v142, v143
 v_cvt_pk_bf16_f32 v150, v144, v145
 v_cvt_pk_bf16_f32 v151, v146, v147
 s_nop 0
 v_permlane16_swap_b32 v148, v150
 v_permlane16_swap_b32 v149, v151
 buffer_store_dwordx4 v[148:151], v198, s[4:7], s29 offen offset:0
 v_pk_fma_f32 v[108:109], v[184:185], v[88:89], v[72:73] op_sel:[0,0,0] op_sel_hi:[1,0,1] neg_lo:[0,1,0] neg_hi:[0,1,0]
 v_pk_fma_f32 v[110:111], v[186:187], v[88:89], v[74:75] op_sel:[0,0,0] op_sel_hi:[1,0,1] neg_lo:[0,1,0] neg_hi:[0,1,0]
 v_pk_fma_f32 v[112:113], v[184:185], v[88:89], v[72:73] op_sel:[0,1,0] op_sel_hi:[1,1,1] neg_lo:[0,1,0] neg_hi:[0,1,0]
 v_pk_fma_f32 v[114:115], v[186:187], v[88:89], v[74:75] op_sel:[0,1,0] op_sel_hi:[1,1,1] neg_lo:[0,1,0] neg_hi:[0,1,0]
 v_pk_fma_f32 v[108:109], v[24:25], v[84:85], v[108:109] op_sel:[0,0,0] op_sel_hi:[1,0,1]
 v_pk_fma_f32 v[110:111], v[26:27], v[84:85], v[110:111] op_sel:[0,0,0] op_sel_hi:[1,0,1]
 v_pk_fma_f32 v[112:113], v[36:37], v[84:85], v[112:113] op_sel:[0,1,0] op_sel_hi:[1,1,1]
 v_pk_fma_f32 v[114:115], v[38:39], v[84:85], v[114:115] op_sel:[0,1,0] op_sel_hi:[1,1,1]
 v_pk_mul_f32 v[116:117], v[108:109], v[108:109]
 v_pk_mul_f32 v[118:119], v[110:111], v[110:111]
 v_pk_mul_f32 v[120:121], v[112:113], v[112:113]
 v_pk_mul_f32 v[122:123], v[114:115], v[114:115]
 v_pk_fma_f32 v[116:117], v[116:117], v[80:81], v[80:81] op_sel:[0,1,0] op_sel_hi:[1,1,0]
 v_pk_fma_f32 v[118:119], v[118:119], v[80:81], v[80:81] op_sel:[0,1,0] op_sel_hi:[1,1,0]
 v_pk_fma_f32 v[120:121], v[120:121], v[80:81], v[80:81] op_sel:[0,1,0] op_sel_hi:[1,1,0]
 v_pk_fma_f32 v[122:123], v[122:123], v[80:81], v[80:81] op_sel:[0,1,0] op_sel_hi:[1,1,0]
 v_pk_mul_f32 v[116:117], v[116:117], v[108:109]
 v_pk_mul_f32 v[118:119], v[118:119], v[110:111]
 v_pk_mul_f32 v[120:121], v[120:121], v[112:113]
 v_pk_mul_f32 v[122:123], v[122:123], v[114:115]
 v_exp_f32 v116, v116
 v_exp_f32 v117, v117
 v_exp_f32 v118, v118
 v_exp_f32 v119, v119
 v_exp_f32 v120, v120
 v_exp_f32 v121, v121
 v_exp_f32 v122, v122
 v_exp_f32 v123, v123
 v_pk_add_f32 v[116:117], v[116:117], v[82:83]
 v_pk_add_f32 v[118:119], v[118:119], v[82:83]
 v_pk_add_f32 v[120:121], v[120:121], v[82:83]
 v_pk_add_f32 v[122:123], v[122:123], v[82:83]
 v_rcp_f32 v116, v116
 v_rcp_f32 v117, v117
 v_rcp_f32 v118, v118
 v_rcp_f32 v119, v119
 v_rcp_f32 v120, v120
 v_rcp_f32 v121, v121
 v_rcp_f32 v122, v122
 v_rcp_f32 v123, v123
 v_pk_mul_f32 v[116:117], v[116:117], v[108:109]
 v_pk_mul_f32 v[118:119], v[118:119], v[110:111]
 v_pk_mul_f32 v[120:121], v[120:121], v[112:113]
 v_pk_mul_f32 v[122:123], v[122:123], v[114:115]
 v_cvt_pk_bf16_f32 v124, v116, v117
 v_cvt_pk_bf16_f32 v125, v118, v119
 v_cvt_pk_bf16_f32 v126, v120, v121
 v_cvt_pk_bf16_f32 v127, v122, v123
 s_nop 0
 v_permlane16_swap_b32 v124, v126
 v_permlane16_swap_b32 v125, v127
 buffer_store_dwordx4 v[124:127], v198, s[4:7], s30 offen offset:512
 v_pk_fma_f32 v[132:133], v[184:185], v[90:91], v[72:73] op_sel:[0,0,0] op_sel_hi:[1,0,1] neg_lo:[0,1,0] neg_hi:[0,1,0]
 v_pk_fma_f32 v[134:135], v[186:187], v[90:91], v[74:75] op_sel:[0,0,0] op_sel_hi:[1,0,1] neg_lo:[0,1,0] neg_hi:[0,1,0]
 v_pk_fma_f32 v[136:137], v[184:185], v[90:91], v[72:73] op_sel:[0,1,0] op_sel_hi:[1,1,1] neg_lo:[0,1,0] neg_hi:[0,1,0]
 v_pk_fma_f32 v[138:139], v[186:187], v[90:91], v[74:75] op_sel:[0,1,0] op_sel_hi:[1,1,1] neg_lo:[0,1,0] neg_hi:[0,1,0]
 v_pk_fma_f32 v[132:133], v[48:49], v[86:87], v[132:133] op_sel:[0,0,0] op_sel_hi:[1,0,1]
 v_pk_fma_f32 v[134:135], v[50:51], v[86:87], v[134:135] op_sel:[0,0,0] op_sel_hi:[1,0,1]
 v_pk_fma_f32 v[136:137], v[60:61], v[86:87], v[136:137] op_sel:[0,1,0] op_sel_hi:[1,1,1]
 v_pk_fma_f32 v[138:139], v[62:63], v[86:87], v[138:139] op_sel:[0,1,0] op_sel_hi:[1,1,1]
 v_pk_mul_f32 v[140:141], v[132:133], v[132:133]
 v_pk_mul_f32 v[142:143], v[134:135], v[134:135]
 v_pk_mul_f32 v[144:145], v[136:137], v[136:137]
 v_pk_mul_f32 v[146:147], v[138:139], v[138:139]
 v_pk_fma_f32 v[140:141], v[140:141], v[80:81], v[80:81] op_sel:[0,1,0] op_sel_hi:[1,1,0]
 v_pk_fma_f32 v[142:143], v[142:143], v[80:81], v[80:81] op_sel:[0,1,0] op_sel_hi:[1,1,0]
 v_pk_fma_f32 v[144:145], v[144:145], v[80:81], v[80:81] op_sel:[0,1,0] op_sel_hi:[1,1,0]
 v_pk_fma_f32 v[146:147], v[146:147], v[80:81], v[80:81] op_sel:[0,1,0] op_sel_hi:[1,1,0]
 v_pk_mul_f32 v[140:141], v[140:141], v[132:133]
 v_pk_mul_f32 v[142:143], v[142:143], v[134:135]
 v_pk_mul_f32 v[144:145], v[144:145], v[136:137]
 v_pk_mul_f32 v[146:147], v[146:147], v[138:139]
 v_exp_f32 v140, v140
 v_exp_f32 v141, v141
 v_exp_f32 v142, v142
 v_exp_f32 v143, v143
 v_exp_f32 v144, v144
 v_exp_f32 v145, v145
 v_exp_f32 v146, v146
 v_exp_f32 v147, v147
 v_pk_add_f32 v[140:141], v[140:141], v[82:83]
 v_pk_add_f32 v[142:143], v[142:143], v[82:83]
 v_pk_add_f32 v[144:145], v[144:145], v[82:83]
 v_pk_add_f32 v[146:147], v[146:147], v[82:83]
 v_rcp_f32 v140, v140
 v_rcp_f32 v141, v141
 v_rcp_f32 v142, v142
 v_rcp_f32 v143, v143
 v_rcp_f32 v144, v144
 v_rcp_f32 v145, v145
 v_rcp_f32 v146, v146
 v_rcp_f32 v147, v147
 v_pk_mul_f32 v[140:141], v[140:141], v[132:133]
 v_pk_mul_f32 v[142:143], v[142:143], v[134:135]
 v_pk_mul_f32 v[144:145], v[144:145], v[136:137]
 v_pk_mul_f32 v[146:147], v[146:147], v[138:139]
 v_cvt_pk_bf16_f32 v148, v140, v141
 v_cvt_pk_bf16_f32 v149, v142, v143
 v_cvt_pk_bf16_f32 v150, v144, v145
 v_cvt_pk_bf16_f32 v151, v146, v147
 s_nop 0
 v_permlane16_swap_b32 v148, v150
 v_permlane16_swap_b32 v149, v151
 buffer_store_dwordx4 v[148:151], v198, s[4:7], s29 offen offset:512
 v_pk_fma_f32 v[108:109], v[188:189], v[88:89], v[76:77] op_sel:[0,0,0] op_sel_hi:[1,0,1] neg_lo:[0,1,0] neg_hi:[0,1,0]
 v_pk_fma_f32 v[110:111], v[190:191], v[88:89], v[78:79] op_sel:[0,0,0] op_sel_hi:[1,0,1] neg_lo:[0,1,0] neg_hi:[0,1,0]
 v_pk_fma_f32 v[112:113], v[188:189], v[88:89], v[76:77] op_sel:[0,1,0] op_sel_hi:[1,1,1] neg_lo:[0,1,0] neg_hi:[0,1,0]
 v_pk_fma_f32 v[114:115], v[190:191], v[88:89], v[78:79] op_sel:[0,1,0] op_sel_hi:[1,1,1] neg_lo:[0,1,0] neg_hi:[0,1,0]
 v_pk_fma_f32 v[108:109], v[28:29], v[84:85], v[108:109] op_sel:[0,0,0] op_sel_hi:[1,0,1]
 v_pk_fma_f32 v[110:111], v[30:31], v[84:85], v[110:111] op_sel:[0,0,0] op_sel_hi:[1,0,1]
 v_pk_fma_f32 v[112:113], v[40:41], v[84:85], v[112:113] op_sel:[0,1,0] op_sel_hi:[1,1,1]
 v_pk_fma_f32 v[114:115], v[42:43], v[84:85], v[114:115] op_sel:[0,1,0] op_sel_hi:[1,1,1]
 v_pk_mul_f32 v[116:117], v[108:109], v[108:109]
 v_pk_mul_f32 v[118:119], v[110:111], v[110:111]
 v_pk_mul_f32 v[120:121], v[112:113], v[112:113]
 v_pk_mul_f32 v[122:123], v[114:115], v[114:115]
 v_pk_fma_f32 v[116:117], v[116:117], v[80:81], v[80:81] op_sel:[0,1,0] op_sel_hi:[1,1,0]
 v_pk_fma_f32 v[118:119], v[118:119], v[80:81], v[80:81] op_sel:[0,1,0] op_sel_hi:[1,1,0]
 v_pk_fma_f32 v[120:121], v[120:121], v[80:81], v[80:81] op_sel:[0,1,0] op_sel_hi:[1,1,0]
 v_pk_fma_f32 v[122:123], v[122:123], v[80:81], v[80:81] op_sel:[0,1,0] op_sel_hi:[1,1,0]
 v_pk_mul_f32 v[116:117], v[116:117], v[108:109]
 v_pk_mul_f32 v[118:119], v[118:119], v[110:111]
 v_pk_mul_f32 v[120:121], v[120:121], v[112:113]
 v_pk_mul_f32 v[122:123], v[122:123], v[114:115]
 v_exp_f32 v116, v116
 v_exp_f32 v117, v117
 v_exp_f32 v118, v118
 v_exp_f32 v119, v119
 v_exp_f32 v120, v120
 v_exp_f32 v121, v121
 v_exp_f32 v122, v122
 v_exp_f32 v123, v123
 v_pk_add_f32 v[116:117], v[116:117], v[82:83]
 v_pk_add_f32 v[118:119], v[118:119], v[82:83]
 v_pk_add_f32 v[120:121], v[120:121], v[82:83]
 v_pk_add_f32 v[122:123], v[122:123], v[82:83]
 v_rcp_f32 v116, v116
 v_rcp_f32 v117, v117
 v_rcp_f32 v118, v118
 v_rcp_f32 v119, v119
 v_rcp_f32 v120, v120
 v_rcp_f32 v121, v121
 v_rcp_f32 v122, v122
 v_rcp_f32 v123, v123
 v_pk_mul_f32 v[116:117], v[116:117], v[108:109]
 v_pk_mul_f32 v[118:119], v[118:119], v[110:111]
 v_pk_mul_f32 v[120:121], v[120:121], v[112:113]
 v_pk_mul_f32 v[122:123], v[122:123], v[114:115]
 v_cvt_pk_bf16_f32 v124, v116, v117
 v_cvt_pk_bf16_f32 v125, v118, v119
 v_cvt_pk_bf16_f32 v126, v120, v121
 v_cvt_pk_bf16_f32 v127, v122, v123
 s_nop 0
 v_permlane16_swap_b32 v124, v126
 v_permlane16_swap_b32 v125, v127
 buffer_store_dwordx4 v[124:127], v198, s[4:7], s30 offen offset:1024
 v_pk_fma_f32 v[132:133], v[188:189], v[90:91], v[76:77] op_sel:[0,0,0] op_sel_hi:[1,0,1] neg_lo:[0,1,0] neg_hi:[0,1,0]
 v_pk_fma_f32 v[134:135], v[190:191], v[90:91], v[78:79] op_sel:[0,0,0] op_sel_hi:[1,0,1] neg_lo:[0,1,0] neg_hi:[0,1,0]
 v_pk_fma_f32 v[136:137], v[188:189], v[90:91], v[76:77] op_sel:[0,1,0] op_sel_hi:[1,1,1] neg_lo:[0,1,0] neg_hi:[0,1,0]
 v_pk_fma_f32 v[138:139], v[190:191], v[90:91], v[78:79] op_sel:[0,1,0] op_sel_hi:[1,1,1] neg_lo:[0,1,0] neg_hi:[0,1,0]
 v_pk_fma_f32 v[132:133], v[52:53], v[86:87], v[132:133] op_sel:[0,0,0] op_sel_hi:[1,0,1]
 v_pk_fma_f32 v[134:135], v[54:55], v[86:87], v[134:135] op_sel:[0,0,0] op_sel_hi:[1,0,1]
 v_pk_fma_f32 v[136:137], v[64:65], v[86:87], v[136:137] op_sel:[0,1,0] op_sel_hi:[1,1,1]
 v_pk_fma_f32 v[138:139], v[66:67], v[86:87], v[138:139] op_sel:[0,1,0] op_sel_hi:[1,1,1]
 v_pk_mul_f32 v[140:141], v[132:133], v[132:133]
 v_pk_mul_f32 v[142:143], v[134:135], v[134:135]
 v_pk_mul_f32 v[144:145], v[136:137], v[136:137]
 v_pk_mul_f32 v[146:147], v[138:139], v[138:139]
 v_pk_fma_f32 v[140:141], v[140:141], v[80:81], v[80:81] op_sel:[0,1,0] op_sel_hi:[1,1,0]
 v_pk_fma_f32 v[142:143], v[142:143], v[80:81], v[80:81] op_sel:[0,1,0] op_sel_hi:[1,1,0]
 v_pk_fma_f32 v[144:145], v[144:145], v[80:81], v[80:81] op_sel:[0,1,0] op_sel_hi:[1,1,0]
 v_pk_fma_f32 v[146:147], v[146:147], v[80:81], v[80:81] op_sel:[0,1,0] op_sel_hi:[1,1,0]
 v_pk_mul_f32 v[140:141], v[140:141], v[132:133]
 v_pk_mul_f32 v[142:143], v[142:143], v[134:135]
 v_pk_mul_f32 v[144:145], v[144:145], v[136:137]
 v_pk_mul_f32 v[146:147], v[146:147], v[138:139]
 v_exp_f32 v140, v140
 v_exp_f32 v141, v141
 v_exp_f32 v142, v142
 v_exp_f32 v143, v143
 v_exp_f32 v144, v144
 v_exp_f32 v145, v145
 v_exp_f32 v146, v146
 v_exp_f32 v147, v147
 v_pk_add_f32 v[140:141], v[140:141], v[82:83]
 v_pk_add_f32 v[142:143], v[142:143], v[82:83]
 v_pk_add_f32 v[144:145], v[144:145], v[82:83]
 v_pk_add_f32 v[146:147], v[146:147], v[82:83]
 v_rcp_f32 v140, v140
 v_rcp_f32 v141, v141
 v_rcp_f32 v142, v142
 v_rcp_f32 v143, v143
 v_rcp_f32 v144, v144
 v_rcp_f32 v145, v145
 v_rcp_f32 v146, v146
 v_rcp_f32 v147, v147
 v_pk_mul_f32 v[140:141], v[140:141], v[132:133]
 v_pk_mul_f32 v[142:143], v[142:143], v[134:135]
 v_pk_mul_f32 v[144:145], v[144:145], v[136:137]
 v_pk_mul_f32 v[146:147], v[146:147], v[138:139]
 v_cvt_pk_bf16_f32 v148, v140, v141
 v_cvt_pk_bf16_f32 v149, v142, v143
 v_cvt_pk_bf16_f32 v150, v144, v145
 v_cvt_pk_bf16_f32 v151, v146, v147
 s_nop 0
 v_permlane16_swap_b32 v148, v150
 v_permlane16_swap_b32 v149, v151
 buffer_store_dwordx4 v[148:151], v198, s[4:7], s29 offen offset:1024
 s_lshl_b32 s23, s21, 7
 s_lshl_b32 s24, s22, 4
 s_add_u32 s23, s23, s24
 s_lshl_b32 s24, s20, 2
 s_add_u32 s23, s23, s24
 s_add_u32 s23, s23, 0x6ec000
 v_mov_b32 v8, 0
 v_mov_b32 v9, 1
 s_mov_b64 exec, 1
 s_waitcnt vmcnt(0)
 buffer_store_dword v9, v8, s[4:7], s23 offen
 s_mov_b64 exec, -1
C2_e1_join:
 v_lshlrev_b32 v3, 4, v1
 s_lshl_b32 s23, s20, 11
 v_add_u32 v2, s23, v3
 v_add_u32 v3, 49152, v3
 v_add_u32 v4, 0x10000, v3
 s_lshl_b32 s30, s21, 2
 s_add_u32 s30, s30, s20
 s_mul_i32 s30, s30, 20480
 s_mul_i32 s23, s22, 2560
 s_add_u32 s30, s30, s23
 v_lshrrev_b32 v8, 4, v1
 v_lshlrev_b32 v8, 3, v8
 s_mul_i32 s24, s22, 160
 buffer_load_dwordx2 v[180:181], v8, s[12:15], s24 offen offset:0
 buffer_load_dwordx2 v[182:183], v8, s[12:15], s24 offen offset:32
 buffer_load_dwordx2 v[184:185], v8, s[12:15], s24 offen offset:64
 buffer_load_dwordx2 v[186:187], v8, s[12:15], s24 offen offset:96
 buffer_load_dwordx2 v[188:189], v8, s[12:15], s24 offen offset:128
 v_lshlrev_b32 v20, 16, v10
 v_and_b32 v21, 0xffff0000, v10
 v_lshlrev_b32 v22, 16, v11
 v_and_b32 v23, 0xffff0000, v11
 v_lshlrev_b32 v24, 16, v12
 v_and_b32 v25, 0xffff0000, v12
 v_lshlrev_b32 v26, 16, v13
 v_and_b32 v27, 0xffff0000, v13
 v_lshlrev_b32 v28, 16, v14
 v_and_b32 v29, 0xffff0000, v14
 v_lshlrev_b32 v30, 16, v15
 v_and_b32 v31, 0xffff0000, v15
 v_lshlrev_b32 v32, 16, v16
 v_and_b32 v33, 0xffff0000, v16
 v_lshlrev_b32 v34, 16, v17
 v_and_b32 v35, 0xffff0000, v17
 v_lshlrev_b32 v36, 16, v18
 v_and_b32 v37, 0xffff0000, v18
 v_lshlrev_b32 v38, 16, v19
 v_and_b32 v39, 0xffff0000, v19
 s_waitcnt vmcnt(0)
 v_lshlrev_b32 v204, 16, v180
 v_and_b32 v205, 0xffff0000, v180
 v_lshlrev_b32 v206, 16, v181
 v_and_b32 v207, 0xffff0000, v181
 v_lshlrev_b32 v208, 16, v182
 v_and_b32 v209, 0xffff0000, v182
 v_lshlrev_b32 v210, 16, v183
 v_and_b32 v211, 0xffff0000, v183
 v_lshlrev_b32 v212, 16, v184
 v_and_b32 v213, 0xffff0000, v184
 v_lshlrev_b32 v214, 16, v185
 v_and_b32 v215, 0xffff0000, v185
 v_lshlrev_b32 v216, 16, v186
 v_and_b32 v217, 0xffff0000, v186
 v_lshlrev_b32 v218, 16, v187
 v_and_b32 v219, 0xffff0000, v187
 v_lshlrev_b32 v220, 16, v188
 v_and_b32 v221, 0xffff0000, v188
 v_lshlrev_b32 v222, 16, v189
 v_and_b32 v223, 0xffff0000, v189
 v_pk_add_f32 v[20:21], v[20:21], v[204:205]
 v_pk_add_f32 v[22:23], v[22:23], v[206:207]
 v_pk_add_f32 v[24:25], v[24:25], v[208:209]
 v_pk_add_f32 v[26:27], v[26:27], v[210:211]
 v_pk_add_f32 v[28:29], v[28:29], v[212:213]
 v_pk_add_f32 v[30:31], v[30:31], v[214:215]
 v_pk_add_f32 v[32:33], v[32:33], v[216:217]
 v_pk_add_f32 v[34:35], v[34:35], v[218:219]
 v_pk_add_f32 v[36:37], v[36:37], v[220:221]
 v_pk_add_f32 v[38:39], v[38:39], v[222:223]
 v_and_b32 v70, 15, v1
 v_mul_u32_u24 v70, 1280, v70
 v_lshrrev_b32 v9, 4, v1
 v_lshlrev_b32 v71, 3, v9
 v_add_u32 v71, v70, v71
 v_and_b32 v205, 1, v9
 v_lshlrev_b32 v205, 5, v205
 v_lshrrev_b32 v9, 1, v9
 v_lshlrev_b32 v9, 4, v9
 v_add_u32 v70, v70, v9
 v_add_u32 v70, v70, v205
 s_lshl_b32 s26, s21, 2
 s_add_u32 s26, s26, s20
 s_mul_i32 s26, s26, 20480
 s_mul_i32 s23, s22, 160
 s_add_u32 s26, s26, s23
 s_barrier
 ds_read_b128 v[104:107], v2 offset:0
 ds_read_b128 v[84:87], v3 offset:25600
 ds_read_b128 v[88:91], v3 offset:26624
 ds_read_b128 v[92:95], v3 offset:27648
 ds_read_b128 v[96:99], v3 offset:28672
 ds_read_b128 v[100:103], v3 offset:29696
 ds_read_b128 v[128:131], v2 offset:1024
 ds_read_b128 v[108:111], v3 offset:30720
 ds_read_b128 v[112:115], v3 offset:31744
 ds_read_b128 v[116:119], v3 offset:32768
 ds_read_b128 v[120:123], v3 offset:33792
 ds_read_b128 v[124:127], v3 offset:34816
 s_waitcnt lgkmcnt(6)
 v_mfma_f32_16x16x32_bf16 v[20:23], v[84:87], v[104:107], v[20:23]
 s_barrier
 ds_read_b128 v[152:155], v2 offset:8192
 ds_read_b128 v[132:135], v3 offset:35840
 v_mfma_f32_16x16x32_bf16 v[24:27], v[88:91], v[104:107], v[24:27]
 ds_read_b128 v[136:139], v3 offset:36864
 v_mfma_f32_16x16x32_bf16 v[28:31], v[92:95], v[104:107], v[28:31]
 ds_read_b128 v[140:143], v3 offset:37888
 v_mfma_f32_16x16x32_bf16 v[32:35], v[96:99], v[104:107], v[32:35]
 ds_read_b128 v[144:147], v3 offset:38912
 v_mfma_f32_16x16x32_bf16 v[36:39], v[100:103], v[104:107], v[36:39]
 ds_read_b128 v[148:151], v3 offset:39936
 s_waitcnt lgkmcnt(6)
 v_mfma_f32_16x16x32_bf16 v[20:23], v[108:111], v[128:131], v[20:23]
 ds_read_b128 v[176:179], v2 offset:9216
 ds_read_b128 v[156:159], v3 offset:40960
 v_mfma_f32_16x16x32_bf16 v[24:27], v[112:115], v[128:131], v[24:27]
 ds_read_b128 v[160:163], v3 offset:41984
 v_mfma_f32_16x16x32_bf16 v[28:31], v[116:119], v[128:131], v[28:31]
 ds_read_b128 v[164:167], v3 offset:43008
 v_mfma_f32_16x16x32_bf16 v[32:35], v[120:123], v[128:131], v[32:35]
 ds_read_b128 v[168:171], v3 offset:44032
 v_mfma_f32_16x16x32_bf16 v[36:39], v[124:127], v[128:131], v[36:39]
 ds_read_b128 v[172:175], v3 offset:45056
 s_waitcnt lgkmcnt(6)
 v_mfma_f32_16x16x32_bf16 v[20:23], v[132:135], v[152:155], v[20:23]
 s_barrier
 ds_read_b128 v[104:107], v2 offset:16384
 ds_read_b128 v[84:87], v3 offset:46080
 v_mfma_f32_16x16x32_bf16 v[24:27], v[136:139], v[152:155], v[24:27]
 ds_read_b128 v[88:91], v3 offset:47104
 v_mfma_f32_16x16x32_bf16 v[28:31], v[140:143], v[152:155], v[28:31]
 ds_read_b128 v[92:95], v3 offset:48128
 v_mfma_f32_16x16x32_bf16 v[32:35], v[144:147], v[152:155], v[32:35]
 ds_read_b128 v[96:99], v3 offset:49152
 v_mfma_f32_16x16x32_bf16 v[36:39], v[148:151], v[152:155], v[36:39]
 ds_read_b128 v[100:103], v3 offset:50176
 s_waitcnt lgkmcnt(6)
 v_mfma_f32_16x16x32_bf16 v[20:23], v[156:159], v[176:179], v[20:23]
 ds_read_b128 v[128:131], v2 offset:17408
 ds_read_b128 v[108:111], v3 offset:51200
 v_mfma_f32_16x16x32_bf16 v[24:27], v[160:163], v[176:179], v[24:27]
 ds_read_b128 v[112:115], v3 offset:52224
 v_mfma_f32_16x16x32_bf16 v[28:31], v[164:167], v[176:179], v[28:31]
 ds_read_b128 v[116:119], v3 offset:53248
 v_mfma_f32_16x16x32_bf16 v[32:35], v[168:171], v[176:179], v[32:35]
 ds_read_b128 v[120:123], v3 offset:54272
 v_mfma_f32_16x16x32_bf16 v[36:39], v[172:175], v[176:179], v[36:39]
 ds_read_b128 v[124:127], v3 offset:55296
 s_waitcnt lgkmcnt(6)
 v_mfma_f32_16x16x32_bf16 v[20:23], v[84:87], v[104:107], v[20:23]
 s_barrier
 ds_read_b128 v[152:155], v2 offset:24576
 ds_read_b128 v[132:135], v3 offset:56320
 v_mfma_f32_16x16x32_bf16 v[24:27], v[88:91], v[104:107], v[24:27]
 ds_read_b128 v[136:139], v3 offset:57344
 v_mfma_f32_16x16x32_bf16 v[28:31], v[92:95], v[104:107], v[28:31]
 ds_read_b128 v[140:143], v3 offset:58368
 v_mfma_f32_16x16x32_bf16 v[32:35], v[96:99], v[104:107], v[32:35]
 ds_read_b128 v[144:147], v3 offset:59392
 v_mfma_f32_16x16x32_bf16 v[36:39], v[100:103], v[104:107], v[36:39]
 ds_read_b128 v[148:151], v3 offset:60416
 s_waitcnt lgkmcnt(6)
 v_mfma_f32_16x16x32_bf16 v[20:23], v[108:111], v[128:131], v[20:23]
 ds_read_b128 v[176:179], v2 offset:25600
 ds_read_b128 v[156:159], v3 offset:61440
 v_mfma_f32_16x16x32_bf16 v[24:27], v[112:115], v[128:131], v[24:27]
 ds_read_b128 v[160:163], v3 offset:62464
 v_mfma_f32_16x16x32_bf16 v[28:31], v[116:119], v[128:131], v[28:31]
 ds_read_b128 v[164:167], v3 offset:63488
 v_mfma_f32_16x16x32_bf16 v[32:35], v[120:123], v[128:131], v[32:35]
 ds_read_b128 v[168:171], v3 offset:64512
 v_mfma_f32_16x16x32_bf16 v[36:39], v[124:127], v[128:131], v[36:39]
 ds_read_b128 v[172:175], v4 offset:0
 s_waitcnt lgkmcnt(6)
 v_mfma_f32_16x16x32_bf16 v[20:23], v[132:135], v[152:155], v[20:23]
 s_barrier
 ds_read_b128 v[104:107], v2 offset:32768
 ds_read_b128 v[84:87], v4 offset:1024
 v_mfma_f32_16x16x32_bf16 v[24:27], v[136:139], v[152:155], v[24:27]
 ds_read_b128 v[88:91], v4 offset:2048
 v_mfma_f32_16x16x32_bf16 v[28:31], v[140:143], v[152:155], v[28:31]
 ds_read_b128 v[92:95], v4 offset:3072
 v_mfma_f32_16x16x32_bf16 v[32:35], v[144:147], v[152:155], v[32:35]
 ds_read_b128 v[96:99], v4 offset:4096
 v_mfma_f32_16x16x32_bf16 v[36:39], v[148:151], v[152:155], v[36:39]
 ds_read_b128 v[100:103], v4 offset:5120
 s_waitcnt lgkmcnt(6)
 v_mfma_f32_16x16x32_bf16 v[20:23], v[156:159], v[176:179], v[20:23]
 ds_read_b128 v[128:131], v2 offset:33792
 ds_read_b128 v[108:111], v4 offset:6144
 v_mfma_f32_16x16x32_bf16 v[24:27], v[160:163], v[176:179], v[24:27]
 ds_read_b128 v[112:115], v4 offset:7168
 v_mfma_f32_16x16x32_bf16 v[28:31], v[164:167], v[176:179], v[28:31]
 ds_read_b128 v[116:119], v4 offset:8192
 v_mfma_f32_16x16x32_bf16 v[32:35], v[168:171], v[176:179], v[32:35]
 ds_read_b128 v[120:123], v4 offset:9216
 v_mfma_f32_16x16x32_bf16 v[36:39], v[172:175], v[176:179], v[36:39]
 ds_read_b128 v[124:127], v4 offset:10240
 s_waitcnt lgkmcnt(6)
 v_mfma_f32_16x16x32_bf16 v[20:23], v[84:87], v[104:107], v[20:23]
 s_barrier
 ds_read_b128 v[152:155], v2 offset:40960
 ds_read_b128 v[132:135], v4 offset:11264
 v_mfma_f32_16x16x32_bf16 v[24:27], v[88:91], v[104:107], v[24:27]
 ds_read_b128 v[136:139], v4 offset:12288
 v_mfma_f32_16x16x32_bf16 v[28:31], v[92:95], v[104:107], v[28:31]
 ds_read_b128 v[140:143], v4 offset:13312
 v_mfma_f32_16x16x32_bf16 v[32:35], v[96:99], v[104:107], v[32:35]
 ds_read_b128 v[144:147], v4 offset:14336
 v_mfma_f32_16x16x32_bf16 v[36:39], v[100:103], v[104:107], v[36:39]
 ds_read_b128 v[148:151], v4 offset:15360
 s_waitcnt lgkmcnt(6)
 v_mfma_f32_16x16x32_bf16 v[20:23], v[108:111], v[128:131], v[20:23]
 ds_read_b128 v[176:179], v2 offset:41984
 ds_read_b128 v[156:159], v4 offset:16384
 v_mfma_f32_16x16x32_bf16 v[24:27], v[112:115], v[128:131], v[24:27]
 ds_read_b128 v[160:163], v4 offset:17408
 v_mfma_f32_16x16x32_bf16 v[28:31], v[116:119], v[128:131], v[28:31]
 ds_read_b128 v[164:167], v4 offset:18432
 v_mfma_f32_16x16x32_bf16 v[32:35], v[120:123], v[128:131], v[32:35]
 ds_read_b128 v[168:171], v4 offset:19456
 v_mfma_f32_16x16x32_bf16 v[36:39], v[124:127], v[128:131], v[36:39]
 ds_read_b128 v[172:175], v4 offset:20480
 s_waitcnt lgkmcnt(6)
 v_mfma_f32_16x16x32_bf16 v[20:23], v[132:135], v[152:155], v[20:23]
 s_barrier
 ds_read_b128 v[104:107], v2 offset:0
 ds_read_b128 v[84:87], v4 offset:21504
 v_mfma_f32_16x16x32_bf16 v[24:27], v[136:139], v[152:155], v[24:27]
 ds_read_b128 v[88:91], v4 offset:22528
 v_mfma_f32_16x16x32_bf16 v[28:31], v[140:143], v[152:155], v[28:31]
 ds_read_b128 v[92:95], v4 offset:23552
 v_mfma_f32_16x16x32_bf16 v[32:35], v[144:147], v[152:155], v[32:35]
 ds_read_b128 v[96:99], v4 offset:24576
 v_mfma_f32_16x16x32_bf16 v[36:39], v[148:151], v[152:155], v[36:39]
 ds_read_b128 v[100:103], v4 offset:25600
 s_waitcnt lgkmcnt(6)
 v_mfma_f32_16x16x32_bf16 v[20:23], v[156:159], v[176:179], v[20:23]
 ds_read_b128 v[128:131], v2 offset:1024
 ds_read_b128 v[108:111], v4 offset:26624
 v_mfma_f32_16x16x32_bf16 v[24:27], v[160:163], v[176:179], v[24:27]
 ds_read_b128 v[112:115], v4 offset:27648
 v_mfma_f32_16x16x32_bf16 v[28:31], v[164:167], v[176:179], v[28:31]
 ds_read_b128 v[116:119], v4 offset:28672
 v_mfma_f32_16x16x32_bf16 v[32:35], v[168:171], v[176:179], v[32:35]
 ds_read_b128 v[120:123], v4 offset:29696
 v_mfma_f32_16x16x32_bf16 v[36:39], v[172:175], v[176:179], v[36:39]
 ds_read_b128 v[124:127], v4 offset:30720
 s_waitcnt lgkmcnt(6)
 v_mfma_f32_16x16x32_bf16 v[20:23], v[84:87], v[104:107], v[20:23]
 s_barrier
 ds_read_b128 v[152:155], v2 offset:8192
 ds_read_b128 v[132:135], v4 offset:31744
 v_mfma_f32_16x16x32_bf16 v[24:27], v[88:91], v[104:107], v[24:27]
 ds_read_b128 v[136:139], v4 offset:32768
 v_mfma_f32_16x16x32_bf16 v[28:31], v[92:95], v[104:107], v[28:31]
 ds_read_b128 v[140:143], v4 offset:33792
 v_mfma_f32_16x16x32_bf16 v[32:35], v[96:99], v[104:107], v[32:35]
 ds_read_b128 v[144:147], v4 offset:34816
 v_mfma_f32_16x16x32_bf16 v[36:39], v[100:103], v[104:107], v[36:39]
 ds_read_b128 v[148:151], v4 offset:35840
 s_waitcnt lgkmcnt(6)
 v_mfma_f32_16x16x32_bf16 v[20:23], v[108:111], v[128:131], v[20:23]
 ds_read_b128 v[176:179], v2 offset:9216
 ds_read_b128 v[156:159], v4 offset:36864
 v_mfma_f32_16x16x32_bf16 v[24:27], v[112:115], v[128:131], v[24:27]
 ds_read_b128 v[160:163], v4 offset:37888
 v_mfma_f32_16x16x32_bf16 v[28:31], v[116:119], v[128:131], v[28:31]
 ds_read_b128 v[164:167], v4 offset:38912
 v_mfma_f32_16x16x32_bf16 v[32:35], v[120:123], v[128:131], v[32:35]
 ds_read_b128 v[168:171], v4 offset:39936
 v_mfma_f32_16x16x32_bf16 v[36:39], v[124:127], v[128:131], v[36:39]
 ds_read_b128 v[172:175], v4 offset:40960
 s_waitcnt lgkmcnt(6)
 v_mfma_f32_16x16x32_bf16 v[20:23], v[132:135], v[152:155], v[20:23]
 s_barrier
 ds_read_b128 v[104:107], v2 offset:16384
 ds_read_b128 v[84:87], v4 offset:41984
 v_mfma_f32_16x16x32_bf16 v[24:27], v[136:139], v[152:155], v[24:27]
 ds_read_b128 v[88:91], v4 offset:43008
 v_mfma_f32_16x16x32_bf16 v[28:31], v[140:143], v[152:155], v[28:31]
 ds_read_b128 v[92:95], v4 offset:44032
 v_mfma_f32_16x16x32_bf16 v[32:35], v[144:147], v[152:155], v[32:35]
 ds_read_b128 v[96:99], v4 offset:45056
 v_mfma_f32_16x16x32_bf16 v[36:39], v[148:151], v[152:155], v[36:39]
 ds_read_b128 v[100:103], v4 offset:46080
 s_waitcnt lgkmcnt(6)
 v_mfma_f32_16x16x32_bf16 v[20:23], v[156:159], v[176:179], v[20:23]
 ds_read_b128 v[128:131], v2 offset:17408
 ds_read_b128 v[108:111], v3 offset:0
 v_mfma_f32_16x16x32_bf16 v[24:27], v[160:163], v[176:179], v[24:27]
 ds_read_b128 v[112:115], v3 offset:1024
 v_mfma_f32_16x16x32_bf16 v[28:31], v[164:167], v[176:179], v[28:31]
 ds_read_b128 v[116:119], v3 offset:2048
 v_mfma_f32_16x16x32_bf16 v[32:35], v[168:171], v[176:179], v[32:35]
 ds_read_b128 v[120:123], v3 offset:3072
 v_mfma_f32_16x16x32_bf16 v[36:39], v[172:175], v[176:179], v[36:39]
 ds_read_b128 v[124:127], v3 offset:4096
 s_waitcnt lgkmcnt(6)
 v_mfma_f32_16x16x32_bf16 v[20:23], v[84:87], v[104:107], v[20:23]
 s_barrier
 ds_read_b128 v[152:155], v2 offset:24576
 ds_read_b128 v[132:135], v3 offset:5120
 v_mfma_f32_16x16x32_bf16 v[24:27], v[88:91], v[104:107], v[24:27]
 ds_read_b128 v[136:139], v3 offset:6144
 v_mfma_f32_16x16x32_bf16 v[28:31], v[92:95], v[104:107], v[28:31]
 ds_read_b128 v[140:143], v3 offset:7168
 v_mfma_f32_16x16x32_bf16 v[32:35], v[96:99], v[104:107], v[32:35]
 ds_read_b128 v[144:147], v3 offset:8192
 v_mfma_f32_16x16x32_bf16 v[36:39], v[100:103], v[104:107], v[36:39]
 ds_read_b128 v[148:151], v3 offset:9216
 s_waitcnt lgkmcnt(6)
 v_mfma_f32_16x16x32_bf16 v[20:23], v[108:111], v[128:131], v[20:23]
 ds_read_b128 v[176:179], v2 offset:25600
 ds_read_b128 v[156:159], v3 offset:10240
 v_mfma_f32_16x16x32_bf16 v[24:27], v[112:115], v[128:131], v[24:27]
 ds_read_b128 v[160:163], v3 offset:11264
 v_mfma_f32_16x16x32_bf16 v[28:31], v[116:119], v[128:131], v[28:31]
 ds_read_b128 v[164:167], v3 offset:12288
 v_mfma_f32_16x16x32_bf16 v[32:35], v[120:123], v[128:131], v[32:35]
 ds_read_b128 v[168:171], v3 offset:13312
 v_mfma_f32_16x16x32_bf16 v[36:39], v[124:127], v[128:131], v[36:39]
 ds_read_b128 v[172:175], v3 offset:14336
 s_waitcnt lgkmcnt(6)
 v_mfma_f32_16x16x32_bf16 v[20:23], v[132:135], v[152:155], v[20:23]
 s_barrier
 ds_read_b128 v[104:107], v2 offset:32768
 ds_read_b128 v[84:87], v3 offset:15360
 v_mfma_f32_16x16x32_bf16 v[24:27], v[136:139], v[152:155], v[24:27]
 ds_read_b128 v[88:91], v3 offset:16384
 v_mfma_f32_16x16x32_bf16 v[28:31], v[140:143], v[152:155], v[28:31]
 ds_read_b128 v[92:95], v3 offset:17408
 v_mfma_f32_16x16x32_bf16 v[32:35], v[144:147], v[152:155], v[32:35]
 ds_read_b128 v[96:99], v3 offset:18432
 v_mfma_f32_16x16x32_bf16 v[36:39], v[148:151], v[152:155], v[36:39]
 ds_read_b128 v[100:103], v3 offset:19456
 s_waitcnt lgkmcnt(6)
 v_mfma_f32_16x16x32_bf16 v[20:23], v[156:159], v[176:179], v[20:23]
 ds_read_b128 v[128:131], v2 offset:33792
 ds_read_b128 v[108:111], v3 offset:20480
 v_mfma_f32_16x16x32_bf16 v[24:27], v[160:163], v[176:179], v[24:27]
 ds_read_b128 v[112:115], v3 offset:21504
 v_mfma_f32_16x16x32_bf16 v[28:31], v[164:167], v[176:179], v[28:31]
 ds_read_b128 v[116:119], v3 offset:22528
 v_mfma_f32_16x16x32_bf16 v[32:35], v[168:171], v[176:179], v[32:35]
 ds_read_b128 v[120:123], v3 offset:23552
 v_mfma_f32_16x16x32_bf16 v[36:39], v[172:175], v[176:179], v[36:39]
 ds_read_b128 v[124:127], v3 offset:24576
 s_waitcnt lgkmcnt(6)
 v_mfma_f32_16x16x32_bf16 v[20:23], v[84:87], v[104:107], v[20:23]
 s_barrier
 ds_read_b128 v[152:155], v2 offset:40960
 ds_read_b128 v[132:135], v3 offset:25600
 v_mfma_f32_16x16x32_bf16 v[24:27], v[88:91], v[104:107], v[24:27]
 ds_read_b128 v[136:139], v3 offset:26624
 v_mfma_f32_16x16x32_bf16 v[28:31], v[92:95], v[104:107], v[28:31]
 ds_read_b128 v[140:143], v3 offset:27648
 v_mfma_f32_16x16x32_bf16 v[32:35], v[96:99], v[104:107], v[32:35]
 ds_read_b128 v[144:147], v3 offset:28672
 v_mfma_f32_16x16x32_bf16 v[36:39], v[100:103], v[104:107], v[36:39]
 ds_read_b128 v[148:151], v3 offset:29696
 s_waitcnt lgkmcnt(6)
 v_mfma_f32_16x16x32_bf16 v[20:23], v[108:111], v[128:131], v[20:23]
 ds_read_b128 v[176:179], v2 offset:41984
 ds_read_b128 v[156:159], v3 offset:30720
 v_mfma_f32_16x16x32_bf16 v[24:27], v[112:115], v[128:131], v[24:27]
 ds_read_b128 v[160:163], v3 offset:31744
 v_mfma_f32_16x16x32_bf16 v[28:31], v[116:119], v[128:131], v[28:31]
 ds_read_b128 v[164:167], v3 offset:32768
 v_mfma_f32_16x16x32_bf16 v[32:35], v[120:123], v[128:131], v[32:35]
 ds_read_b128 v[168:171], v3 offset:33792
 v_mfma_f32_16x16x32_bf16 v[36:39], v[124:127], v[128:131], v[36:39]
 ds_read_b128 v[172:175], v3 offset:34816
 s_waitcnt lgkmcnt(6)
 v_mfma_f32_16x16x32_bf16 v[20:23], v[132:135], v[152:155], v[20:23]
 s_barrier
 ds_read_b128 v[104:107], v2 offset:0
 ds_read_b128 v[84:87], v3 offset:35840
 v_mfma_f32_16x16x32_bf16 v[24:27], v[136:139], v[152:155], v[24:27]
 ds_read_b128 v[88:91], v3 offset:36864
 v_mfma_f32_16x16x32_bf16 v[28:31], v[140:143], v[152:155], v[28:31]
 ds_read_b128 v[92:95], v3 offset:37888
 v_mfma_f32_16x16x32_bf16 v[32:35], v[144:147], v[152:155], v[32:35]
 ds_read_b128 v[96:99], v3 offset:38912
 v_mfma_f32_16x16x32_bf16 v[36:39], v[148:151], v[152:155], v[36:39]
 ds_read_b128 v[100:103], v3 offset:39936
 s_waitcnt lgkmcnt(6)
 v_mfma_f32_16x16x32_bf16 v[20:23], v[156:159], v[176:179], v[20:23]
 ds_read_b128 v[128:131], v2 offset:1024
 ds_read_b128 v[108:111], v3 offset:40960
 v_mfma_f32_16x16x32_bf16 v[24:27], v[160:163], v[176:179], v[24:27]
 ds_read_b128 v[112:115], v3 offset:41984
 v_mfma_f32_16x16x32_bf16 v[28:31], v[164:167], v[176:179], v[28:31]
 ds_read_b128 v[116:119], v3 offset:43008
 v_mfma_f32_16x16x32_bf16 v[32:35], v[168:171], v[176:179], v[32:35]
 ds_read_b128 v[120:123], v3 offset:44032
 v_mfma_f32_16x16x32_bf16 v[36:39], v[172:175], v[176:179], v[36:39]
 ds_read_b128 v[124:127], v3 offset:45056
 s_waitcnt lgkmcnt(6)
 v_mfma_f32_16x16x32_bf16 v[20:23], v[84:87], v[104:107], v[20:23]
 s_barrier
 ds_read_b128 v[152:155], v2 offset:8192
 ds_read_b128 v[132:135], v3 offset:46080
 v_mfma_f32_16x16x32_bf16 v[24:27], v[88:91], v[104:107], v[24:27]
 ds_read_b128 v[136:139], v3 offset:47104
 v_mfma_f32_16x16x32_bf16 v[28:31], v[92:95], v[104:107], v[28:31]
 ds_read_b128 v[140:143], v3 offset:48128
 v_mfma_f32_16x16x32_bf16 v[32:35], v[96:99], v[104:107], v[32:35]
 ds_read_b128 v[144:147], v3 offset:49152
 v_mfma_f32_16x16x32_bf16 v[36:39], v[100:103], v[104:107], v[36:39]
 ds_read_b128 v[148:151], v3 offset:50176
 s_waitcnt lgkmcnt(6)
 v_mfma_f32_16x16x32_bf16 v[20:23], v[108:111], v[128:131], v[20:23]
 ds_read_b128 v[176:179], v2 offset:9216
 ds_read_b128 v[156:159], v3 offset:51200
 v_mfma_f32_16x16x32_bf16 v[24:27], v[112:115], v[128:131], v[24:27]
 ds_read_b128 v[160:163], v3 offset:52224
 v_mfma_f32_16x16x32_bf16 v[28:31], v[116:119], v[128:131], v[28:31]
 ds_read_b128 v[164:167], v3 offset:53248
 v_mfma_f32_16x16x32_bf16 v[32:35], v[120:123], v[128:131], v[32:35]
 ds_read_b128 v[168:171], v3 offset:54272
 v_mfma_f32_16x16x32_bf16 v[36:39], v[124:127], v[128:131], v[36:39]
 ds_read_b128 v[172:175], v3 offset:55296
 s_waitcnt lgkmcnt(6)
 v_mfma_f32_16x16x32_bf16 v[20:23], v[132:135], v[152:155], v[20:23]
 s_barrier
 ds_read_b128 v[104:107], v2 offset:16384
 ds_read_b128 v[84:87], v3 offset:56320
 v_mfma_f32_16x16x32_bf16 v[24:27], v[136:139], v[152:155], v[24:27]
 ds_read_b128 v[88:91], v3 offset:57344
 v_mfma_f32_16x16x32_bf16 v[28:31], v[140:143], v[152:155], v[28:31]
 ds_read_b128 v[92:95], v3 offset:58368
 v_mfma_f32_16x16x32_bf16 v[32:35], v[144:147], v[152:155], v[32:35]
 ds_read_b128 v[96:99], v3 offset:59392
 v_mfma_f32_16x16x32_bf16 v[36:39], v[148:151], v[152:155], v[36:39]
 ds_read_b128 v[100:103], v3 offset:60416
 s_waitcnt lgkmcnt(6)
 v_mfma_f32_16x16x32_bf16 v[20:23], v[156:159], v[176:179], v[20:23]
 ds_read_b128 v[128:131], v2 offset:17408
 ds_read_b128 v[108:111], v3 offset:61440
 v_mfma_f32_16x16x32_bf16 v[24:27], v[160:163], v[176:179], v[24:27]
 ds_read_b128 v[112:115], v3 offset:62464
 v_mfma_f32_16x16x32_bf16 v[28:31], v[164:167], v[176:179], v[28:31]
 ds_read_b128 v[116:119], v3 offset:63488
 v_mfma_f32_16x16x32_bf16 v[32:35], v[168:171], v[176:179], v[32:35]
 ds_read_b128 v[120:123], v3 offset:64512
 v_mfma_f32_16x16x32_bf16 v[36:39], v[172:175], v[176:179], v[36:39]
 ds_read_b128 v[124:127], v4 offset:0
 s_waitcnt lgkmcnt(6)
 v_mfma_f32_16x16x32_bf16 v[20:23], v[84:87], v[104:107], v[20:23]
 s_barrier
 ds_read_b128 v[152:155], v2 offset:24576
 ds_read_b128 v[132:135], v4 offset:1024
 v_mfma_f32_16x16x32_bf16 v[24:27], v[88:91], v[104:107], v[24:27]
 ds_read_b128 v[136:139], v4 offset:2048
 v_mfma_f32_16x16x32_bf16 v[28:31], v[92:95], v[104:107], v[28:31]
 ds_read_b128 v[140:143], v4 offset:3072
 v_mfma_f32_16x16x32_bf16 v[32:35], v[96:99], v[104:107], v[32:35]
 ds_read_b128 v[144:147], v4 offset:4096
 v_mfma_f32_16x16x32_bf16 v[36:39], v[100:103], v[104:107], v[36:39]
 ds_read_b128 v[148:151], v4 offset:5120
 s_waitcnt lgkmcnt(6)
 v_mfma_f32_16x16x32_bf16 v[20:23], v[108:111], v[128:131], v[20:23]
 ds_read_b128 v[176:179], v2 offset:25600
 ds_read_b128 v[156:159], v4 offset:6144
 v_mfma_f32_16x16x32_bf16 v[24:27], v[112:115], v[128:131], v[24:27]
 ds_read_b128 v[160:163], v4 offset:7168
 v_mfma_f32_16x16x32_bf16 v[28:31], v[116:119], v[128:131], v[28:31]
 ds_read_b128 v[164:167], v4 offset:8192
 v_mfma_f32_16x16x32_bf16 v[32:35], v[120:123], v[128:131], v[32:35]
 ds_read_b128 v[168:171], v4 offset:9216
 v_mfma_f32_16x16x32_bf16 v[36:39], v[124:127], v[128:131], v[36:39]
 ds_read_b128 v[172:175], v4 offset:10240
 s_waitcnt lgkmcnt(6)
 v_mfma_f32_16x16x32_bf16 v[20:23], v[132:135], v[152:155], v[20:23]
 s_barrier
 ds_read_b128 v[104:107], v2 offset:32768
 ds_read_b128 v[84:87], v4 offset:11264
 v_mfma_f32_16x16x32_bf16 v[24:27], v[136:139], v[152:155], v[24:27]
 ds_read_b128 v[88:91], v4 offset:12288
 v_mfma_f32_16x16x32_bf16 v[28:31], v[140:143], v[152:155], v[28:31]
 ds_read_b128 v[92:95], v4 offset:13312
 v_mfma_f32_16x16x32_bf16 v[32:35], v[144:147], v[152:155], v[32:35]
 ds_read_b128 v[96:99], v4 offset:14336
 v_mfma_f32_16x16x32_bf16 v[36:39], v[148:151], v[152:155], v[36:39]
 ds_read_b128 v[100:103], v4 offset:15360
 s_waitcnt lgkmcnt(6)
 v_mfma_f32_16x16x32_bf16 v[20:23], v[156:159], v[176:179], v[20:23]
 ds_read_b128 v[128:131], v2 offset:33792
 ds_read_b128 v[108:111], v4 offset:16384
 v_mfma_f32_16x16x32_bf16 v[24:27], v[160:163], v[176:179], v[24:27]
 ds_read_b128 v[112:115], v4 offset:17408
 v_mfma_f32_16x16x32_bf16 v[28:31], v[164:167], v[176:179], v[28:31]
 ds_read_b128 v[116:119], v4 offset:18432
 v_mfma_f32_16x16x32_bf16 v[32:35], v[168:171], v[176:179], v[32:35]
 ds_read_b128 v[120:123], v4 offset:19456
 v_mfma_f32_16x16x32_bf16 v[36:39], v[172:175], v[176:179], v[36:39]
 ds_read_b128 v[124:127], v4 offset:20480
 s_waitcnt lgkmcnt(6)
 v_mfma_f32_16x16x32_bf16 v[20:23], v[84:87], v[104:107], v[20:23]
 s_barrier
 ds_read_b128 v[152:155], v2 offset:40960
 ds_read_b128 v[132:135], v4 offset:21504
 v_mfma_f32_16x16x32_bf16 v[24:27], v[88:91], v[104:107], v[24:27]
 ds_read_b128 v[136:139], v4 offset:22528
 v_mfma_f32_16x16x32_bf16 v[28:31], v[92:95], v[104:107], v[28:31]
 ds_read_b128 v[140:143], v4 offset:23552
 v_mfma_f32_16x16x32_bf16 v[32:35], v[96:99], v[104:107], v[32:35]
 ds_read_b128 v[144:147], v4 offset:24576
 v_mfma_f32_16x16x32_bf16 v[36:39], v[100:103], v[104:107], v[36:39]
 ds_read_b128 v[148:151], v4 offset:25600
 s_waitcnt lgkmcnt(6)
 v_mfma_f32_16x16x32_bf16 v[20:23], v[108:111], v[128:131], v[20:23]
 ds_read_b128 v[176:179], v2 offset:41984
 ds_read_b128 v[156:159], v4 offset:26624
 v_mfma_f32_16x16x32_bf16 v[24:27], v[112:115], v[128:131], v[24:27]
 ds_read_b128 v[160:163], v4 offset:27648
 v_mfma_f32_16x16x32_bf16 v[28:31], v[116:119], v[128:131], v[28:31]
 ds_read_b128 v[164:167], v4 offset:28672
 v_mfma_f32_16x16x32_bf16 v[32:35], v[120:123], v[128:131], v[32:35]
 ds_read_b128 v[168:171], v4 offset:29696
 v_mfma_f32_16x16x32_bf16 v[36:39], v[124:127], v[128:131], v[36:39]
 ds_read_b128 v[172:175], v4 offset:30720
 s_waitcnt lgkmcnt(6)
 v_mfma_f32_16x16x32_bf16 v[20:23], v[132:135], v[152:155], v[20:23]
 s_barrier
 ds_read_b128 v[104:107], v2 offset:0
 ds_read_b128 v[84:87], v4 offset:31744
 v_mfma_f32_16x16x32_bf16 v[24:27], v[136:139], v[152:155], v[24:27]
 ds_read_b128 v[88:91], v4 offset:32768
 v_mfma_f32_16x16x32_bf16 v[28:31], v[140:143], v[152:155], v[28:31]
 ds_read_b128 v[92:95], v4 offset:33792
 v_mfma_f32_16x16x32_bf16 v[32:35], v[144:147], v[152:155], v[32:35]
 ds_read_b128 v[96:99], v4 offset:34816
 v_mfma_f32_16x16x32_bf16 v[36:39], v[148:151], v[152:155], v[36:39]
 ds_read_b128 v[100:103], v4 offset:35840
 s_waitcnt lgkmcnt(6)
 v_mfma_f32_16x16x32_bf16 v[20:23], v[156:159], v[176:179], v[20:23]
 ds_read_b128 v[128:131], v2 offset:1024
 ds_read_b128 v[108:111], v4 offset:36864
 v_mfma_f32_16x16x32_bf16 v[24:27], v[160:163], v[176:179], v[24:27]
 ds_read_b128 v[112:115], v4 offset:37888
 v_mfma_f32_16x16x32_bf16 v[28:31], v[164:167], v[176:179], v[28:31]
 ds_read_b128 v[116:119], v4 offset:38912
 v_mfma_f32_16x16x32_bf16 v[32:35], v[168:171], v[176:179], v[32:35]
 ds_read_b128 v[120:123], v4 offset:39936
 v_mfma_f32_16x16x32_bf16 v[36:39], v[172:175], v[176:179], v[36:39]
 ds_read_b128 v[124:127], v4 offset:40960
 s_waitcnt lgkmcnt(6)
 v_mfma_f32_16x16x32_bf16 v[20:23], v[84:87], v[104:107], v[20:23]
 s_barrier
 ds_read_b128 v[152:155], v2 offset:8192
 ds_read_b128 v[132:135], v4 offset:41984
 v_mfma_f32_16x16x32_bf16 v[24:27], v[88:91], v[104:107], v[24:27]
 ds_read_b128 v[136:139], v4 offset:43008
 v_mfma_f32_16x16x32_bf16 v[28:31], v[92:95], v[104:107], v[28:31]
 ds_read_b128 v[140:143], v4 offset:44032
 v_mfma_f32_16x16x32_bf16 v[32:35], v[96:99], v[104:107], v[32:35]
 ds_read_b128 v[144:147], v4 offset:45056
 v_mfma_f32_16x16x32_bf16 v[36:39], v[100:103], v[104:107], v[36:39]
 ds_read_b128 v[148:151], v4 offset:46080
 s_waitcnt lgkmcnt(6)
 v_mfma_f32_16x16x32_bf16 v[20:23], v[108:111], v[128:131], v[20:23]
 ds_read_b128 v[176:179], v2 offset:9216
 ds_read_b128 v[156:159], v3 offset:0
 v_mfma_f32_16x16x32_bf16 v[24:27], v[112:115], v[128:131], v[24:27]
 ds_read_b128 v[160:163], v3 offset:1024
 v_mfma_f32_16x16x32_bf16 v[28:31], v[116:119], v[128:131], v[28:31]
 ds_read_b128 v[164:167], v3 offset:2048
 v_mfma_f32_16x16x32_bf16 v[32:35], v[120:123], v[128:131], v[32:35]
 ds_read_b128 v[168:171], v3 offset:3072
 v_mfma_f32_16x16x32_bf16 v[36:39], v[124:127], v[128:131], v[36:39]
 ds_read_b128 v[172:175], v3 offset:4096
 s_waitcnt lgkmcnt(6)
 v_mfma_f32_16x16x32_bf16 v[20:23], v[132:135], v[152:155], v[20:23]
 s_barrier
 ds_read_b128 v[104:107], v2 offset:16384
 ds_read_b128 v[84:87], v3 offset:5120
 v_mfma_f32_16x16x32_bf16 v[24:27], v[136:139], v[152:155], v[24:27]
 ds_read_b128 v[88:91], v3 offset:6144
 v_mfma_f32_16x16x32_bf16 v[28:31], v[140:143], v[152:155], v[28:31]
 ds_read_b128 v[92:95], v3 offset:7168
 v_mfma_f32_16x16x32_bf16 v[32:35], v[144:147], v[152:155], v[32:35]
 ds_read_b128 v[96:99], v3 offset:8192
 v_mfma_f32_16x16x32_bf16 v[36:39], v[148:151], v[152:155], v[36:39]
 ds_read_b128 v[100:103], v3 offset:9216
 s_waitcnt lgkmcnt(6)
 v_mfma_f32_16x16x32_bf16 v[20:23], v[156:159], v[176:179], v[20:23]
 ds_read_b128 v[128:131], v2 offset:17408
 ds_read_b128 v[108:111], v3 offset:10240
 v_mfma_f32_16x16x32_bf16 v[24:27], v[160:163], v[176:179], v[24:27]
 ds_read_b128 v[112:115], v3 offset:11264
 v_mfma_f32_16x16x32_bf16 v[28:31], v[164:167], v[176:179], v[28:31]
 ds_read_b128 v[116:119], v3 offset:12288
 v_mfma_f32_16x16x32_bf16 v[32:35], v[168:171], v[176:179], v[32:35]
 ds_read_b128 v[120:123], v3 offset:13312
 v_mfma_f32_16x16x32_bf16 v[36:39], v[172:175], v[176:179], v[36:39]
 ds_read_b128 v[124:127], v3 offset:14336
 s_waitcnt lgkmcnt(6)
 v_mfma_f32_16x16x32_bf16 v[20:23], v[84:87], v[104:107], v[20:23]
 s_barrier
 ds_read_b128 v[152:155], v2 offset:24576
 ds_read_b128 v[132:135], v3 offset:15360
 v_mfma_f32_16x16x32_bf16 v[24:27], v[88:91], v[104:107], v[24:27]
 ds_read_b128 v[136:139], v3 offset:16384
 v_mfma_f32_16x16x32_bf16 v[28:31], v[92:95], v[104:107], v[28:31]
 ds_read_b128 v[140:143], v3 offset:17408
 v_mfma_f32_16x16x32_bf16 v[32:35], v[96:99], v[104:107], v[32:35]
 ds_read_b128 v[144:147], v3 offset:18432
 v_mfma_f32_16x16x32_bf16 v[36:39], v[100:103], v[104:107], v[36:39]
 ds_read_b128 v[148:151], v3 offset:19456
 s_waitcnt lgkmcnt(6)
 v_mfma_f32_16x16x32_bf16 v[20:23], v[108:111], v[128:131], v[20:23]
 ds_read_b128 v[176:179], v2 offset:25600
 ds_read_b128 v[156:159], v3 offset:20480
 v_mfma_f32_16x16x32_bf16 v[24:27], v[112:115], v[128:131], v[24:27]
 ds_read_b128 v[160:163], v3 offset:21504
 v_mfma_f32_16x16x32_bf16 v[28:31], v[116:119], v[128:131], v[28:31]
 ds_read_b128 v[164:167], v3 offset:22528
 v_mfma_f32_16x16x32_bf16 v[32:35], v[120:123], v[128:131], v[32:35]
 ds_read_b128 v[168:171], v3 offset:23552
 v_mfma_f32_16x16x32_bf16 v[36:39], v[124:127], v[128:131], v[36:39]
 ds_read_b128 v[172:175], v3 offset:24576
 s_waitcnt lgkmcnt(6)
 v_mfma_f32_16x16x32_bf16 v[20:23], v[132:135], v[152:155], v[20:23]
 s_barrier
 ds_read_b128 v[104:107], v2 offset:32768
 ds_read_b128 v[84:87], v3 offset:25600
 v_mfma_f32_16x16x32_bf16 v[24:27], v[136:139], v[152:155], v[24:27]
 ds_read_b128 v[88:91], v3 offset:26624
 v_mfma_f32_16x16x32_bf16 v[28:31], v[140:143], v[152:155], v[28:31]
 ds_read_b128 v[92:95], v3 offset:27648
 v_mfma_f32_16x16x32_bf16 v[32:35], v[144:147], v[152:155], v[32:35]
 ds_read_b128 v[96:99], v3 offset:28672
 v_mfma_f32_16x16x32_bf16 v[36:39], v[148:151], v[152:155], v[36:39]
 ds_read_b128 v[100:103], v3 offset:29696
 s_waitcnt lgkmcnt(6)
 v_mfma_f32_16x16x32_bf16 v[20:23], v[156:159], v[176:179], v[20:23]
 ds_read_b128 v[128:131], v2 offset:33792
 ds_read_b128 v[108:111], v3 offset:30720
 v_mfma_f32_16x16x32_bf16 v[24:27], v[160:163], v[176:179], v[24:27]
 ds_read_b128 v[112:115], v3 offset:31744
 v_mfma_f32_16x16x32_bf16 v[28:31], v[164:167], v[176:179], v[28:31]
 ds_read_b128 v[116:119], v3 offset:32768
 v_mfma_f32_16x16x32_bf16 v[32:35], v[168:171], v[176:179], v[32:35]
 ds_read_b128 v[120:123], v3 offset:33792
 v_mfma_f32_16x16x32_bf16 v[36:39], v[172:175], v[176:179], v[36:39]
 ds_read_b128 v[124:127], v3 offset:34816
 s_waitcnt lgkmcnt(6)
 v_mfma_f32_16x16x32_bf16 v[20:23], v[84:87], v[104:107], v[20:23]
 s_barrier
 ds_read_b128 v[152:155], v2 offset:40960
 ds_read_b128 v[132:135], v3 offset:35840
 v_mfma_f32_16x16x32_bf16 v[24:27], v[88:91], v[104:107], v[24:27]
 ds_read_b128 v[136:139], v3 offset:36864
 v_mfma_f32_16x16x32_bf16 v[28:31], v[92:95], v[104:107], v[28:31]
 ds_read_b128 v[140:143], v3 offset:37888
 v_mfma_f32_16x16x32_bf16 v[32:35], v[96:99], v[104:107], v[32:35]
 ds_read_b128 v[144:147], v3 offset:38912
 v_mfma_f32_16x16x32_bf16 v[36:39], v[100:103], v[104:107], v[36:39]
 ds_read_b128 v[148:151], v3 offset:39936
 s_waitcnt lgkmcnt(6)
 v_mfma_f32_16x16x32_bf16 v[20:23], v[108:111], v[128:131], v[20:23]
 ds_read_b128 v[176:179], v2 offset:41984
 ds_read_b128 v[156:159], v3 offset:40960
 v_mfma_f32_16x16x32_bf16 v[24:27], v[112:115], v[128:131], v[24:27]
 ds_read_b128 v[160:163], v3 offset:41984
 v_mfma_f32_16x16x32_bf16 v[28:31], v[116:119], v[128:131], v[28:31]
 ds_read_b128 v[164:167], v3 offset:43008
 v_mfma_f32_16x16x32_bf16 v[32:35], v[120:123], v[128:131], v[32:35]
 ds_read_b128 v[168:171], v3 offset:44032
 v_mfma_f32_16x16x32_bf16 v[36:39], v[124:127], v[128:131], v[36:39]
 ds_read_b128 v[172:175], v3 offset:45056
 s_waitcnt lgkmcnt(6)
 v_mfma_f32_16x16x32_bf16 v[20:23], v[132:135], v[152:155], v[20:23]
 s_barrier
 v_mfma_f32_16x16x32_bf16 v[24:27], v[136:139], v[152:155], v[24:27]
 v_mfma_f32_16x16x32_bf16 v[28:31], v[140:143], v[152:155], v[28:31]
 v_mfma_f32_16x16x32_bf16 v[32:35], v[144:147], v[152:155], v[32:35]
 v_mfma_f32_16x16x32_bf16 v[36:39], v[148:151], v[152:155], v[36:39]
 s_waitcnt lgkmcnt(0)
 v_mfma_f32_16x16x32_bf16 v[20:23], v[156:159], v[176:179], v[20:23]
 v_mfma_f32_16x16x32_bf16 v[24:27], v[160:163], v[176:179], v[24:27]
 v_mfma_f32_16x16x32_bf16 v[28:31], v[164:167], v[176:179], v[28:31]
 v_mfma_f32_16x16x32_bf16 v[32:35], v[168:171], v[176:179], v[32:35]
 v_mfma_f32_16x16x32_bf16 v[36:39], v[172:175], v[176:179], v[36:39]
 s_nop 3
 v_cvt_pk_bf16_f32 v10, v20, v21
 v_cvt_pk_bf16_f32 v11, v22, v23
 v_cvt_pk_bf16_f32 v12, v24, v25
 v_cvt_pk_bf16_f32 v13, v26, v27
 v_cvt_pk_bf16_f32 v14, v28, v29
 v_cvt_pk_bf16_f32 v15, v30, v31
 v_cvt_pk_bf16_f32 v16, v32, v33
 v_cvt_pk_bf16_f32 v17, v34, v35
 v_cvt_pk_bf16_f32 v18, v36, v37
 v_cvt_pk_bf16_f32 v19, v38, v39
 v_permlane16_swap_b32 v10, v12
 v_permlane16_swap_b32 v11, v13
 v_permlane16_swap_b32 v14, v16
 v_permlane16_swap_b32 v15, v17
 buffer_store_dwordx4 v[10:13], v70, s[16:19], s26 offen offset:0
 buffer_store_dwordx4 v[14:17], v70, s[16:19], s26 offen offset:64
 buffer_store_dwordx2 v[18:19], v71, s[16:19], s26 offen offset:128
 s_endpgm
C2_oe_slow:
 s_nop 7
 s_nop 7
 s_nop 3
 buffer_store_dwordx4 v[24:27], v168, s[4:7], s52 offen sc1
 buffer_store_dwordx4 v[32:35], v168, s[4:7], s53 offen sc1
 s_mov_b32 exec_hi, 0
 buffer_store_dwordx2 v[28:29], v169, s[4:7], s52 offen sc1
 buffer_store_dwordx2 v[36:37], v169, s[4:7], s53 offen sc1
 s_mov_b64 exec, 1
 v_mov_b32 v8, 0
 v_mov_b32 v9, 1
 s_waitcnt vmcnt(0)
 buffer_store_dword v9, v8, s[4:7], s45 offen sc1
 buffer_store_dword v9, v8, s[4:7], s47 offen sc1
 s_mov_b64 exec, -1
 s_branch C2_oe_join
C2_e0_slow:
 s_nop 7
 s_nop 7
 s_nop 3
 s_add_u32 s24, s30, 0xbf2000
 buffer_store_dwordx4 v[10:13], v5, s[4:7], s24 offen offset:0 sc1
 buffer_store_dwordx4 v[14:17], v5, s[4:7], s24 offen offset:1024 sc1
 buffer_store_dwordx2 v[18:19], v6, s[4:7], s24 offen offset:2048 sc1
 v_pk_add_f32 v[204:205], v[20:21], v[22:23]
 v_pk_mul_f32 v[206:207], v[20:21], v[20:21]
 v_pk_fma_f32 v[206:207], v[22:23], v[22:23], v[206:207]
 v_pk_add_f32 v[208:209], v[24:25], v[26:27]
 v_pk_mul_f32 v[210:211], v[24:25], v[24:25]
 v_pk_fma_f32 v[210:211], v[26:27], v[26:27], v[210:211]
 v_pk_add_f32 v[204:205], v[204:205], v[28:29]
 v_pk_fma_f32 v[206:207], v[28:29], v[28:29], v[206:207]
 v_pk_add_f32 v[208:209], v[208:209], v[30:31]
 v_pk_fma_f32 v[210:211], v[30:31], v[30:31], v[210:211]
 v_pk_add_f32 v[204:205], v[204:205], v[32:33]
 v_pk_fma_f32 v[206:207], v[32:33], v[32:33], v[206:207]
 v_pk_add_f32 v[208:209], v[208:209], v[34:35]
 v_pk_fma_f32 v[210:211], v[34:35], v[34:35], v[210:211]
 v_pk_add_f32 v[204:205], v[204:205], v[36:37]
 v_pk_fma_f32 v[206:207], v[36:37], v[36:37], v[206:207]
 v_pk_add_f32 v[208:209], v[208:209], v[38:39]
 v_pk_fma_f32 v[210:211], v[38:39], v[38:39], v[210:211]
 v_pk_add_f32 v[204:205], v[204:205], v[208:209]
 v_pk_add_f32 v[206:207], v[206:207], v[210:211]
 v_add_f32 v212, v204, v205
 v_add_f32 v213, v206, v207
 v_mov_b32 v214, v212
 v_mov_b32 v215, v213
 s_nop 0
 v_permlane16_swap_b32 v212, v214
 v_permlane16_swap_b32 v213, v215
 v_add_f32 v212, v212, v214
 v_add_f32 v213, v213, v215
 v_mov_b32 v214, v212
 v_mov_b32 v215, v213
 s_nop 0
 v_permlane32_swap_b32 v212, v214
 v_permlane32_swap_b32 v213, v215
 v_add_f32 v212, v212, v214
 v_add_f32 v213, v213, v215
 s_mov_b64 exec, 0xffff
 buffer_store_dwordx2 v[212:213], v70, s[4:7], s26 offen sc1
 s_mov_b64 exec, -1
 s_lshl_b32 s23, s21, 7
 s_lshl_b32 s24, s22, 4
 s_add_u32 s23, s23, s24
 s_lshl_b32 s24, s20, 2
 s_add_u32 s23, s23, s24
 s_add_u32 s23, s23, 0x6eb000
 v_mov_b32 v8, 0
 v_mov_b32 v9, 1
 s_mov_b64 exec, 1
 s_waitcnt vmcnt(0)
 buffer_store_dword v9, v8, s[4:7], s23 offen sc1
 s_mov_b64 exec, -1
 s_branch C2_e0_join
C2_e1_slow:
 s_nop 7
 s_nop 7
 s_nop 3
 v_pk_fma_f32 v[108:109], v[180:181], v[88:89], v[68:69] op_sel:[0,0,0] op_sel_hi:[1,0,1] neg_lo:[0,1,0] neg_hi:[0,1,0]
 v_pk_fma_f32 v[110:111], v[182:183], v[88:89], v[70:71] op_sel:[0,0,0] op_sel_hi:[1,0,1] neg_lo:[0,1,0] neg_hi:[0,1,0]
 v_pk_fma_f32 v[112:113], v[180:181], v[88:89], v[68:69] op_sel:[0,1,0] op_sel_hi:[1,1,1] neg_lo:[0,1,0] neg_hi:[0,1,0]
 v_pk_fma_f32 v[114:115], v[182:183], v[88:89], v[70:71] op_sel:[0,1,0] op_sel_hi:[1,1,1] neg_lo:[0,1,0] neg_hi:[0,1,0]
 v_pk_fma_f32 v[108:109], v[20:21], v[84:85], v[108:109] op_sel:[0,0,0] op_sel_hi:[1,0,1]
 v_pk_fma_f32 v[110:111], v[22:23], v[84:85], v[110:111] op_sel:[0,0,0] op_sel_hi:[1,0,1]
 v_pk_fma_f32 v[112:113], v[32:33], v[84:85], v[112:113] op_sel:[0,1,0] op_sel_hi:[1,1,1]
 v_pk_fma_f32 v[114:115], v[34:35], v[84:85], v[114:115] op_sel:[0,1,0] op_sel_hi:[1,1,1]
 v_pk_mul_f32 v[116:117], v[108:109], v[108:109]
 v_pk_mul_f32 v[118:119], v[110:111], v[110:111]
 v_pk_mul_f32 v[120:121], v[112:113], v[112:113]
 v_pk_mul_f32 v[122:123], v[114:115], v[114:115]
 v_pk_fma_f32 v[116:117], v[116:117], v[80:81], v[80:81] op_sel:[0,1,0] op_sel_hi:[1,1,0]
 v_pk_fma_f32 v[118:119], v[118:119], v[80:81], v[80:81] op_sel:[0,1,0] op_sel_hi:[1,1,0]
 v_pk_fma_f32 v[120:121], v[120:121], v[80:81], v[80:81] op_sel:[0,1,0] op_sel_hi:[1,1,0]
 v_pk_fma_f32 v[122:123], v[122:123], v[80:81], v[80:81] op_sel:[0,1,0] op_sel_hi:[1,1,0]
 v_pk_mul_f32 v[116:117], v[116:117], v[108:109]
 v_pk_mul_f32 v[118:119], v[118:119], v[110:111]
 v_pk_mul_f32 v[120:121], v[120:121], v[112:113]
 v_pk_mul_f32 v[122:123], v[122:123], v[114:115]
 v_exp_f32 v116, v116
 v_exp_f32 v117, v117
 v_exp_f32 v118, v118
 v_exp_f32 v119, v119
 v_exp_f32 v120, v120
 v_exp_f32 v121, v121
 v_exp_f32 v122, v122
 v_exp_f32 v123, v123
 v_pk_add_f32 v[116:117], v[116:117], v[82:83]
 v_pk_add_f32 v[118:119], v[118:119], v[82:83]
 v_pk_add_f32 v[120:121], v[120:121], v[82:83]
 v_pk_add_f32 v[122:123], v[122:123], v[82:83]
 v_rcp_f32 v116, v116
 v_rcp_f32 v117, v117
 v_rcp_f32 v118, v118
 v_rcp_f32 v119, v119
 v_rcp_f32 v120, v120
 v_rcp_f32 v121, v121
 v_rcp_f32 v122, v122
 v_rcp_f32 v123, v123
 v_pk_mul_f32 v[116:117], v[116:117], v[108:109]
 v_pk_mul_f32 v[118:119], v[118:119], v[110:111]
 v_pk_mul_f32 v[120:121], v[120:121], v[112:113]
 v_pk_mul_f32 v[122:123], v[122:123], v[114:115]
 v_cvt_pk_bf16_f32 v124, v116, v117
 v_cvt_pk_bf16_f32 v125, v118, v119
 v_cvt_pk_bf16_f32 v126, v120, v121
 v_cvt_pk_bf16_f32 v127, v122, v123
 s_nop 0
 v_permlane16_swap_b32 v124, v126
 v_permlane16_swap_b32 v125, v127
 buffer_store_dwordx4 v[124:127], v198, s[4:7], s30 offen offset:0 sc1
 v_pk_fma_f32 v[132:133], v[180:181], v[90:91], v[68:69] op_sel:[0,0,0] op_sel_hi:[1,0,1] neg_lo:[0,1,0] neg_hi:[0,1,0]
 v_pk_fma_f32 v[134:135], v[182:183], v[90:91], v[70:71] op_sel:[0,0,0] op_sel_hi:[1,0,1] neg_lo:[0,1,0] neg_hi:[0,1,0]
 v_pk_fma_f32 v[136:137], v[180:181], v[90:91], v[68:69] op_sel:[0,1,0] op_sel_hi:[1,1,1] neg_lo:[0,1,0] neg_hi:[0,1,0]
 v_pk_fma_f32 v[138:139], v[182:183], v[90:91], v[70:71] op_sel:[0,1,0] op_sel_hi:[1,1,1] neg_lo:[0,1,0] neg_hi:[0,1,0]
 v_pk_fma_f32 v[132:133], v[44:45], v[86:87], v[132:133] op_sel:[0,0,0] op_sel_hi:[1,0,1]
 v_pk_fma_f32 v[134:135], v[46:47], v[86:87], v[134:135] op_sel:[0,0,0] op_sel_hi:[1,0,1]
 v_pk_fma_f32 v[136:137], v[56:57], v[86:87], v[136:137] op_sel:[0,1,0] op_sel_hi:[1,1,1]
 v_pk_fma_f32 v[138:139], v[58:59], v[86:87], v[138:139] op_sel:[0,1,0] op_sel_hi:[1,1,1]
 v_pk_mul_f32 v[140:141], v[132:133], v[132:133]
 v_pk_mul_f32 v[142:143], v[134:135], v[134:135]
 v_pk_mul_f32 v[144:145], v[136:137], v[136:137]
 v_pk_mul_f32 v[146:147], v[138:139], v[138:139]
 v_pk_fma_f32 v[140:141], v[140:141], v[80:81], v[80:81] op_sel:[0,1,0] op_sel_hi:[1,1,0]
 v_pk_fma_f32 v[142:143], v[142:143], v[80:81], v[80:81] op_sel:[0,1,0] op_sel_hi:[1,1,0]
 v_pk_fma_f32 v[144:145], v[144:145], v[80:81], v[80:81] op_sel:[0,1,0] op_sel_hi:[1,1,0]
 v_pk_fma_f32 v[146:147], v[146:147], v[80:81], v[80:81] op_sel:[0,1,0] op_sel_hi:[1,1,0]
 v_pk_mul_f32 v[140:141], v[140:141], v[132:133]
 v_pk_mul_f32 v[142:143], v[142:143], v[134:135]
 v_pk_mul_f32 v[144:145], v[144:145], v[136:137]
 v_pk_mul_f32 v[146:147], v[146:147], v[138:139]
 v_exp_f32 v140, v140
 v_exp_f32 v141, v141
 v_exp_f32 v142, v142
 v_exp_f32 v143, v143
 v_exp_f32 v144, v144
 v_exp_f32 v145, v145
 v_exp_f32 v146, v146
 v_exp_f32 v147, v147
 v_pk_add_f32 v[140:141], v[140:141], v[82:83]
 v_pk_add_f32 v[142:143], v[142:143], v[82:83]
 v_pk_add_f32 v[144:145], v[144:145], v[82:83]
 v_pk_add_f32 v[146:147], v[146:147], v[82:83]
 v_rcp_f32 v140, v140
 v_rcp_f32 v141, v141
 v_rcp_f32 v142, v142
 v_rcp_f32 v143, v143
 v_rcp_f32 v144, v144
 v_rcp_f32 v145, v145
 v_rcp_f32 v146, v146
 v_rcp_f32 v147, v147
 v_pk_mul_f32 v[140:141], v[140:141], v[132:133]
 v_pk_mul_f32 v[142:143], v[142:143], v[134:135]
 v_pk_mul_f32 v[144:145], v[144:145], v[136:137]
 v_pk_mul_f32 v[146:147], v[146:147], v[138:139]
 v_cvt_pk_bf16_f32 v148, v140, v141
 v_cvt_pk_bf16_f32 v149, v142, v143
 v_cvt_pk_bf16_f32 v150, v144, v145
 v_cvt_pk_bf16_f32 v151, v146, v147
 s_nop 0
 v_permlane16_swap_b32 v148, v150
 v_permlane16_swap_b32 v149, v151
 buffer_store_dwordx4 v[148:151], v198, s[4:7], s29 offen offset:0 sc1
 v_pk_fma_f32 v[108:109], v[184:185], v[88:89], v[72:73] op_sel:[0,0,0] op_sel_hi:[1,0,1] neg_lo:[0,1,0] neg_hi:[0,1,0]
 v_pk_fma_f32 v[110:111], v[186:187], v[88:89], v[74:75] op_sel:[0,0,0] op_sel_hi:[1,0,1] neg_lo:[0,1,0] neg_hi:[0,1,0]
 v_pk_fma_f32 v[112:113], v[184:185], v[88:89], v[72:73] op_sel:[0,1,0] op_sel_hi:[1,1,1] neg_lo:[0,1,0] neg_hi:[0,1,0]
 v_pk_fma_f32 v[114:115], v[186:187], v[88:89], v[74:75] op_sel:[0,1,0] op_sel_hi:[1,1,1] neg_lo:[0,1,0] neg_hi:[0,1,0]
 v_pk_fma_f32 v[108:109], v[24:25], v[84:85], v[108:109] op_sel:[0,0,0] op_sel_hi:[1,0,1]
 v_pk_fma_f32 v[110:111], v[26:27], v[84:85], v[110:111] op_sel:[0,0,0] op_sel_hi:[1,0,1]
 v_pk_fma_f32 v[112:113], v[36:37], v[84:85], v[112:113] op_sel:[0,1,0] op_sel_hi:[1,1,1]
 v_pk_fma_f32 v[114:115], v[38:39], v[84:85], v[114:115] op_sel:[0,1,0] op_sel_hi:[1,1,1]
 v_pk_mul_f32 v[116:117], v[108:109], v[108:109]
 v_pk_mul_f32 v[118:119], v[110:111], v[110:111]
 v_pk_mul_f32 v[120:121], v[112:113], v[112:113]
 v_pk_mul_f32 v[122:123], v[114:115], v[114:115]
 v_pk_fma_f32 v[116:117], v[116:117], v[80:81], v[80:81] op_sel:[0,1,0] op_sel_hi:[1,1,0]
 v_pk_fma_f32 v[118:119], v[118:119], v[80:81], v[80:81] op_sel:[0,1,0] op_sel_hi:[1,1,0]
 v_pk_fma_f32 v[120:121], v[120:121], v[80:81], v[80:81] op_sel:[0,1,0] op_sel_hi:[1,1,0]
 v_pk_fma_f32 v[122:123], v[122:123], v[80:81], v[80:81] op_sel:[0,1,0] op_sel_hi:[1,1,0]
 v_pk_mul_f32 v[116:117], v[116:117], v[108:109]
 v_pk_mul_f32 v[118:119], v[118:119], v[110:111]
 v_pk_mul_f32 v[120:121], v[120:121], v[112:113]
 v_pk_mul_f32 v[122:123], v[122:123], v[114:115]
 v_exp_f32 v116, v116
 v_exp_f32 v117, v117
 v_exp_f32 v118, v118
 v_exp_f32 v119, v119
 v_exp_f32 v120, v120
 v_exp_f32 v121, v121
 v_exp_f32 v122, v122
 v_exp_f32 v123, v123
 v_pk_add_f32 v[116:117], v[116:117], v[82:83]
 v_pk_add_f32 v[118:119], v[118:119], v[82:83]
 v_pk_add_f32 v[120:121], v[120:121], v[82:83]
 v_pk_add_f32 v[122:123], v[122:123], v[82:83]
 v_rcp_f32 v116, v116
 v_rcp_f32 v117, v117
 v_rcp_f32 v118, v118
 v_rcp_f32 v119, v119
 v_rcp_f32 v120, v120
 v_rcp_f32 v121, v121
 v_rcp_f32 v122, v122
 v_rcp_f32 v123, v123
 v_pk_mul_f32 v[116:117], v[116:117], v[108:109]
 v_pk_mul_f32 v[118:119], v[118:119], v[110:111]
 v_pk_mul_f32 v[120:121], v[120:121], v[112:113]
 v_pk_mul_f32 v[122:123], v[122:123], v[114:115]
 v_cvt_pk_bf16_f32 v124, v116, v117
 v_cvt_pk_bf16_f32 v125, v118, v119
 v_cvt_pk_bf16_f32 v126, v120, v121
 v_cvt_pk_bf16_f32 v127, v122, v123
 s_nop 0
 v_permlane16_swap_b32 v124, v126
 v_permlane16_swap_b32 v125, v127
 buffer_store_dwordx4 v[124:127], v198, s[4:7], s30 offen offset:512 sc1
 v_pk_fma_f32 v[132:133], v[184:185], v[90:91], v[72:73] op_sel:[0,0,0] op_sel_hi:[1,0,1] neg_lo:[0,1,0] neg_hi:[0,1,0]
 v_pk_fma_f32 v[134:135], v[186:187], v[90:91], v[74:75] op_sel:[0,0,0] op_sel_hi:[1,0,1] neg_lo:[0,1,0] neg_hi:[0,1,0]
 v_pk_fma_f32 v[136:137], v[184:185], v[90:91], v[72:73] op_sel:[0,1,0] op_sel_hi:[1,1,1] neg_lo:[0,1,0] neg_hi:[0,1,0]
 v_pk_fma_f32 v[138:139], v[186:187], v[90:91], v[74:75] op_sel:[0,1,0] op_sel_hi:[1,1,1] neg_lo:[0,1,0] neg_hi:[0,1,0]
 v_pk_fma_f32 v[132:133], v[48:49], v[86:87], v[132:133] op_sel:[0,0,0] op_sel_hi:[1,0,1]
 v_pk_fma_f32 v[134:135], v[50:51], v[86:87], v[134:135] op_sel:[0,0,0] op_sel_hi:[1,0,1]
 v_pk_fma_f32 v[136:137], v[60:61], v[86:87], v[136:137] op_sel:[0,1,0] op_sel_hi:[1,1,1]
 v_pk_fma_f32 v[138:139], v[62:63], v[86:87], v[138:139] op_sel:[0,1,0] op_sel_hi:[1,1,1]
 v_pk_mul_f32 v[140:141], v[132:133], v[132:133]
 v_pk_mul_f32 v[142:143], v[134:135], v[134:135]
 v_pk_mul_f32 v[144:145], v[136:137], v[136:137]
 v_pk_mul_f32 v[146:147], v[138:139], v[138:139]
 v_pk_fma_f32 v[140:141], v[140:141], v[80:81], v[80:81] op_sel:[0,1,0] op_sel_hi:[1,1,0]
 v_pk_fma_f32 v[142:143], v[142:143], v[80:81], v[80:81] op_sel:[0,1,0] op_sel_hi:[1,1,0]
 v_pk_fma_f32 v[144:145], v[144:145], v[80:81], v[80:81] op_sel:[0,1,0] op_sel_hi:[1,1,0]
 v_pk_fma_f32 v[146:147], v[146:147], v[80:81], v[80:81] op_sel:[0,1,0] op_sel_hi:[1,1,0]
 v_pk_mul_f32 v[140:141], v[140:141], v[132:133]
 v_pk_mul_f32 v[142:143], v[142:143], v[134:135]
 v_pk_mul_f32 v[144:145], v[144:145], v[136:137]
 v_pk_mul_f32 v[146:147], v[146:147], v[138:139]
 v_exp_f32 v140, v140
 v_exp_f32 v141, v141
 v_exp_f32 v142, v142
 v_exp_f32 v143, v143
 v_exp_f32 v144, v144
 v_exp_f32 v145, v145
 v_exp_f32 v146, v146
 v_exp_f32 v147, v147
 v_pk_add_f32 v[140:141], v[140:141], v[82:83]
 v_pk_add_f32 v[142:143], v[142:143], v[82:83]
 v_pk_add_f32 v[144:145], v[144:145], v[82:83]
 v_pk_add_f32 v[146:147], v[146:147], v[82:83]
 v_rcp_f32 v140, v140
 v_rcp_f32 v141, v141
 v_rcp_f32 v142, v142
 v_rcp_f32 v143, v143
 v_rcp_f32 v144, v144
 v_rcp_f32 v145, v145
 v_rcp_f32 v146, v146
 v_rcp_f32 v147, v147
 v_pk_mul_f32 v[140:141], v[140:141], v[132:133]
 v_pk_mul_f32 v[142:143], v[142:143], v[134:135]
 v_pk_mul_f32 v[144:145], v[144:145], v[136:137]
 v_pk_mul_f32 v[146:147], v[146:147], v[138:139]
 v_cvt_pk_bf16_f32 v148, v140, v141
 v_cvt_pk_bf16_f32 v149, v142, v143
 v_cvt_pk_bf16_f32 v150, v144, v145
 v_cvt_pk_bf16_f32 v151, v146, v147
 s_nop 0
 v_permlane16_swap_b32 v148, v150
 v_permlane16_swap_b32 v149, v151
 buffer_store_dwordx4 v[148:151], v198, s[4:7], s29 offen offset:512 sc1
 v_pk_fma_f32 v[108:109], v[188:189], v[88:89], v[76:77] op_sel:[0,0,0] op_sel_hi:[1,0,1] neg_lo:[0,1,0] neg_hi:[0,1,0]
 v_pk_fma_f32 v[110:111], v[190:191], v[88:89], v[78:79] op_sel:[0,0,0] op_sel_hi:[1,0,1] neg_lo:[0,1,0] neg_hi:[0,1,0]
 v_pk_fma_f32 v[112:113], v[188:189], v[88:89], v[76:77] op_sel:[0,1,0] op_sel_hi:[1,1,1] neg_lo:[0,1,0] neg_hi:[0,1,0]
 v_pk_fma_f32 v[114:115], v[190:191], v[88:89], v[78:79] op_sel:[0,1,0] op_sel_hi:[1,1,1] neg_lo:[0,1,0] neg_hi:[0,1,0]
 v_pk_fma_f32 v[108:109], v[28:29], v[84:85], v[108:109] op_sel:[0,0,0] op_sel_hi:[1,0,1]
 v_pk_fma_f32 v[110:111], v[30:31], v[84:85], v[110:111] op_sel:[0,0,0] op_sel_hi:[1,0,1]
 v_pk_fma_f32 v[112:113], v[40:41], v[84:85], v[112:113] op_sel:[0,1,0] op_sel_hi:[1,1,1]
 v_pk_fma_f32 v[114:115], v[42:43], v[84:85], v[114:115] op_sel:[0,1,0] op_sel_hi:[1,1,1]
 v_pk_mul_f32 v[116:117], v[108:109], v[108:109]
 v_pk_mul_f32 v[118:119], v[110:111], v[110:111]
 v_pk_mul_f32 v[120:121], v[112:113], v[112:113]
 v_pk_mul_f32 v[122:123], v[114:115], v[114:115]
 v_pk_fma_f32 v[116:117], v[116:117], v[80:81], v[80:81] op_sel:[0,1,0] op_sel_hi:[1,1,0]
 v_pk_fma_f32 v[118:119], v[118:119], v[80:81], v[80:81] op_sel:[0,1,0] op_sel_hi:[1,1,0]
 v_pk_fma_f32 v[120:121], v[120:121], v[80:81], v[80:81] op_sel:[0,1,0] op_sel_hi:[1,1,0]
 v_pk_fma_f32 v[122:123], v[122:123], v[80:81], v[80:81] op_sel:[0,1,0] op_sel_hi:[1,1,0]
 v_pk_mul_f32 v[116:117], v[116:117], v[108:109]
 v_pk_mul_f32 v[118:119], v[118:119], v[110:111]
 v_pk_mul_f32 v[120:121], v[120:121], v[112:113]
 v_pk_mul_f32 v[122:123], v[122:123], v[114:115]
 v_exp_f32 v116, v116
 v_exp_f32 v117, v117
 v_exp_f32 v118, v118
 v_exp_f32 v119, v119
 v_exp_f32 v120, v120
 v_exp_f32 v121, v121
 v_exp_f32 v122, v122
 v_exp_f32 v123, v123
 v_pk_add_f32 v[116:117], v[116:117], v[82:83]
 v_pk_add_f32 v[118:119], v[118:119], v[82:83]
 v_pk_add_f32 v[120:121], v[120:121], v[82:83]
 v_pk_add_f32 v[122:123], v[122:123], v[82:83]
 v_rcp_f32 v116, v116
 v_rcp_f32 v117, v117
 v_rcp_f32 v118, v118
 v_rcp_f32 v119, v119
 v_rcp_f32 v120, v120
 v_rcp_f32 v121, v121
 v_rcp_f32 v122, v122
 v_rcp_f32 v123, v123
 v_pk_mul_f32 v[116:117], v[116:117], v[108:109]
 v_pk_mul_f32 v[118:119], v[118:119], v[110:111]
 v_pk_mul_f32 v[120:121], v[120:121], v[112:113]
 v_pk_mul_f32 v[122:123], v[122:123], v[114:115]
 v_cvt_pk_bf16_f32 v124, v116, v117
 v_cvt_pk_bf16_f32 v125, v118, v119
 v_cvt_pk_bf16_f32 v126, v120, v121
 v_cvt_pk_bf16_f32 v127, v122, v123
 s_nop 0
 v_permlane16_swap_b32 v124, v126
 v_permlane16_swap_b32 v125, v127
 buffer_store_dwordx4 v[124:127], v198, s[4:7], s30 offen offset:1024 sc1
 v_pk_fma_f32 v[132:133], v[188:189], v[90:91], v[76:77] op_sel:[0,0,0] op_sel_hi:[1,0,1] neg_lo:[0,1,0] neg_hi:[0,1,0]
 v_pk_fma_f32 v[134:135], v[190:191], v[90:91], v[78:79] op_sel:[0,0,0] op_sel_hi:[1,0,1] neg_lo:[0,1,0] neg_hi:[0,1,0]
 v_pk_fma_f32 v[136:137], v[188:189], v[90:91], v[76:77] op_sel:[0,1,0] op_sel_hi:[1,1,1] neg_lo:[0,1,0] neg_hi:[0,1,0]
 v_pk_fma_f32 v[138:139], v[190:191], v[90:91], v[78:79] op_sel:[0,1,0] op_sel_hi:[1,1,1] neg_lo:[0,1,0] neg_hi:[0,1,0]
 v_pk_fma_f32 v[132:133], v[52:53], v[86:87], v[132:133] op_sel:[0,0,0] op_sel_hi:[1,0,1]
 v_pk_fma_f32 v[134:135], v[54:55], v[86:87], v[134:135] op_sel:[0,0,0] op_sel_hi:[1,0,1]
 v_pk_fma_f32 v[136:137], v[64:65], v[86:87], v[136:137] op_sel:[0,1,0] op_sel_hi:[1,1,1]
 v_pk_fma_f32 v[138:139], v[66:67], v[86:87], v[138:139] op_sel:[0,1,0] op_sel_hi:[1,1,1]
 v_pk_mul_f32 v[140:141], v[132:133], v[132:133]
 v_pk_mul_f32 v[142:143], v[134:135], v[134:135]
 v_pk_mul_f32 v[144:145], v[136:137], v[136:137]
 v_pk_mul_f32 v[146:147], v[138:139], v[138:139]
 v_pk_fma_f32 v[140:141], v[140:141], v[80:81], v[80:81] op_sel:[0,1,0] op_sel_hi:[1,1,0]
 v_pk_fma_f32 v[142:143], v[142:143], v[80:81], v[80:81] op_sel:[0,1,0] op_sel_hi:[1,1,0]
 v_pk_fma_f32 v[144:145], v[144:145], v[80:81], v[80:81] op_sel:[0,1,0] op_sel_hi:[1,1,0]
 v_pk_fma_f32 v[146:147], v[146:147], v[80:81], v[80:81] op_sel:[0,1,0] op_sel_hi:[1,1,0]
 v_pk_mul_f32 v[140:141], v[140:141], v[132:133]
 v_pk_mul_f32 v[142:143], v[142:143], v[134:135]
 v_pk_mul_f32 v[144:145], v[144:145], v[136:137]
 v_pk_mul_f32 v[146:147], v[146:147], v[138:139]
 v_exp_f32 v140, v140
 v_exp_f32 v141, v141
 v_exp_f32 v142, v142
 v_exp_f32 v143, v143
 v_exp_f32 v144, v144
 v_exp_f32 v145, v145
 v_exp_f32 v146, v146
 v_exp_f32 v147, v147
 v_pk_add_f32 v[140:141], v[140:141], v[82:83]
 v_pk_add_f32 v[142:143], v[142:143], v[82:83]
 v_pk_add_f32 v[144:145], v[144:145], v[82:83]
 v_pk_add_f32 v[146:147], v[146:147], v[82:83]
 v_rcp_f32 v140, v140
 v_rcp_f32 v141, v141
 v_rcp_f32 v142, v142
 v_rcp_f32 v143, v143
 v_rcp_f32 v144, v144
 v_rcp_f32 v145, v145
 v_rcp_f32 v146, v146
 v_rcp_f32 v147, v147
 v_pk_mul_f32 v[140:141], v[140:141], v[132:133]
 v_pk_mul_f32 v[142:143], v[142:143], v[134:135]
 v_pk_mul_f32 v[144:145], v[144:145], v[136:137]
 v_pk_mul_f32 v[146:147], v[146:147], v[138:139]
 v_cvt_pk_bf16_f32 v148, v140, v141
 v_cvt_pk_bf16_f32 v149, v142, v143
 v_cvt_pk_bf16_f32 v150, v144, v145
 v_cvt_pk_bf16_f32 v151, v146, v147
 s_nop 0
 v_permlane16_swap_b32 v148, v150
 v_permlane16_swap_b32 v149, v151
 buffer_store_dwordx4 v[148:151], v198, s[4:7], s29 offen offset:1024 sc1
 s_lshl_b32 s23, s21, 7
 s_lshl_b32 s24, s22, 4
 s_add_u32 s23, s23, s24
 s_lshl_b32 s24, s20, 2
 s_add_u32 s23, s23, s24
 s_add_u32 s23, s23, 0x6ec000
 v_mov_b32 v8, 0
 v_mov_b32 v9, 1
 s_mov_b64 exec, 1
 s_waitcnt vmcnt(0)
 buffer_store_dword v9, v8, s[4:7], s23 offen sc1
 s_mov_b64 exec, -1
 s_branch C2_e1_join
C2_bl0:
 s_waitcnt lgkmcnt(0)
 s_getreg_b32 s34, hwreg(HW_REG_XCC_ID, 0, 4)
 s_add_u32 s34, s34, 1
 s_and_b32 s35, s2, 7
 s_lshl_b32 s35, s35, 7
 s_add_u32 s35, s35, 0x6ed400
 s_lshr_b32 s36, s2, 3
 s_lshl_b32 s36, s36, 2
 s_add_u32 s36, s36, s35
 v_mov_b32 v8, 0
 v_mov_b32 v9, s34
 s_mov_b64 exec, 1
 buffer_store_dword v9, v8, s[4:7], s36 offen sc1
 s_mov_b64 exec, -1
 s_mul_i32 s23, s22, 901120
 v_lshlrev_b32 v2, 4, v1
 v_add_u32 v2, s23, v2
 s_mov_b32 m0, 0xc000
 s_mov_b32 s24, 0x0
 buffer_load_dwordx4 v2, s[4:7], s24 offen offset:0 lds
 buffer_load_dwordx4 v2, s[4:7], s24 offen offset:1024 lds
 buffer_load_dwordx4 v2, s[4:7], s24 offen offset:2048 lds
 buffer_load_dwordx4 v2, s[4:7], s24 offen offset:3072 lds
 s_mov_b32 m0, 0xd000
 s_mov_b32 s24, 0x1000
 buffer_load_dwordx4 v2, s[4:7], s24 offen offset:0 lds
 s_mov_b32 m0, 0xe800
 s_mov_b32 s24, 0x2800
 buffer_load_dwordx4 v2, s[4:7], s24 offen offset:0 lds
 buffer_load_dwordx4 v2, s[4:7], s24 offen offset:1024 lds
 buffer_load_dwordx4 v2, s[4:7], s24 offen offset:2048 lds
 buffer_load_dwordx4 v2, s[4:7], s24 offen offset:3072 lds
 s_mov_b32 m0, 0xf800
 s_mov_b32 s24, 0x3800
 buffer_load_dwordx4 v2, s[4:7], s24 offen offset:0 lds
 s_mov_b32 m0, 0x11000
 s_mov_b32 s24, 0x5000
 buffer_load_dwordx4 v2, s[4:7], s24 offen offset:0 lds
 buffer_load_dwordx4 v2, s[4:7], s24 offen offset:1024 lds
 buffer_load_dwordx4 v2, s[4:7], s24 offen offset:2048 lds
 buffer_load_dwordx4 v2, s[4:7], s24 offen offset:3072 lds
 s_mov_b32 m0, 0x12000
 s_mov_b32 s24, 0x6000
 buffer_load_dwordx4 v2, s[4:7], s24 offen offset:0 lds
 s_waitcnt vmcnt(0)
 v_and_b32 v8, 31, v1
 v_lshlrev_b32 v8, 2, v8
 s_mov_b32 s36, 20000
 s_mov_b32 s33, 0
C2_xq:
 buffer_load_dword v9, v8, s[4:7], s35 offen sc1
 s_sub_u32 s36, s36, 1
 s_waitcnt vmcnt(0)
 v_cmp_eq_u32 vcc, 0, v9
 s_cmp_eq_u32 s36, 0
 s_cbranch_scc1 C2_xqx
 s_nop 1
 s_cbranch_vccnz C2_xq
 v_cmp_ne_u32 vcc, s34, v9
 s_nop 4
 s_cbranch_vccnz C2_xqx
 s_mov_b32 s33, 1
C2_xqx:
 v_mov_b32 v8, 162816
 v_mov_b32 v9, s33
 ds_write_b32 v8, v9
 s_waitcnt lgkmcnt(0)
 s_sub_u32 s38, s20, 4
 s_lshl_b32 s59, s22, 2
 s_add_u32 s59, s59, s38
 s_mul_i32 s58, s21, 81920
 s_mul_i32 s37, s59, 2560
 s_add_u32 s58, s58, s37
 s_add_u32 s56, s16, s58
 s_addc_u32 s57, s17, 0
 s_load_dword s40, s[56:57], 0
 s_load_dword s41, s[56:57], 32
 s_load_dword s42, s[56:57], 64
 s_load_dword s43, s[56:57], 96
 s_load_dword s44, s[56:57], 128
 s_load_dword s45, s[56:57], 160
 s_load_dword s46, s[56:57], 192
 s_load_dword s47, s[56:57], 224
 s_load_dword s48, s[56:57], 256
 s_load_dword s49, s[56:57], 288
 s_load_dword s50, s[56:57], 320
 s_load_dword s51, s[56:57], 352
 s_load_dword s52, s[56:57], 384
 s_load_dword s53, s[56:57], 416
 s_waitcnt lgkmcnt(0)
 s_load_dword s40, s[56:57], 448
 s_load_dword s41, s[56:57], 480
 s_load_dword s42, s[56:57], 512
 s_load_dword s43, s[56:57], 544
 s_load_dword s44, s[56:57], 576
 s_load_dword s45, s[56:57], 608
 s_load_dword s46, s[56:57], 640
 s_load_dword s47, s[56:57], 672
 s_load_dword s48, s[56:57], 704
 s_load_dword s49, s[56:57], 736
 s_load_dword s50, s[56:57], 768
 s_load_dword s51, s[56:57], 800
 s_load_dword s52, s[56:57], 832
 s_load_dword s53, s[56:57], 864
 s_waitcnt lgkmcnt(0)
 s_load_dword s40, s[56:57], 896
 s_load_dword s41, s[56:57], 928
 s_load_dword s42, s[56:57], 960
 s_load_dword s43, s[56:57], 992
 s_load_dword s44, s[56:57], 1024
 s_load_dword s45, s[56:57], 1056
 s_load_dword s46, s[56:57], 1088
 s_load_dword s47, s[56:57], 1120
 s_load_dword s48, s[56:57], 1152
 s_load_dword s49, s[56:57], 1184
 s_load_dword s50, s[56:57], 1216
 s_load_dword s51, s[56:57], 1248
 s_load_dword s52, s[56:57], 1280
 s_load_dword s53, s[56:57], 1312
 s_waitcnt lgkmcnt(0)
 s_load_dword s40, s[56:57], 1344
 s_load_dword s41, s[56:57], 1376
 s_load_dword s42, s[56:57], 1408
 s_load_dword s43, s[56:57], 1440
 s_load_dword s44, s[56:57], 1472
 s_load_dword s45, s[56:57], 1504
 s_load_dword s46, s[56:57], 1536
 s_load_dword s47, s[56:57], 1568
 s_load_dword s48, s[56:57], 1600
 s_load_dword s49, s[56:57], 1632
 s_load_dword s50, s[56:57], 1664
 s_load_dword s51, s[56:57], 1696
 s_load_dword s52, s[56:57], 1728
 s_load_dword s53, s[56:57], 1760
 s_waitcnt lgkmcnt(0)
 s_load_dword s40, s[56:57], 1792
 s_load_dword s41, s[56:57], 1824
 s_load_dword s42, s[56:57], 1856
 s_load_dword s43, s[56:57], 1888
 s_load_dword s44, s[56:57], 1920
 s_load_dword s45, s[56:57], 1952
 s_load_dword s46, s[56:57], 1984
 s_load_dword s47, s[56:57], 2016
 s_load_dword s48, s[56:57], 2048
 s_load_dword s49, s[56:57], 2080
 s_load_dword s50, s[56:57], 2112
 s_load_dword s51, s[56:57], 2144
 s_load_dword s52, s[56:57], 2176
 s_load_dword s53, s[56:57], 2208
 s_waitcnt lgkmcnt(0)
 s_load_dword s40, s[56:57], 2240
 s_load_dword s41, s[56:57], 2272
 s_load_dword s42, s[56:57], 2304
 s_load_dword s43, s[56:57], 2336
 s_load_dword s44, s[56:57], 2368
 s_load_dword s45, s[56:57], 2400
 s_load_dword s46, s[56:57], 2432
 s_load_dword s47, s[56:57], 2464
 s_load_dword s48, s[56:57], 2496
 s_load_dword s49, s[56:57], 2528
 s_lshr_b32 s58, s2, 3
 s_lshl_b32 s58, s58, 2
 s_add_u32 s58, s58, s38
 s_getpc_b64 s[56:57]
C2_pc7:
 s_sub_u32 s56, s56, C2_pc7-C2_start
 s_subb_u32 s57, s57, 0
 s_mul_i32 s58, s58, 32
 s_add_u32 s37, s58, 0
 s_min_u32 s37, s37, C2_end-C2_start
 s_load_dword s50, s[56:57], s37
 s_add_u32 s37, s58, 4096
 s_min_u32 s37, s37, C2_end-C2_start
 s_load_dword s51, s[56:57], s37
 s_add_u32 s37, s58, 8192
 s_min_u32 s37, s37, C2_end-C2_start
 s_load_dword s52, s[56:57], s37
 s_add_u32 s37, s58, 12288
 s_min_u32 s37, s37, C2_end-C2_start
 s_load_dword s53, s[56:57], s37
 s_waitcnt lgkmcnt(0)
 s_add_u32 s37, s58, 16384
 s_min_u32 s37, s37, C2_end-C2_start
 s_load_dword s40, s[56:57], s37
 s_add_u32 s37, s58, 20480
 s_min_u32 s37, s37, C2_end-C2_start
 s_load_dword s41, s[56:57], s37
 s_add_u32 s37, s58, 24576
 s_min_u32 s37, s37, C2_end-C2_start
 s_load_dword s42, s[56:57], s37
 s_add_u32 s37, s58, 28672
 s_min_u32 s37, s37, C2_end-C2_start
 s_load_dword s43, s[56:57], s37
 s_add_u32 s37, s58, 32768
 s_min_u32 s37, s37, C2_end-C2_start
 s_load_dword s44, s[56:57], s37
 s_waitcnt lgkmcnt(0)
 s_mov_b32 m0, 0x13800
 s_mov_b32 s24, 0x7800
 buffer_load_dwordx4 v2, s[4:7], s24 offen offset:0 lds
 buffer_load_dwordx4 v2, s[4:7], s24 offen offset:1024 lds
 buffer_load_dwordx4 v2, s[4:7], s24 offen offset:2048 lds
 buffer_load_dwordx4 v2, s[4:7], s24 offen offset:3072 lds
 s_mov_b32 m0, 0x14800
 s_mov_b32 s24, 0x8800
 buffer_load_dwordx4 v2, s[4:7], s24 offen offset:0 lds
 s_mov_b32 m0, 0x16000
 s_mov_b32 s24, 0xa000
 buffer_load_dwordx4 v2, s[4:7], s24 offen offset:0 lds
 buffer_load_dwordx4 v2, s[4:7], s24 offen offset:1024 lds
 buffer_load_dwordx4 v2, s[4:7], s24 offen offset:2048 lds
 buffer_load_dwordx4 v2, s[4:7], s24 offen offset:3072 lds
 s_mov_b32 m0, 0x17000
 s_mov_b32 s24, 0xb000
 buffer_load_dwordx4 v2, s[4:7], s24 offen offset:0 lds
 s_mov_b32 m0, 0x18800
 s_mov_b32 s24, 0xc800
 buffer_load_dwordx4 v2, s[4:7], s24 offen offset:0 lds
 buffer_load_dwordx4 v2, s[4:7], s24 offen offset:1024 lds
 buffer_load_dwordx4 v2, s[4:7], s24 offen offset:2048 lds
 buffer_load_dwordx4 v2, s[4:7], s24 offen offset:3072 lds
 s_mov_b32 m0, 0x19800
 s_mov_b32 s24, 0xd800
 buffer_load_dwordx4 v2, s[4:7], s24 offen offset:0 lds
 s_mov_b32 m0, 0x1b000
 s_mov_b32 s24, 0xf000
 buffer_load_dwordx4 v2, s[4:7], s24 offen offset:0 lds
 buffer_load_dwordx4 v2, s[4:7], s24 offen offset:1024 lds
 buffer_load_dwordx4 v2, s[4:7], s24 offen offset:2048 lds
 buffer_load_dwordx4 v2, s[4:7], s24 offen offset:3072 lds
 s_mov_b32 m0, 0x1c000
 s_mov_b32 s24, 0x10000
 buffer_load_dwordx4 v2, s[4:7], s24 offen offset:0 lds
 s_mov_b32 m0, 0x1d800
 s_mov_b32 s24, 0x11800
 buffer_load_dwordx4 v2, s[4:7], s24 offen offset:0 lds
 buffer_load_dwordx4 v2, s[4:7], s24 offen offset:1024 lds
 buffer_load_dwordx4 v2, s[4:7], s24 offen offset:2048 lds
 buffer_load_dwordx4 v2, s[4:7], s24 offen offset:3072 lds
 s_mov_b32 m0, 0x1e800
 s_mov_b32 s24, 0x12800
 buffer_load_dwordx4 v2, s[4:7], s24 offen offset:0 lds
 s_mov_b32 m0, 0x20000
 s_mov_b32 s24, 0x14000
 buffer_load_dwordx4 v2, s[4:7], s24 offen offset:0 lds
 buffer_load_dwordx4 v2, s[4:7], s24 offen offset:1024 lds
 buffer_load_dwordx4 v2, s[4:7], s24 offen offset:2048 lds
 buffer_load_dwordx4 v2, s[4:7], s24 offen offset:3072 lds
 s_mov_b32 m0, 0x21000
 s_mov_b32 s24, 0x15000
 buffer_load_dwordx4 v2, s[4:7], s24 offen offset:0 lds
 s_mov_b32 m0, 0x22800
 s_mov_b32 s24, 0x16800
 buffer_load_dwordx4 v2, s[4:7], s24 offen offset:0 lds
 buffer_load_dwordx4 v2, s[4:7], s24 offen offset:1024 lds
 buffer_load_dwordx4 v2, s[4:7], s24 offen offset:2048 lds
 buffer_load_dwordx4 v2, s[4:7], s24 offen offset:3072 lds
 s_mov_b32 m0, 0x23800
 s_mov_b32 s24, 0x17800
 buffer_load_dwordx4 v2, s[4:7], s24 offen offset:0 lds
 s_barrier
 s_barrier
 s_barrier
 s_barrier
 s_waitcnt vmcnt(30)
 s_barrier
 s_waitcnt vmcnt(25)
 s_barrier
 s_waitcnt vmcnt(20)
 s_barrier
 s_waitcnt vmcnt(15)
 s_barrier
 s_mov_b32 m0, 0xc000
 s_mov_b32 s24, 0x19000
 buffer_load_dwordx4 v2, s[4:7], s24 offen offset:0 lds
 buffer_load_dwordx4 v2, s[4:7], s24 offen offset:1024 lds
 buffer_load_dwordx4 v2, s[4:7], s24 offen offset:2048 lds
 buffer_load_dwordx4 v2, s[4:7], s24 offen offset:3072 lds
 s_mov_b32 m0, 0xd000
 s_mov_b32 s24, 0x1a000
 buffer_load_dwordx4 v2, s[4:7], s24 offen offset:0 lds
 buffer_load_dwordx4 v2, s[4:7], s24 offen offset:1024 lds
 buffer_load_dwordx4 v2, s[4:7], s24 offen offset:2048 lds
 buffer_load_dwordx4 v2, s[4:7], s24 offen offset:3072 lds
 s_mov_b32 m0, 0xe000
 s_mov_b32 s24, 0x1b000
 buffer_load_dwordx4 v2, s[4:7], s24 offen offset:0 lds
 buffer_load_dwordx4 v2, s[4:7], s24 offen offset:1024 lds
 buffer_load_dwordx4 v2, s[4:7], s24 offen offset:2048 lds
 buffer_load_dwordx4 v2, s[4:7], s24 offen offset:3072 lds
 s_waitcnt vmcnt(22)
 s_barrier
 s_mov_b32 m0, 0x12000
 s_mov_b32 s24, 0x1f000
 buffer_load_dwordx4 v2, s[4:7], s24 offen offset:0 lds
 buffer_load_dwordx4 v2, s[4:7], s24 offen offset:1024 lds
 buffer_load_dwordx4 v2, s[4:7], s24 offen offset:2048 lds
 buffer_load_dwordx4 v2, s[4:7], s24 offen offset:3072 lds
 s_mov_b32 m0, 0x13000
 s_mov_b32 s24, 0x20000
 buffer_load_dwordx4 v2, s[4:7], s24 offen offset:0 lds
 buffer_load_dwordx4 v2, s[4:7], s24 offen offset:1024 lds
 buffer_load_dwordx4 v2, s[4:7], s24 offen offset:2048 lds
 buffer_load_dwordx4 v2, s[4:7], s24 offen offset:3072 lds
 s_mov_b32 m0, 0x14000
 s_mov_b32 s24, 0x21000
 buffer_load_dwordx4 v2, s[4:7], s24 offen offset:0 lds
 buffer_load_dwordx4 v2, s[4:7], s24 offen offset:1024 lds
 buffer_load_dwordx4 v2, s[4:7], s24 offen offset:2048 lds
 buffer_load_dwordx4 v2, s[4:7], s24 offen offset:3072 lds
 s_waitcnt vmcnt(29)
 s_barrier
 s_mov_b32 m0, 0x18000
 s_mov_b32 s24, 0x25000
 buffer_load_dwordx4 v2, s[4:7], s24 offen offset:0 lds
 buffer_load_dwordx4 v2, s[4:7], s24 offen offset:1024 lds
 buffer_load_dwordx4 v2, s[4:7], s24 offen offset:2048 lds
 buffer_load_dwordx4 v2, s[4:7], s24 offen offset:3072 lds
 s_mov_b32 m0, 0x19000
 s_mov_b32 s24, 0x26000
 buffer_load_dwordx4 v2, s[4:7], s24 offen offset:0 lds
 buffer_load_dwordx4 v2, s[4:7], s24 offen offset:1024 lds
 buffer_load_dwordx4 v2, s[4:7], s24 offen offset:2048 lds
 buffer_load_dwordx4 v2, s[4:7], s24 offen offset:3072 lds
 s_mov_b32 m0, 0x1a000
 s_mov_b32 s24, 0x27000
 buffer_load_dwordx4 v2, s[4:7], s24 offen offset:0 lds
 buffer_load_dwordx4 v2, s[4:7], s24 offen offset:1024 lds
 buffer_load_dwordx4 v2, s[4:7], s24 offen offset:2048 lds
 buffer_load_dwordx4 v2, s[4:7], s24 offen offset:3072 lds
 s_waitcnt vmcnt(36)
 s_barrier
 s_barrier
 s_mov_b32 m0, 0x1e000
 s_mov_b32 s24, 0x2b000
 buffer_load_dwordx4 v2, s[4:7], s24 offen offset:0 lds
 buffer_load_dwordx4 v2, s[4:7], s24 offen offset:1024 lds
 buffer_load_dwordx4 v2, s[4:7], s24 offen offset:2048 lds
 buffer_load_dwordx4 v2, s[4:7], s24 offen offset:3072 lds
 s_mov_b32 m0, 0x1f000
 s_mov_b32 s24, 0x2c000
 buffer_load_dwordx4 v2, s[4:7], s24 offen offset:0 lds
 buffer_load_dwordx4 v2, s[4:7], s24 offen offset:1024 lds
 buffer_load_dwordx4 v2, s[4:7], s24 offen offset:2048 lds
 buffer_load_dwordx4 v2, s[4:7], s24 offen offset:3072 lds
 s_mov_b32 m0, 0x20000
 s_mov_b32 s24, 0x2d000
 buffer_load_dwordx4 v2, s[4:7], s24 offen offset:0 lds
 buffer_load_dwordx4 v2, s[4:7], s24 offen offset:1024 lds
 buffer_load_dwordx4 v2, s[4:7], s24 offen offset:2048 lds
 buffer_load_dwordx4 v2, s[4:7], s24 offen offset:3072 lds
 s_waitcnt vmcnt(36)
 s_barrier
 s_mov_b32 m0, 0x24000
 s_mov_b32 s24, 0x31000
 buffer_load_dwordx4 v2, s[4:7], s24 offen offset:0 lds
 buffer_load_dwordx4 v2, s[4:7], s24 offen offset:1024 lds
 buffer_load_dwordx4 v2, s[4:7], s24 offen offset:2048 lds
 buffer_load_dwordx4 v2, s[4:7], s24 offen offset:3072 lds
 s_mov_b32 m0, 0x25000
 s_mov_b32 s24, 0x32000
 buffer_load_dwordx4 v2, s[4:7], s24 offen offset:0 lds
 buffer_load_dwordx4 v2, s[4:7], s24 offen offset:1024 lds
 buffer_load_dwordx4 v2, s[4:7], s24 offen offset:2048 lds
 buffer_load_dwordx4 v2, s[4:7], s24 offen offset:3072 lds
 s_mov_b32 m0, 0x26000
 s_mov_b32 s24, 0x33000
 buffer_load_dwordx4 v2, s[4:7], s24 offen offset:0 lds
 buffer_load_dwordx4 v2, s[4:7], s24 offen offset:1024 lds
 buffer_load_dwordx4 v2, s[4:7], s24 offen offset:2048 lds
 buffer_load_dwordx4 v2, s[4:7], s24 offen offset:3072 lds
 s_waitcnt vmcnt(36)
 s_barrier
 s_mov_b32 m0, 0xf000
 s_mov_b32 s24, 0x37000
 buffer_load_dwordx4 v2, s[4:7], s24 offen offset:0 lds
 buffer_load_dwordx4 v2, s[4:7], s24 offen offset:1024 lds
 buffer_load_dwordx4 v2, s[4:7], s24 offen offset:2048 lds
 buffer_load_dwordx4 v2, s[4:7], s24 offen offset:3072 lds
 s_mov_b32 m0, 0x10000
 s_mov_b32 s24, 0x38000
 buffer_load_dwordx4 v2, s[4:7], s24 offen offset:0 lds
 buffer_load_dwordx4 v2, s[4:7], s24 offen offset:1024 lds
 buffer_load_dwordx4 v2, s[4:7], s24 offen offset:2048 lds
 buffer_load_dwordx4 v2, s[4:7], s24 offen offset:3072 lds
 s_mov_b32 m0, 0x11000
 s_mov_b32 s24, 0x39000
 buffer_load_dwordx4 v2, s[4:7], s24 offen offset:0 lds
 buffer_load_dwordx4 v2, s[4:7], s24 offen offset:1024 lds
 buffer_load_dwordx4 v2, s[4:7], s24 offen offset:2048 lds
 buffer_load_dwordx4 v2, s[4:7], s24 offen offset:3072 lds
 s_waitcnt vmcnt(36)
 s_barrier
 s_mov_b32 m0, 0x15000
 s_mov_b32 s24, 0x3d000
 buffer_load_dwordx4 v2, s[4:7], s24 offen offset:0 lds
 buffer_load_dwordx4 v2, s[4:7], s24 offen offset:1024 lds
 buffer_load_dwordx4 v2, s[4:7], s24 offen offset:2048 lds
 buffer_load_dwordx4 v2, s[4:7], s24 offen offset:3072 lds
 s_mov_b32 m0, 0x16000
 s_mov_b32 s24, 0x3e000
 buffer_load_dwordx4 v2, s[4:7], s24 offen offset:0 lds
 buffer_load_dwordx4 v2, s[4:7], s24 offen offset:1024 lds
 buffer_load_dwordx4 v2, s[4:7], s24 offen offset:2048 lds
 buffer_load_dwordx4 v2, s[4:7], s24 offen offset:3072 lds
 s_mov_b32 m0, 0x17000
 s_mov_b32 s24, 0x3f000
 buffer_load_dwordx4 v2, s[4:7], s24 offen offset:0 lds
 buffer_load_dwordx4 v2, s[4:7], s24 offen offset:1024 lds
 buffer_load_dwordx4 v2, s[4:7], s24 offen offset:2048 lds
 buffer_load_dwordx4 v2, s[4:7], s24 offen offset:3072 lds
 s_waitcnt vmcnt(36)
 s_barrier
 s_mov_b32 m0, 0x1b000
 s_mov_b32 s24, 0x43000
 buffer_load_dwordx4 v2, s[4:7], s24 offen offset:0 lds
 buffer_load_dwordx4 v2, s[4:7], s24 offen offset:1024 lds
 buffer_load_dwordx4 v2, s[4:7], s24 offen offset:2048 lds
 buffer_load_dwordx4 v2, s[4:7], s24 offen offset:3072 lds
 s_mov_b32 m0, 0x1c000
 s_mov_b32 s24, 0x44000
 buffer_load_dwordx4 v2, s[4:7], s24 offen offset:0 lds
 buffer_load_dwordx4 v2, s[4:7], s24 offen offset:1024 lds
 buffer_load_dwordx4 v2, s[4:7], s24 offen offset:2048 lds
 buffer_load_dwordx4 v2, s[4:7], s24 offen offset:3072 lds
 s_mov_b32 m0, 0x1d000
 s_mov_b32 s24, 0x45000
 buffer_load_dwordx4 v2, s[4:7], s24 offen offset:0 lds
 buffer_load_dwordx4 v2, s[4:7], s24 offen offset:1024 lds
 buffer_load_dwordx4 v2, s[4:7], s24 offen offset:2048 lds
 buffer_load_dwordx4 v2, s[4:7], s24 offen offset:3072 lds
 s_waitcnt vmcnt(36)
 s_barrier
 s_mov_b32 m0, 0x21000
 s_mov_b32 s24, 0x49000
 buffer_load_dwordx4 v2, s[4:7], s24 offen offset:0 lds
 buffer_load_dwordx4 v2, s[4:7], s24 offen offset:1024 lds
 buffer_load_dwordx4 v2, s[4:7], s24 offen offset:2048 lds
 buffer_load_dwordx4 v2, s[4:7], s24 offen offset:3072 lds
 s_mov_b32 m0, 0x22000
 s_mov_b32 s24, 0x4a000
 buffer_load_dwordx4 v2, s[4:7], s24 offen offset:0 lds
 buffer_load_dwordx4 v2, s[4:7], s24 offen offset:1024 lds
 buffer_load_dwordx4 v2, s[4:7], s24 offen offset:2048 lds
 buffer_load_dwordx4 v2, s[4:7], s24 offen offset:3072 lds
 s_mov_b32 m0, 0x23000
 s_mov_b32 s24, 0x4b000
 buffer_load_dwordx4 v2, s[4:7], s24 offen offset:0 lds
 buffer_load_dwordx4 v2, s[4:7], s24 offen offset:1024 lds
 buffer_load_dwordx4 v2, s[4:7], s24 offen offset:2048 lds
 buffer_load_dwordx4 v2, s[4:7], s24 offen offset:3072 lds
 s_waitcnt vmcnt(36)
 s_barrier
 s_mov_b32 m0, 0xc000
 s_mov_b32 s24, 0x4f000
 buffer_load_dwordx4 v2, s[4:7], s24 offen offset:0 lds
 buffer_load_dwordx4 v2, s[4:7], s24 offen offset:1024 lds
 buffer_load_dwordx4 v2, s[4:7], s24 offen offset:2048 lds
 buffer_load_dwordx4 v2, s[4:7], s24 offen offset:3072 lds
 s_mov_b32 m0, 0xd000
 s_mov_b32 s24, 0x50000
 buffer_load_dwordx4 v2, s[4:7], s24 offen offset:0 lds
 buffer_load_dwordx4 v2, s[4:7], s24 offen offset:1024 lds
 buffer_load_dwordx4 v2, s[4:7], s24 offen offset:2048 lds
 buffer_load_dwordx4 v2, s[4:7], s24 offen offset:3072 lds
 s_mov_b32 m0, 0xe000
 s_mov_b32 s24, 0x51000
 buffer_load_dwordx4 v2, s[4:7], s24 offen offset:0 lds
 buffer_load_dwordx4 v2, s[4:7], s24 offen offset:1024 lds
 buffer_load_dwordx4 v2, s[4:7], s24 offen offset:2048 lds
 buffer_load_dwordx4 v2, s[4:7], s24 offen offset:3072 lds
 s_waitcnt vmcnt(36)
 s_barrier
 s_mov_b32 m0, 0x12400
 s_mov_b32 s24, 0x55000
 buffer_load_dwordx4 v2, s[4:7], s24 offen offset:0 lds
 buffer_load_dwordx4 v2, s[4:7], s24 offen offset:1024 lds
 buffer_load_dwordx4 v2, s[4:7], s24 offen offset:2048 lds
 buffer_load_dwordx4 v2, s[4:7], s24 offen offset:3072 lds
 s_mov_b32 m0, 0x13400
 s_mov_b32 s24, 0x56000
 buffer_load_dwordx4 v2, s[4:7], s24 offen offset:0 lds
 s_waitcnt vmcnt(29)
 s_barrier
 s_mov_b32 m0, 0x14c00
 s_mov_b32 s24, 0x57800
 buffer_load_dwordx4 v2, s[4:7], s24 offen offset:0 lds
 buffer_load_dwordx4 v2, s[4:7], s24 offen offset:1024 lds
 buffer_load_dwordx4 v2, s[4:7], s24 offen offset:2048 lds
 buffer_load_dwordx4 v2, s[4:7], s24 offen offset:3072 lds
 s_mov_b32 m0, 0x15c00
 s_mov_b32 s24, 0x58800
 buffer_load_dwordx4 v2, s[4:7], s24 offen offset:0 lds
 s_waitcnt vmcnt(22)
 s_barrier
 s_mov_b32 m0, 0x17400
 s_mov_b32 s24, 0x5a000
 buffer_load_dwordx4 v2, s[4:7], s24 offen offset:0 lds
 buffer_load_dwordx4 v2, s[4:7], s24 offen offset:1024 lds
 buffer_load_dwordx4 v2, s[4:7], s24 offen offset:2048 lds
 buffer_load_dwordx4 v2, s[4:7], s24 offen offset:3072 lds
 s_mov_b32 m0, 0x18400
 s_mov_b32 s24, 0x5b000
 buffer_load_dwordx4 v2, s[4:7], s24 offen offset:0 lds
 s_waitcnt vmcnt(15)
 s_barrier
 s_mov_b32 m0, 0x19c00
 s_mov_b32 s24, 0x5c800
 buffer_load_dwordx4 v2, s[4:7], s24 offen offset:0 lds
 buffer_load_dwordx4 v2, s[4:7], s24 offen offset:1024 lds
 buffer_load_dwordx4 v2, s[4:7], s24 offen offset:2048 lds
 buffer_load_dwordx4 v2, s[4:7], s24 offen offset:3072 lds
 s_mov_b32 m0, 0x1ac00
 s_mov_b32 s24, 0x5d800
 buffer_load_dwordx4 v2, s[4:7], s24 offen offset:0 lds
 s_barrier
 s_mov_b32 m0, 0x1c400
 s_mov_b32 s24, 0x5f000
 buffer_load_dwordx4 v2, s[4:7], s24 offen offset:0 lds
 buffer_load_dwordx4 v2, s[4:7], s24 offen offset:1024 lds
 buffer_load_dwordx4 v2, s[4:7], s24 offen offset:2048 lds
 buffer_load_dwordx4 v2, s[4:7], s24 offen offset:3072 lds
 s_mov_b32 m0, 0x1d400
 s_mov_b32 s24, 0x60000
 buffer_load_dwordx4 v2, s[4:7], s24 offen offset:0 lds
 s_mov_b32 m0, 0x1ec00
 s_mov_b32 s24, 0x61800
 buffer_load_dwordx4 v2, s[4:7], s24 offen offset:0 lds
 buffer_load_dwordx4 v2, s[4:7], s24 offen offset:1024 lds
 buffer_load_dwordx4 v2, s[4:7], s24 offen offset:2048 lds
 buffer_load_dwordx4 v2, s[4:7], s24 offen offset:3072 lds
 s_mov_b32 m0, 0x1fc00
 s_mov_b32 s24, 0x62800
 buffer_load_dwordx4 v2, s[4:7], s24 offen offset:0 lds
 s_mov_b32 m0, 0x21400
 s_mov_b32 s24, 0x64000
 buffer_load_dwordx4 v2, s[4:7], s24 offen offset:0 lds
 buffer_load_dwordx4 v2, s[4:7], s24 offen offset:1024 lds
 buffer_load_dwordx4 v2, s[4:7], s24 offen offset:2048 lds
 buffer_load_dwordx4 v2, s[4:7], s24 offen offset:3072 lds
 s_mov_b32 m0, 0x22400
 s_mov_b32 s24, 0x65000
 buffer_load_dwordx4 v2, s[4:7], s24 offen offset:0 lds
 s_mov_b32 m0, 0x23c00
 s_mov_b32 s24, 0x66800
 buffer_load_dwordx4 v2, s[4:7], s24 offen offset:0 lds
 buffer_load_dwordx4 v2, s[4:7], s24 offen offset:1024 lds
 buffer_load_dwordx4 v2, s[4:7], s24 offen offset:2048 lds
 buffer_load_dwordx4 v2, s[4:7], s24 offen offset:3072 lds
 s_mov_b32 m0, 0x24c00
 s_mov_b32 s24, 0x67800
 buffer_load_dwordx4 v2, s[4:7], s24 offen offset:0 lds
 s_mov_b32 m0, 0x26400
 s_mov_b32 s24, 0x69000
 buffer_load_dwordx4 v2, s[4:7], s24 offen offset:0 lds
 buffer_load_dwordx4 v2, s[4:7], s24 offen offset:1024 lds
 buffer_load_dwordx4 v2, s[4:7], s24 offen offset:2048 lds
 buffer_load_dwordx4 v2, s[4:7], s24 offen offset:3072 lds
 s_mov_b32 m0, 0x27400
 s_mov_b32 s24, 0x6a000
 buffer_load_dwordx4 v2, s[4:7], s24 offen offset:0 lds
 s_mov_b32 m0, 0xd400
 s_mov_b32 s24, 0x6b800
 buffer_load_dwordx4 v2, s[4:7], s24 offen offset:0 lds
 buffer_load_dwordx4 v2, s[4:7], s24 offen offset:1024 lds
 buffer_load_dwordx4 v2, s[4:7], s24 offen offset:2048 lds
 buffer_load_dwordx4 v2, s[4:7], s24 offen offset:3072 lds
 s_mov_b32 m0, 0xe400
 s_mov_b32 s24, 0x6c800
 buffer_load_dwordx4 v2, s[4:7], s24 offen offset:0 lds
 s_mov_b32 m0, 0xfc00
 s_mov_b32 s24, 0x6e000
 buffer_load_dwordx4 v2, s[4:7], s24 offen offset:0 lds
 buffer_load_dwordx4 v2, s[4:7], s24 offen offset:1024 lds
 buffer_load_dwordx4 v2, s[4:7], s24 offen offset:2048 lds
 buffer_load_dwordx4 v2, s[4:7], s24 offen offset:3072 lds
 s_mov_b32 m0, 0x10c00
 s_mov_b32 s24, 0x6f000
 buffer_load_dwordx4 v2, s[4:7], s24 offen offset:0 lds
 s_waitcnt vmcnt(50)
 s_barrier
 s_waitcnt vmcnt(45)
 s_barrier
 s_waitcnt vmcnt(40)
 s_barrier
 s_waitcnt vmcnt(35)
 s_barrier
 s_waitcnt vmcnt(30)
 s_barrier
 s_waitcnt vmcnt(25)
 s_barrier
 s_waitcnt vmcnt(20)
 s_barrier
 s_mov_b32 m0, 0x12400
 s_mov_b32 s24, 0x70800
 buffer_load_dwordx4 v2, s[4:7], s24 offen offset:0 lds
 buffer_load_dwordx4 v2, s[4:7], s24 offen offset:1024 lds
 buffer_load_dwordx4 v2, s[4:7], s24 offen offset:2048 lds
 buffer_load_dwordx4 v2, s[4:7], s24 offen offset:3072 lds
 s_mov_b32 m0, 0x13400
 s_mov_b32 s24, 0x71800
 buffer_load_dwordx4 v2, s[4:7], s24 offen offset:0 lds
 s_waitcnt vmcnt(20)
 s_barrier
 s_mov_b32 m0, 0x14c00
 s_mov_b32 s24, 0x73000
 buffer_load_dwordx4 v2, s[4:7], s24 offen offset:0 lds
 buffer_load_dwordx4 v2, s[4:7], s24 offen offset:1024 lds
 buffer_load_dwordx4 v2, s[4:7], s24 offen offset:2048 lds
 buffer_load_dwordx4 v2, s[4:7], s24 offen offset:3072 lds
 s_mov_b32 m0, 0x15c00
 s_mov_b32 s24, 0x74000
 buffer_load_dwordx4 v2, s[4:7], s24 offen offset:0 lds
 s_waitcnt vmcnt(20)
 s_barrier
 s_mov_b32 m0, 0x17400
 s_mov_b32 s24, 0x75800
 buffer_load_dwordx4 v2, s[4:7], s24 offen offset:0 lds
 buffer_load_dwordx4 v2, s[4:7], s24 offen offset:1024 lds
 buffer_load_dwordx4 v2, s[4:7], s24 offen offset:2048 lds
 buffer_load_dwordx4 v2, s[4:7], s24 offen offset:3072 lds
 s_mov_b32 m0, 0x18400
 s_mov_b32 s24, 0x76800
 buffer_load_dwordx4 v2, s[4:7], s24 offen offset:0 lds
 s_waitcnt vmcnt(20)
 s_barrier
 s_mov_b32 m0, 0x19c00
 s_mov_b32 s24, 0x78000
 buffer_load_dwordx4 v2, s[4:7], s24 offen offset:0 lds
 buffer_load_dwordx4 v2, s[4:7], s24 offen offset:1024 lds
 buffer_load_dwordx4 v2, s[4:7], s24 offen offset:2048 lds
 buffer_load_dwordx4 v2, s[4:7], s24 offen offset:3072 lds
 s_mov_b32 m0, 0x1ac00
 s_mov_b32 s24, 0x79000
 buffer_load_dwordx4 v2, s[4:7], s24 offen offset:0 lds
 s_waitcnt vmcnt(20)
 s_barrier
 s_mov_b32 m0, 0x1c400
 s_mov_b32 s24, 0x7a800
 buffer_load_dwordx4 v2, s[4:7], s24 offen offset:0 lds
 buffer_load_dwordx4 v2, s[4:7], s24 offen offset:1024 lds
 buffer_load_dwordx4 v2, s[4:7], s24 offen offset:2048 lds
 buffer_load_dwordx4 v2, s[4:7], s24 offen offset:3072 lds
 s_mov_b32 m0, 0x1d400
 s_mov_b32 s24, 0x7b800
 buffer_load_dwordx4 v2, s[4:7], s24 offen offset:0 lds
 s_waitcnt vmcnt(20)
 s_barrier
 s_mov_b32 m0, 0x1ec00
 s_mov_b32 s24, 0x7d000
 buffer_load_dwordx4 v2, s[4:7], s24 offen offset:0 lds
 buffer_load_dwordx4 v2, s[4:7], s24 offen offset:1024 lds
 buffer_load_dwordx4 v2, s[4:7], s24 offen offset:2048 lds
 buffer_load_dwordx4 v2, s[4:7], s24 offen offset:3072 lds
 s_mov_b32 m0, 0x1fc00
 s_mov_b32 s24, 0x7e000
 buffer_load_dwordx4 v2, s[4:7], s24 offen offset:0 lds
 s_waitcnt vmcnt(20)
 s_barrier
 s_mov_b32 m0, 0x21400
 s_mov_b32 s24, 0x7f800
 buffer_load_dwordx4 v2, s[4:7], s24 offen offset:0 lds
 buffer_load_dwordx4 v2, s[4:7], s24 offen offset:1024 lds
 buffer_load_dwordx4 v2, s[4:7], s24 offen offset:2048 lds
 buffer_load_dwordx4 v2, s[4:7], s24 offen offset:3072 lds
 s_mov_b32 m0, 0x22400
 s_mov_b32 s24, 0x80800
 buffer_load_dwordx4 v2, s[4:7], s24 offen offset:0 lds
 s_waitcnt vmcnt(20)
 s_barrier
 s_mov_b32 m0, 0x23c00
 s_mov_b32 s24, 0x82000
 buffer_load_dwordx4 v2, s[4:7], s24 offen offset:0 lds
 buffer_load_dwordx4 v2, s[4:7], s24 offen offset:1024 lds
 buffer_load_dwordx4 v2, s[4:7], s24 offen offset:2048 lds
 buffer_load_dwordx4 v2, s[4:7], s24 offen offset:3072 lds
 s_mov_b32 m0, 0x24c00
 s_mov_b32 s24, 0x83000
 buffer_load_dwordx4 v2, s[4:7], s24 offen offset:0 lds
 s_waitcnt vmcnt(20)
 s_barrier
 s_mov_b32 m0, 0x26400
 s_mov_b32 s24, 0x84800
 buffer_load_dwordx4 v2, s[4:7], s24 offen offset:0 lds
 buffer_load_dwordx4 v2, s[4:7], s24 offen offset:1024 lds
 buffer_load_dwordx4 v2, s[4:7], s24 offen offset:2048 lds
 buffer_load_dwordx4 v2, s[4:7], s24 offen offset:3072 lds
 s_mov_b32 m0, 0x27400
 s_mov_b32 s24, 0x85800
 buffer_load_dwordx4 v2, s[4:7], s24 offen offset:0 lds
 s_waitcnt vmcnt(20)
 s_barrier
 s_mov_b32 m0, 0xd400
 s_mov_b32 s24, 0x87000
 buffer_load_dwordx4 v2, s[4:7], s24 offen offset:0 lds
 buffer_load_dwordx4 v2, s[4:7], s24 offen offset:1024 lds
 buffer_load_dwordx4 v2, s[4:7], s24 offen offset:2048 lds
 buffer_load_dwordx4 v2, s[4:7], s24 offen offset:3072 lds
 s_mov_b32 m0, 0xe400
 s_mov_b32 s24, 0x88000
 buffer_load_dwordx4 v2, s[4:7], s24 offen offset:0 lds
 s_waitcnt vmcnt(20)
 s_barrier
 s_mov_b32 m0, 0xfc00
 s_mov_b32 s24, 0x89800
 buffer_load_dwordx4 v2, s[4:7], s24 offen offset:0 lds
 buffer_load_dwordx4 v2, s[4:7], s24 offen offset:1024 lds
 buffer_load_dwordx4 v2, s[4:7], s24 offen offset:2048 lds
 buffer_load_dwordx4 v2, s[4:7], s24 offen offset:3072 lds
 s_mov_b32 m0, 0x10c00
 s_mov_b32 s24, 0x8a800
 buffer_load_dwordx4 v2, s[4:7], s24 offen offset:0 lds
 s_waitcnt vmcnt(20)
 s_barrier
 s_mov_b32 m0, 0x12400
 s_mov_b32 s24, 0x8c000
 buffer_load_dwordx4 v2, s[4:7], s24 offen offset:0 lds
 buffer_load_dwordx4 v2, s[4:7], s24 offen offset:1024 lds
 buffer_load_dwordx4 v2, s[4:7], s24 offen offset:2048 lds
 buffer_load_dwordx4 v2, s[4:7], s24 offen offset:3072 lds
 s_mov_b32 m0, 0x13400
 s_mov_b32 s24, 0x8d000
 buffer_load_dwordx4 v2, s[4:7], s24 offen offset:0 lds
 s_waitcnt vmcnt(20)
 s_barrier
 s_mov_b32 m0, 0x14c00
 s_mov_b32 s24, 0x8e800
 buffer_load_dwordx4 v2, s[4:7], s24 offen offset:0 lds
 buffer_load_dwordx4 v2, s[4:7], s24 offen offset:1024 lds
 buffer_load_dwordx4 v2, s[4:7], s24 offen offset:2048 lds
 buffer_load_dwordx4 v2, s[4:7], s24 offen offset:3072 lds
 s_mov_b32 m0, 0x15c00
 s_mov_b32 s24, 0x8f800
 buffer_load_dwordx4 v2, s[4:7], s24 offen offset:0 lds
 s_waitcnt vmcnt(20)
 s_barrier
 s_waitcnt vmcnt(15)
 s_barrier
 s_waitcnt vmcnt(10)
 s_barrier
 s_waitcnt vmcnt(5)
 s_barrier
 s_waitcnt vmcnt(0)
 s_barrier
 s_barrier
 s_endpgm
C2_bl1:
 s_waitcnt lgkmcnt(0)
 s_mul_i32 s23, s22, 901120
 v_lshlrev_b32 v2, 4, v1
 v_add_u32 v2, s23, v2
 s_mov_b32 m0, 0xd400
 s_mov_b32 s24, 0x1400
 buffer_load_dwordx4 v2, s[4:7], s24 offen offset:0 lds
 buffer_load_dwordx4 v2, s[4:7], s24 offen offset:1024 lds
 buffer_load_dwordx4 v2, s[4:7], s24 offen offset:2048 lds
 buffer_load_dwordx4 v2, s[4:7], s24 offen offset:3072 lds
 s_mov_b32 m0, 0xe400
 s_mov_b32 s24, 0x2400
 buffer_load_dwordx4 v2, s[4:7], s24 offen offset:0 lds
 s_mov_b32 m0, 0xfc00
 s_mov_b32 s24, 0x3c00
 buffer_load_dwordx4 v2, s[4:7], s24 offen offset:0 lds
 buffer_load_dwordx4 v2, s[4:7], s24 offen offset:1024 lds
 buffer_load_dwordx4 v2, s[4:7], s24 offen offset:2048 lds
 buffer_load_dwordx4 v2, s[4:7], s24 offen offset:3072 lds
 s_mov_b32 m0, 0x10c00
 s_mov_b32 s24, 0x4c00
 buffer_load_dwordx4 v2, s[4:7], s24 offen offset:0 lds
 s_mov_b32 m0, 0x12400
 s_mov_b32 s24, 0x6400
 buffer_load_dwordx4 v2, s[4:7], s24 offen offset:0 lds
 buffer_load_dwordx4 v2, s[4:7], s24 offen offset:1024 lds
 buffer_load_dwordx4 v2, s[4:7], s24 offen offset:2048 lds
 buffer_load_dwordx4 v2, s[4:7], s24 offen offset:3072 lds
 s_mov_b32 m0, 0x13400
 s_mov_b32 s24, 0x7400
 buffer_load_dwordx4 v2, s[4:7], s24 offen offset:0 lds
 s_sub_u32 s38, s20, 4
 s_lshl_b32 s59, s22, 2
 s_add_u32 s59, s59, s38
 s_mul_i32 s58, s21, 81920
 s_mul_i32 s37, s59, 2560
 s_add_u32 s58, s58, s37
 s_add_u32 s56, s16, s58
 s_addc_u32 s57, s17, 0
 s_load_dword s40, s[56:57], 0
 s_load_dword s41, s[56:57], 32
 s_load_dword s42, s[56:57], 64
 s_load_dword s43, s[56:57], 96
 s_load_dword s44, s[56:57], 128
 s_load_dword s45, s[56:57], 160
 s_load_dword s46, s[56:57], 192
 s_load_dword s47, s[56:57], 224
 s_load_dword s48, s[56:57], 256
 s_load_dword s49, s[56:57], 288
 s_load_dword s50, s[56:57], 320
 s_load_dword s51, s[56:57], 352
 s_load_dword s52, s[56:57], 384
 s_load_dword s53, s[56:57], 416
 s_waitcnt lgkmcnt(0)
 s_load_dword s40, s[56:57], 448
 s_load_dword s41, s[56:57], 480
 s_load_dword s42, s[56:57], 512
 s_load_dword s43, s[56:57], 544
 s_load_dword s44, s[56:57], 576
 s_load_dword s45, s[56:57], 608
 s_load_dword s46, s[56:57], 640
 s_load_dword s47, s[56:57], 672
 s_load_dword s48, s[56:57], 704
 s_load_dword s49, s[56:57], 736
 s_load_dword s50, s[56:57], 768
 s_load_dword s51, s[56:57], 800
 s_load_dword s52, s[56:57], 832
 s_load_dword s53, s[56:57], 864
 s_waitcnt lgkmcnt(0)
 s_load_dword s40, s[56:57], 896
 s_load_dword s41, s[56:57], 928
 s_load_dword s42, s[56:57], 960
 s_load_dword s43, s[56:57], 992
 s_load_dword s44, s[56:57], 1024
 s_load_dword s45, s[56:57], 1056
 s_load_dword s46, s[56:57], 1088
 s_load_dword s47, s[56:57], 1120
 s_load_dword s48, s[56:57], 1152
 s_load_dword s49, s[56:57], 1184
 s_load_dword s50, s[56:57], 1216
 s_load_dword s51, s[56:57], 1248
 s_load_dword s52, s[56:57], 1280
 s_load_dword s53, s[56:57], 1312
 s_waitcnt lgkmcnt(0)
 s_load_dword s40, s[56:57], 1344
 s_load_dword s41, s[56:57], 1376
 s_load_dword s42, s[56:57], 1408
 s_load_dword s43, s[56:57], 1440
 s_load_dword s44, s[56:57], 1472
 s_load_dword s45, s[56:57], 1504
 s_load_dword s46, s[56:57], 1536
 s_load_dword s47, s[56:57], 1568
 s_load_dword s48, s[56:57], 1600
 s_load_dword s49, s[56:57], 1632
 s_load_dword s50, s[56:57], 1664
 s_load_dword s51, s[56:57], 1696
 s_load_dword s52, s[56:57], 1728
 s_load_dword s53, s[56:57], 1760
 s_waitcnt lgkmcnt(0)
 s_load_dword s40, s[56:57], 1792
 s_load_dword s41, s[56:57], 1824
 s_load_dword s42, s[56:57], 1856
 s_load_dword s43, s[56:57], 1888
 s_load_dword s44, s[56:57], 1920
 s_load_dword s45, s[56:57], 1952
 s_load_dword s46, s[56:57], 1984
 s_load_dword s47, s[56:57], 2016
 s_load_dword s48, s[56:57], 2048
 s_load_dword s49, s[56:57], 2080
 s_load_dword s50, s[56:57], 2112
 s_load_dword s51, s[56:57], 2144
 s_load_dword s52, s[56:57], 2176
 s_load_dword s53, s[56:57], 2208
 s_waitcnt lgkmcnt(0)
 s_load_dword s40, s[56:57], 2240
 s_load_dword s41, s[56:57], 2272
 s_load_dword s42, s[56:57], 2304
 s_load_dword s43, s[56:57], 2336
 s_load_dword s44, s[56:57], 2368
 s_load_dword s45, s[56:57], 2400
 s_load_dword s46, s[56:57], 2432
 s_load_dword s47, s[56:57], 2464
 s_load_dword s48, s[56:57], 2496
 s_load_dword s49, s[56:57], 2528
 s_lshr_b32 s58, s2, 3
 s_lshl_b32 s58, s58, 2
 s_add_u32 s58, s58, s38
 s_getpc_b64 s[56:57]
C2_pc8:
 s_sub_u32 s56, s56, C2_pc8-C2_start
 s_subb_u32 s57, s57, 0
 s_mul_i32 s58, s58, 32
 s_add_u32 s37, s58, 0
 s_min_u32 s37, s37, C2_end-C2_start
 s_load_dword s50, s[56:57], s37
 s_add_u32 s37, s58, 4096
 s_min_u32 s37, s37, C2_end-C2_start
 s_load_dword s51, s[56:57], s37
 s_add_u32 s37, s58, 8192
 s_min_u32 s37, s37, C2_end-C2_start
 s_load_dword s52, s[56:57], s37
 s_add_u32 s37, s58, 12288
 s_min_u32 s37, s37, C2_end-C2_start
 s_load_dword s53, s[56:57], s37
 s_waitcnt lgkmcnt(0)
 s_add_u32 s37, s58, 16384
 s_min_u32 s37, s37, C2_end-C2_start
 s_load_dword s40, s[56:57], s37
 s_add_u32 s37, s58, 20480
 s_min_u32 s37, s37, C2_end-C2_start
 s_load_dword s41, s[56:57], s37
 s_add_u32 s37, s58, 24576
 s_min_u32 s37, s37, C2_end-C2_start
 s_load_dword s42, s[56:57], s37
 s_add_u32 s37, s58, 28672
 s_min_u32 s37, s37, C2_end-C2_start
 s_load_dword s43, s[56:57], s37
 s_add_u32 s37, s58, 32768
 s_min_u32 s37, s37, C2_end-C2_start
 s_load_dword s44, s[56:57], s37
 s_waitcnt lgkmcnt(0)
 s_mov_b32 m0, 0x14c00
 s_mov_b32 s24, 0x8c00
 buffer_load_dwordx4 v2, s[4:7], s24 offen offset:0 lds
 buffer_load_dwordx4 v2, s[4:7], s24 offen offset:1024 lds
 buffer_load_dwordx4 v2, s[4:7], s24 offen offset:2048 lds
 buffer_load_dwordx4 v2, s[4:7], s24 offen offset:3072 lds
 s_mov_b32 m0, 0x15c00
 s_mov_b32 s24, 0x9c00
 buffer_load_dwordx4 v2, s[4:7], s24 offen offset:0 lds
 s_mov_b32 m0, 0x17400
 s_mov_b32 s24, 0xb400
 buffer_load_dwordx4 v2, s[4:7], s24 offen offset:0 lds
 buffer_load_dwordx4 v2, s[4:7], s24 offen offset:1024 lds
 buffer_load_dwordx4 v2, s[4:7], s24 offen offset:2048 lds
 buffer_load_dwordx4 v2, s[4:7], s24 offen offset:3072 lds
 s_mov_b32 m0, 0x18400
 s_mov_b32 s24, 0xc400
 buffer_load_dwordx4 v2, s[4:7], s24 offen offset:0 lds
 s_mov_b32 m0, 0x19c00
 s_mov_b32 s24, 0xdc00
 buffer_load_dwordx4 v2, s[4:7], s24 offen offset:0 lds
 buffer_load_dwordx4 v2, s[4:7], s24 offen offset:1024 lds
 buffer_load_dwordx4 v2, s[4:7], s24 offen offset:2048 lds
 buffer_load_dwordx4 v2, s[4:7], s24 offen offset:3072 lds
 s_mov_b32 m0, 0x1ac00
 s_mov_b32 s24, 0xec00
 buffer_load_dwordx4 v2, s[4:7], s24 offen offset:0 lds
 s_mov_b32 m0, 0x1c400
 s_mov_b32 s24, 0x10400
 buffer_load_dwordx4 v2, s[4:7], s24 offen offset:0 lds
 buffer_load_dwordx4 v2, s[4:7], s24 offen offset:1024 lds
 buffer_load_dwordx4 v2, s[4:7], s24 offen offset:2048 lds
 buffer_load_dwordx4 v2, s[4:7], s24 offen offset:3072 lds
 s_mov_b32 m0, 0x1d400
 s_mov_b32 s24, 0x11400
 buffer_load_dwordx4 v2, s[4:7], s24 offen offset:0 lds
 s_mov_b32 m0, 0x1ec00
 s_mov_b32 s24, 0x12c00
 buffer_load_dwordx4 v2, s[4:7], s24 offen offset:0 lds
 buffer_load_dwordx4 v2, s[4:7], s24 offen offset:1024 lds
 buffer_load_dwordx4 v2, s[4:7], s24 offen offset:2048 lds
 buffer_load_dwordx4 v2, s[4:7], s24 offen offset:3072 lds
 s_mov_b32 m0, 0x1fc00
 s_mov_b32 s24, 0x13c00
 buffer_load_dwordx4 v2, s[4:7], s24 offen offset:0 lds
 s_mov_b32 m0, 0x21400
 s_mov_b32 s24, 0x15400
 buffer_load_dwordx4 v2, s[4:7], s24 offen offset:0 lds
 buffer_load_dwordx4 v2, s[4:7], s24 offen offset:1024 lds
 buffer_load_dwordx4 v2, s[4:7], s24 offen offset:2048 lds
 buffer_load_dwordx4 v2, s[4:7], s24 offen offset:3072 lds
 s_mov_b32 m0, 0x22400
 s_mov_b32 s24, 0x16400
 buffer_load_dwordx4 v2, s[4:7], s24 offen offset:0 lds
 s_mov_b32 m0, 0x23c00
 s_mov_b32 s24, 0x17c00
 buffer_load_dwordx4 v2, s[4:7], s24 offen offset:0 lds
 buffer_load_dwordx4 v2, s[4:7], s24 offen offset:1024 lds
 buffer_load_dwordx4 v2, s[4:7], s24 offen offset:2048 lds
 buffer_load_dwordx4 v2, s[4:7], s24 offen offset:3072 lds
 s_mov_b32 m0, 0x24c00
 s_mov_b32 s24, 0x18c00
 buffer_load_dwordx4 v2, s[4:7], s24 offen offset:0 lds
 s_barrier
 s_waitcnt vmcnt(45)
 s_barrier
 s_waitcnt vmcnt(40)
 s_barrier
 s_waitcnt vmcnt(35)
 s_barrier
 s_waitcnt vmcnt(30)
 s_barrier
 s_waitcnt vmcnt(25)
 s_barrier
 s_waitcnt vmcnt(20)
 s_barrier
 s_waitcnt vmcnt(15)
 s_barrier
 s_mov_b32 m0, 0xf000
 s_mov_b32 s24, 0x1c000
 buffer_load_dwordx4 v2, s[4:7], s24 offen offset:0 lds
 buffer_load_dwordx4 v2, s[4:7], s24 offen offset:1024 lds
 buffer_load_dwordx4 v2, s[4:7], s24 offen offset:2048 lds
 buffer_load_dwordx4 v2, s[4:7], s24 offen offset:3072 lds
 s_mov_b32 m0, 0x10000
 s_mov_b32 s24, 0x1d000
 buffer_load_dwordx4 v2, s[4:7], s24 offen offset:0 lds
 buffer_load_dwordx4 v2, s[4:7], s24 offen offset:1024 lds
 buffer_load_dwordx4 v2, s[4:7], s24 offen offset:2048 lds
 buffer_load_dwordx4 v2, s[4:7], s24 offen offset:3072 lds
 s_mov_b32 m0, 0x11000
 s_mov_b32 s24, 0x1e000
 buffer_load_dwordx4 v2, s[4:7], s24 offen offset:0 lds
 buffer_load_dwordx4 v2, s[4:7], s24 offen offset:1024 lds
 buffer_load_dwordx4 v2, s[4:7], s24 offen offset:2048 lds
 buffer_load_dwordx4 v2, s[4:7], s24 offen offset:3072 lds
 s_waitcnt vmcnt(22)
 s_barrier
 s_mov_b32 m0, 0x15000
 s_mov_b32 s24, 0x22000
 buffer_load_dwordx4 v2, s[4:7], s24 offen offset:0 lds
 buffer_load_dwordx4 v2, s[4:7], s24 offen offset:1024 lds
 buffer_load_dwordx4 v2, s[4:7], s24 offen offset:2048 lds
 buffer_load_dwordx4 v2, s[4:7], s24 offen offset:3072 lds
 s_mov_b32 m0, 0x16000
 s_mov_b32 s24, 0x23000
 buffer_load_dwordx4 v2, s[4:7], s24 offen offset:0 lds
 buffer_load_dwordx4 v2, s[4:7], s24 offen offset:1024 lds
 buffer_load_dwordx4 v2, s[4:7], s24 offen offset:2048 lds
 buffer_load_dwordx4 v2, s[4:7], s24 offen offset:3072 lds
 s_mov_b32 m0, 0x17000
 s_mov_b32 s24, 0x24000
 buffer_load_dwordx4 v2, s[4:7], s24 offen offset:0 lds
 buffer_load_dwordx4 v2, s[4:7], s24 offen offset:1024 lds
 buffer_load_dwordx4 v2, s[4:7], s24 offen offset:2048 lds
 buffer_load_dwordx4 v2, s[4:7], s24 offen offset:3072 lds
 s_waitcnt vmcnt(29)
 s_barrier
 s_waitcnt vmcnt(24)
 s_barrier
 s_mov_b32 m0, 0x1b000
 s_mov_b32 s24, 0x28000
 buffer_load_dwordx4 v2, s[4:7], s24 offen offset:0 lds
 buffer_load_dwordx4 v2, s[4:7], s24 offen offset:1024 lds
 buffer_load_dwordx4 v2, s[4:7], s24 offen offset:2048 lds
 buffer_load_dwordx4 v2, s[4:7], s24 offen offset:3072 lds
 s_mov_b32 m0, 0x1c000
 s_mov_b32 s24, 0x29000
 buffer_load_dwordx4 v2, s[4:7], s24 offen offset:0 lds
 buffer_load_dwordx4 v2, s[4:7], s24 offen offset:1024 lds
 buffer_load_dwordx4 v2, s[4:7], s24 offen offset:2048 lds
 buffer_load_dwordx4 v2, s[4:7], s24 offen offset:3072 lds
 s_mov_b32 m0, 0x1d000
 s_mov_b32 s24, 0x2a000
 buffer_load_dwordx4 v2, s[4:7], s24 offen offset:0 lds
 buffer_load_dwordx4 v2, s[4:7], s24 offen offset:1024 lds
 buffer_load_dwordx4 v2, s[4:7], s24 offen offset:2048 lds
 buffer_load_dwordx4 v2, s[4:7], s24 offen offset:3072 lds
 s_barrier
 s_waitcnt vmcnt(24)
 s_barrier
 s_mov_b32 m0, 0x21000
 s_mov_b32 s24, 0x2e000
 buffer_load_dwordx4 v2, s[4:7], s24 offen offset:0 lds
 buffer_load_dwordx4 v2, s[4:7], s24 offen offset:1024 lds
 buffer_load_dwordx4 v2, s[4:7], s24 offen offset:2048 lds
 buffer_load_dwordx4 v2, s[4:7], s24 offen offset:3072 lds
 s_mov_b32 m0, 0x22000
 s_mov_b32 s24, 0x2f000
 buffer_load_dwordx4 v2, s[4:7], s24 offen offset:0 lds
 buffer_load_dwordx4 v2, s[4:7], s24 offen offset:1024 lds
 buffer_load_dwordx4 v2, s[4:7], s24 offen offset:2048 lds
 buffer_load_dwordx4 v2, s[4:7], s24 offen offset:3072 lds
 s_mov_b32 m0, 0x23000
 s_mov_b32 s24, 0x30000
 buffer_load_dwordx4 v2, s[4:7], s24 offen offset:0 lds
 buffer_load_dwordx4 v2, s[4:7], s24 offen offset:1024 lds
 buffer_load_dwordx4 v2, s[4:7], s24 offen offset:2048 lds
 buffer_load_dwordx4 v2, s[4:7], s24 offen offset:3072 lds
 s_waitcnt vmcnt(24)
 s_barrier
 s_mov_b32 m0, 0xc000
 s_mov_b32 s24, 0x34000
 buffer_load_dwordx4 v2, s[4:7], s24 offen offset:0 lds
 buffer_load_dwordx4 v2, s[4:7], s24 offen offset:1024 lds
 buffer_load_dwordx4 v2, s[4:7], s24 offen offset:2048 lds
 buffer_load_dwordx4 v2, s[4:7], s24 offen offset:3072 lds
 s_mov_b32 m0, 0xd000
 s_mov_b32 s24, 0x35000
 buffer_load_dwordx4 v2, s[4:7], s24 offen offset:0 lds
 buffer_load_dwordx4 v2, s[4:7], s24 offen offset:1024 lds
 buffer_load_dwordx4 v2, s[4:7], s24 offen offset:2048 lds
 buffer_load_dwordx4 v2, s[4:7], s24 offen offset:3072 lds
 s_mov_b32 m0, 0xe000
 s_mov_b32 s24, 0x36000
 buffer_load_dwordx4 v2, s[4:7], s24 offen offset:0 lds
 buffer_load_dwordx4 v2, s[4:7], s24 offen offset:1024 lds
 buffer_load_dwordx4 v2, s[4:7], s24 offen offset:2048 lds
 buffer_load_dwordx4 v2, s[4:7], s24 offen offset:3072 lds
 s_waitcnt vmcnt(24)
 s_barrier
 s_mov_b32 m0, 0x12000
 s_mov_b32 s24, 0x3a000
 buffer_load_dwordx4 v2, s[4:7], s24 offen offset:0 lds
 buffer_load_dwordx4 v2, s[4:7], s24 offen offset:1024 lds
 buffer_load_dwordx4 v2, s[4:7], s24 offen offset:2048 lds
 buffer_load_dwordx4 v2, s[4:7], s24 offen offset:3072 lds
 s_mov_b32 m0, 0x13000
 s_mov_b32 s24, 0x3b000
 buffer_load_dwordx4 v2, s[4:7], s24 offen offset:0 lds
 buffer_load_dwordx4 v2, s[4:7], s24 offen offset:1024 lds
 buffer_load_dwordx4 v2, s[4:7], s24 offen offset:2048 lds
 buffer_load_dwordx4 v2, s[4:7], s24 offen offset:3072 lds
 s_mov_b32 m0, 0x14000
 s_mov_b32 s24, 0x3c000
 buffer_load_dwordx4 v2, s[4:7], s24 offen offset:0 lds
 buffer_load_dwordx4 v2, s[4:7], s24 offen offset:1024 lds
 buffer_load_dwordx4 v2, s[4:7], s24 offen offset:2048 lds
 buffer_load_dwordx4 v2, s[4:7], s24 offen offset:3072 lds
 s_waitcnt vmcnt(24)
 s_barrier
 s_mov_b32 m0, 0x18000
 s_mov_b32 s24, 0x40000
 buffer_load_dwordx4 v2, s[4:7], s24 offen offset:0 lds
 buffer_load_dwordx4 v2, s[4:7], s24 offen offset:1024 lds
 buffer_load_dwordx4 v2, s[4:7], s24 offen offset:2048 lds
 buffer_load_dwordx4 v2, s[4:7], s24 offen offset:3072 lds
 s_mov_b32 m0, 0x19000
 s_mov_b32 s24, 0x41000
 buffer_load_dwordx4 v2, s[4:7], s24 offen offset:0 lds
 buffer_load_dwordx4 v2, s[4:7], s24 offen offset:1024 lds
 buffer_load_dwordx4 v2, s[4:7], s24 offen offset:2048 lds
 buffer_load_dwordx4 v2, s[4:7], s24 offen offset:3072 lds
 s_mov_b32 m0, 0x1a000
 s_mov_b32 s24, 0x42000
 buffer_load_dwordx4 v2, s[4:7], s24 offen offset:0 lds
 buffer_load_dwordx4 v2, s[4:7], s24 offen offset:1024 lds
 buffer_load_dwordx4 v2, s[4:7], s24 offen offset:2048 lds
 buffer_load_dwordx4 v2, s[4:7], s24 offen offset:3072 lds
 s_waitcnt vmcnt(24)
 s_barrier
 s_mov_b32 m0, 0x1e000
 s_mov_b32 s24, 0x46000
 buffer_load_dwordx4 v2, s[4:7], s24 offen offset:0 lds
 buffer_load_dwordx4 v2, s[4:7], s24 offen offset:1024 lds
 buffer_load_dwordx4 v2, s[4:7], s24 offen offset:2048 lds
 buffer_load_dwordx4 v2, s[4:7], s24 offen offset:3072 lds
 s_mov_b32 m0, 0x1f000
 s_mov_b32 s24, 0x47000
 buffer_load_dwordx4 v2, s[4:7], s24 offen offset:0 lds
 buffer_load_dwordx4 v2, s[4:7], s24 offen offset:1024 lds
 buffer_load_dwordx4 v2, s[4:7], s24 offen offset:2048 lds
 buffer_load_dwordx4 v2, s[4:7], s24 offen offset:3072 lds
 s_mov_b32 m0, 0x20000
 s_mov_b32 s24, 0x48000
 buffer_load_dwordx4 v2, s[4:7], s24 offen offset:0 lds
 buffer_load_dwordx4 v2, s[4:7], s24 offen offset:1024 lds
 buffer_load_dwordx4 v2, s[4:7], s24 offen offset:2048 lds
 buffer_load_dwordx4 v2, s[4:7], s24 offen offset:3072 lds
 s_waitcnt vmcnt(24)
 s_barrier
 s_mov_b32 m0, 0x24000
 s_mov_b32 s24, 0x4c000
 buffer_load_dwordx4 v2, s[4:7], s24 offen offset:0 lds
 buffer_load_dwordx4 v2, s[4:7], s24 offen offset:1024 lds
 buffer_load_dwordx4 v2, s[4:7], s24 offen offset:2048 lds
 buffer_load_dwordx4 v2, s[4:7], s24 offen offset:3072 lds
 s_mov_b32 m0, 0x25000
 s_mov_b32 s24, 0x4d000
 buffer_load_dwordx4 v2, s[4:7], s24 offen offset:0 lds
 buffer_load_dwordx4 v2, s[4:7], s24 offen offset:1024 lds
 buffer_load_dwordx4 v2, s[4:7], s24 offen offset:2048 lds
 buffer_load_dwordx4 v2, s[4:7], s24 offen offset:3072 lds
 s_mov_b32 m0, 0x26000
 s_mov_b32 s24, 0x4e000
 buffer_load_dwordx4 v2, s[4:7], s24 offen offset:0 lds
 buffer_load_dwordx4 v2, s[4:7], s24 offen offset:1024 lds
 buffer_load_dwordx4 v2, s[4:7], s24 offen offset:2048 lds
 buffer_load_dwordx4 v2, s[4:7], s24 offen offset:3072 lds
 s_waitcnt vmcnt(24)
 s_barrier
 s_mov_b32 m0, 0xf000
 s_mov_b32 s24, 0x52000
 buffer_load_dwordx4 v2, s[4:7], s24 offen offset:0 lds
 buffer_load_dwordx4 v2, s[4:7], s24 offen offset:1024 lds
 buffer_load_dwordx4 v2, s[4:7], s24 offen offset:2048 lds
 buffer_load_dwordx4 v2, s[4:7], s24 offen offset:3072 lds
 s_mov_b32 m0, 0x10000
 s_mov_b32 s24, 0x53000
 buffer_load_dwordx4 v2, s[4:7], s24 offen offset:0 lds
 buffer_load_dwordx4 v2, s[4:7], s24 offen offset:1024 lds
 buffer_load_dwordx4 v2, s[4:7], s24 offen offset:2048 lds
 buffer_load_dwordx4 v2, s[4:7], s24 offen offset:3072 lds
 s_mov_b32 m0, 0x11000
 s_mov_b32 s24, 0x54000
 buffer_load_dwordx4 v2, s[4:7], s24 offen offset:0 lds
 buffer_load_dwordx4 v2, s[4:7], s24 offen offset:1024 lds
 buffer_load_dwordx4 v2, s[4:7], s24 offen offset:2048 lds
 buffer_load_dwordx4 v2, s[4:7], s24 offen offset:3072 lds
 s_mov_b32 m0, 0x13800
 s_mov_b32 s24, 0x56400
 buffer_load_dwordx4 v2, s[4:7], s24 offen offset:0 lds
 buffer_load_dwordx4 v2, s[4:7], s24 offen offset:1024 lds
 buffer_load_dwordx4 v2, s[4:7], s24 offen offset:2048 lds
 buffer_load_dwordx4 v2, s[4:7], s24 offen offset:3072 lds
 s_mov_b32 m0, 0x14800
 s_mov_b32 s24, 0x57400
 buffer_load_dwordx4 v2, s[4:7], s24 offen offset:0 lds
 s_waitcnt vmcnt(29)
 s_barrier
 s_mov_b32 m0, 0x16000
 s_mov_b32 s24, 0x58c00
 buffer_load_dwordx4 v2, s[4:7], s24 offen offset:0 lds
 buffer_load_dwordx4 v2, s[4:7], s24 offen offset:1024 lds
 buffer_load_dwordx4 v2, s[4:7], s24 offen offset:2048 lds
 buffer_load_dwordx4 v2, s[4:7], s24 offen offset:3072 lds
 s_mov_b32 m0, 0x17000
 s_mov_b32 s24, 0x59c00
 buffer_load_dwordx4 v2, s[4:7], s24 offen offset:0 lds
 s_waitcnt vmcnt(22)
 s_barrier
 s_mov_b32 m0, 0x18800
 s_mov_b32 s24, 0x5b400
 buffer_load_dwordx4 v2, s[4:7], s24 offen offset:0 lds
 buffer_load_dwordx4 v2, s[4:7], s24 offen offset:1024 lds
 buffer_load_dwordx4 v2, s[4:7], s24 offen offset:2048 lds
 buffer_load_dwordx4 v2, s[4:7], s24 offen offset:3072 lds
 s_mov_b32 m0, 0x19800
 s_mov_b32 s24, 0x5c400
 buffer_load_dwordx4 v2, s[4:7], s24 offen offset:0 lds
 s_waitcnt vmcnt(15)
 s_barrier
 s_mov_b32 m0, 0x1b000
 s_mov_b32 s24, 0x5dc00
 buffer_load_dwordx4 v2, s[4:7], s24 offen offset:0 lds
 buffer_load_dwordx4 v2, s[4:7], s24 offen offset:1024 lds
 buffer_load_dwordx4 v2, s[4:7], s24 offen offset:2048 lds
 buffer_load_dwordx4 v2, s[4:7], s24 offen offset:3072 lds
 s_mov_b32 m0, 0x1c000
 s_mov_b32 s24, 0x5ec00
 buffer_load_dwordx4 v2, s[4:7], s24 offen offset:0 lds
 s_barrier
 s_mov_b32 m0, 0x1d800
 s_mov_b32 s24, 0x60400
 buffer_load_dwordx4 v2, s[4:7], s24 offen offset:0 lds
 buffer_load_dwordx4 v2, s[4:7], s24 offen offset:1024 lds
 buffer_load_dwordx4 v2, s[4:7], s24 offen offset:2048 lds
 buffer_load_dwordx4 v2, s[4:7], s24 offen offset:3072 lds
 s_mov_b32 m0, 0x1e800
 s_mov_b32 s24, 0x61400
 buffer_load_dwordx4 v2, s[4:7], s24 offen offset:0 lds
 s_mov_b32 m0, 0x20000
 s_mov_b32 s24, 0x62c00
 buffer_load_dwordx4 v2, s[4:7], s24 offen offset:0 lds
 buffer_load_dwordx4 v2, s[4:7], s24 offen offset:1024 lds
 buffer_load_dwordx4 v2, s[4:7], s24 offen offset:2048 lds
 buffer_load_dwordx4 v2, s[4:7], s24 offen offset:3072 lds
 s_mov_b32 m0, 0x21000
 s_mov_b32 s24, 0x63c00
 buffer_load_dwordx4 v2, s[4:7], s24 offen offset:0 lds
 s_mov_b32 m0, 0x22800
 s_mov_b32 s24, 0x65400
 buffer_load_dwordx4 v2, s[4:7], s24 offen offset:0 lds
 buffer_load_dwordx4 v2, s[4:7], s24 offen offset:1024 lds
 buffer_load_dwordx4 v2, s[4:7], s24 offen offset:2048 lds
 buffer_load_dwordx4 v2, s[4:7], s24 offen offset:3072 lds
 s_mov_b32 m0, 0x23800
 s_mov_b32 s24, 0x66400
 buffer_load_dwordx4 v2, s[4:7], s24 offen offset:0 lds
 s_mov_b32 m0, 0x25000
 s_mov_b32 s24, 0x67c00
 buffer_load_dwordx4 v2, s[4:7], s24 offen offset:0 lds
 buffer_load_dwordx4 v2, s[4:7], s24 offen offset:1024 lds
 buffer_load_dwordx4 v2, s[4:7], s24 offen offset:2048 lds
 buffer_load_dwordx4 v2, s[4:7], s24 offen offset:3072 lds
 s_mov_b32 m0, 0x26000
 s_mov_b32 s24, 0x68c00
 buffer_load_dwordx4 v2, s[4:7], s24 offen offset:0 lds
 s_mov_b32 m0, 0xc000
 s_mov_b32 s24, 0x6a400
 buffer_load_dwordx4 v2, s[4:7], s24 offen offset:0 lds
 buffer_load_dwordx4 v2, s[4:7], s24 offen offset:1024 lds
 buffer_load_dwordx4 v2, s[4:7], s24 offen offset:2048 lds
 buffer_load_dwordx4 v2, s[4:7], s24 offen offset:3072 lds
 s_mov_b32 m0, 0xd000
 s_mov_b32 s24, 0x6b400
 buffer_load_dwordx4 v2, s[4:7], s24 offen offset:0 lds
 s_mov_b32 m0, 0xe800
 s_mov_b32 s24, 0x6cc00
 buffer_load_dwordx4 v2, s[4:7], s24 offen offset:0 lds
 buffer_load_dwordx4 v2, s[4:7], s24 offen offset:1024 lds
 buffer_load_dwordx4 v2, s[4:7], s24 offen offset:2048 lds
 buffer_load_dwordx4 v2, s[4:7], s24 offen offset:3072 lds
 s_mov_b32 m0, 0xf800
 s_mov_b32 s24, 0x6dc00
 buffer_load_dwordx4 v2, s[4:7], s24 offen offset:0 lds
 s_mov_b32 m0, 0x11000
 s_mov_b32 s24, 0x6f400
 buffer_load_dwordx4 v2, s[4:7], s24 offen offset:0 lds
 buffer_load_dwordx4 v2, s[4:7], s24 offen offset:1024 lds
 buffer_load_dwordx4 v2, s[4:7], s24 offen offset:2048 lds
 buffer_load_dwordx4 v2, s[4:7], s24 offen offset:3072 lds
 s_mov_b32 m0, 0x12000
 s_mov_b32 s24, 0x70400
 buffer_load_dwordx4 v2, s[4:7], s24 offen offset:0 lds
 s_waitcnt vmcnt(50)
 s_barrier
 s_waitcnt vmcnt(45)
 s_barrier
 s_waitcnt vmcnt(40)
 s_barrier
 s_waitcnt vmcnt(35)
 s_barrier
 s_waitcnt vmcnt(30)
 s_barrier
 s_waitcnt vmcnt(25)
 s_barrier
 s_waitcnt vmcnt(20)
 s_barrier
 s_mov_b32 m0, 0x13800
 s_mov_b32 s24, 0x71c00
 buffer_load_dwordx4 v2, s[4:7], s24 offen offset:0 lds
 buffer_load_dwordx4 v2, s[4:7], s24 offen offset:1024 lds
 buffer_load_dwordx4 v2, s[4:7], s24 offen offset:2048 lds
 buffer_load_dwordx4 v2, s[4:7], s24 offen offset:3072 lds
 s_mov_b32 m0, 0x14800
 s_mov_b32 s24, 0x72c00
 buffer_load_dwordx4 v2, s[4:7], s24 offen offset:0 lds
 s_waitcnt vmcnt(20)
 s_barrier
 s_mov_b32 m0, 0x16000
 s_mov_b32 s24, 0x74400
 buffer_load_dwordx4 v2, s[4:7], s24 offen offset:0 lds
 buffer_load_dwordx4 v2, s[4:7], s24 offen offset:1024 lds
 buffer_load_dwordx4 v2, s[4:7], s24 offen offset:2048 lds
 buffer_load_dwordx4 v2, s[4:7], s24 offen offset:3072 lds
 s_mov_b32 m0, 0x17000
 s_mov_b32 s24, 0x75400
 buffer_load_dwordx4 v2, s[4:7], s24 offen offset:0 lds
 s_waitcnt vmcnt(20)
 s_barrier
 s_mov_b32 m0, 0x18800
 s_mov_b32 s24, 0x76c00
 buffer_load_dwordx4 v2, s[4:7], s24 offen offset:0 lds
 buffer_load_dwordx4 v2, s[4:7], s24 offen offset:1024 lds
 buffer_load_dwordx4 v2, s[4:7], s24 offen offset:2048 lds
 buffer_load_dwordx4 v2, s[4:7], s24 offen offset:3072 lds
 s_mov_b32 m0, 0x19800
 s_mov_b32 s24, 0x77c00
 buffer_load_dwordx4 v2, s[4:7], s24 offen offset:0 lds
 s_waitcnt vmcnt(20)
 s_barrier
 s_mov_b32 m0, 0x1b000
 s_mov_b32 s24, 0x79400
 buffer_load_dwordx4 v2, s[4:7], s24 offen offset:0 lds
 buffer_load_dwordx4 v2, s[4:7], s24 offen offset:1024 lds
 buffer_load_dwordx4 v2, s[4:7], s24 offen offset:2048 lds
 buffer_load_dwordx4 v2, s[4:7], s24 offen offset:3072 lds
 s_mov_b32 m0, 0x1c000
 s_mov_b32 s24, 0x7a400
 buffer_load_dwordx4 v2, s[4:7], s24 offen offset:0 lds
 s_waitcnt vmcnt(20)
 s_barrier
 s_mov_b32 m0, 0x1d800
 s_mov_b32 s24, 0x7bc00
 buffer_load_dwordx4 v2, s[4:7], s24 offen offset:0 lds
 buffer_load_dwordx4 v2, s[4:7], s24 offen offset:1024 lds
 buffer_load_dwordx4 v2, s[4:7], s24 offen offset:2048 lds
 buffer_load_dwordx4 v2, s[4:7], s24 offen offset:3072 lds
 s_mov_b32 m0, 0x1e800
 s_mov_b32 s24, 0x7cc00
 buffer_load_dwordx4 v2, s[4:7], s24 offen offset:0 lds
 s_waitcnt vmcnt(20)
 s_barrier
 s_mov_b32 m0, 0x20000
 s_mov_b32 s24, 0x7e400
 buffer_load_dwordx4 v2, s[4:7], s24 offen offset:0 lds
 buffer_load_dwordx4 v2, s[4:7], s24 offen offset:1024 lds
 buffer_load_dwordx4 v2, s[4:7], s24 offen offset:2048 lds
 buffer_load_dwordx4 v2, s[4:7], s24 offen offset:3072 lds
 s_mov_b32 m0, 0x21000
 s_mov_b32 s24, 0x7f400
 buffer_load_dwordx4 v2, s[4:7], s24 offen offset:0 lds
 s_waitcnt vmcnt(20)
 s_barrier
 s_mov_b32 m0, 0x22800
 s_mov_b32 s24, 0x80c00
 buffer_load_dwordx4 v2, s[4:7], s24 offen offset:0 lds
 buffer_load_dwordx4 v2, s[4:7], s24 offen offset:1024 lds
 buffer_load_dwordx4 v2, s[4:7], s24 offen offset:2048 lds
 buffer_load_dwordx4 v2, s[4:7], s24 offen offset:3072 lds
 s_mov_b32 m0, 0x23800
 s_mov_b32 s24, 0x81c00
 buffer_load_dwordx4 v2, s[4:7], s24 offen offset:0 lds
 s_waitcnt vmcnt(20)
 s_barrier
 s_mov_b32 m0, 0x25000
 s_mov_b32 s24, 0x83400
 buffer_load_dwordx4 v2, s[4:7], s24 offen offset:0 lds
 buffer_load_dwordx4 v2, s[4:7], s24 offen offset:1024 lds
 buffer_load_dwordx4 v2, s[4:7], s24 offen offset:2048 lds
 buffer_load_dwordx4 v2, s[4:7], s24 offen offset:3072 lds
 s_mov_b32 m0, 0x26000
 s_mov_b32 s24, 0x84400
 buffer_load_dwordx4 v2, s[4:7], s24 offen offset:0 lds
 s_waitcnt vmcnt(20)
 s_barrier
 s_mov_b32 m0, 0xc000
 s_mov_b32 s24, 0x85c00
 buffer_load_dwordx4 v2, s[4:7], s24 offen offset:0 lds
 buffer_load_dwordx4 v2, s[4:7], s24 offen offset:1024 lds
 buffer_load_dwordx4 v2, s[4:7], s24 offen offset:2048 lds
 buffer_load_dwordx4 v2, s[4:7], s24 offen offset:3072 lds
 s_mov_b32 m0, 0xd000
 s_mov_b32 s24, 0x86c00
 buffer_load_dwordx4 v2, s[4:7], s24 offen offset:0 lds
 s_waitcnt vmcnt(20)
 s_barrier
 s_mov_b32 m0, 0xe800
 s_mov_b32 s24, 0x88400
 buffer_load_dwordx4 v2, s[4:7], s24 offen offset:0 lds
 buffer_load_dwordx4 v2, s[4:7], s24 offen offset:1024 lds
 buffer_load_dwordx4 v2, s[4:7], s24 offen offset:2048 lds
 buffer_load_dwordx4 v2, s[4:7], s24 offen offset:3072 lds
 s_mov_b32 m0, 0xf800
 s_mov_b32 s24, 0x89400
 buffer_load_dwordx4 v2, s[4:7], s24 offen offset:0 lds
 s_waitcnt vmcnt(20)
 s_barrier
 s_mov_b32 m0, 0x11000
 s_mov_b32 s24, 0x8ac00
 buffer_load_dwordx4 v2, s[4:7], s24 offen offset:0 lds
 buffer_load_dwordx4 v2, s[4:7], s24 offen offset:1024 lds
 buffer_load_dwordx4 v2, s[4:7], s24 offen offset:2048 lds
 buffer_load_dwordx4 v2, s[4:7], s24 offen offset:3072 lds
 s_mov_b32 m0, 0x12000
 s_mov_b32 s24, 0x8bc00
 buffer_load_dwordx4 v2, s[4:7], s24 offen offset:0 lds
 s_waitcnt vmcnt(20)
 s_barrier
 s_mov_b32 m0, 0x13800
 s_mov_b32 s24, 0x8d400
 buffer_load_dwordx4 v2, s[4:7], s24 offen offset:0 lds
 buffer_load_dwordx4 v2, s[4:7], s24 offen offset:1024 lds
 buffer_load_dwordx4 v2, s[4:7], s24 offen offset:2048 lds
 buffer_load_dwordx4 v2, s[4:7], s24 offen offset:3072 lds
 s_mov_b32 m0, 0x14800
 s_mov_b32 s24, 0x8e400
 buffer_load_dwordx4 v2, s[4:7], s24 offen offset:0 lds
 s_waitcnt vmcnt(20)
 s_barrier
 s_mov_b32 m0, 0x16000
 s_mov_b32 s24, 0x8fc00
 buffer_load_dwordx4 v2, s[4:7], s24 offen offset:0 lds
 buffer_load_dwordx4 v2, s[4:7], s24 offen offset:1024 lds
 buffer_load_dwordx4 v2, s[4:7], s24 offen offset:2048 lds
 buffer_load_dwordx4 v2, s[4:7], s24 offen offset:3072 lds
 s_mov_b32 m0, 0x17000
 s_mov_b32 s24, 0x90c00
 buffer_load_dwordx4 v2, s[4:7], s24 offen offset:0 lds
 s_waitcnt vmcnt(20)
 s_barrier
 s_waitcnt vmcnt(15)
 s_barrier
 s_waitcnt vmcnt(10)
 s_barrier
 s_waitcnt vmcnt(5)
 s_barrier
 s_waitcnt vmcnt(0)
 s_barrier
 s_barrier
 s_endpgm
C2_al:
 s_waitcnt lgkmcnt(0)
 s_sub_u32 s23, s20, 6
 s_lshl_b32 s25, s23, 12
 v_lshlrev_b32 v4, 4, v1
 s_lshl_b32 s26, s21, 2
 s_lshl_b32 s27, s23, 1
 s_add_u32 s26, s26, s27
 v_and_b32 v5, 31, v1
 v_lshlrev_b32 v5, 2, v5
 s_lshl_b32 s27, s21, 7
 v_add_u32 v5, s27, v5
 v_and_b32 v6, 15, v1
 v_lshlrev_b32 v6, 2, v6
 s_lshl_b32 s27, s23, 7
 s_add_u32 s27, s27, 161792
 v_add_u32 v6, s27, v6
 s_lshl_b32 s27, s26, 10
 v_add_u32 v7, s27, v4
 s_sub_u32 s38, s20, 4
 s_lshl_b32 s59, s22, 2
 s_add_u32 s59, s59, s38
 s_mul_i32 s58, s21, 81920
 s_mul_i32 s37, s59, 2560
 s_add_u32 s58, s58, s37
 s_add_u32 s56, s16, s58
 s_addc_u32 s57, s17, 0
 s_load_dword s40, s[56:57], 0
 s_load_dword s41, s[56:57], 32
 s_load_dword s42, s[56:57], 64
 s_load_dword s43, s[56:57], 96
 s_load_dword s44, s[56:57], 128
 s_load_dword s45, s[56:57], 160
 s_load_dword s46, s[56:57], 192
 s_load_dword s47, s[56:57], 224
 s_load_dword s48, s[56:57], 256
 s_load_dword s49, s[56:57], 288
 s_load_dword s50, s[56:57], 320
 s_load_dword s51, s[56:57], 352
 s_load_dword s52, s[56:57], 384
 s_load_dword s53, s[56:57], 416
 s_waitcnt lgkmcnt(0)
 s_load_dword s40, s[56:57], 448
 s_load_dword s41, s[56:57], 480
 s_load_dword s42, s[56:57], 512
 s_load_dword s43, s[56:57], 544
 s_load_dword s44, s[56:57], 576
 s_load_dword s45, s[56:57], 608
 s_load_dword s46, s[56:57], 640
 s_load_dword s47, s[56:57], 672
 s_load_dword s48, s[56:57], 704
 s_load_dword s49, s[56:57], 736
 s_load_dword s50, s[56:57], 768
 s_load_dword s51, s[56:57], 800
 s_load_dword s52, s[56:57], 832
 s_load_dword s53, s[56:57], 864
 s_waitcnt lgkmcnt(0)
 s_load_dword s40, s[56:57], 896
 s_load_dword s41, s[56:57], 928
 s_load_dword s42, s[56:57], 960
 s_load_dword s43, s[56:57], 992
 s_load_dword s44, s[56:57], 1024
 s_load_dword s45, s[56:57], 1056
 s_load_dword s46, s[56:57], 1088
 s_load_dword s47, s[56:57], 1120
 s_load_dword s48, s[56:57], 1152
 s_load_dword s49, s[56:57], 1184
 s_load_dword s50, s[56:57], 1216
 s_load_dword s51, s[56:57], 1248
 s_load_dword s52, s[56:57], 1280
 s_load_dword s53, s[56:57], 1312
 s_waitcnt lgkmcnt(0)
 s_load_dword s40, s[56:57], 1344
 s_load_dword s41, s[56:57], 1376
 s_load_dword s42, s[56:57], 1408
 s_load_dword s43, s[56:57], 1440
 s_load_dword s44, s[56:57], 1472
 s_load_dword s45, s[56:57], 1504
 s_load_dword s46, s[56:57], 1536
 s_load_dword s47, s[56:57], 1568
 s_load_dword s48, s[56:57], 1600
 s_load_dword s49, s[56:57], 1632
 s_load_dword s50, s[56:57], 1664
 s_load_dword s51, s[56:57], 1696
 s_load_dword s52, s[56:57], 1728
 s_load_dword s53, s[56:57], 1760
 s_waitcnt lgkmcnt(0)
 s_load_dword s40, s[56:57], 1792
 s_load_dword s41, s[56:57], 1824
 s_load_dword s42, s[56:57], 1856
 s_load_dword s43, s[56:57], 1888
 s_load_dword s44, s[56:57], 1920
 s_load_dword s45, s[56:57], 1952
 s_load_dword s46, s[56:57], 1984
 s_load_dword s47, s[56:57], 2016
 s_load_dword s48, s[56:57], 2048
 s_load_dword s49, s[56:57], 2080
 s_load_dword s50, s[56:57], 2112
 s_load_dword s51, s[56:57], 2144
 s_load_dword s52, s[56:57], 2176
 s_load_dword s53, s[56:57], 2208
 s_waitcnt lgkmcnt(0)
 s_load_dword s40, s[56:57], 2240
 s_load_dword s41, s[56:57], 2272
 s_load_dword s42, s[56:57], 2304
 s_load_dword s43, s[56:57], 2336
 s_load_dword s44, s[56:57], 2368
 s_load_dword s45, s[56:57], 2400
 s_load_dword s46, s[56:57], 2432
 s_load_dword s47, s[56:57], 2464
 s_load_dword s48, s[56:57], 2496
 s_load_dword s49, s[56:57], 2528
 s_lshr_b32 s58, s2, 3
 s_lshl_b32 s58, s58, 2
 s_add_u32 s58, s58, s38
 s_getpc_b64 s[56:57]
C2_pc9:
 s_sub_u32 s56, s56, C2_pc9-C2_start
 s_subb_u32 s57, s57, 0
 s_mul_i32 s58, s58, 32
 s_add_u32 s37, s58, 0
 s_min_u32 s37, s37, C2_end-C2_start
 s_load_dword s50, s[56:57], s37
 s_add_u32 s37, s58, 4096
 s_min_u32 s37, s37, C2_end-C2_start
 s_load_dword s51, s[56:57], s37
 s_add_u32 s37, s58, 8192
 s_min_u32 s37, s37, C2_end-C2_start
 s_load_dword s52, s[56:57], s37
 s_add_u32 s37, s58, 12288
 s_min_u32 s37, s37, C2_end-C2_start
 s_load_dword s53, s[56:57], s37
 s_waitcnt lgkmcnt(0)
 s_add_u32 s37, s58, 16384
 s_min_u32 s37, s37, C2_end-C2_start
 s_load_dword s40, s[56:57], s37
 s_add_u32 s37, s58, 20480
 s_min_u32 s37, s37, C2_end-C2_start
 s_load_dword s41, s[56:57], s37
 s_add_u32 s37, s58, 24576
 s_min_u32 s37, s37, C2_end-C2_start
 s_load_dword s42, s[56:57], s37
 s_add_u32 s37, s58, 28672
 s_min_u32 s37, s37, C2_end-C2_start
 s_load_dword s43, s[56:57], s37
 s_add_u32 s37, s58, 32768
 s_min_u32 s37, s37, C2_end-C2_start
 s_load_dword s44, s[56:57], s37
 s_waitcnt lgkmcnt(0)
 s_barrier
 s_mul_i32 s27, s26, 61440
 v_add_u32 v2, s27, v4
 v_add_u32 v3, 59392, v2
 s_mov_b32 s28, 0x6ef000
 s_mov_b32 s29, 20000
C2_poll0:
 buffer_load_dword v8, v5, s[4:7], s28 offen sc1
 s_sub_u32 s29, s29, 1
 s_waitcnt vmcnt(0)
 v_cmp_ne_u32 vcc, 1, v8
 s_cmp_eq_u32 s29, 0
 s_cbranch_scc1 C2_pollx0
 s_nop 1
 s_cbranch_vccnz C2_poll0
C2_pollx0:
 s_add_u32 m0, s25, 0x0
 s_mov_b32 s28, 0x117c000
 buffer_load_dwordx4 v2, s[4:7], s28 offen offset:0 sc1 lds
 buffer_load_dwordx4 v2, s[4:7], s28 offen offset:1024 sc1 lds
 buffer_load_dwordx4 v3, s[4:7], s28 offen offset:2048 sc1 lds
 buffer_load_dwordx4 v3, s[4:7], s28 offen offset:3072 sc1 lds
 s_add_u32 m0, s25, 0x2000
 s_mov_b32 s28, 0x117c800
 buffer_load_dwordx4 v2, s[4:7], s28 offen offset:0 sc1 lds
 buffer_load_dwordx4 v2, s[4:7], s28 offen offset:1024 sc1 lds
 buffer_load_dwordx4 v3, s[4:7], s28 offen offset:2048 sc1 lds
 buffer_load_dwordx4 v3, s[4:7], s28 offen offset:3072 sc1 lds
 s_add_u32 m0, s25, 0x4000
 s_mov_b32 s28, 0x117d000
 buffer_load_dwordx4 v2, s[4:7], s28 offen offset:0 sc1 lds
 buffer_load_dwordx4 v2, s[4:7], s28 offen offset:1024 sc1 lds
 buffer_load_dwordx4 v3, s[4:7], s28 offen offset:2048 sc1 lds
 buffer_load_dwordx4 v3, s[4:7], s28 offen offset:3072 sc1 lds
 s_add_u32 m0, s25, 0x6000
 s_mov_b32 s28, 0x117d800
 buffer_load_dwordx4 v2, s[4:7], s28 offen offset:0 sc1 lds
 buffer_load_dwordx4 v2, s[4:7], s28 offen offset:1024 sc1 lds
 buffer_load_dwordx4 v3, s[4:7], s28 offen offset:2048 sc1 lds
 buffer_load_dwordx4 v3, s[4:7], s28 offen offset:3072 sc1 lds
 s_add_u32 m0, s25, 0x8000
 s_mov_b32 s28, 0x117e000
 buffer_load_dwordx4 v2, s[4:7], s28 offen offset:0 sc1 lds
 buffer_load_dwordx4 v2, s[4:7], s28 offen offset:1024 sc1 lds
 buffer_load_dwordx4 v3, s[4:7], s28 offen offset:2048 sc1 lds
 buffer_load_dwordx4 v3, s[4:7], s28 offen offset:3072 sc1 lds
 s_add_u32 m0, s25, 0xa000
 s_mov_b32 s28, 0x117e800
 buffer_load_dwordx4 v2, s[4:7], s28 offen offset:0 sc1 lds
 buffer_load_dwordx4 v2, s[4:7], s28 offen offset:1024 sc1 lds
 buffer_load_dwordx4 v3, s[4:7], s28 offen offset:2048 sc1 lds
 buffer_load_dwordx4 v3, s[4:7], s28 offen offset:3072 sc1 lds
 s_waitcnt vmcnt(20)
 s_barrier
 s_waitcnt vmcnt(16)
 s_barrier
 s_waitcnt vmcnt(12)
 s_barrier
 s_add_u32 m0, s25, 0x0
 s_mov_b32 s28, 0x117f000
 buffer_load_dwordx4 v2, s[4:7], s28 offen offset:0 sc1 lds
 buffer_load_dwordx4 v2, s[4:7], s28 offen offset:1024 sc1 lds
 buffer_load_dwordx4 v3, s[4:7], s28 offen offset:2048 sc1 lds
 buffer_load_dwordx4 v3, s[4:7], s28 offen offset:3072 sc1 lds
 s_waitcnt vmcnt(12)
 s_barrier
 s_add_u32 m0, s25, 0x2000
 s_mov_b32 s28, 0x117f800
 buffer_load_dwordx4 v2, s[4:7], s28 offen offset:0 sc1 lds
 buffer_load_dwordx4 v2, s[4:7], s28 offen offset:1024 sc1 lds
 buffer_load_dwordx4 v3, s[4:7], s28 offen offset:2048 sc1 lds
 buffer_load_dwordx4 v3, s[4:7], s28 offen offset:3072 sc1 lds
 s_waitcnt vmcnt(12)
 s_barrier
 s_add_u32 m0, s25, 0x4000
 s_mov_b32 s28, 0x1180000
 buffer_load_dwordx4 v2, s[4:7], s28 offen offset:0 sc1 lds
 buffer_load_dwordx4 v2, s[4:7], s28 offen offset:1024 sc1 lds
 buffer_load_dwordx4 v3, s[4:7], s28 offen offset:2048 sc1 lds
 buffer_load_dwordx4 v3, s[4:7], s28 offen offset:3072 sc1 lds
 s_waitcnt vmcnt(12)
 s_barrier
 s_add_u32 m0, s25, 0x6000
 s_mov_b32 s28, 0x1180800
 buffer_load_dwordx4 v2, s[4:7], s28 offen offset:0 sc1 lds
 buffer_load_dwordx4 v2, s[4:7], s28 offen offset:1024 sc1 lds
 buffer_load_dwordx4 v3, s[4:7], s28 offen offset:2048 sc1 lds
 buffer_load_dwordx4 v3, s[4:7], s28 offen offset:3072 sc1 lds
 s_waitcnt vmcnt(12)
 s_barrier
 s_waitcnt vmcnt(8)
 s_barrier
 s_waitcnt vmcnt(4)
 s_barrier
 s_waitcnt vmcnt(0)
 s_barrier
 s_barrier
 s_mul_i32 s27, s26, 20480
 v_add_u32 v2, s27, v4
 v_add_u32 v3, 18432, v2
 s_mov_b32 s28, 0x6eb000
 s_mov_b32 s29, 20000
 v_lshlrev_b32 v20, 5, v1
 s_lshl_b32 s30, s23, 11
 s_add_u32 s30, s30, 0x6f1000
C2_poll1:
 buffer_load_dword v8, v5, s[4:7], s28 offen sc1
 buffer_load_dwordx4 v[12:15], v20, s[4:7], s30 offen sc1
 buffer_load_dwordx4 v[16:19], v20, s[4:7], s30 offen offset:16 sc1
 s_sub_u32 s29, s29, 1
 s_waitcnt vmcnt(0)
 v_and_b32 v8, v8, v12
 v_and_b32 v8, v8, v13
 v_and_b32 v8, v8, v14
 v_and_b32 v8, v8, v15
 v_and_b32 v8, v8, v16
 v_and_b32 v8, v8, v17
 v_and_b32 v8, v8, v18
 v_and_b32 v8, v8, v19
 v_cmp_ne_u32 vcc, 1, v8
 s_cmp_eq_u32 s29, 0
 s_cbranch_scc1 C2_pollx1
 s_nop 1
 s_cbranch_vccnz C2_poll1
C2_pollx1:
 s_mov_b32 s28, 0x1112000
 buffer_load_dwordx4 v[8:11], v7, s[4:7], s28 offen sc1
 buffer_load_dwordx4 v[12:15], v7, s[4:7], s28 offen offset:1024 sc1
 s_add_u32 m0, s25, 0x0
 s_mov_b32 s28, 0xbf2000
 buffer_load_dwordx4 v2, s[4:7], s28 offen offset:0 sc1 lds
 buffer_load_dwordx4 v2, s[4:7], s28 offen offset:1024 sc1 lds
 buffer_load_dwordx4 v3, s[4:7], s28 offen offset:2048 sc1 lds
 buffer_load_dwordx4 v3, s[4:7], s28 offen offset:3072 sc1 lds
 s_add_u32 m0, s25, 0x2000
 s_mov_b32 s28, 0xbf2800
 buffer_load_dwordx4 v2, s[4:7], s28 offen offset:0 sc1 lds
 buffer_load_dwordx4 v2, s[4:7], s28 offen offset:1024 sc1 lds
 buffer_load_dwordx4 v3, s[4:7], s28 offen offset:2048 sc1 lds
 buffer_load_dwordx4 v3, s[4:7], s28 offen offset:3072 sc1 lds
 s_add_u32 m0, s25, 0x4000
 s_mov_b32 s28, 0xbf3000
 buffer_load_dwordx4 v2, s[4:7], s28 offen offset:0 sc1 lds
 buffer_load_dwordx4 v2, s[4:7], s28 offen offset:1024 sc1 lds
 buffer_load_dwordx4 v3, s[4:7], s28 offen offset:2048 sc1 lds
 buffer_load_dwordx4 v3, s[4:7], s28 offen offset:3072 sc1 lds
 s_add_u32 m0, s25, 0x6000
 s_mov_b32 s28, 0xbf3800
 buffer_load_dwordx4 v2, s[4:7], s28 offen offset:0 sc1 lds
 buffer_load_dwordx4 v2, s[4:7], s28 offen offset:1024 sc1 lds
 buffer_load_dwordx4 v3, s[4:7], s28 offen offset:2048 sc1 lds
 buffer_load_dwordx4 v3, s[4:7], s28 offen offset:3072 sc1 lds
 s_add_u32 m0, s25, 0x8000
 s_mov_b32 s28, 0xbf4000
 buffer_load_dwordx4 v2, s[4:7], s28 offen offset:0 sc1 lds
 buffer_load_dwordx4 v2, s[4:7], s28 offen offset:1024 sc1 lds
 buffer_load_dwordx4 v3, s[4:7], s28 offen offset:2048 sc1 lds
 buffer_load_dwordx4 v3, s[4:7], s28 offen offset:3072 sc1 lds
 s_add_u32 m0, s25, 0xa000
 s_mov_b32 s28, 0xbf4800
 buffer_load_dwordx4 v2, s[4:7], s28 offen offset:0 sc1 lds
 buffer_load_dwordx4 v2, s[4:7], s28 offen offset:1024 sc1 lds
 buffer_load_dwordx4 v3, s[4:7], s28 offen offset:2048 sc1 lds
 buffer_load_dwordx4 v3, s[4:7], s28 offen offset:3072 sc1 lds
 s_waitcnt vmcnt(20)
 s_barrier
 v_add_f32 v8, v8, v10
 v_add_f32 v9, v9, v11
 v_add_f32 v12, v12, v14
 v_add_f32 v13, v13, v15
 v_mov_b32 v16, v8
 v_mov_b32 v17, v9
 v_mov_b32 v20, v12
 v_mov_b32 v21, v13
 v_permlane16_swap_b32 v8, v16
 v_permlane16_swap_b32 v9, v17
 v_permlane16_swap_b32 v12, v20
 v_permlane16_swap_b32 v13, v21
 v_add_f32 v8, v8, v16
 v_add_f32 v9, v9, v17
 v_add_f32 v12, v12, v20
 v_add_f32 v13, v13, v21
 v_mov_b32 v16, v8
 v_mov_b32 v17, v9
 v_mov_b32 v20, v12
 v_mov_b32 v21, v13
 v_permlane32_swap_b32 v8, v16
 v_permlane32_swap_b32 v9, v17
 v_permlane32_swap_b32 v12, v20
 v_permlane32_swap_b32 v13, v21
 v_add_f32 v8, v8, v16
 v_add_f32 v9, v9, v17
 v_add_f32 v12, v12, v20
 v_add_f32 v13, v13, v21
 v_mul_f32 v8, 0x3acccccd, v8
 v_mul_f32 v9, 0x3acccccd, v9
 v_mul_f32 v12, 0x3acccccd, v12
 v_mul_f32 v13, 0x3acccccd, v13
 v_fma_f32 v9, -v8, v8, v9
 v_fma_f32 v13, -v12, v12, v13
 v_max_f32 v9, 0, v9
 v_max_f32 v13, 0, v13
 v_add_f32 v10, 0x3727c5ac, v9
 v_add_f32 v14, 0x3727c5ac, v13
 v_rsq_f32 v10, v10
 v_rsq_f32 v14, v14
 v_mul_f32 v11, v10, v10
 v_mul_f32 v15, v14, v14
 v_mul_f32 v11, v9, v11
 v_mul_f32 v15, v13, v15
 v_add_f32 v11, 0x3727c5ac, v11
 v_add_f32 v15, 0x3727c5ac, v15
 v_rsq_f32 v11, v11
 v_rsq_f32 v15, v15
 v_mul_f32 v10, v10, v11
 v_mul_f32 v14, v14, v15
 v_mul_f32 v11, v8, v10
 v_mul_f32 v15, v12, v14
 s_mov_b64 exec, 0xffff
 ds_write_b32 v6, v10
 ds_write_b32 v6, v11 offset:256
 ds_write_b32 v6, v14 offset:64
 ds_write_b32 v6, v15 offset:320
 s_mov_b64 exec, -1
 s_waitcnt vmcnt(16)
 s_waitcnt lgkmcnt(0)
 s_barrier
 s_add_u32 m0, s25, 0x0
 s_mov_b32 s28, 0xbf5000
 buffer_load_dwordx4 v2, s[4:7], s28 offen offset:0 sc1 lds
 buffer_load_dwordx4 v2, s[4:7], s28 offen offset:1024 sc1 lds
 buffer_load_dwordx4 v3, s[4:7], s28 offen offset:2048 sc1 lds
 buffer_load_dwordx4 v3, s[4:7], s28 offen offset:3072 sc1 lds
 s_waitcnt vmcnt(16)
 s_barrier
 s_add_u32 m0, s25, 0x2000
 s_mov_b32 s28, 0xbf5800
 buffer_load_dwordx4 v2, s[4:7], s28 offen offset:0 sc1 lds
 buffer_load_dwordx4 v2, s[4:7], s28 offen offset:1024 sc1 lds
 buffer_load_dwordx4 v3, s[4:7], s28 offen offset:2048 sc1 lds
 buffer_load_dwordx4 v3, s[4:7], s28 offen offset:3072 sc1 lds
 s_waitcnt vmcnt(16)
 s_barrier
 s_add_u32 m0, s25, 0x4000
 s_mov_b32 s28, 0xbf6000
 buffer_load_dwordx4 v2, s[4:7], s28 offen offset:0 sc1 lds
 buffer_load_dwordx4 v2, s[4:7], s28 offen offset:1024 sc1 lds
 buffer_load_dwordx4 v3, s[4:7], s28 offen offset:2048 sc1 lds
 buffer_load_dwordx4 v3, s[4:7], s28 offen offset:3072 sc1 lds
 s_waitcnt vmcnt(16)
 s_barrier
 s_add_u32 m0, s25, 0x6000
 s_mov_b32 s28, 0xbf6800
 buffer_load_dwordx4 v2, s[4:7], s28 offen offset:0 sc1 lds
 buffer_load_dwordx4 v2, s[4:7], s28 offen offset:1024 sc1 lds
 buffer_load_dwordx4 v3, s[4:7], s28 offen offset:2048 sc1 lds
 buffer_load_dwordx4 v3, s[4:7], s28 offen offset:3072 sc1 lds
 s_waitcnt vmcnt(16)
 s_barrier
 s_waitcnt vmcnt(12)
 s_barrier
 s_waitcnt vmcnt(8)
 s_barrier
 s_waitcnt vmcnt(4)
 s_barrier
 s_waitcnt vmcnt(0)
 s_barrier
 s_barrier
 s_mul_i32 s27, s26, 61440
 v_add_u32 v2, s27, v4
 v_add_u32 v3, 59392, v2
 s_mov_b32 s28, 0x6ec000
 s_mov_b32 s29, 20000
C2_poll2:
 buffer_load_dword v8, v5, s[4:7], s28 offen sc1
 s_sub_u32 s29, s29, 1
 s_waitcnt vmcnt(0)
 v_cmp_ne_u32 vcc, 1, v8
 s_cmp_eq_u32 s29, 0
 s_cbranch_scc1 C2_pollx2
 s_nop 1
 s_cbranch_vccnz C2_poll2
C2_pollx2:
 s_add_u32 m0, s25, 0x0
 s_mov_b32 s28, 0x1172000
 buffer_load_dwordx4 v2, s[4:7], s28 offen offset:0 sc1 lds
 buffer_load_dwordx4 v2, s[4:7], s28 offen offset:1024 sc1 lds
 buffer_load_dwordx4 v3, s[4:7], s28 offen offset:2048 sc1 lds
 buffer_load_dwordx4 v3, s[4:7], s28 offen offset:3072 sc1 lds
 s_add_u32 m0, s25, 0x2000
 s_mov_b32 s28, 0x1172800
 buffer_load_dwordx4 v2, s[4:7], s28 offen offset:0 sc1 lds
 buffer_load_dwordx4 v2, s[4:7], s28 offen offset:1024 sc1 lds
 buffer_load_dwordx4 v3, s[4:7], s28 offen offset:2048 sc1 lds
 buffer_load_dwordx4 v3, s[4:7], s28 offen offset:3072 sc1 lds
 s_add_u32 m0, s25, 0x4000
 s_mov_b32 s28, 0x1173000
 buffer_load_dwordx4 v2, s[4:7], s28 offen offset:0 sc1 lds
 buffer_load_dwordx4 v2, s[4:7], s28 offen offset:1024 sc1 lds
 buffer_load_dwordx4 v3, s[4:7], s28 offen offset:2048 sc1 lds
 buffer_load_dwordx4 v3, s[4:7], s28 offen offset:3072 sc1 lds
 s_add_u32 m0, s25, 0x6000
 s_mov_b32 s28, 0x1173800
 buffer_load_dwordx4 v2, s[4:7], s28 offen offset:0 sc1 lds
 buffer_load_dwordx4 v2, s[4:7], s28 offen offset:1024 sc1 lds
 buffer_load_dwordx4 v3, s[4:7], s28 offen offset:2048 sc1 lds
 buffer_load_dwordx4 v3, s[4:7], s28 offen offset:3072 sc1 lds
 s_add_u32 m0, s25, 0x8000
 s_mov_b32 s28, 0x1174000
 buffer_load_dwordx4 v2, s[4:7], s28 offen offset:0 sc1 lds
 buffer_load_dwordx4 v2, s[4:7], s28 offen offset:1024 sc1 lds
 buffer_load_dwordx4 v3, s[4:7], s28 offen offset:2048 sc1 lds
 buffer_load_dwordx4 v3, s[4:7], s28 offen offset:3072 sc1 lds
 s_add_u32 m0, s25, 0xa000
 s_mov_b32 s28, 0x1174800
 buffer_load_dwordx4 v2, s[4:7], s28 offen offset:0 sc1 lds
 buffer_load_dwordx4 v2, s[4:7], s28 offen offset:1024 sc1 lds
 buffer_load_dwordx4 v3, s[4:7], s28 offen offset:2048 sc1 lds
 buffer_load_dwordx4 v3, s[4:7], s28 offen offset:3072 sc1 lds
 s_waitcnt vmcnt(20)
 s_barrier
 s_waitcnt vmcnt(16)
 s_barrier
 s_waitcnt vmcnt(12)
 s_barrier
 s_add_u32 m0, s25, 0x0
 s_mov_b32 s28, 0x1175000
 buffer_load_dwordx4 v2, s[4:7], s28 offen offset:0 sc1 lds
 buffer_load_dwordx4 v2, s[4:7], s28 offen offset:1024 sc1 lds
 buffer_load_dwordx4 v3, s[4:7], s28 offen offset:2048 sc1 lds
 buffer_load_dwordx4 v3, s[4:7], s28 offen offset:3072 sc1 lds
 s_waitcnt vmcnt(12)
 s_barrier
 s_add_u32 m0, s25, 0x2000
 s_mov_b32 s28, 0x1175800
 buffer_load_dwordx4 v2, s[4:7], s28 offen offset:0 sc1 lds
 buffer_load_dwordx4 v2, s[4:7], s28 offen offset:1024 sc1 lds
 buffer_load_dwordx4 v3, s[4:7], s28 offen offset:2048 sc1 lds
 buffer_load_dwordx4 v3, s[4:7], s28 offen offset:3072 sc1 lds
 s_waitcnt vmcnt(12)
 s_barrier
 s_add_u32 m0, s25, 0x4000
 s_mov_b32 s28, 0x1176000
 buffer_load_dwordx4 v2, s[4:7], s28 offen offset:0 sc1 lds
 buffer_load_dwordx4 v2, s[4:7], s28 offen offset:1024 sc1 lds
 buffer_load_dwordx4 v3, s[4:7], s28 offen offset:2048 sc1 lds
 buffer_load_dwordx4 v3, s[4:7], s28 offen offset:3072 sc1 lds
 s_waitcnt vmcnt(12)
 s_barrier
 s_add_u32 m0, s25, 0x6000
 s_mov_b32 s28, 0x1176800
 buffer_load_dwordx4 v2, s[4:7], s28 offen offset:0 sc1 lds
 buffer_load_dwordx4 v2, s[4:7], s28 offen offset:1024 sc1 lds
 buffer_load_dwordx4 v3, s[4:7], s28 offen offset:2048 sc1 lds
 buffer_load_dwordx4 v3, s[4:7], s28 offen offset:3072 sc1 lds
 s_waitcnt vmcnt(12)
 s_barrier
 s_add_u32 m0, s25, 0x8000
 s_mov_b32 s28, 0x1177000
 buffer_load_dwordx4 v2, s[4:7], s28 offen offset:0 sc1 lds
 buffer_load_dwordx4 v2, s[4:7], s28 offen offset:1024 sc1 lds
 buffer_load_dwordx4 v3, s[4:7], s28 offen offset:2048 sc1 lds
 buffer_load_dwordx4 v3, s[4:7], s28 offen offset:3072 sc1 lds
 s_waitcnt vmcnt(12)
 s_barrier
 s_add_u32 m0, s25, 0xa000
 s_mov_b32 s28, 0x1177800
 buffer_load_dwordx4 v2, s[4:7], s28 offen offset:0 sc1 lds
 buffer_load_dwordx4 v2, s[4:7], s28 offen offset:1024 sc1 lds
 buffer_load_dwordx4 v3, s[4:7], s28 offen offset:2048 sc1 lds
 buffer_load_dwordx4 v3, s[4:7], s28 offen offset:3072 sc1 lds
 s_waitcnt vmcnt(12)
 s_barrier
 s_add_u32 m0, s25, 0x0
 s_mov_b32 s28, 0x1178000
 buffer_load_dwordx4 v2, s[4:7], s28 offen offset:0 sc1 lds
 buffer_load_dwordx4 v2, s[4:7], s28 offen offset:1024 sc1 lds
 buffer_load_dwordx4 v3, s[4:7], s28 offen offset:2048 sc1 lds
 buffer_load_dwordx4 v3, s[4:7], s28 offen offset:3072 sc1 lds
 s_waitcnt vmcnt(12)
 s_barrier
 s_add_u32 m0, s25, 0x2000
 s_mov_b32 s28, 0x1178800
 buffer_load_dwordx4 v2, s[4:7], s28 offen offset:0 sc1 lds
 buffer_load_dwordx4 v2, s[4:7], s28 offen offset:1024 sc1 lds
 buffer_load_dwordx4 v3, s[4:7], s28 offen offset:2048 sc1 lds
 buffer_load_dwordx4 v3, s[4:7], s28 offen offset:3072 sc1 lds
 s_waitcnt vmcnt(12)
 s_barrier
 s_add_u32 m0, s25, 0x4000
 s_mov_b32 s28, 0x1179000
 buffer_load_dwordx4 v2, s[4:7], s28 offen offset:0 sc1 lds
 buffer_load_dwordx4 v2, s[4:7], s28 offen offset:1024 sc1 lds
 buffer_load_dwordx4 v3, s[4:7], s28 offen offset:2048 sc1 lds
 buffer_load_dwordx4 v3, s[4:7], s28 offen offset:3072 sc1 lds
 s_waitcnt vmcnt(12)
 s_barrier
 s_add_u32 m0, s25, 0x6000
 s_mov_b32 s28, 0x1179800
 buffer_load_dwordx4 v2, s[4:7], s28 offen offset:0 sc1 lds
 buffer_load_dwordx4 v2, s[4:7], s28 offen offset:1024 sc1 lds
 buffer_load_dwordx4 v3, s[4:7], s28 offen offset:2048 sc1 lds
 buffer_load_dwordx4 v3, s[4:7], s28 offen offset:3072 sc1 lds
 s_waitcnt vmcnt(12)
 s_barrier
 s_add_u32 m0, s25, 0x8000
 s_mov_b32 s28, 0x117a000
 buffer_load_dwordx4 v2, s[4:7], s28 offen offset:0 sc1 lds
 buffer_load_dwordx4 v2, s[4:7], s28 offen offset:1024 sc1 lds
 buffer_load_dwordx4 v3, s[4:7], s28 offen offset:2048 sc1 lds
 buffer_load_dwordx4 v3, s[4:7], s28 offen offset:3072 sc1 lds
 s_waitcnt vmcnt(12)
 s_barrier
 s_add_u32 m0, s25, 0xa000
 s_mov_b32 s28, 0x117a800
 buffer_load_dwordx4 v2, s[4:7], s28 offen offset:0 sc1 lds
 buffer_load_dwordx4 v2, s[4:7], s28 offen offset:1024 sc1 lds
 buffer_load_dwordx4 v3, s[4:7], s28 offen offset:2048 sc1 lds
 buffer_load_dwordx4 v3, s[4:7], s28 offen offset:3072 sc1 lds
 s_waitcnt vmcnt(12)
 s_barrier
 s_add_u32 m0, s25, 0x0
 s_mov_b32 s28, 0x117b000
 buffer_load_dwordx4 v2, s[4:7], s28 offen offset:0 sc1 lds
 buffer_load_dwordx4 v2, s[4:7], s28 offen offset:1024 sc1 lds
 buffer_load_dwordx4 v3, s[4:7], s28 offen offset:2048 sc1 lds
 buffer_load_dwordx4 v3, s[4:7], s28 offen offset:3072 sc1 lds
 s_waitcnt vmcnt(12)
 s_barrier
 s_add_u32 m0, s25, 0x2000
 s_mov_b32 s28, 0x117b800
 buffer_load_dwordx4 v2, s[4:7], s28 offen offset:0 sc1 lds
 buffer_load_dwordx4 v2, s[4:7], s28 offen offset:1024 sc1 lds
 buffer_load_dwordx4 v3, s[4:7], s28 offen offset:2048 sc1 lds
 buffer_load_dwordx4 v3, s[4:7], s28 offen offset:3072 sc1 lds
 s_waitcnt vmcnt(12)
 s_barrier
 s_add_u32 m0, s25, 0x4000
 s_mov_b32 s28, 0x117c000
 buffer_load_dwordx4 v2, s[4:7], s28 offen offset:0 sc1 lds
 buffer_load_dwordx4 v2, s[4:7], s28 offen offset:1024 sc1 lds
 buffer_load_dwordx4 v3, s[4:7], s28 offen offset:2048 sc1 lds
 buffer_load_dwordx4 v3, s[4:7], s28 offen offset:3072 sc1 lds
 s_waitcnt vmcnt(12)
 s_barrier
 s_add_u32 m0, s25, 0x6000
 s_mov_b32 s28, 0x117c800
 buffer_load_dwordx4 v2, s[4:7], s28 offen offset:0 sc1 lds
 buffer_load_dwordx4 v2, s[4:7], s28 offen offset:1024 sc1 lds
 buffer_load_dwordx4 v3, s[4:7], s28 offen offset:2048 sc1 lds
 buffer_load_dwordx4 v3, s[4:7], s28 offen offset:3072 sc1 lds
 s_waitcnt vmcnt(12)
 s_barrier
 s_add_u32 m0, s25, 0x8000
 s_mov_b32 s28, 0x117d000
 buffer_load_dwordx4 v2, s[4:7], s28 offen offset:0 sc1 lds
 buffer_load_dwordx4 v2, s[4:7], s28 offen offset:1024 sc1 lds
 buffer_load_dwordx4 v3, s[4:7], s28 offen offset:2048 sc1 lds
 buffer_load_dwordx4 v3, s[4:7], s28 offen offset:3072 sc1 lds
 s_waitcnt vmcnt(12)
 s_barrier
 s_add_u32 m0, s25, 0xa000
 s_mov_b32 s28, 0x117d800
 buffer_load_dwordx4 v2, s[4:7], s28 offen offset:0 sc1 lds
 buffer_load_dwordx4 v2, s[4:7], s28 offen offset:1024 sc1 lds
 buffer_load_dwordx4 v3, s[4:7], s28 offen offset:2048 sc1 lds
 buffer_load_dwordx4 v3, s[4:7], s28 offen offset:3072 sc1 lds
 s_waitcnt vmcnt(12)
 s_barrier
 s_waitcnt vmcnt(8)
 s_barrier
 s_waitcnt vmcnt(4)
 s_barrier
 s_waitcnt vmcnt(0)
 s_barrier
 s_barrier
 s_endpgm
C2_end:
 s_endpgm
.section .rodata,"a"
.p2align 6
.amdhsa_kernel interleave_layers__mha_block__mixer_channel_mlp__prompt_kernel
  .amdhsa_next_free_vgpr 256
  .amdhsa_next_free_sgpr 96
  .amdhsa_accum_offset 256
  .amdhsa_group_segment_fixed_size 0
  .amdhsa_kernarg_size 88
  .amdhsa_user_sgpr_count 2
  .amdhsa_user_sgpr_kernarg_segment_ptr 1
  .amdhsa_system_sgpr_workgroup_id_x 1
.end_amdhsa_kernel
.p2align 6
.amdhsa_kernel c1_kernel
  .amdhsa_next_free_vgpr 256
  .amdhsa_next_free_sgpr 96
  .amdhsa_accum_offset 256
  .amdhsa_group_segment_fixed_size 0
  .amdhsa_kernarg_size 88
  .amdhsa_user_sgpr_count 2
  .amdhsa_user_sgpr_kernarg_segment_ptr 1
  .amdhsa_system_sgpr_workgroup_id_x 1
.end_amdhsa_kernel
.p2align 6
.amdhsa_kernel c2_kernel
  .amdhsa_next_free_vgpr 256
  .amdhsa_next_free_sgpr 96
  .amdhsa_accum_offset 256
  .amdhsa_group_segment_fixed_size 0
  .amdhsa_kernarg_size 88
  .amdhsa_user_sgpr_count 2
  .amdhsa_user_sgpr_kernarg_segment_ptr 1
  .amdhsa_system_sgpr_workgroup_id_x 1
.end_amdhsa_kernel
```
